```python
import torch

def _softmax(x, axis=-1):
    return torch.softmax(x, dim=axis)
def _gelu(x):
    return torch.nn.functional.gelu(x, approximate="tanh")
def _silu(x):
    return torch.nn.functional.silu(x)
def _sigmoid(x):
    return torch.sigmoid(x)
def _layernorm(x, axis=-1, eps=1e-5):
    m = x.mean(dim=axis, keepdim=True)
    v = x.var(dim=axis, keepdim=True, unbiased=False)
    return (x - m) / torch.sqrt(v + eps)
def _scatter_add(tgt, idx, src, axis=0):
    return tgt.clone().index_add_(axis, idx, src)
def _segment_sum(src, seg, n):
    out = torch.zeros((n,) + src.shape[1:], dtype=src.dtype)
    return out.index_add_(0, seg, src)
def _pad(x, pw):
    flat = tuple(v for pair in reversed(pw) for v in pair)
    return torch.nn.functional.pad(x, flat)

kernel_name = 'interleave_layers__sliding_local_dilated__ssm_conv_s4__prompt'

def setup_inputs():

    _w = (lambda a: (lambda t: t.to(torch.bfloat16) if t.is_floating_point() else t)(torch.as_tensor(a)))
    def _A_setup():
        B, S, D = 1, 2048, 512
        return {
            "x": _w((lambda *s: torch.randn(*s, dtype=torch.bfloat16) * 0.05)(B, S, D)),
            "wqkv": _w((lambda *s: torch.randn(*s, dtype=torch.bfloat16) * 0.05)(D, 3 * D)),
            "wo": _w((lambda *s: torch.randn(*s, dtype=torch.bfloat16) * 0.05)(D, D)),
        }
    _A_in = _A_setup()

    def _B_setup():
        B, L, D, N = 1, 2048, 512, 128
        A_re = -(lambda _x: torch.exp(torch.as_tensor(_x)))((lambda *s: torch.randn(*s, dtype=torch.bfloat16) * 3.2)(D, N))
        A_im = torch.pi * (lambda *s: torch.randn(*s, dtype=torch.bfloat16) * 0.1)(D, N)
        B_re = (lambda *s: torch.randn(*s, dtype=torch.bfloat16) * 0.1)(D, N)
        B_im = (lambda *s: torch.randn(*s, dtype=torch.bfloat16) * 0.1)(D, N)
        C_re = (lambda *s: torch.randn(*s, dtype=torch.bfloat16) * 0.1)(D, N)
        C_im = (lambda *s: torch.randn(*s, dtype=torch.bfloat16) * 0.1)(D, N)
        log_dt = (lambda *s: torch.randn(*s, dtype=torch.bfloat16) * 0.1)(D) * 0.5 - 4.0
        Dskip = (lambda *s: torch.randn(*s, dtype=torch.bfloat16) * 0.1)(D)
        return {
            "u": _w((lambda *s: torch.randn(*s, dtype=torch.bfloat16) * 0.05)(B, L, D)),
            "A_re": _w(A_re),
            "A_im": _w(A_im),
            "B_re": _w(B_re),
            "B_im": _w(B_im),
            "C_re": _w(C_re),
            "C_im": _w(C_im),
            "log_dt": _w(log_dt),
            "Dskip": _w(Dskip),
        }
    _B_in = _B_setup()

    return {
        "A_x": _A_in["x"],
        "A_wqkv": _A_in["wqkv"],
        "A_wo": _A_in["wo"],
        "B_u": _B_in["u"],
        "B_A_re": _B_in["A_re"],
        "B_A_im": _B_in["A_im"],
        "B_B_re": _B_in["B_re"],
        "B_B_im": _B_in["B_im"],
        "B_C_re": _B_in["C_re"],
        "B_C_im": _B_in["C_im"],
        "B_log_dt": _B_in["log_dt"],
        "B_Dskip": _B_in["Dskip"],
    }

def reference(A_x, A_wqkv, A_wo, B_u, B_A_re, B_A_im, B_B_re, B_B_im, B_C_re, B_C_im, B_log_dt, B_Dskip):
    def _A_ref(x, wqkv, wo):
        B, S, D = x.shape
        H = 32; Dh = D // H
        W, dil = 8, 2
        qkv = (lambda x, *d: x.permute(*d))((x @ wqkv).reshape(B, S, 3, H, Dh), 2, 0, 3, 1, 4)
        q, k, v = qkv[0], qkv[1], qkv[2]
        scale = Dh ** -0.5
        pos = torch.arange(S)
        off = torch.arange(W) * dil
        idx = pos[:, None] - off[None, :]
        mask = idx >= 0
        idx_c = torch.where(mask, idx, 0).reshape(-1)
        kg = k[:, :, idx_c, :].reshape(B, H, S, W, Dh)
        vg = v[:, :, idx_c, :].reshape(B, H, S, W, Dh)
        logits = torch.einsum("bhsd,bhswd->bhsw", q, kg) * scale
        logits = torch.where(mask[None, None, :, :], logits, -1e9)
        attn = _softmax(logits, axis=-1)
        o = torch.einsum("bhsw,bhswd->bhsd", attn, vg)
        return (lambda x, *d: x.permute(*d))(o, 0, 2, 1, 3).reshape(B, S, D) @ wo

    def _B_ref(u, A_re, A_im, B_re, B_im, C_re, C_im, log_dt, Dskip):
        Bsz, L, D = u.shape
        dt = torch.exp(log_dt)[:, None]
        A = A_re + 1j * A_im
        Bc = B_re + 1j * B_im
        Cc = C_re + 1j * C_im
        logdA = dt * A
        dB = dt * Bc
        l = (lambda x, dt: x.to(dt))(torch.arange(L), A_re.dtype)
        P = torch.exp(logdA[:, :, None] * l[None, None, :])
        K = torch.einsum("dn,dnl,dn->dl", Cc, P, dB).real
        L2 = 2 * L
        Kp = _pad(K, ((0, 0), (0, L)))
        up = (lambda x, *d: x.permute(*d))(u, 0, 2, 1)
        up = _pad(up, ((0, 0), (0, 0), (0, L)))
        Kf = (lambda x, axes=(-2,-1): torch.fft.rfft2(x.float(), dim=axes))(Kp[:, None, :], axes=(-2, -1))
        Uf = (lambda x, axes=(-2,-1): torch.fft.rfft2(x.float(), dim=axes))(up[:, :, None, :], axes=(-2, -1))
        Yf = Uf * Kf[None, :, :, :]
        y = (lambda x, s, axes=(-2,-1): torch.fft.irfft2(x, s=s, dim=axes).to(torch.bfloat16))(Yf, (1, L2), axes=(-2, -1))[:, :, 0, :L]
        y = (lambda x, *d: x.permute(*d))(y, 0, 2, 1) + u * Dskip[None, None, :]
        return y

    x = A_x
    x = x + _A_ref(_layernorm(x, axis=-1), A_wqkv, A_wo)
    x = x + _B_ref(_layernorm(x, axis=-1), B_A_re, B_A_im, B_B_re, B_B_im, B_C_re, B_C_im, B_log_dt, B_Dskip)
    x = x + _A_ref(_layernorm(x, axis=-1), A_wqkv, A_wo)
    x = x + _B_ref(_layernorm(x, axis=-1), B_A_re, B_A_im, B_B_re, B_B_im, B_C_re, B_C_im, B_log_dt, B_Dskip)
    return x
```

```asm
; @launch kernel=att1_kernel grid=(512,1,1) block=(768,1,1) lds=163840
; @launch kernel=conv1_kernel grid=(256,1,1) block=(512,1,1) lds=110592
; @launch kernel=att2_kernel grid=(256,1,1) block=(768,1,1) lds=163840
; @launch kernel=conv2_kernel grid=(256,1,1) block=(512,1,1) lds=110592
.amdgcn_target "amdgcn-amd-amdhsa--gfx950"
.text
.globl att1_kernel
.p2align 8
.type att1_kernel,@function
att1_kernel:
    s_cmp_ge_u32 s2, 512
    s_cbranch_scc1 att_exit
    s_cmp_lt_u32 s2, 256
    s_cbranch_scc0 att_role
    s_cmp_lt_u32 s2, 16
    s_cbranch_scc0 kgen_body
    s_getpc_b64 s[22:23]
    v_lshlrev_b32 v2, 7, v0
    v_cmp_gt_u32 vcc, (text_end-att1_kernel-128)>>7, v0
    s_and_saveexec_b64 s[24:25], vcc
    s_cbranch_execz att_nocode
    global_load_dword v167, v2, s[22:23]
att_nocode:
    s_mov_b64 exec, s[24:25]
    s_branch kgen_body
att_role:
    s_sub_u32 s2, s2, 256
    s_load_dwordx2 s[16:17], s[0:1], 0
    s_load_dwordx2 s[18:19], s[0:1], 8
    s_load_dwordx2 s[14:15], s[0:1], 16
    s_load_dwordx4 s[56:59], s[0:1], 104
    s_mov_b32 s53, 0
    s_mov_b32 s52, 1
    s_branch att_body
.globl att2_kernel
.p2align 8
.type att2_kernel,@function
att2_kernel:
    s_cmp_ge_u32 s2, 256
    s_cbranch_scc1 att_exit
    s_load_dwordx2 s[16:17], s[0:1], 112
    s_load_dwordx2 s[18:19], s[0:1], 8
    s_load_dwordx2 s[14:15], s[0:1], 16
    s_load_dwordx4 s[56:59], s[0:1], 104
    s_mov_b32 s53, 4194304
    s_mov_b32 s52, 2
att_body:
    v_lshrrev_b32 v2, 6, v0
    s_and_b32 s22, s2, 7
    s_lshr_b32 s23, s2, 3
    v_readfirstlane_b32 s27, v2
    s_lshl_b32 s24, s22, 2
    s_lshr_b32 s25, s23, 3
    s_add_u32 s24, s24, s25
    s_and_b32 s25, s23, 7
    s_lshl_b32 s24, s24, 6
    v_and_b32 v1, 63, v0
    v_and_b32 v12, 15, v0
    v_lshrrev_b32 v13, 4, v1
    v_lshlrev_b32 v5, 4, v1
    s_cmp_lt_u32 s27, 4
    s_nop 1
    s_cbranch_scc1 att_compute
    s_setprio 3
    s_sub_u32 s28, s27, 4
    s_lshr_b32 s38, s28, 2
    s_and_b32 s39, s28, 3
    v_lshrrev_b32 v6, 3, v1
    s_cmp_eq_u32 s52, 2
    s_cbranch_scc1 att_ld_xt
    v_lshrrev_b32 v7, 4, v1
    s_and_b32 s29, s28, 1
    s_lshl_b32 s29, s29, 2
    v_xor_b32 v7, s29, v7
    v_and_b32 v2, 7, v1
    v_xor_b32 v2, v2, v7
    v_lshlrev_b32 v2, 4, v2
    s_lshl_b32 s29, s28, 3
    s_add_u32 s29, s29, s24
    s_sub_u32 s29, s29, 16
    v_add_u32 v3, s29, v6
    v_lshl_add_u32 v2, v3, 10, v2
    v_add_u32 v3, 0x10000, v2
    s_movk_i32 s26, 128
    s_movk_i32 s63, 128
    s_cmp_eq_u32 s28, 0
    s_cselect_b32 s40, 0xffffff00, -1
    s_nop 0
    s_branch att_ld_xdone
att_ld_xt:
    s_lshl_b32 s29, s28, 3
    v_add_u32 v7, s29, v6
    v_and_b32 v2, 0x33, v7
    v_bfe_u32 v8, v7, 2, 1
    v_lshl_add_u32 v2, v8, 3, v2
    v_bfe_u32 v8, v7, 3, 1
    v_lshl_add_u32 v2, v8, 2, v2
    v_lshlrev_b32 v2, 12, v2
    v_bfe_u32 v7, v1, 1, 2
    v_xor_b32 v7, v7, v13
    v_lshl_add_u32 v2, v7, 5, v2
    v_and_b32 v8, 1, v1
    v_lshl_add_u32 v2, v8, 4, v2
    s_lshl_b32 s29, s24, 1
    v_add_u32 v2, s29, v2
    s_lshl_b32 s29, s28, 5
    v_lshrrev_b32 v7, 1, v1
    v_add_u32 v7, s29, v7
    v_and_b32 v3, 0x33, v7
    v_bfe_u32 v9, v7, 2, 1
    v_lshl_add_u32 v3, v9, 3, v3
    v_bfe_u32 v9, v7, 3, 1
    v_lshl_add_u32 v3, v9, 2, v3
    v_lshlrev_b32 v3, 5, v3
    v_lshl_add_u32 v3, v8, 4, v3
    s_lshl_b32 s29, s24, 8
    s_add_u32 s29, s29, 8372224
    s_cmp_eq_u32 s24, 0
    s_cselect_b32 s29, 0x7f000000, s29
    v_add_u32 v3, s29, v3
    s_mov_b32 s63, 0x800
    s_mov_b32 s26, 0x40000
    s_mov_b32 s40, -1
    s_nop 0
att_ld_xdone:
    v_lshrrev_b32 v4, 2, v6
    v_lshlrev_b32 v4, 3, v4
    v_and_b32 v7, 3, v6
    v_add_u32 v4, v4, v7
    s_lshr_b32 s29, s39, 1
    s_lshl_b32 s29, s29, 4
    s_and_b32 s33, s39, 1
    s_lshl_b32 s33, s33, 2
    s_add_u32 s29, s29, s33
    s_lshl_b32 s33, s38, 5
    s_add_u32 s29, s29, s33
    v_add_u32 v4, s29, v4
    v_mul_u32_u24 v4, 3072, v4
    v_bfe_u32 v7, v1, 1, 2
    v_xor_b32 v7, v7, v13
    v_lshl_add_u32 v4, v7, 5, v4
    v_and_b32 v7, 1, v1
    v_lshl_add_u32 v4, v7, 4, v4
    s_lshl_b32 s29, s25, 7
    v_add_u32 v4, s29, v4
    s_mov_b32 s30, 0
    s_mov_b32 s62, 0
    s_mov_b32 s33, 0
    s_lshl_b32 s31, s33, 7
    s_mul_i32 s32, s33, 196608
    s_mul_i32 s50, s28, 3072
    s_add_u32 s50, s50, 10240
    s_lshl_b32 s51, s28, 10
    s_mov_b32 s41, -1
    s_mov_b32 s34, 0
    s_waitcnt lgkmcnt(0)
    s_mov_b64 s[20:21], s[58:59]
    s_mov_b64 s[54:55], s[14:15]
    s_add_u32 s4, s16, s53
    s_addc_u32 s5, s17, 0
    s_mov_b32 s6, 0x200000
    s_cmp_eq_u32 s52, 2
    s_cselect_b32 s6, 8912896, s6
    s_mov_b32 s7, 0x00020000
    s_mov_b32 s8, s18
    s_mov_b32 s9, s19
    s_mov_b32 s10, 0x00180000
    s_mov_b32 s11, 0x00020000
    s_add_u32 m0, s30, s51
    s_mov_b64 exec, s[40:41]
    buffer_load_dwordx4 v2, s[4:7], s31 offen lds
    s_mov_b64 exec, -1
    s_cmp_lt_u32 s28, 2
    s_cbranch_scc0 att_ld_nx_1
    s_add_u32 m0, m0, 8192
    s_nop 0
    buffer_load_dwordx4 v3, s[4:7], s62 offen lds
    s_add_u32 s62, s62, s63
att_ld_nx_1:
    s_add_u32 m0, s30, s50
    s_add_u32 s31, s31, s26
    buffer_load_dwordx4 v4, s[8:11], s32 offen lds
    buffer_load_dwordx4 v4, s[8:11], s32 offen offset:1024 lds
    buffer_load_dwordx4 v4, s[8:11], s32 offen offset:2048 lds
    s_add_u32 s32, s32, 196608
    s_add_u32 s30, s30, 34816
    s_cmp_ge_u32 s30, 104448
    s_cselect_b32 s30, 0, s30
    s_add_u32 m0, s30, s51
    s_mov_b64 exec, s[40:41]
    buffer_load_dwordx4 v2, s[4:7], s31 offen lds
    s_mov_b64 exec, -1
    s_cmp_lt_u32 s28, 2
    s_cbranch_scc0 att_ld_nx_2
    s_add_u32 m0, m0, 8192
    s_nop 0
    buffer_load_dwordx4 v3, s[4:7], s62 offen lds
    s_add_u32 s62, s62, s63
att_ld_nx_2:
    s_add_u32 m0, s30, s50
    s_add_u32 s31, s31, s26
    buffer_load_dwordx4 v4, s[8:11], s32 offen lds
    buffer_load_dwordx4 v4, s[8:11], s32 offen offset:1024 lds
    buffer_load_dwordx4 v4, s[8:11], s32 offen offset:2048 lds
    s_add_u32 s32, s32, 196608
    s_add_u32 s30, s30, 34816
    s_cmp_ge_u32 s30, 104448
    s_cselect_b32 s30, 0, s30
    s_mov_b32 s12, s54
    s_mov_b32 s13, s55
    s_mov_b32 s14, 0x00080000
    s_mov_b32 s15, 0x00020000
    v_lshrrev_b32 v14, 2, v6
    v_lshlrev_b32 v14, 3, v14
    v_and_b32 v7, 3, v6
    v_add_u32 v14, v14, v7
    s_lshr_b32 s29, s39, 1
    s_lshl_b32 s29, s29, 4
    s_and_b32 s33, s39, 1
    s_lshl_b32 s33, s33, 2
    s_add_u32 s29, s29, s33
    v_add_u32 v14, s29, v14
    v_lshlrev_b32 v14, 10, v14
    v_bfe_u32 v7, v1, 1, 2
    v_xor_b32 v7, v7, v13
    v_lshl_add_u32 v14, v7, 5, v14
    v_and_b32 v7, 1, v1
    v_lshl_add_u32 v14, v7, 4, v14
    s_and_b32 s33, s25, 3
    s_lshl_b32 s33, s33, 8
    s_lshl_b32 s29, s38, 7
    s_add_u32 s33, s33, s29
    v_add_u32 v14, s33, v14
    s_lshl_b32 s60, s39, 11
    s_lshl_b32 s33, s38, 10
    s_add_u32 s60, s60, s33
    s_add_u32 s60, s60, 106496
    s_mov_b32 s61, 0
    s_max_u32 s29, s28, 3
    s_sub_u32 s29, s29, 3
    v_lshrrev_b32 v10, 3, v12
    v_lshlrev_b32 v10, 10, v10
    v_and_b32 v9, 7, v12
    v_lshl_add_u32 v10, v9, 7, v10
    v_lshrrev_b32 v9, 1, v12
    v_xor_b32 v9, v9, v13
    v_lshl_add_u32 v10, v9, 4, v10
    s_lshl_b32 s33, s29, 11
    s_cmp_eq_u32 s52, 2
    s_cbranch_scc0 att_ld_sa
    v_lshrrev_b32 v10, 5, v1
    v_lshlrev_b32 v10, 4, v10
    v_bfe_u32 v9, v1, 2, 3
    v_add_u32 v10, v10, v9
    v_and_b32 v9, 3, v1
    v_lshlrev_b32 v9, 3, v9
    v_lshl_add_u32 v11, v10, 5, v9
    v_add_u32 v11, 0x2000, v11
    v_lshl_add_u32 v10, v10, 7, v9
    v_bfe_u32 v9, v1, 3, 2
    s_sub_u32 s33, s29, 1
    v_xor_b32 v9, s33, v9
    v_and_b32 v9, 3, v9
    v_lshl_add_u32 v10, v9, 5, v10
    s_cmp_eq_u32 s29, 0
    s_cselect_b64 s[46:47], -1, 0
    v_cndmask_b32 v10, v10, v11, s[46:47]
    s_cselect_b32 s45, 4, 16
    s_lshl_b32 s45, s45, 6
    v_add_u32 v11, s45, v10
    s_lshl_b32 s45, s45, 2
    s_mov_b32 s33, 0
att_ld_sa:
    v_add_u32 v8, s33, v10
    v_mov_b32 v24, 0x3f803f80
    v_mov_b32 v25, 0x3f803f80
    v_mov_b32 v26, 0x3f803f80
    v_mov_b32 v27, 0x3f803f80
    v_mov_b32 v28, 0x3f803f80
    v_mov_b32 v29, 0x3f803f80
    v_mov_b32 v30, 0x3f803f80
    v_mov_b32 v31, 0x3f803f80
    s_sub_u32 s44, s28, 3
    s_or_b32 s44, s44, s53
    s_cmp_eq_u32 s44, 0
    s_cselect_b32 s44, 1, 0
    s_mov_b32 s36, 0
    v_mov_b32 v40, 0
    v_mov_b32 v41, 0
    v_mov_b32 v42, 0
    v_mov_b32 v43, 0
    v_mov_b32 v44, 0
    v_mov_b32 v45, 0
    v_mov_b32 v46, 0
    v_mov_b32 v47, 0
    v_mov_b32 v16, 0x3f803f80
    v_mov_b32 v17, 0x3f803f80
    v_mov_b32 v18, 0x3f803f80
    v_mov_b32 v19, 0x3f803f80
    s_min_u32 s33, s39, 2
    s_mul_i32 s33, s33, 34816
    v_add_u32 v6, s33, v5
    s_cmp_eq_u32 s52, 2
    s_cbranch_scc1 att_ld_noones
    s_mov_b64 exec, 0xff
    ds_write_b128 v6, v[16:19]
    s_mov_b64 exec, -1
att_ld_noones:
    s_mov_b32 s34, 0
att_ld_main:
    s_waitcnt vmcnt(5) lgkmcnt(0)
    s_cmp_lt_u32 s28, 2
    s_cbranch_scc1 att_ld_w5
    s_waitcnt vmcnt(4)
att_ld_w5:
    s_barrier
    s_cmp_lt_u32 s28, 3
    s_cbranch_scc1 att_ld_nx_3_r
    v_add_u32 v6, s36, v8
    v_add_u32 v7, s36, v10
    s_cmp_eq_u32 s52, 2
    s_cbranch_scc1 att_ld_nx_3_t
    ds_read_b128 v[16:19], v6
    ds_read_b128 v[24:27], v7
    v_xor_b32 v6, 64, v6
    v_xor_b32 v7, 64, v7
    ds_read_b128 v[20:23], v6
    ds_read_b128 v[28:31], v7
    s_branch att_ld_nx_3_u
att_ld_nx_3_t:
    v_add_u32 v7, s36, v11
    ds_read_b64_tr_b16 v[16:17], v6
    ds_read_b64_tr_b16 v[18:19], v7
    v_add_u32 v6, s45, v6
    v_add_u32 v7, s45, v7
    ds_read_b64_tr_b16 v[20:21], v6
    ds_read_b64_tr_b16 v[22:23], v7
att_ld_nx_3_u:
    s_add_u32 s36, s36, 34816
    s_cmp_ge_u32 s36, 104448
    s_cselect_b32 s36, 0, s36
att_ld_nx_3_r:
    s_add_u32 m0, s30, s51
    s_mov_b64 exec, s[40:41]
    buffer_load_dwordx4 v2, s[4:7], s31 offen lds
    s_mov_b64 exec, -1
    s_cmp_lt_u32 s28, 2
    s_cbranch_scc0 att_ld_nx_3
    s_add_u32 m0, m0, 8192
    s_nop 0
    buffer_load_dwordx4 v3, s[4:7], s62 offen lds
    s_add_u32 s62, s62, s63
att_ld_nx_3:
    s_add_u32 m0, s30, s50
    s_add_u32 s31, s31, s26
    buffer_load_dwordx4 v4, s[8:11], s32 offen lds
    s_cmp_lt_u32 s28, 3
    s_cbranch_scc1 att_ld_nx_3_a
    s_waitcnt lgkmcnt(0)
    v_mfma_f32_16x16x32_bf16 v[40:43], v[16:19], v[16:19], v[40:43]
    v_mfma_f32_16x16x32_bf16 v[40:43], v[20:23], v[20:23], v[40:43]
    s_cmp_eq_u32 s44, 1
    s_cbranch_scc1 att_ld_nx_3_a
    v_mfma_f32_16x16x32_bf16 v[44:47], v[16:19], v[24:27], v[44:47]
    v_mfma_f32_16x16x32_bf16 v[44:47], v[20:23], v[28:31], v[44:47]
att_ld_nx_3_a:
    buffer_load_dwordx4 v4, s[8:11], s32 offen offset:1024 lds
    buffer_load_dwordx4 v4, s[8:11], s32 offen offset:2048 lds
    s_add_u32 s32, s32, 196608
    s_add_u32 s30, s30, 34816
    s_cmp_ge_u32 s30, 104448
    s_cselect_b32 s30, 0, s30
    s_add_u32 s34, s34, 1
    s_cmp_lt_u32 s34, 6
    s_cbranch_scc1 att_ld_main
    s_waitcnt vmcnt(4)
    s_barrier
    s_cmp_lt_u32 s28, 3
    s_cbranch_scc1 att_ld_nx_4_r
    v_add_u32 v6, s36, v8
    v_add_u32 v7, s36, v10
    s_cmp_eq_u32 s52, 2
    s_cbranch_scc1 att_ld_nx_4_t
    ds_read_b128 v[16:19], v6
    ds_read_b128 v[24:27], v7
    v_xor_b32 v6, 64, v6
    v_xor_b32 v7, 64, v7
    ds_read_b128 v[20:23], v6
    ds_read_b128 v[28:31], v7
    s_branch att_ld_nx_4_u
att_ld_nx_4_t:
    v_add_u32 v7, s36, v11
    ds_read_b64_tr_b16 v[16:17], v6
    ds_read_b64_tr_b16 v[18:19], v7
    v_add_u32 v6, s45, v6
    v_add_u32 v7, s45, v7
    ds_read_b64_tr_b16 v[20:21], v6
    ds_read_b64_tr_b16 v[22:23], v7
att_ld_nx_4_u:
    s_add_u32 s36, s36, 34816
    s_cmp_ge_u32 s36, 104448
    s_cselect_b32 s36, 0, s36
att_ld_nx_4_r:
    s_mov_b32 m0, s60
    s_add_u32 s60, s60, 8192
    buffer_load_dwordx4 v14, s[12:15], s61 offen lds
    s_add_u32 s61, s61, 32768
    s_mov_b32 m0, s60
    s_add_u32 s60, s60, 8192
    buffer_load_dwordx4 v14, s[12:15], s61 offen lds
    s_add_u32 s61, s61, 32768
    s_mov_b32 m0, s60
    s_add_u32 s60, s60, 8192
    buffer_load_dwordx4 v14, s[12:15], s61 offen lds
    s_add_u32 s61, s61, 32768
    s_mov_b32 m0, s60
    s_add_u32 s60, s60, 8192
    buffer_load_dwordx4 v14, s[12:15], s61 offen lds
    s_add_u32 s61, s61, 32768
    s_cmp_lt_u32 s28, 3
    s_cbranch_scc1 att_ld_nx_4_a
    s_waitcnt lgkmcnt(0)
    v_mfma_f32_16x16x32_bf16 v[40:43], v[16:19], v[16:19], v[40:43]
    v_mfma_f32_16x16x32_bf16 v[40:43], v[20:23], v[20:23], v[40:43]
    s_cmp_eq_u32 s44, 1
    s_cbranch_scc1 att_ld_nx_4_a
    v_mfma_f32_16x16x32_bf16 v[44:47], v[16:19], v[24:27], v[44:47]
    v_mfma_f32_16x16x32_bf16 v[44:47], v[20:23], v[28:31], v[44:47]
att_ld_nx_4_a:
    s_waitcnt vmcnt(4)
    s_barrier
    s_cmp_lt_u32 s28, 3
    s_cbranch_scc1 att_ld_nx_5_r
    v_add_u32 v6, s36, v8
    v_add_u32 v7, s36, v10
    s_cmp_eq_u32 s52, 2
    s_cbranch_scc1 att_ld_nx_5_t
    ds_read_b128 v[16:19], v6
    ds_read_b128 v[24:27], v7
    v_xor_b32 v6, 64, v6
    v_xor_b32 v7, 64, v7
    ds_read_b128 v[20:23], v6
    ds_read_b128 v[28:31], v7
    s_branch att_ld_nx_5_u
att_ld_nx_5_t:
    v_add_u32 v7, s36, v11
    ds_read_b64_tr_b16 v[16:17], v6
    ds_read_b64_tr_b16 v[18:19], v7
    v_add_u32 v6, s45, v6
    v_add_u32 v7, s45, v7
    ds_read_b64_tr_b16 v[20:21], v6
    ds_read_b64_tr_b16 v[22:23], v7
att_ld_nx_5_u:
    s_add_u32 s36, s36, 34816
    s_cmp_ge_u32 s36, 104448
    s_cselect_b32 s36, 0, s36
att_ld_nx_5_r:
    s_mov_b32 m0, s60
    s_add_u32 s60, s60, 8192
    buffer_load_dwordx4 v14, s[12:15], s61 offen lds
    s_add_u32 s61, s61, 32768
    s_mov_b32 m0, s60
    s_add_u32 s60, s60, 8192
    buffer_load_dwordx4 v14, s[12:15], s61 offen lds
    s_add_u32 s61, s61, 32768
    s_mov_b32 m0, s60
    s_add_u32 s60, s60, 8192
    buffer_load_dwordx4 v14, s[12:15], s61 offen lds
    s_add_u32 s61, s61, 32768
    s_cmp_lt_u32 s28, 3
    s_cbranch_scc1 att_ld_nx_5_a
    s_waitcnt lgkmcnt(0)
    v_mfma_f32_16x16x32_bf16 v[40:43], v[16:19], v[16:19], v[40:43]
    v_mfma_f32_16x16x32_bf16 v[40:43], v[20:23], v[20:23], v[40:43]
    s_cmp_eq_u32 s44, 1
    s_cbranch_scc1 att_ld_nx_5_a
    v_mfma_f32_16x16x32_bf16 v[44:47], v[16:19], v[24:27], v[44:47]
    v_mfma_f32_16x16x32_bf16 v[44:47], v[20:23], v[28:31], v[44:47]
att_ld_nx_5_a:
    s_cmp_eq_u32 s28, 0
    s_cbranch_scc0 att_ld_notag
    s_mov_b32 s8, s56
    s_mov_b32 s9, s57
    s_mov_b32 s10, 0x00000100
    s_mov_b32 s11, 0x00020000
    s_lshr_b32 s29, s24, 4
    v_mov_b32 v2, 0
    v_mov_b32 v3, 106432
    s_mov_b32 s35, 0
att_tagpoll:
    buffer_load_dword v15, v2, s[8:11], s29 offen sc1
    s_add_u32 s35, s35, 1
    s_waitcnt vmcnt(0)
    v_cmp_eq_u32 vcc, 0, v15
    s_cmp_gt_u32 s35, 0x40000
    s_cbranch_scc1 att_tagdone
    s_nop 3
    s_cbranch_vccnz att_tagpoll
att_tagdone:
    ds_write2_b32 v3, v15, v2 offset0:0 offset1:1
    ds_write_b32 v3, v2 offset:8
    s_waitcnt lgkmcnt(0)
att_ld_notag:
    s_cmp_lt_u32 s28, 3
    s_cbranch_scc1 att_ld_fin
    s_lshl_b32 s33, s29, 7
    s_add_u32 s33, s33, 105728
    v_lshlrev_b32 v6, 2, v12
    v_add_u32 v6, s33, v6
    v_lshlrev_b32 v7, 4, v13
    v_add_u32 v7, s33, v7
    v_and_b32 v16, 1, v12
    v_cmp_eq_u32 vcc, 1, v16
    v_and_b32 v16, 2, v12
    s_cmp_eq_u32 s44, 1
    s_cselect_b64 s[46:47], -1, 0
    v_cmp_eq_u32 s[44:45], 2, v16
    s_nop 4
    v_cndmask_b32 v16, v40, v41, vcc
    v_cndmask_b32 v17, v42, v43, vcc
    v_cndmask_b32 v20, v44, v40, s[46:47]
    v_cndmask_b32 v21, v45, v41, s[46:47]
    v_cndmask_b32 v22, v46, v42, s[46:47]
    v_cndmask_b32 v23, v47, v43, s[46:47]
    v_cndmask_b32 v16, v16, v17, s[44:45]
    s_mov_b32 s42, 0x00f0000f
    s_mov_b32 s43, 0xf0000f00
    s_mov_b64 exec, s[42:43]
    ds_write_b32 v6, v16 offset:64
    s_mov_b32 s42, 0x00010001
    s_mov_b32 s43, 0x00010001
    s_mov_b64 exec, s[42:43]
    ds_write_b128 v7, v[20:23]
    s_mov_b64 exec, -1
    s_waitcnt lgkmcnt(0)
    ds_read2_b32 v[40:41], v6 offset0:0 offset1:16
    s_waitcnt lgkmcnt(0)
    v_mul_f32 v40, 0x3b000000, v40
    v_mul_f32 v41, 0x3b000000, v41
    v_fma_f32 v41, -v40, v40, v41
    v_max_f32 v41, 0, v41
    v_cvt_pk_bf16_f32 v40, v40, v41
    v_and_b32 v17, 0xffff0000, v40
    v_lshlrev_b32 v16, 16, v40
    v_add_f32 v17, 0x3727c5ac, v17
    v_cvt_pk_bf16_f32 v17, v17, v17
    v_lshlrev_b32 v17, 16, v17
    v_sqrt_f32 v17, v17
    s_nop 0
    v_cvt_pk_bf16_f32 v17, v17, v17
    v_lshlrev_b32 v17, 16, v17
    v_rcp_f32 v17, v17
    s_lshl_b32 s33, s29, 4
    v_add_u32 v6, s33, v12
    v_lshlrev_b32 v7, 2, v6
    v_lshlrev_b32 v6, 3, v6
    v_add_u32 v6, 104448, v6
    v_add_u32 v7, 105088, v7
    ds_write_b64 v6, v[16:17]
    ds_write2_b32 v7, v16, v17 offset0:0 offset1:80
    s_waitcnt lgkmcnt(0)
att_ld_fin:
    s_barrier
    s_setprio 0
    s_mov_b32 s8, s20
    s_mov_b32 s9, s21
    s_mov_b32 s10, 0x01000000
    s_mov_b32 s11, 0x00020000
    s_sub_u32 s60, s60, 163840
att_wo:
    s_mov_b32 m0, s60
    s_add_u32 s60, s60, 8192
    buffer_load_dwordx4 v14, s[12:15], s61 offen lds
    s_add_u32 s61, s61, 32768
    s_cmp_lt_u32 s61, 524288
    s_cbranch_scc1 att_wo
    s_and_b32 s36, s25, 3
    s_lshr_b32 s37, s25, 2
    s_lshl_b32 s37, s37, 5
    s_add_u32 s37, s37, s24
    s_lshl_b32 s32, s36, 8
    s_and_b32 s33, s28, 1
    s_lshl_b32 s33, s33, 2
    v_xor_b32 v8, s33, v13
    v_bfe_u32 v9, v1, 1, 3
    v_xor_b32 v8, v8, v9
    v_lshlrev_b32 v8, 5, v8
    v_and_b32 v7, 1, v1
    v_lshl_add_u32 v8, v7, 4, v8
    v_lshl_add_u32 v8, v13, 10, v8
    s_lshl_b32 s33, s28, 2
    s_add_u32 s33, s33, s37
    s_lshl_b32 s33, s33, 10
    s_add_u32 s33, s33, s32
    s_cmp_eq_u32 s52, 2
    s_cbranch_scc0 att_resrm
    v_lshrrev_b32 v8, 2, v1
    v_lshlrev_b32 v8, 12, v8
    v_and_b32 v9, 3, v1
    v_lshl_add_u32 v8, v9, 4, v8
    s_lshl_b32 s33, s36, 19
    s_lshl_b32 s34, s28, 16
    s_add_u32 s33, s33, s34
    s_lshl_b32 s34, s37, 1
    s_add_u32 s33, s33, s34
att_resrm:
    buffer_load_dwordx4 v[32:35], v8, s[4:7], s33 offen
    v_lshrrev_b32 v6, 3, v1
    v_and_b32 v2, 7, v1
    v_xor_b32 v2, v2, v13
    v_lshrrev_b32 v9, 1, v2
    v_and_b32 v2, 1, v2
    v_lshlrev_b32 v2, 4, v2
    v_lshl_add_u32 v2, v9, 11, v2
    v_lshl_add_u32 v2, v6, 5, v2
    v_xor_b32 v3, 0x1000, v2
    s_lshl_b32 s33, s24, 10
    s_sub_u32 s34, s37, s24
    s_lshl_b32 s34, s34, 5
    s_add_u32 s33, s33, s34
    s_lshl_b32 s34, s28, 13
    s_add_u32 s33, s33, s34
    s_lshl_b32 s34, s28, 12
    s_add_u32 s34, s34, 73728
    v_add_u32 v9, s34, v5
    s_lshl_b32 s34, s28, 10
    s_add_u32 s34, s34, 106496
    v_add_u32 v10, s34, v5
    v_mov_b32 v11, 106432
    ds_read_b32 v11, v11
    s_lshl_b32 s34, s24, 5
    s_lshl_b32 s35, s28, 8
    s_add_u32 s34, s34, s35
    s_add_u32 s34, s34, 6815744
    s_getreg_b32 s35, hwreg(HW_REG_XCC_ID, 0, 3)
    s_or_b32 s35, s35, 8
    v_lshlrev_b32 v14, 2, v1
    v_add_u32 v14, 124, v14
    v_mov_b32 v7, 1
    v_mov_b32 v8, s35
    v_cmp_eq_u32 vcc, 0, v1
    s_nop 1
    v_cndmask_b32 v14, v14, v1, vcc
    v_cndmask_b32 v7, v7, v8, vcc
    s_mov_b32 s35, 0
    v_mov_b32 v12, 106440
    v_mov_b32 v13, 1
    s_waitcnt lgkmcnt(0)
    v_or_b32 v11, v11, v7
att_poll:
    s_add_u32 s35, s35, 1
    s_and_b32 s36, s35, 7
    s_cmp_eq_u32 s36, 0
    s_cselect_b64 exec, 0x1f, 1
    buffer_load_dword v15, v14, s[8:11], s34 offen sc1
    s_waitcnt vmcnt(0)
    v_cmp_eq_u32 vcc, v15, v11
    s_cmp_gt_u32 s35, 0x100000
    s_cbranch_scc1 att_nopoll
    s_nop 2
    s_bitcmp1_b32 vcc_lo, 0
    s_cbranch_scc1 att_gotlocal
    s_cmp_eq_u32 vcc_lo, 0x1e
    s_cbranch_scc0 att_poll
    s_add_u32 s33, s33, 14680064
    s_branch att_nopoll
att_gotlocal:
    s_mov_b64 exec, 1
    ds_add_u32 v12, v13
att_nopoll:
    s_mov_b64 exec, -1
    buffer_load_dwordx4 v[16:19], v2, s[8:11], s33 offen offset:0 sc1
    buffer_load_dwordx4 v[20:23], v3, s[8:11], s33 offen offset:256 sc1
    buffer_load_dwordx4 v[24:27], v2, s[8:11], s33 offen offset:512 sc1
    buffer_load_dwordx4 v[28:31], v3, s[8:11], s33 offen offset:768 sc1
    s_waitcnt lgkmcnt(0)
    s_barrier
    s_waitcnt vmcnt(3)
    ds_write_b128 v9, v[16:19] offset:0
    s_waitcnt vmcnt(2)
    ds_write_b128 v9, v[20:23] offset:1024
    s_waitcnt vmcnt(1)
    ds_write_b128 v9, v[24:27] offset:2048
    s_waitcnt vmcnt(0)
    ds_write_b128 v9, v[28:31] offset:3072
    s_waitcnt lgkmcnt(0)
    s_barrier
    s_barrier
    ds_write_b128 v10, v[32:35]
    s_waitcnt lgkmcnt(0)
    s_barrier
    s_endpgm
att_compute:
    s_memrealtime s[28:29]
    s_waitcnt lgkmcnt(0)
    s_mov_b64 s[20:21], s[58:59]
    s_mov_b32 s12, s20
    s_mov_b32 s13, s21
    s_mov_b32 s14, 0x01000000
    s_mov_b32 s15, 0x00020000
    s_mov_b32 s8, s56
    s_mov_b32 s9, s57
    s_mov_b32 s10, 0x00000100
    s_mov_b32 s11, 0x00020000
    s_lshr_b32 s29, s24, 4
    s_or_b32 s31, s27, s25
    s_cmp_eq_u32 s31, 0
    s_cbranch_scc0 att_notag
    s_or_b32 s28, s28, 16
    s_and_b32 s28, s28, -16
    v_mov_b32 v3, s28
    v_mov_b32 v2, 0
    s_mov_b64 exec, 1
    buffer_store_dword v3, v2, s[8:11], s29 offen sc1
    s_mov_b64 exec, -1
att_notag:
    v_lshrrev_b32 v6, 5, v1
    v_mul_u32_u24 v6, 6144, v6
    v_bfe_u32 v8, v1, 2, 3
    v_lshl_add_u32 v6, v8, 7, v6
    v_bfe_u32 v8, v1, 3, 2
    v_xor_b32 v8, s27, v8
    v_lshl_add_u32 v6, v8, 5, v6
    v_and_b32 v8, 3, v1
    v_lshl_add_u32 v6, v8, 3, v6
    v_add_u32 v6, 10240, v6
    v_add_u32 v7, 69632, v6
    v_lshrrev_b32 v8, 3, v12
    v_lshlrev_b32 v8, 10, v8
    v_and_b32 v9, 7, v12
    v_lshl_add_u32 v8, v9, 7, v8
    v_lshrrev_b32 v9, 1, v12
    v_xor_b32 v9, v9, v13
    v_lshl_add_u32 v8, v9, 4, v8
    v_xor_b32 v9, 64, v8
    v_add_u32 v10, 69632, v8
    v_add_u32 v11, 69632, v9
    s_lshl_b32 s30, s25, 10
    s_lshl_b32 s31, s27, 8
    s_add_u32 s30, s30, s31
    s_add_u32 s30, s30, 7077888
    v_lshlrev_b32 v167, 4, v13
    v_lshlrev_b32 v165, 2, v12
    s_cmp_eq_u32 s52, 2
    s_cbranch_scc0 att_nocs
    buffer_load_dwordx4 v[156:159], v167, s[12:15], s30 offen
    buffer_load_dwordx4 v[160:163], v167, s[12:15], s30 offen offset:64
    buffer_load_dword v164, v165, s[12:15], s30 offen offset:128
    v_lshrrev_b32 v2, 5, v1
    v_lshlrev_b32 v2, 4, v2
    v_bfe_u32 v3, v1, 2, 3
    v_add_u32 v2, v2, v3
    v_and_b32 v3, 3, v1
    v_lshlrev_b32 v3, 3, v3
    v_lshl_add_u32 v147, v2, 5, v3
    v_add_u32 v147, 0x2000, v147
    v_add_u32 v166, 69632, v147
    v_lshl_add_u32 v8, v2, 7, v3
    v_bfe_u32 v3, v1, 3, 2
    v_lshl_add_u32 v8, v3, 5, v8
    v_xor_b32 v9, 32, v8
    v_xor_b32 v10, 64, v8
    v_xor_b32 v11, 96, v8
    v_add_u32 v14, 69632, v8
    v_add_u32 v15, 69632, v9
    v_add_u32 v148, 69632, v10
    v_add_u32 v149, 69632, v11
att_nocs:
    v_mov_b32 v16, 0
    v_mov_b32 v17, 0
    v_mov_b32 v18, 0
    v_mov_b32 v19, 0
    v_mov_b32 v20, 0
    v_mov_b32 v21, 0
    v_mov_b32 v22, 0
    v_mov_b32 v23, 0
    v_mov_b32 v24, 0
    v_mov_b32 v25, 0
    v_mov_b32 v26, 0
    v_mov_b32 v27, 0
    v_mov_b32 v28, 0
    v_mov_b32 v29, 0
    v_mov_b32 v30, 0
    v_mov_b32 v31, 0
    v_mov_b32 v32, 0
    v_mov_b32 v33, 0
    v_mov_b32 v34, 0
    v_mov_b32 v35, 0
    v_mov_b32 v36, 0
    v_mov_b32 v37, 0
    v_mov_b32 v38, 0
    v_mov_b32 v39, 0
    v_mov_b32 v40, 0
    v_mov_b32 v41, 0
    v_mov_b32 v42, 0
    v_mov_b32 v43, 0
    v_mov_b32 v44, 0
    v_mov_b32 v45, 0
    v_mov_b32 v46, 0
    v_mov_b32 v47, 0
    v_mov_b32 v48, 0
    v_mov_b32 v49, 0
    v_mov_b32 v50, 0
    v_mov_b32 v51, 0
    v_mov_b32 v52, 0
    v_mov_b32 v53, 0
    v_mov_b32 v54, 0
    v_mov_b32 v55, 0
    v_mov_b32 v56, 0
    v_mov_b32 v57, 0
    v_mov_b32 v58, 0
    v_mov_b32 v59, 0
    v_mov_b32 v60, 0
    v_mov_b32 v61, 0
    v_mov_b32 v62, 0
    v_mov_b32 v63, 0
    v_mov_b32 v64, 0
    v_mov_b32 v65, 0
    v_mov_b32 v66, 0
    v_mov_b32 v67, 0
    v_mov_b32 v68, 0
    v_mov_b32 v69, 0
    v_mov_b32 v70, 0
    v_mov_b32 v71, 0
    v_mov_b32 v72, 0
    v_mov_b32 v73, 0
    v_mov_b32 v74, 0
    v_mov_b32 v75, 0
    v_and_b32 v2, 1, v12
    v_lshl_add_u32 v3, v13, 2, v2
    v_cmp_eq_u32 s[42:43], 1, v2
    v_cmp_le_u32 s[44:45], v3, v12
    v_add_u32 v3, 2, v3
    v_cmp_le_u32 s[46:47], v3, v12
    v_mov_b32 v2, 0x0c0c0100
    v_mov_b32 v3, 0x01000c0c
    v_mov_b32 v4, 0x0c0c0c0c
    v_cndmask_b32 v2, v2, v3, s[42:43]
    v_cndmask_b32 v140, v2, v4, s[44:45]
    v_cndmask_b32 v142, v4, v2, s[44:45]
    v_mov_b32 v2, 0x0c0c0302
    v_mov_b32 v3, 0x03020c0c
    v_cndmask_b32 v2, v2, v3, s[42:43]
    v_cndmask_b32 v141, v2, v4, s[46:47]
    v_cndmask_b32 v143, v4, v2, s[46:47]
    v_and_b32 v2, 1, v13
    v_lshl_add_u32 v144, v2, 4, v12
    v_lshlrev_b32 v144, 5, v144
    v_lshrrev_b32 v2, 1, v13
    v_lshl_add_u32 v144, v2, 4, v144
    s_lshl_b32 s34, s25, 2
    s_add_u32 s34, s34, s27
    s_lshl_b32 s34, s34, 11
    s_lshl_b32 s31, s24, 10
    s_add_u32 s34, s34, s31
    s_cmp_eq_u32 s24, 0
    s_cselect_b64 s[48:49], -1, 0
    v_lshlrev_b32 v145, 3, v12
    v_add_u32 v145, 104448, v145
    v_lshlrev_b32 v146, 4, v13
    v_add_u32 v146, 105088, v146
    s_barrier
    s_cmp_eq_u32 s52, 2
    s_cbranch_scc1 att_loop_xt
    ds_read_b64_tr_b16 v[96:97], v6 offset:0
    ds_read_b64_tr_b16 v[98:99], v6 offset:3072
    ds_read_b64_tr_b16 v[100:101], v6 offset:1024
    ds_read_b64_tr_b16 v[102:103], v6 offset:4096
    ds_read_b64_tr_b16 v[104:105], v6 offset:2048
    ds_read_b64_tr_b16 v[106:107], v6 offset:5120
    ds_read_b128 v[76:79], v8 offset:0
    ds_read_b128 v[80:83], v8 offset:2048
    ds_read_b128 v[84:87], v8 offset:4096
    ds_read_b128 v[88:91], v8 offset:6144
    ds_read_b128 v[92:95], v8 offset:8192
    s_waitcnt lgkmcnt(0)
    v_mfma_f32_16x16x32_bf16 v[16:19], v[96:99], v[76:79], v[16:19]
    ds_read_b64_tr_b16 v[128:129], v6 offset:12288
    v_mfma_f32_16x16x32_bf16 v[20:23], v[100:103], v[76:79], v[20:23]
    ds_read_b64_tr_b16 v[130:131], v6 offset:15360
    v_mfma_f32_16x16x32_bf16 v[24:27], v[76:79], v[104:107], v[24:27]
    ds_read_b64_tr_b16 v[132:133], v6 offset:13312
    v_mfma_f32_16x16x32_bf16 v[28:31], v[96:99], v[80:83], v[28:31]
    ds_read_b64_tr_b16 v[134:135], v6 offset:16384
    v_mfma_f32_16x16x32_bf16 v[32:35], v[100:103], v[80:83], v[32:35]
    ds_read_b64_tr_b16 v[136:137], v6 offset:14336
    v_mfma_f32_16x16x32_bf16 v[36:39], v[80:83], v[104:107], v[36:39]
    ds_read_b64_tr_b16 v[138:139], v6 offset:17408
    v_mfma_f32_16x16x32_bf16 v[40:43], v[96:99], v[84:87], v[40:43]
    ds_read_b128 v[108:111], v9 offset:0
    v_mfma_f32_16x16x32_bf16 v[44:47], v[100:103], v[84:87], v[44:47]
    ds_read_b128 v[112:115], v9 offset:2048
    v_mfma_f32_16x16x32_bf16 v[48:51], v[84:87], v[104:107], v[48:51]
    ds_read_b128 v[116:119], v9 offset:4096
    v_mfma_f32_16x16x32_bf16 v[52:55], v[96:99], v[88:91], v[52:55]
    ds_read_b128 v[120:123], v9 offset:6144
    v_mfma_f32_16x16x32_bf16 v[56:59], v[100:103], v[88:91], v[56:59]
    ds_read_b128 v[124:127], v9 offset:8192
    v_mfma_f32_16x16x32_bf16 v[60:63], v[88:91], v[104:107], v[60:63]
    v_mfma_f32_16x16x32_bf16 v[64:67], v[96:99], v[92:95], v[64:67]
    v_mfma_f32_16x16x32_bf16 v[68:71], v[100:103], v[92:95], v[68:71]
    v_mfma_f32_16x16x32_bf16 v[72:75], v[92:95], v[104:107], v[72:75]
    s_waitcnt lgkmcnt(0)
    s_barrier
    v_mfma_f32_16x16x32_bf16 v[16:19], v[128:131], v[108:111], v[16:19]
    ds_read_b64_tr_b16 v[96:97], v6 offset:34816
    v_mfma_f32_16x16x32_bf16 v[20:23], v[132:135], v[108:111], v[20:23]
    ds_read_b64_tr_b16 v[98:99], v6 offset:37888
    v_mfma_f32_16x16x32_bf16 v[24:27], v[108:111], v[136:139], v[24:27]
    ds_read_b64_tr_b16 v[100:101], v6 offset:35840
    v_mfma_f32_16x16x32_bf16 v[28:31], v[128:131], v[112:115], v[28:31]
    ds_read_b64_tr_b16 v[102:103], v6 offset:38912
    v_mfma_f32_16x16x32_bf16 v[32:35], v[132:135], v[112:115], v[32:35]
    ds_read_b64_tr_b16 v[104:105], v6 offset:36864
    v_mfma_f32_16x16x32_bf16 v[36:39], v[112:115], v[136:139], v[36:39]
    ds_read_b64_tr_b16 v[106:107], v6 offset:39936
    v_mfma_f32_16x16x32_bf16 v[40:43], v[128:131], v[116:119], v[40:43]
    ds_read_b128 v[76:79], v8 offset:34816
    v_mfma_f32_16x16x32_bf16 v[44:47], v[132:135], v[116:119], v[44:47]
    ds_read_b128 v[80:83], v8 offset:36864
    v_mfma_f32_16x16x32_bf16 v[48:51], v[116:119], v[136:139], v[48:51]
    ds_read_b128 v[84:87], v8 offset:38912
    v_mfma_f32_16x16x32_bf16 v[52:55], v[128:131], v[120:123], v[52:55]
    ds_read_b128 v[88:91], v8 offset:40960
    v_mfma_f32_16x16x32_bf16 v[56:59], v[132:135], v[120:123], v[56:59]
    ds_read_b128 v[92:95], v8 offset:43008
    v_mfma_f32_16x16x32_bf16 v[60:63], v[120:123], v[136:139], v[60:63]
    v_mfma_f32_16x16x32_bf16 v[64:67], v[128:131], v[124:127], v[64:67]
    v_mfma_f32_16x16x32_bf16 v[68:71], v[132:135], v[124:127], v[68:71]
    v_mfma_f32_16x16x32_bf16 v[72:75], v[124:127], v[136:139], v[72:75]
    s_waitcnt lgkmcnt(0)
    v_mfma_f32_16x16x32_bf16 v[16:19], v[96:99], v[76:79], v[16:19]
    ds_read_b64_tr_b16 v[128:129], v6 offset:47104
    v_mfma_f32_16x16x32_bf16 v[20:23], v[100:103], v[76:79], v[20:23]
    ds_read_b64_tr_b16 v[130:131], v6 offset:50176
    v_mfma_f32_16x16x32_bf16 v[24:27], v[76:79], v[104:107], v[24:27]
    ds_read_b64_tr_b16 v[132:133], v6 offset:48128
    v_mfma_f32_16x16x32_bf16 v[28:31], v[96:99], v[80:83], v[28:31]
    ds_read_b64_tr_b16 v[134:135], v6 offset:51200
    v_mfma_f32_16x16x32_bf16 v[32:35], v[100:103], v[80:83], v[32:35]
    ds_read_b64_tr_b16 v[136:137], v6 offset:49152
    v_mfma_f32_16x16x32_bf16 v[36:39], v[80:83], v[104:107], v[36:39]
    ds_read_b64_tr_b16 v[138:139], v6 offset:52224
    v_mfma_f32_16x16x32_bf16 v[40:43], v[96:99], v[84:87], v[40:43]
    ds_read_b128 v[108:111], v9 offset:34816
    v_mfma_f32_16x16x32_bf16 v[44:47], v[100:103], v[84:87], v[44:47]
    ds_read_b128 v[112:115], v9 offset:36864
    v_mfma_f32_16x16x32_bf16 v[48:51], v[84:87], v[104:107], v[48:51]
    ds_read_b128 v[116:119], v9 offset:38912
    v_mfma_f32_16x16x32_bf16 v[52:55], v[96:99], v[88:91], v[52:55]
    ds_read_b128 v[120:123], v9 offset:40960
    v_mfma_f32_16x16x32_bf16 v[56:59], v[100:103], v[88:91], v[56:59]
    ds_read_b128 v[124:127], v9 offset:43008
    v_mfma_f32_16x16x32_bf16 v[60:63], v[88:91], v[104:107], v[60:63]
    v_mfma_f32_16x16x32_bf16 v[64:67], v[96:99], v[92:95], v[64:67]
    v_mfma_f32_16x16x32_bf16 v[68:71], v[100:103], v[92:95], v[68:71]
    v_mfma_f32_16x16x32_bf16 v[72:75], v[92:95], v[104:107], v[72:75]
    s_waitcnt lgkmcnt(0)
    s_barrier
    v_mfma_f32_16x16x32_bf16 v[16:19], v[128:131], v[108:111], v[16:19]
    ds_read_b64_tr_b16 v[96:97], v7 offset:0
    v_mfma_f32_16x16x32_bf16 v[20:23], v[132:135], v[108:111], v[20:23]
    ds_read_b64_tr_b16 v[98:99], v7 offset:3072
    v_mfma_f32_16x16x32_bf16 v[24:27], v[108:111], v[136:139], v[24:27]
    ds_read_b64_tr_b16 v[100:101], v7 offset:1024
    v_mfma_f32_16x16x32_bf16 v[28:31], v[128:131], v[112:115], v[28:31]
    ds_read_b64_tr_b16 v[102:103], v7 offset:4096
    v_mfma_f32_16x16x32_bf16 v[32:35], v[132:135], v[112:115], v[32:35]
    ds_read_b64_tr_b16 v[104:105], v7 offset:2048
    v_mfma_f32_16x16x32_bf16 v[36:39], v[112:115], v[136:139], v[36:39]
    ds_read_b64_tr_b16 v[106:107], v7 offset:5120
    v_mfma_f32_16x16x32_bf16 v[40:43], v[128:131], v[116:119], v[40:43]
    ds_read_b128 v[76:79], v10 offset:0
    v_mfma_f32_16x16x32_bf16 v[44:47], v[132:135], v[116:119], v[44:47]
    ds_read_b128 v[80:83], v10 offset:2048
    v_mfma_f32_16x16x32_bf16 v[48:51], v[116:119], v[136:139], v[48:51]
    ds_read_b128 v[84:87], v10 offset:4096
    v_mfma_f32_16x16x32_bf16 v[52:55], v[128:131], v[120:123], v[52:55]
    ds_read_b128 v[88:91], v10 offset:6144
    v_mfma_f32_16x16x32_bf16 v[56:59], v[132:135], v[120:123], v[56:59]
    ds_read_b128 v[92:95], v10 offset:8192
    v_mfma_f32_16x16x32_bf16 v[60:63], v[120:123], v[136:139], v[60:63]
    v_mfma_f32_16x16x32_bf16 v[64:67], v[128:131], v[124:127], v[64:67]
    v_mfma_f32_16x16x32_bf16 v[68:71], v[132:135], v[124:127], v[68:71]
    v_mfma_f32_16x16x32_bf16 v[72:75], v[124:127], v[136:139], v[72:75]
    s_waitcnt lgkmcnt(0)
    v_mfma_f32_16x16x32_bf16 v[16:19], v[96:99], v[76:79], v[16:19]
    ds_read_b64_tr_b16 v[128:129], v7 offset:12288
    v_mfma_f32_16x16x32_bf16 v[20:23], v[100:103], v[76:79], v[20:23]
    ds_read_b64_tr_b16 v[130:131], v7 offset:15360
    v_mfma_f32_16x16x32_bf16 v[24:27], v[76:79], v[104:107], v[24:27]
    ds_read_b64_tr_b16 v[132:133], v7 offset:13312
    v_mfma_f32_16x16x32_bf16 v[28:31], v[96:99], v[80:83], v[28:31]
    ds_read_b64_tr_b16 v[134:135], v7 offset:16384
    v_mfma_f32_16x16x32_bf16 v[32:35], v[100:103], v[80:83], v[32:35]
    ds_read_b64_tr_b16 v[136:137], v7 offset:14336
    v_mfma_f32_16x16x32_bf16 v[36:39], v[80:83], v[104:107], v[36:39]
    ds_read_b64_tr_b16 v[138:139], v7 offset:17408
    v_mfma_f32_16x16x32_bf16 v[40:43], v[96:99], v[84:87], v[40:43]
    ds_read_b128 v[108:111], v11 offset:0
    v_mfma_f32_16x16x32_bf16 v[44:47], v[100:103], v[84:87], v[44:47]
    ds_read_b128 v[112:115], v11 offset:2048
    v_mfma_f32_16x16x32_bf16 v[48:51], v[84:87], v[104:107], v[48:51]
    ds_read_b128 v[116:119], v11 offset:4096
    v_mfma_f32_16x16x32_bf16 v[52:55], v[96:99], v[88:91], v[52:55]
    ds_read_b128 v[120:123], v11 offset:6144
    v_mfma_f32_16x16x32_bf16 v[56:59], v[100:103], v[88:91], v[56:59]
    ds_read_b128 v[124:127], v11 offset:8192
    v_mfma_f32_16x16x32_bf16 v[60:63], v[88:91], v[104:107], v[60:63]
    v_mfma_f32_16x16x32_bf16 v[64:67], v[96:99], v[92:95], v[64:67]
    v_mfma_f32_16x16x32_bf16 v[68:71], v[100:103], v[92:95], v[68:71]
    v_mfma_f32_16x16x32_bf16 v[72:75], v[92:95], v[104:107], v[72:75]
    s_waitcnt lgkmcnt(0)
    s_barrier
    v_mfma_f32_16x16x32_bf16 v[16:19], v[128:131], v[108:111], v[16:19]
    ds_read_b64_tr_b16 v[96:97], v6 offset:0
    v_mfma_f32_16x16x32_bf16 v[20:23], v[132:135], v[108:111], v[20:23]
    ds_read_b64_tr_b16 v[98:99], v6 offset:3072
    v_mfma_f32_16x16x32_bf16 v[24:27], v[108:111], v[136:139], v[24:27]
    ds_read_b64_tr_b16 v[100:101], v6 offset:1024
    v_mfma_f32_16x16x32_bf16 v[28:31], v[128:131], v[112:115], v[28:31]
    ds_read_b64_tr_b16 v[102:103], v6 offset:4096
    v_mfma_f32_16x16x32_bf16 v[32:35], v[132:135], v[112:115], v[32:35]
    ds_read_b64_tr_b16 v[104:105], v6 offset:2048
    v_mfma_f32_16x16x32_bf16 v[36:39], v[112:115], v[136:139], v[36:39]
    ds_read_b64_tr_b16 v[106:107], v6 offset:5120
    v_mfma_f32_16x16x32_bf16 v[40:43], v[128:131], v[116:119], v[40:43]
    ds_read_b128 v[76:79], v8 offset:0
    v_mfma_f32_16x16x32_bf16 v[44:47], v[132:135], v[116:119], v[44:47]
    ds_read_b128 v[80:83], v8 offset:2048
    v_mfma_f32_16x16x32_bf16 v[48:51], v[116:119], v[136:139], v[48:51]
    ds_read_b128 v[84:87], v8 offset:4096
    v_mfma_f32_16x16x32_bf16 v[52:55], v[128:131], v[120:123], v[52:55]
    ds_read_b128 v[88:91], v8 offset:6144
    v_mfma_f32_16x16x32_bf16 v[56:59], v[132:135], v[120:123], v[56:59]
    ds_read_b128 v[92:95], v8 offset:8192
    v_mfma_f32_16x16x32_bf16 v[60:63], v[120:123], v[136:139], v[60:63]
    v_mfma_f32_16x16x32_bf16 v[64:67], v[128:131], v[124:127], v[64:67]
    v_mfma_f32_16x16x32_bf16 v[68:71], v[132:135], v[124:127], v[68:71]
    v_mfma_f32_16x16x32_bf16 v[72:75], v[124:127], v[136:139], v[72:75]
    s_waitcnt lgkmcnt(0)
    v_mfma_f32_16x16x32_bf16 v[16:19], v[96:99], v[76:79], v[16:19]
    ds_read_b64_tr_b16 v[128:129], v6 offset:12288
    v_mfma_f32_16x16x32_bf16 v[20:23], v[100:103], v[76:79], v[20:23]
    ds_read_b64_tr_b16 v[130:131], v6 offset:15360
    v_mfma_f32_16x16x32_bf16 v[24:27], v[76:79], v[104:107], v[24:27]
    ds_read_b64_tr_b16 v[132:133], v6 offset:13312
    v_mfma_f32_16x16x32_bf16 v[28:31], v[96:99], v[80:83], v[28:31]
    ds_read_b64_tr_b16 v[134:135], v6 offset:16384
    v_mfma_f32_16x16x32_bf16 v[32:35], v[100:103], v[80:83], v[32:35]
    ds_read_b64_tr_b16 v[136:137], v6 offset:14336
    v_mfma_f32_16x16x32_bf16 v[36:39], v[80:83], v[104:107], v[36:39]
    ds_read_b64_tr_b16 v[138:139], v6 offset:17408
    v_mfma_f32_16x16x32_bf16 v[40:43], v[96:99], v[84:87], v[40:43]
    ds_read_b128 v[108:111], v9 offset:0
    v_mfma_f32_16x16x32_bf16 v[44:47], v[100:103], v[84:87], v[44:47]
    ds_read_b128 v[112:115], v9 offset:2048
    v_mfma_f32_16x16x32_bf16 v[48:51], v[84:87], v[104:107], v[48:51]
    ds_read_b128 v[116:119], v9 offset:4096
    v_mfma_f32_16x16x32_bf16 v[52:55], v[96:99], v[88:91], v[52:55]
    ds_read_b128 v[120:123], v9 offset:6144
    v_mfma_f32_16x16x32_bf16 v[56:59], v[100:103], v[88:91], v[56:59]
    ds_read_b128 v[124:127], v9 offset:8192
    v_mfma_f32_16x16x32_bf16 v[60:63], v[88:91], v[104:107], v[60:63]
    v_mfma_f32_16x16x32_bf16 v[64:67], v[96:99], v[92:95], v[64:67]
    v_mfma_f32_16x16x32_bf16 v[68:71], v[100:103], v[92:95], v[68:71]
    v_mfma_f32_16x16x32_bf16 v[72:75], v[92:95], v[104:107], v[72:75]
    s_waitcnt lgkmcnt(0)
    s_barrier
    v_mfma_f32_16x16x32_bf16 v[16:19], v[128:131], v[108:111], v[16:19]
    ds_read_b64_tr_b16 v[96:97], v6 offset:34816
    v_mfma_f32_16x16x32_bf16 v[20:23], v[132:135], v[108:111], v[20:23]
    ds_read_b64_tr_b16 v[98:99], v6 offset:37888
    v_mfma_f32_16x16x32_bf16 v[24:27], v[108:111], v[136:139], v[24:27]
    ds_read_b64_tr_b16 v[100:101], v6 offset:35840
    v_mfma_f32_16x16x32_bf16 v[28:31], v[128:131], v[112:115], v[28:31]
    ds_read_b64_tr_b16 v[102:103], v6 offset:38912
    v_mfma_f32_16x16x32_bf16 v[32:35], v[132:135], v[112:115], v[32:35]
    ds_read_b64_tr_b16 v[104:105], v6 offset:36864
    v_mfma_f32_16x16x32_bf16 v[36:39], v[112:115], v[136:139], v[36:39]
    ds_read_b64_tr_b16 v[106:107], v6 offset:39936
    v_mfma_f32_16x16x32_bf16 v[40:43], v[128:131], v[116:119], v[40:43]
    ds_read_b128 v[76:79], v8 offset:34816
    v_mfma_f32_16x16x32_bf16 v[44:47], v[132:135], v[116:119], v[44:47]
    ds_read_b128 v[80:83], v8 offset:36864
    v_mfma_f32_16x16x32_bf16 v[48:51], v[116:119], v[136:139], v[48:51]
    ds_read_b128 v[84:87], v8 offset:38912
    v_mfma_f32_16x16x32_bf16 v[52:55], v[128:131], v[120:123], v[52:55]
    ds_read_b128 v[88:91], v8 offset:40960
    v_mfma_f32_16x16x32_bf16 v[56:59], v[132:135], v[120:123], v[56:59]
    ds_read_b128 v[92:95], v8 offset:43008
    v_mfma_f32_16x16x32_bf16 v[60:63], v[120:123], v[136:139], v[60:63]
    v_mfma_f32_16x16x32_bf16 v[64:67], v[128:131], v[124:127], v[64:67]
    v_mfma_f32_16x16x32_bf16 v[68:71], v[132:135], v[124:127], v[68:71]
    v_mfma_f32_16x16x32_bf16 v[72:75], v[124:127], v[136:139], v[72:75]
    s_waitcnt lgkmcnt(0)
    v_mfma_f32_16x16x32_bf16 v[16:19], v[96:99], v[76:79], v[16:19]
    ds_read_b64_tr_b16 v[128:129], v6 offset:47104
    v_mfma_f32_16x16x32_bf16 v[20:23], v[100:103], v[76:79], v[20:23]
    ds_read_b64_tr_b16 v[130:131], v6 offset:50176
    v_mfma_f32_16x16x32_bf16 v[24:27], v[76:79], v[104:107], v[24:27]
    ds_read_b64_tr_b16 v[132:133], v6 offset:48128
    v_mfma_f32_16x16x32_bf16 v[28:31], v[96:99], v[80:83], v[28:31]
    ds_read_b64_tr_b16 v[134:135], v6 offset:51200
    v_mfma_f32_16x16x32_bf16 v[32:35], v[100:103], v[80:83], v[32:35]
    ds_read_b64_tr_b16 v[136:137], v6 offset:49152
    v_mfma_f32_16x16x32_bf16 v[36:39], v[80:83], v[104:107], v[36:39]
    ds_read_b64_tr_b16 v[138:139], v6 offset:52224
    v_mfma_f32_16x16x32_bf16 v[40:43], v[96:99], v[84:87], v[40:43]
    ds_read_b128 v[108:111], v9 offset:34816
    v_mfma_f32_16x16x32_bf16 v[44:47], v[100:103], v[84:87], v[44:47]
    ds_read_b128 v[112:115], v9 offset:36864
    v_mfma_f32_16x16x32_bf16 v[48:51], v[84:87], v[104:107], v[48:51]
    ds_read_b128 v[116:119], v9 offset:38912
    v_mfma_f32_16x16x32_bf16 v[52:55], v[96:99], v[88:91], v[52:55]
    ds_read_b128 v[120:123], v9 offset:40960
    v_mfma_f32_16x16x32_bf16 v[56:59], v[100:103], v[88:91], v[56:59]
    ds_read_b128 v[124:127], v9 offset:43008
    v_mfma_f32_16x16x32_bf16 v[60:63], v[88:91], v[104:107], v[60:63]
    v_mfma_f32_16x16x32_bf16 v[64:67], v[96:99], v[92:95], v[64:67]
    v_mfma_f32_16x16x32_bf16 v[68:71], v[100:103], v[92:95], v[68:71]
    v_mfma_f32_16x16x32_bf16 v[72:75], v[92:95], v[104:107], v[72:75]
    s_waitcnt lgkmcnt(0)
    s_barrier
    v_mfma_f32_16x16x32_bf16 v[16:19], v[128:131], v[108:111], v[16:19]
    ds_read_b64_tr_b16 v[96:97], v7 offset:0
    v_mfma_f32_16x16x32_bf16 v[20:23], v[132:135], v[108:111], v[20:23]
    ds_read_b64_tr_b16 v[98:99], v7 offset:3072
    v_mfma_f32_16x16x32_bf16 v[24:27], v[108:111], v[136:139], v[24:27]
    ds_read_b64_tr_b16 v[100:101], v7 offset:1024
    v_mfma_f32_16x16x32_bf16 v[28:31], v[128:131], v[112:115], v[28:31]
    ds_read_b64_tr_b16 v[102:103], v7 offset:4096
    v_mfma_f32_16x16x32_bf16 v[32:35], v[132:135], v[112:115], v[32:35]
    ds_read_b64_tr_b16 v[104:105], v7 offset:2048
    v_mfma_f32_16x16x32_bf16 v[36:39], v[112:115], v[136:139], v[36:39]
    ds_read_b64_tr_b16 v[106:107], v7 offset:5120
    v_mfma_f32_16x16x32_bf16 v[40:43], v[128:131], v[116:119], v[40:43]
    ds_read_b128 v[76:79], v10 offset:0
    v_mfma_f32_16x16x32_bf16 v[44:47], v[132:135], v[116:119], v[44:47]
    ds_read_b128 v[80:83], v10 offset:2048
    v_mfma_f32_16x16x32_bf16 v[48:51], v[116:119], v[136:139], v[48:51]
    ds_read_b128 v[84:87], v10 offset:4096
    v_mfma_f32_16x16x32_bf16 v[52:55], v[128:131], v[120:123], v[52:55]
    ds_read_b128 v[88:91], v10 offset:6144
    v_mfma_f32_16x16x32_bf16 v[56:59], v[132:135], v[120:123], v[56:59]
    ds_read_b128 v[92:95], v10 offset:8192
    v_mfma_f32_16x16x32_bf16 v[60:63], v[120:123], v[136:139], v[60:63]
    v_mfma_f32_16x16x32_bf16 v[64:67], v[128:131], v[124:127], v[64:67]
    v_mfma_f32_16x16x32_bf16 v[68:71], v[132:135], v[124:127], v[68:71]
    v_mfma_f32_16x16x32_bf16 v[72:75], v[124:127], v[136:139], v[72:75]
    s_waitcnt lgkmcnt(0)
    v_mfma_f32_16x16x32_bf16 v[16:19], v[96:99], v[76:79], v[16:19]
    ds_read_b64_tr_b16 v[128:129], v7 offset:12288
    v_mfma_f32_16x16x32_bf16 v[20:23], v[100:103], v[76:79], v[20:23]
    ds_read_b64_tr_b16 v[130:131], v7 offset:15360
    v_mfma_f32_16x16x32_bf16 v[24:27], v[76:79], v[104:107], v[24:27]
    ds_read_b64_tr_b16 v[132:133], v7 offset:13312
    v_mfma_f32_16x16x32_bf16 v[28:31], v[96:99], v[80:83], v[28:31]
    ds_read_b64_tr_b16 v[134:135], v7 offset:16384
    v_mfma_f32_16x16x32_bf16 v[32:35], v[100:103], v[80:83], v[32:35]
    ds_read_b64_tr_b16 v[136:137], v7 offset:14336
    v_mfma_f32_16x16x32_bf16 v[36:39], v[80:83], v[104:107], v[36:39]
    ds_read_b64_tr_b16 v[138:139], v7 offset:17408
    v_mfma_f32_16x16x32_bf16 v[40:43], v[96:99], v[84:87], v[40:43]
    ds_read_b128 v[108:111], v11 offset:0
    v_mfma_f32_16x16x32_bf16 v[44:47], v[100:103], v[84:87], v[44:47]
    ds_read_b128 v[112:115], v11 offset:2048
    v_mfma_f32_16x16x32_bf16 v[48:51], v[84:87], v[104:107], v[48:51]
    ds_read_b128 v[116:119], v11 offset:4096
    v_mfma_f32_16x16x32_bf16 v[52:55], v[96:99], v[88:91], v[52:55]
    ds_read_b128 v[120:123], v11 offset:6144
    v_mfma_f32_16x16x32_bf16 v[56:59], v[100:103], v[88:91], v[56:59]
    ds_read_b128 v[124:127], v11 offset:8192
    v_mfma_f32_16x16x32_bf16 v[60:63], v[88:91], v[104:107], v[60:63]
    v_mfma_f32_16x16x32_bf16 v[64:67], v[96:99], v[92:95], v[64:67]
    v_mfma_f32_16x16x32_bf16 v[68:71], v[100:103], v[92:95], v[68:71]
    v_mfma_f32_16x16x32_bf16 v[72:75], v[92:95], v[104:107], v[72:75]
    s_waitcnt lgkmcnt(0)
    s_barrier
    v_mfma_f32_16x16x32_bf16 v[16:19], v[128:131], v[108:111], v[16:19]
    ds_read_b64_tr_b16 v[96:97], v6 offset:0
    v_mfma_f32_16x16x32_bf16 v[20:23], v[132:135], v[108:111], v[20:23]
    ds_read_b64_tr_b16 v[98:99], v6 offset:3072
    v_mfma_f32_16x16x32_bf16 v[24:27], v[108:111], v[136:139], v[24:27]
    ds_read_b64_tr_b16 v[100:101], v6 offset:1024
    v_mfma_f32_16x16x32_bf16 v[28:31], v[128:131], v[112:115], v[28:31]
    ds_read_b64_tr_b16 v[102:103], v6 offset:4096
    v_mfma_f32_16x16x32_bf16 v[32:35], v[132:135], v[112:115], v[32:35]
    ds_read_b64_tr_b16 v[104:105], v6 offset:2048
    v_mfma_f32_16x16x32_bf16 v[36:39], v[112:115], v[136:139], v[36:39]
    ds_read_b64_tr_b16 v[106:107], v6 offset:5120
    v_mfma_f32_16x16x32_bf16 v[40:43], v[128:131], v[116:119], v[40:43]
    ds_read_b128 v[76:79], v8 offset:0
    v_mfma_f32_16x16x32_bf16 v[44:47], v[132:135], v[116:119], v[44:47]
    ds_read_b128 v[80:83], v8 offset:2048
    v_mfma_f32_16x16x32_bf16 v[48:51], v[116:119], v[136:139], v[48:51]
    ds_read_b128 v[84:87], v8 offset:4096
    v_mfma_f32_16x16x32_bf16 v[52:55], v[128:131], v[120:123], v[52:55]
    ds_read_b128 v[88:91], v8 offset:6144
    v_mfma_f32_16x16x32_bf16 v[56:59], v[132:135], v[120:123], v[56:59]
    ds_read_b128 v[92:95], v8 offset:8192
    v_mfma_f32_16x16x32_bf16 v[60:63], v[120:123], v[136:139], v[60:63]
    v_mfma_f32_16x16x32_bf16 v[64:67], v[128:131], v[124:127], v[64:67]
    v_mfma_f32_16x16x32_bf16 v[68:71], v[132:135], v[124:127], v[68:71]
    v_mfma_f32_16x16x32_bf16 v[72:75], v[124:127], v[136:139], v[72:75]
    s_waitcnt lgkmcnt(0)
    v_mfma_f32_16x16x32_bf16 v[16:19], v[96:99], v[76:79], v[16:19]
    ds_read_b64_tr_b16 v[128:129], v6 offset:12288
    v_mfma_f32_16x16x32_bf16 v[20:23], v[100:103], v[76:79], v[20:23]
    ds_read_b64_tr_b16 v[130:131], v6 offset:15360
    v_mfma_f32_16x16x32_bf16 v[24:27], v[76:79], v[104:107], v[24:27]
    ds_read_b64_tr_b16 v[132:133], v6 offset:13312
    v_mfma_f32_16x16x32_bf16 v[28:31], v[96:99], v[80:83], v[28:31]
    ds_read_b64_tr_b16 v[134:135], v6 offset:16384
    v_mfma_f32_16x16x32_bf16 v[32:35], v[100:103], v[80:83], v[32:35]
    ds_read_b64_tr_b16 v[136:137], v6 offset:14336
    v_mfma_f32_16x16x32_bf16 v[36:39], v[80:83], v[104:107], v[36:39]
    ds_read_b64_tr_b16 v[138:139], v6 offset:17408
    v_mfma_f32_16x16x32_bf16 v[40:43], v[96:99], v[84:87], v[40:43]
    ds_read_b128 v[108:111], v9 offset:0
    v_mfma_f32_16x16x32_bf16 v[44:47], v[100:103], v[84:87], v[44:47]
    ds_read_b128 v[112:115], v9 offset:2048
    v_mfma_f32_16x16x32_bf16 v[48:51], v[84:87], v[104:107], v[48:51]
    ds_read_b128 v[116:119], v9 offset:4096
    v_mfma_f32_16x16x32_bf16 v[52:55], v[96:99], v[88:91], v[52:55]
    ds_read_b128 v[120:123], v9 offset:6144
    v_mfma_f32_16x16x32_bf16 v[56:59], v[100:103], v[88:91], v[56:59]
    ds_read_b128 v[124:127], v9 offset:8192
    v_mfma_f32_16x16x32_bf16 v[60:63], v[88:91], v[104:107], v[60:63]
    v_mfma_f32_16x16x32_bf16 v[64:67], v[96:99], v[92:95], v[64:67]
    v_mfma_f32_16x16x32_bf16 v[68:71], v[100:103], v[92:95], v[68:71]
    v_mfma_f32_16x16x32_bf16 v[72:75], v[92:95], v[104:107], v[72:75]
    s_waitcnt lgkmcnt(0)
    s_barrier
    v_mfma_f32_16x16x32_bf16 v[16:19], v[128:131], v[108:111], v[16:19]
    ds_read_b64_tr_b16 v[96:97], v6 offset:34816
    v_mfma_f32_16x16x32_bf16 v[20:23], v[132:135], v[108:111], v[20:23]
    ds_read_b64_tr_b16 v[98:99], v6 offset:37888
    v_mfma_f32_16x16x32_bf16 v[24:27], v[108:111], v[136:139], v[24:27]
    ds_read_b64_tr_b16 v[100:101], v6 offset:35840
    v_mfma_f32_16x16x32_bf16 v[28:31], v[128:131], v[112:115], v[28:31]
    ds_read_b64_tr_b16 v[102:103], v6 offset:38912
    v_mfma_f32_16x16x32_bf16 v[32:35], v[132:135], v[112:115], v[32:35]
    ds_read_b64_tr_b16 v[104:105], v6 offset:36864
    v_mfma_f32_16x16x32_bf16 v[36:39], v[112:115], v[136:139], v[36:39]
    ds_read_b64_tr_b16 v[106:107], v6 offset:39936
    v_mfma_f32_16x16x32_bf16 v[40:43], v[128:131], v[116:119], v[40:43]
    ds_read_b128 v[76:79], v8 offset:34816
    v_mfma_f32_16x16x32_bf16 v[44:47], v[132:135], v[116:119], v[44:47]
    ds_read_b128 v[80:83], v8 offset:36864
    v_mfma_f32_16x16x32_bf16 v[48:51], v[116:119], v[136:139], v[48:51]
    ds_read_b128 v[84:87], v8 offset:38912
    v_mfma_f32_16x16x32_bf16 v[52:55], v[128:131], v[120:123], v[52:55]
    ds_read_b128 v[88:91], v8 offset:40960
    v_mfma_f32_16x16x32_bf16 v[56:59], v[132:135], v[120:123], v[56:59]
    ds_read_b128 v[92:95], v8 offset:43008
    v_mfma_f32_16x16x32_bf16 v[60:63], v[120:123], v[136:139], v[60:63]
    v_mfma_f32_16x16x32_bf16 v[64:67], v[128:131], v[124:127], v[64:67]
    v_mfma_f32_16x16x32_bf16 v[68:71], v[132:135], v[124:127], v[68:71]
    v_mfma_f32_16x16x32_bf16 v[72:75], v[124:127], v[136:139], v[72:75]
    s_waitcnt lgkmcnt(0)
    v_mfma_f32_16x16x32_bf16 v[16:19], v[96:99], v[76:79], v[16:19]
    ds_read_b64_tr_b16 v[128:129], v6 offset:47104
    v_mfma_f32_16x16x32_bf16 v[20:23], v[100:103], v[76:79], v[20:23]
    ds_read_b64_tr_b16 v[130:131], v6 offset:50176
    v_mfma_f32_16x16x32_bf16 v[24:27], v[76:79], v[104:107], v[24:27]
    ds_read_b64_tr_b16 v[132:133], v6 offset:48128
    v_mfma_f32_16x16x32_bf16 v[28:31], v[96:99], v[80:83], v[28:31]
    ds_read_b64_tr_b16 v[134:135], v6 offset:51200
    v_mfma_f32_16x16x32_bf16 v[32:35], v[100:103], v[80:83], v[32:35]
    ds_read_b64_tr_b16 v[136:137], v6 offset:49152
    v_mfma_f32_16x16x32_bf16 v[36:39], v[80:83], v[104:107], v[36:39]
    ds_read_b64_tr_b16 v[138:139], v6 offset:52224
    v_mfma_f32_16x16x32_bf16 v[40:43], v[96:99], v[84:87], v[40:43]
    ds_read_b128 v[108:111], v9 offset:34816
    v_mfma_f32_16x16x32_bf16 v[44:47], v[100:103], v[84:87], v[44:47]
    ds_read_b128 v[112:115], v9 offset:36864
    v_mfma_f32_16x16x32_bf16 v[48:51], v[84:87], v[104:107], v[48:51]
    ds_read_b128 v[116:119], v9 offset:38912
    v_mfma_f32_16x16x32_bf16 v[52:55], v[96:99], v[88:91], v[52:55]
    ds_read_b128 v[120:123], v9 offset:40960
    v_mfma_f32_16x16x32_bf16 v[56:59], v[100:103], v[88:91], v[56:59]
    ds_read_b128 v[124:127], v9 offset:43008
    v_mfma_f32_16x16x32_bf16 v[60:63], v[88:91], v[104:107], v[60:63]
    v_mfma_f32_16x16x32_bf16 v[64:67], v[96:99], v[92:95], v[64:67]
    v_mfma_f32_16x16x32_bf16 v[68:71], v[100:103], v[92:95], v[68:71]
    v_mfma_f32_16x16x32_bf16 v[72:75], v[92:95], v[104:107], v[72:75]
    s_waitcnt lgkmcnt(0)
    v_mfma_f32_16x16x32_bf16 v[16:19], v[128:131], v[108:111], v[16:19]
    v_mfma_f32_16x16x32_bf16 v[20:23], v[132:135], v[108:111], v[20:23]
    v_mfma_f32_16x16x32_bf16 v[24:27], v[108:111], v[136:139], v[24:27]
    v_mfma_f32_16x16x32_bf16 v[28:31], v[128:131], v[112:115], v[28:31]
    v_mfma_f32_16x16x32_bf16 v[32:35], v[132:135], v[112:115], v[32:35]
    v_mfma_f32_16x16x32_bf16 v[36:39], v[112:115], v[136:139], v[36:39]
    v_mfma_f32_16x16x32_bf16 v[40:43], v[128:131], v[116:119], v[40:43]
    v_mfma_f32_16x16x32_bf16 v[44:47], v[132:135], v[116:119], v[44:47]
    v_mfma_f32_16x16x32_bf16 v[48:51], v[116:119], v[136:139], v[48:51]
    v_mfma_f32_16x16x32_bf16 v[52:55], v[128:131], v[120:123], v[52:55]
    v_mfma_f32_16x16x32_bf16 v[56:59], v[132:135], v[120:123], v[56:59]
    v_mfma_f32_16x16x32_bf16 v[60:63], v[120:123], v[136:139], v[60:63]
    v_mfma_f32_16x16x32_bf16 v[64:67], v[128:131], v[124:127], v[64:67]
    v_mfma_f32_16x16x32_bf16 v[68:71], v[132:135], v[124:127], v[68:71]
    v_mfma_f32_16x16x32_bf16 v[72:75], v[124:127], v[136:139], v[72:75]
    s_branch att_loop_done
att_loop_xt:
    ds_read_b64_tr_b16 v[76:77], v147 offset:0
    ds_read_b64_tr_b16 v[78:79], v147 offset:256
    ds_read_b64_tr_b16 v[96:97], v6 offset:0
    ds_read_b64_tr_b16 v[98:99], v6 offset:3072
    ds_read_b64_tr_b16 v[100:101], v6 offset:1024
    ds_read_b64_tr_b16 v[102:103], v6 offset:4096
    ds_read_b64_tr_b16 v[104:105], v6 offset:2048
    ds_read_b64_tr_b16 v[106:107], v6 offset:5120
    ds_read_b64_tr_b16 v[80:81], v8 offset:0
    ds_read_b64_tr_b16 v[82:83], v8 offset:1024
    ds_read_b64_tr_b16 v[84:85], v9 offset:0
    ds_read_b64_tr_b16 v[86:87], v9 offset:1024
    ds_read_b64_tr_b16 v[88:89], v10 offset:0
    ds_read_b64_tr_b16 v[90:91], v10 offset:1024
    ds_read_b64_tr_b16 v[92:93], v11 offset:0
    ds_read_b64_tr_b16 v[94:95], v11 offset:1024
    s_waitcnt lgkmcnt(0)
    v_mfma_f32_16x16x32_bf16 v[20:23], v[100:103], v[76:79], v[20:23]
    ds_read_b64_tr_b16 v[108:109], v147 offset:1024
    ds_read_b64_tr_b16 v[110:111], v147 offset:1280
    v_mfma_f32_16x16x32_bf16 v[24:27], v[76:79], v[104:107], v[24:27]
    ds_read_b64_tr_b16 v[128:129], v6 offset:12288
    ds_read_b64_tr_b16 v[130:131], v6 offset:15360
    v_mfma_f32_16x16x32_bf16 v[28:31], v[96:99], v[80:83], v[28:31]
    ds_read_b64_tr_b16 v[132:133], v6 offset:13312
    ds_read_b64_tr_b16 v[134:135], v6 offset:16384
    v_mfma_f32_16x16x32_bf16 v[32:35], v[100:103], v[80:83], v[32:35]
    ds_read_b64_tr_b16 v[136:137], v6 offset:14336
    ds_read_b64_tr_b16 v[138:139], v6 offset:17408
    v_mfma_f32_16x16x32_bf16 v[36:39], v[80:83], v[104:107], v[36:39]
    ds_read_b64_tr_b16 v[112:113], v8 offset:4096
    v_mfma_f32_16x16x32_bf16 v[40:43], v[96:99], v[84:87], v[40:43]
    ds_read_b64_tr_b16 v[114:115], v8 offset:5120
    v_mfma_f32_16x16x32_bf16 v[44:47], v[100:103], v[84:87], v[44:47]
    ds_read_b64_tr_b16 v[116:117], v9 offset:4096
    v_mfma_f32_16x16x32_bf16 v[48:51], v[84:87], v[104:107], v[48:51]
    ds_read_b64_tr_b16 v[118:119], v9 offset:5120
    v_mfma_f32_16x16x32_bf16 v[52:55], v[96:99], v[88:91], v[52:55]
    ds_read_b64_tr_b16 v[120:121], v10 offset:4096
    v_mfma_f32_16x16x32_bf16 v[56:59], v[100:103], v[88:91], v[56:59]
    ds_read_b64_tr_b16 v[122:123], v10 offset:5120
    v_mfma_f32_16x16x32_bf16 v[60:63], v[88:91], v[104:107], v[60:63]
    ds_read_b64_tr_b16 v[124:125], v11 offset:4096
    v_mfma_f32_16x16x32_bf16 v[64:67], v[96:99], v[92:95], v[64:67]
    ds_read_b64_tr_b16 v[126:127], v11 offset:5120
    v_mfma_f32_16x16x32_bf16 v[68:71], v[100:103], v[92:95], v[68:71]
    v_mfma_f32_16x16x32_bf16 v[72:75], v[92:95], v[104:107], v[72:75]
    s_waitcnt lgkmcnt(0)
    s_barrier
    v_mfma_f32_16x16x32_bf16 v[20:23], v[132:135], v[108:111], v[20:23]
    ds_read_b64_tr_b16 v[76:77], v147 offset:34816
    ds_read_b64_tr_b16 v[78:79], v147 offset:35072
    v_mfma_f32_16x16x32_bf16 v[24:27], v[108:111], v[136:139], v[24:27]
    ds_read_b64_tr_b16 v[96:97], v6 offset:34816
    ds_read_b64_tr_b16 v[98:99], v6 offset:37888
    v_mfma_f32_16x16x32_bf16 v[28:31], v[128:131], v[112:115], v[28:31]
    ds_read_b64_tr_b16 v[100:101], v6 offset:35840
    ds_read_b64_tr_b16 v[102:103], v6 offset:38912
    v_mfma_f32_16x16x32_bf16 v[32:35], v[132:135], v[112:115], v[32:35]
    ds_read_b64_tr_b16 v[104:105], v6 offset:36864
    ds_read_b64_tr_b16 v[106:107], v6 offset:39936
    v_mfma_f32_16x16x32_bf16 v[36:39], v[112:115], v[136:139], v[36:39]
    ds_read_b64_tr_b16 v[80:81], v8 offset:34816
    v_mfma_f32_16x16x32_bf16 v[40:43], v[128:131], v[116:119], v[40:43]
    ds_read_b64_tr_b16 v[82:83], v8 offset:35840
    v_mfma_f32_16x16x32_bf16 v[44:47], v[132:135], v[116:119], v[44:47]
    ds_read_b64_tr_b16 v[84:85], v9 offset:34816
    v_mfma_f32_16x16x32_bf16 v[48:51], v[116:119], v[136:139], v[48:51]
    ds_read_b64_tr_b16 v[86:87], v9 offset:35840
    v_mfma_f32_16x16x32_bf16 v[52:55], v[128:131], v[120:123], v[52:55]
    ds_read_b64_tr_b16 v[88:89], v10 offset:34816
    v_mfma_f32_16x16x32_bf16 v[56:59], v[132:135], v[120:123], v[56:59]
    ds_read_b64_tr_b16 v[90:91], v10 offset:35840
    v_mfma_f32_16x16x32_bf16 v[60:63], v[120:123], v[136:139], v[60:63]
    ds_read_b64_tr_b16 v[92:93], v11 offset:34816
    v_mfma_f32_16x16x32_bf16 v[64:67], v[128:131], v[124:127], v[64:67]
    ds_read_b64_tr_b16 v[94:95], v11 offset:35840
    v_mfma_f32_16x16x32_bf16 v[68:71], v[132:135], v[124:127], v[68:71]
    v_mfma_f32_16x16x32_bf16 v[72:75], v[124:127], v[136:139], v[72:75]
    s_waitcnt lgkmcnt(0)
    v_mfma_f32_16x16x32_bf16 v[20:23], v[100:103], v[76:79], v[20:23]
    ds_read_b64_tr_b16 v[108:109], v147 offset:35840
    ds_read_b64_tr_b16 v[110:111], v147 offset:36096
    v_mfma_f32_16x16x32_bf16 v[24:27], v[76:79], v[104:107], v[24:27]
    ds_read_b64_tr_b16 v[128:129], v6 offset:47104
    ds_read_b64_tr_b16 v[130:131], v6 offset:50176
    v_mfma_f32_16x16x32_bf16 v[28:31], v[96:99], v[80:83], v[28:31]
    ds_read_b64_tr_b16 v[132:133], v6 offset:48128
    ds_read_b64_tr_b16 v[134:135], v6 offset:51200
    v_mfma_f32_16x16x32_bf16 v[32:35], v[100:103], v[80:83], v[32:35]
    ds_read_b64_tr_b16 v[136:137], v6 offset:49152
    ds_read_b64_tr_b16 v[138:139], v6 offset:52224
    v_mfma_f32_16x16x32_bf16 v[36:39], v[80:83], v[104:107], v[36:39]
    ds_read_b64_tr_b16 v[112:113], v8 offset:38912
    v_mfma_f32_16x16x32_bf16 v[40:43], v[96:99], v[84:87], v[40:43]
    ds_read_b64_tr_b16 v[114:115], v8 offset:39936
    v_mfma_f32_16x16x32_bf16 v[44:47], v[100:103], v[84:87], v[44:47]
    ds_read_b64_tr_b16 v[116:117], v9 offset:38912
    v_mfma_f32_16x16x32_bf16 v[48:51], v[84:87], v[104:107], v[48:51]
    ds_read_b64_tr_b16 v[118:119], v9 offset:39936
    v_mfma_f32_16x16x32_bf16 v[52:55], v[96:99], v[88:91], v[52:55]
    ds_read_b64_tr_b16 v[120:121], v10 offset:38912
    v_mfma_f32_16x16x32_bf16 v[56:59], v[100:103], v[88:91], v[56:59]
    ds_read_b64_tr_b16 v[122:123], v10 offset:39936
    v_mfma_f32_16x16x32_bf16 v[60:63], v[88:91], v[104:107], v[60:63]
    ds_read_b64_tr_b16 v[124:125], v11 offset:38912
    v_mfma_f32_16x16x32_bf16 v[64:67], v[96:99], v[92:95], v[64:67]
    ds_read_b64_tr_b16 v[126:127], v11 offset:39936
    v_mfma_f32_16x16x32_bf16 v[68:71], v[100:103], v[92:95], v[68:71]
    v_mfma_f32_16x16x32_bf16 v[72:75], v[92:95], v[104:107], v[72:75]
    s_waitcnt lgkmcnt(0)
    s_barrier
    v_mfma_f32_16x16x32_bf16 v[20:23], v[132:135], v[108:111], v[20:23]
    ds_read_b64_tr_b16 v[76:77], v166 offset:0
    ds_read_b64_tr_b16 v[78:79], v166 offset:256
    v_mfma_f32_16x16x32_bf16 v[24:27], v[108:111], v[136:139], v[24:27]
    ds_read_b64_tr_b16 v[96:97], v7 offset:0
    ds_read_b64_tr_b16 v[98:99], v7 offset:3072
    v_mfma_f32_16x16x32_bf16 v[28:31], v[128:131], v[112:115], v[28:31]
    ds_read_b64_tr_b16 v[100:101], v7 offset:1024
    ds_read_b64_tr_b16 v[102:103], v7 offset:4096
    v_mfma_f32_16x16x32_bf16 v[32:35], v[132:135], v[112:115], v[32:35]
    ds_read_b64_tr_b16 v[104:105], v7 offset:2048
    ds_read_b64_tr_b16 v[106:107], v7 offset:5120
    v_mfma_f32_16x16x32_bf16 v[36:39], v[112:115], v[136:139], v[36:39]
    ds_read_b64_tr_b16 v[80:81], v14 offset:0
    v_mfma_f32_16x16x32_bf16 v[40:43], v[128:131], v[116:119], v[40:43]
    ds_read_b64_tr_b16 v[82:83], v14 offset:1024
    v_mfma_f32_16x16x32_bf16 v[44:47], v[132:135], v[116:119], v[44:47]
    ds_read_b64_tr_b16 v[84:85], v15 offset:0
    v_mfma_f32_16x16x32_bf16 v[48:51], v[116:119], v[136:139], v[48:51]
    ds_read_b64_tr_b16 v[86:87], v15 offset:1024
    v_mfma_f32_16x16x32_bf16 v[52:55], v[128:131], v[120:123], v[52:55]
    ds_read_b64_tr_b16 v[88:89], v148 offset:0
    v_mfma_f32_16x16x32_bf16 v[56:59], v[132:135], v[120:123], v[56:59]
    ds_read_b64_tr_b16 v[90:91], v148 offset:1024
    v_mfma_f32_16x16x32_bf16 v[60:63], v[120:123], v[136:139], v[60:63]
    ds_read_b64_tr_b16 v[92:93], v149 offset:0
    v_mfma_f32_16x16x32_bf16 v[64:67], v[128:131], v[124:127], v[64:67]
    ds_read_b64_tr_b16 v[94:95], v149 offset:1024
    v_mfma_f32_16x16x32_bf16 v[68:71], v[132:135], v[124:127], v[68:71]
    v_mfma_f32_16x16x32_bf16 v[72:75], v[124:127], v[136:139], v[72:75]
    s_waitcnt lgkmcnt(0)
    v_mfma_f32_16x16x32_bf16 v[20:23], v[100:103], v[76:79], v[20:23]
    ds_read_b64_tr_b16 v[108:109], v166 offset:1024
    ds_read_b64_tr_b16 v[110:111], v166 offset:1280
    v_mfma_f32_16x16x32_bf16 v[24:27], v[76:79], v[104:107], v[24:27]
    ds_read_b64_tr_b16 v[128:129], v7 offset:12288
    ds_read_b64_tr_b16 v[130:131], v7 offset:15360
    v_mfma_f32_16x16x32_bf16 v[28:31], v[96:99], v[80:83], v[28:31]
    ds_read_b64_tr_b16 v[132:133], v7 offset:13312
    ds_read_b64_tr_b16 v[134:135], v7 offset:16384
    v_mfma_f32_16x16x32_bf16 v[32:35], v[100:103], v[80:83], v[32:35]
    ds_read_b64_tr_b16 v[136:137], v7 offset:14336
    ds_read_b64_tr_b16 v[138:139], v7 offset:17408
    v_mfma_f32_16x16x32_bf16 v[36:39], v[80:83], v[104:107], v[36:39]
    ds_read_b64_tr_b16 v[112:113], v14 offset:4096
    v_mfma_f32_16x16x32_bf16 v[40:43], v[96:99], v[84:87], v[40:43]
    ds_read_b64_tr_b16 v[114:115], v14 offset:5120
    v_mfma_f32_16x16x32_bf16 v[44:47], v[100:103], v[84:87], v[44:47]
    ds_read_b64_tr_b16 v[116:117], v15 offset:4096
    v_mfma_f32_16x16x32_bf16 v[48:51], v[84:87], v[104:107], v[48:51]
    ds_read_b64_tr_b16 v[118:119], v15 offset:5120
    v_mfma_f32_16x16x32_bf16 v[52:55], v[96:99], v[88:91], v[52:55]
    ds_read_b64_tr_b16 v[120:121], v148 offset:4096
    v_mfma_f32_16x16x32_bf16 v[56:59], v[100:103], v[88:91], v[56:59]
    ds_read_b64_tr_b16 v[122:123], v148 offset:5120
    v_mfma_f32_16x16x32_bf16 v[60:63], v[88:91], v[104:107], v[60:63]
    ds_read_b64_tr_b16 v[124:125], v149 offset:4096
    v_mfma_f32_16x16x32_bf16 v[64:67], v[96:99], v[92:95], v[64:67]
    ds_read_b64_tr_b16 v[126:127], v149 offset:5120
    v_mfma_f32_16x16x32_bf16 v[68:71], v[100:103], v[92:95], v[68:71]
    v_mfma_f32_16x16x32_bf16 v[72:75], v[92:95], v[104:107], v[72:75]
    s_waitcnt lgkmcnt(0)
    s_barrier
    v_mfma_f32_16x16x32_bf16 v[20:23], v[132:135], v[108:111], v[20:23]
    ds_read_b64_tr_b16 v[76:77], v147 offset:0
    ds_read_b64_tr_b16 v[78:79], v147 offset:256
    v_mfma_f32_16x16x32_bf16 v[24:27], v[108:111], v[136:139], v[24:27]
    ds_read_b64_tr_b16 v[96:97], v6 offset:0
    ds_read_b64_tr_b16 v[98:99], v6 offset:3072
    v_mfma_f32_16x16x32_bf16 v[28:31], v[128:131], v[112:115], v[28:31]
    ds_read_b64_tr_b16 v[100:101], v6 offset:1024
    ds_read_b64_tr_b16 v[102:103], v6 offset:4096
    v_mfma_f32_16x16x32_bf16 v[32:35], v[132:135], v[112:115], v[32:35]
    ds_read_b64_tr_b16 v[104:105], v6 offset:2048
    ds_read_b64_tr_b16 v[106:107], v6 offset:5120
    v_mfma_f32_16x16x32_bf16 v[36:39], v[112:115], v[136:139], v[36:39]
    ds_read_b64_tr_b16 v[80:81], v8 offset:0
    v_mfma_f32_16x16x32_bf16 v[40:43], v[128:131], v[116:119], v[40:43]
    ds_read_b64_tr_b16 v[82:83], v8 offset:1024
    v_mfma_f32_16x16x32_bf16 v[44:47], v[132:135], v[116:119], v[44:47]
    ds_read_b64_tr_b16 v[84:85], v9 offset:0
    v_mfma_f32_16x16x32_bf16 v[48:51], v[116:119], v[136:139], v[48:51]
    ds_read_b64_tr_b16 v[86:87], v9 offset:1024
    v_mfma_f32_16x16x32_bf16 v[52:55], v[128:131], v[120:123], v[52:55]
    ds_read_b64_tr_b16 v[88:89], v10 offset:0
    v_mfma_f32_16x16x32_bf16 v[56:59], v[132:135], v[120:123], v[56:59]
    ds_read_b64_tr_b16 v[90:91], v10 offset:1024
    v_mfma_f32_16x16x32_bf16 v[60:63], v[120:123], v[136:139], v[60:63]
    ds_read_b64_tr_b16 v[92:93], v11 offset:0
    v_mfma_f32_16x16x32_bf16 v[64:67], v[128:131], v[124:127], v[64:67]
    ds_read_b64_tr_b16 v[94:95], v11 offset:1024
    v_mfma_f32_16x16x32_bf16 v[68:71], v[132:135], v[124:127], v[68:71]
    v_mfma_f32_16x16x32_bf16 v[72:75], v[124:127], v[136:139], v[72:75]
    s_waitcnt lgkmcnt(0)
    v_mfma_f32_16x16x32_bf16 v[20:23], v[100:103], v[76:79], v[20:23]
    ds_read_b64_tr_b16 v[108:109], v147 offset:1024
    ds_read_b64_tr_b16 v[110:111], v147 offset:1280
    v_mfma_f32_16x16x32_bf16 v[24:27], v[76:79], v[104:107], v[24:27]
    ds_read_b64_tr_b16 v[128:129], v6 offset:12288
    ds_read_b64_tr_b16 v[130:131], v6 offset:15360
    v_mfma_f32_16x16x32_bf16 v[28:31], v[96:99], v[80:83], v[28:31]
    ds_read_b64_tr_b16 v[132:133], v6 offset:13312
    ds_read_b64_tr_b16 v[134:135], v6 offset:16384
    v_mfma_f32_16x16x32_bf16 v[32:35], v[100:103], v[80:83], v[32:35]
    ds_read_b64_tr_b16 v[136:137], v6 offset:14336
    ds_read_b64_tr_b16 v[138:139], v6 offset:17408
    v_mfma_f32_16x16x32_bf16 v[36:39], v[80:83], v[104:107], v[36:39]
    ds_read_b64_tr_b16 v[112:113], v8 offset:4096
    v_mfma_f32_16x16x32_bf16 v[40:43], v[96:99], v[84:87], v[40:43]
    ds_read_b64_tr_b16 v[114:115], v8 offset:5120
    v_mfma_f32_16x16x32_bf16 v[44:47], v[100:103], v[84:87], v[44:47]
    ds_read_b64_tr_b16 v[116:117], v9 offset:4096
    v_mfma_f32_16x16x32_bf16 v[48:51], v[84:87], v[104:107], v[48:51]
    ds_read_b64_tr_b16 v[118:119], v9 offset:5120
    v_mfma_f32_16x16x32_bf16 v[52:55], v[96:99], v[88:91], v[52:55]
    ds_read_b64_tr_b16 v[120:121], v10 offset:4096
    v_mfma_f32_16x16x32_bf16 v[56:59], v[100:103], v[88:91], v[56:59]
    ds_read_b64_tr_b16 v[122:123], v10 offset:5120
    v_mfma_f32_16x16x32_bf16 v[60:63], v[88:91], v[104:107], v[60:63]
    ds_read_b64_tr_b16 v[124:125], v11 offset:4096
    v_mfma_f32_16x16x32_bf16 v[64:67], v[96:99], v[92:95], v[64:67]
    ds_read_b64_tr_b16 v[126:127], v11 offset:5120
    v_mfma_f32_16x16x32_bf16 v[68:71], v[100:103], v[92:95], v[68:71]
    v_mfma_f32_16x16x32_bf16 v[72:75], v[92:95], v[104:107], v[72:75]
    s_waitcnt lgkmcnt(0)
    s_barrier
    v_mfma_f32_16x16x32_bf16 v[20:23], v[132:135], v[108:111], v[20:23]
    ds_read_b64_tr_b16 v[76:77], v147 offset:34816
    ds_read_b64_tr_b16 v[78:79], v147 offset:35072
    v_mfma_f32_16x16x32_bf16 v[24:27], v[108:111], v[136:139], v[24:27]
    ds_read_b64_tr_b16 v[96:97], v6 offset:34816
    ds_read_b64_tr_b16 v[98:99], v6 offset:37888
    v_mfma_f32_16x16x32_bf16 v[28:31], v[128:131], v[112:115], v[28:31]
    ds_read_b64_tr_b16 v[100:101], v6 offset:35840
    ds_read_b64_tr_b16 v[102:103], v6 offset:38912
    v_mfma_f32_16x16x32_bf16 v[32:35], v[132:135], v[112:115], v[32:35]
    ds_read_b64_tr_b16 v[104:105], v6 offset:36864
    ds_read_b64_tr_b16 v[106:107], v6 offset:39936
    v_mfma_f32_16x16x32_bf16 v[36:39], v[112:115], v[136:139], v[36:39]
    ds_read_b64_tr_b16 v[80:81], v8 offset:34816
    v_mfma_f32_16x16x32_bf16 v[40:43], v[128:131], v[116:119], v[40:43]
    ds_read_b64_tr_b16 v[82:83], v8 offset:35840
    v_mfma_f32_16x16x32_bf16 v[44:47], v[132:135], v[116:119], v[44:47]
    ds_read_b64_tr_b16 v[84:85], v9 offset:34816
    v_mfma_f32_16x16x32_bf16 v[48:51], v[116:119], v[136:139], v[48:51]
    ds_read_b64_tr_b16 v[86:87], v9 offset:35840
    v_mfma_f32_16x16x32_bf16 v[52:55], v[128:131], v[120:123], v[52:55]
    ds_read_b64_tr_b16 v[88:89], v10 offset:34816
    v_mfma_f32_16x16x32_bf16 v[56:59], v[132:135], v[120:123], v[56:59]
    ds_read_b64_tr_b16 v[90:91], v10 offset:35840
    v_mfma_f32_16x16x32_bf16 v[60:63], v[120:123], v[136:139], v[60:63]
    ds_read_b64_tr_b16 v[92:93], v11 offset:34816
    v_mfma_f32_16x16x32_bf16 v[64:67], v[128:131], v[124:127], v[64:67]
    ds_read_b64_tr_b16 v[94:95], v11 offset:35840
    v_mfma_f32_16x16x32_bf16 v[68:71], v[132:135], v[124:127], v[68:71]
    v_mfma_f32_16x16x32_bf16 v[72:75], v[124:127], v[136:139], v[72:75]
    s_waitcnt lgkmcnt(0)
    v_mfma_f32_16x16x32_bf16 v[20:23], v[100:103], v[76:79], v[20:23]
    ds_read_b64_tr_b16 v[108:109], v147 offset:35840
    ds_read_b64_tr_b16 v[110:111], v147 offset:36096
    v_mfma_f32_16x16x32_bf16 v[24:27], v[76:79], v[104:107], v[24:27]
    ds_read_b64_tr_b16 v[128:129], v6 offset:47104
    ds_read_b64_tr_b16 v[130:131], v6 offset:50176
    v_mfma_f32_16x16x32_bf16 v[28:31], v[96:99], v[80:83], v[28:31]
    ds_read_b64_tr_b16 v[132:133], v6 offset:48128
    ds_read_b64_tr_b16 v[134:135], v6 offset:51200
    v_mfma_f32_16x16x32_bf16 v[32:35], v[100:103], v[80:83], v[32:35]
    ds_read_b64_tr_b16 v[136:137], v6 offset:49152
    ds_read_b64_tr_b16 v[138:139], v6 offset:52224
    v_mfma_f32_16x16x32_bf16 v[36:39], v[80:83], v[104:107], v[36:39]
    ds_read_b64_tr_b16 v[112:113], v8 offset:38912
    v_mfma_f32_16x16x32_bf16 v[40:43], v[96:99], v[84:87], v[40:43]
    ds_read_b64_tr_b16 v[114:115], v8 offset:39936
    v_mfma_f32_16x16x32_bf16 v[44:47], v[100:103], v[84:87], v[44:47]
    ds_read_b64_tr_b16 v[116:117], v9 offset:38912
    v_mfma_f32_16x16x32_bf16 v[48:51], v[84:87], v[104:107], v[48:51]
    ds_read_b64_tr_b16 v[118:119], v9 offset:39936
    v_mfma_f32_16x16x32_bf16 v[52:55], v[96:99], v[88:91], v[52:55]
    ds_read_b64_tr_b16 v[120:121], v10 offset:38912
    v_mfma_f32_16x16x32_bf16 v[56:59], v[100:103], v[88:91], v[56:59]
    ds_read_b64_tr_b16 v[122:123], v10 offset:39936
    v_mfma_f32_16x16x32_bf16 v[60:63], v[88:91], v[104:107], v[60:63]
    ds_read_b64_tr_b16 v[124:125], v11 offset:38912
    v_mfma_f32_16x16x32_bf16 v[64:67], v[96:99], v[92:95], v[64:67]
    ds_read_b64_tr_b16 v[126:127], v11 offset:39936
    v_mfma_f32_16x16x32_bf16 v[68:71], v[100:103], v[92:95], v[68:71]
    v_mfma_f32_16x16x32_bf16 v[72:75], v[92:95], v[104:107], v[72:75]
    s_waitcnt lgkmcnt(0)
    s_barrier
    v_mfma_f32_16x16x32_bf16 v[20:23], v[132:135], v[108:111], v[20:23]
    ds_read_b64_tr_b16 v[76:77], v166 offset:0
    ds_read_b64_tr_b16 v[78:79], v166 offset:256
    v_mfma_f32_16x16x32_bf16 v[24:27], v[108:111], v[136:139], v[24:27]
    ds_read_b64_tr_b16 v[96:97], v7 offset:0
    ds_read_b64_tr_b16 v[98:99], v7 offset:3072
    v_mfma_f32_16x16x32_bf16 v[28:31], v[128:131], v[112:115], v[28:31]
    ds_read_b64_tr_b16 v[100:101], v7 offset:1024
    ds_read_b64_tr_b16 v[102:103], v7 offset:4096
    v_mfma_f32_16x16x32_bf16 v[32:35], v[132:135], v[112:115], v[32:35]
    ds_read_b64_tr_b16 v[104:105], v7 offset:2048
    ds_read_b64_tr_b16 v[106:107], v7 offset:5120
    v_mfma_f32_16x16x32_bf16 v[36:39], v[112:115], v[136:139], v[36:39]
    ds_read_b64_tr_b16 v[80:81], v14 offset:0
    v_mfma_f32_16x16x32_bf16 v[40:43], v[128:131], v[116:119], v[40:43]
    ds_read_b64_tr_b16 v[82:83], v14 offset:1024
    v_mfma_f32_16x16x32_bf16 v[44:47], v[132:135], v[116:119], v[44:47]
    ds_read_b64_tr_b16 v[84:85], v15 offset:0
    v_mfma_f32_16x16x32_bf16 v[48:51], v[116:119], v[136:139], v[48:51]
    ds_read_b64_tr_b16 v[86:87], v15 offset:1024
    v_mfma_f32_16x16x32_bf16 v[52:55], v[128:131], v[120:123], v[52:55]
    ds_read_b64_tr_b16 v[88:89], v148 offset:0
    v_mfma_f32_16x16x32_bf16 v[56:59], v[132:135], v[120:123], v[56:59]
    ds_read_b64_tr_b16 v[90:91], v148 offset:1024
    v_mfma_f32_16x16x32_bf16 v[60:63], v[120:123], v[136:139], v[60:63]
    ds_read_b64_tr_b16 v[92:93], v149 offset:0
    v_mfma_f32_16x16x32_bf16 v[64:67], v[128:131], v[124:127], v[64:67]
    ds_read_b64_tr_b16 v[94:95], v149 offset:1024
    v_mfma_f32_16x16x32_bf16 v[68:71], v[132:135], v[124:127], v[68:71]
    v_mfma_f32_16x16x32_bf16 v[72:75], v[124:127], v[136:139], v[72:75]
    s_waitcnt lgkmcnt(0)
    v_mfma_f32_16x16x32_bf16 v[20:23], v[100:103], v[76:79], v[20:23]
    ds_read_b64_tr_b16 v[108:109], v166 offset:1024
    ds_read_b64_tr_b16 v[110:111], v166 offset:1280
    v_mfma_f32_16x16x32_bf16 v[24:27], v[76:79], v[104:107], v[24:27]
    ds_read_b64_tr_b16 v[128:129], v7 offset:12288
    ds_read_b64_tr_b16 v[130:131], v7 offset:15360
    v_mfma_f32_16x16x32_bf16 v[28:31], v[96:99], v[80:83], v[28:31]
    ds_read_b64_tr_b16 v[132:133], v7 offset:13312
    ds_read_b64_tr_b16 v[134:135], v7 offset:16384
    v_mfma_f32_16x16x32_bf16 v[32:35], v[100:103], v[80:83], v[32:35]
    ds_read_b64_tr_b16 v[136:137], v7 offset:14336
    ds_read_b64_tr_b16 v[138:139], v7 offset:17408
    v_mfma_f32_16x16x32_bf16 v[36:39], v[80:83], v[104:107], v[36:39]
    ds_read_b64_tr_b16 v[112:113], v14 offset:4096
    v_mfma_f32_16x16x32_bf16 v[40:43], v[96:99], v[84:87], v[40:43]
    ds_read_b64_tr_b16 v[114:115], v14 offset:5120
    v_mfma_f32_16x16x32_bf16 v[44:47], v[100:103], v[84:87], v[44:47]
    ds_read_b64_tr_b16 v[116:117], v15 offset:4096
    v_mfma_f32_16x16x32_bf16 v[48:51], v[84:87], v[104:107], v[48:51]
    ds_read_b64_tr_b16 v[118:119], v15 offset:5120
    v_mfma_f32_16x16x32_bf16 v[52:55], v[96:99], v[88:91], v[52:55]
    ds_read_b64_tr_b16 v[120:121], v148 offset:4096
    v_mfma_f32_16x16x32_bf16 v[56:59], v[100:103], v[88:91], v[56:59]
    ds_read_b64_tr_b16 v[122:123], v148 offset:5120
    v_mfma_f32_16x16x32_bf16 v[60:63], v[88:91], v[104:107], v[60:63]
    ds_read_b64_tr_b16 v[124:125], v149 offset:4096
    v_mfma_f32_16x16x32_bf16 v[64:67], v[96:99], v[92:95], v[64:67]
    ds_read_b64_tr_b16 v[126:127], v149 offset:5120
    v_mfma_f32_16x16x32_bf16 v[68:71], v[100:103], v[92:95], v[68:71]
    v_mfma_f32_16x16x32_bf16 v[72:75], v[92:95], v[104:107], v[72:75]
    s_waitcnt lgkmcnt(0)
    s_barrier
    v_mfma_f32_16x16x32_bf16 v[20:23], v[132:135], v[108:111], v[20:23]
    ds_read_b64_tr_b16 v[76:77], v147 offset:0
    ds_read_b64_tr_b16 v[78:79], v147 offset:256
    v_mfma_f32_16x16x32_bf16 v[24:27], v[108:111], v[136:139], v[24:27]
    ds_read_b64_tr_b16 v[96:97], v6 offset:0
    ds_read_b64_tr_b16 v[98:99], v6 offset:3072
    v_mfma_f32_16x16x32_bf16 v[28:31], v[128:131], v[112:115], v[28:31]
    ds_read_b64_tr_b16 v[100:101], v6 offset:1024
    ds_read_b64_tr_b16 v[102:103], v6 offset:4096
    v_mfma_f32_16x16x32_bf16 v[32:35], v[132:135], v[112:115], v[32:35]
    ds_read_b64_tr_b16 v[104:105], v6 offset:2048
    ds_read_b64_tr_b16 v[106:107], v6 offset:5120
    v_mfma_f32_16x16x32_bf16 v[36:39], v[112:115], v[136:139], v[36:39]
    ds_read_b64_tr_b16 v[80:81], v8 offset:0
    v_mfma_f32_16x16x32_bf16 v[40:43], v[128:131], v[116:119], v[40:43]
    ds_read_b64_tr_b16 v[82:83], v8 offset:1024
    v_mfma_f32_16x16x32_bf16 v[44:47], v[132:135], v[116:119], v[44:47]
    ds_read_b64_tr_b16 v[84:85], v9 offset:0
    v_mfma_f32_16x16x32_bf16 v[48:51], v[116:119], v[136:139], v[48:51]
    ds_read_b64_tr_b16 v[86:87], v9 offset:1024
    v_mfma_f32_16x16x32_bf16 v[52:55], v[128:131], v[120:123], v[52:55]
    ds_read_b64_tr_b16 v[88:89], v10 offset:0
    v_mfma_f32_16x16x32_bf16 v[56:59], v[132:135], v[120:123], v[56:59]
    ds_read_b64_tr_b16 v[90:91], v10 offset:1024
    v_mfma_f32_16x16x32_bf16 v[60:63], v[120:123], v[136:139], v[60:63]
    ds_read_b64_tr_b16 v[92:93], v11 offset:0
    v_mfma_f32_16x16x32_bf16 v[64:67], v[128:131], v[124:127], v[64:67]
    ds_read_b64_tr_b16 v[94:95], v11 offset:1024
    v_mfma_f32_16x16x32_bf16 v[68:71], v[132:135], v[124:127], v[68:71]
    v_mfma_f32_16x16x32_bf16 v[72:75], v[124:127], v[136:139], v[72:75]
    s_waitcnt lgkmcnt(0)
    v_mfma_f32_16x16x32_bf16 v[20:23], v[100:103], v[76:79], v[20:23]
    ds_read_b64_tr_b16 v[108:109], v147 offset:1024
    ds_read_b64_tr_b16 v[110:111], v147 offset:1280
    v_mfma_f32_16x16x32_bf16 v[24:27], v[76:79], v[104:107], v[24:27]
    ds_read_b64_tr_b16 v[128:129], v6 offset:12288
    ds_read_b64_tr_b16 v[130:131], v6 offset:15360
    v_mfma_f32_16x16x32_bf16 v[28:31], v[96:99], v[80:83], v[28:31]
    ds_read_b64_tr_b16 v[132:133], v6 offset:13312
    ds_read_b64_tr_b16 v[134:135], v6 offset:16384
    v_mfma_f32_16x16x32_bf16 v[32:35], v[100:103], v[80:83], v[32:35]
    ds_read_b64_tr_b16 v[136:137], v6 offset:14336
    ds_read_b64_tr_b16 v[138:139], v6 offset:17408
    v_mfma_f32_16x16x32_bf16 v[36:39], v[80:83], v[104:107], v[36:39]
    ds_read_b64_tr_b16 v[112:113], v8 offset:4096
    v_mfma_f32_16x16x32_bf16 v[40:43], v[96:99], v[84:87], v[40:43]
    ds_read_b64_tr_b16 v[114:115], v8 offset:5120
    v_mfma_f32_16x16x32_bf16 v[44:47], v[100:103], v[84:87], v[44:47]
    ds_read_b64_tr_b16 v[116:117], v9 offset:4096
    v_mfma_f32_16x16x32_bf16 v[48:51], v[84:87], v[104:107], v[48:51]
    ds_read_b64_tr_b16 v[118:119], v9 offset:5120
    v_mfma_f32_16x16x32_bf16 v[52:55], v[96:99], v[88:91], v[52:55]
    ds_read_b64_tr_b16 v[120:121], v10 offset:4096
    v_mfma_f32_16x16x32_bf16 v[56:59], v[100:103], v[88:91], v[56:59]
    ds_read_b64_tr_b16 v[122:123], v10 offset:5120
    v_mfma_f32_16x16x32_bf16 v[60:63], v[88:91], v[104:107], v[60:63]
    ds_read_b64_tr_b16 v[124:125], v11 offset:4096
    v_mfma_f32_16x16x32_bf16 v[64:67], v[96:99], v[92:95], v[64:67]
    ds_read_b64_tr_b16 v[126:127], v11 offset:5120
    v_mfma_f32_16x16x32_bf16 v[68:71], v[100:103], v[92:95], v[68:71]
    v_mfma_f32_16x16x32_bf16 v[72:75], v[92:95], v[104:107], v[72:75]
    s_waitcnt lgkmcnt(0)
    s_barrier
    v_mfma_f32_16x16x32_bf16 v[20:23], v[132:135], v[108:111], v[20:23]
    ds_read_b64_tr_b16 v[76:77], v147 offset:34816
    ds_read_b64_tr_b16 v[78:79], v147 offset:35072
    v_mfma_f32_16x16x32_bf16 v[24:27], v[108:111], v[136:139], v[24:27]
    ds_read_b64_tr_b16 v[96:97], v6 offset:34816
    ds_read_b64_tr_b16 v[98:99], v6 offset:37888
    v_mfma_f32_16x16x32_bf16 v[28:31], v[128:131], v[112:115], v[28:31]
    ds_read_b64_tr_b16 v[100:101], v6 offset:35840
    ds_read_b64_tr_b16 v[102:103], v6 offset:38912
    v_mfma_f32_16x16x32_bf16 v[32:35], v[132:135], v[112:115], v[32:35]
    ds_read_b64_tr_b16 v[104:105], v6 offset:36864
    ds_read_b64_tr_b16 v[106:107], v6 offset:39936
    v_mfma_f32_16x16x32_bf16 v[36:39], v[112:115], v[136:139], v[36:39]
    ds_read_b64_tr_b16 v[80:81], v8 offset:34816
    v_mfma_f32_16x16x32_bf16 v[40:43], v[128:131], v[116:119], v[40:43]
    ds_read_b64_tr_b16 v[82:83], v8 offset:35840
    v_mfma_f32_16x16x32_bf16 v[44:47], v[132:135], v[116:119], v[44:47]
    ds_read_b64_tr_b16 v[84:85], v9 offset:34816
    v_mfma_f32_16x16x32_bf16 v[48:51], v[116:119], v[136:139], v[48:51]
    ds_read_b64_tr_b16 v[86:87], v9 offset:35840
    v_mfma_f32_16x16x32_bf16 v[52:55], v[128:131], v[120:123], v[52:55]
    ds_read_b64_tr_b16 v[88:89], v10 offset:34816
    v_mfma_f32_16x16x32_bf16 v[56:59], v[132:135], v[120:123], v[56:59]
    ds_read_b64_tr_b16 v[90:91], v10 offset:35840
    v_mfma_f32_16x16x32_bf16 v[60:63], v[120:123], v[136:139], v[60:63]
    ds_read_b64_tr_b16 v[92:93], v11 offset:34816
    v_mfma_f32_16x16x32_bf16 v[64:67], v[128:131], v[124:127], v[64:67]
    ds_read_b64_tr_b16 v[94:95], v11 offset:35840
    v_mfma_f32_16x16x32_bf16 v[68:71], v[132:135], v[124:127], v[68:71]
    v_mfma_f32_16x16x32_bf16 v[72:75], v[124:127], v[136:139], v[72:75]
    s_waitcnt lgkmcnt(0)
    v_mfma_f32_16x16x32_bf16 v[20:23], v[100:103], v[76:79], v[20:23]
    ds_read_b64_tr_b16 v[108:109], v147 offset:35840
    ds_read_b64_tr_b16 v[110:111], v147 offset:36096
    v_mfma_f32_16x16x32_bf16 v[24:27], v[76:79], v[104:107], v[24:27]
    ds_read_b64_tr_b16 v[128:129], v6 offset:47104
    ds_read_b64_tr_b16 v[130:131], v6 offset:50176
    v_mfma_f32_16x16x32_bf16 v[28:31], v[96:99], v[80:83], v[28:31]
    ds_read_b64_tr_b16 v[132:133], v6 offset:48128
    ds_read_b64_tr_b16 v[134:135], v6 offset:51200
    v_mfma_f32_16x16x32_bf16 v[32:35], v[100:103], v[80:83], v[32:35]
    ds_read_b64_tr_b16 v[136:137], v6 offset:49152
    ds_read_b64_tr_b16 v[138:139], v6 offset:52224
    v_mfma_f32_16x16x32_bf16 v[36:39], v[80:83], v[104:107], v[36:39]
    ds_read_b64_tr_b16 v[112:113], v8 offset:38912
    v_mfma_f32_16x16x32_bf16 v[40:43], v[96:99], v[84:87], v[40:43]
    ds_read_b64_tr_b16 v[114:115], v8 offset:39936
    v_mfma_f32_16x16x32_bf16 v[44:47], v[100:103], v[84:87], v[44:47]
    ds_read_b64_tr_b16 v[116:117], v9 offset:38912
    v_mfma_f32_16x16x32_bf16 v[48:51], v[84:87], v[104:107], v[48:51]
    ds_read_b64_tr_b16 v[118:119], v9 offset:39936
    v_mfma_f32_16x16x32_bf16 v[52:55], v[96:99], v[88:91], v[52:55]
    ds_read_b64_tr_b16 v[120:121], v10 offset:38912
    v_mfma_f32_16x16x32_bf16 v[56:59], v[100:103], v[88:91], v[56:59]
    ds_read_b64_tr_b16 v[122:123], v10 offset:39936
    v_mfma_f32_16x16x32_bf16 v[60:63], v[88:91], v[104:107], v[60:63]
    ds_read_b64_tr_b16 v[124:125], v11 offset:38912
    v_mfma_f32_16x16x32_bf16 v[64:67], v[96:99], v[92:95], v[64:67]
    ds_read_b64_tr_b16 v[126:127], v11 offset:39936
    v_mfma_f32_16x16x32_bf16 v[68:71], v[100:103], v[92:95], v[68:71]
    v_mfma_f32_16x16x32_bf16 v[72:75], v[92:95], v[104:107], v[72:75]
    s_waitcnt lgkmcnt(0)
    v_mfma_f32_16x16x32_bf16 v[20:23], v[132:135], v[108:111], v[20:23]
    v_mfma_f32_16x16x32_bf16 v[24:27], v[108:111], v[136:139], v[24:27]
    v_mfma_f32_16x16x32_bf16 v[28:31], v[128:131], v[112:115], v[28:31]
    v_mfma_f32_16x16x32_bf16 v[32:35], v[132:135], v[112:115], v[32:35]
    v_mfma_f32_16x16x32_bf16 v[36:39], v[112:115], v[136:139], v[36:39]
    v_mfma_f32_16x16x32_bf16 v[40:43], v[128:131], v[116:119], v[40:43]
    v_mfma_f32_16x16x32_bf16 v[44:47], v[132:135], v[116:119], v[44:47]
    v_mfma_f32_16x16x32_bf16 v[48:51], v[116:119], v[136:139], v[48:51]
    v_mfma_f32_16x16x32_bf16 v[52:55], v[128:131], v[120:123], v[52:55]
    v_mfma_f32_16x16x32_bf16 v[56:59], v[132:135], v[120:123], v[56:59]
    v_mfma_f32_16x16x32_bf16 v[60:63], v[120:123], v[136:139], v[60:63]
    v_mfma_f32_16x16x32_bf16 v[64:67], v[128:131], v[124:127], v[64:67]
    v_mfma_f32_16x16x32_bf16 v[68:71], v[132:135], v[124:127], v[68:71]
    v_mfma_f32_16x16x32_bf16 v[72:75], v[124:127], v[136:139], v[72:75]
att_loop_done:
    s_barrier
    ds_read_b64 v[76:77], v145 offset:0
    ds_read_b64 v[78:79], v145 offset:128
    ds_read_b64 v[80:81], v145 offset:256
    ds_read_b64 v[82:83], v145 offset:384
    ds_read_b64 v[84:85], v145 offset:512
    ds_read_b128 v[88:91], v146 offset:0
    ds_read_b128 v[92:95], v146 offset:320
    ds_read_b128 v[96:99], v146 offset:64
    ds_read_b128 v[100:103], v146 offset:384
    ds_read_b128 v[104:107], v146 offset:128
    ds_read_b128 v[108:111], v146 offset:448
    ds_read_b128 v[112:115], v146 offset:192
    ds_read_b128 v[116:119], v146 offset:512
    ds_read_b128 v[120:123], v146 offset:256
    ds_read_b128 v[124:127], v146 offset:576
    s_cmp_eq_u32 s52, 2
    s_cbranch_scc1 att_cs2
    v_mov_b32_dpp v128, v16 row_newbcast:0 row_mask:0xf bank_mask:0xf
    v_mov_b32_dpp v129, v17 row_newbcast:0 row_mask:0xf bank_mask:0xf
    v_mov_b32_dpp v130, v18 row_newbcast:0 row_mask:0xf bank_mask:0xf
    v_mov_b32_dpp v131, v19 row_newbcast:0 row_mask:0xf bank_mask:0xf
    v_mov_b32_dpp v132, v20 row_newbcast:0 row_mask:0xf bank_mask:0xf
    v_mov_b32_dpp v133, v21 row_newbcast:0 row_mask:0xf bank_mask:0xf
    v_mov_b32_dpp v134, v22 row_newbcast:0 row_mask:0xf bank_mask:0xf
    v_mov_b32_dpp v135, v23 row_newbcast:0 row_mask:0xf bank_mask:0xf
    v_mov_b32 v136, v24
    v_mov_b32 v137, v24
    s_nop 1
    v_permlane16_swap_b32 v136, v137
    v_mov_b32 v137, v136
    s_nop 1
    v_permlane32_swap_b32 v136, v137
    s_cmp_eq_u32 s24, 0
    s_cbranch_scc0 att_cs3
    buffer_store_dwordx4 v[128:131], v167, s[12:15], s30 offen
    buffer_store_dwordx4 v[132:135], v167, s[12:15], s30 offen offset:64
    buffer_store_dword v136, v165, s[12:15], s30 offen offset:128
    s_branch att_cs3
att_cs2:
    s_waitcnt vmcnt(0)
    v_mov_b32 v128, v156
    v_mov_b32 v129, v157
    v_mov_b32 v130, v158
    v_mov_b32 v131, v159
    v_mov_b32 v132, v160
    v_mov_b32 v133, v161
    v_mov_b32 v134, v162
    v_mov_b32 v135, v163
    v_mov_b32 v136, v164
    s_nop 2
att_cs3:
    s_waitcnt lgkmcnt(10)
    v_pk_fma_f32 v[20:21], v[132:133], v[76:77], v[20:21] op_sel_hi:[1,0,1] neg_lo:[0,1,0] neg_hi:[0,1,0]
    v_pk_fma_f32 v[22:23], v[134:135], v[76:77], v[22:23] op_sel_hi:[1,0,1] neg_lo:[0,1,0] neg_hi:[0,1,0]
    v_pk_fma_f32 v[28:29], v[128:129], v[78:79], v[28:29] op_sel_hi:[1,0,1] neg_lo:[0,1,0] neg_hi:[0,1,0]
    v_pk_fma_f32 v[30:31], v[130:131], v[78:79], v[30:31] op_sel_hi:[1,0,1] neg_lo:[0,1,0] neg_hi:[0,1,0]
    v_pk_fma_f32 v[32:33], v[132:133], v[78:79], v[32:33] op_sel_hi:[1,0,1] neg_lo:[0,1,0] neg_hi:[0,1,0]
    v_pk_fma_f32 v[34:35], v[134:135], v[78:79], v[34:35] op_sel_hi:[1,0,1] neg_lo:[0,1,0] neg_hi:[0,1,0]
    v_pk_fma_f32 v[40:41], v[128:129], v[80:81], v[40:41] op_sel_hi:[1,0,1] neg_lo:[0,1,0] neg_hi:[0,1,0]
    v_pk_fma_f32 v[42:43], v[130:131], v[80:81], v[42:43] op_sel_hi:[1,0,1] neg_lo:[0,1,0] neg_hi:[0,1,0]
    v_pk_fma_f32 v[44:45], v[132:133], v[80:81], v[44:45] op_sel_hi:[1,0,1] neg_lo:[0,1,0] neg_hi:[0,1,0]
    v_pk_fma_f32 v[46:47], v[134:135], v[80:81], v[46:47] op_sel_hi:[1,0,1] neg_lo:[0,1,0] neg_hi:[0,1,0]
    v_pk_fma_f32 v[52:53], v[128:129], v[82:83], v[52:53] op_sel_hi:[1,0,1] neg_lo:[0,1,0] neg_hi:[0,1,0]
    v_pk_fma_f32 v[54:55], v[130:131], v[82:83], v[54:55] op_sel_hi:[1,0,1] neg_lo:[0,1,0] neg_hi:[0,1,0]
    v_pk_fma_f32 v[56:57], v[132:133], v[82:83], v[56:57] op_sel_hi:[1,0,1] neg_lo:[0,1,0] neg_hi:[0,1,0]
    v_pk_fma_f32 v[58:59], v[134:135], v[82:83], v[58:59] op_sel_hi:[1,0,1] neg_lo:[0,1,0] neg_hi:[0,1,0]
    v_pk_fma_f32 v[64:65], v[128:129], v[84:85], v[64:65] op_sel_hi:[1,0,1] neg_lo:[0,1,0] neg_hi:[0,1,0]
    v_pk_fma_f32 v[66:67], v[130:131], v[84:85], v[66:67] op_sel_hi:[1,0,1] neg_lo:[0,1,0] neg_hi:[0,1,0]
    v_pk_fma_f32 v[68:69], v[132:133], v[84:85], v[68:69] op_sel_hi:[1,0,1] neg_lo:[0,1,0] neg_hi:[0,1,0]
    v_pk_fma_f32 v[70:71], v[134:135], v[84:85], v[70:71] op_sel_hi:[1,0,1] neg_lo:[0,1,0] neg_hi:[0,1,0]
    v_pk_mul_f32 v[20:21], v[20:21], v[76:77] op_sel:[0,1] op_sel_hi:[1,1]
    v_pk_mul_f32 v[22:23], v[22:23], v[76:77] op_sel:[0,1] op_sel_hi:[1,1]
    v_pk_mul_f32 v[28:29], v[28:29], v[78:79] op_sel:[0,1] op_sel_hi:[1,1]
    v_pk_mul_f32 v[30:31], v[30:31], v[78:79] op_sel:[0,1] op_sel_hi:[1,1]
    v_pk_mul_f32 v[32:33], v[32:33], v[78:79] op_sel:[0,1] op_sel_hi:[1,1]
    v_pk_mul_f32 v[34:35], v[34:35], v[78:79] op_sel:[0,1] op_sel_hi:[1,1]
    v_pk_mul_f32 v[40:41], v[40:41], v[80:81] op_sel:[0,1] op_sel_hi:[1,1]
    v_pk_mul_f32 v[42:43], v[42:43], v[80:81] op_sel:[0,1] op_sel_hi:[1,1]
    v_pk_mul_f32 v[44:45], v[44:45], v[80:81] op_sel:[0,1] op_sel_hi:[1,1]
    v_pk_mul_f32 v[46:47], v[46:47], v[80:81] op_sel:[0,1] op_sel_hi:[1,1]
    v_pk_mul_f32 v[52:53], v[52:53], v[82:83] op_sel:[0,1] op_sel_hi:[1,1]
    v_pk_mul_f32 v[54:55], v[54:55], v[82:83] op_sel:[0,1] op_sel_hi:[1,1]
    v_pk_mul_f32 v[56:57], v[56:57], v[82:83] op_sel:[0,1] op_sel_hi:[1,1]
    v_pk_mul_f32 v[58:59], v[58:59], v[82:83] op_sel:[0,1] op_sel_hi:[1,1]
    v_pk_mul_f32 v[64:65], v[64:65], v[84:85] op_sel:[0,1] op_sel_hi:[1,1]
    v_pk_mul_f32 v[66:67], v[66:67], v[84:85] op_sel:[0,1] op_sel_hi:[1,1]
    v_pk_mul_f32 v[68:69], v[68:69], v[84:85] op_sel:[0,1] op_sel_hi:[1,1]
    v_pk_mul_f32 v[70:71], v[70:71], v[84:85] op_sel:[0,1] op_sel_hi:[1,1]
    v_cvt_pk_bf16_f32 v20, v20, v21
    v_cvt_pk_bf16_f32 v21, v22, v23
    v_cvt_pk_bf16_f32 v148, v28, v29
    v_cvt_pk_bf16_f32 v149, v30, v31
    v_cvt_pk_bf16_f32 v32, v32, v33
    v_cvt_pk_bf16_f32 v33, v34, v35
    v_cvt_pk_bf16_f32 v150, v40, v41
    v_cvt_pk_bf16_f32 v151, v42, v43
    v_cvt_pk_bf16_f32 v44, v44, v45
    v_cvt_pk_bf16_f32 v45, v46, v47
    v_cvt_pk_bf16_f32 v152, v52, v53
    v_cvt_pk_bf16_f32 v153, v54, v55
    v_cvt_pk_bf16_f32 v56, v56, v57
    v_cvt_pk_bf16_f32 v57, v58, v59
    v_cvt_pk_bf16_f32 v154, v64, v65
    v_cvt_pk_bf16_f32 v155, v66, v67
    v_cvt_pk_bf16_f32 v68, v68, v69
    v_cvt_pk_bf16_f32 v69, v70, v71
    s_waitcnt lgkmcnt(0)
    v_pk_fma_f32 v[24:25], v[88:89], v[136:137], v[24:25] op_sel_hi:[1,0,1] neg_lo:[1,0,0] neg_hi:[1,0,0]
    v_pk_fma_f32 v[26:27], v[90:91], v[136:137], v[26:27] op_sel_hi:[1,0,1] neg_lo:[1,0,0] neg_hi:[1,0,0]
    v_pk_fma_f32 v[36:37], v[96:97], v[136:137], v[36:37] op_sel_hi:[1,0,1] neg_lo:[1,0,0] neg_hi:[1,0,0]
    v_pk_fma_f32 v[38:39], v[98:99], v[136:137], v[38:39] op_sel_hi:[1,0,1] neg_lo:[1,0,0] neg_hi:[1,0,0]
    v_pk_fma_f32 v[48:49], v[104:105], v[136:137], v[48:49] op_sel_hi:[1,0,1] neg_lo:[1,0,0] neg_hi:[1,0,0]
    v_pk_fma_f32 v[50:51], v[106:107], v[136:137], v[50:51] op_sel_hi:[1,0,1] neg_lo:[1,0,0] neg_hi:[1,0,0]
    v_pk_fma_f32 v[60:61], v[112:113], v[136:137], v[60:61] op_sel_hi:[1,0,1] neg_lo:[1,0,0] neg_hi:[1,0,0]
    v_pk_fma_f32 v[62:63], v[114:115], v[136:137], v[62:63] op_sel_hi:[1,0,1] neg_lo:[1,0,0] neg_hi:[1,0,0]
    v_pk_fma_f32 v[72:73], v[120:121], v[136:137], v[72:73] op_sel_hi:[1,0,1] neg_lo:[1,0,0] neg_hi:[1,0,0]
    v_pk_fma_f32 v[74:75], v[122:123], v[136:137], v[74:75] op_sel_hi:[1,0,1] neg_lo:[1,0,0] neg_hi:[1,0,0]
    v_pk_mul_f32 v[24:25], v[24:25], v[92:93]
    v_pk_mul_f32 v[26:27], v[26:27], v[94:95]
    v_pk_mul_f32 v[36:37], v[36:37], v[100:101]
    v_pk_mul_f32 v[38:39], v[38:39], v[102:103]
    v_pk_mul_f32 v[48:49], v[48:49], v[108:109]
    v_pk_mul_f32 v[50:51], v[50:51], v[110:111]
    v_pk_mul_f32 v[60:61], v[60:61], v[116:117]
    v_pk_mul_f32 v[62:63], v[62:63], v[118:119]
    v_pk_mul_f32 v[72:73], v[72:73], v[124:125]
    v_pk_mul_f32 v[74:75], v[74:75], v[126:127]
    v_cvt_pk_bf16_f32 v156, v24, v25
    v_cvt_pk_bf16_f32 v157, v26, v27
    v_cvt_pk_bf16_f32 v158, v36, v37
    v_cvt_pk_bf16_f32 v159, v38, v39
    v_cvt_pk_bf16_f32 v160, v48, v49
    v_cvt_pk_bf16_f32 v161, v50, v51
    v_cvt_pk_bf16_f32 v162, v60, v61
    v_cvt_pk_bf16_f32 v163, v62, v63
    v_cvt_pk_bf16_f32 v164, v72, v73
    v_cvt_pk_bf16_f32 v165, v74, v75
    v_mfma_f32_16x16x16_bf16 v[28:31], v[32:33], v[148:149], 0
    v_mfma_f32_16x16x16_bf16 v[36:39], v[20:21], v[148:149], 0
    v_mfma_f32_16x16x16_bf16 v[40:43], v[44:45], v[150:151], 0
    v_mfma_f32_16x16x16_bf16 v[48:51], v[32:33], v[150:151], 0
    v_mfma_f32_16x16x16_bf16 v[52:55], v[56:57], v[152:153], 0
    v_mfma_f32_16x16x16_bf16 v[60:63], v[44:45], v[152:153], 0
    v_mfma_f32_16x16x16_bf16 v[64:67], v[68:69], v[154:155], 0
    v_mfma_f32_16x16x16_bf16 v[72:75], v[56:57], v[154:155], 0
    v_mov_b32 v2, 0xcf6e6b28
    s_mov_b32 s35, 0xffff0000
    s_mov_b32 s36, 0x3eb8aa3b
    v_cndmask_b32 v76, v28, v29, s[42:43]
    v_cndmask_b32 v77, v30, v31, s[42:43]
    v_cndmask_b32 v78, v36, v37, s[42:43]
    v_cndmask_b32 v79, v38, v39, s[42:43]
    v_cndmask_b32 v78, v78, v2, s[48:49]
    v_cndmask_b32 v79, v79, v2, s[48:49]
    v_cndmask_b32 v84, v40, v41, s[42:43]
    v_cndmask_b32 v85, v42, v43, s[42:43]
    v_cndmask_b32 v86, v48, v49, s[42:43]
    v_cndmask_b32 v87, v50, v51, s[42:43]
    v_cndmask_b32 v92, v52, v53, s[42:43]
    v_cndmask_b32 v93, v54, v55, s[42:43]
    v_cndmask_b32 v94, v60, v61, s[42:43]
    v_cndmask_b32 v95, v62, v63, s[42:43]
    v_cndmask_b32 v100, v64, v65, s[42:43]
    v_cndmask_b32 v101, v66, v67, s[42:43]
    v_cndmask_b32 v102, v72, v73, s[42:43]
    v_cndmask_b32 v103, v74, v75, s[42:43]
    v_cndmask_b32 v76, v78, v76, s[44:45]
    v_cndmask_b32 v77, v79, v77, s[46:47]
    v_cndmask_b32 v84, v86, v84, s[44:45]
    v_cndmask_b32 v85, v87, v85, s[46:47]
    v_cndmask_b32 v92, v94, v92, s[44:45]
    v_cndmask_b32 v93, v95, v93, s[46:47]
    v_cndmask_b32 v100, v102, v100, s[44:45]
    v_cndmask_b32 v101, v103, v101, s[46:47]
    v_cvt_pk_bf16_f32 v78, v76, v77
    v_cvt_pk_bf16_f32 v86, v84, v85
    v_cvt_pk_bf16_f32 v94, v92, v93
    v_cvt_pk_bf16_f32 v102, v100, v101
    v_lshlrev_b32 v76, 16, v78
    v_and_b32 v77, s35, v78
    v_lshlrev_b32 v84, 16, v86
    v_and_b32 v85, s35, v86
    v_lshlrev_b32 v92, 16, v94
    v_and_b32 v93, s35, v94
    v_lshlrev_b32 v100, 16, v102
    v_and_b32 v101, s35, v102
    v_max_f32 v78, v76, v77
    v_max_f32 v86, v84, v85
    v_max_f32 v94, v92, v93
    v_max_f32 v102, v100, v101
    v_mov_b32 v79, v78
    v_mov_b32 v87, v86
    v_mov_b32 v95, v94
    v_mov_b32 v103, v102
    v_permlane16_swap_b32 v78, v79
    v_permlane16_swap_b32 v86, v87
    v_permlane16_swap_b32 v94, v95
    v_permlane16_swap_b32 v102, v103
    v_max_f32 v78, v78, v79
    v_max_f32 v86, v86, v87
    v_max_f32 v94, v94, v95
    v_max_f32 v102, v102, v103
    v_mov_b32 v79, v78
    v_mov_b32 v87, v86
    v_mov_b32 v95, v94
    v_mov_b32 v103, v102
    v_permlane32_swap_b32 v78, v79
    v_permlane32_swap_b32 v86, v87
    v_permlane32_swap_b32 v94, v95
    v_permlane32_swap_b32 v102, v103
    v_max_f32 v78, v78, v79
    v_max_f32 v86, v86, v87
    v_max_f32 v94, v94, v95
    v_max_f32 v102, v102, v103
    v_sub_f32 v76, v76, v78
    v_sub_f32 v77, v77, v78
    v_sub_f32 v84, v84, v86
    v_sub_f32 v85, v85, v86
    v_sub_f32 v92, v92, v94
    v_sub_f32 v93, v93, v94
    v_sub_f32 v100, v100, v102
    v_sub_f32 v101, v101, v102
    v_mul_f32 v76, s36, v76
    v_mul_f32 v77, s36, v77
    v_mul_f32 v84, s36, v84
    v_mul_f32 v85, s36, v85
    v_mul_f32 v92, s36, v92
    v_mul_f32 v93, s36, v93
    v_mul_f32 v100, s36, v100
    v_mul_f32 v101, s36, v101
    v_exp_f32 v76, v76
    v_exp_f32 v77, v77
    v_exp_f32 v84, v84
    v_exp_f32 v85, v85
    v_exp_f32 v92, v92
    v_exp_f32 v93, v93
    v_exp_f32 v100, v100
    v_exp_f32 v101, v101
    v_add_f32 v78, v76, v77
    v_add_f32 v86, v84, v85
    v_add_f32 v94, v92, v93
    v_add_f32 v102, v100, v101
    v_mov_b32 v79, v78
    v_mov_b32 v87, v86
    v_mov_b32 v95, v94
    v_mov_b32 v103, v102
    v_permlane16_swap_b32 v78, v79
    v_permlane16_swap_b32 v86, v87
    v_permlane16_swap_b32 v94, v95
    v_permlane16_swap_b32 v102, v103
    v_add_f32 v78, v78, v79
    v_add_f32 v86, v86, v87
    v_add_f32 v94, v94, v95
    v_add_f32 v102, v102, v103
    v_mov_b32 v79, v78
    v_mov_b32 v87, v86
    v_mov_b32 v95, v94
    v_mov_b32 v103, v102
    v_permlane32_swap_b32 v78, v79
    v_permlane32_swap_b32 v86, v87
    v_permlane32_swap_b32 v94, v95
    v_permlane32_swap_b32 v102, v103
    v_add_f32 v78, v78, v79
    v_add_f32 v86, v86, v87
    v_add_f32 v94, v94, v95
    v_add_f32 v102, v102, v103
    v_rcp_f32 v78, v78
    v_rcp_f32 v86, v86
    v_rcp_f32 v94, v94
    v_rcp_f32 v102, v102
    v_mul_f32 v76, v76, v78
    v_mul_f32 v77, v77, v78
    v_mul_f32 v84, v84, v86
    v_mul_f32 v85, v85, v86
    v_mul_f32 v92, v92, v94
    v_mul_f32 v93, v93, v94
    v_mul_f32 v100, v100, v102
    v_mul_f32 v101, v101, v102
    v_cvt_pk_bf16_f32 v78, v76, v77
    v_cvt_pk_bf16_f32 v86, v84, v85
    v_cvt_pk_bf16_f32 v94, v92, v93
    v_cvt_pk_bf16_f32 v102, v100, v101
    v_perm_b32 v80, v78, v78, v140
    v_perm_b32 v81, v78, v78, v141
    v_perm_b32 v82, v78, v78, v142
    v_perm_b32 v83, v78, v78, v143
    v_perm_b32 v88, v86, v86, v140
    v_perm_b32 v89, v86, v86, v141
    v_perm_b32 v90, v86, v86, v142
    v_perm_b32 v91, v86, v86, v143
    v_perm_b32 v96, v94, v94, v140
    v_perm_b32 v97, v94, v94, v141
    v_perm_b32 v98, v94, v94, v142
    v_perm_b32 v99, v94, v94, v143
    v_perm_b32 v104, v102, v102, v140
    v_perm_b32 v105, v102, v102, v141
    v_perm_b32 v106, v102, v102, v142
    v_perm_b32 v107, v102, v102, v143
    v_mfma_f32_16x16x32_bf16 v[28:31], v[156:159], v[80:83], 0
    v_mfma_f32_16x16x32_bf16 v[40:43], v[158:161], v[88:91], 0
    v_mfma_f32_16x16x32_bf16 v[52:55], v[160:163], v[96:99], 0
    v_mfma_f32_16x16x32_bf16 v[64:67], v[162:165], v[104:107], 0
    s_nop 4
    v_cvt_pk_bf16_f32 v76, v28, v29
    v_cvt_pk_bf16_f32 v77, v30, v31
    v_cvt_pk_bf16_f32 v78, v40, v41
    v_cvt_pk_bf16_f32 v79, v42, v43
    v_cvt_pk_bf16_f32 v84, v52, v53
    v_cvt_pk_bf16_f32 v85, v54, v55
    v_cvt_pk_bf16_f32 v86, v64, v65
    v_cvt_pk_bf16_f32 v87, v66, v67
    v_mov_b32 v3, 106432
    ds_read_b32 v3, v3
    v_permlane16_swap_b32 v76, v78
    v_permlane16_swap_b32 v77, v79
    buffer_store_dwordx4 v[76:79], v144, s[12:15], s34 offen offset:0
    v_permlane16_swap_b32 v84, v86
    v_permlane16_swap_b32 v85, v87
    buffer_store_dwordx4 v[84:87], v144, s[12:15], s34 offen offset:1024
    s_add_u32 s38, s34, 14680064
    v_mov_b32 v128, v76
    v_mov_b32 v132, v84
    v_mov_b32 v129, v77
    v_mov_b32 v133, v85
    v_mov_b32 v130, v78
    v_mov_b32 v134, v86
    v_mov_b32 v131, v79
    v_mov_b32 v135, v87
    s_and_b32 s36, s25, 3
    s_lshr_b32 s37, s25, 2
    s_lshl_b32 s37, s37, 5
    s_add_u32 s37, s37, s24
    s_lshl_b32 s30, s24, 5
    s_lshl_b32 s31, s25, 8
    s_add_u32 s30, s30, s31
    s_add_u32 s30, s30, 6815744
    s_lshl_b32 s31, s27, 2
    s_add_u32 s31, s31, s30
    s_getreg_b32 s33, hwreg(HW_REG_XCC_ID, 0, 3)
    s_or_b32 s33, s33, 8
    v_mov_b32 v4, 106436
    v_mov_b32 v5, 1
    v_mov_b32 v2, 0
    s_mov_b64 s[48:49], s[42:43]
    s_add_u32 s40, s20, 0x00200000
    s_addc_u32 s41, s21, 0
    s_mov_b32 s42, 0x00200000
    s_mov_b32 s43, 0x00020000
    s_add_u32 s44, s20, 0x00600000
    s_addc_u32 s45, s21, 0
    s_mov_b32 s46, 0x00010000
    s_mov_b32 s47, 0x00020000
    v_lshrrev_b32 v8, 3, v12
    v_lshlrev_b32 v8, 10, v8
    v_and_b32 v9, 7, v12
    v_lshl_add_u32 v8, v9, 7, v8
    v_lshrrev_b32 v9, 1, v12
    v_xor_b32 v9, v9, v13
    v_lshl_add_u32 v8, v9, 4, v8
    v_add_u32 v8, 73728, v8
    v_xor_b32 v9, 64, v8
    v_lshrrev_b32 v10, 5, v1
    v_lshlrev_b32 v10, 12, v10
    v_bfe_u32 v14, v1, 2, 3
    v_lshl_add_u32 v10, v14, 7, v10
    v_bfe_u32 v14, v1, 3, 2
    s_and_b32 s34, s27, 1
    s_lshl_b32 s34, s34, 1
    v_xor_b32 v14, s34, v14
    v_lshl_add_u32 v10, v14, 5, v10
    v_and_b32 v14, 3, v1
    v_lshl_add_u32 v10, v14, 3, v10
    s_lshr_b32 s34, s27, 1
    s_lshl_b32 s34, s34, 10
    v_add_u32 v10, s34, v10
    v_xor_b32 v11, 32, v10
    v_add_u32 v6, 0x10000, v10
    v_add_u32 v7, 0x10000, v11
    v_add_u32 v116, 0x20000, v10
    v_add_u32 v117, 0x20000, v11
    s_waitcnt vmcnt(0) lgkmcnt(0)
    s_mov_b64 exec, 1
    ds_add_rtn_u32 v5, v4, v5
    v_or_b32 v4, s33, v3
    v_or_b32 v3, 1, v3
    s_waitcnt lgkmcnt(0)
    v_cmp_eq_u32 vcc, 3, v5
    s_and_b64 exec, exec, vcc
    s_cbranch_execz att_nopub
    buffer_store_dword v4, v2, s[12:15], s30 offen
att_nopub:
    s_mov_b64 exec, -1
    v_lshrrev_b32 v14, 2, v1
    v_lshlrev_b32 v72, 8, v14
    v_and_b32 v14, 7, v14
    s_lshl_b32 s34, s27, 1
    v_xor_b32 v14, s34, v14
    v_lshl_add_u32 v72, v14, 5, v72
    v_and_b32 v14, 3, v1
    v_lshl_add_u32 v72, v14, 3, v72
    v_xor_b32 v73, 32, v72
    s_lshl_b32 s34, s27, 5
    v_add_u32 v74, s34, v12
    v_mul_u32_u24 v74, 96, v74
    v_lshl_add_u32 v74, v13, 3, v74
    v_lshrrev_b32 v75, 2, v0
    v_and_b32 v14, 3, v0
    v_mul_u32_u24 v76, 96, v75
    v_lshl_add_u32 v76, v14, 4, v76
    s_lshl_b32 s34, s36, 7
    v_add_u32 v75, s34, v75
    v_lshlrev_b32 v75, 12, v75
    v_lshl_add_u32 v75, v14, 4, v75
    v_add_u32 v77, 0x40000, v75
    v_bfe_u32 v14, v1, 2, 2
    v_lshl_add_u32 v14, v13, 3, v14
    v_mul_u32_u24 v78, 96, v14
    v_and_b32 v14, 3, v1
    v_lshl_add_u32 v78, v14, 3, v78
    s_lshl_b32 s34, s27, 5
    v_add_u32 v78, s34, v78
    s_lshl_b32 s34, s27, 11
    v_lshlrev_b32 v79, 6, v12
    v_lshl_add_u32 v79, v13, 3, v79
    v_add_u32 v79, s34, v79
    v_add_u32 v72, 106496, v72
    v_add_u32 v73, 106496, v73
    v_add_u32 v74, 106496, v74
    v_add_u32 v76, 106496, v76
    v_add_u32 v78, 106496, v78
    v_add_u32 v79, 106496, v79
    v_and_b32 v14, 2, v12
    v_cmp_eq_u32 s[50:51], 2, v14
    v_mov_b32 v80, 0x3f803f80
    v_mov_b32 v81, 0x3f803f80
    v_mov_b32 v82, 0x3f803f80
    v_mov_b32 v83, 0x3f803f80
    v_mov_b32 v136, v3
    v_mov_b32 v4, 106440
    s_mov_b32 s33, 0
att_lwait:
    ds_read_b32 v5, v4
    s_add_u32 s33, s33, 1
    s_waitcnt lgkmcnt(0)
    v_readfirstlane_b32 s39, v5
    s_cmp_eq_u32 s39, 8
    s_cbranch_scc1 att_alllocal
    s_cmp_lt_u32 s33, 160
    s_cbranch_scc1 att_lwait
    buffer_store_dwordx4 v[128:131], v144, s[12:15], s38 offen sc1
    buffer_store_dwordx4 v[132:135], v144, s[12:15], s38 offen offset:1024 sc1
    v_mov_b32 v2, 0
    s_waitcnt vmcnt(0)
    s_mov_b64 exec, 1
    buffer_store_dword v136, v2, s[12:15], s31 offen offset:128 sc1
    s_mov_b64 exec, -1
att_alllocal:
    s_barrier
    s_barrier
    ds_read_b128 v[40:43], v8 offset:0
    ds_read_b128 v[44:47], v8 offset:2048
    ds_read_b64_tr_b16 v[48:49], v6 offset:40960
    ds_read_b64_tr_b16 v[50:51], v6 offset:43008
    ds_read_b64_tr_b16 v[52:53], v7 offset:40960
    ds_read_b64_tr_b16 v[54:55], v7 offset:43008
    ds_read_b128 v[56:59], v9 offset:0
    ds_read_b128 v[60:63], v9 offset:2048
    ds_read_b64_tr_b16 v[64:65], v6 offset:49152
    ds_read_b64_tr_b16 v[66:67], v6 offset:51200
    ds_read_b64_tr_b16 v[68:69], v7 offset:49152
    ds_read_b64_tr_b16 v[70:71], v7 offset:51200
    s_waitcnt lgkmcnt(6)
    v_mfma_f32_16x16x32_bf16 v[24:27], v[40:43], v[48:51], 0
    ds_read_b128 v[84:87], v8 offset:4096
    ds_read_b128 v[88:91], v8 offset:6144
    v_mfma_f32_16x16x32_bf16 v[28:31], v[40:43], v[52:55], 0
    ds_read_b64_tr_b16 v[92:93], v6 offset:57344
    ds_read_b64_tr_b16 v[94:95], v6 offset:59392
    v_mfma_f32_16x16x32_bf16 v[32:35], v[44:47], v[48:51], 0
    ds_read_b64_tr_b16 v[96:97], v7 offset:57344
    ds_read_b64_tr_b16 v[98:99], v7 offset:59392
    v_mfma_f32_16x16x32_bf16 v[36:39], v[44:47], v[52:55], 0
    s_waitcnt lgkmcnt(6)
    v_mfma_f32_16x16x32_bf16 v[24:27], v[56:59], v[64:67], v[24:27]
    ds_read_b128 v[100:103], v9 offset:4096
    ds_read_b128 v[104:107], v9 offset:6144
    v_mfma_f32_16x16x32_bf16 v[28:31], v[56:59], v[68:71], v[28:31]
    ds_read_b64_tr_b16 v[108:109], v116 offset:0
    ds_read_b64_tr_b16 v[110:111], v116 offset:2048
    v_mfma_f32_16x16x32_bf16 v[32:35], v[60:63], v[64:67], v[32:35]
    ds_read_b64_tr_b16 v[112:113], v117 offset:0
    ds_read_b64_tr_b16 v[114:115], v117 offset:2048
    v_mfma_f32_16x16x32_bf16 v[36:39], v[60:63], v[68:71], v[36:39]
    s_waitcnt lgkmcnt(6)
    v_mfma_f32_16x16x32_bf16 v[24:27], v[84:87], v[92:95], v[24:27]
    ds_read_b128 v[40:43], v8 offset:8192
    ds_read_b128 v[44:47], v8 offset:10240
    v_mfma_f32_16x16x32_bf16 v[28:31], v[84:87], v[96:99], v[28:31]
    ds_read_b64_tr_b16 v[48:49], v116 offset:8192
    ds_read_b64_tr_b16 v[50:51], v116 offset:10240
    v_mfma_f32_16x16x32_bf16 v[32:35], v[88:91], v[92:95], v[32:35]
    ds_read_b64_tr_b16 v[52:53], v117 offset:8192
    ds_read_b64_tr_b16 v[54:55], v117 offset:10240
    v_mfma_f32_16x16x32_bf16 v[36:39], v[88:91], v[96:99], v[36:39]
    s_waitcnt lgkmcnt(6)
    v_mfma_f32_16x16x32_bf16 v[24:27], v[100:103], v[108:111], v[24:27]
    ds_read_b128 v[56:59], v9 offset:8192
    ds_read_b128 v[60:63], v9 offset:10240
    v_mfma_f32_16x16x32_bf16 v[28:31], v[100:103], v[112:115], v[28:31]
    ds_read_b64_tr_b16 v[64:65], v116 offset:16384
    ds_read_b64_tr_b16 v[66:67], v116 offset:18432
    v_mfma_f32_16x16x32_bf16 v[32:35], v[104:107], v[108:111], v[32:35]
    ds_read_b64_tr_b16 v[68:69], v117 offset:16384
    ds_read_b64_tr_b16 v[70:71], v117 offset:18432
    v_mfma_f32_16x16x32_bf16 v[36:39], v[104:107], v[112:115], v[36:39]
    s_waitcnt lgkmcnt(6)
    v_mfma_f32_16x16x32_bf16 v[24:27], v[40:43], v[48:51], v[24:27]
    ds_read_b128 v[84:87], v8 offset:12288
    ds_read_b128 v[88:91], v8 offset:14336
    v_mfma_f32_16x16x32_bf16 v[28:31], v[40:43], v[52:55], v[28:31]
    ds_read_b64_tr_b16 v[92:93], v116 offset:24576
    ds_read_b64_tr_b16 v[94:95], v116 offset:26624
    v_mfma_f32_16x16x32_bf16 v[32:35], v[44:47], v[48:51], v[32:35]
    ds_read_b64_tr_b16 v[96:97], v117 offset:24576
    ds_read_b64_tr_b16 v[98:99], v117 offset:26624
    v_mfma_f32_16x16x32_bf16 v[36:39], v[44:47], v[52:55], v[36:39]
    s_barrier
    s_waitcnt lgkmcnt(6)
    v_mfma_f32_16x16x32_bf16 v[24:27], v[56:59], v[64:67], v[24:27]
    ds_read_b128 v[100:103], v9 offset:12288
    ds_read_b128 v[104:107], v9 offset:14336
    v_mfma_f32_16x16x32_bf16 v[28:31], v[56:59], v[68:71], v[28:31]
    ds_read_b64_tr_b16 v[108:109], v10 offset:0
    ds_read_b64_tr_b16 v[110:111], v10 offset:2048
    v_mfma_f32_16x16x32_bf16 v[32:35], v[60:63], v[64:67], v[32:35]
    ds_read_b64_tr_b16 v[112:113], v11 offset:0
    ds_read_b64_tr_b16 v[114:115], v11 offset:2048
    v_mfma_f32_16x16x32_bf16 v[36:39], v[60:63], v[68:71], v[36:39]
    s_waitcnt lgkmcnt(6)
    v_mfma_f32_16x16x32_bf16 v[24:27], v[84:87], v[92:95], v[24:27]
    ds_read_b128 v[40:43], v8 offset:16384
    ds_read_b128 v[44:47], v8 offset:18432
    v_mfma_f32_16x16x32_bf16 v[28:31], v[84:87], v[96:99], v[28:31]
    ds_read_b64_tr_b16 v[48:49], v10 offset:8192
    ds_read_b64_tr_b16 v[50:51], v10 offset:10240
    v_mfma_f32_16x16x32_bf16 v[32:35], v[88:91], v[92:95], v[32:35]
    ds_read_b64_tr_b16 v[52:53], v11 offset:8192
    ds_read_b64_tr_b16 v[54:55], v11 offset:10240
    v_mfma_f32_16x16x32_bf16 v[36:39], v[88:91], v[96:99], v[36:39]
    s_waitcnt lgkmcnt(6)
    v_mfma_f32_16x16x32_bf16 v[24:27], v[100:103], v[108:111], v[24:27]
    ds_read_b128 v[56:59], v9 offset:16384
    ds_read_b128 v[60:63], v9 offset:18432
    v_mfma_f32_16x16x32_bf16 v[28:31], v[100:103], v[112:115], v[28:31]
    ds_read_b64_tr_b16 v[64:65], v10 offset:16384
    ds_read_b64_tr_b16 v[66:67], v10 offset:18432
    v_mfma_f32_16x16x32_bf16 v[32:35], v[104:107], v[108:111], v[32:35]
    ds_read_b64_tr_b16 v[68:69], v11 offset:16384
    ds_read_b64_tr_b16 v[70:71], v11 offset:18432
    v_mfma_f32_16x16x32_bf16 v[36:39], v[104:107], v[112:115], v[36:39]
    s_waitcnt lgkmcnt(6)
    v_mfma_f32_16x16x32_bf16 v[24:27], v[40:43], v[48:51], v[24:27]
    ds_read_b128 v[84:87], v8 offset:20480
    ds_read_b128 v[88:91], v8 offset:22528
    v_mfma_f32_16x16x32_bf16 v[28:31], v[40:43], v[52:55], v[28:31]
    ds_read_b64_tr_b16 v[92:93], v10 offset:24576
    ds_read_b64_tr_b16 v[94:95], v10 offset:26624
    v_mfma_f32_16x16x32_bf16 v[32:35], v[44:47], v[48:51], v[32:35]
    ds_read_b64_tr_b16 v[96:97], v11 offset:24576
    ds_read_b64_tr_b16 v[98:99], v11 offset:26624
    v_mfma_f32_16x16x32_bf16 v[36:39], v[44:47], v[52:55], v[36:39]
    s_waitcnt lgkmcnt(6)
    v_mfma_f32_16x16x32_bf16 v[24:27], v[56:59], v[64:67], v[24:27]
    ds_read_b128 v[100:103], v9 offset:20480
    ds_read_b128 v[104:107], v9 offset:22528
    v_mfma_f32_16x16x32_bf16 v[28:31], v[56:59], v[68:71], v[28:31]
    ds_read_b64_tr_b16 v[108:109], v10 offset:32768
    ds_read_b64_tr_b16 v[110:111], v10 offset:34816
    v_mfma_f32_16x16x32_bf16 v[32:35], v[60:63], v[64:67], v[32:35]
    ds_read_b64_tr_b16 v[112:113], v11 offset:32768
    ds_read_b64_tr_b16 v[114:115], v11 offset:34816
    v_mfma_f32_16x16x32_bf16 v[36:39], v[60:63], v[68:71], v[36:39]
    s_waitcnt lgkmcnt(6)
    v_mfma_f32_16x16x32_bf16 v[24:27], v[84:87], v[92:95], v[24:27]
    ds_read_b128 v[40:43], v8 offset:24576
    ds_read_b128 v[44:47], v8 offset:26624
    v_mfma_f32_16x16x32_bf16 v[28:31], v[84:87], v[96:99], v[28:31]
    ds_read_b64_tr_b16 v[48:49], v10 offset:40960
    ds_read_b64_tr_b16 v[50:51], v10 offset:43008
    v_mfma_f32_16x16x32_bf16 v[32:35], v[88:91], v[92:95], v[32:35]
    ds_read_b64_tr_b16 v[52:53], v11 offset:40960
    ds_read_b64_tr_b16 v[54:55], v11 offset:43008
    v_mfma_f32_16x16x32_bf16 v[36:39], v[88:91], v[96:99], v[36:39]
    s_waitcnt lgkmcnt(6)
    v_mfma_f32_16x16x32_bf16 v[24:27], v[100:103], v[108:111], v[24:27]
    ds_read_b128 v[56:59], v9 offset:24576
    ds_read_b128 v[60:63], v9 offset:26624
    v_mfma_f32_16x16x32_bf16 v[28:31], v[100:103], v[112:115], v[28:31]
    ds_read_b64_tr_b16 v[64:65], v10 offset:49152
    ds_read_b64_tr_b16 v[66:67], v10 offset:51200
    v_mfma_f32_16x16x32_bf16 v[32:35], v[104:107], v[108:111], v[32:35]
    ds_read_b64_tr_b16 v[68:69], v11 offset:49152
    ds_read_b64_tr_b16 v[70:71], v11 offset:51200
    v_mfma_f32_16x16x32_bf16 v[36:39], v[104:107], v[112:115], v[36:39]
    s_waitcnt lgkmcnt(6)
    v_mfma_f32_16x16x32_bf16 v[24:27], v[40:43], v[48:51], v[24:27]
    ds_read_b128 v[84:87], v8 offset:28672
    ds_read_b128 v[88:91], v8 offset:30720
    v_mfma_f32_16x16x32_bf16 v[28:31], v[40:43], v[52:55], v[28:31]
    ds_read_b64_tr_b16 v[92:93], v10 offset:57344
    ds_read_b64_tr_b16 v[94:95], v10 offset:59392
    v_mfma_f32_16x16x32_bf16 v[32:35], v[44:47], v[48:51], v[32:35]
    ds_read_b64_tr_b16 v[96:97], v11 offset:57344
    ds_read_b64_tr_b16 v[98:99], v11 offset:59392
    v_mfma_f32_16x16x32_bf16 v[36:39], v[44:47], v[52:55], v[36:39]
    s_waitcnt lgkmcnt(6)
    v_mfma_f32_16x16x32_bf16 v[24:27], v[56:59], v[64:67], v[24:27]
    ds_read_b128 v[100:103], v9 offset:28672
    ds_read_b128 v[104:107], v9 offset:30720
    v_mfma_f32_16x16x32_bf16 v[28:31], v[56:59], v[68:71], v[28:31]
    ds_read_b64_tr_b16 v[108:109], v6 offset:0
    ds_read_b64_tr_b16 v[110:111], v6 offset:2048
    v_mfma_f32_16x16x32_bf16 v[32:35], v[60:63], v[64:67], v[32:35]
    ds_read_b64_tr_b16 v[112:113], v7 offset:0
    ds_read_b64_tr_b16 v[114:115], v7 offset:2048
    v_mfma_f32_16x16x32_bf16 v[36:39], v[60:63], v[68:71], v[36:39]
    s_waitcnt lgkmcnt(6)
    v_mfma_f32_16x16x32_bf16 v[24:27], v[84:87], v[92:95], v[24:27]
    v_mfma_f32_16x16x32_bf16 v[28:31], v[84:87], v[96:99], v[28:31]
    v_mfma_f32_16x16x32_bf16 v[32:35], v[88:91], v[92:95], v[32:35]
    v_mfma_f32_16x16x32_bf16 v[36:39], v[88:91], v[96:99], v[36:39]
    s_waitcnt lgkmcnt(0)
    v_mfma_f32_16x16x32_bf16 v[24:27], v[100:103], v[108:111], v[24:27]
    v_mfma_f32_16x16x32_bf16 v[28:31], v[100:103], v[112:115], v[28:31]
    v_mfma_f32_16x16x32_bf16 v[32:35], v[104:107], v[108:111], v[32:35]
    v_mfma_f32_16x16x32_bf16 v[36:39], v[104:107], v[112:115], v[36:39]
    s_nop 4
    v_cvt_pk_bf16_f32 v48, v24, v25
    v_cvt_pk_bf16_f32 v49, v26, v27
    v_cvt_pk_bf16_f32 v50, v28, v29
    v_cvt_pk_bf16_f32 v51, v30, v31
    v_cvt_pk_bf16_f32 v52, v32, v33
    v_cvt_pk_bf16_f32 v53, v34, v35
    v_cvt_pk_bf16_f32 v54, v36, v37
    v_cvt_pk_bf16_f32 v55, v38, v39
    s_barrier
    s_cmp_eq_u32 s52, 2
    s_cbranch_scc1 att_resxt
    ds_read_b64_tr_b16 v[120:121], v72 offset:0
    ds_read_b64_tr_b16 v[122:123], v73 offset:0
    ds_read_b64_tr_b16 v[124:125], v72 offset:4096
    ds_read_b64_tr_b16 v[126:127], v73 offset:4096
    s_branch att_havres
att_resxt:
    ds_read_b64 v[120:121], v79 offset:0
    ds_read_b64 v[122:123], v79 offset:1024
    ds_read_b64 v[124:125], v79 offset:32
    ds_read_b64 v[126:127], v79 offset:1056
att_havres:
    v_lshlrev_b32 v24, 16, v48
    v_and_b32 v25, s35, v48
    v_lshlrev_b32 v26, 16, v49
    v_and_b32 v27, s35, v49
    v_lshlrev_b32 v28, 16, v50
    v_and_b32 v29, s35, v50
    v_lshlrev_b32 v30, 16, v51
    v_and_b32 v31, s35, v51
    v_lshlrev_b32 v32, 16, v52
    v_and_b32 v33, s35, v52
    v_lshlrev_b32 v34, 16, v53
    v_and_b32 v35, s35, v53
    v_lshlrev_b32 v36, 16, v54
    v_and_b32 v37, s35, v54
    v_lshlrev_b32 v38, 16, v55
    v_and_b32 v39, s35, v55
    s_waitcnt vmcnt(0) lgkmcnt(0)
    v_lshlrev_b32 v56, 16, v120
    v_and_b32 v57, s35, v120
    v_lshlrev_b32 v58, 16, v121
    v_and_b32 v59, s35, v121
    v_lshlrev_b32 v60, 16, v122
    v_and_b32 v61, s35, v122
    v_lshlrev_b32 v62, 16, v123
    v_and_b32 v63, s35, v123
    v_lshlrev_b32 v64, 16, v124
    v_and_b32 v65, s35, v124
    v_lshlrev_b32 v66, 16, v125
    v_and_b32 v67, s35, v125
    v_lshlrev_b32 v68, 16, v126
    v_and_b32 v69, s35, v126
    v_lshlrev_b32 v70, 16, v127
    v_and_b32 v71, s35, v127
    v_pk_add_f32 v[24:25], v[24:25], v[56:57]
    v_pk_add_f32 v[26:27], v[26:27], v[58:59]
    v_pk_add_f32 v[28:29], v[28:29], v[60:61]
    v_pk_add_f32 v[30:31], v[30:31], v[62:63]
    v_pk_add_f32 v[32:33], v[32:33], v[64:65]
    v_pk_add_f32 v[34:35], v[34:35], v[66:67]
    v_pk_add_f32 v[36:37], v[36:37], v[68:69]
    v_pk_add_f32 v[38:39], v[38:39], v[70:71]
    v_cvt_pk_bf16_f32 v48, v24, v25
    v_cvt_pk_bf16_f32 v49, v26, v27
    ds_write_b64 v74, v[48:49] offset:8192
    v_cvt_pk_bf16_f32 v50, v28, v29
    v_cvt_pk_bf16_f32 v51, v30, v31
    ds_write_b64 v74, v[50:51] offset:9728
    v_cvt_pk_bf16_f32 v52, v32, v33
    v_cvt_pk_bf16_f32 v53, v34, v35
    ds_write_b64 v74, v[52:53] offset:8224
    v_cvt_pk_bf16_f32 v54, v36, v37
    v_cvt_pk_bf16_f32 v55, v38, v39
    ds_write_b64 v74, v[54:55] offset:9760
    s_waitcnt lgkmcnt(0)
    s_barrier
    ds_read_b128 v[24:27], v76 offset:8192
    ds_read_b128 v[28:31], v76 offset:14336
    s_lshl_b32 s38, s37, 1
    s_cmp_lt_u32 s27, 2
    s_cbranch_scc0 att_nostats
    ds_read_b64_tr_b16 v[40:41], v78 offset:8192
    ds_read_b64_tr_b16 v[42:43], v78 offset:8576
    ds_read_b64_tr_b16 v[44:45], v78 offset:11264
    ds_read_b64_tr_b16 v[46:47], v78 offset:11648
    ds_read_b64_tr_b16 v[48:49], v78 offset:14336
    ds_read_b64_tr_b16 v[50:51], v78 offset:14720
    ds_read_b64_tr_b16 v[52:53], v78 offset:17408
    ds_read_b64_tr_b16 v[54:55], v78 offset:17792
    s_waitcnt lgkmcnt(8)
    buffer_store_dwordx4 v[24:27], v75, s[40:43], s38 offen
    buffer_store_dwordx4 v[28:31], v77, s[40:43], s38 offen
    s_waitcnt lgkmcnt(6)
    v_mfma_f32_16x16x32_bf16 v[56:59], v[40:43], v[80:83], 0
    v_mfma_f32_16x16x32_bf16 v[60:63], v[40:43], v[40:43], 0
    s_waitcnt lgkmcnt(4)
    v_mfma_f32_16x16x32_bf16 v[56:59], v[44:47], v[80:83], v[56:59]
    v_mfma_f32_16x16x32_bf16 v[60:63], v[44:47], v[44:47], v[60:63]
    s_waitcnt lgkmcnt(2)
    v_mfma_f32_16x16x32_bf16 v[56:59], v[48:51], v[80:83], v[56:59]
    v_mfma_f32_16x16x32_bf16 v[60:63], v[48:51], v[48:51], v[60:63]
    s_waitcnt lgkmcnt(0)
    v_mfma_f32_16x16x32_bf16 v[56:59], v[52:55], v[80:83], v[56:59]
    v_mfma_f32_16x16x32_bf16 v[60:63], v[52:55], v[52:55], v[60:63]
    s_lshl_b32 s34, s36, 3
    s_lshl_b32 s35, s37, 5
    s_add_u32 s34, s34, s35
    s_lshl_b32 s35, s27, 9
    s_add_u32 s34, s34, s35
    v_lshlrev_b32 v4, 5, v12
    s_mov_b32 s52, 0x00f0000f
    s_mov_b32 s53, 0xf0000f00
    v_cndmask_b32 v64, v56, v57, s[48:49]
    v_cndmask_b32 v65, v58, v59, s[48:49]
    v_cndmask_b32 v66, v60, v61, s[48:49]
    v_cndmask_b32 v67, v62, v63, s[48:49]
    v_cndmask_b32 v64, v64, v65, s[50:51]
    v_cndmask_b32 v65, v66, v67, s[50:51]
    s_mov_b64 exec, s[52:53]
    buffer_store_dwordx2 v[64:65], v4, s[44:47], s34 offen
    s_endpgm
att_nostats:
    s_waitcnt lgkmcnt(0)
    buffer_store_dwordx4 v[24:27], v75, s[40:43], s38 offen
    buffer_store_dwordx4 v[28:31], v77, s[40:43], s38 offen
att_exit:
    s_endpgm
kgen_body:
    s_load_dwordx16 s[16:31], s[0:1], 32
    s_load_dwordx2 s[4:5], s[0:1], 112
    v_lshrrev_b32 v6, 6, v0
    v_and_b32 v3, 63, v0
    v_and_b32 v4, 15, v0
    v_readfirstlane_b32 s34, v6
    v_lshrrev_b32 v5, 4, v3
    s_cmp_ge_u32 s34, 8
    s_cbranch_scc1 kgen_aux
    s_load_dwordx4 s[56:59], s[0:1], 0
    s_load_dwordx2 s[60:61], s[0:1], 16
    s_load_dwordx2 s[46:47], s[0:1], 96
    s_lshr_b32 s33, s34, 2
    s_and_b32 s36, s34, 3
    s_and_b32 s37, s34, 1
    s_lshl_b32 s6, s2, 1
    s_add_u32 s6, s6, s33
    s_lshl_b32 s7, s6, 8
    s_lshl_b32 s38, s37, 7
    s_add_u32 s7, s7, s38
    v_lshl_add_u32 v1, v3, 1, s7
    s_lshl_b32 s7, s6, 1
    v_mov_b32 v8, s7
    s_mul_i32 s35, s33, 49152
    v_mov_b32 v10, 0
    v_mov_b32 v11, 0
    v_mov_b32 v12, 0
    v_mov_b32 v13, 0
    v_mov_b32 v14, 0
    v_mov_b32 v15, 0
    v_mov_b32 v16, 0
    s_cmp_lt_u32 s36, 2
    s_waitcnt lgkmcnt(0)
    global_load_short_d16_hi v16, v8, s[28:29]
    global_load_short_d16_hi v10, v1, s[16:17]
    global_load_short_d16_hi v11, v1, s[18:19]
    s_cbranch_scc1 kgen_noload
    global_load_short_d16_hi v12, v1, s[20:21]
    global_load_short_d16_hi v13, v1, s[22:23]
    global_load_short_d16_hi v14, v1, s[24:25]
    global_load_short_d16_hi v15, v1, s[26:27]
kgen_noload:
    v_mul_u32_u24 v9, 1088, v5
    v_bfe_u32 v18, v3, 2, 2
    v_mul_u32_u24 v18, 272, v18
    v_add_u32 v9, v9, v18
    v_and_b32 v18, 3, v3
    v_lshl_add_u32 v9, v18, 2, v9
    s_mul_i32 s38, s37, 4352
    s_add_u32 s38, s38, s35
    v_add_u32 v9, s38, v9
    v_lshlrev_b32 v17, 7, v3
    v_lshlrev_b32 v18, 20, v3
    s_mov_b32 s12, 0x3fb8aa3b
    s_mov_b32 s13, 0x32a57060
    s_mov_b32 s14, 0x3f317218
    s_waitcnt vmcnt(0)
    s_cmp_eq_u32 s34, 2
    s_cbranch_scc0 kgen_t1
    s_mov_b32 s48, s56
    s_mov_b32 s49, s57
    s_mov_b32 s50, 0x00200000
    s_mov_b32 s51, 0x00020000
    s_lshl_b32 s39, s2, 13
    buffer_load_dword v166, v17, s[48:51], s39 offen
    s_branch kgen_tdone
kgen_t1:
    s_cmp_eq_u32 s34, 3
    s_cbranch_scc0 kgen_t2
    s_mov_b32 s48, s58
    s_mov_b32 s49, s59
    s_mov_b32 s50, 0x00180000
    s_mov_b32 s51, 0x00020000
    s_mul_i32 s39, s2, 6144
    buffer_load_dword v166, v17, s[48:51], s39 offen
    s_branch kgen_tdone
kgen_t2:
    s_cmp_eq_u32 s34, 6
    s_cbranch_scc0 kgen_t3
    s_mov_b32 s48, s60
    s_mov_b32 s49, s61
    s_mov_b32 s50, 0x00080000
    s_mov_b32 s51, 0x00020000
    s_lshl_b32 s39, s2, 11
    s_mov_b64 exec, 0xffff
    buffer_load_dword v166, v17, s[48:51], s39 offen
    s_branch kgen_tdone
kgen_t3:
    s_cmp_eq_u32 s34, 7
    s_cbranch_scc0 kgen_tdone
    s_mov_b32 s48, s4
    s_mov_b32 s49, s5
    s_mov_b32 s50, 0x01000000
    s_mov_b32 s51, 0x00020000
    buffer_load_dword v166, v18, s[48:51], 0 offen
    s_mov_b32 s52, s46
    s_mov_b32 s53, s47
    s_mov_b32 s54, 0x00200000
    s_mov_b32 s55, 0x00020000
    s_mov_b64 exec, 1
    buffer_load_dword v165, v17, s[52:55], 0 offen
kgen_tdone:
    s_mov_b64 exec, -1
    v_mul_f32 v30, s12, v16
    v_fma_f32 v31, v16, s12, -v30
    v_fma_f32 v31, v16, s13, v31
    v_exp_f32 v30, v30
    v_mul_f32 v31, s14, v31
    v_fma_f32 v30, v30, v31, v30
    v_cvt_pk_bf16_f32 v30, v30, v30
    v_lshlrev_b32 v30, 16, v30
    v_mul_f32 v10, v30, v10
    v_mul_f32 v11, v30, v11
    v_mul_f32 v12, v30, v12
    v_mul_f32 v13, v30, v13
    v_mul_f32 v20, s12, v10
    v_mul_f32 v22, v14, v12
    v_mul_f32 v23, v14, v13
    v_mul_f32 v21, 0x3e22f983, v11
    v_fma_f32 v22, -v15, v13, v22
    v_fma_f32 v23, v15, v12, v23
    v_mov_b32 v24, v20
    v_mov_b32 v26, 0x02081cea
    v_max3_f32 v25, abs(v22), abs(v23), v26
    v_max_f32_dpp v24, v24, v24 row_ror:8 row_mask:0xf bank_mask:0xf
    s_nop 0
    v_max_f32_dpp v25, v25, v25 row_ror:8 row_mask:0xf bank_mask:0xf
    v_max_f32_dpp v24, v24, v24 row_ror:4 row_mask:0xf bank_mask:0xf
    s_nop 0
    v_max_f32_dpp v25, v25, v25 row_ror:4 row_mask:0xf bank_mask:0xf
    v_max_f32_dpp v24, v24, v24 row_ror:2 row_mask:0xf bank_mask:0xf
    s_nop 0
    v_max_f32_dpp v25, v25, v25 row_ror:2 row_mask:0xf bank_mask:0xf
    v_max_f32_dpp v24, v24, v24 row_ror:1 row_mask:0xf bank_mask:0xf
    s_nop 0
    v_max_f32_dpp v25, v25, v25 row_ror:1 row_mask:0xf bank_mask:0xf
    v_mov_b32 v26, v24
    v_mov_b32 v27, v25
    s_nop 0
    v_permlane16_swap_b32 v24, v26
    v_permlane16_swap_b32 v25, v27
    v_max_f32 v24, v24, v26
    v_max_f32 v25, v25, v27
    v_mov_b32 v26, v24
    v_mov_b32 v27, v25
    s_nop 0
    v_permlane32_swap_b32 v24, v26
    v_permlane32_swap_b32 v25, v27
    v_max_f32 v24, v24, v26
    v_max_f32 v25, v25, v27
    v_rcp_f32 v26, v25
    v_sub_f32 v12, v20, v24
    v_mov_b32 v13, v21
    v_mul_f32 v14, v22, v26
    v_mul_f32 v15, v23, v26
    v_rcp_f32 v25, v26
    s_cmp_lt_u32 s36, 2
    s_cbranch_scc0 kgen_job1
    v_mul_f32 v60, 0x3f800000, v12
    v_mul_f32 v16, 0x3f800000, v13
    v_mul_f32 v61, 0x40000000, v12
    v_mul_f32 v18, 0x40000000, v13
    v_mul_f32 v62, 0x40800000, v12
    v_mul_f32 v20, 0x40800000, v13
    v_mul_f32 v63, 0x43000000, v12
    v_mul_f32 v22, 0x43000000, v13
    v_mul_f32 v64, 0x43800000, v12
    v_mul_f32 v24, 0x43800000, v13
    v_mul_f32 v65, 0x44000000, v12
    v_mul_f32 v26, 0x44000000, v13
    v_exp_f32 v60, v60
    v_fract_f32 v16, v16
    v_exp_f32 v61, v61
    v_fract_f32 v18, v18
    v_exp_f32 v62, v62
    v_fract_f32 v20, v20
    v_exp_f32 v63, v63
    v_fract_f32 v22, v22
    v_exp_f32 v64, v64
    v_fract_f32 v24, v24
    v_exp_f32 v65, v65
    v_fract_f32 v26, v26
    v_sin_f32 v17, v16
    v_cos_f32 v16, v16
    v_sin_f32 v19, v18
    v_cos_f32 v18, v18
    v_sin_f32 v21, v20
    v_cos_f32 v20, v20
    v_sin_f32 v23, v22
    v_cos_f32 v22, v22
    v_sin_f32 v25, v24
    v_cos_f32 v24, v24
    v_sin_f32 v27, v26
    v_cos_f32 v26, v26
    v_mul_f32 v17, v17, v60
    v_mul_f32 v16, v16, v60
    v_mul_f32 v19, v19, v61
    v_mul_f32 v18, v18, v61
    v_mul_f32 v21, v21, v62
    v_mul_f32 v20, v20, v62
    v_mul_f32 v23, v23, v63
    v_mul_f32 v22, v22, v63
    v_mul_f32 v25, v25, v64
    v_mul_f32 v24, v24, v64
    v_mul_f32 v27, v27, v65
    v_mul_f32 v26, v26, v65
    v_mov_b32 v88, 0x3c00
    ds_write_b32 v9, v88 offset:0
    v_cvt_pk_f16_f32 v80, v16, v17
    ds_write_b32 v9, v80 offset:16
    v_cvt_pk_f16_f32 v81, v18, v19
    ds_write_b32 v9, v81 offset:32
    v_cvt_pk_f16_f32 v82, v20, v21
    ds_write_b32 v9, v82 offset:64
    v_cvt_pk_f16_f32 v83, v22, v23
    ds_write_b32 v9, v83 offset:128
    v_cvt_pk_f16_f32 v84, v24, v25
    ds_write_b32 v9, v84 offset:8704
    v_cvt_pk_f16_f32 v85, v26, v27
    ds_write_b32 v9, v85 offset:8832
    v_mul_f32 v28, v16, v18
    v_mul_f32 v29, v16, v19
    v_mul_f32 v30, v16, v20
    v_mul_f32 v31, v16, v21
    v_mul_f32 v32, v18, v20
    v_mul_f32 v33, v18, v21
    v_mul_f32 v34, v22, v24
    v_mul_f32 v35, v22, v25
    v_mul_f32 v36, v26, v22
    v_mul_f32 v37, v26, v23
    v_mul_f32 v38, v26, v24
    v_mul_f32 v39, v26, v25
    v_fma_f32 v28, -v17, v19, v28
    v_fma_f32 v29, v17, v18, v29
    v_fma_f32 v30, -v17, v21, v30
    v_fma_f32 v31, v17, v20, v31
    v_fma_f32 v32, -v19, v21, v32
    v_fma_f32 v33, v19, v20, v33
    v_fma_f32 v34, -v23, v25, v34
    v_fma_f32 v35, v23, v24, v35
    v_fma_f32 v36, -v27, v23, v36
    v_fma_f32 v37, v27, v22, v37
    v_fma_f32 v38, -v27, v25, v38
    v_fma_f32 v39, v27, v24, v39
    v_cvt_pk_f16_f32 v86, v28, v29
    ds_write_b32 v9, v86 offset:48
    v_cvt_pk_f16_f32 v87, v30, v31
    ds_write_b32 v9, v87 offset:80
    v_cvt_pk_f16_f32 v80, v32, v33
    ds_write_b32 v9, v80 offset:96
    v_cvt_pk_f16_f32 v81, v34, v35
    ds_write_b32 v9, v81 offset:8768
    v_cvt_pk_f16_f32 v82, v36, v37
    ds_write_b32 v9, v82 offset:8864
    v_cvt_pk_f16_f32 v83, v38, v39
    ds_write_b32 v9, v83 offset:8896
    v_mul_f32 v40, v28, v20
    v_mul_f32 v41, v28, v21
    v_mul_f32 v42, v26, v34
    v_mul_f32 v43, v26, v35
    v_mul_f32 v68, v22, v16
    v_mul_f32 v69, v22, v17
    v_mul_f32 v70, v22, v18
    v_mul_f32 v71, v22, v19
    v_mul_f32 v72, v22, v28
    v_mul_f32 v73, v22, v29
    v_mul_f32 v74, v22, v20
    v_mul_f32 v75, v22, v21
    v_fma_f32 v40, -v29, v21, v40
    v_fma_f32 v41, v29, v20, v41
    v_fma_f32 v42, -v27, v35, v42
    v_fma_f32 v43, v27, v34, v43
    v_fma_f32 v68, -v23, v17, v68
    v_fma_f32 v69, v23, v16, v69
    v_fma_f32 v70, -v23, v19, v70
    v_fma_f32 v71, v23, v18, v71
    v_fma_f32 v72, -v23, v29, v72
    v_fma_f32 v73, v23, v28, v73
    v_fma_f32 v74, -v23, v21, v74
    v_fma_f32 v75, v23, v20, v75
    v_cvt_pk_f16_f32 v84, v40, v41
    ds_write_b32 v9, v84 offset:112
    v_cvt_pk_f16_f32 v85, v42, v43
    ds_write_b32 v9, v85 offset:8928
    v_cvt_pk_f16_f32 v86, v68, v69
    ds_write_b32 v9, v86 offset:144
    v_cvt_pk_f16_f32 v87, v70, v71
    ds_write_b32 v9, v87 offset:160
    v_cvt_pk_f16_f32 v80, v72, v73
    ds_write_b32 v9, v80 offset:176
    v_cvt_pk_f16_f32 v81, v74, v75
    ds_write_b32 v9, v81 offset:192
    v_mul_f32 v76, v22, v30
    v_mul_f32 v77, v22, v31
    v_mul_f32 v78, v22, v32
    v_mul_f32 v79, v22, v33
    v_mul_f32 v68, v22, v40
    v_mul_f32 v69, v22, v41
    v_mul_f32 v70, v24, v18
    v_mul_f32 v71, v24, v19
    v_mul_f32 v72, v24, v20
    v_mul_f32 v73, v24, v21
    v_mul_f32 v74, v24, v32
    v_mul_f32 v75, v24, v33
    v_fma_f32 v76, -v23, v31, v76
    v_fma_f32 v77, v23, v30, v77
    v_fma_f32 v78, -v23, v33, v78
    v_fma_f32 v79, v23, v32, v79
    v_fma_f32 v68, -v23, v41, v68
    v_fma_f32 v69, v23, v40, v69
    v_fma_f32 v70, -v25, v19, v70
    v_fma_f32 v71, v25, v18, v71
    v_fma_f32 v72, -v25, v21, v72
    v_fma_f32 v73, v25, v20, v73
    v_fma_f32 v74, -v25, v33, v74
    v_fma_f32 v75, v25, v32, v75
    v_cvt_pk_f16_f32 v82, v76, v77
    ds_write_b32 v9, v82 offset:208
    v_cvt_pk_f16_f32 v83, v78, v79
    ds_write_b32 v9, v83 offset:224
    v_cvt_pk_f16_f32 v84, v68, v69
    ds_write_b32 v9, v84 offset:240
    v_cvt_pk_f16_f32 v85, v70, v71
    ds_write_b32 v9, v85 offset:8720
    v_cvt_pk_f16_f32 v86, v72, v73
    ds_write_b32 v9, v86 offset:8736
    v_cvt_pk_f16_f32 v87, v74, v75
    ds_write_b32 v9, v87 offset:8752
    v_mul_f32 v76, v34, v18
    v_mul_f32 v77, v34, v19
    v_mul_f32 v78, v34, v20
    v_mul_f32 v79, v34, v21
    v_mul_f32 v68, v34, v32
    v_mul_f32 v69, v34, v33
    v_mul_f32 v70, v26, v20
    v_mul_f32 v71, v26, v21
    v_mul_f32 v72, v36, v20
    v_mul_f32 v73, v36, v21
    v_mul_f32 v74, v38, v20
    v_mul_f32 v75, v38, v21
    v_fma_f32 v76, -v35, v19, v76
    v_fma_f32 v77, v35, v18, v77
    v_fma_f32 v78, -v35, v21, v78
    v_fma_f32 v79, v35, v20, v79
    v_fma_f32 v68, -v35, v33, v68
    v_fma_f32 v69, v35, v32, v69
    v_fma_f32 v70, -v27, v21, v70
    v_fma_f32 v71, v27, v20, v71
    v_fma_f32 v72, -v37, v21, v72
    v_fma_f32 v73, v37, v20, v73
    v_fma_f32 v74, -v39, v21, v74
    v_fma_f32 v75, v39, v20, v75
    v_cvt_pk_f16_f32 v80, v76, v77
    ds_write_b32 v9, v80 offset:8784
    v_cvt_pk_f16_f32 v81, v78, v79
    ds_write_b32 v9, v81 offset:8800
    v_cvt_pk_f16_f32 v82, v68, v69
    ds_write_b32 v9, v82 offset:8816
    v_cvt_pk_f16_f32 v83, v70, v71
    ds_write_b32 v9, v83 offset:8848
    v_cvt_pk_f16_f32 v84, v72, v73
    ds_write_b32 v9, v84 offset:8880
    v_cvt_pk_f16_f32 v85, v74, v75
    ds_write_b32 v9, v85 offset:8912
    v_mul_f32 v76, v42, v20
    v_mul_f32 v77, v42, v21
    v_fma_f32 v76, -v43, v21, v76
    v_fma_f32 v77, v43, v20, v77
    v_cvt_pk_f16_f32 v86, v76, v77
    ds_write_b32 v9, v86 offset:8944
    s_nop 1
    s_branch kgen_tabdone
kgen_job1:
    s_lshl_b32 s38, s37, 3
    s_add_u32 s38, s38, s35
    v_mov_b32 v26, s38
    ds_write_b64 v26, v[24:25] offset:48640
    v_mul_f32 v60, 0x41000000, v12
    v_mul_f32 v16, 0x41000000, v13
    v_mul_f32 v61, 0x41800000, v12
    v_mul_f32 v18, 0x41800000, v13
    v_mul_f32 v62, 0x42000000, v12
    v_mul_f32 v20, 0x42000000, v13
    v_mul_f32 v63, 0x42800000, v12
    v_mul_f32 v22, 0x42800000, v13
    v_mul_f32 v64, 0x43000000, v12
    v_mul_f32 v24, 0x43000000, v13
    v_mul_f32 v65, 0x43800000, v12
    v_mul_f32 v26, 0x43800000, v13
    v_mul_f32 v66, 0x44000000, v12
    v_mul_f32 v28, 0x44000000, v13
    v_mul_f32 v67, 0x44800000, v12
    v_mul_f32 v30, 0x44800000, v13
    v_exp_f32 v60, v60
    v_fract_f32 v16, v16
    v_exp_f32 v61, v61
    v_fract_f32 v18, v18
    v_exp_f32 v62, v62
    v_fract_f32 v20, v20
    v_exp_f32 v63, v63
    v_fract_f32 v22, v22
    v_exp_f32 v64, v64
    v_fract_f32 v24, v24
    v_exp_f32 v65, v65
    v_fract_f32 v26, v26
    v_exp_f32 v66, v66
    v_fract_f32 v28, v28
    v_exp_f32 v67, v67
    v_fract_f32 v30, v30
    v_sin_f32 v17, v16
    v_cos_f32 v16, v16
    v_sin_f32 v19, v18
    v_cos_f32 v18, v18
    v_sin_f32 v21, v20
    v_cos_f32 v20, v20
    v_sin_f32 v23, v22
    v_cos_f32 v22, v22
    v_sin_f32 v25, v24
    v_cos_f32 v24, v24
    v_sin_f32 v27, v26
    v_cos_f32 v26, v26
    v_sin_f32 v29, v28
    v_cos_f32 v28, v28
    v_sin_f32 v31, v30
    v_cos_f32 v30, v30
    v_mul_f32 v17, v17, v60
    v_mul_f32 v16, v16, v60
    v_mul_f32 v19, v19, v61
    v_mul_f32 v18, v18, v61
    v_mul_f32 v21, v21, v62
    v_mul_f32 v20, v20, v62
    v_mul_f32 v23, v23, v63
    v_mul_f32 v22, v22, v63
    v_mul_f32 v25, v25, v64
    v_mul_f32 v24, v24, v64
    v_mul_f32 v27, v27, v65
    v_mul_f32 v26, v26, v65
    v_mul_f32 v29, v29, v66
    v_mul_f32 v28, v28, v66
    v_mul_f32 v31, v31, v67
    v_mul_f32 v30, v30, v67
    v_cvt_pk_f16_f32 v87, v14, -v15
    ds_write_b32 v9, v87 offset:26112
    v_cvt_pk_f16_f32 v80, v30, v31
    ds_write_b32 v9, v80 offset:17408
    v_mul_f32 v78, v14, v16
    v_mul_f32 v79, v14, v17
    v_mul_f32 v32, v14, v18
    v_mul_f32 v33, v14, v19
    v_mul_f32 v34, v14, v20
    v_mul_f32 v35, v14, v21
    v_mul_f32 v36, v14, v22
    v_mul_f32 v37, v14, v23
    v_mul_f32 v68, v30, v24
    v_mul_f32 v69, v30, v25
    v_mul_f32 v38, v30, v26
    v_mul_f32 v39, v30, v27
    v_mul_f32 v40, v30, v28
    v_mul_f32 v41, v30, v29
    v_mul_f32 v70, v30, v30
    v_mul_f32 v71, v30, v31
    v_fma_f32 v78, -v15, v17, v78
    v_fma_f32 v79, v15, v16, v79
    v_fma_f32 v32, -v15, v19, v32
    v_fma_f32 v33, v15, v18, v33
    v_fma_f32 v34, -v15, v21, v34
    v_fma_f32 v35, v15, v20, v35
    v_fma_f32 v36, -v15, v23, v36
    v_fma_f32 v37, v15, v22, v37
    v_fma_f32 v68, -v31, v25, v68
    v_fma_f32 v69, v31, v24, v69
    v_fma_f32 v38, -v31, v27, v38
    v_fma_f32 v39, v31, v26, v39
    v_fma_f32 v40, -v31, v29, v40
    v_fma_f32 v41, v31, v28, v41
    v_fma_f32 v70, -v31, v31, v70
    v_fma_f32 v71, v31, v30, v71
    v_cvt_pk_f16_f32 v81, v78, -v79
    ds_write_b32 v9, v81 offset:26128
    v_cvt_pk_f16_f32 v82, v32, -v33
    ds_write_b32 v9, v82 offset:26144
    v_cvt_pk_f16_f32 v83, v34, -v35
    ds_write_b32 v9, v83 offset:26176
    v_cvt_pk_f16_f32 v84, v36, -v37
    ds_write_b32 v9, v84 offset:26240
    v_cvt_pk_f16_f32 v85, v68, v69
    ds_write_b32 v9, v85 offset:17424
    v_cvt_pk_f16_f32 v86, v38, v39
    ds_write_b32 v9, v86 offset:17440
    v_cvt_pk_f16_f32 v87, v40, v41
    ds_write_b32 v9, v87 offset:17472
    v_cvt_pk_f16_f32 v80, v70, v71
    ds_write_b32 v9, v80 offset:17536
    v_mul_f32 v72, v32, v16
    v_mul_f32 v73, v32, v17
    v_mul_f32 v74, v34, v16
    v_mul_f32 v75, v34, v17
    v_mul_f32 v42, v34, v18
    v_mul_f32 v43, v34, v19
    v_mul_f32 v76, v36, v16
    v_mul_f32 v77, v36, v17
    v_mul_f32 v44, v36, v18
    v_mul_f32 v45, v36, v19
    v_mul_f32 v46, v36, v20
    v_mul_f32 v47, v36, v21
    v_mul_f32 v78, v38, v24
    v_mul_f32 v79, v38, v25
    v_mul_f32 v68, v40, v24
    v_mul_f32 v69, v40, v25
    v_mul_f32 v48, v40, v26
    v_mul_f32 v49, v40, v27
    v_fma_f32 v72, -v33, v17, v72
    v_fma_f32 v73, v33, v16, v73
    v_fma_f32 v74, -v35, v17, v74
    v_fma_f32 v75, v35, v16, v75
    v_fma_f32 v42, -v35, v19, v42
    v_fma_f32 v43, v35, v18, v43
    v_fma_f32 v76, -v37, v17, v76
    v_fma_f32 v77, v37, v16, v77
    v_fma_f32 v44, -v37, v19, v44
    v_fma_f32 v45, v37, v18, v45
    v_fma_f32 v46, -v37, v21, v46
    v_fma_f32 v47, v37, v20, v47
    v_fma_f32 v78, -v39, v25, v78
    v_fma_f32 v79, v39, v24, v79
    v_fma_f32 v68, -v41, v25, v68
    v_fma_f32 v69, v41, v24, v69
    v_fma_f32 v48, -v41, v27, v48
    v_fma_f32 v49, v41, v26, v49
    v_cvt_pk_f16_f32 v81, v72, -v73
    ds_write_b32 v9, v81 offset:26160
    v_cvt_pk_f16_f32 v82, v74, -v75
    ds_write_b32 v9, v82 offset:26192
    v_cvt_pk_f16_f32 v83, v42, -v43
    ds_write_b32 v9, v83 offset:26208
    v_cvt_pk_f16_f32 v84, v76, -v77
    ds_write_b32 v9, v84 offset:26256
    v_cvt_pk_f16_f32 v85, v44, -v45
    ds_write_b32 v9, v85 offset:26272
    v_cvt_pk_f16_f32 v86, v46, -v47
    ds_write_b32 v9, v86 offset:26304
    v_cvt_pk_f16_f32 v87, v78, v79
    ds_write_b32 v9, v87 offset:17456
    v_cvt_pk_f16_f32 v80, v68, v69
    ds_write_b32 v9, v80 offset:17488
    v_cvt_pk_f16_f32 v81, v48, v49
    ds_write_b32 v9, v81 offset:17504
    v_mul_f32 v70, v42, v16
    v_mul_f32 v71, v42, v17
    v_mul_f32 v72, v44, v16
    v_mul_f32 v73, v44, v17
    v_mul_f32 v74, v46, v16
    v_mul_f32 v75, v46, v17
    v_mul_f32 v50, v46, v18
    v_mul_f32 v51, v46, v19
    v_mul_f32 v76, v48, v24
    v_mul_f32 v77, v48, v25
    v_fma_f32 v70, -v43, v17, v70
    v_fma_f32 v71, v43, v16, v71
    v_fma_f32 v72, -v45, v17, v72
    v_fma_f32 v73, v45, v16, v73
    v_fma_f32 v74, -v47, v17, v74
    v_fma_f32 v75, v47, v16, v75
    v_fma_f32 v50, -v47, v19, v50
    v_fma_f32 v51, v47, v18, v51
    v_fma_f32 v76, -v49, v25, v76
    v_fma_f32 v77, v49, v24, v77
    v_cvt_pk_f16_f32 v82, v70, -v71
    ds_write_b32 v9, v82 offset:26224
    v_cvt_pk_f16_f32 v83, v72, -v73
    ds_write_b32 v9, v83 offset:26288
    v_cvt_pk_f16_f32 v84, v74, -v75
    ds_write_b32 v9, v84 offset:26320
    v_cvt_pk_f16_f32 v85, v50, -v51
    ds_write_b32 v9, v85 offset:26336
    v_cvt_pk_f16_f32 v86, v76, v77
    ds_write_b32 v9, v86 offset:17520
    v_mul_f32 v78, v50, v16
    v_mul_f32 v79, v50, v17
    v_fma_f32 v78, -v51, v17, v78
    v_fma_f32 v79, v51, v16, v79
    v_cvt_pk_f16_f32 v87, v78, -v79
    ds_write_b32 v9, v87 offset:26352
    s_nop 1
kgen_tabdone:
    v_mul_u32_u24 v9, 272, v5
    v_lshl_add_u32 v9, v4, 4, v9
    v_add_u32 v10, s35, v9
    s_mul_i32 s38, s36, 8704
    v_add_u32 v9, s38, v10
    s_lshl_b32 s38, s36, 6
    s_add_u32 s38, s38, 98304
    v_lshl_add_u32 v11, v5, 4, s38
    v_mov_b32 v12, s35
    s_waitcnt lgkmcnt(0)
    s_barrier
    s_cmp_lt_u32 s36, 3
    s_cbranch_scc0 kgen_fin
    ds_read_b128 v[56:59], v11
    ds_read_b128 v[12:15], v12 offset:48640
    ds_read_b128 v[16:19], v9 offset:0
    ds_read_b128 v[20:23], v10 offset:26112
    ds_read_b128 v[24:27], v9 offset:1088
    ds_read_b128 v[28:31], v10 offset:27200
    ds_read_b128 v[32:35], v9 offset:2176
    ds_read_b128 v[36:39], v10 offset:28288
    ds_read_b128 v[40:43], v9 offset:3264
    ds_read_b128 v[44:47], v10 offset:29376
    ds_read_b128 v[64:67], v9 offset:4352
    ds_read_b128 v[68:71], v10 offset:30464
    ds_read_b128 v[72:75], v9 offset:5440
    ds_read_b128 v[76:79], v10 offset:31552
    ds_read_b128 v[80:83], v9 offset:6528
    ds_read_b128 v[84:87], v10 offset:32640
    ds_read_b128 v[88:91], v9 offset:7616
    ds_read_b128 v[92:95], v10 offset:33728
    v_lshlrev_b32 v11, 3, v4
    s_add_u32 s38, s35, 34816
    s_waitcnt lgkmcnt(14)
    v_add_u32 v56, v56, v11
    v_add_u32 v57, v57, v11
    v_add_u32 v58, v58, v11
    v_add_u32 v59, v59, v11
    v_cvt_f32_u32 v100, v56
    v_cvt_f32_u32 v101, v57
    v_cvt_f32_u32 v102, v58
    v_cvt_f32_u32 v103, v59
    s_waitcnt lgkmcnt(14)
    v_mfma_f32_16x16x32_f16 v[48:51], v[16:19], v[20:23], 0
    v_mul_f32 v96, v100, v12
    v_mul_f32 v100, v100, v14
    v_mul_f32 v97, v101, v12
    v_mul_f32 v101, v101, v14
    v_mul_f32 v98, v102, v12
    s_waitcnt lgkmcnt(12)
    v_mfma_f32_16x16x32_f16 v[48:51], v[24:27], v[28:31], v[48:51]
    v_mul_f32 v102, v102, v14
    v_mul_f32 v99, v103, v12
    v_mul_f32 v103, v103, v14
    v_exp_f32 v96, v96
    v_exp_f32 v100, v100
    s_waitcnt lgkmcnt(10)
    v_mfma_f32_16x16x32_f16 v[48:51], v[32:35], v[36:39], v[48:51]
    v_lshrrev_b32 v60, 3, v56
    v_exp_f32 v97, v97
    v_exp_f32 v101, v101
    v_lshrrev_b32 v61, 3, v57
    v_exp_f32 v98, v98
    s_waitcnt lgkmcnt(8)
    v_mfma_f32_16x16x32_f16 v[48:51], v[40:43], v[44:47], v[48:51]
    v_exp_f32 v102, v102
    v_lshrrev_b32 v62, 3, v58
    v_exp_f32 v99, v99
    v_exp_f32 v103, v103
    v_lshrrev_b32 v63, 3, v59
    s_waitcnt lgkmcnt(6)
    v_mfma_f32_16x16x32_f16 v[52:55], v[64:67], v[68:71], 0
    v_mul_f32 v96, v96, v13
    v_mul_f32 v100, v100, v15
    v_add_u32 v56, v56, v60
    v_mul_f32 v97, v97, v13
    v_mul_f32 v101, v101, v15
    s_waitcnt lgkmcnt(4)
    v_mfma_f32_16x16x32_f16 v[52:55], v[72:75], v[76:79], v[52:55]
    v_add_u32 v57, v57, v61
    v_mul_f32 v98, v98, v13
    v_mul_f32 v102, v102, v15
    v_add_u32 v58, v58, v62
    v_mul_f32 v99, v99, v13
    s_waitcnt lgkmcnt(2)
    v_mfma_f32_16x16x32_f16 v[52:55], v[80:83], v[84:87], v[52:55]
    v_mul_f32 v103, v103, v15
    v_add_u32 v59, v59, v63
    v_lshl_add_u32 v56, v56, 2, s38
    v_lshl_add_u32 v57, v57, 2, s38
    v_lshl_add_u32 v58, v58, 2, s38
    s_waitcnt lgkmcnt(0)
    v_mfma_f32_16x16x32_f16 v[52:55], v[88:91], v[92:95], v[52:55]
    v_lshl_add_u32 v59, v59, 2, s38
    v_mul_f32 v48, v48, v96
    v_mul_f32 v49, v49, v97
    v_mul_f32 v50, v50, v98
    v_mul_f32 v51, v51, v99
    s_nop 2
    v_fma_f32 v48, v52, v100, v48
    v_fma_f32 v49, v53, v101, v49
    v_fma_f32 v50, v54, v102, v50
    v_fma_f32 v51, v55, v103, v51
    ds_write_b32 v56, v48
    ds_write_b32 v57, v49
    ds_write_b32 v58, v50
    ds_write_b32 v59, v51
    s_waitcnt lgkmcnt(0)
kgen_fin:
    s_barrier
    s_endpgm
kgen_aux:
    s_bfe_u32 s33, s34, 0x10001
    v_and_b32 v7, 127, v0
    s_mul_i32 s35, s33, 49152
    s_getpc_b64 s[44:45]
kgen_pc:
    s_add_u32 s44, s44, kgen_tab-kgen_pc
    s_addc_u32 s45, s45, 0
    v_lshlrev_b32 v8, 6, v7
    global_load_dwordx4 v[80:83], v8, s[44:45] offset:0
    global_load_dwordx4 v[84:87], v8, s[44:45] offset:16
    global_load_dwordx4 v[88:91], v8, s[44:45] offset:32
    global_load_dwordx4 v[92:95], v8, s[44:45] offset:48
    s_waitcnt lgkmcnt(0)
    v_lshrrev_b32 v20, 3, v4
    v_lshlrev_b32 v20, 7, v20
    v_and_b32 v21, 7, v4
    v_add_u32 v20, v20, v21
    v_lshrrev_b32 v22, 2, v4
    v_lshlrev_b32 v22, 7, v22
    v_and_b32 v23, 3, v4
    v_lshl_add_u32 v22, v23, 1, v22
    v_add_u32 v22, 0x100, v22
    v_lshrrev_b32 v23, 1, v21
    v_lshlrev_b32 v23, 7, v23
    v_and_b32 v24, 1, v4
    v_lshl_add_u32 v23, v24, 2, v23
    v_add_u32 v23, 0x200, v23
    v_cmp_gt_u32 vcc, 8, v4
    s_nop 1
    v_cndmask_b32 v21, v23, v22, vcc
    v_lshlrev_b32 v22, 7, v4
    v_add_u32 v22, 0x400, v22
    v_lshlrev_b32 v23, 2, v4
    v_add_u32 v23, 98304, v23
    ds_write_b32 v23, v20
    ds_write_b32 v23, v21 offset:64
    ds_write_b32 v23, v22 offset:128
    s_add_u32 s37, s35, 34816
    s_add_u32 s38, s37, 13800
    v_mov_b32 v9, s38
    v_mov_b32 v10, 0
    ds_write_b32 v9, v10
    s_lshl_b32 s7, s2, 1
    s_add_u32 s7, s7, s33
    s_mul_i32 s7, s7, 9216
    s_add_u32 s7, s7, 0x00700000
    s_add_u32 s8, s4, s7
    s_addc_u32 s9, s5, 0
    s_mov_b32 s10, 9216
    s_mov_b32 s11, 0x00020000
    v_lshlrev_b32 v12, 4, v7
    s_movk_i32 s15, 4416
    v_cmp_gt_u32 vcc, 20, v7
    s_waitcnt lgkmcnt(0)
    s_barrier
    s_waitcnt vmcnt(0)
    v_add_u32_sdwa v48, v80, s37 dst_sel:DWORD dst_unused:UNUSED_PAD src0_sel:WORD_0 src1_sel:DWORD
    v_add_u32_sdwa v49, v80, s37 dst_sel:DWORD dst_unused:UNUSED_PAD src0_sel:WORD_1 src1_sel:DWORD
    v_add_u32_sdwa v50, v81, s37 dst_sel:DWORD dst_unused:UNUSED_PAD src0_sel:WORD_0 src1_sel:DWORD
    v_add_u32_sdwa v51, v81, s37 dst_sel:DWORD dst_unused:UNUSED_PAD src0_sel:WORD_1 src1_sel:DWORD
    v_add_u32_sdwa v52, v82, s37 dst_sel:DWORD dst_unused:UNUSED_PAD src0_sel:WORD_0 src1_sel:DWORD
    v_add_u32_sdwa v53, v82, s37 dst_sel:DWORD dst_unused:UNUSED_PAD src0_sel:WORD_1 src1_sel:DWORD
    v_add_u32_sdwa v54, v83, s37 dst_sel:DWORD dst_unused:UNUSED_PAD src0_sel:WORD_0 src1_sel:DWORD
    v_add_u32_sdwa v55, v83, s37 dst_sel:DWORD dst_unused:UNUSED_PAD src0_sel:WORD_1 src1_sel:DWORD
    v_add_u32_sdwa v56, v84, s37 dst_sel:DWORD dst_unused:UNUSED_PAD src0_sel:WORD_0 src1_sel:DWORD
    v_add_u32_sdwa v57, v84, s37 dst_sel:DWORD dst_unused:UNUSED_PAD src0_sel:WORD_1 src1_sel:DWORD
    v_add_u32_sdwa v58, v85, s37 dst_sel:DWORD dst_unused:UNUSED_PAD src0_sel:WORD_0 src1_sel:DWORD
    v_add_u32_sdwa v59, v85, s37 dst_sel:DWORD dst_unused:UNUSED_PAD src0_sel:WORD_1 src1_sel:DWORD
    v_add_u32_sdwa v60, v86, s37 dst_sel:DWORD dst_unused:UNUSED_PAD src0_sel:WORD_0 src1_sel:DWORD
    v_add_u32_sdwa v61, v86, s37 dst_sel:DWORD dst_unused:UNUSED_PAD src0_sel:WORD_1 src1_sel:DWORD
    v_add_u32_sdwa v62, v87, s37 dst_sel:DWORD dst_unused:UNUSED_PAD src0_sel:WORD_0 src1_sel:DWORD
    v_add_u32_sdwa v63, v87, s37 dst_sel:DWORD dst_unused:UNUSED_PAD src0_sel:WORD_1 src1_sel:DWORD
    v_add_u32_sdwa v64, v88, s37 dst_sel:DWORD dst_unused:UNUSED_PAD src0_sel:WORD_0 src1_sel:DWORD
    v_add_u32_sdwa v65, v88, s37 dst_sel:DWORD dst_unused:UNUSED_PAD src0_sel:WORD_1 src1_sel:DWORD
    v_add_u32_sdwa v66, v89, s37 dst_sel:DWORD dst_unused:UNUSED_PAD src0_sel:WORD_0 src1_sel:DWORD
    v_add_u32_sdwa v67, v89, s37 dst_sel:DWORD dst_unused:UNUSED_PAD src0_sel:WORD_1 src1_sel:DWORD
    v_add_u32_sdwa v68, v90, s37 dst_sel:DWORD dst_unused:UNUSED_PAD src0_sel:WORD_0 src1_sel:DWORD
    v_add_u32_sdwa v69, v90, s37 dst_sel:DWORD dst_unused:UNUSED_PAD src0_sel:WORD_1 src1_sel:DWORD
    v_add_u32_sdwa v70, v91, s37 dst_sel:DWORD dst_unused:UNUSED_PAD src0_sel:WORD_0 src1_sel:DWORD
    v_add_u32_sdwa v71, v91, s37 dst_sel:DWORD dst_unused:UNUSED_PAD src0_sel:WORD_1 src1_sel:DWORD
    v_add_u32_sdwa v72, v92, s37 dst_sel:DWORD dst_unused:UNUSED_PAD src0_sel:WORD_0 src1_sel:DWORD
    v_add_u32_sdwa v73, v92, s37 dst_sel:DWORD dst_unused:UNUSED_PAD src0_sel:WORD_1 src1_sel:DWORD
    v_add_u32_sdwa v74, v93, s37 dst_sel:DWORD dst_unused:UNUSED_PAD src0_sel:WORD_0 src1_sel:DWORD
    s_barrier
    ds_read_b32 v48, v48
    ds_read_b32 v49, v49
    ds_read_b32 v50, v50
    ds_read_b32 v51, v51
    ds_read_b32 v52, v52
    ds_read_b32 v53, v53
    ds_read_b32 v54, v54
    ds_read_b32 v55, v55
    ds_read_b32 v56, v56
    ds_read_b32 v57, v57
    ds_read_b32 v58, v58
    ds_read_b32 v59, v59
    ds_read_b32 v60, v60
    ds_read_b32 v61, v61
    ds_read_b32 v62, v62
    ds_read_b32 v63, v63
    ds_read_b32 v64, v64
    ds_read_b32 v65, v65
    ds_read_b32 v66, v66
    ds_read_b32 v67, v67
    ds_read_b32 v68, v68
    ds_read_b32 v69, v69
    ds_read_b32 v70, v70
    ds_read_b32 v71, v71
    ds_read_b32 v72, v72
    ds_read_b32 v73, v73
    ds_read_b32 v74, v74
    s_waitcnt lgkmcnt(15)
    v_cvt_pk_bf16_f32 v16, v48, v49
    v_cvt_pk_bf16_f32 v20, v49, v50
    v_cvt_pk_bf16_f32 v17, v50, v51
    v_cvt_pk_bf16_f32 v21, v51, v52
    v_cvt_pk_bf16_f32 v18, v52, v53
    v_cvt_pk_bf16_f32 v22, v53, v54
    v_cvt_pk_bf16_f32 v19, v54, v55
    v_cvt_pk_bf16_f32 v23, v55, v56
    buffer_store_dwordx4 v[16:19], v12, s[8:11], 0 offen offset:0
    buffer_store_dwordx4 v[20:23], v12, s[8:11], s15 offen offset:0
    s_waitcnt lgkmcnt(9)
    v_cvt_pk_bf16_f32 v24, v57, v58
    v_cvt_pk_bf16_f32 v28, v58, v59
    v_cvt_pk_bf16_f32 v25, v59, v60
    v_cvt_pk_bf16_f32 v29, v60, v61
    v_cvt_pk_bf16_f32 v26, v61, v62
    v_cvt_pk_bf16_f32 v30, v62, v63
    v_cvt_pk_bf16_f32 v27, v63, v64
    v_cvt_pk_bf16_f32 v31, v64, v65
    buffer_store_dwordx4 v[24:27], v12, s[8:11], 0 offen offset:2048
    buffer_store_dwordx4 v[28:31], v12, s[8:11], s15 offen offset:2048
    s_waitcnt lgkmcnt(0)
    v_cvt_pk_bf16_f32 v32, v66, v67
    v_cvt_pk_bf16_f32 v36, v67, v68
    v_cvt_pk_bf16_f32 v33, v68, v69
    v_cvt_pk_bf16_f32 v37, v69, v70
    v_cvt_pk_bf16_f32 v34, v70, v71
    v_cvt_pk_bf16_f32 v38, v71, v72
    v_cvt_pk_bf16_f32 v35, v72, v73
    v_cvt_pk_bf16_f32 v39, v73, v74
    s_and_saveexec_b64 s[32:33], vcc
    s_cbranch_execz kgen_done
    v_add_u32 v12, 0x1000, v12
    buffer_store_dwordx4 v[32:35], v12, s[8:11], 0 offen offset:0
    buffer_store_dwordx4 v[36:39], v12, s[8:11], s15 offen offset:0
kgen_done:
    s_endpgm
.globl conv1_kernel
.p2align 8
.type conv1_kernel,@function
conv1_kernel:
    s_cmp_ge_u32 s2, 256
    s_cbranch_scc1 conv_exit
    s_load_dwordx2 s[16:17], s[0:1], 88
    s_load_dwordx2 s[18:19], s[0:1], 112
    s_load_dwordx2 s[20:21], s[0:1], 112
    s_mov_b32 s53, 4194304
    s_branch conv_body
.globl conv2_kernel
.p2align 8
.type conv2_kernel,@function
conv2_kernel:
    s_cmp_ge_u32 s2, 256
    s_cbranch_scc1 conv_exit
    s_load_dwordx2 s[16:17], s[0:1], 88
    s_load_dwordx2 s[18:19], s[0:1], 96
    s_load_dwordx2 s[20:21], s[0:1], 112
    s_mov_b32 s53, 0
conv_body:
    v_lshrrev_b32 v2, 6, v0
    s_and_b32 s22, s2, 7
    s_lshl_b32 s22, s22, 5
    v_readfirstlane_b32 s27, v2
    s_lshr_b32 s23, s2, 3
    s_add_u32 s22, s22, s23
    s_lshl_b32 s23, s22, 2
    v_and_b32 v1, 63, v0
    v_lshlrev_b32 v5, 4, v1
    s_mul_i32 s30, s22, 18432
    s_lshl_b32 s31, s27, 10
    s_add_u32 s30, s30, s31
    s_add_u32 s30, s30, 7340032
    s_lshl_b32 s47, s27, 11
    s_add_u32 s47, s47, 6291456
    v_add_u32 v3, s47, v5
    v_lshrrev_b32 v6, 3, v1
    v_lshlrev_b32 v6, 10, v6
    v_and_b32 v7, 7, v1
    v_lshl_add_u32 v9, v7, 4, v6
    s_lshl_b32 s28, s22, 13
    s_lshl_b32 s29, s27, 7
    s_add_u32 s28, s28, s29
    s_add_u32 s28, s28, 2097152
    s_add_u32 m0, s31, 28672
    s_add_u32 s32, s30, 8192
    s_waitcnt lgkmcnt(0)
    s_mov_b32 s12, s20
    s_mov_b32 s13, s21
    s_mov_b32 s14, 0x00c00000
    s_mov_b32 s15, 0x00020000
    buffer_load_dwordx4 v9, s[12:15], s28 offen lds
    buffer_load_dwordx4 v[64:67], v3, s[12:15], 0 offen
    buffer_load_dwordx4 v[68:71], v3, s[12:15], 0 offen offset:1024
    v_add_u32 v3, 0x4000, v3
    buffer_load_dwordx4 v[72:75], v3, s[12:15], 0 offen
    buffer_load_dwordx4 v[76:79], v3, s[12:15], 0 offen offset:1024
    s_add_u32 m0, s31, 0
    s_load_dword s26, s[16:17], s23
    buffer_load_dwordx4 v5, s[12:15], s30 offen lds
    s_add_u32 m0, s31, 8192
    s_cmp_lt_u32 s27, 2
    buffer_load_dwordx4 v5, s[12:15], s32 offen lds
    s_cbranch_scc0 conv_nodma
    s_add_u32 m0, s31, 16384
    s_add_u32 s33, s30, 16384
    buffer_load_dwordx4 v5, s[12:15], s33 offen lds
conv_nodma:
    s_add_u32 s4, s18, s53
    s_addc_u32 s5, s19, 0
    s_mov_b32 s6, 0x200000
    s_cmp_eq_u32 s53, 0
    s_cselect_b32 s6, s6, 8912896
    s_mov_b32 s7, 0x00020000
    v_mov_b32 v96, 0
    v_mov_b32 v97, 0
    v_mov_b32 v98, 0
    v_mov_b32 v99, 0
    v_mov_b32 v100, 0
    v_mov_b32 v101, 0
    v_mov_b32 v102, 0
    v_mov_b32 v103, 0
    v_lshrrev_b32 v109, 1, v1
    v_and_b32 v7, 1, v1
    v_lshl_add_u32 v109, v7, 5, v109
    v_cmp_eq_u32 s[48:49], 1, v7
    v_lshlrev_b32 v108, 1, v109
    s_add_u32 s29, s31, 28672
    v_add_u32 v108, s29, v108
    s_lshl_b32 s29, s27, 6
    v_add_u32 v109, s29, v109
    v_lshlrev_b32 v4, 1, v109
    v_mov_b32 v12, 0
    v_mov_b32 v13, 0
    v_mov_b32 v14, 0
    v_mov_b32 v15, 0
    v_mul_u32_u24 v6, 5120, v2
    v_add_u32 v6, v6, v5
    s_cmp_lt_u32 s27, 2
    s_cbranch_scc0 conv_nozero
    ds_write_b128 v6, v[12:15] offset:18432
conv_nozero:
    s_and_b32 s33, s27, 3
    s_lshr_b32 s34, s27, 2
    v_and_b32 v6, 15, v1
    v_lshrrev_b32 v7, 4, v1
    v_lshlrev_b32 v24, 5, v6
    v_lshl_add_u32 v24, v7, 4, v24
    s_mul_i32 s30, s34, 5120
    s_lshl_b32 s31, s33, 6
    s_sub_u32 s30, s30, s31
    s_add_u32 s30, s30, 18912
    v_add_u32 v24, s30, v24
    v_add_u32 v25, 1, v6
    v_lshrrev_b32 v25, 1, v25
    v_lshlrev_b32 v25, 2, v25
    v_lshlrev_b32 v8, 4, v7
    v_sub_u32 v25, v8, v25
    v_and_b32 v8, 1, v6
    v_mul_u32_u24 v8, 4416, v8
    v_add_u32 v25, v25, v8
    s_mul_i32 s30, s34, 9216
    s_sub_u32 s30, s30, s31
    s_add_u32 s30, s30, 224
    v_add_u32 v25, s30, v25
    v_add_u32 v26, 1024, v25
    v_add_u32 v27, 2048, v25
    v_add_u32 v28, 3072, v25
    v_add_u32 v29, 4096, v25
    v_mul_u32_u24 v30, 288, v7
    v_lshl_add_u32 v30, v6, 4, v30
    s_mul_i32 s30, s27, 9216
    s_add_u32 s30, s30, 36864
    v_add_u32 v30, s30, v30
    v_lshrrev_b32 v8, 8, v109
    v_mul_u32_u24 v31, 1152, v8
    v_bfe_u32 v8, v109, 2, 2
    v_mul_u32_u24 v8, 288, v8
    v_add_u32 v31, v31, v8
    v_bfe_u32 v8, v109, 4, 4
    v_lshl_add_u32 v31, v8, 4, v31
    v_and_b32 v8, 3, v109
    v_lshl_add_u32 v31, v8, 2, v31
    v_add_u32 v31, 36864, v31
    v_add_u32 v2, 36864, v31
    v_lshlrev_b32 v5, 10, v109
    s_mov_b32 s35, 0xffff0000
    s_mov_b32 s41, 0x3b000000
    v_mov_b32 v110, 0x3727c5ac
    s_waitcnt vmcnt(2)
    ds_read_u16_d16_hi v96, v108 offset:0
    ds_read_u16_d16_hi v97, v108 offset:512
    ds_read_u16_d16_hi v98, v108 offset:128
    ds_read_u16_d16_hi v99, v108 offset:640
    ds_read_u16_d16_hi v100, v108 offset:256
    ds_read_u16_d16_hi v101, v108 offset:768
    ds_read_u16_d16_hi v102, v108 offset:384
    ds_read_u16_d16_hi v103, v108 offset:896
    v_add_f32 v64, v64, v66
    v_add_f32 v72, v72, v74
    v_add_f32 v65, v65, v67
    v_add_f32 v73, v73, v75
    v_add_f32 v68, v68, v70
    v_add_f32 v76, v76, v78
    v_add_f32 v69, v69, v71
    v_add_f32 v77, v77, v79
    v_cndmask_b32 v66, v68, v64, s[48:49]
    v_cndmask_b32 v74, v76, v72, s[48:49]
    v_cndmask_b32 v67, v69, v65, s[48:49]
    v_cndmask_b32 v75, v77, v73, s[48:49]
    v_cndmask_b32 v64, v64, v68, s[48:49]
    v_cndmask_b32 v72, v72, v76, s[48:49]
    v_cndmask_b32 v65, v65, v69, s[48:49]
    v_cndmask_b32 v73, v73, v77, s[48:49]
    v_add_f32_dpp v64, v66, v64 quad_perm:[1,0,3,2] row_mask:0xf bank_mask:0xf
    v_add_f32_dpp v72, v74, v72 quad_perm:[1,0,3,2] row_mask:0xf bank_mask:0xf
    v_add_f32_dpp v65, v67, v65 quad_perm:[1,0,3,2] row_mask:0xf bank_mask:0xf
    v_add_f32_dpp v73, v75, v73 quad_perm:[1,0,3,2] row_mask:0xf bank_mask:0xf
    v_mul_f32 v64, 0x3b000000, v64
    v_mul_f32 v72, 0x3b000000, v72
    v_fma_f32 v65, v65, s41, v110
    v_fma_f32 v73, v73, s41, v110
    v_fma_f32 v65, -v64, v64, v65
    v_fma_f32 v73, -v72, v72, v73
    v_max_f32 v65, v110, v65
    v_max_f32 v73, v110, v73
    s_waitcnt lgkmcnt(0)
    v_sqrt_f32 v65, v65
    v_sqrt_f32 v73, v73
    v_sub_f32 v66, v96, v64
    v_sub_f32 v74, v98, v72
    v_sub_f32 v67, v97, v64
    v_sub_f32 v75, v99, v72
    v_cvt_pk_bf16_f32 v65, v65, v65
    v_cvt_pk_bf16_f32 v73, v73, v73
    v_lshlrev_b32 v65, 16, v65
    v_lshlrev_b32 v73, 16, v73
    v_rcp_f32 v65, v65
    v_rcp_f32 v73, v73
    v_mul_f32 v66, v66, v65
    v_mul_f32 v74, v74, v73
    v_mul_f32 v67, v67, v65
    v_mul_f32 v75, v75, v73
    v_cvt_pk_bf16_f32 v104, v66, v67
    v_cvt_pk_bf16_f32 v105, v74, v75
    ds_write_b16 v4, v104 offset:19456
    ds_write_b16 v4, v105 offset:20480
    ds_write_b16_d16_hi v4, v104 offset:24576
    ds_write_b16_d16_hi v4, v105 offset:25600
    s_waitcnt vmcnt(0)
    s_waitcnt lgkmcnt(0)
    s_barrier
    ds_read_b128 a[68:71], v24 offset:0
    ds_read2_b32 a[8:9], v28 offset0:128 offset1:129
    ds_read2_b32 a[10:11], v28 offset0:130 offset1:131
    ds_read_b128 a[72:75], v24 offset:256
    ds_read2_b32 a[4:5], v28 offset0:192 offset1:193
    ds_read2_b32 a[6:7], v28 offset0:194 offset1:195
    ds_read_b128 a[76:79], v24 offset:512
    ds_read2_b32 a[0:1], v29 offset0:0 offset1:1
    ds_read2_b32 a[2:3], v29 offset0:2 offset1:3
    ds_read2_b32 a[16:17], v28 offset0:0 offset1:1
    ds_read2_b32 a[18:19], v28 offset0:2 offset1:3
    ds_read2_b32 a[12:13], v28 offset0:64 offset1:65
    ds_read2_b32 a[14:15], v28 offset0:66 offset1:67
    ds_read_b128 a[80:83], v24 offset:768
    ds_read_b128 a[84:87], v24 offset:1024
    v_add_u32 v3, 0x4000, v3
    buffer_load_dwordx4 v[80:83], v3, s[12:15], 0 offen
    buffer_load_dwordx4 v[84:87], v3, s[12:15], 0 offen offset:1024
    v_add_u32 v3, 0x4000, v3
    buffer_load_dwordx4 v[88:91], v3, s[12:15], 0 offen
    buffer_load_dwordx4 v[92:95], v3, s[12:15], 0 offen offset:1024
    s_lshl_b32 s36, s26, 16
    s_and_b32 s37, s26, 0xffff0000
    s_lshl_b32 s39, s22, 13
    s_add_u32 s40, s39, 4096
    s_lshl_b32 s42, s27, 14
    s_lshl_b32 s43, s22, 6
    s_add_u32 s42, s42, s43
    s_add_u32 s42, s42, 8388608
    v_and_b32 v111, 15, v109
    v_lshlrev_b32 v111, 1, v111
    s_mov_b32 s50, 0
    s_mov_b32 s51, 0xaaaaaaaa
    s_waitcnt lgkmcnt(12)
    v_mfma_f32_16x16x32_bf16 v[32:35], a[8:11], a[68:71], 0
    ds_read2_b32 a[20:21], v27 offset0:192 offset1:193
    s_waitcnt lgkmcnt(10)
    v_mfma_f32_16x16x32_bf16 v[32:35], a[4:7], a[72:75], v[32:35]
    ds_read2_b32 a[22:23], v27 offset0:194 offset1:195
    s_waitcnt lgkmcnt(8)
    v_mfma_f32_16x16x32_bf16 v[32:35], a[0:3], a[76:79], v[32:35]
    ds_read2_b32 a[24:25], v27 offset0:128 offset1:129
    s_waitcnt lgkmcnt(7)
    v_mfma_f32_16x16x32_bf16 v[36:39], a[16:19], a[68:71], 0
    ds_read2_b32 a[26:27], v27 offset0:130 offset1:131
    s_waitcnt lgkmcnt(6)
    v_mfma_f32_16x16x32_bf16 v[36:39], a[12:15], a[72:75], v[36:39]
    ds_read2_b32 a[28:29], v27 offset0:64 offset1:65
    v_mfma_f32_16x16x32_bf16 v[36:39], a[8:11], a[76:79], v[36:39]
    ds_read2_b32 a[30:31], v27 offset0:66 offset1:67
    s_waitcnt lgkmcnt(7)
    v_mfma_f32_16x16x32_bf16 v[36:39], a[4:7], a[80:83], v[36:39]
    ds_read2_b32 a[32:33], v27 offset0:0 offset1:1
    s_waitcnt lgkmcnt(7)
    v_mfma_f32_16x16x32_bf16 v[36:39], a[0:3], a[84:87], v[36:39]
    ds_read2_b32 a[34:35], v27 offset0:2 offset1:3
    s_waitcnt lgkmcnt(4)
    v_mfma_f32_16x16x32_bf16 v[40:43], a[24:27], a[68:71], 0
    v_mfma_f32_16x16x32_bf16 v[40:43], a[20:23], a[72:75], v[40:43]
    v_mfma_f32_16x16x32_bf16 v[40:43], a[16:19], a[76:79], v[40:43]
    ds_write_b128 v30, v[32:35] offset:0
    v_mfma_f32_16x16x32_bf16 v[40:43], a[12:15], a[80:83], v[40:43]
    s_nop 0
    ds_write_b128 v30, v[36:39] offset:1152
    v_mfma_f32_16x16x32_bf16 v[40:43], a[8:11], a[84:87], v[40:43]
    s_waitcnt lgkmcnt(0)
    s_barrier
    ds_read2st64_b32 v[12:13], v31 offset0:0 offset1:36
    ds_read2st64_b32 v[14:15], v31 offset0:72 offset1:108
    ds_read2st64_b32 v[16:17], v2 offset0:0 offset1:36
    ds_read2st64_b32 v[18:19], v2 offset0:72 offset1:108
    ds_read_b128 a[88:91], v24 offset:1280
    ds_read_b128 a[92:95], v24 offset:1536
    ds_read_b128 a[96:99], v24 offset:1792
    ds_read_b128 a[100:103], v24 offset:2048
    v_mfma_f32_16x16x32_bf16 v[44:47], a[32:35], a[68:71], 0
    v_and_b32 v21, s35, v104
    v_lshlrev_b32 v20, 16, v104
    v_fma_f32 v21, v21, s37, v97
    v_fma_f32 v20, v20, s36, v96
    s_add_u32 s38, s23, 0
    v_mfma_f32_16x16x32_bf16 v[44:47], a[28:31], a[72:75], v[44:47]
    s_waitcnt lgkmcnt(4)
    v_add_f32 v12, v12, v13
    v_add_f32 v14, v14, v15
    v_add_f32 v16, v16, v17
    v_add_f32 v18, v18, v19
    v_mfma_f32_16x16x32_bf16 v[44:47], a[24:27], a[76:79], v[44:47]
    v_add_f32 v20, v20, v12
    v_add_f32 v21, v21, v16
    v_add_f32 v20, v20, v14
    v_add_f32 v21, v21, v18
    v_cvt_pk_bf16_f32 v104, v20, v21
    v_mfma_f32_16x16x32_bf16 v[44:47], a[20:23], a[80:83], v[44:47]
    s_cmp_eq_u32 s53, 0
    s_cbranch_scc1 conv_st2_0
    buffer_store_short v104, v4, s[4:7], s39 offen offset:0
    buffer_store_short_d16_hi v104, v4, s[4:7], s40 offen offset:0
    s_mov_b64 exec, s[50:51]
    s_add_u32 s38, s42, 0
    buffer_store_short v104, v111, s[4:7], s38 offen
    buffer_store_short_d16_hi v104, v111, s[4:7], s38 offen offset:32
    s_mov_b64 exec, -1
    s_branch conv_st3_0
conv_st2_0:
    buffer_store_dword v104, v5, s[4:7], s38 offen
conv_st3_0:
    ds_read2_b32 a[36:37], v26 offset0:192 offset1:193
    ds_read2_b32 a[38:39], v26 offset0:194 offset1:195
    ds_read2_b32 a[40:41], v26 offset0:128 offset1:129
    ds_read2_b32 a[42:43], v26 offset0:130 offset1:131
    v_mfma_f32_16x16x32_bf16 v[44:47], a[16:19], a[84:87], v[44:47]
    ds_read2_b32 a[44:45], v26 offset0:64 offset1:65
    ds_read2_b32 a[46:47], v26 offset0:66 offset1:67
    ds_read2_b32 a[48:49], v26 offset0:0 offset1:1
    ds_read2_b32 a[50:51], v26 offset0:2 offset1:3
    s_waitcnt vmcnt(3)
    s_waitcnt lgkmcnt(11)
    v_mfma_f32_16x16x32_bf16 v[40:43], a[4:7], a[88:91], v[40:43]
    v_add_f32 v80, v80, v82
    v_add_f32 v81, v81, v83
    v_add_f32 v84, v84, v86
    v_add_f32 v85, v85, v87
    v_cndmask_b32 v82, v84, v80, s[48:49]
    s_waitcnt lgkmcnt(10)
    v_mfma_f32_16x16x32_bf16 v[40:43], a[0:3], a[92:95], v[40:43]
    v_cndmask_b32 v83, v85, v81, s[48:49]
    v_cndmask_b32 v80, v80, v84, s[48:49]
    v_cndmask_b32 v81, v81, v85, s[48:49]
    s_nop 0
    v_add_f32_dpp v80, v82, v80 quad_perm:[1,0,3,2] row_mask:0xf bank_mask:0xf
    v_add_f32_dpp v81, v83, v81 quad_perm:[1,0,3,2] row_mask:0xf bank_mask:0xf
    v_mfma_f32_16x16x32_bf16 v[44:47], a[12:15], a[88:91], v[44:47]
    v_mul_f32 v80, 0x3b000000, v80
    v_fma_f32 v81, v81, s41, v110
    v_fma_f32 v81, -v80, v80, v81
    v_max_f32 v81, v110, v81
    v_mfma_f32_16x16x32_bf16 v[44:47], a[8:11], a[92:95], v[44:47]
    v_sqrt_f32 v81, v81
    v_sub_f32 v82, v100, v80
    v_sub_f32 v83, v101, v80
    v_cvt_pk_bf16_f32 v81, v81, v81
    s_waitcnt lgkmcnt(9)
    v_mfma_f32_16x16x32_bf16 v[44:47], a[4:7], a[96:99], v[44:47]
    v_lshlrev_b32 v81, 16, v81
    v_rcp_f32 v81, v81
    s_nop 0
    v_mul_f32 v82, v82, v81
    s_waitcnt lgkmcnt(8)
    v_mfma_f32_16x16x32_bf16 v[44:47], a[0:3], a[100:103], v[44:47]
    v_mul_f32 v83, v83, v81
    v_cvt_pk_bf16_f32 v106, v82, v83
    ds_write_b16 v4, v106 offset:21504
    ds_write_b16_d16_hi v4, v106 offset:26624
    s_waitcnt lgkmcnt(6)
    v_mfma_f32_16x16x32_bf16 v[48:51], a[40:43], a[68:71], 0
    v_mfma_f32_16x16x32_bf16 v[48:51], a[36:39], a[72:75], v[48:51]
    v_mfma_f32_16x16x32_bf16 v[48:51], a[32:35], a[76:79], v[48:51]
    ds_write_b128 v30, v[40:43] offset:2304
    v_mfma_f32_16x16x32_bf16 v[48:51], a[28:31], a[80:83], v[48:51]
    ds_write_b128 v30, v[44:47] offset:3456
    v_mfma_f32_16x16x32_bf16 v[48:51], a[24:27], a[84:87], v[48:51]
    v_mfma_f32_16x16x32_bf16 v[48:51], a[20:23], a[88:91], v[48:51]
    v_mfma_f32_16x16x32_bf16 v[48:51], a[16:19], a[92:95], v[48:51]
    v_mfma_f32_16x16x32_bf16 v[48:51], a[12:15], a[96:99], v[48:51]
    v_mfma_f32_16x16x32_bf16 v[48:51], a[8:11], a[100:103], v[48:51]
    s_waitcnt lgkmcnt(0)
    s_barrier
    ds_read2st64_b32 v[12:13], v31 offset0:9 offset1:45
    ds_read2st64_b32 v[14:15], v31 offset0:81 offset1:117
    ds_read2st64_b32 v[16:17], v2 offset0:9 offset1:45
    ds_read2st64_b32 v[18:19], v2 offset0:81 offset1:117
    ds_read_b128 a[104:107], v24 offset:2304
    ds_read_b128 a[108:111], v24 offset:2560
    ds_read_b128 a[112:115], v24 offset:2816
    ds_read_b128 a[116:119], v24 offset:3072
    v_mfma_f32_16x16x32_bf16 v[52:55], a[48:51], a[68:71], 0
    v_and_b32 v21, s35, v105
    v_lshlrev_b32 v20, 16, v105
    v_fma_f32 v21, v21, s37, v99
    v_fma_f32 v20, v20, s36, v98
    v_mfma_f32_16x16x32_bf16 v[52:55], a[44:47], a[72:75], v[52:55]
    s_add_u32 s38, s23, 524288
    s_waitcnt lgkmcnt(4)
    v_add_f32 v12, v12, v13
    v_add_f32 v14, v14, v15
    v_mfma_f32_16x16x32_bf16 v[52:55], a[40:43], a[76:79], v[52:55]
    v_add_f32 v16, v16, v17
    v_add_f32 v18, v18, v19
    v_add_f32 v20, v20, v12
    v_add_f32 v21, v21, v16
    v_mfma_f32_16x16x32_bf16 v[52:55], a[36:39], a[80:83], v[52:55]
    v_add_f32 v20, v20, v14
    v_add_f32 v21, v21, v18
    v_cvt_pk_bf16_f32 v105, v20, v21
    s_cmp_eq_u32 s53, 0
    s_cbranch_scc1 conv_st2_1
    buffer_store_short v105, v4, s[4:7], s39 offen offset:1024
    buffer_store_short_d16_hi v105, v4, s[4:7], s40 offen offset:1024
    s_mov_b64 exec, s[50:51]
    s_add_u32 s38, s42, 131072
    buffer_store_short v105, v111, s[4:7], s38 offen
    buffer_store_short_d16_hi v105, v111, s[4:7], s38 offen offset:32
    s_mov_b64 exec, -1
    s_branch conv_st3_1
conv_st2_1:
    buffer_store_dword v105, v5, s[4:7], s38 offen
conv_st3_1:
    v_mfma_f32_16x16x32_bf16 v[52:55], a[32:35], a[84:87], v[52:55]
    ds_read2_b32 a[52:53], v25 offset0:192 offset1:193
    ds_read2_b32 a[54:55], v25 offset0:194 offset1:195
    ds_read2_b32 a[56:57], v25 offset0:128 offset1:129
    ds_read2_b32 a[58:59], v25 offset0:130 offset1:131
    v_mfma_f32_16x16x32_bf16 v[52:55], a[28:31], a[88:91], v[52:55]
    ds_read2_b32 a[60:61], v25 offset0:64 offset1:65
    ds_read2_b32 a[62:63], v25 offset0:66 offset1:67
    ds_read2_b32 a[64:65], v25 offset0:0 offset1:1
    ds_read2_b32 a[66:67], v25 offset0:2 offset1:3
    v_mfma_f32_16x16x32_bf16 v[52:55], a[24:27], a[92:95], v[52:55]
    s_waitcnt vmcnt(2)
    v_add_f32 v88, v88, v90
    v_add_f32 v89, v89, v91
    v_add_f32 v92, v92, v94
    v_mfma_f32_16x16x32_bf16 v[52:55], a[20:23], a[96:99], v[52:55]
    v_add_f32 v93, v93, v95
    v_cndmask_b32 v90, v92, v88, s[48:49]
    v_cndmask_b32 v91, v93, v89, s[48:49]
    v_mfma_f32_16x16x32_bf16 v[52:55], a[16:19], a[100:103], v[52:55]
    v_cndmask_b32 v88, v88, v92, s[48:49]
    v_cndmask_b32 v89, v89, v93, s[48:49]
    s_nop 0
    v_add_f32_dpp v88, v90, v88 quad_perm:[1,0,3,2] row_mask:0xf bank_mask:0xf
    s_waitcnt lgkmcnt(11)
    v_mfma_f32_16x16x32_bf16 v[48:51], a[4:7], a[104:107], v[48:51]
    v_add_f32_dpp v89, v91, v89 quad_perm:[1,0,3,2] row_mask:0xf bank_mask:0xf
    v_mul_f32 v88, 0x3b000000, v88
    v_fma_f32 v89, v89, s41, v110
    s_waitcnt lgkmcnt(10)
    v_mfma_f32_16x16x32_bf16 v[48:51], a[0:3], a[108:111], v[48:51]
    v_fma_f32 v89, -v88, v88, v89
    v_max_f32 v89, v110, v89
    v_mfma_f32_16x16x32_bf16 v[52:55], a[12:15], a[104:107], v[52:55]
    v_sqrt_f32 v89, v89
    v_sub_f32 v90, v102, v88
    v_sub_f32 v91, v103, v88
    v_mfma_f32_16x16x32_bf16 v[52:55], a[8:11], a[108:111], v[52:55]
    v_cvt_pk_bf16_f32 v89, v89, v89
    v_lshlrev_b32 v89, 16, v89
    v_rcp_f32 v89, v89
    s_waitcnt lgkmcnt(9)
    v_mfma_f32_16x16x32_bf16 v[52:55], a[4:7], a[112:115], v[52:55]
    s_nop 0
    v_mul_f32 v90, v90, v89
    v_mul_f32 v91, v91, v89
    s_waitcnt lgkmcnt(8)
    v_mfma_f32_16x16x32_bf16 v[52:55], a[0:3], a[116:119], v[52:55]
    v_cvt_pk_bf16_f32 v107, v90, v91
    ds_write_b16 v4, v107 offset:22528
    ds_write_b16_d16_hi v4, v107 offset:27648
    s_waitcnt lgkmcnt(6)
    v_mfma_f32_16x16x32_bf16 v[56:59], a[56:59], a[68:71], 0
    v_mfma_f32_16x16x32_bf16 v[56:59], a[52:55], a[72:75], v[56:59]
    v_mfma_f32_16x16x32_bf16 v[56:59], a[48:51], a[76:79], v[56:59]
    ds_write_b128 v30, v[48:51] offset:4608
    v_mfma_f32_16x16x32_bf16 v[56:59], a[44:47], a[80:83], v[56:59]
    ds_write_b128 v30, v[52:55] offset:5760
    v_mfma_f32_16x16x32_bf16 v[56:59], a[40:43], a[84:87], v[56:59]
    v_mfma_f32_16x16x32_bf16 v[56:59], a[36:39], a[88:91], v[56:59]
    v_mfma_f32_16x16x32_bf16 v[56:59], a[32:35], a[92:95], v[56:59]
    v_mfma_f32_16x16x32_bf16 v[56:59], a[28:31], a[96:99], v[56:59]
    v_mfma_f32_16x16x32_bf16 v[56:59], a[24:27], a[100:103], v[56:59]
    v_mfma_f32_16x16x32_bf16 v[56:59], a[20:23], a[104:107], v[56:59]
    v_mfma_f32_16x16x32_bf16 v[56:59], a[16:19], a[108:111], v[56:59]
    v_mfma_f32_16x16x32_bf16 v[56:59], a[12:15], a[112:115], v[56:59]
    v_mfma_f32_16x16x32_bf16 v[56:59], a[8:11], a[116:119], v[56:59]
    s_waitcnt lgkmcnt(0)
    s_barrier
    ds_read2st64_b32 v[12:13], v31 offset0:18 offset1:54
    ds_read2st64_b32 v[14:15], v31 offset0:90 offset1:126
    ds_read2st64_b32 v[16:17], v2 offset0:18 offset1:54
    ds_read2st64_b32 v[18:19], v2 offset0:90 offset1:126
    ds_read_b128 a[120:123], v24 offset:3328
    ds_read_b128 a[124:127], v24 offset:3584
    ds_read_b128 a[128:131], v24 offset:3840
    ds_read_b128 a[132:135], v24 offset:4096
    v_mfma_f32_16x16x32_bf16 v[60:63], a[64:67], a[68:71], 0
    v_and_b32 v21, s35, v106
    v_mfma_f32_16x16x32_bf16 v[60:63], a[60:63], a[72:75], v[60:63]
    v_lshlrev_b32 v20, 16, v106
    v_mfma_f32_16x16x32_bf16 v[60:63], a[56:59], a[76:79], v[60:63]
    v_fma_f32 v21, v21, s37, v101
    v_mfma_f32_16x16x32_bf16 v[60:63], a[52:55], a[80:83], v[60:63]
    v_fma_f32 v20, v20, s36, v100
    v_mfma_f32_16x16x32_bf16 v[60:63], a[48:51], a[84:87], v[60:63]
    s_add_u32 s38, s23, 1048576
    v_mfma_f32_16x16x32_bf16 v[60:63], a[44:47], a[88:91], v[60:63]
    s_waitcnt lgkmcnt(4)
    v_mfma_f32_16x16x32_bf16 v[60:63], a[40:43], a[92:95], v[60:63]
    v_add_f32 v12, v12, v13
    v_mfma_f32_16x16x32_bf16 v[60:63], a[36:39], a[96:99], v[60:63]
    v_add_f32 v14, v14, v15
    v_mfma_f32_16x16x32_bf16 v[60:63], a[32:35], a[100:103], v[60:63]
    v_add_f32 v16, v16, v17
    v_mfma_f32_16x16x32_bf16 v[60:63], a[28:31], a[104:107], v[60:63]
    v_add_f32 v18, v18, v19
    v_mfma_f32_16x16x32_bf16 v[60:63], a[24:27], a[108:111], v[60:63]
    v_add_f32 v20, v20, v12
    v_mfma_f32_16x16x32_bf16 v[60:63], a[20:23], a[112:115], v[60:63]
    v_add_f32 v21, v21, v16
    v_mfma_f32_16x16x32_bf16 v[60:63], a[16:19], a[116:119], v[60:63]
    v_add_f32 v20, v20, v14
    s_waitcnt lgkmcnt(3)
    v_mfma_f32_16x16x32_bf16 v[56:59], a[4:7], a[120:123], v[56:59]
    v_add_f32 v21, v21, v18
    s_waitcnt lgkmcnt(2)
    v_mfma_f32_16x16x32_bf16 v[56:59], a[0:3], a[124:127], v[56:59]
    v_cvt_pk_bf16_f32 v106, v20, v21
    v_mfma_f32_16x16x32_bf16 v[60:63], a[12:15], a[120:123], v[60:63]
    s_cmp_eq_u32 s53, 0
    s_cbranch_scc1 conv_st2_2
    buffer_store_short v106, v4, s[4:7], s39 offen offset:2048
    buffer_store_short_d16_hi v106, v4, s[4:7], s40 offen offset:2048
    s_mov_b64 exec, s[50:51]
    s_add_u32 s38, s42, 262144
    buffer_store_short v106, v111, s[4:7], s38 offen
    buffer_store_short_d16_hi v106, v111, s[4:7], s38 offen offset:32
    s_mov_b64 exec, -1
    s_branch conv_st3_2
conv_st2_2:
    buffer_store_dword v106, v5, s[4:7], s38 offen
conv_st3_2:
    v_mfma_f32_16x16x32_bf16 v[60:63], a[8:11], a[124:127], v[60:63]
    s_waitcnt lgkmcnt(1)
    v_mfma_f32_16x16x32_bf16 v[60:63], a[4:7], a[128:131], v[60:63]
    s_waitcnt lgkmcnt(0)
    v_mfma_f32_16x16x32_bf16 v[60:63], a[0:3], a[132:135], v[60:63]
    ds_write_b128 v30, v[56:59] offset:6912
    s_nop 6
    ds_write_b128 v30, v[60:63] offset:8064
    s_waitcnt lgkmcnt(0)
    s_barrier
    ds_read2st64_b32 v[12:13], v31 offset0:27 offset1:63
    ds_read2st64_b32 v[14:15], v31 offset0:99 offset1:135
    ds_read2st64_b32 v[16:17], v2 offset0:27 offset1:63
    ds_read2st64_b32 v[18:19], v2 offset0:99 offset1:135
    v_and_b32 v21, s35, v107
    v_lshlrev_b32 v20, 16, v107
    v_fma_f32 v21, v21, s37, v103
    v_fma_f32 v20, v20, s36, v102
    s_add_u32 s38, s23, 1572864
    s_waitcnt lgkmcnt(0)
    v_add_f32 v12, v12, v13
    v_add_f32 v14, v14, v15
    v_add_f32 v16, v16, v17
    v_add_f32 v18, v18, v19
    v_add_f32 v20, v20, v12
    v_add_f32 v21, v21, v16
    v_add_f32 v20, v20, v14
    v_add_f32 v21, v21, v18
    v_cvt_pk_bf16_f32 v107, v20, v21
    s_cmp_eq_u32 s53, 0
    s_cbranch_scc1 conv_st2_3
    buffer_store_short v107, v4, s[4:7], s39 offen offset:3072
    buffer_store_short_d16_hi v107, v4, s[4:7], s40 offen offset:3072
    s_mov_b64 exec, s[50:51]
    s_add_u32 s38, s42, 393216
    buffer_store_short v107, v111, s[4:7], s38 offen
    buffer_store_short_d16_hi v107, v111, s[4:7], s38 offen offset:32
    s_mov_b64 exec, -1
    s_branch conv_st3_3
conv_st2_3:
    buffer_store_dword v107, v5, s[4:7], s38 offen
conv_st3_3:
conv_exit:
    s_endpgm
.p2align 7
.type kgen_tab,@object
kgen_tab:
    .short 13800, 13800, 13800, 13800, 13800, 13800, 13800, 13800, 13800, 5184, 5184, 5184, 5184, 5184, 5148, 5148, 5148, 5148, 576, 568, 564, 560, 556, 552, 548, 544, 540, 0, 0, 0, 0, 0
    .short 13800, 13800, 13800, 13800, 13800, 13800, 13800, 13800, 13800, 5148, 5148, 5148, 5148, 5112, 5112, 5112, 5112, 5112, 540, 532, 528, 524, 520, 516, 512, 508, 504, 0, 0, 0, 0, 0
    .short 13800, 13800, 13800, 13800, 13800, 13800, 13800, 13800, 13800, 5112, 5112, 5112, 5112, 5112, 5076, 5076, 5076, 5076, 504, 496, 492, 488, 484, 480, 476, 472, 468, 0, 0, 0, 0, 0
    .short 13800, 13800, 13800, 13800, 13800, 13800, 13800, 13800, 13800, 5076, 5076, 5076, 5076, 5040, 5040, 5040, 5040, 5040, 468, 460, 456, 452, 448, 444, 440, 436, 432, 0, 0, 0, 0, 0
    .short 13800, 13800, 13800, 13800, 13800, 13800, 13800, 13800, 13800, 5040, 5040, 5040, 5040, 5040, 5004, 5004, 5004, 5004, 432, 424, 420, 416, 412, 408, 404, 400, 396, 0, 0, 0, 0, 0
    .short 13800, 13800, 13800, 13800, 13800, 13800, 13800, 13800, 13800, 5004, 5004, 5004, 5004, 4968, 4968, 4968, 4968, 4968, 396, 388, 384, 380, 376, 372, 368, 364, 360, 0, 0, 0, 0, 0
    .short 13800, 13800, 13800, 13800, 13800, 13800, 13800, 13800, 13800, 4968, 4968, 4968, 4968, 4968, 4932, 4932, 4932, 4932, 360, 352, 348, 344, 340, 336, 332, 328, 324, 0, 0, 0, 0, 0
    .short 13800, 13800, 13800, 13800, 13800, 13800, 13800, 13800, 13800, 4932, 4932, 4932, 4932, 4896, 4896, 4896, 4896, 4896, 324, 316, 312, 308, 304, 300, 296, 292, 288, 0, 0, 0, 0, 0
    .short 13800, 13800, 13800, 13800, 13800, 13800, 13800, 13800, 13800, 4896, 4896, 4896, 4896, 4896, 4860, 4860, 4860, 4860, 288, 280, 276, 272, 268, 264, 260, 256, 252, 0, 0, 0, 0, 0
    .short 13800, 13800, 13800, 13800, 13800, 13800, 13800, 13800, 13800, 4860, 4860, 4860, 4860, 4824, 4824, 4824, 4824, 4824, 252, 244, 240, 236, 232, 228, 224, 220, 216, 0, 0, 0, 0, 0
    .short 13800, 13800, 13800, 13800, 13800, 13800, 13800, 13800, 13800, 4824, 4824, 4824, 4824, 4824, 4788, 4788, 4788, 4788, 216, 208, 204, 200, 196, 192, 188, 184, 180, 0, 0, 0, 0, 0
    .short 13800, 13800, 13800, 13800, 13800, 13800, 13800, 13800, 13800, 4788, 4788, 4788, 4788, 4752, 4752, 4752, 4752, 4752, 180, 172, 168, 164, 160, 156, 152, 148, 144, 0, 0, 0, 0, 0
    .short 13800, 13800, 13800, 13800, 13800, 13800, 13800, 13800, 13800, 4752, 4752, 4752, 4752, 4752, 4716, 4716, 4716, 4716, 144, 136, 132, 128, 124, 120, 116, 112, 108, 0, 0, 0, 0, 0
    .short 13800, 13800, 13800, 13800, 13800, 13800, 13800, 13800, 13800, 4716, 4716, 4716, 4716, 4680, 4680, 4680, 4680, 4680, 108, 100, 96, 92, 88, 84, 80, 76, 72, 0, 0, 0, 0, 0
    .short 13800, 13800, 13800, 13800, 13800, 13800, 13800, 13800, 13800, 4680, 4680, 4680, 4680, 4680, 4644, 4644, 4644, 4644, 72, 64, 60, 56, 52, 48, 44, 40, 36, 0, 0, 0, 0, 0
    .short 13800, 13800, 13800, 13800, 13800, 13800, 13800, 13800, 13800, 4644, 4644, 4644, 4644, 4608, 4608, 4608, 4608, 4608, 36, 28, 24, 20, 16, 12, 8, 4, 0, 0, 0, 0, 0, 0
    .short 13800, 9216, 9216, 9216, 9216, 9180, 9180, 9180, 9180, 4608, 4608, 4608, 4588, 4588, 4588, 4572, 4572, 4572, 0, 13800, 13800, 13800, 13800, 13800, 13800, 13800, 13800, 0, 0, 0, 0, 0
    .short 9180, 9180, 9180, 9180, 9144, 9144, 9144, 9144, 9144, 4572, 4572, 4572, 4552, 4552, 4552, 4536, 4536, 4536, 13800, 13800, 13800, 13800, 13800, 13800, 13800, 13800, 13800, 0, 0, 0, 0, 0
    .short 9144, 9144, 9144, 9144, 9144, 9108, 9108, 9108, 9108, 4536, 4536, 4536, 4516, 4516, 4516, 4500, 4500, 4500, 13800, 13800, 13800, 13800, 13800, 13800, 13800, 13800, 13800, 0, 0, 0, 0, 0
    .short 9108, 9108, 9108, 9108, 9072, 9072, 9072, 9072, 9072, 4500, 4500, 4500, 4480, 4480, 4480, 4464, 4464, 4464, 13800, 13800, 13800, 13800, 13800, 13800, 13800, 13800, 13800, 0, 0, 0, 0, 0
    .short 9072, 9072, 9072, 9072, 9072, 9036, 9036, 9036, 9036, 4464, 4464, 4464, 4444, 4444, 4444, 4428, 4428, 4428, 13800, 13800, 13800, 13800, 13800, 13800, 13800, 13800, 13800, 0, 0, 0, 0, 0
    .short 9036, 9036, 9036, 9036, 9000, 9000, 9000, 9000, 9000, 4428, 4428, 4428, 4408, 4408, 4408, 4392, 4392, 4392, 13800, 13800, 13800, 13800, 13800, 13800, 13800, 13800, 13800, 0, 0, 0, 0, 0
    .short 9000, 9000, 9000, 9000, 9000, 8964, 8964, 8964, 8964, 4392, 4392, 4392, 4372, 4372, 4372, 4356, 4356, 4356, 13800, 13800, 13800, 13800, 13800, 13800, 13800, 13800, 13800, 0, 0, 0, 0, 0
    .short 8964, 8964, 8964, 8964, 8928, 8928, 8928, 8928, 8928, 4356, 4356, 4356, 4336, 4336, 4336, 4320, 4320, 4320, 13800, 13800, 13800, 13800, 13800, 13800, 13800, 13800, 13800, 0, 0, 0, 0, 0
    .short 8928, 8928, 8928, 8928, 8928, 8892, 8892, 8892, 8892, 4320, 4320, 4320, 4300, 4300, 4300, 4284, 4284, 4284, 13800, 13800, 13800, 13800, 13800, 13800, 13800, 13800, 13800, 0, 0, 0, 0, 0
    .short 8892, 8892, 8892, 8892, 8856, 8856, 8856, 8856, 8856, 4284, 4284, 4284, 4264, 4264, 4264, 4248, 4248, 4248, 13800, 13800, 13800, 13800, 13800, 13800, 13800, 13800, 13800, 0, 0, 0, 0, 0
    .short 8856, 8856, 8856, 8856, 8856, 8820, 8820, 8820, 8820, 4248, 4248, 4248, 4228, 4228, 4228, 4212, 4212, 4212, 13800, 13800, 13800, 13800, 13800, 13800, 13800, 13800, 13800, 0, 0, 0, 0, 0
    .short 8820, 8820, 8820, 8820, 8784, 8784, 8784, 8784, 8784, 4212, 4212, 4212, 4192, 4192, 4192, 4176, 4176, 4176, 13800, 13800, 13800, 13800, 13800, 13800, 13800, 13800, 13800, 0, 0, 0, 0, 0
    .short 8784, 8784, 8784, 8784, 8784, 8748, 8748, 8748, 8748, 4176, 4176, 4176, 4156, 4156, 4156, 4140, 4140, 4140, 13800, 13800, 13800, 13800, 13800, 13800, 13800, 13800, 13800, 0, 0, 0, 0, 0
    .short 8748, 8748, 8748, 8748, 8712, 8712, 8712, 8712, 8712, 4140, 4140, 4140, 4120, 4120, 4120, 4104, 4104, 4104, 13800, 13800, 13800, 13800, 13800, 13800, 13800, 13800, 13800, 0, 0, 0, 0, 0
    .short 8712, 8712, 8712, 8712, 8712, 8676, 8676, 8676, 8676, 4104, 4104, 4104, 4084, 4084, 4084, 4068, 4068, 4068, 13800, 13800, 13800, 13800, 13800, 13800, 13800, 13800, 13800, 0, 0, 0, 0, 0
    .short 8676, 8676, 8676, 8676, 8640, 8640, 8640, 8640, 8640, 4068, 4068, 4068, 4048, 4048, 4048, 4032, 4032, 4032, 13800, 13800, 13800, 13800, 13800, 13800, 13800, 13800, 13800, 0, 0, 0, 0, 0
    .short 8640, 8640, 8640, 8640, 8640, 8604, 8604, 8604, 8604, 4032, 4032, 4032, 4012, 4012, 4012, 3996, 3996, 3996, 13800, 13800, 13800, 13800, 13800, 13800, 13800, 13800, 13800, 0, 0, 0, 0, 0
    .short 8604, 8604, 8604, 8604, 8568, 8568, 8568, 8568, 8568, 3996, 3996, 3996, 3976, 3976, 3976, 3960, 3960, 3960, 13800, 13800, 13800, 13800, 13800, 13800, 13800, 13800, 13800, 0, 0, 0, 0, 0
    .short 8568, 8568, 8568, 8568, 8568, 8532, 8532, 8532, 8532, 3960, 3960, 3960, 3940, 3940, 3940, 3924, 3924, 3924, 13800, 13800, 13800, 13800, 13800, 13800, 13800, 13800, 13800, 0, 0, 0, 0, 0
    .short 8532, 8532, 8532, 8532, 8496, 8496, 8496, 8496, 8496, 3924, 3924, 3924, 3904, 3904, 3904, 3888, 3888, 3888, 13800, 13800, 13800, 13800, 13800, 13800, 13800, 13800, 13800, 0, 0, 0, 0, 0
    .short 8496, 8496, 8496, 8496, 8496, 8460, 8460, 8460, 8460, 3888, 3888, 3888, 3868, 3868, 3868, 3852, 3852, 3852, 13800, 13800, 13800, 13800, 13800, 13800, 13800, 13800, 13800, 0, 0, 0, 0, 0
    .short 8460, 8460, 8460, 8460, 8424, 8424, 8424, 8424, 8424, 3852, 3852, 3852, 3832, 3832, 3832, 3816, 3816, 3816, 13800, 13800, 13800, 13800, 13800, 13800, 13800, 13800, 13800, 0, 0, 0, 0, 0
    .short 8424, 8424, 8424, 8424, 8424, 8388, 8388, 8388, 8388, 3816, 3816, 3816, 3796, 3796, 3796, 3780, 3780, 3780, 13800, 13800, 13800, 13800, 13800, 13800, 13800, 13800, 13800, 0, 0, 0, 0, 0
    .short 8388, 8388, 8388, 8388, 8352, 8352, 8352, 8352, 8352, 3780, 3780, 3780, 3760, 3760, 3760, 3744, 3744, 3744, 13800, 13800, 13800, 13800, 13800, 13800, 13800, 13800, 13800, 0, 0, 0, 0, 0
    .short 8352, 8352, 8352, 8352, 8352, 8316, 8316, 8316, 8316, 3744, 3744, 3744, 3724, 3724, 3724, 3708, 3708, 3708, 13800, 13800, 13800, 13800, 13800, 13800, 13800, 13800, 13800, 0, 0, 0, 0, 0
    .short 8316, 8316, 8316, 8316, 8280, 8280, 8280, 8280, 8280, 3708, 3708, 3708, 3688, 3688, 3688, 3672, 3672, 3672, 13800, 13800, 13800, 13800, 13800, 13800, 13800, 13800, 13800, 0, 0, 0, 0, 0
    .short 8280, 8280, 8280, 8280, 8280, 8244, 8244, 8244, 8244, 3672, 3672, 3672, 3652, 3652, 3652, 3636, 3636, 3636, 13800, 13800, 13800, 13800, 13800, 13800, 13800, 13800, 13800, 0, 0, 0, 0, 0
    .short 8244, 8244, 8244, 8244, 8208, 8208, 8208, 8208, 8208, 3636, 3636, 3636, 3616, 3616, 3616, 3600, 3600, 3600, 13800, 13800, 13800, 13800, 13800, 13800, 13800, 13800, 13800, 0, 0, 0, 0, 0
    .short 8208, 8208, 8208, 8208, 8208, 8172, 8172, 8172, 8172, 3600, 3600, 3600, 3580, 3580, 3580, 3564, 3564, 3564, 13800, 13800, 13800, 13800, 13800, 13800, 13800, 13800, 13800, 0, 0, 0, 0, 0
    .short 8172, 8172, 8172, 8172, 8136, 8136, 8136, 8136, 8136, 3564, 3564, 3564, 3544, 3544, 3544, 3528, 3528, 3528, 13800, 13800, 13800, 13800, 13800, 13800, 13800, 13800, 13800, 0, 0, 0, 0, 0
    .short 8136, 8136, 8136, 8136, 8136, 8100, 8100, 8100, 8100, 3528, 3528, 3528, 3508, 3508, 3508, 3492, 3492, 3492, 13800, 13800, 13800, 13800, 13800, 13800, 13800, 13800, 13800, 0, 0, 0, 0, 0
    .short 8100, 8100, 8100, 8100, 8064, 8064, 8064, 8064, 8064, 3492, 3492, 3492, 3472, 3472, 3472, 3456, 3456, 3456, 13800, 13800, 13800, 13800, 13800, 13800, 13800, 13800, 13800, 0, 0, 0, 0, 0
    .short 8064, 8064, 8064, 8064, 8064, 8028, 8028, 8028, 8028, 3456, 3456, 3456, 3436, 3436, 3436, 3420, 3420, 3420, 13800, 13800, 13800, 13800, 13800, 13800, 13800, 13800, 13800, 0, 0, 0, 0, 0
    .short 8028, 8028, 8028, 8028, 7992, 7992, 7992, 7992, 7992, 3420, 3420, 3420, 3400, 3400, 3400, 3384, 3384, 3384, 13800, 13800, 13800, 13800, 13800, 13800, 13800, 13800, 13800, 0, 0, 0, 0, 0
    .short 7992, 7992, 7992, 7992, 7992, 7956, 7956, 7956, 7956, 3384, 3384, 3384, 3364, 3364, 3364, 3348, 3348, 3348, 13800, 13800, 13800, 13800, 13800, 13800, 13800, 13800, 13800, 0, 0, 0, 0, 0
    .short 7956, 7956, 7956, 7956, 7920, 7920, 7920, 7920, 7920, 3348, 3348, 3348, 3328, 3328, 3328, 3312, 3312, 3312, 13800, 13800, 13800, 13800, 13800, 13800, 13800, 13800, 13800, 0, 0, 0, 0, 0
    .short 7920, 7920, 7920, 7920, 7920, 7884, 7884, 7884, 7884, 3312, 3312, 3312, 3292, 3292, 3292, 3276, 3276, 3276, 13800, 13800, 13800, 13800, 13800, 13800, 13800, 13800, 13800, 0, 0, 0, 0, 0
    .short 7884, 7884, 7884, 7884, 7848, 7848, 7848, 7848, 7848, 3276, 3276, 3276, 3256, 3256, 3256, 3240, 3240, 3240, 13800, 13800, 13800, 13800, 13800, 13800, 13800, 13800, 13800, 0, 0, 0, 0, 0
    .short 7848, 7848, 7848, 7848, 7848, 7812, 7812, 7812, 7812, 3240, 3240, 3240, 3220, 3220, 3220, 3204, 3204, 3204, 13800, 13800, 13800, 13800, 13800, 13800, 13800, 13800, 13800, 0, 0, 0, 0, 0
    .short 7812, 7812, 7812, 7812, 7776, 7776, 7776, 7776, 7776, 3204, 3204, 3204, 3184, 3184, 3184, 3168, 3168, 3168, 13800, 13800, 13800, 13800, 13800, 13800, 13800, 13800, 13800, 0, 0, 0, 0, 0
    .short 7776, 7776, 7776, 7776, 7776, 7740, 7740, 7740, 7740, 3168, 3168, 3168, 3148, 3148, 3148, 3132, 3132, 3132, 13800, 13800, 13800, 13800, 13800, 13800, 13800, 13800, 13800, 0, 0, 0, 0, 0
    .short 7740, 7740, 7740, 7740, 7704, 7704, 7704, 7704, 7704, 3132, 3132, 3132, 3112, 3112, 3112, 3096, 3096, 3096, 13800, 13800, 13800, 13800, 13800, 13800, 13800, 13800, 13800, 0, 0, 0, 0, 0
    .short 7704, 7704, 7704, 7704, 7704, 7668, 7668, 7668, 7668, 3096, 3096, 3096, 3076, 3076, 3076, 3060, 3060, 3060, 13800, 13800, 13800, 13800, 13800, 13800, 13800, 13800, 13800, 0, 0, 0, 0, 0
    .short 7668, 7668, 7668, 7668, 7632, 7632, 7632, 7632, 7632, 3060, 3060, 3060, 3040, 3040, 3040, 3024, 3024, 3024, 13800, 13800, 13800, 13800, 13800, 13800, 13800, 13800, 13800, 0, 0, 0, 0, 0
    .short 7632, 7632, 7632, 7632, 7632, 7596, 7596, 7596, 7596, 3024, 3024, 3024, 3004, 3004, 3004, 2988, 2988, 2988, 13800, 13800, 13800, 13800, 13800, 13800, 13800, 13800, 13800, 0, 0, 0, 0, 0
    .short 7596, 7596, 7596, 7596, 7560, 7560, 7560, 7560, 7560, 2988, 2988, 2988, 2968, 2968, 2968, 2952, 2952, 2952, 13800, 13800, 13800, 13800, 13800, 13800, 13800, 13800, 13800, 0, 0, 0, 0, 0
    .short 7560, 7560, 7560, 7560, 7560, 7524, 7524, 7524, 7524, 2952, 2952, 2952, 2932, 2932, 2932, 2916, 2916, 2916, 13800, 13800, 13800, 13800, 13800, 13800, 13800, 13800, 13800, 0, 0, 0, 0, 0
    .short 7524, 7524, 7524, 7524, 7488, 7488, 7488, 7488, 7488, 2916, 2916, 2916, 2896, 2896, 2896, 2880, 2880, 2880, 13800, 13800, 13800, 13800, 13800, 13800, 13800, 13800, 13800, 0, 0, 0, 0, 0
    .short 7488, 7488, 7488, 7488, 7488, 7452, 7452, 7452, 7452, 2880, 2880, 2880, 2860, 2860, 2860, 2844, 2844, 2844, 13800, 13800, 13800, 13800, 13800, 13800, 13800, 13800, 13800, 0, 0, 0, 0, 0
    .short 7452, 7452, 7452, 7452, 7416, 7416, 7416, 7416, 7416, 2844, 2844, 2844, 2824, 2824, 2824, 2808, 2808, 2808, 13800, 13800, 13800, 13800, 13800, 13800, 13800, 13800, 13800, 0, 0, 0, 0, 0
    .short 7416, 7416, 7416, 7416, 7416, 7380, 7380, 7380, 7380, 2808, 2808, 2808, 2788, 2788, 2788, 2772, 2772, 2772, 13800, 13800, 13800, 13800, 13800, 13800, 13800, 13800, 13800, 0, 0, 0, 0, 0
    .short 7380, 7380, 7380, 7380, 7344, 7344, 7344, 7344, 7344, 2772, 2772, 2772, 2752, 2752, 2752, 2736, 2736, 2736, 13800, 13800, 13800, 13800, 13800, 13800, 13800, 13800, 13800, 0, 0, 0, 0, 0
    .short 7344, 7344, 7344, 7344, 7344, 7308, 7308, 7308, 7308, 2736, 2736, 2736, 2716, 2716, 2716, 2700, 2700, 2700, 13800, 13800, 13800, 13800, 13800, 13800, 13800, 13800, 13800, 0, 0, 0, 0, 0
    .short 7308, 7308, 7308, 7308, 7272, 7272, 7272, 7272, 7272, 2700, 2700, 2700, 2680, 2680, 2680, 2664, 2664, 2664, 13800, 13800, 13800, 13800, 13800, 13800, 13800, 13800, 13800, 0, 0, 0, 0, 0
    .short 7272, 7272, 7272, 7272, 7272, 7236, 7236, 7236, 7236, 2664, 2664, 2664, 2644, 2644, 2644, 2628, 2628, 2628, 13800, 13800, 13800, 13800, 13800, 13800, 13800, 13800, 13800, 0, 0, 0, 0, 0
    .short 7236, 7236, 7236, 7236, 7200, 7200, 7200, 7200, 7200, 2628, 2628, 2628, 2608, 2608, 2608, 2592, 2592, 2592, 13800, 13800, 13800, 13800, 13800, 13800, 13800, 13800, 13800, 0, 0, 0, 0, 0
    .short 7200, 7200, 7200, 7200, 7200, 7164, 7164, 7164, 7164, 2592, 2592, 2592, 2572, 2572, 2572, 2556, 2556, 2556, 13800, 13800, 13800, 13800, 13800, 13800, 13800, 13800, 13800, 0, 0, 0, 0, 0
    .short 7164, 7164, 7164, 7164, 7128, 7128, 7128, 7128, 7128, 2556, 2556, 2556, 2536, 2536, 2536, 2520, 2520, 2520, 13800, 13800, 13800, 13800, 13800, 13800, 13800, 13800, 13800, 0, 0, 0, 0, 0
    .short 7128, 7128, 7128, 7128, 7128, 7092, 7092, 7092, 7092, 2520, 2520, 2520, 2500, 2500, 2500, 2484, 2484, 2484, 13800, 13800, 13800, 13800, 13800, 13800, 13800, 13800, 13800, 0, 0, 0, 0, 0
    .short 7092, 7092, 7092, 7092, 7056, 7056, 7056, 7056, 7056, 2484, 2484, 2484, 2464, 2464, 2464, 2448, 2448, 2448, 13800, 13800, 13800, 13800, 13800, 13800, 13800, 13800, 13800, 0, 0, 0, 0, 0
    .short 7056, 7056, 7056, 7056, 7056, 7020, 7020, 7020, 7020, 2448, 2448, 2448, 2428, 2428, 2428, 2412, 2412, 2412, 13800, 13800, 13800, 13800, 13800, 13800, 13800, 13800, 13800, 0, 0, 0, 0, 0
    .short 7020, 7020, 7020, 7020, 6984, 6984, 6984, 6984, 6984, 2412, 2412, 2412, 2392, 2392, 2392, 2376, 2376, 2376, 13800, 13800, 13800, 13800, 13800, 13800, 13800, 13800, 13800, 0, 0, 0, 0, 0
    .short 6984, 6984, 6984, 6984, 6984, 6948, 6948, 6948, 6948, 2376, 2376, 2376, 2356, 2356, 2356, 2340, 2340, 2340, 13800, 13800, 13800, 13800, 13800, 13800, 13800, 13800, 13800, 0, 0, 0, 0, 0
    .short 6948, 6948, 6948, 6948, 6912, 6912, 6912, 6912, 6912, 2340, 2340, 2340, 2320, 2320, 2320, 2304, 2304, 2304, 13800, 13800, 13800, 13800, 13800, 13800, 13800, 13800, 13800, 0, 0, 0, 0, 0
    .short 6912, 6912, 6912, 6912, 6912, 6876, 6876, 6876, 6876, 2304, 2304, 2292, 2284, 2284, 2284, 2276, 2268, 2268, 13800, 13800, 13800, 13800, 13800, 13800, 13800, 13800, 13800, 0, 0, 0, 0, 0
    .short 6876, 6876, 6876, 6876, 6840, 6840, 6840, 6840, 6840, 2268, 2268, 2256, 2248, 2248, 2248, 2240, 2232, 2232, 13800, 13800, 13800, 13800, 13800, 13800, 13800, 13800, 13800, 0, 0, 0, 0, 0
    .short 6840, 6840, 6840, 6840, 6840, 6804, 6804, 6804, 6804, 2232, 2232, 2220, 2212, 2212, 2212, 2204, 2196, 2196, 13800, 13800, 13800, 13800, 13800, 13800, 13800, 13800, 13800, 0, 0, 0, 0, 0
    .short 6804, 6804, 6804, 6804, 6768, 6768, 6768, 6768, 6768, 2196, 2196, 2184, 2176, 2176, 2176, 2168, 2160, 2160, 13800, 13800, 13800, 13800, 13800, 13800, 13800, 13800, 13800, 0, 0, 0, 0, 0
    .short 6768, 6768, 6768, 6768, 6768, 6732, 6732, 6732, 6732, 2160, 2160, 2148, 2140, 2140, 2140, 2132, 2124, 2124, 13800, 13800, 13800, 13800, 13800, 13800, 13800, 13800, 13800, 0, 0, 0, 0, 0
    .short 6732, 6732, 6732, 6732, 6696, 6696, 6696, 6696, 6696, 2124, 2124, 2112, 2104, 2104, 2104, 2096, 2088, 2088, 13800, 13800, 13800, 13800, 13800, 13800, 13800, 13800, 13800, 0, 0, 0, 0, 0
    .short 6696, 6696, 6696, 6696, 6696, 6660, 6660, 6660, 6660, 2088, 2088, 2076, 2068, 2068, 2068, 2060, 2052, 2052, 13800, 13800, 13800, 13800, 13800, 13800, 13800, 13800, 13800, 0, 0, 0, 0, 0
    .short 6660, 6660, 6660, 6660, 6624, 6624, 6624, 6624, 6624, 2052, 2052, 2040, 2032, 2032, 2032, 2024, 2016, 2016, 13800, 13800, 13800, 13800, 13800, 13800, 13800, 13800, 13800, 0, 0, 0, 0, 0
    .short 6624, 6624, 6624, 6624, 6624, 6588, 6588, 6588, 6588, 2016, 2016, 2004, 1996, 1996, 1996, 1988, 1980, 1980, 13800, 13800, 13800, 13800, 13800, 13800, 13800, 13800, 13800, 0, 0, 0, 0, 0
    .short 6588, 6588, 6588, 6588, 6552, 6552, 6552, 6552, 6552, 1980, 1980, 1968, 1960, 1960, 1960, 1952, 1944, 1944, 13800, 13800, 13800, 13800, 13800, 13800, 13800, 13800, 13800, 0, 0, 0, 0, 0
    .short 6552, 6552, 6552, 6552, 6552, 6516, 6516, 6516, 6516, 1944, 1944, 1932, 1924, 1924, 1924, 1916, 1908, 1908, 13800, 13800, 13800, 13800, 13800, 13800, 13800, 13800, 13800, 0, 0, 0, 0, 0
    .short 6516, 6516, 6516, 6516, 6480, 6480, 6480, 6480, 6480, 1908, 1908, 1896, 1888, 1888, 1888, 1880, 1872, 1872, 13800, 13800, 13800, 13800, 13800, 13800, 13800, 13800, 13800, 0, 0, 0, 0, 0
    .short 6480, 6480, 6480, 6480, 6480, 6444, 6444, 6444, 6444, 1872, 1872, 1860, 1852, 1852, 1852, 1844, 1836, 1836, 13800, 13800, 13800, 13800, 13800, 13800, 13800, 13800, 13800, 0, 0, 0, 0, 0
    .short 6444, 6444, 6444, 6444, 6408, 6408, 6408, 6408, 6408, 1836, 1836, 1824, 1816, 1816, 1816, 1808, 1800, 1800, 13800, 13800, 13800, 13800, 13800, 13800, 13800, 13800, 13800, 0, 0, 0, 0, 0
    .short 6408, 6408, 6408, 6408, 6408, 6372, 6372, 6372, 6372, 1800, 1800, 1788, 1780, 1780, 1780, 1772, 1764, 1764, 13800, 13800, 13800, 13800, 13800, 13800, 13800, 13800, 13800, 0, 0, 0, 0, 0
    .short 6372, 6372, 6372, 6372, 6336, 6336, 6336, 6336, 6336, 1764, 1764, 1752, 1744, 1744, 1744, 1736, 1728, 1728, 13800, 13800, 13800, 13800, 13800, 13800, 13800, 13800, 13800, 0, 0, 0, 0, 0
    .short 6336, 6336, 6336, 6336, 6336, 6300, 6300, 6300, 6300, 1728, 1728, 1716, 1708, 1708, 1708, 1700, 1692, 1692, 13800, 13800, 13800, 13800, 13800, 13800, 13800, 13800, 13800, 0, 0, 0, 0, 0
    .short 6300, 6300, 6300, 6300, 6264, 6264, 6264, 6264, 6264, 1692, 1692, 1680, 1672, 1672, 1672, 1664, 1656, 1656, 13800, 13800, 13800, 13800, 13800, 13800, 13800, 13800, 13800, 0, 0, 0, 0, 0
    .short 6264, 6264, 6264, 6264, 6264, 6228, 6228, 6228, 6228, 1656, 1656, 1644, 1636, 1636, 1636, 1628, 1620, 1620, 13800, 13800, 13800, 13800, 13800, 13800, 13800, 13800, 13800, 0, 0, 0, 0, 0
    .short 6228, 6228, 6228, 6228, 6192, 6192, 6192, 6192, 6192, 1620, 1620, 1608, 1600, 1600, 1600, 1592, 1584, 1584, 13800, 13800, 13800, 13800, 13800, 13800, 13800, 13800, 13800, 0, 0, 0, 0, 0
    .short 6192, 6192, 6192, 6192, 6192, 6156, 6156, 6156, 6156, 1584, 1584, 1572, 1564, 1564, 1564, 1556, 1548, 1548, 13800, 13800, 13800, 13800, 13800, 13800, 13800, 13800, 13800, 0, 0, 0, 0, 0
    .short 6156, 6156, 6156, 6156, 6120, 6120, 6120, 6120, 6120, 1548, 1548, 1536, 1528, 1528, 1528, 1520, 1512, 1512, 13800, 13800, 13800, 13800, 13800, 13800, 13800, 13800, 13800, 0, 0, 0, 0, 0
    .short 6120, 6120, 6120, 6120, 6120, 6084, 6084, 6084, 6084, 1512, 1512, 1500, 1492, 1492, 1492, 1484, 1476, 1476, 13800, 13800, 13800, 13800, 13800, 13800, 13800, 13800, 13800, 0, 0, 0, 0, 0
    .short 6084, 6084, 6084, 6084, 6048, 6048, 6048, 6048, 6048, 1476, 1476, 1464, 1456, 1456, 1456, 1448, 1440, 1440, 13800, 13800, 13800, 13800, 13800, 13800, 13800, 13800, 13800, 0, 0, 0, 0, 0
    .short 6048, 6048, 6048, 6048, 6048, 6012, 6012, 6012, 6012, 1440, 1440, 1428, 1420, 1420, 1420, 1412, 1404, 1404, 13800, 13800, 13800, 13800, 13800, 13800, 13800, 13800, 13800, 0, 0, 0, 0, 0
    .short 6012, 6012, 6012, 6012, 5976, 5976, 5976, 5976, 5976, 1404, 1404, 1392, 1384, 1384, 1384, 1376, 1368, 1368, 13800, 13800, 13800, 13800, 13800, 13800, 13800, 13800, 13800, 0, 0, 0, 0, 0
    .short 5976, 5976, 5976, 5976, 5976, 5940, 5940, 5940, 5940, 1368, 1368, 1356, 1348, 1348, 1348, 1340, 1332, 1332, 13800, 13800, 13800, 13800, 13800, 13800, 13800, 13800, 13800, 0, 0, 0, 0, 0
    .short 5940, 5940, 5940, 5940, 5904, 5904, 5904, 5904, 5904, 1332, 1332, 1320, 1312, 1312, 1312, 1304, 1296, 1296, 13800, 13800, 13800, 13800, 13800, 13800, 13800, 13800, 13800, 0, 0, 0, 0, 0
    .short 5904, 5904, 5904, 5904, 5904, 5868, 5868, 5868, 5868, 1296, 1296, 1284, 1276, 1276, 1276, 1268, 1260, 1260, 13800, 13800, 13800, 13800, 13800, 13800, 13800, 13800, 13800, 0, 0, 0, 0, 0
    .short 5868, 5868, 5868, 5868, 5832, 5832, 5832, 5832, 5832, 1260, 1260, 1248, 1240, 1240, 1240, 1232, 1224, 1224, 13800, 13800, 13800, 13800, 13800, 13800, 13800, 13800, 13800, 0, 0, 0, 0, 0
    .short 5832, 5832, 5832, 5832, 5832, 5796, 5796, 5796, 5796, 1224, 1224, 1212, 1204, 1204, 1204, 1196, 1188, 1188, 13800, 13800, 13800, 13800, 13800, 13800, 13800, 13800, 13800, 0, 0, 0, 0, 0
    .short 5796, 5796, 5796, 5796, 5760, 5760, 5760, 5760, 5760, 1188, 1188, 1176, 1168, 1168, 1168, 1160, 1152, 1152, 13800, 13800, 13800, 13800, 13800, 13800, 13800, 13800, 13800, 0, 0, 0, 0, 0
    .short 5760, 5760, 5760, 5760, 5760, 5724, 5724, 5724, 5724, 1152, 1144, 1140, 1136, 1132, 1128, 1124, 1120, 1116, 13800, 13800, 13800, 13800, 13800, 13800, 13800, 13800, 13800, 0, 0, 0, 0, 0
    .short 5724, 5724, 5724, 5724, 5688, 5688, 5688, 5688, 5688, 1116, 1108, 1104, 1100, 1096, 1092, 1088, 1084, 1080, 13800, 13800, 13800, 13800, 13800, 13800, 13800, 13800, 13800, 0, 0, 0, 0, 0
    .short 5688, 5688, 5688, 5688, 5688, 5652, 5652, 5652, 5652, 1080, 1072, 1068, 1064, 1060, 1056, 1052, 1048, 1044, 13800, 13800, 13800, 13800, 13800, 13800, 13800, 13800, 13800, 0, 0, 0, 0, 0
    .short 5652, 5652, 5652, 5652, 5616, 5616, 5616, 5616, 5616, 1044, 1036, 1032, 1028, 1024, 1020, 1016, 1012, 1008, 13800, 13800, 13800, 13800, 13800, 13800, 13800, 13800, 13800, 0, 0, 0, 0, 0
    .short 5616, 5616, 5616, 5616, 5616, 5580, 5580, 5580, 5580, 1008, 1000, 996, 992, 988, 984, 980, 976, 972, 13800, 13800, 13800, 13800, 13800, 13800, 13800, 13800, 13800, 0, 0, 0, 0, 0
    .short 5580, 5580, 5580, 5580, 5544, 5544, 5544, 5544, 5544, 972, 964, 960, 956, 952, 948, 944, 940, 936, 13800, 13800, 13800, 13800, 13800, 13800, 13800, 13800, 13800, 0, 0, 0, 0, 0
    .short 5544, 5544, 5544, 5544, 5544, 5508, 5508, 5508, 5508, 936, 928, 924, 920, 916, 912, 908, 904, 900, 13800, 13800, 13800, 13800, 13800, 13800, 13800, 13800, 13800, 0, 0, 0, 0, 0
    .short 5508, 5508, 5508, 5508, 5472, 5472, 5472, 5472, 5472, 900, 892, 888, 884, 880, 876, 872, 868, 864, 13800, 13800, 13800, 13800, 13800, 13800, 13800, 13800, 13800, 0, 0, 0, 0, 0
    .short 5472, 5472, 5472, 5472, 5472, 5436, 5436, 5436, 5436, 864, 856, 852, 848, 844, 840, 836, 832, 828, 13800, 13800, 13800, 13800, 13800, 13800, 13800, 13800, 13800, 0, 0, 0, 0, 0
    .short 5436, 5436, 5436, 5436, 5400, 5400, 5400, 5400, 5400, 828, 820, 816, 812, 808, 804, 800, 796, 792, 13800, 13800, 13800, 13800, 13800, 13800, 13800, 13800, 13800, 0, 0, 0, 0, 0
    .short 5400, 5400, 5400, 5400, 5400, 5364, 5364, 5364, 5364, 792, 784, 780, 776, 772, 768, 764, 760, 756, 13800, 13800, 13800, 13800, 13800, 13800, 13800, 13800, 13800, 0, 0, 0, 0, 0
    .short 5364, 5364, 5364, 5364, 5328, 5328, 5328, 5328, 5328, 756, 748, 744, 740, 736, 732, 728, 724, 720, 13800, 13800, 13800, 13800, 13800, 13800, 13800, 13800, 13800, 0, 0, 0, 0, 0
    .short 5328, 5328, 5328, 5328, 5328, 5292, 5292, 5292, 5292, 720, 712, 708, 704, 700, 696, 692, 688, 684, 13800, 13800, 13800, 13800, 13800, 13800, 13800, 13800, 13800, 0, 0, 0, 0, 0
    .short 5292, 5292, 5292, 5292, 5256, 5256, 5256, 5256, 5256, 684, 676, 672, 668, 664, 660, 656, 652, 648, 13800, 13800, 13800, 13800, 13800, 13800, 13800, 13800, 13800, 0, 0, 0, 0, 0
    .short 5256, 5256, 5256, 5256, 5256, 5220, 5220, 5220, 5220, 648, 640, 636, 632, 628, 624, 620, 616, 612, 13800, 13800, 13800, 13800, 13800, 13800, 13800, 13800, 13800, 0, 0, 0, 0, 0
    .short 5220, 5220, 5220, 5220, 5184, 5184, 5184, 5184, 5184, 612, 604, 600, 596, 592, 588, 584, 580, 576, 13800, 13800, 13800, 13800, 13800, 13800, 13800, 13800, 13800, 0, 0, 0, 0, 0
.size kgen_tab, 8192
text_end:
.section .rodata,"a"
.p2align 6
.amdhsa_kernel att1_kernel
  .amdhsa_next_free_vgpr 168
  .amdhsa_next_free_sgpr 64
  .amdhsa_accum_offset 168
  .amdhsa_group_segment_fixed_size 0
  .amdhsa_kernarg_size 120
  .amdhsa_user_sgpr_count 2
  .amdhsa_user_sgpr_kernarg_segment_ptr 1
  .amdhsa_system_sgpr_workgroup_id_x 1
.end_amdhsa_kernel
.amdhsa_kernel att2_kernel
  .amdhsa_next_free_vgpr 168
  .amdhsa_next_free_sgpr 64
  .amdhsa_accum_offset 168
  .amdhsa_group_segment_fixed_size 0
  .amdhsa_kernarg_size 120
  .amdhsa_user_sgpr_count 2
  .amdhsa_user_sgpr_kernarg_segment_ptr 1
  .amdhsa_system_sgpr_workgroup_id_x 1
.end_amdhsa_kernel
.amdhsa_kernel conv1_kernel
  .amdhsa_next_free_vgpr 248
  .amdhsa_next_free_sgpr 56
  .amdhsa_accum_offset 112
  .amdhsa_group_segment_fixed_size 0
  .amdhsa_kernarg_size 120
  .amdhsa_user_sgpr_count 2
  .amdhsa_user_sgpr_kernarg_segment_ptr 1
  .amdhsa_system_sgpr_workgroup_id_x 1
.end_amdhsa_kernel
.amdhsa_kernel conv2_kernel
  .amdhsa_next_free_vgpr 248
  .amdhsa_next_free_sgpr 56
  .amdhsa_accum_offset 112
  .amdhsa_group_segment_fixed_size 0
  .amdhsa_kernarg_size 120
  .amdhsa_user_sgpr_count 2
  .amdhsa_user_sgpr_kernarg_segment_ptr 1
  .amdhsa_system_sgpr_workgroup_id_x 1
.end_amdhsa_kernel
```

```asm
; @launch kernel=main_kernel grid=(256,1,1) block=(768,1,1) lds=163840
.amdgcn_target "amdgcn-amd-amdhsa--gfx950"
.text
.globl main_kernel
.p2align 8
.type main_kernel,@function
main_kernel:
    s_cmp_ge_u32 s2, 256
    s_cbranch_scc1 k_exit
    s_load_dwordx4 s[68:71], s[0:1], 0
    s_load_dwordx4 s[64:67], s[0:1], 104
    s_load_dwordx2 s[72:73], s[0:1], 16
    s_load_dwordx2 s[74:75], s[0:1], 96
    s_load_dwordx16 s[80:95], s[0:1], 32
    v_lshrrev_b32 v2, 6, v0
    s_and_b32 s22, s2, 7
    s_lshr_b32 s23, s2, 3
    v_readfirstlane_b32 s27, v2
    s_lshl_b32 s24, s22, 2
    s_lshr_b32 s25, s23, 3
    s_add_u32 s24, s24, s25
    s_and_b32 s25, s23, 7
    s_lshl_b32 s24, s24, 6
    s_lshl_b32 s77, s22, 5
    s_add_u32 s77, s77, s23
    s_mov_b32 s52, 1
    s_mov_b32 s78, 0
    v_and_b32 v1, 63, v0
    v_and_b32 v12, 15, v0
    v_lshrrev_b32 v13, 4, v1
    v_lshlrev_b32 v5, 4, v1
    s_cmp_lt_u32 s27, 4
    s_nop 1
    s_cbranch_scc1 comp_start
    s_setprio 3
    s_sub_u32 s28, s27, 4
    s_lshr_b32 s38, s28, 2
    s_and_b32 s39, s28, 3
    v_lshrrev_b32 v6, 3, v1
    v_lshrrev_b32 v7, 4, v1
    s_and_b32 s29, s28, 1
    s_lshl_b32 s29, s29, 2
    v_xor_b32 v7, s29, v7
    v_and_b32 v2, 7, v1
    v_xor_b32 v2, v2, v7
    v_lshlrev_b32 v2, 4, v2
    s_lshl_b32 s29, s28, 3
    s_add_u32 s29, s29, s24
    s_sub_u32 s29, s29, 16
    v_add_u32 v3, s29, v6
    v_lshl_add_u32 v2, v3, 10, v2
    v_add_u32 v3, 0x10000, v2
    s_movk_i32 s26, 128
    s_movk_i32 s63, 128
    s_cmp_eq_u32 s28, 0
    s_cselect_b32 s40, 0xffffff00, -1
    v_lshrrev_b32 v4, 2, v6
    v_lshlrev_b32 v4, 3, v4
    v_and_b32 v7, 3, v6
    v_add_u32 v14, v4, v7
    s_lshr_b32 s29, s39, 1
    s_lshl_b32 s29, s29, 4
    s_and_b32 s33, s39, 1
    s_lshl_b32 s33, s33, 2
    s_add_u32 s29, s29, s33
    v_add_u32 v14, s29, v14
    s_lshl_b32 s33, s38, 5
    v_add_u32 v4, s33, v14
    v_mul_u32_u24 v4, 3072, v4
    v_bfe_u32 v7, v1, 1, 2
    v_xor_b32 v7, v7, v13
    v_lshlrev_b32 v7, 5, v7
    v_and_b32 v8, 1, v1
    v_lshl_add_u32 v7, v8, 4, v7
    s_lshl_b32 s29, s25, 7
    v_add3_u32 v4, v4, v7, s29
    s_mov_b32 s30, 0
    s_mov_b32 s62, 0
    s_mov_b32 s31, 0
    s_mov_b32 s32, 0
    s_mul_i32 s50, s28, 3072
    s_add_u32 s50, s50, 10240
    s_lshl_b32 s51, s28, 10
    s_mov_b32 s41, -1
    s_waitcnt lgkmcnt(0)
    s_mov_b32 s4, s68
    s_mov_b32 s5, s69
    s_mov_b32 s6, 0x00200000
    s_mov_b32 s7, 0x00020000
    s_mov_b32 s8, s70
    s_mov_b32 s9, s71
    s_mov_b32 s10, 0x00180000
    s_mov_b32 s11, 0x00020000
    s_add_u32 m0, s30, s51
    s_mov_b64 exec, s[40:41]
    buffer_load_dwordx4 v2, s[4:7], s31 offen sc1 lds
    s_mov_b64 exec, -1
    s_cmp_lt_u32 s28, 2
    s_cbranch_scc0 ld_nx_1
    s_add_u32 m0, m0, 8192
    s_nop 0
    buffer_load_dwordx4 v3, s[4:7], s62 offen sc1 lds
    s_add_u32 s62, s62, s63
ld_nx_1:
    s_add_u32 m0, s30, s50
    s_add_u32 s31, s31, s26
    buffer_load_dwordx4 v4, s[8:11], s32 offen lds
    buffer_load_dwordx4 v4, s[8:11], s32 offen offset:1024 lds
    buffer_load_dwordx4 v4, s[8:11], s32 offen offset:2048 lds
    s_add_u32 s32, s32, 196608
    s_add_u32 s30, s30, 34816
    s_cmp_ge_u32 s30, 104448
    s_cselect_b32 s30, 0, s30
    s_add_u32 m0, s30, s51
    s_mov_b64 exec, s[40:41]
    buffer_load_dwordx4 v2, s[4:7], s31 offen sc1 lds
    s_mov_b64 exec, -1
    s_cmp_lt_u32 s28, 2
    s_cbranch_scc0 ld_nx_2
    s_add_u32 m0, m0, 8192
    s_nop 0
    buffer_load_dwordx4 v3, s[4:7], s62 offen sc1 lds
    s_add_u32 s62, s62, s63
ld_nx_2:
    s_add_u32 m0, s30, s50
    s_add_u32 s31, s31, s26
    buffer_load_dwordx4 v4, s[8:11], s32 offen lds
    buffer_load_dwordx4 v4, s[8:11], s32 offen offset:1024 lds
    buffer_load_dwordx4 v4, s[8:11], s32 offen offset:2048 lds
    s_add_u32 s32, s32, 196608
    s_add_u32 s30, s30, 34816
    s_cmp_ge_u32 s30, 104448
    s_cselect_b32 s30, 0, s30
    s_mov_b32 s12, s72
    s_mov_b32 s13, s73
    s_mov_b32 s14, 0x00080000
    s_mov_b32 s15, 0x00020000
    s_mov_b32 s16, s66
    s_mov_b32 s17, s67
    s_mov_b32 s18, 0x01400000
    s_mov_b32 s19, 0x00020000
    v_lshl_add_u32 v14, v14, 10, v7
    s_and_b32 s33, s25, 3
    s_lshl_b32 s33, s33, 8
    s_lshl_b32 s29, s38, 7
    s_add_u32 s33, s33, s29
    v_add_u32 v14, s33, v14
    s_max_u32 s29, s28, 3
    s_sub_u32 s29, s29, 3
    v_lshrrev_b32 v10, 3, v12
    v_lshlrev_b32 v10, 10, v10
    v_and_b32 v9, 7, v12
    v_lshl_add_u32 v10, v9, 7, v10
    v_lshrrev_b32 v9, 1, v12
    v_xor_b32 v9, v9, v13
    v_lshl_add_u32 v10, v9, 4, v10
    s_lshl_b32 s33, s29, 11
    v_add_u32 v8, s33, v10
    s_cmp_eq_u32 s28, 3
    s_cselect_b32 s44, 1, 0
    s_lshl_b32 s60, s39, 11
    s_lshl_b32 s33, s38, 10
    s_add_u32 s60, s60, s33
    s_add_u32 s60, s60, 106496
    s_mov_b32 s61, 0
    s_mov_b32 s36, 0
    v_mov_b32 v24, 0x3f803f80
    v_mov_b32 v25, 0x3f803f80
    v_mov_b32 v26, 0x3f803f80
    v_mov_b32 v27, 0x3f803f80
    v_mov_b32 v28, 0x3f803f80
    v_mov_b32 v29, 0x3f803f80
    v_mov_b32 v30, 0x3f803f80
    v_mov_b32 v31, 0x3f803f80
    v_mov_b32 v40, 0
    v_mov_b32 v41, 0
    v_mov_b32 v42, 0
    v_mov_b32 v43, 0
    v_mov_b32 v44, 0
    v_mov_b32 v45, 0
    v_mov_b32 v46, 0
    v_mov_b32 v47, 0
    v_mov_b32 v16, 0x3f803f80
    v_mov_b32 v17, 0x3f803f80
    v_mov_b32 v18, 0x3f803f80
    v_mov_b32 v19, 0x3f803f80
    s_min_u32 s33, s39, 2
    s_mul_i32 s33, s33, 34816
    v_add_u32 v6, s33, v5
    s_mov_b64 exec, 0xff
    ds_write_b128 v6, v[16:19]
    s_mov_b64 exec, -1
    s_cmp_eq_u32 s28, 0
    s_cbranch_scc0 ld_nozf_3
    v_mov_b32 v6, 0
    v_and_b32 v7, 7, v1
    v_lshlrev_b32 v7, 2, v7
    v_add_u32 v7, 106368, v7
    ds_write_b32 v7, v6
ld_nozf_3:
ld_main:
    s_mov_b32 s34, 0
ld_loop:
    s_waitcnt vmcnt(5) lgkmcnt(0)
    s_cmp_lt_u32 s28, 2
    s_cbranch_scc1 ld_w5
    s_waitcnt vmcnt(4)
ld_w5:
    s_barrier
    s_cmp_lt_u32 s28, 3
    s_cbranch_scc1 ld_nx_4_r
    v_add_u32 v6, s36, v8
    s_cmp_eq_u32 s52, 2
    s_cbranch_scc1 ld_nx_4_t
    v_add_u32 v7, s36, v10
    ds_read_b128 v[16:19], v6
    ds_read_b128 v[24:27], v7
    v_xor_b32 v6, 64, v6
    v_xor_b32 v7, 64, v7
    ds_read_b128 v[20:23], v6
    ds_read_b128 v[28:31], v7
    s_branch ld_nx_4_u
ld_nx_4_t:
    v_add_u32 v7, s36, v11
    ds_read_b64_tr_b16 v[16:17], v6
    ds_read_b64_tr_b16 v[18:19], v7
    v_add_u32 v6, s45, v6
    v_add_u32 v7, s45, v7
    ds_read_b64_tr_b16 v[20:21], v6
    ds_read_b64_tr_b16 v[22:23], v7
ld_nx_4_u:
    s_add_u32 s36, s36, 34816
    s_cmp_ge_u32 s36, 104448
    s_cselect_b32 s36, 0, s36
ld_nx_4_r:
    s_add_u32 m0, s30, s51
    s_mov_b64 exec, s[40:41]
    buffer_load_dwordx4 v2, s[4:7], s31 offen sc1 lds
    s_mov_b64 exec, -1
    s_cmp_lt_u32 s28, 2
    s_cbranch_scc0 ld_nx_4
    s_add_u32 m0, m0, 8192
    s_nop 0
    buffer_load_dwordx4 v3, s[4:7], s62 offen sc1 lds
    s_add_u32 s62, s62, s63
ld_nx_4:
    s_add_u32 m0, s30, s50
    s_add_u32 s31, s31, s26
    buffer_load_dwordx4 v4, s[8:11], s32 offen lds
    s_cmp_lt_u32 s28, 3
    s_cbranch_scc1 ld_nx_4_a
    s_waitcnt lgkmcnt(0)
    v_mfma_f32_16x16x32_bf16 v[40:43], v[16:19], v[16:19], v[40:43]
    v_mfma_f32_16x16x32_bf16 v[40:43], v[20:23], v[20:23], v[40:43]
    s_cmp_eq_u32 s44, 1
    s_cbranch_scc1 ld_nx_4_a
    v_mfma_f32_16x16x32_bf16 v[44:47], v[16:19], v[24:27], v[44:47]
    v_mfma_f32_16x16x32_bf16 v[44:47], v[20:23], v[28:31], v[44:47]
ld_nx_4_a:
    buffer_load_dwordx4 v4, s[8:11], s32 offen offset:1024 lds
    buffer_load_dwordx4 v4, s[8:11], s32 offen offset:2048 lds
    s_add_u32 s32, s32, 196608
    s_add_u32 s30, s30, 34816
    s_cmp_ge_u32 s30, 104448
    s_cselect_b32 s30, 0, s30
    s_add_u32 s34, s34, 1
    s_cmp_lt_u32 s34, 6
    s_cbranch_scc1 ld_loop
    s_waitcnt vmcnt(4)
    s_barrier
    s_cmp_lt_u32 s28, 3
    s_cbranch_scc1 ld_nx_5_r
    v_add_u32 v6, s36, v8
    s_cmp_eq_u32 s52, 2
    s_cbranch_scc1 ld_nx_5_t
    v_add_u32 v7, s36, v10
    ds_read_b128 v[16:19], v6
    ds_read_b128 v[24:27], v7
    v_xor_b32 v6, 64, v6
    v_xor_b32 v7, 64, v7
    ds_read_b128 v[20:23], v6
    ds_read_b128 v[28:31], v7
    s_branch ld_nx_5_u
ld_nx_5_t:
    v_add_u32 v7, s36, v11
    ds_read_b64_tr_b16 v[16:17], v6
    ds_read_b64_tr_b16 v[18:19], v7
    v_add_u32 v6, s45, v6
    v_add_u32 v7, s45, v7
    ds_read_b64_tr_b16 v[20:21], v6
    ds_read_b64_tr_b16 v[22:23], v7
ld_nx_5_u:
    s_add_u32 s36, s36, 34816
    s_cmp_ge_u32 s36, 104448
    s_cselect_b32 s36, 0, s36
ld_nx_5_r:
    s_mov_b32 m0, s60
    s_add_u32 s60, s60, 8192
    buffer_load_dwordx4 v14, s[12:15], s61 offen lds
    s_add_u32 s61, s61, 32768
    s_mov_b32 m0, s60
    s_add_u32 s60, s60, 8192
    buffer_load_dwordx4 v14, s[12:15], s61 offen lds
    s_add_u32 s61, s61, 32768
    s_mov_b32 m0, s60
    s_add_u32 s60, s60, 8192
    buffer_load_dwordx4 v14, s[12:15], s61 offen lds
    s_add_u32 s61, s61, 32768
    s_mov_b32 m0, s60
    s_add_u32 s60, s60, 8192
    buffer_load_dwordx4 v14, s[12:15], s61 offen lds
    s_add_u32 s61, s61, 32768
    s_cmp_lt_u32 s28, 3
    s_cbranch_scc1 ld_nx_5_a
    s_waitcnt lgkmcnt(0)
    v_mfma_f32_16x16x32_bf16 v[40:43], v[16:19], v[16:19], v[40:43]
    v_mfma_f32_16x16x32_bf16 v[40:43], v[20:23], v[20:23], v[40:43]
    s_cmp_eq_u32 s44, 1
    s_cbranch_scc1 ld_nx_5_a
    v_mfma_f32_16x16x32_bf16 v[44:47], v[16:19], v[24:27], v[44:47]
    v_mfma_f32_16x16x32_bf16 v[44:47], v[20:23], v[28:31], v[44:47]
ld_nx_5_a:
    s_waitcnt vmcnt(4)
    s_barrier
    s_cmp_lt_u32 s28, 3
    s_cbranch_scc1 ld_nx_6_r
    v_add_u32 v6, s36, v8
    s_cmp_eq_u32 s52, 2
    s_cbranch_scc1 ld_nx_6_t
    v_add_u32 v7, s36, v10
    ds_read_b128 v[16:19], v6
    ds_read_b128 v[24:27], v7
    v_xor_b32 v6, 64, v6
    v_xor_b32 v7, 64, v7
    ds_read_b128 v[20:23], v6
    ds_read_b128 v[28:31], v7
    s_branch ld_nx_6_u
ld_nx_6_t:
    v_add_u32 v7, s36, v11
    ds_read_b64_tr_b16 v[16:17], v6
    ds_read_b64_tr_b16 v[18:19], v7
    v_add_u32 v6, s45, v6
    v_add_u32 v7, s45, v7
    ds_read_b64_tr_b16 v[20:21], v6
    ds_read_b64_tr_b16 v[22:23], v7
ld_nx_6_u:
    s_add_u32 s36, s36, 34816
    s_cmp_ge_u32 s36, 104448
    s_cselect_b32 s36, 0, s36
ld_nx_6_r:
    s_mov_b32 m0, s60
    s_add_u32 s60, s60, 8192
    buffer_load_dwordx4 v14, s[12:15], s61 offen lds
    s_add_u32 s61, s61, 32768
    s_mov_b32 m0, s60
    s_add_u32 s60, s60, 8192
    buffer_load_dwordx4 v14, s[12:15], s61 offen lds
    s_add_u32 s61, s61, 32768
    s_mov_b32 m0, s60
    s_add_u32 s60, s60, 8192
    buffer_load_dwordx4 v14, s[12:15], s61 offen lds
    s_add_u32 s61, s61, 32768
    s_cmp_lt_u32 s28, 3
    s_cbranch_scc1 ld_nx_6_a
    s_waitcnt lgkmcnt(0)
    v_mfma_f32_16x16x32_bf16 v[40:43], v[16:19], v[16:19], v[40:43]
    v_mfma_f32_16x16x32_bf16 v[40:43], v[20:23], v[20:23], v[40:43]
    s_cmp_eq_u32 s44, 1
    s_cbranch_scc1 ld_nx_6_a
    v_mfma_f32_16x16x32_bf16 v[44:47], v[16:19], v[24:27], v[44:47]
    v_mfma_f32_16x16x32_bf16 v[44:47], v[20:23], v[28:31], v[44:47]
ld_nx_6_a:
    s_cmp_lt_u32 s28, 3
    s_cbranch_scc1 ld_fin
    s_sub_u32 s29, s28, 3
    s_lshl_b32 s33, s29, 7
    s_add_u32 s33, s33, 105728
    v_lshlrev_b32 v6, 2, v12
    v_add_u32 v6, s33, v6
    v_lshlrev_b32 v7, 4, v13
    v_add_u32 v7, s33, v7
    v_and_b32 v16, 1, v12
    v_cmp_eq_u32 vcc, 1, v16
    v_and_b32 v16, 2, v12
    s_cmp_eq_u32 s44, 1
    s_cselect_b64 s[46:47], -1, 0
    v_cmp_eq_u32 s[48:49], 2, v16
    s_nop 4
    v_cndmask_b32 v16, v40, v41, vcc
    v_cndmask_b32 v17, v42, v43, vcc
    v_cndmask_b32 v20, v44, v40, s[46:47]
    v_cndmask_b32 v21, v45, v41, s[46:47]
    v_cndmask_b32 v22, v46, v42, s[46:47]
    v_cndmask_b32 v23, v47, v43, s[46:47]
    v_cndmask_b32 v16, v16, v17, s[48:49]
    s_mov_b32 s42, 0x00f0000f
    s_mov_b32 s43, 0xf0000f00
    s_mov_b64 exec, s[42:43]
    ds_write_b32 v6, v16 offset:64
    s_mov_b32 s42, 0x00010001
    s_mov_b32 s43, 0x00010001
    s_mov_b64 exec, s[42:43]
    ds_write_b128 v7, v[20:23]
    s_mov_b64 exec, -1
    s_waitcnt lgkmcnt(0)
    ds_read2_b32 v[40:41], v6 offset0:0 offset1:16
    s_lshl_b32 s33, s78, 2
    s_add_u32 s33, s33, 106368
    v_mov_b32 v18, s33
    s_waitcnt lgkmcnt(0)
    v_cmp_u_f32 vcc, v41, v41
    v_mul_f32 v40, 0x3b000000, v40
    v_mul_f32 v41, 0x3b000000, v41
    s_cmp_eq_u32 s52, 2
    s_cselect_b64 exec, vcc, 0
    s_cbranch_execz ld_noflag
    ds_write_b32 v18, v18
ld_noflag:
    s_mov_b64 exec, -1
    v_fma_f32 v41, -v40, v40, v41
    v_max_f32 v41, 0, v41
    v_cvt_pk_bf16_f32 v40, v40, v41
    v_and_b32 v17, 0xffff0000, v40
    v_lshlrev_b32 v16, 16, v40
    v_add_f32 v17, 0x3727c5ac, v17
    v_cvt_pk_bf16_f32 v17, v17, v17
    v_lshlrev_b32 v17, 16, v17
    v_sqrt_f32 v17, v17
    s_nop 0
    v_cvt_pk_bf16_f32 v17, v17, v17
    v_lshlrev_b32 v17, 16, v17
    v_rcp_f32 v17, v17
    s_lshl_b32 s33, s29, 4
    v_add_u32 v6, s33, v12
    v_lshlrev_b32 v7, 2, v6
    v_lshlrev_b32 v6, 3, v6
    v_add_u32 v6, 104448, v6
    v_add_u32 v7, 105088, v7
    ds_write_b64 v6, v[16:17]
    ds_write2_b32 v7, v16, v17 offset0:0 offset1:80
    s_waitcnt lgkmcnt(0)
ld_fin:
    s_barrier
    s_setprio 0
    s_lshl_b32 s33, s78, 2
    s_add_u32 s33, s33, 106368
    v_mov_b32 v6, s33
    ds_read_b32 v6, v6
    s_mov_b32 s56, s64
    s_mov_b32 s57, s65
    s_mov_b32 s58, 0x00000100
    s_mov_b32 s59, 0x00020000
    s_lshr_b32 s35, s24, 3
    s_waitcnt lgkmcnt(0)
    v_readfirstlane_b32 s33, v6
    s_cmp_eq_u32 s33, 0
    s_cbranch_scc1 ld_go
    s_add_u32 s78, s78, 1
    s_cmp_lt_u32 s78, 8
    s_cbranch_scc0 ld_go0
    s_setprio 3
    s_mov_b32 s30, 0
    s_mov_b32 s62, 0
    s_mov_b32 s31, 0
    s_mov_b32 s32, 0
    s_waitcnt vmcnt(0)
    s_add_u32 m0, s30, s51
    s_mov_b64 exec, s[40:41]
    buffer_load_dwordx4 v2, s[4:7], s31 offen sc1 lds
    s_mov_b64 exec, -1
    s_cmp_lt_u32 s28, 2
    s_cbranch_scc0 ld_nx_7
    s_add_u32 m0, m0, 8192
    s_nop 0
    buffer_load_dwordx4 v3, s[4:7], s62 offen sc1 lds
    s_add_u32 s62, s62, s63
ld_nx_7:
    s_add_u32 m0, s30, s50
    s_add_u32 s31, s31, s26
    buffer_load_dwordx4 v4, s[8:11], s32 offen lds
    buffer_load_dwordx4 v4, s[8:11], s32 offen offset:1024 lds
    buffer_load_dwordx4 v4, s[8:11], s32 offen offset:2048 lds
    s_add_u32 s32, s32, 196608
    s_add_u32 s30, s30, 34816
    s_cmp_ge_u32 s30, 104448
    s_cselect_b32 s30, 0, s30
    s_add_u32 m0, s30, s51
    s_mov_b64 exec, s[40:41]
    buffer_load_dwordx4 v2, s[4:7], s31 offen sc1 lds
    s_mov_b64 exec, -1
    s_cmp_lt_u32 s28, 2
    s_cbranch_scc0 ld_nx_8
    s_add_u32 m0, m0, 8192
    s_nop 0
    buffer_load_dwordx4 v3, s[4:7], s62 offen sc1 lds
    s_add_u32 s62, s62, s63
ld_nx_8:
    s_add_u32 m0, s30, s50
    s_add_u32 s31, s31, s26
    buffer_load_dwordx4 v4, s[8:11], s32 offen lds
    buffer_load_dwordx4 v4, s[8:11], s32 offen offset:1024 lds
    buffer_load_dwordx4 v4, s[8:11], s32 offen offset:2048 lds
    s_add_u32 s32, s32, 196608
    s_add_u32 s30, s30, 34816
    s_cmp_ge_u32 s30, 104448
    s_cselect_b32 s30, 0, s30
    s_lshl_b32 s60, s39, 11
    s_lshl_b32 s33, s38, 10
    s_add_u32 s60, s60, s33
    s_add_u32 s60, s60, 106496
    s_mov_b32 s61, 0
    s_mov_b32 s36, 0
    v_mov_b32 v24, 0x3f803f80
    v_mov_b32 v25, 0x3f803f80
    v_mov_b32 v26, 0x3f803f80
    v_mov_b32 v27, 0x3f803f80
    v_mov_b32 v28, 0x3f803f80
    v_mov_b32 v29, 0x3f803f80
    v_mov_b32 v30, 0x3f803f80
    v_mov_b32 v31, 0x3f803f80
    v_mov_b32 v40, 0
    v_mov_b32 v41, 0
    v_mov_b32 v42, 0
    v_mov_b32 v43, 0
    v_mov_b32 v44, 0
    v_mov_b32 v45, 0
    v_mov_b32 v46, 0
    v_mov_b32 v47, 0
    s_nop 2
    s_branch ld_main
ld_go0:
    s_mov_b32 s78, 7
ld_go:
    s_sub_u32 s60, s60, 163840
ld_wo:
    s_mov_b32 m0, s60
    s_add_u32 s60, s60, 8192
    buffer_load_dwordx4 v14, s[12:15], s61 offen lds
    s_add_u32 s61, s61, 32768
    s_cmp_lt_u32 s61, 524288
    s_cbranch_scc1 ld_wo
    s_and_b32 s36, s25, 3
    s_lshr_b32 s37, s25, 2
    s_lshl_b32 s37, s37, 5
    s_add_u32 s37, s37, s24
    s_cmp_eq_u32 s52, 2
    s_cbranch_scc1 ld_resxt
    s_lshl_b32 s32, s36, 8
    s_and_b32 s33, s28, 1
    s_lshl_b32 s33, s33, 2
    v_xor_b32 v8, s33, v13
    v_bfe_u32 v9, v1, 1, 3
    v_xor_b32 v8, v8, v9
    v_lshlrev_b32 v8, 5, v8
    v_and_b32 v7, 1, v1
    v_lshl_add_u32 v8, v7, 4, v8
    v_lshl_add_u32 v8, v13, 10, v8
    s_lshl_b32 s33, s28, 2
    s_add_u32 s33, s33, s37
    s_lshl_b32 s33, s33, 10
    s_add_u32 s33, s33, s32
    buffer_load_dwordx4 v[32:35], v8, s[4:7], s33 offen
    s_lshr_b32 s20, s28, 2
    s_lshl_b32 s21, s77, 1
    s_add_u32 s21, s21, s20
    s_lshl_b32 s22, s21, 8
    s_and_b32 s23, s28, 1
    s_lshl_b32 s23, s23, 7
    s_add_u32 s22, s22, s23
    v_lshl_add_u32 v6, v1, 1, s22
    s_lshl_b32 s21, s21, 1
    v_mov_b32 v7, s21
    v_mov_b32 v48, 0
    v_mov_b32 v49, 0
    v_mov_b32 v50, 0
    v_mov_b32 v51, 0
    v_mov_b32 v52, 0
    v_mov_b32 v53, 0
    v_mov_b32 v54, 0
    global_load_short_d16_hi v54, v7, s[92:93]
    global_load_short_d16_hi v48, v6, s[80:81]
    global_load_short_d16_hi v49, v6, s[82:83]
    global_load_short_d16_hi v50, v6, s[84:85]
    global_load_short_d16_hi v51, v6, s[86:87]
    global_load_short_d16_hi v52, v6, s[88:89]
    global_load_short_d16_hi v53, v6, s[90:91]
    s_getpc_b64 s[22:23]
kg_pc:
    s_add_u32 s22, s22, kgen_tab-kg_pc
    s_addc_u32 s23, s23, 0
    s_lshl_b32 s33, s39, 6
    v_add_u32 v6, s33, v1
    v_lshlrev_b32 v6, 5, v6
    v_lshl_add_u32 v7, v13, 4, s33
    v_add_u32 v7, 0x2000, v7
    global_load_dwordx4 v[56:59], v6, s[22:23]
    global_load_dword v55, v6, s[22:23] offset:16
    global_load_dwordx4 v[60:63], v7, s[22:23]
    v_mov_b32 v16, -1
    v_mov_b32 v17, -1
    v_mov_b32 v18, -1
    v_mov_b32 v19, -1
    s_lshl_b32 s33, s77, 13
    s_add_u32 s33, s33, s51
    s_add_u32 s33, s33, 8388608
    buffer_store_dwordx4 v[16:19], v5, s[16:19], s33 offen sc1
    s_lshl_b32 s33, s24, 10
    s_lshl_b32 s34, s25, 13
    s_add_u32 s33, s33, s34
    s_add_u32 s33, s33, s51
    s_add_u32 s33, s33, 2097152
    buffer_store_dwordx4 v[16:19], v5, s[16:19], s33 offen sc1
    v_lshrrev_b32 v6, 3, v1
    v_lshlrev_b32 v6, 13, v6
    v_and_b32 v7, 7, v1
    v_lshl_add_u32 v6, v7, 4, v6
    s_lshl_b32 s33, s36, 19
    s_lshl_b32 s34, s28, 16
    s_add_u32 s33, s33, s34
    s_lshl_b32 s34, s37, 2
    s_add_u32 s33, s33, s34
    s_add_u32 s33, s33, 6291456
    buffer_store_dwordx4 v[16:19], v6, s[16:19], s33 offen sc1
    s_cmp_lt_u32 s28, 2
    s_cbranch_scc0 ld_pf2
    v_lshrrev_b32 v6, 2, v1
    v_lshlrev_b32 v6, 14, v6
    v_and_b32 v7, 3, v1
    v_lshl_add_u32 v6, v7, 4, v6
    s_lshl_b32 s33, s28, 18
    s_lshl_b32 s34, s77, 6
    s_add_u32 s33, s33, s34
    s_add_u32 s33, s33, 10485760
    buffer_store_dwordx4 v[16:19], v6, s[16:19], s33 offen sc1
    s_branch ld_havres
ld_pf2:
    s_cmp_eq_u32 s28, 2
    s_cbranch_scc0 ld_havres
    s_lshl_b32 s33, s36, 14
    s_lshl_b32 s34, s37, 3
    s_add_u32 s33, s33, s34
    s_add_u32 s33, s33, 11599872
    s_mov_b64 exec, 0xffff
    buffer_store_dwordx4 v[16:19], v5, s[16:19], s33 offen sc1
    s_mov_b64 exec, -1
    s_branch ld_havres
ld_resxt:
    v_lshrrev_b32 v8, 2, v1
    v_lshlrev_b32 v8, 12, v8
    v_and_b32 v9, 3, v1
    v_lshl_add_u32 v8, v9, 4, v8
    s_lshl_b32 s33, s36, 19
    s_lshl_b32 s34, s28, 16
    s_add_u32 s33, s33, s34
    s_lshl_b32 s34, s37, 1
    s_add_u32 s33, s33, s34
    buffer_load_dwordx4 v[32:35], v8, s[4:7], s33 offen sc1
ld_havres:
    v_lshrrev_b32 v6, 3, v1
    v_and_b32 v2, 7, v1
    v_xor_b32 v2, v2, v13
    v_lshrrev_b32 v9, 1, v2
    v_and_b32 v2, 1, v2
    v_lshlrev_b32 v2, 4, v2
    v_lshl_add_u32 v2, v9, 11, v2
    v_lshl_add_u32 v2, v6, 5, v2
    v_xor_b32 v3, 0x1000, v2
    s_lshl_b32 s33, s24, 10
    s_sub_u32 s34, s37, s24
    s_lshl_b32 s34, s34, 5
    s_add_u32 s33, s33, s34
    s_lshl_b32 s34, s28, 13
    s_add_u32 s33, s33, s34
    s_sub_u32 s34, s52, 1
    s_lshl_b32 s34, s34, 21
    s_add_u32 s33, s33, s34
    s_lshl_b32 s34, s28, 12
    s_add_u32 s34, s34, 73728
    v_add_u32 v9, s34, v5
    s_add_u32 s34, s51, 106496
    v_add_u32 v10, s34, v5
    v_mov_b32 v6, 0
    s_mov_b32 s34, 0
ld_arr:
    buffer_load_dword v7, v6, s[56:59], s35 offen sc1
    s_add_u32 s34, s34, 1
    s_waitcnt vmcnt(0)
    v_lshrrev_b32 v8, 4, v7
    v_and_b32 v8, 0x0f0f0f0f, v8
    v_and_b32 v7, 0x0f0f0f0f, v7
    v_add_u32 v7, v7, v8
    v_lshrrev_b32 v8, 16, v7
    v_add_u32 v7, v7, v8
    v_lshrrev_b32 v8, 8, v7
    v_add_u32 v7, v7, v8
    v_and_b32 v7, 0xff, v7
    v_cmp_ne_u32 vcc, 8, v7
    s_cmp_gt_u32 s34, 32768
    s_cbranch_scc1 ld_arrd
    s_nop 3
    s_cbranch_vccnz ld_arr
ld_arrd:
    s_mov_b32 s34, 0
ld_poll:
    buffer_load_dwordx4 v[16:19], v2, s[16:19], s33 offen sc1
    s_add_u32 s34, s34, 1
    s_waitcnt vmcnt(0)
    v_cmp_eq_u32 vcc, -1, v16
    s_cmp_gt_u32 s34, 32768
    s_cbranch_scc1 ld_poll2
    s_nop 3
    s_cbranch_vccnz ld_poll
ld_poll2:
    buffer_load_dwordx4 v[20:23], v3, s[16:19], s33 offen offset:256 sc1
    buffer_load_dwordx4 v[24:27], v2, s[16:19], s33 offen offset:512 sc1
    buffer_load_dwordx4 v[28:31], v3, s[16:19], s33 offen offset:768 sc1
    s_add_u32 s34, s34, 1
    s_waitcnt vmcnt(0)
    v_cmp_eq_u32 vcc, -1, v20
    v_cmp_eq_u32 s[42:43], -1, v24
    v_cmp_eq_u32 s[46:47], -1, v28
    s_nop 1
    s_or_b64 vcc, vcc, s[42:43]
    s_or_b64 vcc, vcc, s[46:47]
    s_cmp_gt_u32 s34, 32768
    s_cbranch_scc1 ld_polld
    s_cbranch_vccnz ld_poll2
ld_polld:
    s_barrier
    ds_write_b128 v9, v[16:19] offset:0
    ds_write_b128 v9, v[20:23] offset:1024
    ds_write_b128 v9, v[24:27] offset:2048
    ds_write_b128 v9, v[28:31] offset:3072
    s_waitcnt lgkmcnt(0)
    s_barrier
    s_cmp_eq_u32 s52, 2
    s_cbranch_scc0 kg_tables
    s_barrier
    ds_write_b128 v10, v[32:35]
    v_mov_b32 v6, 0
    v_and_b32 v7, 7, v1
    v_lshlrev_b32 v7, 2, v7
    v_add_u32 v7, 126976, v7
    ds_write_b32 v7, v6
    s_waitcnt lgkmcnt(0)
    s_barrier
    s_branch cv_setup
kg_tables:
    s_mov_b32 s20, 0x3fb8aa3b
    s_mov_b32 s21, 0x32a57060
    s_mov_b32 s22, 0x3f317218
    v_mul_f32 v72, s20, v54
    v_fma_f32 v73, v54, s20, -v72
    v_fma_f32 v73, v54, s21, v73
    v_exp_f32 v72, v72
    v_mul_f32 v73, s22, v73
    v_fma_f32 v72, v72, v73, v72
    v_cvt_pk_bf16_f32 v72, v72, v72
    v_lshlrev_b32 v72, 16, v72
    v_mul_f32 v48, v72, v48
    v_mul_f32 v49, v72, v49
    v_mul_f32 v50, v72, v50
    v_mul_f32 v51, v72, v51
    v_mul_f32 v74, s20, v48
    v_mul_f32 v75, v52, v50
    v_mul_f32 v76, v52, v51
    v_mul_f32 v65, 0x3e22f983, v49
    v_fma_f32 v75, -v53, v51, v75
    v_fma_f32 v76, v53, v50, v76
    v_mov_b32 v68, v74
    v_mov_b32 v70, 0x02081cea
    v_max3_f32 v69, abs(v75), abs(v76), v70
    v_max_f32_dpp v68, v68, v68 row_ror:8 row_mask:0xf bank_mask:0xf
    s_nop 0
    v_max_f32_dpp v69, v69, v69 row_ror:8 row_mask:0xf bank_mask:0xf
    v_max_f32_dpp v68, v68, v68 row_ror:4 row_mask:0xf bank_mask:0xf
    s_nop 0
    v_max_f32_dpp v69, v69, v69 row_ror:4 row_mask:0xf bank_mask:0xf
    v_max_f32_dpp v68, v68, v68 row_ror:2 row_mask:0xf bank_mask:0xf
    s_nop 0
    v_max_f32_dpp v69, v69, v69 row_ror:2 row_mask:0xf bank_mask:0xf
    v_max_f32_dpp v68, v68, v68 row_ror:1 row_mask:0xf bank_mask:0xf
    s_nop 0
    v_max_f32_dpp v69, v69, v69 row_ror:1 row_mask:0xf bank_mask:0xf
    v_mov_b32 v70, v68
    v_mov_b32 v71, v69
    s_nop 0
    v_permlane16_swap_b32 v68, v70
    v_permlane16_swap_b32 v69, v71
    v_max_f32 v68, v68, v70
    v_max_f32 v69, v69, v71
    v_mov_b32 v70, v68
    v_mov_b32 v71, v69
    s_nop 0
    v_permlane32_swap_b32 v68, v70
    v_permlane32_swap_b32 v69, v71
    v_max_f32 v68, v68, v70
    v_max_f32 v69, v69, v71
    v_rcp_f32 v70, v69
    v_sub_f32 v64, v74, v68
    v_mul_f32 v66, v75, v70
    v_mul_f32 v67, v76, v70
    v_rcp_f32 v69, v70
    s_lshr_b32 s20, s28, 2
    s_mul_i32 s35, s20, 49152
    s_and_b32 s37, s28, 1
    v_mul_u32_u24 v9, 1088, v13
    v_bfe_u32 v6, v1, 2, 2
    v_mul_u32_u24 v6, 272, v6
    v_add_u32 v9, v9, v6
    v_and_b32 v6, 3, v1
    v_lshl_add_u32 v9, v6, 2, v9
    s_mul_i32 s33, s37, 4352
    s_add_u32 s33, s33, s35
    v_add_u32 v9, s33, v9
    s_cmp_lt_u32 s39, 2
    s_cbranch_scc0 kg_job1
    v_mul_f32 v84, 0x3f800000, v64
    v_mul_f32 v136, 0x3f800000, v65
    v_mul_f32 v85, 0x40000000, v64
    v_mul_f32 v138, 0x40000000, v65
    v_mul_f32 v86, 0x40800000, v64
    v_mul_f32 v140, 0x40800000, v65
    v_mul_f32 v87, 0x43000000, v64
    v_mul_f32 v142, 0x43000000, v65
    v_mul_f32 v88, 0x43800000, v64
    v_mul_f32 v144, 0x43800000, v65
    v_mul_f32 v89, 0x44000000, v64
    v_mul_f32 v146, 0x44000000, v65
    v_exp_f32 v84, v84
    v_fract_f32 v136, v136
    v_exp_f32 v85, v85
    v_fract_f32 v138, v138
    v_exp_f32 v86, v86
    v_fract_f32 v140, v140
    v_exp_f32 v87, v87
    v_fract_f32 v142, v142
    v_exp_f32 v88, v88
    v_fract_f32 v144, v144
    v_exp_f32 v89, v89
    v_fract_f32 v146, v146
    v_sin_f32 v137, v136
    v_cos_f32 v136, v136
    v_sin_f32 v139, v138
    v_cos_f32 v138, v138
    v_sin_f32 v141, v140
    v_cos_f32 v140, v140
    s_barrier
    ds_write_b128 v10, v[32:35]
    v_mov_b32 v6, 0
    v_and_b32 v7, 7, v1
    v_lshlrev_b32 v7, 2, v7
    v_add_u32 v7, 126976, v7
    ds_write_b32 v7, v6
    v_sin_f32 v143, v142
    v_cos_f32 v142, v142
    v_sin_f32 v145, v144
    v_cos_f32 v144, v144
    v_sin_f32 v147, v146
    v_cos_f32 v146, v146
    v_mul_f32 v137, v137, v84
    v_mul_f32 v136, v136, v84
    v_mul_f32 v139, v139, v85
    v_mul_f32 v138, v138, v85
    v_mul_f32 v141, v141, v86
    v_mul_f32 v140, v140, v86
    v_mul_f32 v143, v143, v87
    v_mul_f32 v142, v142, v87
    v_mul_f32 v145, v145, v88
    v_mul_f32 v144, v144, v88
    v_mul_f32 v147, v147, v89
    v_mul_f32 v146, v146, v89
    v_mov_b32 v104, 0x3c00
    v_cvt_pk_f16_f32 v105, v136, v137
    v_cvt_pk_f16_f32 v106, v138, v139
    v_cvt_pk_f16_f32 v107, v140, v141
    v_cvt_pk_f16_f32 v108, v142, v143
    v_cvt_pk_f16_f32 v109, v144, v145
    v_cvt_pk_f16_f32 v110, v146, v147
    v_mul_f32 v148, v136, v138
    v_mul_f32 v149, v136, v139
    v_mul_f32 v150, v136, v140
    v_mul_f32 v151, v136, v141
    v_mul_f32 v152, v138, v140
    v_mul_f32 v153, v138, v141
    v_mul_f32 v154, v142, v144
    v_mul_f32 v155, v142, v145
    v_mul_f32 v156, v146, v142
    v_mul_f32 v157, v146, v143
    v_mul_f32 v158, v146, v144
    v_mul_f32 v159, v146, v145
    v_fma_f32 v148, -v137, v139, v148
    v_fma_f32 v149, v137, v138, v149
    v_fma_f32 v150, -v137, v141, v150
    v_fma_f32 v151, v137, v140, v151
    v_fma_f32 v152, -v139, v141, v152
    v_fma_f32 v153, v139, v140, v153
    v_fma_f32 v154, -v143, v145, v154
    v_fma_f32 v155, v143, v144, v155
    v_fma_f32 v156, -v147, v143, v156
    v_fma_f32 v157, v147, v142, v157
    v_fma_f32 v158, -v147, v145, v158
    v_fma_f32 v159, v147, v144, v159
    v_cvt_pk_f16_f32 v111, v148, v149
    v_cvt_pk_f16_f32 v112, v150, v151
    v_cvt_pk_f16_f32 v113, v152, v153
    v_cvt_pk_f16_f32 v114, v154, v155
    v_cvt_pk_f16_f32 v115, v156, v157
    v_cvt_pk_f16_f32 v116, v158, v159
    v_mul_f32 v160, v148, v140
    v_mul_f32 v161, v148, v141
    v_mul_f32 v162, v146, v154
    v_mul_f32 v163, v146, v155
    v_mul_f32 v72, v142, v136
    v_mul_f32 v73, v142, v137
    v_mul_f32 v74, v142, v138
    v_mul_f32 v75, v142, v139
    v_mul_f32 v76, v142, v148
    v_mul_f32 v77, v142, v149
    v_mul_f32 v78, v142, v140
    v_mul_f32 v79, v142, v141
    v_fma_f32 v160, -v149, v141, v160
    v_fma_f32 v161, v149, v140, v161
    v_fma_f32 v162, -v147, v155, v162
    v_fma_f32 v163, v147, v154, v163
    v_fma_f32 v72, -v143, v137, v72
    v_fma_f32 v73, v143, v136, v73
    v_fma_f32 v74, -v143, v139, v74
    v_fma_f32 v75, v143, v138, v75
    v_fma_f32 v76, -v143, v149, v76
    v_fma_f32 v77, v143, v148, v77
    v_fma_f32 v78, -v143, v141, v78
    v_fma_f32 v79, v143, v140, v79
    v_cvt_pk_f16_f32 v117, v160, v161
    v_cvt_pk_f16_f32 v118, v162, v163
    v_cvt_pk_f16_f32 v119, v72, v73
    v_cvt_pk_f16_f32 v120, v74, v75
    v_cvt_pk_f16_f32 v121, v76, v77
    v_cvt_pk_f16_f32 v122, v78, v79
    v_mul_f32 v80, v142, v150
    v_mul_f32 v81, v142, v151
    v_mul_f32 v82, v142, v152
    v_mul_f32 v83, v142, v153
    v_mul_f32 v72, v142, v160
    v_mul_f32 v73, v142, v161
    v_mul_f32 v74, v144, v138
    v_mul_f32 v75, v144, v139
    v_mul_f32 v76, v144, v140
    v_mul_f32 v77, v144, v141
    v_mul_f32 v78, v144, v152
    v_mul_f32 v79, v144, v153
    v_fma_f32 v80, -v143, v151, v80
    v_fma_f32 v81, v143, v150, v81
    v_fma_f32 v82, -v143, v153, v82
    v_fma_f32 v83, v143, v152, v83
    v_fma_f32 v72, -v143, v161, v72
    v_fma_f32 v73, v143, v160, v73
    v_fma_f32 v74, -v145, v139, v74
    v_fma_f32 v75, v145, v138, v75
    v_fma_f32 v76, -v145, v141, v76
    v_fma_f32 v77, v145, v140, v77
    v_fma_f32 v78, -v145, v153, v78
    v_fma_f32 v79, v145, v152, v79
    v_cvt_pk_f16_f32 v123, v80, v81
    v_cvt_pk_f16_f32 v124, v82, v83
    v_cvt_pk_f16_f32 v125, v72, v73
    v_cvt_pk_f16_f32 v126, v74, v75
    v_cvt_pk_f16_f32 v127, v76, v77
    v_cvt_pk_f16_f32 v128, v78, v79
    v_mul_f32 v80, v154, v138
    v_mul_f32 v81, v154, v139
    v_mul_f32 v82, v154, v140
    v_mul_f32 v83, v154, v141
    v_mul_f32 v72, v154, v152
    v_mul_f32 v73, v154, v153
    v_mul_f32 v74, v146, v140
    v_mul_f32 v75, v146, v141
    v_mul_f32 v76, v156, v140
    v_mul_f32 v77, v156, v141
    v_mul_f32 v78, v158, v140
    v_mul_f32 v79, v158, v141
    v_fma_f32 v80, -v155, v139, v80
    v_fma_f32 v81, v155, v138, v81
    v_fma_f32 v82, -v155, v141, v82
    v_fma_f32 v83, v155, v140, v83
    v_fma_f32 v72, -v155, v153, v72
    v_fma_f32 v73, v155, v152, v73
    v_fma_f32 v74, -v147, v141, v74
    v_fma_f32 v75, v147, v140, v75
    v_fma_f32 v76, -v157, v141, v76
    v_fma_f32 v77, v157, v140, v77
    v_fma_f32 v78, -v159, v141, v78
    v_fma_f32 v79, v159, v140, v79
    v_cvt_pk_f16_f32 v129, v80, v81
    v_cvt_pk_f16_f32 v130, v82, v83
    v_cvt_pk_f16_f32 v131, v72, v73
    v_cvt_pk_f16_f32 v132, v74, v75
    v_cvt_pk_f16_f32 v133, v76, v77
    v_cvt_pk_f16_f32 v134, v78, v79
    v_mul_f32 v80, v162, v140
    v_mul_f32 v81, v162, v141
    v_fma_f32 v80, -v163, v141, v80
    v_fma_f32 v81, v163, v140, v81
    v_cvt_pk_f16_f32 v135, v80, v81
    s_waitcnt lgkmcnt(0)
    s_barrier
    ds_write_b32 v9, v104 offset:0
    ds_write_b32 v9, v105 offset:16
    ds_write_b32 v9, v106 offset:32
    ds_write_b32 v9, v107 offset:64
    ds_write_b32 v9, v108 offset:128
    ds_write_b32 v9, v109 offset:8704
    ds_write_b32 v9, v110 offset:8832
    ds_write_b32 v9, v111 offset:48
    ds_write_b32 v9, v112 offset:80
    ds_write_b32 v9, v113 offset:96
    ds_write_b32 v9, v114 offset:8768
    ds_write_b32 v9, v115 offset:8864
    ds_write_b32 v9, v116 offset:8896
    ds_write_b32 v9, v117 offset:112
    ds_write_b32 v9, v118 offset:8928
    ds_write_b32 v9, v119 offset:144
    ds_write_b32 v9, v120 offset:160
    ds_write_b32 v9, v121 offset:176
    ds_write_b32 v9, v122 offset:192
    ds_write_b32 v9, v123 offset:208
    ds_write_b32 v9, v124 offset:224
    ds_write_b32 v9, v125 offset:240
    ds_write_b32 v9, v126 offset:8720
    ds_write_b32 v9, v127 offset:8736
    ds_write_b32 v9, v128 offset:8752
    ds_write_b32 v9, v129 offset:8784
    ds_write_b32 v9, v130 offset:8800
    ds_write_b32 v9, v131 offset:8816
    ds_write_b32 v9, v132 offset:8848
    ds_write_b32 v9, v133 offset:8880
    ds_write_b32 v9, v134 offset:8912
    ds_write_b32 v9, v135 offset:8944
    s_branch kg_tabdone
kg_job1:
    v_mul_f32 v84, 0x41000000, v64
    v_mul_f32 v136, 0x41000000, v65
    v_mul_f32 v85, 0x41800000, v64
    v_mul_f32 v138, 0x41800000, v65
    v_mul_f32 v86, 0x42000000, v64
    v_mul_f32 v140, 0x42000000, v65
    v_mul_f32 v87, 0x42800000, v64
    v_mul_f32 v142, 0x42800000, v65
    v_mul_f32 v88, 0x43000000, v64
    v_mul_f32 v144, 0x43000000, v65
    v_mul_f32 v89, 0x43800000, v64
    v_mul_f32 v146, 0x43800000, v65
    v_mul_f32 v90, 0x44000000, v64
    v_mul_f32 v148, 0x44000000, v65
    v_mul_f32 v91, 0x44800000, v64
    v_mul_f32 v150, 0x44800000, v65
    v_exp_f32 v84, v84
    v_fract_f32 v136, v136
    v_exp_f32 v85, v85
    v_fract_f32 v138, v138
    v_exp_f32 v86, v86
    v_fract_f32 v140, v140
    v_exp_f32 v87, v87
    v_fract_f32 v142, v142
    v_exp_f32 v88, v88
    v_fract_f32 v144, v144
    v_exp_f32 v89, v89
    v_fract_f32 v146, v146
    v_exp_f32 v90, v90
    v_fract_f32 v148, v148
    s_barrier
    ds_write_b128 v10, v[32:35]
    v_mov_b32 v6, 0
    v_and_b32 v7, 7, v1
    v_lshlrev_b32 v7, 2, v7
    v_add_u32 v7, 126976, v7
    ds_write_b32 v7, v6
    v_exp_f32 v91, v91
    v_fract_f32 v150, v150
    v_sin_f32 v137, v136
    v_cos_f32 v136, v136
    v_sin_f32 v139, v138
    v_cos_f32 v138, v138
    v_sin_f32 v141, v140
    v_cos_f32 v140, v140
    v_sin_f32 v143, v142
    v_cos_f32 v142, v142
    v_sin_f32 v145, v144
    v_cos_f32 v144, v144
    v_sin_f32 v147, v146
    v_cos_f32 v146, v146
    v_sin_f32 v149, v148
    v_cos_f32 v148, v148
    v_sin_f32 v151, v150
    v_cos_f32 v150, v150
    v_mul_f32 v137, v137, v84
    v_mul_f32 v136, v136, v84
    v_mul_f32 v139, v139, v85
    v_mul_f32 v138, v138, v85
    v_mul_f32 v141, v141, v86
    v_mul_f32 v140, v140, v86
    v_mul_f32 v143, v143, v87
    v_mul_f32 v142, v142, v87
    v_mul_f32 v145, v145, v88
    v_mul_f32 v144, v144, v88
    v_mul_f32 v147, v147, v89
    v_mul_f32 v146, v146, v89
    v_mul_f32 v149, v149, v90
    v_mul_f32 v148, v148, v90
    v_mul_f32 v151, v151, v91
    v_mul_f32 v150, v150, v91
    v_cvt_pk_f16_f32 v104, v66, -v67
    v_cvt_pk_f16_f32 v105, v150, v151
    v_mul_f32 v72, v66, v136
    v_mul_f32 v73, v66, v137
    v_mul_f32 v152, v66, v138
    v_mul_f32 v153, v66, v139
    v_mul_f32 v154, v66, v140
    v_mul_f32 v155, v66, v141
    v_mul_f32 v156, v66, v142
    v_mul_f32 v157, v66, v143
    v_mul_f32 v74, v150, v144
    v_mul_f32 v75, v150, v145
    v_mul_f32 v158, v150, v146
    v_mul_f32 v159, v150, v147
    v_mul_f32 v160, v150, v148
    v_mul_f32 v161, v150, v149
    v_mul_f32 v76, v150, v150
    v_mul_f32 v77, v150, v151
    v_fma_f32 v72, -v67, v137, v72
    v_fma_f32 v73, v67, v136, v73
    v_fma_f32 v152, -v67, v139, v152
    v_fma_f32 v153, v67, v138, v153
    v_fma_f32 v154, -v67, v141, v154
    v_fma_f32 v155, v67, v140, v155
    v_fma_f32 v156, -v67, v143, v156
    v_fma_f32 v157, v67, v142, v157
    v_fma_f32 v74, -v151, v145, v74
    v_fma_f32 v75, v151, v144, v75
    v_fma_f32 v158, -v151, v147, v158
    v_fma_f32 v159, v151, v146, v159
    v_fma_f32 v160, -v151, v149, v160
    v_fma_f32 v161, v151, v148, v161
    v_fma_f32 v76, -v151, v151, v76
    v_fma_f32 v77, v151, v150, v77
    v_cvt_pk_f16_f32 v106, v72, -v73
    v_cvt_pk_f16_f32 v107, v152, -v153
    v_cvt_pk_f16_f32 v108, v154, -v155
    v_cvt_pk_f16_f32 v109, v156, -v157
    v_cvt_pk_f16_f32 v110, v74, v75
    v_cvt_pk_f16_f32 v111, v158, v159
    v_cvt_pk_f16_f32 v112, v160, v161
    v_cvt_pk_f16_f32 v113, v76, v77
    v_mul_f32 v78, v152, v136
    v_mul_f32 v79, v152, v137
    v_mul_f32 v80, v154, v136
    v_mul_f32 v81, v154, v137
    v_mul_f32 v162, v154, v138
    v_mul_f32 v163, v154, v139
    v_mul_f32 v82, v156, v136
    v_mul_f32 v83, v156, v137
    v_mul_f32 v164, v156, v138
    v_mul_f32 v165, v156, v139
    v_mul_f32 v166, v156, v140
    v_mul_f32 v167, v156, v141
    v_mul_f32 v72, v158, v144
    v_mul_f32 v73, v158, v145
    v_mul_f32 v74, v160, v144
    v_mul_f32 v75, v160, v145
    v_mul_f32 v92, v160, v146
    v_mul_f32 v93, v160, v147
    v_fma_f32 v78, -v153, v137, v78
    v_fma_f32 v79, v153, v136, v79
    v_fma_f32 v80, -v155, v137, v80
    v_fma_f32 v81, v155, v136, v81
    v_fma_f32 v162, -v155, v139, v162
    v_fma_f32 v163, v155, v138, v163
    v_fma_f32 v82, -v157, v137, v82
    v_fma_f32 v83, v157, v136, v83
    v_fma_f32 v164, -v157, v139, v164
    v_fma_f32 v165, v157, v138, v165
    v_fma_f32 v166, -v157, v141, v166
    v_fma_f32 v167, v157, v140, v167
    v_fma_f32 v72, -v159, v145, v72
    v_fma_f32 v73, v159, v144, v73
    v_fma_f32 v74, -v161, v145, v74
    v_fma_f32 v75, v161, v144, v75
    v_fma_f32 v92, -v161, v147, v92
    v_fma_f32 v93, v161, v146, v93
    v_cvt_pk_f16_f32 v114, v78, -v79
    v_cvt_pk_f16_f32 v115, v80, -v81
    v_cvt_pk_f16_f32 v116, v162, -v163
    v_cvt_pk_f16_f32 v117, v82, -v83
    v_cvt_pk_f16_f32 v118, v164, -v165
    v_cvt_pk_f16_f32 v119, v166, -v167
    v_cvt_pk_f16_f32 v120, v72, v73
    v_cvt_pk_f16_f32 v121, v74, v75
    v_cvt_pk_f16_f32 v122, v92, v93
    v_mul_f32 v76, v162, v136
    v_mul_f32 v77, v162, v137
    v_mul_f32 v78, v164, v136
    v_mul_f32 v79, v164, v137
    v_mul_f32 v80, v166, v136
    v_mul_f32 v81, v166, v137
    v_mul_f32 v94, v166, v138
    v_mul_f32 v95, v166, v139
    v_mul_f32 v82, v92, v144
    v_mul_f32 v83, v92, v145
    v_fma_f32 v76, -v163, v137, v76
    v_fma_f32 v77, v163, v136, v77
    v_fma_f32 v78, -v165, v137, v78
    v_fma_f32 v79, v165, v136, v79
    v_fma_f32 v80, -v167, v137, v80
    v_fma_f32 v81, v167, v136, v81
    v_fma_f32 v94, -v167, v139, v94
    v_fma_f32 v95, v167, v138, v95
    v_fma_f32 v82, -v93, v145, v82
    v_fma_f32 v83, v93, v144, v83
    v_cvt_pk_f16_f32 v123, v76, -v77
    v_cvt_pk_f16_f32 v124, v78, -v79
    v_cvt_pk_f16_f32 v125, v80, -v81
    v_cvt_pk_f16_f32 v126, v94, -v95
    v_cvt_pk_f16_f32 v127, v82, v83
    v_mul_f32 v72, v94, v136
    v_mul_f32 v73, v94, v137
    v_fma_f32 v72, -v95, v137, v72
    v_fma_f32 v73, v95, v136, v73
    v_cvt_pk_f16_f32 v128, v72, -v73
    s_waitcnt lgkmcnt(0)
    s_barrier
    ds_write_b32 v9, v104 offset:26112
    ds_write_b32 v9, v105 offset:17408
    ds_write_b32 v9, v106 offset:26128
    ds_write_b32 v9, v107 offset:26144
    ds_write_b32 v9, v108 offset:26176
    ds_write_b32 v9, v109 offset:26240
    ds_write_b32 v9, v110 offset:17424
    ds_write_b32 v9, v111 offset:17440
    ds_write_b32 v9, v112 offset:17472
    ds_write_b32 v9, v113 offset:17536
    ds_write_b32 v9, v114 offset:26160
    ds_write_b32 v9, v115 offset:26192
    ds_write_b32 v9, v116 offset:26208
    ds_write_b32 v9, v117 offset:26256
    ds_write_b32 v9, v118 offset:26272
    ds_write_b32 v9, v119 offset:26304
    ds_write_b32 v9, v120 offset:17456
    ds_write_b32 v9, v121 offset:17488
    ds_write_b32 v9, v122 offset:17504
    ds_write_b32 v9, v123 offset:26224
    ds_write_b32 v9, v124 offset:26288
    ds_write_b32 v9, v125 offset:26320
    ds_write_b32 v9, v126 offset:26336
    ds_write_b32 v9, v127 offset:17520
    ds_write_b32 v9, v128 offset:26352
    s_lshl_b32 s33, s37, 3
    s_add_u32 s33, s33, s35
    v_mov_b32 v6, s33
    ds_write_b64 v6, v[68:69] offset:48640
kg_tabdone:
    s_lshl_b32 s33, s20, 4
    s_add_u32 s33, s33, 126976
    v_mov_b32 v11, s33
    v_mov_b32 v8, 1
    s_add_u32 s21, s35, 34816
    s_add_u32 s33, s21, 13800
    v_mov_b32 v6, s33
    v_mov_b32 v16, 0
    v_mov_b32 v17, 0
    v_mov_b32 v18, 0
    v_mov_b32 v19, 0
    ds_write_b32 v6, v16
    s_mul_i32 s22, s20, 9216
    s_add_u32 s22, s22, 131072
    v_and_b32 v6, 1, v1
    v_lshl_add_u32 v6, v6, 4, s22
    ds_write_b128 v6, v[16:19] offset:4352
    ds_write_b128 v6, v[16:19] offset:8768
    v_mul_u32_u24 v9, 272, v13
    v_lshl_add_u32 v9, v12, 4, v9
    v_add_u32 v10, s35, v9
    s_mul_i32 s33, s39, 8704
    v_add_u32 v9, s33, v10
    v_mov_b32 v7, s35
    v_lshlrev_b32 v6, 3, v12
    v_add_u32 v60, v60, v6
    v_add_u32 v61, v61, v6
    v_add_u32 v62, v62, v6
    v_add_u32 v63, v63, v6
    v_cvt_f32_u32 v20, v60
    v_cvt_f32_u32 v21, v61
    v_cvt_f32_u32 v22, v62
    v_cvt_f32_u32 v23, v63
    v_lshrrev_b32 v24, 3, v60
    v_lshrrev_b32 v25, 3, v61
    v_lshrrev_b32 v26, 3, v62
    v_lshrrev_b32 v27, 3, v63
    v_add_u32 v60, v60, v24
    v_add_u32 v61, v61, v25
    v_add_u32 v62, v62, v26
    v_add_u32 v63, v63, v27
    v_lshl_add_u32 v60, v60, 2, s21
    v_lshl_add_u32 v61, v61, 2, s21
    v_lshl_add_u32 v62, v62, 2, s21
    v_lshl_add_u32 v63, v63, 2, s21
    v_add_u32_sdwa v64, v56, s21 dst_sel:DWORD dst_unused:UNUSED_PAD src0_sel:WORD_0 src1_sel:DWORD
    v_add_u32_sdwa v65, v56, s21 dst_sel:DWORD dst_unused:UNUSED_PAD src0_sel:WORD_1 src1_sel:DWORD
    v_add_u32_sdwa v66, v57, s21 dst_sel:DWORD dst_unused:UNUSED_PAD src0_sel:WORD_0 src1_sel:DWORD
    v_add_u32_sdwa v67, v57, s21 dst_sel:DWORD dst_unused:UNUSED_PAD src0_sel:WORD_1 src1_sel:DWORD
    v_add_u32_sdwa v68, v58, s21 dst_sel:DWORD dst_unused:UNUSED_PAD src0_sel:WORD_0 src1_sel:DWORD
    v_add_u32_sdwa v69, v58, s21 dst_sel:DWORD dst_unused:UNUSED_PAD src0_sel:WORD_1 src1_sel:DWORD
    v_add_u32_sdwa v70, v59, s21 dst_sel:DWORD dst_unused:UNUSED_PAD src0_sel:WORD_0 src1_sel:DWORD
    v_add_u32_sdwa v71, v59, s21 dst_sel:DWORD dst_unused:UNUSED_PAD src0_sel:WORD_1 src1_sel:DWORD
    v_add_u32_sdwa v72, v55, s21 dst_sel:DWORD dst_unused:UNUSED_PAD src0_sel:WORD_0 src1_sel:DWORD
    s_waitcnt lgkmcnt(0)
    s_mov_b64 exec, 1
    ds_add_u32 v11, v8 offset:0
    s_mov_b64 exec, -1
    s_mov_b32 s34, 0
kg_sy0:
    ds_read_b32 v6, v11 offset:0
    s_add_u32 s34, s34, 1
    s_waitcnt lgkmcnt(0)
    v_readfirstlane_b32 s33, v6
    s_cmp_gt_u32 s34, 32768
    s_cbranch_scc1 kg_sd0
    s_cmp_lt_u32 s33, 4
    s_cbranch_scc1 kg_sy0
kg_sd0:
    s_cmp_lt_u32 s39, 3
    s_cbranch_scc0 kg_fin
    ds_read_b128 v[16:19], v7 offset:48640
    ds_read_b128 v[104:107], v9 offset:0
    ds_read_b128 v[108:111], v10 offset:26112
    ds_read_b128 v[112:115], v9 offset:1088
    ds_read_b128 v[116:119], v10 offset:27200
    ds_read_b128 v[120:123], v9 offset:2176
    ds_read_b128 v[124:127], v10 offset:28288
    ds_read_b128 v[128:131], v9 offset:3264
    ds_read_b128 v[132:135], v10 offset:29376
    ds_read_b128 v[136:139], v9 offset:4352
    ds_read_b128 v[140:143], v10 offset:30464
    ds_read_b128 v[144:147], v9 offset:5440
    ds_read_b128 v[148:151], v10 offset:31552
    ds_read_b128 v[152:155], v9 offset:6528
    ds_read_b128 v[156:159], v10 offset:32640
    ds_read_b128 v[160:163], v9 offset:7616
    ds_read_b128 v[164:167], v10 offset:33728
    s_waitcnt lgkmcnt(15)
    v_mul_f32 v24, v20, v16
    v_mul_f32 v20, v20, v18
    v_mul_f32 v25, v21, v16
    v_mul_f32 v21, v21, v18
    v_mul_f32 v26, v22, v16
    v_mul_f32 v22, v22, v18
    v_mul_f32 v27, v23, v16
    v_mul_f32 v23, v23, v18
    s_waitcnt lgkmcnt(14)
    v_mfma_f32_16x16x32_f16 v[28:31], v[104:107], v[108:111], 0
    v_exp_f32 v24, v24
    v_exp_f32 v20, v20
    s_waitcnt lgkmcnt(12)
    v_mfma_f32_16x16x32_f16 v[28:31], v[112:115], v[116:119], v[28:31]
    v_exp_f32 v25, v25
    v_exp_f32 v21, v21
    s_waitcnt lgkmcnt(10)
    v_mfma_f32_16x16x32_f16 v[28:31], v[120:123], v[124:127], v[28:31]
    v_exp_f32 v26, v26
    v_exp_f32 v22, v22
    s_waitcnt lgkmcnt(8)
    v_mfma_f32_16x16x32_f16 v[28:31], v[128:131], v[132:135], v[28:31]
    v_exp_f32 v27, v27
    v_exp_f32 v23, v23
    s_waitcnt lgkmcnt(6)
    v_mfma_f32_16x16x32_f16 v[32:35], v[136:139], v[140:143], 0
    v_mul_f32 v24, v24, v17
    v_mul_f32 v20, v20, v19
    s_waitcnt lgkmcnt(4)
    v_mfma_f32_16x16x32_f16 v[32:35], v[144:147], v[148:151], v[32:35]
    v_mul_f32 v25, v25, v17
    v_mul_f32 v21, v21, v19
    s_waitcnt lgkmcnt(2)
    v_mfma_f32_16x16x32_f16 v[32:35], v[152:155], v[156:159], v[32:35]
    v_mul_f32 v26, v26, v17
    v_mul_f32 v22, v22, v19
    s_waitcnt lgkmcnt(0)
    v_mfma_f32_16x16x32_f16 v[32:35], v[160:163], v[164:167], v[32:35]
    v_mul_f32 v27, v27, v17
    v_mul_f32 v23, v23, v19
    v_mul_f32 v28, v28, v24
    v_mul_f32 v29, v29, v25
    v_mul_f32 v30, v30, v26
    v_mul_f32 v31, v31, v27
    s_nop 1
    v_fma_f32 v28, v32, v20, v28
    v_fma_f32 v29, v33, v21, v29
    v_fma_f32 v30, v34, v22, v30
    v_fma_f32 v31, v35, v23, v31
    ds_write_b32 v60, v28
    ds_write_b32 v61, v29
    ds_write_b32 v62, v30
    ds_write_b32 v63, v31
kg_fin:
    s_waitcnt lgkmcnt(0)
    s_mov_b64 exec, 1
    ds_add_u32 v11, v8 offset:4
    s_mov_b64 exec, -1
    s_mov_b32 s34, 0
kg_sy1:
    ds_read_b32 v6, v11 offset:4
    s_add_u32 s34, s34, 1
    s_waitcnt lgkmcnt(0)
    v_readfirstlane_b32 s33, v6
    s_cmp_gt_u32 s34, 32768
    s_cbranch_scc1 kg_sd1
    s_cmp_lt_u32 s33, 4
    s_cbranch_scc1 kg_sy1
kg_sd1:
    ds_read_b32 v64, v64
    ds_read_b32 v65, v65
    ds_read_b32 v66, v66
    ds_read_b32 v67, v67
    ds_read_b32 v68, v68
    ds_read_b32 v69, v69
    ds_read_b32 v70, v70
    ds_read_b32 v71, v71
    ds_read_b32 v72, v72
    s_lshl_b32 s33, s39, 10
    s_add_u32 s33, s33, s22
    v_add_u32 v9, s33, v5
    s_waitcnt lgkmcnt(0)
    v_cvt_pk_bf16_f32 v16, v64, v65
    v_cvt_pk_bf16_f32 v20, v65, v66
    v_cvt_pk_bf16_f32 v17, v66, v67
    v_cvt_pk_bf16_f32 v21, v67, v68
    v_cvt_pk_bf16_f32 v18, v68, v69
    v_cvt_pk_bf16_f32 v22, v69, v70
    v_cvt_pk_bf16_f32 v19, v70, v71
    v_cvt_pk_bf16_f32 v23, v71, v72
    ds_write_b128 v9, v[16:19] offset:256
    ds_write_b128 v9, v[20:23] offset:4672
    s_cmp_eq_u32 s39, 3
    s_cbranch_scc0 kg_not0
    s_mov_b32 exec_lo, 0
    s_mov_b32 exec_hi, 0x80000000
    ds_write_b16_d16_hi v9, v23 offset:272
    s_mov_b64 exec, -1
kg_not0:
    v_add_u32 v6, 1, v12
    v_lshrrev_b32 v6, 1, v6
    v_lshlrev_b32 v6, 2, v6
    v_lshlrev_b32 v7, 4, v13
    v_sub_u32 v6, v7, v6
    v_and_b32 v7, 1, v12
    v_mul_u32_u24 v7, 4416, v7
    s_lshl_b32 s33, s39, 6
    s_sub_u32 s33, s22, s33
    s_add_u32 s33, s33, 480
    v_add3_u32 v24, v6, v7, s33
    v_add_u32 v25, 1024, v24
    v_add_u32 v26, 2048, v24
    v_add_u32 v27, 3072, v24
    s_waitcnt lgkmcnt(0)
    s_mov_b64 exec, 1
    ds_add_u32 v11, v8 offset:8
    s_mov_b64 exec, -1
    s_mov_b32 s34, 0
kg_sy2:
    ds_read_b32 v6, v11 offset:8
    s_add_u32 s34, s34, 1
    s_waitcnt lgkmcnt(0)
    v_readfirstlane_b32 s33, v6
    s_cmp_gt_u32 s34, 32768
    s_cbranch_scc1 kg_sd2
    s_cmp_lt_u32 s33, 4
    s_cbranch_scc1 kg_sy2
kg_sd2:
    ds_read2_b32 v[104:105], v27 offset0:192 offset1:193
    ds_read2_b32 v[106:107], v27 offset0:194 offset1:195
    ds_read2_b32 v[108:109], v27 offset0:128 offset1:129
    ds_read2_b32 v[110:111], v27 offset0:130 offset1:131
    ds_read2_b32 v[112:113], v27 offset0:64 offset1:65
    ds_read2_b32 v[114:115], v27 offset0:66 offset1:67
    ds_read2_b32 v[116:117], v27 offset0:0 offset1:1
    ds_read2_b32 v[118:119], v27 offset0:2 offset1:3
    ds_read2_b32 v[120:121], v26 offset0:192 offset1:193
    ds_read2_b32 v[122:123], v26 offset0:194 offset1:195
    ds_read2_b32 v[124:125], v26 offset0:128 offset1:129
    ds_read2_b32 v[126:127], v26 offset0:130 offset1:131
    ds_read2_b32 v[128:129], v26 offset0:64 offset1:65
    ds_read2_b32 v[130:131], v26 offset0:66 offset1:67
    ds_read2_b32 v[132:133], v26 offset0:0 offset1:1
    ds_read2_b32 v[134:135], v26 offset0:2 offset1:3
    ds_read2_b32 v[136:137], v25 offset0:192 offset1:193
    ds_read2_b32 v[138:139], v25 offset0:194 offset1:195
    ds_read2_b32 v[140:141], v25 offset0:128 offset1:129
    ds_read2_b32 v[142:143], v25 offset0:130 offset1:131
    ds_read2_b32 v[144:145], v25 offset0:64 offset1:65
    ds_read2_b32 v[146:147], v25 offset0:66 offset1:67
    ds_read2_b32 v[148:149], v25 offset0:0 offset1:1
    ds_read2_b32 v[150:151], v25 offset0:2 offset1:3
    ds_read2_b32 v[152:153], v24 offset0:192 offset1:193
    ds_read2_b32 v[154:155], v24 offset0:194 offset1:195
    ds_read2_b32 v[156:157], v24 offset0:128 offset1:129
    ds_read2_b32 v[158:159], v24 offset0:130 offset1:131
    ds_read2_b32 v[160:161], v24 offset0:64 offset1:65
    ds_read2_b32 v[162:163], v24 offset0:66 offset1:67
    ds_read2_b32 v[164:165], v24 offset0:0 offset1:1
    ds_read2_b32 v[166:167], v24 offset0:2 offset1:3
    v_lshrrev_b32 v6, 3, v1
    s_lshl_b32 s29, s28, 3
    v_add_u32 v7, s29, v6
    v_and_b32 v2, 0x33, v7
    v_bfe_u32 v8, v7, 2, 1
    v_lshl_add_u32 v2, v8, 3, v2
    v_bfe_u32 v8, v7, 3, 1
    v_lshl_add_u32 v2, v8, 2, v2
    v_lshlrev_b32 v2, 12, v2
    v_bfe_u32 v7, v1, 1, 2
    v_xor_b32 v7, v7, v13
    v_lshl_add_u32 v2, v7, 5, v2
    v_and_b32 v8, 1, v1
    v_lshl_add_u32 v2, v8, 4, v2
    s_lshl_b32 s33, s24, 1
    v_add_u32 v2, s33, v2
    v_and_b32 v7, 7, v1
    v_add_u32 v7, s29, v7
    v_and_b32 v0, 0x33, v7
    v_bfe_u32 v9, v7, 2, 1
    v_lshl_add_u32 v0, v9, 3, v0
    v_bfe_u32 v9, v7, 3, 1
    v_lshl_add_u32 v0, v9, 2, v0
    v_lshlrev_b32 v0, 12, v0
    v_lshl_add_u32 v0, v6, 18, v0
    s_add_u32 s33, s33, 124
    v_add_u32 v0, s33, v0
    s_lshl_b32 s29, s28, 5
    v_lshrrev_b32 v7, 1, v1
    v_add_u32 v7, s29, v7
    v_and_b32 v3, 0x33, v7
    v_bfe_u32 v9, v7, 2, 1
    v_lshl_add_u32 v3, v9, 3, v3
    v_bfe_u32 v9, v7, 3, 1
    v_lshl_add_u32 v3, v9, 2, v3
    v_lshlrev_b32 v3, 5, v3
    v_lshl_add_u32 v3, v8, 4, v3
    s_lshl_b32 s29, s24, 8
    s_add_u32 s29, s29, 2080768
    s_cmp_eq_u32 s24, 0
    s_cselect_b32 s29, 0x7f000000, s29
    v_add_u32 v3, s29, v3
    s_mov_b32 s63, 0x800
    s_mov_b32 s26, 0x40000
    s_mov_b32 s40, -1
    s_mov_b32 s44, 0
    s_add_u32 s4, s66, 0x00800000
    s_addc_u32 s5, s67, 0
    s_mov_b32 s6, 0x00280000
    s_mov_b32 s7, 0x00020000
    s_max_u32 s29, s28, 3
    s_sub_u32 s29, s29, 3
    v_lshrrev_b32 v10, 5, v1
    v_lshlrev_b32 v10, 4, v10
    v_bfe_u32 v9, v1, 2, 3
    v_add_u32 v10, v10, v9
    v_and_b32 v9, 3, v1
    v_lshlrev_b32 v9, 3, v9
    v_lshl_add_u32 v11, v10, 5, v9
    v_add_u32 v11, 0x2000, v11
    v_lshl_add_u32 v10, v10, 7, v9
    v_bfe_u32 v9, v1, 3, 2
    s_sub_u32 s33, s29, 1
    v_xor_b32 v9, s33, v9
    v_and_b32 v9, 3, v9
    v_lshl_add_u32 v10, v9, 5, v10
    s_cmp_eq_u32 s29, 0
    s_cselect_b64 s[46:47], -1, 0
    v_cndmask_b32 v8, v10, v11, s[46:47]
    s_cselect_b32 s45, 4, 16
    s_lshl_b32 s45, s45, 6
    v_add_u32 v11, s45, v8
    s_lshl_b32 s45, s45, 2
cv_setup:
    s_lshr_b32 s20, s28, 2
    v_lshlrev_b32 v9, 5, v12
    v_lshl_add_u32 v9, v13, 4, v9
    s_mul_i32 s33, s20, 5120
    s_lshl_b32 s34, s39, 6
    s_sub_u32 s34, s33, s34
    s_add_u32 s34, s34, 150240
    v_add_u32 v9, s34, v9
    v_mul_u32_u24 v10, 320, v13
    v_lshl_add_u32 v10, v12, 4, v10
    s_mul_i32 s34, s28, 5120
    s_add_u32 s34, s34, 69632
    v_add_u32 v10, s34, v10
    s_cmp_eq_u32 s39, 0
    s_cbranch_scc0 cv_nozero
    v_mov_b32 v16, 0
    v_mov_b32 v17, 0
    v_mov_b32 v18, 0
    v_mov_b32 v19, 0
    s_add_u32 s33, s33, 149504
    v_add_u32 v6, s33, v5
    ds_write_b128 v6, v[16:19]
cv_nozero:
    s_waitcnt lgkmcnt(0)
    s_barrier
    ds_read_b128 v[40:43], v9 offset:0
    ds_read_b128 v[44:47], v9 offset:256
    ds_read_b128 v[48:51], v9 offset:512
    ds_read_b128 v[52:55], v9 offset:768
    s_cmp_eq_u32 s52, 1
    s_cbranch_scc0 cv_nopre
    s_add_u32 m0, s50, 0
    s_mov_b32 s32, 0
    buffer_load_dwordx4 v4, s[8:11], s32 offen offset:0 lds
    buffer_load_dwordx4 v4, s[8:11], s32 offen offset:1024 lds
    buffer_load_dwordx4 v4, s[8:11], s32 offen offset:2048 lds
    s_add_u32 m0, s50, 34816
    s_mov_b32 s32, 196608
    buffer_load_dwordx4 v4, s[8:11], s32 offen offset:0 lds
    buffer_load_dwordx4 v4, s[8:11], s32 offen offset:1024 lds
    buffer_load_dwordx4 v4, s[8:11], s32 offen offset:2048 lds
cv_nopre:
    s_waitcnt lgkmcnt(3)
    v_mfma_f32_16x16x32_bf16 v[16:19], v[108:111], v[40:43], 0
    v_mfma_f32_16x16x32_bf16 v[20:23], v[116:119], v[40:43], 0
    s_waitcnt lgkmcnt(2)
    v_mfma_f32_16x16x32_bf16 v[16:19], v[104:107], v[44:47], v[16:19]
    v_mfma_f32_16x16x32_bf16 v[20:23], v[112:115], v[44:47], v[20:23]
    s_waitcnt lgkmcnt(1)
    v_mfma_f32_16x16x32_bf16 v[20:23], v[108:111], v[48:51], v[20:23]
    s_waitcnt lgkmcnt(0)
    v_mfma_f32_16x16x32_bf16 v[20:23], v[104:107], v[52:55], v[20:23]
    v_mfma_f32_16x16x32_bf16 v[24:27], v[124:127], v[40:43], 0
    v_mfma_f32_16x16x32_bf16 v[24:27], v[120:123], v[44:47], v[24:27]
    s_nop 0
    ds_write_b128 v10, v[16:19] offset:0
    v_mfma_f32_16x16x32_bf16 v[24:27], v[116:119], v[48:51], v[24:27]
    s_nop 2
    ds_write_b128 v10, v[20:23] offset:1280
    v_mfma_f32_16x16x32_bf16 v[24:27], v[112:115], v[52:55], v[24:27]
    s_waitcnt lgkmcnt(0)
    s_barrier
    ds_read_b128 v[56:59], v9 offset:1024
    ds_read_b128 v[60:63], v9 offset:1280
    ds_read_b128 v[64:67], v9 offset:1536
    ds_read_b128 v[68:71], v9 offset:1792
    v_mfma_f32_16x16x32_bf16 v[28:31], v[132:135], v[40:43], 0
    v_mfma_f32_16x16x32_bf16 v[28:31], v[128:131], v[44:47], v[28:31]
    v_mfma_f32_16x16x32_bf16 v[28:31], v[124:127], v[48:51], v[28:31]
    v_mfma_f32_16x16x32_bf16 v[28:31], v[120:123], v[52:55], v[28:31]
    s_waitcnt lgkmcnt(3)
    v_mfma_f32_16x16x32_bf16 v[24:27], v[108:111], v[56:59], v[24:27]
    v_mfma_f32_16x16x32_bf16 v[28:31], v[116:119], v[56:59], v[28:31]
    s_waitcnt lgkmcnt(2)
    v_mfma_f32_16x16x32_bf16 v[24:27], v[104:107], v[60:63], v[24:27]
    v_mfma_f32_16x16x32_bf16 v[28:31], v[112:115], v[60:63], v[28:31]
    s_waitcnt lgkmcnt(1)
    v_mfma_f32_16x16x32_bf16 v[28:31], v[108:111], v[64:67], v[28:31]
    s_waitcnt lgkmcnt(0)
    v_mfma_f32_16x16x32_bf16 v[28:31], v[104:107], v[68:71], v[28:31]
    v_mfma_f32_16x16x32_bf16 v[16:19], v[140:143], v[40:43], 0
    v_mfma_f32_16x16x32_bf16 v[16:19], v[136:139], v[44:47], v[16:19]
    s_nop 0
    ds_write_b128 v10, v[24:27] offset:2560
    v_mfma_f32_16x16x32_bf16 v[16:19], v[132:135], v[48:51], v[16:19]
    s_nop 2
    ds_write_b128 v10, v[28:31] offset:3840
    v_mfma_f32_16x16x32_bf16 v[16:19], v[128:131], v[52:55], v[16:19]
    v_mfma_f32_16x16x32_bf16 v[16:19], v[124:127], v[56:59], v[16:19]
    v_mfma_f32_16x16x32_bf16 v[16:19], v[120:123], v[60:63], v[16:19]
    v_mfma_f32_16x16x32_bf16 v[16:19], v[116:119], v[64:67], v[16:19]
    v_mfma_f32_16x16x32_bf16 v[16:19], v[112:115], v[68:71], v[16:19]
    s_waitcnt lgkmcnt(0)
    s_barrier
    ds_read_b128 v[72:75], v9 offset:2048
    ds_read_b128 v[76:79], v9 offset:2304
    ds_read_b128 v[80:83], v9 offset:2560
    ds_read_b128 v[84:87], v9 offset:2816
    v_mfma_f32_16x16x32_bf16 v[20:23], v[148:151], v[40:43], 0
    v_mfma_f32_16x16x32_bf16 v[20:23], v[144:147], v[44:47], v[20:23]
    v_mfma_f32_16x16x32_bf16 v[20:23], v[140:143], v[48:51], v[20:23]
    v_mfma_f32_16x16x32_bf16 v[20:23], v[136:139], v[52:55], v[20:23]
    v_mfma_f32_16x16x32_bf16 v[20:23], v[132:135], v[56:59], v[20:23]
    v_mfma_f32_16x16x32_bf16 v[20:23], v[128:131], v[60:63], v[20:23]
    v_mfma_f32_16x16x32_bf16 v[20:23], v[124:127], v[64:67], v[20:23]
    v_mfma_f32_16x16x32_bf16 v[20:23], v[120:123], v[68:71], v[20:23]
    s_waitcnt lgkmcnt(3)
    v_mfma_f32_16x16x32_bf16 v[16:19], v[108:111], v[72:75], v[16:19]
    v_mfma_f32_16x16x32_bf16 v[20:23], v[116:119], v[72:75], v[20:23]
    s_waitcnt lgkmcnt(2)
    v_mfma_f32_16x16x32_bf16 v[16:19], v[104:107], v[76:79], v[16:19]
    v_mfma_f32_16x16x32_bf16 v[20:23], v[112:115], v[76:79], v[20:23]
    s_waitcnt lgkmcnt(1)
    v_mfma_f32_16x16x32_bf16 v[20:23], v[108:111], v[80:83], v[20:23]
    s_waitcnt lgkmcnt(0)
    v_mfma_f32_16x16x32_bf16 v[20:23], v[104:107], v[84:87], v[20:23]
    v_mfma_f32_16x16x32_bf16 v[24:27], v[156:159], v[40:43], 0
    v_mfma_f32_16x16x32_bf16 v[24:27], v[152:155], v[44:47], v[24:27]
    s_nop 0
    ds_write_b128 v10, v[16:19] offset:0
    v_mfma_f32_16x16x32_bf16 v[24:27], v[148:151], v[48:51], v[24:27]
    s_nop 2
    ds_write_b128 v10, v[20:23] offset:1280
    v_mfma_f32_16x16x32_bf16 v[24:27], v[144:147], v[52:55], v[24:27]
    v_mfma_f32_16x16x32_bf16 v[24:27], v[140:143], v[56:59], v[24:27]
    v_mfma_f32_16x16x32_bf16 v[24:27], v[136:139], v[60:63], v[24:27]
    v_mfma_f32_16x16x32_bf16 v[24:27], v[132:135], v[64:67], v[24:27]
    v_mfma_f32_16x16x32_bf16 v[24:27], v[128:131], v[68:71], v[24:27]
    v_mfma_f32_16x16x32_bf16 v[24:27], v[124:127], v[72:75], v[24:27]
    v_mfma_f32_16x16x32_bf16 v[24:27], v[120:123], v[76:79], v[24:27]
    v_mfma_f32_16x16x32_bf16 v[24:27], v[116:119], v[80:83], v[24:27]
    v_mfma_f32_16x16x32_bf16 v[24:27], v[112:115], v[84:87], v[24:27]
    s_waitcnt lgkmcnt(0)
    s_barrier
    ds_read_b128 v[88:91], v9 offset:3072
    ds_read_b128 v[92:95], v9 offset:3328
    ds_read_b128 v[96:99], v9 offset:3584
    ds_read_b128 v[100:103], v9 offset:3840
    v_mfma_f32_16x16x32_bf16 v[28:31], v[164:167], v[40:43], 0
    v_mfma_f32_16x16x32_bf16 v[28:31], v[160:163], v[44:47], v[28:31]
    v_mfma_f32_16x16x32_bf16 v[28:31], v[156:159], v[48:51], v[28:31]
    v_mfma_f32_16x16x32_bf16 v[28:31], v[152:155], v[52:55], v[28:31]
    v_mfma_f32_16x16x32_bf16 v[28:31], v[148:151], v[56:59], v[28:31]
    v_mfma_f32_16x16x32_bf16 v[28:31], v[144:147], v[60:63], v[28:31]
    v_mfma_f32_16x16x32_bf16 v[28:31], v[140:143], v[64:67], v[28:31]
    v_mfma_f32_16x16x32_bf16 v[28:31], v[136:139], v[68:71], v[28:31]
    v_mfma_f32_16x16x32_bf16 v[28:31], v[132:135], v[72:75], v[28:31]
    v_mfma_f32_16x16x32_bf16 v[28:31], v[128:131], v[76:79], v[28:31]
    v_mfma_f32_16x16x32_bf16 v[28:31], v[124:127], v[80:83], v[28:31]
    v_mfma_f32_16x16x32_bf16 v[28:31], v[120:123], v[84:87], v[28:31]
    s_waitcnt lgkmcnt(3)
    v_mfma_f32_16x16x32_bf16 v[24:27], v[108:111], v[88:91], v[24:27]
    v_mfma_f32_16x16x32_bf16 v[28:31], v[116:119], v[88:91], v[28:31]
    s_waitcnt lgkmcnt(2)
    v_mfma_f32_16x16x32_bf16 v[24:27], v[104:107], v[92:95], v[24:27]
    v_mfma_f32_16x16x32_bf16 v[28:31], v[112:115], v[92:95], v[28:31]
    s_waitcnt lgkmcnt(1)
    v_mfma_f32_16x16x32_bf16 v[28:31], v[108:111], v[96:99], v[28:31]
    s_waitcnt lgkmcnt(0)
    v_mfma_f32_16x16x32_bf16 v[28:31], v[104:107], v[100:103], v[28:31]
    s_nop 2
    ds_write_b128 v10, v[24:27] offset:2560
    s_nop 3
    ds_write_b128 v10, v[28:31] offset:3840
    s_waitcnt lgkmcnt(0)
    s_barrier
    s_cmp_eq_u32 s52, 2
    s_cbranch_scc0 ld_next
    s_endpgm
ld_next:
    s_setprio 3
    s_mov_b32 s52, 2
    s_mov_b32 s30, 0
    s_mov_b32 s31, 0
    s_mov_b32 s62, 0
    s_mov_b32 s34, 0
    s_mov_b64 exec, 0xffff
ld_pa:
    buffer_load_dword v6, v0, s[4:7], 0 offen sc1
    s_add_u32 s34, s34, 1
    s_waitcnt vmcnt(0)
    v_cmp_eq_u32 vcc, -1, v6
    s_cmp_gt_u32 s34, 32768
    s_cbranch_scc1 ld_pad
    s_nop 3
    s_cbranch_vccnz ld_pa
ld_pad:
    s_mov_b64 exec, -1
    s_add_u32 m0, s30, s51
    s_mov_b64 exec, s[40:41]
    buffer_load_dwordx4 v2, s[4:7], s31 offen sc1 lds
    s_mov_b64 exec, -1
    s_cmp_lt_u32 s28, 2
    s_cbranch_scc0 ld_x2_0
    s_add_u32 m0, m0, 8192
    s_nop 0
    buffer_load_dwordx4 v3, s[4:7], s62 offen sc1 lds
    s_add_u32 s62, s62, s63
ld_x2_0:
    s_add_u32 s31, s31, s26
    s_add_u32 s30, s30, 34816
    s_add_u32 m0, s30, s51
    s_mov_b64 exec, s[40:41]
    buffer_load_dwordx4 v2, s[4:7], s31 offen sc1 lds
    s_mov_b64 exec, -1
    s_cmp_lt_u32 s28, 2
    s_cbranch_scc0 ld_x2_1
    s_add_u32 m0, m0, 8192
    s_nop 0
    buffer_load_dwordx4 v3, s[4:7], s62 offen sc1 lds
    s_add_u32 s62, s62, s63
ld_x2_1:
    s_add_u32 s31, s31, s26
    s_add_u32 s30, s30, 34816
    s_mov_b32 s32, 393216
    s_lshl_b32 s60, s39, 11
    s_lshl_b32 s33, s38, 10
    s_add_u32 s60, s60, s33
    s_add_u32 s60, s60, 106496
    s_mov_b32 s61, 0
    s_mov_b32 s36, 0
    v_mov_b32 v24, 0x3f803f80
    v_mov_b32 v25, 0x3f803f80
    v_mov_b32 v26, 0x3f803f80
    v_mov_b32 v27, 0x3f803f80
    v_mov_b32 v28, 0x3f803f80
    v_mov_b32 v29, 0x3f803f80
    v_mov_b32 v30, 0x3f803f80
    v_mov_b32 v31, 0x3f803f80
    v_mov_b32 v40, 0
    v_mov_b32 v41, 0
    v_mov_b32 v42, 0
    v_mov_b32 v43, 0
    v_mov_b32 v44, 0
    v_mov_b32 v45, 0
    v_mov_b32 v46, 0
    v_mov_b32 v47, 0
    s_cmp_eq_u32 s28, 0
    s_cbranch_scc0 ld_nozf_9
    v_mov_b32 v6, 0
    v_and_b32 v7, 7, v1
    v_lshlrev_b32 v7, 2, v7
    v_add_u32 v7, 106368, v7
    ds_write_b32 v7, v6
ld_nozf_9:
ld_pb:
    buffer_load_dword v6, v0, s[4:7], 0 offen sc1
    s_add_u32 s34, s34, 1
    s_waitcnt vmcnt(0)
    v_cmp_eq_u32 vcc, -1, v6
    s_cmp_gt_u32 s34, 32768
    s_cbranch_scc1 ld_main
    s_nop 3
    s_cbranch_vccnz ld_pb
    s_branch ld_main
comp_start:
    v_mov_b32 v76, -1
    v_mov_b32 v77, -1
    v_mov_b32 v78, -1
    v_mov_b32 v79, -1
    v_lshrrev_b32 v2, 3, v0
    v_lshlrev_b32 v2, 13, v2
    v_and_b32 v3, 7, v0
    v_lshl_add_u32 v2, v3, 4, v2
    v_add_u32 v3, 0x40000, v2
    s_and_b32 s36, s25, 3
    s_lshr_b32 s37, s25, 2
    s_lshl_b32 s37, s37, 5
    s_add_u32 s37, s37, s24
    s_lshl_b32 s30, s24, 10
    s_lshl_b32 s31, s25, 13
    s_add_u32 s30, s30, s31
    s_lshl_b32 s31, s27, 11
    s_add_u32 s30, s30, s31
    s_lshl_b32 s31, s36, 19
    s_lshl_b32 s32, s37, 2
    s_add_u32 s31, s31, s32
    s_add_u32 s31, s31, 4194304
    s_lshl_b32 s32, s36, 14
    s_lshl_b32 s33, s37, 3
    s_add_u32 s32, s32, s33
    s_add_u32 s32, s32, 11534336
    s_lshl_b32 s33, s77, 2
    v_lshlrev_b32 v4, 7, v1
    s_waitcnt lgkmcnt(0)
    s_load_dword s76, s[94:95], s33
    s_mov_b32 s12, s66
    s_mov_b32 s13, s67
    s_mov_b32 s14, 0x01400000
    s_mov_b32 s15, 0x00020000
    s_mov_b32 s8, s64
    s_mov_b32 s9, s65
    s_mov_b32 s10, 0x00000100
    s_mov_b32 s11, 0x00020000
    s_mov_b32 s16, s70
    s_mov_b32 s17, s71
    s_mov_b32 s18, 0x00180000
    s_mov_b32 s19, 0x00020000
    s_lshl_b32 s33, s23, 13
    s_mul_i32 s34, s27, 0x80000
    s_add_u32 s33, s33, s34
    s_cmp_lt_u32 s27, 3
    s_cbranch_scc0 c_t3
    buffer_load_dword v150, v4, s[16:19], s33 offen
    s_add_u32 s33, s33, 0x40000
    buffer_load_dword v151, v4, s[16:19], s33 offen
    s_branch c_t4
c_t3:
    s_mov_b32 s16, s68
    s_mov_b32 s17, s69
    s_mov_b32 s18, 0x00200000
    s_mov_b32 s19, 0x00020000
    s_lshl_b32 s33, s22, 18
    s_lshl_b32 s34, s23, 13
    s_add_u32 s33, s33, s34
    buffer_load_dword v150, v4, s[16:19], s33 offen
    s_mov_b32 s16, s72
    s_mov_b32 s17, s73
    s_mov_b32 s18, 0x00080000
    s_mov_b32 s19, 0x00020000
    s_lshl_b32 s33, s23, 14
    buffer_load_dword v151, v4, s[16:19], s33 offen
    s_add_u32 s33, s33, 0x2000
    buffer_load_dword v152, v4, s[16:19], s33 offen
c_t4:
    s_cmp_lt_u32 s2, 16
    s_cbranch_scc0 c_t5
    s_getpc_b64 s[34:35]
c_pc:
    s_sub_u32 s34, s34, c_pc-main_kernel
    s_subb_u32 s35, s35, 0
    v_lshlrev_b32 v8, 7, v0
    v_add_u32 v9, 0, v0
    v_cmp_gt_u32 vcc, (text_end-main_kernel)>>7, v9
    s_and_saveexec_b64 s[38:39], vcc
    s_cbranch_execz c_nc0
    global_load_dword v153, v8, s[34:35]
c_nc0:
    s_mov_b64 exec, s[38:39]
    v_add_u32 v8, 0x8000, v8
    v_add_u32 v9, 256, v0
    v_cmp_gt_u32 vcc, (text_end-main_kernel)>>7, v9
    s_and_saveexec_b64 s[38:39], vcc
    s_cbranch_execz c_nc1
    global_load_dword v154, v8, s[34:35]
c_nc1:
    s_mov_b64 exec, s[38:39]
    v_add_u32 v8, 0x8000, v8
    v_add_u32 v9, 512, v0
    v_cmp_gt_u32 vcc, (text_end-main_kernel)>>7, v9
    s_and_saveexec_b64 s[38:39], vcc
    s_cbranch_execz c_nc2
    global_load_dword v155, v8, s[34:35]
c_nc2:
    s_mov_b64 exec, s[38:39]
    v_add_u32 v8, 0x8000, v8
c_t5:
    buffer_store_dwordx4 v[76:79], v5, s[12:15], s30 offen sc1
    buffer_store_dwordx4 v[76:79], v5, s[12:15], s30 offen offset:1024 sc1
    buffer_store_dwordx4 v[76:79], v2, s[12:15], s31 offen sc1
    buffer_store_dwordx4 v[76:79], v3, s[12:15], s31 offen sc1
    s_cmp_eq_u32 s27, 0
    s_cbranch_scc0 c_nost
    s_mov_b64 exec, 0xffff
    buffer_store_dwordx4 v[76:79], v5, s[12:15], s32 offen sc1
    s_mov_b64 exec, -1
c_nost:
    v_lshrrev_b32 v6, 5, v1
    v_mul_u32_u24 v6, 6144, v6
    v_bfe_u32 v8, v1, 2, 3
    v_lshl_add_u32 v6, v8, 7, v6
    v_bfe_u32 v8, v1, 3, 2
    v_xor_b32 v8, s27, v8
    v_lshl_add_u32 v6, v8, 5, v6
    v_and_b32 v8, 3, v1
    v_lshl_add_u32 v6, v8, 3, v6
    v_add_u32 v6, 10240, v6
    v_add_u32 v7, 69632, v6
    v_and_b32 v2, 1, v12
    v_lshl_add_u32 v3, v13, 2, v2
    v_cmp_eq_u32 s[42:43], 1, v2
    v_cmp_le_u32 s[44:45], v3, v12
    v_add_u32 v3, 2, v3
    v_cmp_le_u32 s[46:47], v3, v12
    s_cmp_eq_u32 s24, 0
    s_cselect_b64 s[48:49], -1, 0
    v_lshrrev_b32 v8, 3, v12
    v_lshlrev_b32 v8, 10, v8
    v_and_b32 v9, 7, v12
    v_lshl_add_u32 v8, v9, 7, v8
    v_lshrrev_b32 v9, 1, v12
    v_xor_b32 v9, v9, v13
    v_lshl_add_u32 v8, v9, 4, v8
    v_xor_b32 v9, 64, v8
    v_add_u32 v10, 69632, v8
    v_add_u32 v11, 69632, v9
    v_mov_b32 v2, 0x0c0c0100
    v_mov_b32 v3, 0x01000c0c
    v_mov_b32 v4, 0x0c0c0c0c
    v_cndmask_b32 v2, v2, v3, s[42:43]
    v_cndmask_b32 v140, v2, v4, s[44:45]
    v_cndmask_b32 v142, v4, v2, s[44:45]
    v_mov_b32 v2, 0x0c0c0302
    v_mov_b32 v3, 0x03020c0c
    v_cndmask_b32 v2, v2, v3, s[42:43]
    v_cndmask_b32 v141, v2, v4, s[46:47]
    v_cndmask_b32 v143, v4, v2, s[46:47]
    v_and_b32 v2, 1, v13
    v_lshl_add_u32 v144, v2, 4, v12
    v_lshlrev_b32 v144, 5, v144
    v_lshrrev_b32 v2, 1, v13
    v_lshl_add_u32 v144, v2, 4, v144
    v_lshlrev_b32 v145, 3, v12
    v_add_u32 v145, 104448, v145
    v_lshlrev_b32 v146, 4, v13
    v_add_u32 v146, 105088, v146
    s_getreg_b32 s33, hwreg(HW_REG_XCC_ID, 0, 3)
    s_lshl_b32 s54, s33, 2
    s_lshr_b32 s55, s24, 3
    s_nop 0
c_att_rm:
    s_barrier
    ds_read_b64_tr_b16 v[96:97], v6 offset:0
    ds_read_b64_tr_b16 v[98:99], v6 offset:3072
    ds_read_b64_tr_b16 v[100:101], v6 offset:1024
    ds_read_b64_tr_b16 v[102:103], v6 offset:4096
    ds_read_b64_tr_b16 v[104:105], v6 offset:2048
    ds_read_b64_tr_b16 v[106:107], v6 offset:5120
    ds_read_b128 v[76:79], v8 offset:0
    ds_read_b128 v[80:83], v8 offset:2048
    ds_read_b128 v[84:87], v8 offset:4096
    ds_read_b128 v[88:91], v8 offset:6144
    ds_read_b128 v[92:95], v8 offset:8192
    s_waitcnt lgkmcnt(0)
    v_mfma_f32_16x16x32_bf16 v[16:19], v[96:99], v[76:79], 0
    ds_read_b64_tr_b16 v[128:129], v6 offset:12288
    v_mfma_f32_16x16x32_bf16 v[20:23], v[100:103], v[76:79], 0
    ds_read_b64_tr_b16 v[130:131], v6 offset:15360
    v_mfma_f32_16x16x32_bf16 v[24:27], v[76:79], v[104:107], 0
    ds_read_b64_tr_b16 v[132:133], v6 offset:13312
    v_mfma_f32_16x16x32_bf16 v[28:31], v[96:99], v[80:83], 0
    ds_read_b64_tr_b16 v[134:135], v6 offset:16384
    v_mfma_f32_16x16x32_bf16 v[32:35], v[100:103], v[80:83], 0
    ds_read_b64_tr_b16 v[136:137], v6 offset:14336
    v_mfma_f32_16x16x32_bf16 v[36:39], v[80:83], v[104:107], 0
    ds_read_b64_tr_b16 v[138:139], v6 offset:17408
    v_mfma_f32_16x16x32_bf16 v[40:43], v[96:99], v[84:87], 0
    ds_read_b128 v[108:111], v9 offset:0
    v_mfma_f32_16x16x32_bf16 v[44:47], v[100:103], v[84:87], 0
    ds_read_b128 v[112:115], v9 offset:2048
    v_mfma_f32_16x16x32_bf16 v[48:51], v[84:87], v[104:107], 0
    ds_read_b128 v[116:119], v9 offset:4096
    v_mfma_f32_16x16x32_bf16 v[52:55], v[96:99], v[88:91], 0
    ds_read_b128 v[120:123], v9 offset:6144
    v_mfma_f32_16x16x32_bf16 v[56:59], v[100:103], v[88:91], 0
    ds_read_b128 v[124:127], v9 offset:8192
    v_mfma_f32_16x16x32_bf16 v[60:63], v[88:91], v[104:107], 0
    v_mfma_f32_16x16x32_bf16 v[64:67], v[96:99], v[92:95], 0
    v_mfma_f32_16x16x32_bf16 v[68:71], v[100:103], v[92:95], 0
    v_mfma_f32_16x16x32_bf16 v[72:75], v[92:95], v[104:107], 0
    s_waitcnt lgkmcnt(0)
    s_barrier
    v_mfma_f32_16x16x32_bf16 v[16:19], v[128:131], v[108:111], v[16:19]
    ds_read_b64_tr_b16 v[96:97], v6 offset:34816
    v_mfma_f32_16x16x32_bf16 v[20:23], v[132:135], v[108:111], v[20:23]
    ds_read_b64_tr_b16 v[98:99], v6 offset:37888
    v_mfma_f32_16x16x32_bf16 v[24:27], v[108:111], v[136:139], v[24:27]
    ds_read_b64_tr_b16 v[100:101], v6 offset:35840
    v_mfma_f32_16x16x32_bf16 v[28:31], v[128:131], v[112:115], v[28:31]
    ds_read_b64_tr_b16 v[102:103], v6 offset:38912
    v_mfma_f32_16x16x32_bf16 v[32:35], v[132:135], v[112:115], v[32:35]
    ds_read_b64_tr_b16 v[104:105], v6 offset:36864
    v_mfma_f32_16x16x32_bf16 v[36:39], v[112:115], v[136:139], v[36:39]
    ds_read_b64_tr_b16 v[106:107], v6 offset:39936
    v_mfma_f32_16x16x32_bf16 v[40:43], v[128:131], v[116:119], v[40:43]
    ds_read_b128 v[76:79], v8 offset:34816
    v_mfma_f32_16x16x32_bf16 v[44:47], v[132:135], v[116:119], v[44:47]
    ds_read_b128 v[80:83], v8 offset:36864
    v_mfma_f32_16x16x32_bf16 v[48:51], v[116:119], v[136:139], v[48:51]
    ds_read_b128 v[84:87], v8 offset:38912
    v_mfma_f32_16x16x32_bf16 v[52:55], v[128:131], v[120:123], v[52:55]
    ds_read_b128 v[88:91], v8 offset:40960
    v_mfma_f32_16x16x32_bf16 v[56:59], v[132:135], v[120:123], v[56:59]
    ds_read_b128 v[92:95], v8 offset:43008
    v_mfma_f32_16x16x32_bf16 v[60:63], v[120:123], v[136:139], v[60:63]
    v_mfma_f32_16x16x32_bf16 v[64:67], v[128:131], v[124:127], v[64:67]
    v_mfma_f32_16x16x32_bf16 v[68:71], v[132:135], v[124:127], v[68:71]
    v_mfma_f32_16x16x32_bf16 v[72:75], v[124:127], v[136:139], v[72:75]
    s_waitcnt lgkmcnt(0)
    v_mfma_f32_16x16x32_bf16 v[16:19], v[96:99], v[76:79], v[16:19]
    ds_read_b64_tr_b16 v[128:129], v6 offset:47104
    v_mfma_f32_16x16x32_bf16 v[20:23], v[100:103], v[76:79], v[20:23]
    ds_read_b64_tr_b16 v[130:131], v6 offset:50176
    v_mfma_f32_16x16x32_bf16 v[24:27], v[76:79], v[104:107], v[24:27]
    ds_read_b64_tr_b16 v[132:133], v6 offset:48128
    v_mfma_f32_16x16x32_bf16 v[28:31], v[96:99], v[80:83], v[28:31]
    ds_read_b64_tr_b16 v[134:135], v6 offset:51200
    v_mfma_f32_16x16x32_bf16 v[32:35], v[100:103], v[80:83], v[32:35]
    ds_read_b64_tr_b16 v[136:137], v6 offset:49152
    v_mfma_f32_16x16x32_bf16 v[36:39], v[80:83], v[104:107], v[36:39]
    ds_read_b64_tr_b16 v[138:139], v6 offset:52224
    v_mfma_f32_16x16x32_bf16 v[40:43], v[96:99], v[84:87], v[40:43]
    ds_read_b128 v[108:111], v9 offset:34816
    v_mfma_f32_16x16x32_bf16 v[44:47], v[100:103], v[84:87], v[44:47]
    ds_read_b128 v[112:115], v9 offset:36864
    v_mfma_f32_16x16x32_bf16 v[48:51], v[84:87], v[104:107], v[48:51]
    ds_read_b128 v[116:119], v9 offset:38912
    v_mfma_f32_16x16x32_bf16 v[52:55], v[96:99], v[88:91], v[52:55]
    ds_read_b128 v[120:123], v9 offset:40960
    v_mfma_f32_16x16x32_bf16 v[56:59], v[100:103], v[88:91], v[56:59]
    ds_read_b128 v[124:127], v9 offset:43008
    v_mfma_f32_16x16x32_bf16 v[60:63], v[88:91], v[104:107], v[60:63]
    v_mfma_f32_16x16x32_bf16 v[64:67], v[96:99], v[92:95], v[64:67]
    v_mfma_f32_16x16x32_bf16 v[68:71], v[100:103], v[92:95], v[68:71]
    v_mfma_f32_16x16x32_bf16 v[72:75], v[92:95], v[104:107], v[72:75]
    s_waitcnt lgkmcnt(0)
    s_barrier
    v_mfma_f32_16x16x32_bf16 v[16:19], v[128:131], v[108:111], v[16:19]
    ds_read_b64_tr_b16 v[96:97], v7 offset:0
    v_mfma_f32_16x16x32_bf16 v[20:23], v[132:135], v[108:111], v[20:23]
    ds_read_b64_tr_b16 v[98:99], v7 offset:3072
    v_mfma_f32_16x16x32_bf16 v[24:27], v[108:111], v[136:139], v[24:27]
    ds_read_b64_tr_b16 v[100:101], v7 offset:1024
    v_mfma_f32_16x16x32_bf16 v[28:31], v[128:131], v[112:115], v[28:31]
    ds_read_b64_tr_b16 v[102:103], v7 offset:4096
    v_mfma_f32_16x16x32_bf16 v[32:35], v[132:135], v[112:115], v[32:35]
    ds_read_b64_tr_b16 v[104:105], v7 offset:2048
    v_mfma_f32_16x16x32_bf16 v[36:39], v[112:115], v[136:139], v[36:39]
    ds_read_b64_tr_b16 v[106:107], v7 offset:5120
    v_mfma_f32_16x16x32_bf16 v[40:43], v[128:131], v[116:119], v[40:43]
    ds_read_b128 v[76:79], v10 offset:0
    v_mfma_f32_16x16x32_bf16 v[44:47], v[132:135], v[116:119], v[44:47]
    ds_read_b128 v[80:83], v10 offset:2048
    v_mfma_f32_16x16x32_bf16 v[48:51], v[116:119], v[136:139], v[48:51]
    ds_read_b128 v[84:87], v10 offset:4096
    v_mfma_f32_16x16x32_bf16 v[52:55], v[128:131], v[120:123], v[52:55]
    ds_read_b128 v[88:91], v10 offset:6144
    v_mfma_f32_16x16x32_bf16 v[56:59], v[132:135], v[120:123], v[56:59]
    ds_read_b128 v[92:95], v10 offset:8192
    v_mfma_f32_16x16x32_bf16 v[60:63], v[120:123], v[136:139], v[60:63]
    v_mfma_f32_16x16x32_bf16 v[64:67], v[128:131], v[124:127], v[64:67]
    v_mfma_f32_16x16x32_bf16 v[68:71], v[132:135], v[124:127], v[68:71]
    v_mfma_f32_16x16x32_bf16 v[72:75], v[124:127], v[136:139], v[72:75]
    s_waitcnt lgkmcnt(0)
    v_mfma_f32_16x16x32_bf16 v[16:19], v[96:99], v[76:79], v[16:19]
    ds_read_b64_tr_b16 v[128:129], v7 offset:12288
    v_mfma_f32_16x16x32_bf16 v[20:23], v[100:103], v[76:79], v[20:23]
    ds_read_b64_tr_b16 v[130:131], v7 offset:15360
    v_mfma_f32_16x16x32_bf16 v[24:27], v[76:79], v[104:107], v[24:27]
    ds_read_b64_tr_b16 v[132:133], v7 offset:13312
    v_mfma_f32_16x16x32_bf16 v[28:31], v[96:99], v[80:83], v[28:31]
    ds_read_b64_tr_b16 v[134:135], v7 offset:16384
    v_mfma_f32_16x16x32_bf16 v[32:35], v[100:103], v[80:83], v[32:35]
    ds_read_b64_tr_b16 v[136:137], v7 offset:14336
    v_mfma_f32_16x16x32_bf16 v[36:39], v[80:83], v[104:107], v[36:39]
    ds_read_b64_tr_b16 v[138:139], v7 offset:17408
    v_mfma_f32_16x16x32_bf16 v[40:43], v[96:99], v[84:87], v[40:43]
    ds_read_b128 v[108:111], v11 offset:0
    v_mfma_f32_16x16x32_bf16 v[44:47], v[100:103], v[84:87], v[44:47]
    ds_read_b128 v[112:115], v11 offset:2048
    v_mfma_f32_16x16x32_bf16 v[48:51], v[84:87], v[104:107], v[48:51]
    ds_read_b128 v[116:119], v11 offset:4096
    v_mfma_f32_16x16x32_bf16 v[52:55], v[96:99], v[88:91], v[52:55]
    ds_read_b128 v[120:123], v11 offset:6144
    v_mfma_f32_16x16x32_bf16 v[56:59], v[100:103], v[88:91], v[56:59]
    ds_read_b128 v[124:127], v11 offset:8192
    v_mfma_f32_16x16x32_bf16 v[60:63], v[88:91], v[104:107], v[60:63]
    v_mfma_f32_16x16x32_bf16 v[64:67], v[96:99], v[92:95], v[64:67]
    v_mfma_f32_16x16x32_bf16 v[68:71], v[100:103], v[92:95], v[68:71]
    v_mfma_f32_16x16x32_bf16 v[72:75], v[92:95], v[104:107], v[72:75]
    s_waitcnt lgkmcnt(0)
    s_barrier
    v_mfma_f32_16x16x32_bf16 v[16:19], v[128:131], v[108:111], v[16:19]
    ds_read_b64_tr_b16 v[96:97], v6 offset:0
    v_mfma_f32_16x16x32_bf16 v[20:23], v[132:135], v[108:111], v[20:23]
    ds_read_b64_tr_b16 v[98:99], v6 offset:3072
    v_mfma_f32_16x16x32_bf16 v[24:27], v[108:111], v[136:139], v[24:27]
    ds_read_b64_tr_b16 v[100:101], v6 offset:1024
    v_mfma_f32_16x16x32_bf16 v[28:31], v[128:131], v[112:115], v[28:31]
    ds_read_b64_tr_b16 v[102:103], v6 offset:4096
    v_mfma_f32_16x16x32_bf16 v[32:35], v[132:135], v[112:115], v[32:35]
    ds_read_b64_tr_b16 v[104:105], v6 offset:2048
    v_mfma_f32_16x16x32_bf16 v[36:39], v[112:115], v[136:139], v[36:39]
    ds_read_b64_tr_b16 v[106:107], v6 offset:5120
    v_mfma_f32_16x16x32_bf16 v[40:43], v[128:131], v[116:119], v[40:43]
    ds_read_b128 v[76:79], v8 offset:0
    v_mfma_f32_16x16x32_bf16 v[44:47], v[132:135], v[116:119], v[44:47]
    ds_read_b128 v[80:83], v8 offset:2048
    v_mfma_f32_16x16x32_bf16 v[48:51], v[116:119], v[136:139], v[48:51]
    ds_read_b128 v[84:87], v8 offset:4096
    v_mfma_f32_16x16x32_bf16 v[52:55], v[128:131], v[120:123], v[52:55]
    ds_read_b128 v[88:91], v8 offset:6144
    v_mfma_f32_16x16x32_bf16 v[56:59], v[132:135], v[120:123], v[56:59]
    ds_read_b128 v[92:95], v8 offset:8192
    v_mfma_f32_16x16x32_bf16 v[60:63], v[120:123], v[136:139], v[60:63]
    v_mfma_f32_16x16x32_bf16 v[64:67], v[128:131], v[124:127], v[64:67]
    v_mfma_f32_16x16x32_bf16 v[68:71], v[132:135], v[124:127], v[68:71]
    v_mfma_f32_16x16x32_bf16 v[72:75], v[124:127], v[136:139], v[72:75]
    s_waitcnt lgkmcnt(0)
    v_mfma_f32_16x16x32_bf16 v[16:19], v[96:99], v[76:79], v[16:19]
    ds_read_b64_tr_b16 v[128:129], v6 offset:12288
    v_mfma_f32_16x16x32_bf16 v[20:23], v[100:103], v[76:79], v[20:23]
    ds_read_b64_tr_b16 v[130:131], v6 offset:15360
    v_mfma_f32_16x16x32_bf16 v[24:27], v[76:79], v[104:107], v[24:27]
    ds_read_b64_tr_b16 v[132:133], v6 offset:13312
    v_mfma_f32_16x16x32_bf16 v[28:31], v[96:99], v[80:83], v[28:31]
    ds_read_b64_tr_b16 v[134:135], v6 offset:16384
    v_mfma_f32_16x16x32_bf16 v[32:35], v[100:103], v[80:83], v[32:35]
    ds_read_b64_tr_b16 v[136:137], v6 offset:14336
    v_mfma_f32_16x16x32_bf16 v[36:39], v[80:83], v[104:107], v[36:39]
    ds_read_b64_tr_b16 v[138:139], v6 offset:17408
    v_mfma_f32_16x16x32_bf16 v[40:43], v[96:99], v[84:87], v[40:43]
    ds_read_b128 v[108:111], v9 offset:0
    v_mfma_f32_16x16x32_bf16 v[44:47], v[100:103], v[84:87], v[44:47]
    ds_read_b128 v[112:115], v9 offset:2048
    v_mfma_f32_16x16x32_bf16 v[48:51], v[84:87], v[104:107], v[48:51]
    ds_read_b128 v[116:119], v9 offset:4096
    v_mfma_f32_16x16x32_bf16 v[52:55], v[96:99], v[88:91], v[52:55]
    ds_read_b128 v[120:123], v9 offset:6144
    v_mfma_f32_16x16x32_bf16 v[56:59], v[100:103], v[88:91], v[56:59]
    ds_read_b128 v[124:127], v9 offset:8192
    v_mfma_f32_16x16x32_bf16 v[60:63], v[88:91], v[104:107], v[60:63]
    v_mfma_f32_16x16x32_bf16 v[64:67], v[96:99], v[92:95], v[64:67]
    v_mfma_f32_16x16x32_bf16 v[68:71], v[100:103], v[92:95], v[68:71]
    v_mfma_f32_16x16x32_bf16 v[72:75], v[92:95], v[104:107], v[72:75]
    s_waitcnt lgkmcnt(0)
    s_waitcnt vmcnt(0)
    s_barrier
    s_cmp_eq_u32 s27, 0
    s_cbranch_scc0 c_noarr
    s_lshl_b32 s33, 1, s54
    v_mov_b32 v3, s33
    v_mov_b32 v2, 0
    s_mov_b64 exec, 1
    buffer_atomic_add v3, v2, s[8:11], s55 offen sc1
    s_mov_b64 exec, -1
c_noarr:
    v_mfma_f32_16x16x32_bf16 v[16:19], v[128:131], v[108:111], v[16:19]
    ds_read_b64_tr_b16 v[96:97], v6 offset:34816
    v_mfma_f32_16x16x32_bf16 v[20:23], v[132:135], v[108:111], v[20:23]
    ds_read_b64_tr_b16 v[98:99], v6 offset:37888
    v_mfma_f32_16x16x32_bf16 v[24:27], v[108:111], v[136:139], v[24:27]
    ds_read_b64_tr_b16 v[100:101], v6 offset:35840
    v_mfma_f32_16x16x32_bf16 v[28:31], v[128:131], v[112:115], v[28:31]
    ds_read_b64_tr_b16 v[102:103], v6 offset:38912
    v_mfma_f32_16x16x32_bf16 v[32:35], v[132:135], v[112:115], v[32:35]
    ds_read_b64_tr_b16 v[104:105], v6 offset:36864
    v_mfma_f32_16x16x32_bf16 v[36:39], v[112:115], v[136:139], v[36:39]
    ds_read_b64_tr_b16 v[106:107], v6 offset:39936
    v_mfma_f32_16x16x32_bf16 v[40:43], v[128:131], v[116:119], v[40:43]
    ds_read_b128 v[76:79], v8 offset:34816
    v_mfma_f32_16x16x32_bf16 v[44:47], v[132:135], v[116:119], v[44:47]
    ds_read_b128 v[80:83], v8 offset:36864
    v_mfma_f32_16x16x32_bf16 v[48:51], v[116:119], v[136:139], v[48:51]
    ds_read_b128 v[84:87], v8 offset:38912
    v_mfma_f32_16x16x32_bf16 v[52:55], v[128:131], v[120:123], v[52:55]
    ds_read_b128 v[88:91], v8 offset:40960
    v_mfma_f32_16x16x32_bf16 v[56:59], v[132:135], v[120:123], v[56:59]
    ds_read_b128 v[92:95], v8 offset:43008
    v_mfma_f32_16x16x32_bf16 v[60:63], v[120:123], v[136:139], v[60:63]
    v_mfma_f32_16x16x32_bf16 v[64:67], v[128:131], v[124:127], v[64:67]
    v_mfma_f32_16x16x32_bf16 v[68:71], v[132:135], v[124:127], v[68:71]
    v_mfma_f32_16x16x32_bf16 v[72:75], v[124:127], v[136:139], v[72:75]
    s_waitcnt lgkmcnt(0)
    v_mfma_f32_16x16x32_bf16 v[16:19], v[96:99], v[76:79], v[16:19]
    ds_read_b64_tr_b16 v[128:129], v6 offset:47104
    v_mfma_f32_16x16x32_bf16 v[20:23], v[100:103], v[76:79], v[20:23]
    ds_read_b64_tr_b16 v[130:131], v6 offset:50176
    v_mfma_f32_16x16x32_bf16 v[24:27], v[76:79], v[104:107], v[24:27]
    ds_read_b64_tr_b16 v[132:133], v6 offset:48128
    v_mfma_f32_16x16x32_bf16 v[28:31], v[96:99], v[80:83], v[28:31]
    ds_read_b64_tr_b16 v[134:135], v6 offset:51200
    v_mfma_f32_16x16x32_bf16 v[32:35], v[100:103], v[80:83], v[32:35]
    ds_read_b64_tr_b16 v[136:137], v6 offset:49152
    v_mfma_f32_16x16x32_bf16 v[36:39], v[80:83], v[104:107], v[36:39]
    ds_read_b64_tr_b16 v[138:139], v6 offset:52224
    v_mfma_f32_16x16x32_bf16 v[40:43], v[96:99], v[84:87], v[40:43]
    ds_read_b128 v[108:111], v9 offset:34816
    v_mfma_f32_16x16x32_bf16 v[44:47], v[100:103], v[84:87], v[44:47]
    ds_read_b128 v[112:115], v9 offset:36864
    v_mfma_f32_16x16x32_bf16 v[48:51], v[84:87], v[104:107], v[48:51]
    ds_read_b128 v[116:119], v9 offset:38912
    v_mfma_f32_16x16x32_bf16 v[52:55], v[96:99], v[88:91], v[52:55]
    ds_read_b128 v[120:123], v9 offset:40960
    v_mfma_f32_16x16x32_bf16 v[56:59], v[100:103], v[88:91], v[56:59]
    ds_read_b128 v[124:127], v9 offset:43008
    v_mfma_f32_16x16x32_bf16 v[60:63], v[88:91], v[104:107], v[60:63]
    v_mfma_f32_16x16x32_bf16 v[64:67], v[96:99], v[92:95], v[64:67]
    v_mfma_f32_16x16x32_bf16 v[68:71], v[100:103], v[92:95], v[68:71]
    v_mfma_f32_16x16x32_bf16 v[72:75], v[92:95], v[104:107], v[72:75]
    s_waitcnt lgkmcnt(0)
    s_barrier
    v_mfma_f32_16x16x32_bf16 v[16:19], v[128:131], v[108:111], v[16:19]
    ds_read_b64_tr_b16 v[96:97], v7 offset:0
    v_mfma_f32_16x16x32_bf16 v[20:23], v[132:135], v[108:111], v[20:23]
    ds_read_b64_tr_b16 v[98:99], v7 offset:3072
    v_mfma_f32_16x16x32_bf16 v[24:27], v[108:111], v[136:139], v[24:27]
    ds_read_b64_tr_b16 v[100:101], v7 offset:1024
    v_mfma_f32_16x16x32_bf16 v[28:31], v[128:131], v[112:115], v[28:31]
    ds_read_b64_tr_b16 v[102:103], v7 offset:4096
    v_mfma_f32_16x16x32_bf16 v[32:35], v[132:135], v[112:115], v[32:35]
    ds_read_b64_tr_b16 v[104:105], v7 offset:2048
    v_mfma_f32_16x16x32_bf16 v[36:39], v[112:115], v[136:139], v[36:39]
    ds_read_b64_tr_b16 v[106:107], v7 offset:5120
    v_mfma_f32_16x16x32_bf16 v[40:43], v[128:131], v[116:119], v[40:43]
    ds_read_b128 v[76:79], v10 offset:0
    v_mfma_f32_16x16x32_bf16 v[44:47], v[132:135], v[116:119], v[44:47]
    ds_read_b128 v[80:83], v10 offset:2048
    v_mfma_f32_16x16x32_bf16 v[48:51], v[116:119], v[136:139], v[48:51]
    ds_read_b128 v[84:87], v10 offset:4096
    v_mfma_f32_16x16x32_bf16 v[52:55], v[128:131], v[120:123], v[52:55]
    ds_read_b128 v[88:91], v10 offset:6144
    v_mfma_f32_16x16x32_bf16 v[56:59], v[132:135], v[120:123], v[56:59]
    ds_read_b128 v[92:95], v10 offset:8192
    v_mfma_f32_16x16x32_bf16 v[60:63], v[120:123], v[136:139], v[60:63]
    v_mfma_f32_16x16x32_bf16 v[64:67], v[128:131], v[124:127], v[64:67]
    v_mfma_f32_16x16x32_bf16 v[68:71], v[132:135], v[124:127], v[68:71]
    v_mfma_f32_16x16x32_bf16 v[72:75], v[124:127], v[136:139], v[72:75]
    s_waitcnt lgkmcnt(0)
    v_mfma_f32_16x16x32_bf16 v[16:19], v[96:99], v[76:79], v[16:19]
    ds_read_b64_tr_b16 v[128:129], v7 offset:12288
    v_mfma_f32_16x16x32_bf16 v[20:23], v[100:103], v[76:79], v[20:23]
    ds_read_b64_tr_b16 v[130:131], v7 offset:15360
    v_mfma_f32_16x16x32_bf16 v[24:27], v[76:79], v[104:107], v[24:27]
    ds_read_b64_tr_b16 v[132:133], v7 offset:13312
    v_mfma_f32_16x16x32_bf16 v[28:31], v[96:99], v[80:83], v[28:31]
    ds_read_b64_tr_b16 v[134:135], v7 offset:16384
    v_mfma_f32_16x16x32_bf16 v[32:35], v[100:103], v[80:83], v[32:35]
    ds_read_b64_tr_b16 v[136:137], v7 offset:14336
    v_mfma_f32_16x16x32_bf16 v[36:39], v[80:83], v[104:107], v[36:39]
    ds_read_b64_tr_b16 v[138:139], v7 offset:17408
    v_mfma_f32_16x16x32_bf16 v[40:43], v[96:99], v[84:87], v[40:43]
    ds_read_b128 v[108:111], v11 offset:0
    v_mfma_f32_16x16x32_bf16 v[44:47], v[100:103], v[84:87], v[44:47]
    ds_read_b128 v[112:115], v11 offset:2048
    v_mfma_f32_16x16x32_bf16 v[48:51], v[84:87], v[104:107], v[48:51]
    ds_read_b128 v[116:119], v11 offset:4096
    v_mfma_f32_16x16x32_bf16 v[52:55], v[96:99], v[88:91], v[52:55]
    ds_read_b128 v[120:123], v11 offset:6144
    v_mfma_f32_16x16x32_bf16 v[56:59], v[100:103], v[88:91], v[56:59]
    ds_read_b128 v[124:127], v11 offset:8192
    v_mfma_f32_16x16x32_bf16 v[60:63], v[88:91], v[104:107], v[60:63]
    v_mfma_f32_16x16x32_bf16 v[64:67], v[96:99], v[92:95], v[64:67]
    v_mfma_f32_16x16x32_bf16 v[68:71], v[100:103], v[92:95], v[68:71]
    v_mfma_f32_16x16x32_bf16 v[72:75], v[92:95], v[104:107], v[72:75]
    s_waitcnt lgkmcnt(0)
    s_barrier
    v_mfma_f32_16x16x32_bf16 v[16:19], v[128:131], v[108:111], v[16:19]
    ds_read_b64_tr_b16 v[96:97], v6 offset:0
    v_mfma_f32_16x16x32_bf16 v[20:23], v[132:135], v[108:111], v[20:23]
    ds_read_b64_tr_b16 v[98:99], v6 offset:3072
    v_mfma_f32_16x16x32_bf16 v[24:27], v[108:111], v[136:139], v[24:27]
    ds_read_b64_tr_b16 v[100:101], v6 offset:1024
    v_mfma_f32_16x16x32_bf16 v[28:31], v[128:131], v[112:115], v[28:31]
    ds_read_b64_tr_b16 v[102:103], v6 offset:4096
    v_mfma_f32_16x16x32_bf16 v[32:35], v[132:135], v[112:115], v[32:35]
    ds_read_b64_tr_b16 v[104:105], v6 offset:2048
    v_mfma_f32_16x16x32_bf16 v[36:39], v[112:115], v[136:139], v[36:39]
    ds_read_b64_tr_b16 v[106:107], v6 offset:5120
    v_mfma_f32_16x16x32_bf16 v[40:43], v[128:131], v[116:119], v[40:43]
    ds_read_b128 v[76:79], v8 offset:0
    v_mfma_f32_16x16x32_bf16 v[44:47], v[132:135], v[116:119], v[44:47]
    ds_read_b128 v[80:83], v8 offset:2048
    v_mfma_f32_16x16x32_bf16 v[48:51], v[116:119], v[136:139], v[48:51]
    ds_read_b128 v[84:87], v8 offset:4096
    v_mfma_f32_16x16x32_bf16 v[52:55], v[128:131], v[120:123], v[52:55]
    ds_read_b128 v[88:91], v8 offset:6144
    v_mfma_f32_16x16x32_bf16 v[56:59], v[132:135], v[120:123], v[56:59]
    ds_read_b128 v[92:95], v8 offset:8192
    v_mfma_f32_16x16x32_bf16 v[60:63], v[120:123], v[136:139], v[60:63]
    v_mfma_f32_16x16x32_bf16 v[64:67], v[128:131], v[124:127], v[64:67]
    v_mfma_f32_16x16x32_bf16 v[68:71], v[132:135], v[124:127], v[68:71]
    v_mfma_f32_16x16x32_bf16 v[72:75], v[124:127], v[136:139], v[72:75]
    s_waitcnt lgkmcnt(0)
    v_mfma_f32_16x16x32_bf16 v[16:19], v[96:99], v[76:79], v[16:19]
    ds_read_b64_tr_b16 v[128:129], v6 offset:12288
    v_mfma_f32_16x16x32_bf16 v[20:23], v[100:103], v[76:79], v[20:23]
    ds_read_b64_tr_b16 v[130:131], v6 offset:15360
    v_mfma_f32_16x16x32_bf16 v[24:27], v[76:79], v[104:107], v[24:27]
    ds_read_b64_tr_b16 v[132:133], v6 offset:13312
    v_mfma_f32_16x16x32_bf16 v[28:31], v[96:99], v[80:83], v[28:31]
    ds_read_b64_tr_b16 v[134:135], v6 offset:16384
    v_mfma_f32_16x16x32_bf16 v[32:35], v[100:103], v[80:83], v[32:35]
    ds_read_b64_tr_b16 v[136:137], v6 offset:14336
    v_mfma_f32_16x16x32_bf16 v[36:39], v[80:83], v[104:107], v[36:39]
    ds_read_b64_tr_b16 v[138:139], v6 offset:17408
    v_mfma_f32_16x16x32_bf16 v[40:43], v[96:99], v[84:87], v[40:43]
    ds_read_b128 v[108:111], v9 offset:0
    v_mfma_f32_16x16x32_bf16 v[44:47], v[100:103], v[84:87], v[44:47]
    ds_read_b128 v[112:115], v9 offset:2048
    v_mfma_f32_16x16x32_bf16 v[48:51], v[84:87], v[104:107], v[48:51]
    ds_read_b128 v[116:119], v9 offset:4096
    v_mfma_f32_16x16x32_bf16 v[52:55], v[96:99], v[88:91], v[52:55]
    ds_read_b128 v[120:123], v9 offset:6144
    v_mfma_f32_16x16x32_bf16 v[56:59], v[100:103], v[88:91], v[56:59]
    ds_read_b128 v[124:127], v9 offset:8192
    v_mfma_f32_16x16x32_bf16 v[60:63], v[88:91], v[104:107], v[60:63]
    v_mfma_f32_16x16x32_bf16 v[64:67], v[96:99], v[92:95], v[64:67]
    v_mfma_f32_16x16x32_bf16 v[68:71], v[100:103], v[92:95], v[68:71]
    v_mfma_f32_16x16x32_bf16 v[72:75], v[92:95], v[104:107], v[72:75]
    s_waitcnt lgkmcnt(0)
    s_barrier
    v_mfma_f32_16x16x32_bf16 v[16:19], v[128:131], v[108:111], v[16:19]
    ds_read_b64_tr_b16 v[96:97], v6 offset:34816
    v_mfma_f32_16x16x32_bf16 v[20:23], v[132:135], v[108:111], v[20:23]
    ds_read_b64_tr_b16 v[98:99], v6 offset:37888
    v_mfma_f32_16x16x32_bf16 v[24:27], v[108:111], v[136:139], v[24:27]
    ds_read_b64_tr_b16 v[100:101], v6 offset:35840
    v_mfma_f32_16x16x32_bf16 v[28:31], v[128:131], v[112:115], v[28:31]
    ds_read_b64_tr_b16 v[102:103], v6 offset:38912
    v_mfma_f32_16x16x32_bf16 v[32:35], v[132:135], v[112:115], v[32:35]
    ds_read_b64_tr_b16 v[104:105], v6 offset:36864
    v_mfma_f32_16x16x32_bf16 v[36:39], v[112:115], v[136:139], v[36:39]
    ds_read_b64_tr_b16 v[106:107], v6 offset:39936
    v_mfma_f32_16x16x32_bf16 v[40:43], v[128:131], v[116:119], v[40:43]
    ds_read_b128 v[76:79], v8 offset:34816
    v_mfma_f32_16x16x32_bf16 v[44:47], v[132:135], v[116:119], v[44:47]
    ds_read_b128 v[80:83], v8 offset:36864
    v_mfma_f32_16x16x32_bf16 v[48:51], v[116:119], v[136:139], v[48:51]
    ds_read_b128 v[84:87], v8 offset:38912
    v_mfma_f32_16x16x32_bf16 v[52:55], v[128:131], v[120:123], v[52:55]
    ds_read_b128 v[88:91], v8 offset:40960
    v_mfma_f32_16x16x32_bf16 v[56:59], v[132:135], v[120:123], v[56:59]
    ds_read_b128 v[92:95], v8 offset:43008
    v_mfma_f32_16x16x32_bf16 v[60:63], v[120:123], v[136:139], v[60:63]
    v_mfma_f32_16x16x32_bf16 v[64:67], v[128:131], v[124:127], v[64:67]
    v_mfma_f32_16x16x32_bf16 v[68:71], v[132:135], v[124:127], v[68:71]
    v_mfma_f32_16x16x32_bf16 v[72:75], v[124:127], v[136:139], v[72:75]
    s_waitcnt lgkmcnt(0)
    v_mfma_f32_16x16x32_bf16 v[16:19], v[96:99], v[76:79], v[16:19]
    ds_read_b64_tr_b16 v[128:129], v6 offset:47104
    v_mfma_f32_16x16x32_bf16 v[20:23], v[100:103], v[76:79], v[20:23]
    ds_read_b64_tr_b16 v[130:131], v6 offset:50176
    v_mfma_f32_16x16x32_bf16 v[24:27], v[76:79], v[104:107], v[24:27]
    ds_read_b64_tr_b16 v[132:133], v6 offset:48128
    v_mfma_f32_16x16x32_bf16 v[28:31], v[96:99], v[80:83], v[28:31]
    ds_read_b64_tr_b16 v[134:135], v6 offset:51200
    v_mfma_f32_16x16x32_bf16 v[32:35], v[100:103], v[80:83], v[32:35]
    ds_read_b64_tr_b16 v[136:137], v6 offset:49152
    v_mfma_f32_16x16x32_bf16 v[36:39], v[80:83], v[104:107], v[36:39]
    ds_read_b64_tr_b16 v[138:139], v6 offset:52224
    v_mfma_f32_16x16x32_bf16 v[40:43], v[96:99], v[84:87], v[40:43]
    ds_read_b128 v[108:111], v9 offset:34816
    v_mfma_f32_16x16x32_bf16 v[44:47], v[100:103], v[84:87], v[44:47]
    ds_read_b128 v[112:115], v9 offset:36864
    v_mfma_f32_16x16x32_bf16 v[48:51], v[84:87], v[104:107], v[48:51]
    ds_read_b128 v[116:119], v9 offset:38912
    v_mfma_f32_16x16x32_bf16 v[52:55], v[96:99], v[88:91], v[52:55]
    ds_read_b128 v[120:123], v9 offset:40960
    v_mfma_f32_16x16x32_bf16 v[56:59], v[100:103], v[88:91], v[56:59]
    ds_read_b128 v[124:127], v9 offset:43008
    v_mfma_f32_16x16x32_bf16 v[60:63], v[88:91], v[104:107], v[60:63]
    v_mfma_f32_16x16x32_bf16 v[64:67], v[96:99], v[92:95], v[64:67]
    v_mfma_f32_16x16x32_bf16 v[68:71], v[100:103], v[92:95], v[68:71]
    v_mfma_f32_16x16x32_bf16 v[72:75], v[92:95], v[104:107], v[72:75]
    s_waitcnt lgkmcnt(0)
    v_mfma_f32_16x16x32_bf16 v[16:19], v[128:131], v[108:111], v[16:19]
    v_mfma_f32_16x16x32_bf16 v[20:23], v[132:135], v[108:111], v[20:23]
    v_mfma_f32_16x16x32_bf16 v[24:27], v[108:111], v[136:139], v[24:27]
    v_mfma_f32_16x16x32_bf16 v[28:31], v[128:131], v[112:115], v[28:31]
    v_mfma_f32_16x16x32_bf16 v[32:35], v[132:135], v[112:115], v[32:35]
    v_mfma_f32_16x16x32_bf16 v[36:39], v[112:115], v[136:139], v[36:39]
    v_mfma_f32_16x16x32_bf16 v[40:43], v[128:131], v[116:119], v[40:43]
    v_mfma_f32_16x16x32_bf16 v[44:47], v[132:135], v[116:119], v[44:47]
    v_mfma_f32_16x16x32_bf16 v[48:51], v[116:119], v[136:139], v[48:51]
    v_mfma_f32_16x16x32_bf16 v[52:55], v[128:131], v[120:123], v[52:55]
    v_mfma_f32_16x16x32_bf16 v[56:59], v[132:135], v[120:123], v[56:59]
    v_mfma_f32_16x16x32_bf16 v[60:63], v[120:123], v[136:139], v[60:63]
    v_mfma_f32_16x16x32_bf16 v[64:67], v[128:131], v[124:127], v[64:67]
    v_mfma_f32_16x16x32_bf16 v[68:71], v[132:135], v[124:127], v[68:71]
    v_mfma_f32_16x16x32_bf16 v[72:75], v[124:127], v[136:139], v[72:75]
    s_branch c_loopdone
c_att_xt:
    s_barrier
    ds_read_b64_tr_b16 v[76:77], v147 offset:0
    ds_read_b64_tr_b16 v[78:79], v147 offset:256
    ds_read_b64_tr_b16 v[96:97], v6 offset:0
    ds_read_b64_tr_b16 v[98:99], v6 offset:3072
    ds_read_b64_tr_b16 v[100:101], v6 offset:1024
    ds_read_b64_tr_b16 v[102:103], v6 offset:4096
    ds_read_b64_tr_b16 v[104:105], v6 offset:2048
    ds_read_b64_tr_b16 v[106:107], v6 offset:5120
    ds_read_b64_tr_b16 v[80:81], v8 offset:0
    ds_read_b64_tr_b16 v[82:83], v8 offset:1024
    ds_read_b64_tr_b16 v[84:85], v9 offset:0
    ds_read_b64_tr_b16 v[86:87], v9 offset:1024
    ds_read_b64_tr_b16 v[88:89], v10 offset:0
    ds_read_b64_tr_b16 v[90:91], v10 offset:1024
    ds_read_b64_tr_b16 v[92:93], v11 offset:0
    ds_read_b64_tr_b16 v[94:95], v11 offset:1024
    s_waitcnt lgkmcnt(0)
    v_mfma_f32_16x16x32_bf16 v[20:23], v[100:103], v[76:79], 0
    ds_read_b64_tr_b16 v[108:109], v147 offset:1024
    ds_read_b64_tr_b16 v[110:111], v147 offset:1280
    v_mfma_f32_16x16x32_bf16 v[24:27], v[76:79], v[104:107], 0
    ds_read_b64_tr_b16 v[128:129], v6 offset:12288
    ds_read_b64_tr_b16 v[130:131], v6 offset:15360
    v_mfma_f32_16x16x32_bf16 v[28:31], v[96:99], v[80:83], 0
    ds_read_b64_tr_b16 v[132:133], v6 offset:13312
    ds_read_b64_tr_b16 v[134:135], v6 offset:16384
    v_mfma_f32_16x16x32_bf16 v[32:35], v[100:103], v[80:83], 0
    ds_read_b64_tr_b16 v[136:137], v6 offset:14336
    ds_read_b64_tr_b16 v[138:139], v6 offset:17408
    v_mfma_f32_16x16x32_bf16 v[36:39], v[80:83], v[104:107], 0
    ds_read_b64_tr_b16 v[112:113], v8 offset:4096
    v_mfma_f32_16x16x32_bf16 v[40:43], v[96:99], v[84:87], 0
    ds_read_b64_tr_b16 v[114:115], v8 offset:5120
    v_mfma_f32_16x16x32_bf16 v[44:47], v[100:103], v[84:87], 0
    ds_read_b64_tr_b16 v[116:117], v9 offset:4096
    v_mfma_f32_16x16x32_bf16 v[48:51], v[84:87], v[104:107], 0
    ds_read_b64_tr_b16 v[118:119], v9 offset:5120
    v_mfma_f32_16x16x32_bf16 v[52:55], v[96:99], v[88:91], 0
    ds_read_b64_tr_b16 v[120:121], v10 offset:4096
    v_mfma_f32_16x16x32_bf16 v[56:59], v[100:103], v[88:91], 0
    ds_read_b64_tr_b16 v[122:123], v10 offset:5120
    v_mfma_f32_16x16x32_bf16 v[60:63], v[88:91], v[104:107], 0
    ds_read_b64_tr_b16 v[124:125], v11 offset:4096
    v_mfma_f32_16x16x32_bf16 v[64:67], v[96:99], v[92:95], 0
    ds_read_b64_tr_b16 v[126:127], v11 offset:5120
    v_mfma_f32_16x16x32_bf16 v[68:71], v[100:103], v[92:95], 0
    v_mfma_f32_16x16x32_bf16 v[72:75], v[92:95], v[104:107], 0
    s_waitcnt lgkmcnt(0)
    s_barrier
    v_mfma_f32_16x16x32_bf16 v[20:23], v[132:135], v[108:111], v[20:23]
    ds_read_b64_tr_b16 v[76:77], v147 offset:34816
    ds_read_b64_tr_b16 v[78:79], v147 offset:35072
    v_mfma_f32_16x16x32_bf16 v[24:27], v[108:111], v[136:139], v[24:27]
    ds_read_b64_tr_b16 v[96:97], v6 offset:34816
    ds_read_b64_tr_b16 v[98:99], v6 offset:37888
    v_mfma_f32_16x16x32_bf16 v[28:31], v[128:131], v[112:115], v[28:31]
    ds_read_b64_tr_b16 v[100:101], v6 offset:35840
    ds_read_b64_tr_b16 v[102:103], v6 offset:38912
    v_mfma_f32_16x16x32_bf16 v[32:35], v[132:135], v[112:115], v[32:35]
    ds_read_b64_tr_b16 v[104:105], v6 offset:36864
    ds_read_b64_tr_b16 v[106:107], v6 offset:39936
    v_mfma_f32_16x16x32_bf16 v[36:39], v[112:115], v[136:139], v[36:39]
    ds_read_b64_tr_b16 v[80:81], v8 offset:34816
    v_mfma_f32_16x16x32_bf16 v[40:43], v[128:131], v[116:119], v[40:43]
    ds_read_b64_tr_b16 v[82:83], v8 offset:35840
    v_mfma_f32_16x16x32_bf16 v[44:47], v[132:135], v[116:119], v[44:47]
    ds_read_b64_tr_b16 v[84:85], v9 offset:34816
    v_mfma_f32_16x16x32_bf16 v[48:51], v[116:119], v[136:139], v[48:51]
    ds_read_b64_tr_b16 v[86:87], v9 offset:35840
    v_mfma_f32_16x16x32_bf16 v[52:55], v[128:131], v[120:123], v[52:55]
    ds_read_b64_tr_b16 v[88:89], v10 offset:34816
    v_mfma_f32_16x16x32_bf16 v[56:59], v[132:135], v[120:123], v[56:59]
    ds_read_b64_tr_b16 v[90:91], v10 offset:35840
    v_mfma_f32_16x16x32_bf16 v[60:63], v[120:123], v[136:139], v[60:63]
    ds_read_b64_tr_b16 v[92:93], v11 offset:34816
    v_mfma_f32_16x16x32_bf16 v[64:67], v[128:131], v[124:127], v[64:67]
    ds_read_b64_tr_b16 v[94:95], v11 offset:35840
    v_mfma_f32_16x16x32_bf16 v[68:71], v[132:135], v[124:127], v[68:71]
    v_mfma_f32_16x16x32_bf16 v[72:75], v[124:127], v[136:139], v[72:75]
    s_waitcnt lgkmcnt(0)
    v_mfma_f32_16x16x32_bf16 v[20:23], v[100:103], v[76:79], v[20:23]
    ds_read_b64_tr_b16 v[108:109], v147 offset:35840
    ds_read_b64_tr_b16 v[110:111], v147 offset:36096
    v_mfma_f32_16x16x32_bf16 v[24:27], v[76:79], v[104:107], v[24:27]
    ds_read_b64_tr_b16 v[128:129], v6 offset:47104
    ds_read_b64_tr_b16 v[130:131], v6 offset:50176
    v_mfma_f32_16x16x32_bf16 v[28:31], v[96:99], v[80:83], v[28:31]
    ds_read_b64_tr_b16 v[132:133], v6 offset:48128
    ds_read_b64_tr_b16 v[134:135], v6 offset:51200
    v_mfma_f32_16x16x32_bf16 v[32:35], v[100:103], v[80:83], v[32:35]
    ds_read_b64_tr_b16 v[136:137], v6 offset:49152
    ds_read_b64_tr_b16 v[138:139], v6 offset:52224
    v_mfma_f32_16x16x32_bf16 v[36:39], v[80:83], v[104:107], v[36:39]
    ds_read_b64_tr_b16 v[112:113], v8 offset:38912
    v_mfma_f32_16x16x32_bf16 v[40:43], v[96:99], v[84:87], v[40:43]
    ds_read_b64_tr_b16 v[114:115], v8 offset:39936
    v_mfma_f32_16x16x32_bf16 v[44:47], v[100:103], v[84:87], v[44:47]
    ds_read_b64_tr_b16 v[116:117], v9 offset:38912
    v_mfma_f32_16x16x32_bf16 v[48:51], v[84:87], v[104:107], v[48:51]
    ds_read_b64_tr_b16 v[118:119], v9 offset:39936
    v_mfma_f32_16x16x32_bf16 v[52:55], v[96:99], v[88:91], v[52:55]
    ds_read_b64_tr_b16 v[120:121], v10 offset:38912
    v_mfma_f32_16x16x32_bf16 v[56:59], v[100:103], v[88:91], v[56:59]
    ds_read_b64_tr_b16 v[122:123], v10 offset:39936
    v_mfma_f32_16x16x32_bf16 v[60:63], v[88:91], v[104:107], v[60:63]
    ds_read_b64_tr_b16 v[124:125], v11 offset:38912
    v_mfma_f32_16x16x32_bf16 v[64:67], v[96:99], v[92:95], v[64:67]
    ds_read_b64_tr_b16 v[126:127], v11 offset:39936
    v_mfma_f32_16x16x32_bf16 v[68:71], v[100:103], v[92:95], v[68:71]
    v_mfma_f32_16x16x32_bf16 v[72:75], v[92:95], v[104:107], v[72:75]
    s_waitcnt lgkmcnt(0)
    s_barrier
    v_mfma_f32_16x16x32_bf16 v[20:23], v[132:135], v[108:111], v[20:23]
    ds_read_b64_tr_b16 v[76:77], v166 offset:0
    ds_read_b64_tr_b16 v[78:79], v166 offset:256
    v_mfma_f32_16x16x32_bf16 v[24:27], v[108:111], v[136:139], v[24:27]
    ds_read_b64_tr_b16 v[96:97], v7 offset:0
    ds_read_b64_tr_b16 v[98:99], v7 offset:3072
    v_mfma_f32_16x16x32_bf16 v[28:31], v[128:131], v[112:115], v[28:31]
    ds_read_b64_tr_b16 v[100:101], v7 offset:1024
    ds_read_b64_tr_b16 v[102:103], v7 offset:4096
    v_mfma_f32_16x16x32_bf16 v[32:35], v[132:135], v[112:115], v[32:35]
    ds_read_b64_tr_b16 v[104:105], v7 offset:2048
    ds_read_b64_tr_b16 v[106:107], v7 offset:5120
    v_mfma_f32_16x16x32_bf16 v[36:39], v[112:115], v[136:139], v[36:39]
    ds_read_b64_tr_b16 v[80:81], v14 offset:0
    v_mfma_f32_16x16x32_bf16 v[40:43], v[128:131], v[116:119], v[40:43]
    ds_read_b64_tr_b16 v[82:83], v14 offset:1024
    v_mfma_f32_16x16x32_bf16 v[44:47], v[132:135], v[116:119], v[44:47]
    ds_read_b64_tr_b16 v[84:85], v15 offset:0
    v_mfma_f32_16x16x32_bf16 v[48:51], v[116:119], v[136:139], v[48:51]
    ds_read_b64_tr_b16 v[86:87], v15 offset:1024
    v_mfma_f32_16x16x32_bf16 v[52:55], v[128:131], v[120:123], v[52:55]
    ds_read_b64_tr_b16 v[88:89], v148 offset:0
    v_mfma_f32_16x16x32_bf16 v[56:59], v[132:135], v[120:123], v[56:59]
    ds_read_b64_tr_b16 v[90:91], v148 offset:1024
    v_mfma_f32_16x16x32_bf16 v[60:63], v[120:123], v[136:139], v[60:63]
    ds_read_b64_tr_b16 v[92:93], v149 offset:0
    v_mfma_f32_16x16x32_bf16 v[64:67], v[128:131], v[124:127], v[64:67]
    ds_read_b64_tr_b16 v[94:95], v149 offset:1024
    v_mfma_f32_16x16x32_bf16 v[68:71], v[132:135], v[124:127], v[68:71]
    v_mfma_f32_16x16x32_bf16 v[72:75], v[124:127], v[136:139], v[72:75]
    s_waitcnt lgkmcnt(0)
    v_mfma_f32_16x16x32_bf16 v[20:23], v[100:103], v[76:79], v[20:23]
    ds_read_b64_tr_b16 v[108:109], v166 offset:1024
    ds_read_b64_tr_b16 v[110:111], v166 offset:1280
    v_mfma_f32_16x16x32_bf16 v[24:27], v[76:79], v[104:107], v[24:27]
    ds_read_b64_tr_b16 v[128:129], v7 offset:12288
    ds_read_b64_tr_b16 v[130:131], v7 offset:15360
    v_mfma_f32_16x16x32_bf16 v[28:31], v[96:99], v[80:83], v[28:31]
    ds_read_b64_tr_b16 v[132:133], v7 offset:13312
    ds_read_b64_tr_b16 v[134:135], v7 offset:16384
    v_mfma_f32_16x16x32_bf16 v[32:35], v[100:103], v[80:83], v[32:35]
    ds_read_b64_tr_b16 v[136:137], v7 offset:14336
    ds_read_b64_tr_b16 v[138:139], v7 offset:17408
    v_mfma_f32_16x16x32_bf16 v[36:39], v[80:83], v[104:107], v[36:39]
    ds_read_b64_tr_b16 v[112:113], v14 offset:4096
    v_mfma_f32_16x16x32_bf16 v[40:43], v[96:99], v[84:87], v[40:43]
    ds_read_b64_tr_b16 v[114:115], v14 offset:5120
    v_mfma_f32_16x16x32_bf16 v[44:47], v[100:103], v[84:87], v[44:47]
    ds_read_b64_tr_b16 v[116:117], v15 offset:4096
    v_mfma_f32_16x16x32_bf16 v[48:51], v[84:87], v[104:107], v[48:51]
    ds_read_b64_tr_b16 v[118:119], v15 offset:5120
    v_mfma_f32_16x16x32_bf16 v[52:55], v[96:99], v[88:91], v[52:55]
    ds_read_b64_tr_b16 v[120:121], v148 offset:4096
    v_mfma_f32_16x16x32_bf16 v[56:59], v[100:103], v[88:91], v[56:59]
    ds_read_b64_tr_b16 v[122:123], v148 offset:5120
    v_mfma_f32_16x16x32_bf16 v[60:63], v[88:91], v[104:107], v[60:63]
    ds_read_b64_tr_b16 v[124:125], v149 offset:4096
    v_mfma_f32_16x16x32_bf16 v[64:67], v[96:99], v[92:95], v[64:67]
    ds_read_b64_tr_b16 v[126:127], v149 offset:5120
    v_mfma_f32_16x16x32_bf16 v[68:71], v[100:103], v[92:95], v[68:71]
    v_mfma_f32_16x16x32_bf16 v[72:75], v[92:95], v[104:107], v[72:75]
    s_waitcnt lgkmcnt(0)
    s_barrier
    v_mfma_f32_16x16x32_bf16 v[20:23], v[132:135], v[108:111], v[20:23]
    ds_read_b64_tr_b16 v[76:77], v147 offset:0
    ds_read_b64_tr_b16 v[78:79], v147 offset:256
    v_mfma_f32_16x16x32_bf16 v[24:27], v[108:111], v[136:139], v[24:27]
    ds_read_b64_tr_b16 v[96:97], v6 offset:0
    ds_read_b64_tr_b16 v[98:99], v6 offset:3072
    v_mfma_f32_16x16x32_bf16 v[28:31], v[128:131], v[112:115], v[28:31]
    ds_read_b64_tr_b16 v[100:101], v6 offset:1024
    ds_read_b64_tr_b16 v[102:103], v6 offset:4096
    v_mfma_f32_16x16x32_bf16 v[32:35], v[132:135], v[112:115], v[32:35]
    ds_read_b64_tr_b16 v[104:105], v6 offset:2048
    ds_read_b64_tr_b16 v[106:107], v6 offset:5120
    v_mfma_f32_16x16x32_bf16 v[36:39], v[112:115], v[136:139], v[36:39]
    ds_read_b64_tr_b16 v[80:81], v8 offset:0
    v_mfma_f32_16x16x32_bf16 v[40:43], v[128:131], v[116:119], v[40:43]
    ds_read_b64_tr_b16 v[82:83], v8 offset:1024
    v_mfma_f32_16x16x32_bf16 v[44:47], v[132:135], v[116:119], v[44:47]
    ds_read_b64_tr_b16 v[84:85], v9 offset:0
    v_mfma_f32_16x16x32_bf16 v[48:51], v[116:119], v[136:139], v[48:51]
    ds_read_b64_tr_b16 v[86:87], v9 offset:1024
    v_mfma_f32_16x16x32_bf16 v[52:55], v[128:131], v[120:123], v[52:55]
    ds_read_b64_tr_b16 v[88:89], v10 offset:0
    v_mfma_f32_16x16x32_bf16 v[56:59], v[132:135], v[120:123], v[56:59]
    ds_read_b64_tr_b16 v[90:91], v10 offset:1024
    v_mfma_f32_16x16x32_bf16 v[60:63], v[120:123], v[136:139], v[60:63]
    ds_read_b64_tr_b16 v[92:93], v11 offset:0
    v_mfma_f32_16x16x32_bf16 v[64:67], v[128:131], v[124:127], v[64:67]
    ds_read_b64_tr_b16 v[94:95], v11 offset:1024
    v_mfma_f32_16x16x32_bf16 v[68:71], v[132:135], v[124:127], v[68:71]
    v_mfma_f32_16x16x32_bf16 v[72:75], v[124:127], v[136:139], v[72:75]
    s_waitcnt lgkmcnt(0)
    v_mfma_f32_16x16x32_bf16 v[20:23], v[100:103], v[76:79], v[20:23]
    ds_read_b64_tr_b16 v[108:109], v147 offset:1024
    ds_read_b64_tr_b16 v[110:111], v147 offset:1280
    v_mfma_f32_16x16x32_bf16 v[24:27], v[76:79], v[104:107], v[24:27]
    ds_read_b64_tr_b16 v[128:129], v6 offset:12288
    ds_read_b64_tr_b16 v[130:131], v6 offset:15360
    v_mfma_f32_16x16x32_bf16 v[28:31], v[96:99], v[80:83], v[28:31]
    ds_read_b64_tr_b16 v[132:133], v6 offset:13312
    ds_read_b64_tr_b16 v[134:135], v6 offset:16384
    v_mfma_f32_16x16x32_bf16 v[32:35], v[100:103], v[80:83], v[32:35]
    ds_read_b64_tr_b16 v[136:137], v6 offset:14336
    ds_read_b64_tr_b16 v[138:139], v6 offset:17408
    v_mfma_f32_16x16x32_bf16 v[36:39], v[80:83], v[104:107], v[36:39]
    ds_read_b64_tr_b16 v[112:113], v8 offset:4096
    v_mfma_f32_16x16x32_bf16 v[40:43], v[96:99], v[84:87], v[40:43]
    ds_read_b64_tr_b16 v[114:115], v8 offset:5120
    v_mfma_f32_16x16x32_bf16 v[44:47], v[100:103], v[84:87], v[44:47]
    ds_read_b64_tr_b16 v[116:117], v9 offset:4096
    v_mfma_f32_16x16x32_bf16 v[48:51], v[84:87], v[104:107], v[48:51]
    ds_read_b64_tr_b16 v[118:119], v9 offset:5120
    v_mfma_f32_16x16x32_bf16 v[52:55], v[96:99], v[88:91], v[52:55]
    ds_read_b64_tr_b16 v[120:121], v10 offset:4096
    v_mfma_f32_16x16x32_bf16 v[56:59], v[100:103], v[88:91], v[56:59]
    ds_read_b64_tr_b16 v[122:123], v10 offset:5120
    v_mfma_f32_16x16x32_bf16 v[60:63], v[88:91], v[104:107], v[60:63]
    ds_read_b64_tr_b16 v[124:125], v11 offset:4096
    v_mfma_f32_16x16x32_bf16 v[64:67], v[96:99], v[92:95], v[64:67]
    ds_read_b64_tr_b16 v[126:127], v11 offset:5120
    v_mfma_f32_16x16x32_bf16 v[68:71], v[100:103], v[92:95], v[68:71]
    v_mfma_f32_16x16x32_bf16 v[72:75], v[92:95], v[104:107], v[72:75]
    s_waitcnt lgkmcnt(0)
    s_barrier
    v_mfma_f32_16x16x32_bf16 v[20:23], v[132:135], v[108:111], v[20:23]
    ds_read_b64_tr_b16 v[76:77], v147 offset:34816
    ds_read_b64_tr_b16 v[78:79], v147 offset:35072
    v_mfma_f32_16x16x32_bf16 v[24:27], v[108:111], v[136:139], v[24:27]
    ds_read_b64_tr_b16 v[96:97], v6 offset:34816
    ds_read_b64_tr_b16 v[98:99], v6 offset:37888
    v_mfma_f32_16x16x32_bf16 v[28:31], v[128:131], v[112:115], v[28:31]
    ds_read_b64_tr_b16 v[100:101], v6 offset:35840
    ds_read_b64_tr_b16 v[102:103], v6 offset:38912
    v_mfma_f32_16x16x32_bf16 v[32:35], v[132:135], v[112:115], v[32:35]
    ds_read_b64_tr_b16 v[104:105], v6 offset:36864
    ds_read_b64_tr_b16 v[106:107], v6 offset:39936
    v_mfma_f32_16x16x32_bf16 v[36:39], v[112:115], v[136:139], v[36:39]
    ds_read_b64_tr_b16 v[80:81], v8 offset:34816
    v_mfma_f32_16x16x32_bf16 v[40:43], v[128:131], v[116:119], v[40:43]
    ds_read_b64_tr_b16 v[82:83], v8 offset:35840
    v_mfma_f32_16x16x32_bf16 v[44:47], v[132:135], v[116:119], v[44:47]
    ds_read_b64_tr_b16 v[84:85], v9 offset:34816
    v_mfma_f32_16x16x32_bf16 v[48:51], v[116:119], v[136:139], v[48:51]
    ds_read_b64_tr_b16 v[86:87], v9 offset:35840
    v_mfma_f32_16x16x32_bf16 v[52:55], v[128:131], v[120:123], v[52:55]
    ds_read_b64_tr_b16 v[88:89], v10 offset:34816
    v_mfma_f32_16x16x32_bf16 v[56:59], v[132:135], v[120:123], v[56:59]
    ds_read_b64_tr_b16 v[90:91], v10 offset:35840
    v_mfma_f32_16x16x32_bf16 v[60:63], v[120:123], v[136:139], v[60:63]
    ds_read_b64_tr_b16 v[92:93], v11 offset:34816
    v_mfma_f32_16x16x32_bf16 v[64:67], v[128:131], v[124:127], v[64:67]
    ds_read_b64_tr_b16 v[94:95], v11 offset:35840
    v_mfma_f32_16x16x32_bf16 v[68:71], v[132:135], v[124:127], v[68:71]
    v_mfma_f32_16x16x32_bf16 v[72:75], v[124:127], v[136:139], v[72:75]
    s_waitcnt lgkmcnt(0)
    v_mfma_f32_16x16x32_bf16 v[20:23], v[100:103], v[76:79], v[20:23]
    ds_read_b64_tr_b16 v[108:109], v147 offset:35840
    ds_read_b64_tr_b16 v[110:111], v147 offset:36096
    v_mfma_f32_16x16x32_bf16 v[24:27], v[76:79], v[104:107], v[24:27]
    ds_read_b64_tr_b16 v[128:129], v6 offset:47104
    ds_read_b64_tr_b16 v[130:131], v6 offset:50176
    v_mfma_f32_16x16x32_bf16 v[28:31], v[96:99], v[80:83], v[28:31]
    ds_read_b64_tr_b16 v[132:133], v6 offset:48128
    ds_read_b64_tr_b16 v[134:135], v6 offset:51200
    v_mfma_f32_16x16x32_bf16 v[32:35], v[100:103], v[80:83], v[32:35]
    ds_read_b64_tr_b16 v[136:137], v6 offset:49152
    ds_read_b64_tr_b16 v[138:139], v6 offset:52224
    v_mfma_f32_16x16x32_bf16 v[36:39], v[80:83], v[104:107], v[36:39]
    ds_read_b64_tr_b16 v[112:113], v8 offset:38912
    v_mfma_f32_16x16x32_bf16 v[40:43], v[96:99], v[84:87], v[40:43]
    ds_read_b64_tr_b16 v[114:115], v8 offset:39936
    v_mfma_f32_16x16x32_bf16 v[44:47], v[100:103], v[84:87], v[44:47]
    ds_read_b64_tr_b16 v[116:117], v9 offset:38912
    v_mfma_f32_16x16x32_bf16 v[48:51], v[84:87], v[104:107], v[48:51]
    ds_read_b64_tr_b16 v[118:119], v9 offset:39936
    v_mfma_f32_16x16x32_bf16 v[52:55], v[96:99], v[88:91], v[52:55]
    ds_read_b64_tr_b16 v[120:121], v10 offset:38912
    v_mfma_f32_16x16x32_bf16 v[56:59], v[100:103], v[88:91], v[56:59]
    ds_read_b64_tr_b16 v[122:123], v10 offset:39936
    v_mfma_f32_16x16x32_bf16 v[60:63], v[88:91], v[104:107], v[60:63]
    ds_read_b64_tr_b16 v[124:125], v11 offset:38912
    v_mfma_f32_16x16x32_bf16 v[64:67], v[96:99], v[92:95], v[64:67]
    ds_read_b64_tr_b16 v[126:127], v11 offset:39936
    v_mfma_f32_16x16x32_bf16 v[68:71], v[100:103], v[92:95], v[68:71]
    v_mfma_f32_16x16x32_bf16 v[72:75], v[92:95], v[104:107], v[72:75]
    s_waitcnt lgkmcnt(0)
    s_barrier
    v_mfma_f32_16x16x32_bf16 v[20:23], v[132:135], v[108:111], v[20:23]
    ds_read_b64_tr_b16 v[76:77], v166 offset:0
    ds_read_b64_tr_b16 v[78:79], v166 offset:256
    v_mfma_f32_16x16x32_bf16 v[24:27], v[108:111], v[136:139], v[24:27]
    ds_read_b64_tr_b16 v[96:97], v7 offset:0
    ds_read_b64_tr_b16 v[98:99], v7 offset:3072
    v_mfma_f32_16x16x32_bf16 v[28:31], v[128:131], v[112:115], v[28:31]
    ds_read_b64_tr_b16 v[100:101], v7 offset:1024
    ds_read_b64_tr_b16 v[102:103], v7 offset:4096
    v_mfma_f32_16x16x32_bf16 v[32:35], v[132:135], v[112:115], v[32:35]
    ds_read_b64_tr_b16 v[104:105], v7 offset:2048
    ds_read_b64_tr_b16 v[106:107], v7 offset:5120
    v_mfma_f32_16x16x32_bf16 v[36:39], v[112:115], v[136:139], v[36:39]
    ds_read_b64_tr_b16 v[80:81], v14 offset:0
    v_mfma_f32_16x16x32_bf16 v[40:43], v[128:131], v[116:119], v[40:43]
    ds_read_b64_tr_b16 v[82:83], v14 offset:1024
    v_mfma_f32_16x16x32_bf16 v[44:47], v[132:135], v[116:119], v[44:47]
    ds_read_b64_tr_b16 v[84:85], v15 offset:0
    v_mfma_f32_16x16x32_bf16 v[48:51], v[116:119], v[136:139], v[48:51]
    ds_read_b64_tr_b16 v[86:87], v15 offset:1024
    v_mfma_f32_16x16x32_bf16 v[52:55], v[128:131], v[120:123], v[52:55]
    ds_read_b64_tr_b16 v[88:89], v148 offset:0
    v_mfma_f32_16x16x32_bf16 v[56:59], v[132:135], v[120:123], v[56:59]
    ds_read_b64_tr_b16 v[90:91], v148 offset:1024
    v_mfma_f32_16x16x32_bf16 v[60:63], v[120:123], v[136:139], v[60:63]
    ds_read_b64_tr_b16 v[92:93], v149 offset:0
    v_mfma_f32_16x16x32_bf16 v[64:67], v[128:131], v[124:127], v[64:67]
    ds_read_b64_tr_b16 v[94:95], v149 offset:1024
    v_mfma_f32_16x16x32_bf16 v[68:71], v[132:135], v[124:127], v[68:71]
    v_mfma_f32_16x16x32_bf16 v[72:75], v[124:127], v[136:139], v[72:75]
    s_waitcnt lgkmcnt(0)
    v_mfma_f32_16x16x32_bf16 v[20:23], v[100:103], v[76:79], v[20:23]
    ds_read_b64_tr_b16 v[108:109], v166 offset:1024
    ds_read_b64_tr_b16 v[110:111], v166 offset:1280
    v_mfma_f32_16x16x32_bf16 v[24:27], v[76:79], v[104:107], v[24:27]
    ds_read_b64_tr_b16 v[128:129], v7 offset:12288
    ds_read_b64_tr_b16 v[130:131], v7 offset:15360
    v_mfma_f32_16x16x32_bf16 v[28:31], v[96:99], v[80:83], v[28:31]
    ds_read_b64_tr_b16 v[132:133], v7 offset:13312
    ds_read_b64_tr_b16 v[134:135], v7 offset:16384
    v_mfma_f32_16x16x32_bf16 v[32:35], v[100:103], v[80:83], v[32:35]
    ds_read_b64_tr_b16 v[136:137], v7 offset:14336
    ds_read_b64_tr_b16 v[138:139], v7 offset:17408
    v_mfma_f32_16x16x32_bf16 v[36:39], v[80:83], v[104:107], v[36:39]
    ds_read_b64_tr_b16 v[112:113], v14 offset:4096
    v_mfma_f32_16x16x32_bf16 v[40:43], v[96:99], v[84:87], v[40:43]
    ds_read_b64_tr_b16 v[114:115], v14 offset:5120
    v_mfma_f32_16x16x32_bf16 v[44:47], v[100:103], v[84:87], v[44:47]
    ds_read_b64_tr_b16 v[116:117], v15 offset:4096
    v_mfma_f32_16x16x32_bf16 v[48:51], v[84:87], v[104:107], v[48:51]
    ds_read_b64_tr_b16 v[118:119], v15 offset:5120
    v_mfma_f32_16x16x32_bf16 v[52:55], v[96:99], v[88:91], v[52:55]
    ds_read_b64_tr_b16 v[120:121], v148 offset:4096
    v_mfma_f32_16x16x32_bf16 v[56:59], v[100:103], v[88:91], v[56:59]
    ds_read_b64_tr_b16 v[122:123], v148 offset:5120
    v_mfma_f32_16x16x32_bf16 v[60:63], v[88:91], v[104:107], v[60:63]
    ds_read_b64_tr_b16 v[124:125], v149 offset:4096
    v_mfma_f32_16x16x32_bf16 v[64:67], v[96:99], v[92:95], v[64:67]
    ds_read_b64_tr_b16 v[126:127], v149 offset:5120
    v_mfma_f32_16x16x32_bf16 v[68:71], v[100:103], v[92:95], v[68:71]
    v_mfma_f32_16x16x32_bf16 v[72:75], v[92:95], v[104:107], v[72:75]
    s_waitcnt lgkmcnt(0)
    s_barrier
    v_mfma_f32_16x16x32_bf16 v[20:23], v[132:135], v[108:111], v[20:23]
    ds_read_b64_tr_b16 v[76:77], v147 offset:0
    ds_read_b64_tr_b16 v[78:79], v147 offset:256
    v_mfma_f32_16x16x32_bf16 v[24:27], v[108:111], v[136:139], v[24:27]
    ds_read_b64_tr_b16 v[96:97], v6 offset:0
    ds_read_b64_tr_b16 v[98:99], v6 offset:3072
    v_mfma_f32_16x16x32_bf16 v[28:31], v[128:131], v[112:115], v[28:31]
    ds_read_b64_tr_b16 v[100:101], v6 offset:1024
    ds_read_b64_tr_b16 v[102:103], v6 offset:4096
    v_mfma_f32_16x16x32_bf16 v[32:35], v[132:135], v[112:115], v[32:35]
    ds_read_b64_tr_b16 v[104:105], v6 offset:2048
    ds_read_b64_tr_b16 v[106:107], v6 offset:5120
    v_mfma_f32_16x16x32_bf16 v[36:39], v[112:115], v[136:139], v[36:39]
    ds_read_b64_tr_b16 v[80:81], v8 offset:0
    v_mfma_f32_16x16x32_bf16 v[40:43], v[128:131], v[116:119], v[40:43]
    ds_read_b64_tr_b16 v[82:83], v8 offset:1024
    v_mfma_f32_16x16x32_bf16 v[44:47], v[132:135], v[116:119], v[44:47]
    ds_read_b64_tr_b16 v[84:85], v9 offset:0
    v_mfma_f32_16x16x32_bf16 v[48:51], v[116:119], v[136:139], v[48:51]
    ds_read_b64_tr_b16 v[86:87], v9 offset:1024
    v_mfma_f32_16x16x32_bf16 v[52:55], v[128:131], v[120:123], v[52:55]
    ds_read_b64_tr_b16 v[88:89], v10 offset:0
    v_mfma_f32_16x16x32_bf16 v[56:59], v[132:135], v[120:123], v[56:59]
    ds_read_b64_tr_b16 v[90:91], v10 offset:1024
    v_mfma_f32_16x16x32_bf16 v[60:63], v[120:123], v[136:139], v[60:63]
    ds_read_b64_tr_b16 v[92:93], v11 offset:0
    v_mfma_f32_16x16x32_bf16 v[64:67], v[128:131], v[124:127], v[64:67]
    ds_read_b64_tr_b16 v[94:95], v11 offset:1024
    v_mfma_f32_16x16x32_bf16 v[68:71], v[132:135], v[124:127], v[68:71]
    v_mfma_f32_16x16x32_bf16 v[72:75], v[124:127], v[136:139], v[72:75]
    s_waitcnt lgkmcnt(0)
    v_mfma_f32_16x16x32_bf16 v[20:23], v[100:103], v[76:79], v[20:23]
    ds_read_b64_tr_b16 v[108:109], v147 offset:1024
    ds_read_b64_tr_b16 v[110:111], v147 offset:1280
    v_mfma_f32_16x16x32_bf16 v[24:27], v[76:79], v[104:107], v[24:27]
    ds_read_b64_tr_b16 v[128:129], v6 offset:12288
    ds_read_b64_tr_b16 v[130:131], v6 offset:15360
    v_mfma_f32_16x16x32_bf16 v[28:31], v[96:99], v[80:83], v[28:31]
    ds_read_b64_tr_b16 v[132:133], v6 offset:13312
    ds_read_b64_tr_b16 v[134:135], v6 offset:16384
    v_mfma_f32_16x16x32_bf16 v[32:35], v[100:103], v[80:83], v[32:35]
    ds_read_b64_tr_b16 v[136:137], v6 offset:14336
    ds_read_b64_tr_b16 v[138:139], v6 offset:17408
    v_mfma_f32_16x16x32_bf16 v[36:39], v[80:83], v[104:107], v[36:39]
    ds_read_b64_tr_b16 v[112:113], v8 offset:4096
    v_mfma_f32_16x16x32_bf16 v[40:43], v[96:99], v[84:87], v[40:43]
    ds_read_b64_tr_b16 v[114:115], v8 offset:5120
    v_mfma_f32_16x16x32_bf16 v[44:47], v[100:103], v[84:87], v[44:47]
    ds_read_b64_tr_b16 v[116:117], v9 offset:4096
    v_mfma_f32_16x16x32_bf16 v[48:51], v[84:87], v[104:107], v[48:51]
    ds_read_b64_tr_b16 v[118:119], v9 offset:5120
    v_mfma_f32_16x16x32_bf16 v[52:55], v[96:99], v[88:91], v[52:55]
    ds_read_b64_tr_b16 v[120:121], v10 offset:4096
    v_mfma_f32_16x16x32_bf16 v[56:59], v[100:103], v[88:91], v[56:59]
    ds_read_b64_tr_b16 v[122:123], v10 offset:5120
    v_mfma_f32_16x16x32_bf16 v[60:63], v[88:91], v[104:107], v[60:63]
    ds_read_b64_tr_b16 v[124:125], v11 offset:4096
    v_mfma_f32_16x16x32_bf16 v[64:67], v[96:99], v[92:95], v[64:67]
    ds_read_b64_tr_b16 v[126:127], v11 offset:5120
    v_mfma_f32_16x16x32_bf16 v[68:71], v[100:103], v[92:95], v[68:71]
    v_mfma_f32_16x16x32_bf16 v[72:75], v[92:95], v[104:107], v[72:75]
    s_waitcnt lgkmcnt(0)
    s_barrier
    v_mfma_f32_16x16x32_bf16 v[20:23], v[132:135], v[108:111], v[20:23]
    ds_read_b64_tr_b16 v[76:77], v147 offset:34816
    ds_read_b64_tr_b16 v[78:79], v147 offset:35072
    v_mfma_f32_16x16x32_bf16 v[24:27], v[108:111], v[136:139], v[24:27]
    ds_read_b64_tr_b16 v[96:97], v6 offset:34816
    ds_read_b64_tr_b16 v[98:99], v6 offset:37888
    v_mfma_f32_16x16x32_bf16 v[28:31], v[128:131], v[112:115], v[28:31]
    ds_read_b64_tr_b16 v[100:101], v6 offset:35840
    ds_read_b64_tr_b16 v[102:103], v6 offset:38912
    v_mfma_f32_16x16x32_bf16 v[32:35], v[132:135], v[112:115], v[32:35]
    ds_read_b64_tr_b16 v[104:105], v6 offset:36864
    ds_read_b64_tr_b16 v[106:107], v6 offset:39936
    v_mfma_f32_16x16x32_bf16 v[36:39], v[112:115], v[136:139], v[36:39]
    ds_read_b64_tr_b16 v[80:81], v8 offset:34816
    v_mfma_f32_16x16x32_bf16 v[40:43], v[128:131], v[116:119], v[40:43]
    ds_read_b64_tr_b16 v[82:83], v8 offset:35840
    v_mfma_f32_16x16x32_bf16 v[44:47], v[132:135], v[116:119], v[44:47]
    ds_read_b64_tr_b16 v[84:85], v9 offset:34816
    v_mfma_f32_16x16x32_bf16 v[48:51], v[116:119], v[136:139], v[48:51]
    ds_read_b64_tr_b16 v[86:87], v9 offset:35840
    v_mfma_f32_16x16x32_bf16 v[52:55], v[128:131], v[120:123], v[52:55]
    ds_read_b64_tr_b16 v[88:89], v10 offset:34816
    v_mfma_f32_16x16x32_bf16 v[56:59], v[132:135], v[120:123], v[56:59]
    ds_read_b64_tr_b16 v[90:91], v10 offset:35840
    v_mfma_f32_16x16x32_bf16 v[60:63], v[120:123], v[136:139], v[60:63]
    ds_read_b64_tr_b16 v[92:93], v11 offset:34816
    v_mfma_f32_16x16x32_bf16 v[64:67], v[128:131], v[124:127], v[64:67]
    ds_read_b64_tr_b16 v[94:95], v11 offset:35840
    v_mfma_f32_16x16x32_bf16 v[68:71], v[132:135], v[124:127], v[68:71]
    v_mfma_f32_16x16x32_bf16 v[72:75], v[124:127], v[136:139], v[72:75]
    s_waitcnt lgkmcnt(0)
    v_mfma_f32_16x16x32_bf16 v[20:23], v[100:103], v[76:79], v[20:23]
    ds_read_b64_tr_b16 v[108:109], v147 offset:35840
    ds_read_b64_tr_b16 v[110:111], v147 offset:36096
    v_mfma_f32_16x16x32_bf16 v[24:27], v[76:79], v[104:107], v[24:27]
    ds_read_b64_tr_b16 v[128:129], v6 offset:47104
    ds_read_b64_tr_b16 v[130:131], v6 offset:50176
    v_mfma_f32_16x16x32_bf16 v[28:31], v[96:99], v[80:83], v[28:31]
    ds_read_b64_tr_b16 v[132:133], v6 offset:48128
    ds_read_b64_tr_b16 v[134:135], v6 offset:51200
    v_mfma_f32_16x16x32_bf16 v[32:35], v[100:103], v[80:83], v[32:35]
    ds_read_b64_tr_b16 v[136:137], v6 offset:49152
    ds_read_b64_tr_b16 v[138:139], v6 offset:52224
    v_mfma_f32_16x16x32_bf16 v[36:39], v[80:83], v[104:107], v[36:39]
    ds_read_b64_tr_b16 v[112:113], v8 offset:38912
    v_mfma_f32_16x16x32_bf16 v[40:43], v[96:99], v[84:87], v[40:43]
    ds_read_b64_tr_b16 v[114:115], v8 offset:39936
    v_mfma_f32_16x16x32_bf16 v[44:47], v[100:103], v[84:87], v[44:47]
    ds_read_b64_tr_b16 v[116:117], v9 offset:38912
    v_mfma_f32_16x16x32_bf16 v[48:51], v[84:87], v[104:107], v[48:51]
    ds_read_b64_tr_b16 v[118:119], v9 offset:39936
    v_mfma_f32_16x16x32_bf16 v[52:55], v[96:99], v[88:91], v[52:55]
    ds_read_b64_tr_b16 v[120:121], v10 offset:38912
    v_mfma_f32_16x16x32_bf16 v[56:59], v[100:103], v[88:91], v[56:59]
    ds_read_b64_tr_b16 v[122:123], v10 offset:39936
    v_mfma_f32_16x16x32_bf16 v[60:63], v[88:91], v[104:107], v[60:63]
    ds_read_b64_tr_b16 v[124:125], v11 offset:38912
    v_mfma_f32_16x16x32_bf16 v[64:67], v[96:99], v[92:95], v[64:67]
    ds_read_b64_tr_b16 v[126:127], v11 offset:39936
    v_mfma_f32_16x16x32_bf16 v[68:71], v[100:103], v[92:95], v[68:71]
    v_mfma_f32_16x16x32_bf16 v[72:75], v[92:95], v[104:107], v[72:75]
    s_waitcnt lgkmcnt(0)
    v_mfma_f32_16x16x32_bf16 v[20:23], v[132:135], v[108:111], v[20:23]
    v_mfma_f32_16x16x32_bf16 v[24:27], v[108:111], v[136:139], v[24:27]
    v_mfma_f32_16x16x32_bf16 v[28:31], v[128:131], v[112:115], v[28:31]
    v_mfma_f32_16x16x32_bf16 v[32:35], v[132:135], v[112:115], v[32:35]
    v_mfma_f32_16x16x32_bf16 v[36:39], v[112:115], v[136:139], v[36:39]
    v_mfma_f32_16x16x32_bf16 v[40:43], v[128:131], v[116:119], v[40:43]
    v_mfma_f32_16x16x32_bf16 v[44:47], v[132:135], v[116:119], v[44:47]
    v_mfma_f32_16x16x32_bf16 v[48:51], v[116:119], v[136:139], v[48:51]
    v_mfma_f32_16x16x32_bf16 v[52:55], v[128:131], v[120:123], v[52:55]
    v_mfma_f32_16x16x32_bf16 v[56:59], v[132:135], v[120:123], v[56:59]
    v_mfma_f32_16x16x32_bf16 v[60:63], v[120:123], v[136:139], v[60:63]
    v_mfma_f32_16x16x32_bf16 v[64:67], v[128:131], v[124:127], v[64:67]
    v_mfma_f32_16x16x32_bf16 v[68:71], v[132:135], v[124:127], v[68:71]
    v_mfma_f32_16x16x32_bf16 v[72:75], v[124:127], v[136:139], v[72:75]
c_loopdone:
    v_mov_b32 v2, 0
    buffer_load_dword v138, v2, s[8:11], s55 offen sc1
    s_lshl_b32 s33, s78, 2
    s_add_u32 s33, s33, 106368
    v_mov_b32 v3, s33
    s_barrier
    ds_read_b32 v3, v3
    ds_read_b64 v[76:77], v145 offset:0
    ds_read_b64 v[78:79], v145 offset:128
    ds_read_b64 v[80:81], v145 offset:256
    ds_read_b64 v[82:83], v145 offset:384
    ds_read_b64 v[84:85], v145 offset:512
    ds_read_b128 v[88:91], v146 offset:0
    ds_read_b128 v[92:95], v146 offset:320
    ds_read_b128 v[96:99], v146 offset:64
    ds_read_b128 v[100:103], v146 offset:384
    ds_read_b128 v[104:107], v146 offset:128
    ds_read_b128 v[108:111], v146 offset:448
    ds_read_b128 v[112:115], v146 offset:192
    ds_read_b128 v[116:119], v146 offset:512
    ds_read_b128 v[120:123], v146 offset:256
    ds_read_b128 v[124:127], v146 offset:576
    s_cmp_eq_u32 s52, 2
    s_cbranch_scc1 c_cs2
    v_mov_b32_dpp v128, v16 row_newbcast:0 row_mask:0xf bank_mask:0xf
    v_mov_b32_dpp v129, v17 row_newbcast:0 row_mask:0xf bank_mask:0xf
    v_mov_b32_dpp v130, v18 row_newbcast:0 row_mask:0xf bank_mask:0xf
    v_mov_b32_dpp v131, v19 row_newbcast:0 row_mask:0xf bank_mask:0xf
    v_mov_b32_dpp v132, v20 row_newbcast:0 row_mask:0xf bank_mask:0xf
    v_mov_b32_dpp v133, v21 row_newbcast:0 row_mask:0xf bank_mask:0xf
    v_mov_b32_dpp v134, v22 row_newbcast:0 row_mask:0xf bank_mask:0xf
    v_mov_b32_dpp v135, v23 row_newbcast:0 row_mask:0xf bank_mask:0xf
    v_mov_b32 v136, v24
    v_mov_b32 v137, v24
    s_nop 1
    v_permlane16_swap_b32 v136, v137
    v_mov_b32 v137, v136
    s_nop 1
    v_permlane32_swap_b32 v136, v137
    s_branch c_cs3
c_cs2:
    s_waitcnt lgkmcnt(15)
    v_readfirstlane_b32 s33, v3
    v_mov_b32 v128, v156
    v_mov_b32 v129, v157
    v_mov_b32 v130, v158
    v_mov_b32 v131, v159
    v_mov_b32 v132, v160
    v_mov_b32 v133, v161
    v_mov_b32 v134, v162
    v_mov_b32 v135, v163
    v_mov_b32 v136, v164
    s_cmp_eq_u32 s33, 0
    s_cbranch_scc1 c_cs3
    s_add_u32 s78, s78, 1
    s_cmp_lt_u32 s78, 8
    s_waitcnt lgkmcnt(0)
    s_cbranch_scc1 c_att_xt
    s_mov_b32 s78, 7
    s_nop 0
c_cs3:
    s_waitcnt lgkmcnt(10)
    v_pk_fma_f32 v[20:21], v[132:133], v[76:77], v[20:21] op_sel_hi:[1,0,1] neg_lo:[0,1,0] neg_hi:[0,1,0]
    v_pk_fma_f32 v[22:23], v[134:135], v[76:77], v[22:23] op_sel_hi:[1,0,1] neg_lo:[0,1,0] neg_hi:[0,1,0]
    v_pk_fma_f32 v[28:29], v[128:129], v[78:79], v[28:29] op_sel_hi:[1,0,1] neg_lo:[0,1,0] neg_hi:[0,1,0]
    v_pk_fma_f32 v[30:31], v[130:131], v[78:79], v[30:31] op_sel_hi:[1,0,1] neg_lo:[0,1,0] neg_hi:[0,1,0]
    v_pk_fma_f32 v[32:33], v[132:133], v[78:79], v[32:33] op_sel_hi:[1,0,1] neg_lo:[0,1,0] neg_hi:[0,1,0]
    v_pk_fma_f32 v[34:35], v[134:135], v[78:79], v[34:35] op_sel_hi:[1,0,1] neg_lo:[0,1,0] neg_hi:[0,1,0]
    v_pk_fma_f32 v[40:41], v[128:129], v[80:81], v[40:41] op_sel_hi:[1,0,1] neg_lo:[0,1,0] neg_hi:[0,1,0]
    v_pk_fma_f32 v[42:43], v[130:131], v[80:81], v[42:43] op_sel_hi:[1,0,1] neg_lo:[0,1,0] neg_hi:[0,1,0]
    v_pk_fma_f32 v[44:45], v[132:133], v[80:81], v[44:45] op_sel_hi:[1,0,1] neg_lo:[0,1,0] neg_hi:[0,1,0]
    v_pk_fma_f32 v[46:47], v[134:135], v[80:81], v[46:47] op_sel_hi:[1,0,1] neg_lo:[0,1,0] neg_hi:[0,1,0]
    v_pk_fma_f32 v[52:53], v[128:129], v[82:83], v[52:53] op_sel_hi:[1,0,1] neg_lo:[0,1,0] neg_hi:[0,1,0]
    v_pk_fma_f32 v[54:55], v[130:131], v[82:83], v[54:55] op_sel_hi:[1,0,1] neg_lo:[0,1,0] neg_hi:[0,1,0]
    v_pk_fma_f32 v[56:57], v[132:133], v[82:83], v[56:57] op_sel_hi:[1,0,1] neg_lo:[0,1,0] neg_hi:[0,1,0]
    v_pk_fma_f32 v[58:59], v[134:135], v[82:83], v[58:59] op_sel_hi:[1,0,1] neg_lo:[0,1,0] neg_hi:[0,1,0]
    v_pk_fma_f32 v[64:65], v[128:129], v[84:85], v[64:65] op_sel_hi:[1,0,1] neg_lo:[0,1,0] neg_hi:[0,1,0]
    v_pk_fma_f32 v[66:67], v[130:131], v[84:85], v[66:67] op_sel_hi:[1,0,1] neg_lo:[0,1,0] neg_hi:[0,1,0]
    v_pk_fma_f32 v[68:69], v[132:133], v[84:85], v[68:69] op_sel_hi:[1,0,1] neg_lo:[0,1,0] neg_hi:[0,1,0]
    v_pk_fma_f32 v[70:71], v[134:135], v[84:85], v[70:71] op_sel_hi:[1,0,1] neg_lo:[0,1,0] neg_hi:[0,1,0]
    v_pk_mul_f32 v[20:21], v[20:21], v[76:77] op_sel:[0,1] op_sel_hi:[1,1]
    v_pk_mul_f32 v[22:23], v[22:23], v[76:77] op_sel:[0,1] op_sel_hi:[1,1]
    v_pk_mul_f32 v[28:29], v[28:29], v[78:79] op_sel:[0,1] op_sel_hi:[1,1]
    v_pk_mul_f32 v[30:31], v[30:31], v[78:79] op_sel:[0,1] op_sel_hi:[1,1]
    v_pk_mul_f32 v[32:33], v[32:33], v[78:79] op_sel:[0,1] op_sel_hi:[1,1]
    v_pk_mul_f32 v[34:35], v[34:35], v[78:79] op_sel:[0,1] op_sel_hi:[1,1]
    v_pk_mul_f32 v[40:41], v[40:41], v[80:81] op_sel:[0,1] op_sel_hi:[1,1]
    v_pk_mul_f32 v[42:43], v[42:43], v[80:81] op_sel:[0,1] op_sel_hi:[1,1]
    v_pk_mul_f32 v[44:45], v[44:45], v[80:81] op_sel:[0,1] op_sel_hi:[1,1]
    v_pk_mul_f32 v[46:47], v[46:47], v[80:81] op_sel:[0,1] op_sel_hi:[1,1]
    v_pk_mul_f32 v[52:53], v[52:53], v[82:83] op_sel:[0,1] op_sel_hi:[1,1]
    v_pk_mul_f32 v[54:55], v[54:55], v[82:83] op_sel:[0,1] op_sel_hi:[1,1]
    v_pk_mul_f32 v[56:57], v[56:57], v[82:83] op_sel:[0,1] op_sel_hi:[1,1]
    v_pk_mul_f32 v[58:59], v[58:59], v[82:83] op_sel:[0,1] op_sel_hi:[1,1]
    v_pk_mul_f32 v[64:65], v[64:65], v[84:85] op_sel:[0,1] op_sel_hi:[1,1]
    v_pk_mul_f32 v[66:67], v[66:67], v[84:85] op_sel:[0,1] op_sel_hi:[1,1]
    v_pk_mul_f32 v[68:69], v[68:69], v[84:85] op_sel:[0,1] op_sel_hi:[1,1]
    v_pk_mul_f32 v[70:71], v[70:71], v[84:85] op_sel:[0,1] op_sel_hi:[1,1]
    v_cvt_pk_bf16_f32 v20, v20, v21
    v_cvt_pk_bf16_f32 v21, v22, v23
    v_cvt_pk_bf16_f32 v148, v28, v29
    v_cvt_pk_bf16_f32 v149, v30, v31
    v_cvt_pk_bf16_f32 v32, v32, v33
    v_cvt_pk_bf16_f32 v33, v34, v35
    v_cvt_pk_bf16_f32 v150, v40, v41
    v_cvt_pk_bf16_f32 v151, v42, v43
    v_cvt_pk_bf16_f32 v44, v44, v45
    v_cvt_pk_bf16_f32 v45, v46, v47
    v_cvt_pk_bf16_f32 v152, v52, v53
    v_cvt_pk_bf16_f32 v153, v54, v55
    v_cvt_pk_bf16_f32 v56, v56, v57
    v_cvt_pk_bf16_f32 v57, v58, v59
    v_cvt_pk_bf16_f32 v154, v64, v65
    v_cvt_pk_bf16_f32 v155, v66, v67
    v_cvt_pk_bf16_f32 v68, v68, v69
    v_cvt_pk_bf16_f32 v69, v70, v71
    s_waitcnt lgkmcnt(0)
    v_pk_fma_f32 v[24:25], v[88:89], v[136:137], v[24:25] op_sel_hi:[1,0,1] neg_lo:[1,0,0] neg_hi:[1,0,0]
    v_pk_fma_f32 v[26:27], v[90:91], v[136:137], v[26:27] op_sel_hi:[1,0,1] neg_lo:[1,0,0] neg_hi:[1,0,0]
    v_pk_fma_f32 v[36:37], v[96:97], v[136:137], v[36:37] op_sel_hi:[1,0,1] neg_lo:[1,0,0] neg_hi:[1,0,0]
    v_pk_fma_f32 v[38:39], v[98:99], v[136:137], v[38:39] op_sel_hi:[1,0,1] neg_lo:[1,0,0] neg_hi:[1,0,0]
    v_pk_fma_f32 v[48:49], v[104:105], v[136:137], v[48:49] op_sel_hi:[1,0,1] neg_lo:[1,0,0] neg_hi:[1,0,0]
    v_pk_fma_f32 v[50:51], v[106:107], v[136:137], v[50:51] op_sel_hi:[1,0,1] neg_lo:[1,0,0] neg_hi:[1,0,0]
    v_pk_fma_f32 v[60:61], v[112:113], v[136:137], v[60:61] op_sel_hi:[1,0,1] neg_lo:[1,0,0] neg_hi:[1,0,0]
    v_pk_fma_f32 v[62:63], v[114:115], v[136:137], v[62:63] op_sel_hi:[1,0,1] neg_lo:[1,0,0] neg_hi:[1,0,0]
    v_pk_fma_f32 v[72:73], v[120:121], v[136:137], v[72:73] op_sel_hi:[1,0,1] neg_lo:[1,0,0] neg_hi:[1,0,0]
    v_pk_fma_f32 v[74:75], v[122:123], v[136:137], v[74:75] op_sel_hi:[1,0,1] neg_lo:[1,0,0] neg_hi:[1,0,0]
    v_pk_mul_f32 v[24:25], v[24:25], v[92:93]
    v_pk_mul_f32 v[26:27], v[26:27], v[94:95]
    v_pk_mul_f32 v[36:37], v[36:37], v[100:101]
    v_pk_mul_f32 v[38:39], v[38:39], v[102:103]
    v_pk_mul_f32 v[48:49], v[48:49], v[108:109]
    v_pk_mul_f32 v[50:51], v[50:51], v[110:111]
    v_pk_mul_f32 v[60:61], v[60:61], v[116:117]
    v_pk_mul_f32 v[62:63], v[62:63], v[118:119]
    v_pk_mul_f32 v[72:73], v[72:73], v[124:125]
    v_pk_mul_f32 v[74:75], v[74:75], v[126:127]
    v_cvt_pk_bf16_f32 v156, v24, v25
    v_cvt_pk_bf16_f32 v157, v26, v27
    v_cvt_pk_bf16_f32 v158, v36, v37
    v_cvt_pk_bf16_f32 v159, v38, v39
    v_cvt_pk_bf16_f32 v160, v48, v49
    v_cvt_pk_bf16_f32 v161, v50, v51
    v_cvt_pk_bf16_f32 v162, v60, v61
    v_cvt_pk_bf16_f32 v163, v62, v63
    v_cvt_pk_bf16_f32 v164, v72, v73
    v_cvt_pk_bf16_f32 v165, v74, v75
    v_mfma_f32_16x16x16_bf16 v[28:31], v[32:33], v[148:149], 0
    v_mfma_f32_16x16x16_bf16 v[36:39], v[20:21], v[148:149], 0
    v_mfma_f32_16x16x16_bf16 v[40:43], v[44:45], v[150:151], 0
    v_mfma_f32_16x16x16_bf16 v[48:51], v[32:33], v[150:151], 0
    v_mfma_f32_16x16x16_bf16 v[52:55], v[56:57], v[152:153], 0
    v_mfma_f32_16x16x16_bf16 v[60:63], v[44:45], v[152:153], 0
    v_mfma_f32_16x16x16_bf16 v[64:67], v[68:69], v[154:155], 0
    v_mfma_f32_16x16x16_bf16 v[72:75], v[56:57], v[154:155], 0
    v_mov_b32 v2, 0xcf6e6b28
    s_mov_b32 s35, 0xffff0000
    s_mov_b32 s36, 0x3eb8aa3b
    s_lshl_b32 s34, s25, 2
    s_add_u32 s34, s34, s27
    s_lshl_b32 s34, s34, 11
    s_lshl_b32 s31, s24, 10
    s_add_u32 s34, s34, s31
    s_sub_u32 s53, s52, 1
    s_lshl_b32 s31, s53, 21
    s_add_u32 s34, s34, s31
    v_cndmask_b32 v76, v28, v29, s[42:43]
    v_cndmask_b32 v77, v30, v31, s[42:43]
    v_cndmask_b32 v78, v36, v37, s[42:43]
    v_cndmask_b32 v79, v38, v39, s[42:43]
    v_cndmask_b32 v78, v78, v2, s[48:49]
    v_cndmask_b32 v79, v79, v2, s[48:49]
    v_cndmask_b32 v84, v40, v41, s[42:43]
    v_cndmask_b32 v85, v42, v43, s[42:43]
    v_cndmask_b32 v86, v48, v49, s[42:43]
    v_cndmask_b32 v87, v50, v51, s[42:43]
    v_cndmask_b32 v92, v52, v53, s[42:43]
    v_cndmask_b32 v93, v54, v55, s[42:43]
    v_cndmask_b32 v94, v60, v61, s[42:43]
    v_cndmask_b32 v95, v62, v63, s[42:43]
    v_cndmask_b32 v100, v64, v65, s[42:43]
    v_cndmask_b32 v101, v66, v67, s[42:43]
    v_cndmask_b32 v102, v72, v73, s[42:43]
    v_cndmask_b32 v103, v74, v75, s[42:43]
    v_cndmask_b32 v76, v78, v76, s[44:45]
    v_cndmask_b32 v77, v79, v77, s[46:47]
    v_cndmask_b32 v84, v86, v84, s[44:45]
    v_cndmask_b32 v85, v87, v85, s[46:47]
    v_cndmask_b32 v92, v94, v92, s[44:45]
    v_cndmask_b32 v93, v95, v93, s[46:47]
    v_cndmask_b32 v100, v102, v100, s[44:45]
    v_cndmask_b32 v101, v103, v101, s[46:47]
    v_cvt_pk_bf16_f32 v78, v76, v77
    v_cvt_pk_bf16_f32 v86, v84, v85
    v_cvt_pk_bf16_f32 v94, v92, v93
    v_cvt_pk_bf16_f32 v102, v100, v101
    v_lshlrev_b32 v76, 16, v78
    v_and_b32 v77, s35, v78
    v_lshlrev_b32 v84, 16, v86
    v_and_b32 v85, s35, v86
    v_lshlrev_b32 v92, 16, v94
    v_and_b32 v93, s35, v94
    v_lshlrev_b32 v100, 16, v102
    v_and_b32 v101, s35, v102
    v_max_f32 v78, v76, v77
    v_max_f32 v86, v84, v85
    v_max_f32 v94, v92, v93
    v_max_f32 v102, v100, v101
    v_mov_b32 v79, v78
    v_mov_b32 v87, v86
    v_mov_b32 v95, v94
    v_mov_b32 v103, v102
    v_permlane16_swap_b32 v78, v79
    v_permlane16_swap_b32 v86, v87
    v_permlane16_swap_b32 v94, v95
    v_permlane16_swap_b32 v102, v103
    v_max_f32 v78, v78, v79
    v_max_f32 v86, v86, v87
    v_max_f32 v94, v94, v95
    v_max_f32 v102, v102, v103
    v_mov_b32 v79, v78
    v_mov_b32 v87, v86
    v_mov_b32 v95, v94
    v_mov_b32 v103, v102
    v_permlane32_swap_b32 v78, v79
    v_permlane32_swap_b32 v86, v87
    v_permlane32_swap_b32 v94, v95
    v_permlane32_swap_b32 v102, v103
    v_max_f32 v78, v78, v79
    v_max_f32 v86, v86, v87
    v_max_f32 v94, v94, v95
    v_max_f32 v102, v102, v103
    v_sub_f32 v76, v76, v78
    v_sub_f32 v77, v77, v78
    v_sub_f32 v84, v84, v86
    v_sub_f32 v85, v85, v86
    v_sub_f32 v92, v92, v94
    v_sub_f32 v93, v93, v94
    v_sub_f32 v100, v100, v102
    v_sub_f32 v101, v101, v102
    v_mul_f32 v76, s36, v76
    v_mul_f32 v77, s36, v77
    v_mul_f32 v84, s36, v84
    v_mul_f32 v85, s36, v85
    v_mul_f32 v92, s36, v92
    v_mul_f32 v93, s36, v93
    v_mul_f32 v100, s36, v100
    v_mul_f32 v101, s36, v101
    v_exp_f32 v76, v76
    v_exp_f32 v77, v77
    v_exp_f32 v84, v84
    v_exp_f32 v85, v85
    v_exp_f32 v92, v92
    v_exp_f32 v93, v93
    v_exp_f32 v100, v100
    v_exp_f32 v101, v101
    v_add_f32 v78, v76, v77
    v_add_f32 v86, v84, v85
    v_add_f32 v94, v92, v93
    v_add_f32 v102, v100, v101
    v_mov_b32 v79, v78
    v_mov_b32 v87, v86
    v_mov_b32 v95, v94
    v_mov_b32 v103, v102
    v_permlane16_swap_b32 v78, v79
    v_permlane16_swap_b32 v86, v87
    v_permlane16_swap_b32 v94, v95
    v_permlane16_swap_b32 v102, v103
    v_add_f32 v78, v78, v79
    v_add_f32 v86, v86, v87
    v_add_f32 v94, v94, v95
    v_add_f32 v102, v102, v103
    v_mov_b32 v79, v78
    v_mov_b32 v87, v86
    v_mov_b32 v95, v94
    v_mov_b32 v103, v102
    v_permlane32_swap_b32 v78, v79
    v_permlane32_swap_b32 v86, v87
    v_permlane32_swap_b32 v94, v95
    v_permlane32_swap_b32 v102, v103
    v_add_f32 v78, v78, v79
    v_add_f32 v86, v86, v87
    v_add_f32 v94, v94, v95
    v_add_f32 v102, v102, v103
    v_rcp_f32 v78, v78
    v_rcp_f32 v86, v86
    v_rcp_f32 v94, v94
    v_rcp_f32 v102, v102
    v_mul_f32 v76, v76, v78
    v_mul_f32 v77, v77, v78
    v_mul_f32 v84, v84, v86
    v_mul_f32 v85, v85, v86
    v_mul_f32 v92, v92, v94
    v_mul_f32 v93, v93, v94
    v_mul_f32 v100, v100, v102
    v_mul_f32 v101, v101, v102
    v_cvt_pk_bf16_f32 v78, v76, v77
    v_cvt_pk_bf16_f32 v86, v84, v85
    v_cvt_pk_bf16_f32 v94, v92, v93
    v_cvt_pk_bf16_f32 v102, v100, v101
    v_perm_b32 v80, v78, v78, v140
    v_perm_b32 v81, v78, v78, v141
    v_perm_b32 v82, v78, v78, v142
    v_perm_b32 v83, v78, v78, v143
    v_perm_b32 v88, v86, v86, v140
    v_perm_b32 v89, v86, v86, v141
    v_perm_b32 v90, v86, v86, v142
    v_perm_b32 v91, v86, v86, v143
    v_perm_b32 v96, v94, v94, v140
    v_perm_b32 v97, v94, v94, v141
    v_perm_b32 v98, v94, v94, v142
    v_perm_b32 v99, v94, v94, v143
    v_perm_b32 v104, v102, v102, v140
    v_perm_b32 v105, v102, v102, v141
    v_perm_b32 v106, v102, v102, v142
    v_perm_b32 v107, v102, v102, v143
    v_mfma_f32_16x16x32_bf16 v[28:31], v[156:159], v[80:83], 0
    v_mfma_f32_16x16x32_bf16 v[40:43], v[158:161], v[88:91], 0
    v_mfma_f32_16x16x32_bf16 v[52:55], v[160:163], v[96:99], 0
    v_mfma_f32_16x16x32_bf16 v[64:67], v[162:165], v[104:107], 0
    s_waitcnt vmcnt(0)
    v_readfirstlane_b32 s33, v138
    s_nop 2
    v_cvt_pk_bf16_f32 v76, v28, v29
    v_cvt_pk_bf16_f32 v77, v30, v31
    v_cvt_pk_bf16_f32 v78, v40, v41
    v_cvt_pk_bf16_f32 v79, v42, v43
    v_cvt_pk_bf16_f32 v84, v52, v53
    v_cvt_pk_bf16_f32 v85, v54, v55
    v_cvt_pk_bf16_f32 v86, v64, v65
    v_cvt_pk_bf16_f32 v87, v66, v67
    v_permlane16_swap_b32 v76, v78
    v_permlane16_swap_b32 v77, v79
    v_permlane16_swap_b32 v84, v86
    v_permlane16_swap_b32 v85, v87
    s_lshr_b32 s33, s33, s54
    s_and_b32 s33, s33, 15
    s_cmp_eq_u32 s33, 8
    s_cbranch_scc1 c_olocal
    buffer_store_dwordx4 v[76:79], v144, s[12:15], s34 offen offset:0 sc1
    buffer_store_dwordx4 v[84:87], v144, s[12:15], s34 offen offset:1024 sc1
    s_branch c_odone
c_olocal:
    buffer_store_dwordx4 v[76:79], v144, s[12:15], s34 offen offset:0
    buffer_store_dwordx4 v[84:87], v144, s[12:15], s34 offen offset:1024
c_odone:
    s_and_b32 s36, s25, 3
    s_lshr_b32 s37, s25, 2
    s_lshl_b32 s37, s37, 5
    s_add_u32 s37, s37, s24
    v_lshrrev_b32 v8, 3, v12
    v_lshlrev_b32 v8, 10, v8
    v_and_b32 v9, 7, v12
    v_lshl_add_u32 v8, v9, 7, v8
    v_lshrrev_b32 v9, 1, v12
    v_xor_b32 v9, v9, v13
    v_lshl_add_u32 v8, v9, 4, v8
    v_add_u32 v8, 73728, v8
    v_xor_b32 v9, 64, v8
    v_lshrrev_b32 v10, 5, v1
    v_lshlrev_b32 v10, 12, v10
    v_bfe_u32 v14, v1, 2, 3
    v_lshl_add_u32 v10, v14, 7, v10
    v_bfe_u32 v14, v1, 3, 2
    s_and_b32 s34, s27, 1
    s_lshl_b32 s34, s34, 1
    v_xor_b32 v14, s34, v14
    v_lshl_add_u32 v10, v14, 5, v10
    v_and_b32 v14, 3, v1
    v_lshl_add_u32 v10, v14, 3, v10
    s_lshr_b32 s34, s27, 1
    s_lshl_b32 s34, s34, 10
    v_add_u32 v10, s34, v10
    v_xor_b32 v11, 32, v10
    v_add_u32 v6, 0x10000, v10
    v_add_u32 v7, 0x10000, v11
    v_add_u32 v116, 0x20000, v10
    v_add_u32 v117, 0x20000, v11
    v_lshrrev_b32 v14, 2, v1
    v_lshlrev_b32 v72, 8, v14
    v_and_b32 v14, 7, v14
    s_lshl_b32 s34, s27, 1
    v_xor_b32 v14, s34, v14
    v_lshl_add_u32 v72, v14, 5, v72
    v_and_b32 v14, 3, v1
    v_lshl_add_u32 v72, v14, 3, v72
    v_xor_b32 v73, 32, v72
    s_lshl_b32 s34, s27, 5
    v_add_u32 v74, s34, v12
    v_mul_u32_u24 v74, 96, v74
    v_lshl_add_u32 v74, v13, 3, v74
    v_lshrrev_b32 v75, 2, v0
    v_and_b32 v14, 3, v0
    v_mul_u32_u24 v76, 96, v75
    v_lshl_add_u32 v76, v14, 4, v76
    v_lshrrev_b32 v75, 3, v0
    v_lshlrev_b32 v75, 13, v75
    v_and_b32 v14, 7, v0
    v_lshl_add_u32 v75, v14, 4, v75
    v_add_u32 v77, 0x40000, v75
    v_bfe_u32 v14, v1, 2, 2
    v_lshl_add_u32 v14, v13, 3, v14
    v_mul_u32_u24 v78, 96, v14
    v_and_b32 v14, 3, v1
    v_lshl_add_u32 v78, v14, 3, v78
    s_lshl_b32 s34, s27, 5
    v_add_u32 v78, s34, v78
    s_lshl_b32 s34, s27, 11
    v_lshlrev_b32 v79, 6, v12
    v_lshl_add_u32 v79, v13, 3, v79
    v_add_u32 v79, s34, v79
    v_add_u32 v72, 106496, v72
    v_add_u32 v73, 106496, v73
    v_add_u32 v74, 106496, v74
    v_add_u32 v76, 106496, v76
    v_add_u32 v78, 106496, v78
    v_add_u32 v79, 106496, v79
    v_and_b32 v14, 2, v12
    v_cmp_eq_u32 s[50:51], 2, v14
    v_mov_b32 v80, 0x3f803f80
    v_mov_b32 v81, 0x3f803f80
    v_mov_b32 v82, 0x3f803f80
    v_mov_b32 v83, 0x3f803f80
    s_lshl_b32 s38, s36, 19
    s_lshl_b32 s34, s37, 2
    s_add_u32 s38, s38, s34
    s_lshl_b32 s34, s53, 21
    s_add_u32 s38, s38, s34
    s_add_u32 s38, s38, 4194304
    s_lshl_b32 s39, s36, 14
    s_lshl_b32 s34, s37, 3
    s_add_u32 s39, s39, s34
    s_lshl_b32 s34, s27, 7
    s_add_u32 s39, s39, s34
    s_lshl_b32 s34, s53, 16
    s_add_u32 s39, s39, s34
    s_add_u32 s39, s39, 11534336
    v_lshlrev_b32 v4, 3, v12
    v_lshlrev_b32 v118, 3, v1
    s_setprio 1
    s_barrier
    s_barrier
    ds_read_b128 v[40:43], v8 offset:0
    ds_read_b128 v[44:47], v8 offset:2048
    ds_read_b64_tr_b16 v[48:49], v6 offset:40960
    ds_read_b64_tr_b16 v[50:51], v6 offset:43008
    ds_read_b64_tr_b16 v[52:53], v7 offset:40960
    ds_read_b64_tr_b16 v[54:55], v7 offset:43008
    ds_read_b128 v[56:59], v9 offset:0
    ds_read_b128 v[60:63], v9 offset:2048
    ds_read_b64_tr_b16 v[64:65], v6 offset:49152
    ds_read_b64_tr_b16 v[66:67], v6 offset:51200
    ds_read_b64_tr_b16 v[68:69], v7 offset:49152
    ds_read_b64_tr_b16 v[70:71], v7 offset:51200
    s_mov_b64 exec, 0xffffffff
    buffer_load_dword v119, v118, s[8:11], 0 offen sc1
    s_mov_b64 exec, -1
    s_waitcnt lgkmcnt(6)
    v_mfma_f32_16x16x32_bf16 v[24:27], v[40:43], v[48:51], 0
    ds_read_b128 v[84:87], v8 offset:4096
    ds_read_b128 v[88:91], v8 offset:6144
    v_mfma_f32_16x16x32_bf16 v[28:31], v[40:43], v[52:55], 0
    ds_read_b64_tr_b16 v[92:93], v6 offset:57344
    ds_read_b64_tr_b16 v[94:95], v6 offset:59392
    v_mfma_f32_16x16x32_bf16 v[32:35], v[44:47], v[48:51], 0
    ds_read_b64_tr_b16 v[96:97], v7 offset:57344
    ds_read_b64_tr_b16 v[98:99], v7 offset:59392
    v_mfma_f32_16x16x32_bf16 v[36:39], v[44:47], v[52:55], 0
    s_waitcnt lgkmcnt(6)
    v_mfma_f32_16x16x32_bf16 v[24:27], v[56:59], v[64:67], v[24:27]
    ds_read_b128 v[100:103], v9 offset:4096
    ds_read_b128 v[104:107], v9 offset:6144
    v_mfma_f32_16x16x32_bf16 v[28:31], v[56:59], v[68:71], v[28:31]
    ds_read_b64_tr_b16 v[108:109], v116 offset:0
    ds_read_b64_tr_b16 v[110:111], v116 offset:2048
    v_mfma_f32_16x16x32_bf16 v[32:35], v[60:63], v[64:67], v[32:35]
    ds_read_b64_tr_b16 v[112:113], v117 offset:0
    ds_read_b64_tr_b16 v[114:115], v117 offset:2048
    v_mfma_f32_16x16x32_bf16 v[36:39], v[60:63], v[68:71], v[36:39]
    s_waitcnt lgkmcnt(6)
    v_mfma_f32_16x16x32_bf16 v[24:27], v[84:87], v[92:95], v[24:27]
    ds_read_b128 v[40:43], v8 offset:8192
    ds_read_b128 v[44:47], v8 offset:10240
    v_mfma_f32_16x16x32_bf16 v[28:31], v[84:87], v[96:99], v[28:31]
    ds_read_b64_tr_b16 v[48:49], v116 offset:8192
    ds_read_b64_tr_b16 v[50:51], v116 offset:10240
    v_mfma_f32_16x16x32_bf16 v[32:35], v[88:91], v[92:95], v[32:35]
    ds_read_b64_tr_b16 v[52:53], v117 offset:8192
    ds_read_b64_tr_b16 v[54:55], v117 offset:10240
    v_mfma_f32_16x16x32_bf16 v[36:39], v[88:91], v[96:99], v[36:39]
    s_waitcnt lgkmcnt(6)
    v_mfma_f32_16x16x32_bf16 v[24:27], v[100:103], v[108:111], v[24:27]
    ds_read_b128 v[56:59], v9 offset:8192
    ds_read_b128 v[60:63], v9 offset:10240
    v_mfma_f32_16x16x32_bf16 v[28:31], v[100:103], v[112:115], v[28:31]
    ds_read_b64_tr_b16 v[64:65], v116 offset:16384
    ds_read_b64_tr_b16 v[66:67], v116 offset:18432
    v_mfma_f32_16x16x32_bf16 v[32:35], v[104:107], v[108:111], v[32:35]
    ds_read_b64_tr_b16 v[68:69], v117 offset:16384
    ds_read_b64_tr_b16 v[70:71], v117 offset:18432
    v_mfma_f32_16x16x32_bf16 v[36:39], v[104:107], v[112:115], v[36:39]
    s_waitcnt lgkmcnt(6)
    v_mfma_f32_16x16x32_bf16 v[24:27], v[40:43], v[48:51], v[24:27]
    ds_read_b128 v[84:87], v8 offset:12288
    ds_read_b128 v[88:91], v8 offset:14336
    v_mfma_f32_16x16x32_bf16 v[28:31], v[40:43], v[52:55], v[28:31]
    ds_read_b64_tr_b16 v[92:93], v116 offset:24576
    ds_read_b64_tr_b16 v[94:95], v116 offset:26624
    v_mfma_f32_16x16x32_bf16 v[32:35], v[44:47], v[48:51], v[32:35]
    ds_read_b64_tr_b16 v[96:97], v117 offset:24576
    ds_read_b64_tr_b16 v[98:99], v117 offset:26624
    v_mfma_f32_16x16x32_bf16 v[36:39], v[44:47], v[52:55], v[36:39]
    s_barrier
    s_waitcnt lgkmcnt(6)
    v_mfma_f32_16x16x32_bf16 v[24:27], v[56:59], v[64:67], v[24:27]
    ds_read_b128 v[100:103], v9 offset:12288
    ds_read_b128 v[104:107], v9 offset:14336
    v_mfma_f32_16x16x32_bf16 v[28:31], v[56:59], v[68:71], v[28:31]
    ds_read_b64_tr_b16 v[108:109], v10 offset:0
    ds_read_b64_tr_b16 v[110:111], v10 offset:2048
    v_mfma_f32_16x16x32_bf16 v[32:35], v[60:63], v[64:67], v[32:35]
    ds_read_b64_tr_b16 v[112:113], v11 offset:0
    ds_read_b64_tr_b16 v[114:115], v11 offset:2048
    v_mfma_f32_16x16x32_bf16 v[36:39], v[60:63], v[68:71], v[36:39]
    s_waitcnt lgkmcnt(6)
    v_mfma_f32_16x16x32_bf16 v[24:27], v[84:87], v[92:95], v[24:27]
    ds_read_b128 v[40:43], v8 offset:16384
    ds_read_b128 v[44:47], v8 offset:18432
    v_mfma_f32_16x16x32_bf16 v[28:31], v[84:87], v[96:99], v[28:31]
    ds_read_b64_tr_b16 v[48:49], v10 offset:8192
    ds_read_b64_tr_b16 v[50:51], v10 offset:10240
    v_mfma_f32_16x16x32_bf16 v[32:35], v[88:91], v[92:95], v[32:35]
    ds_read_b64_tr_b16 v[52:53], v11 offset:8192
    ds_read_b64_tr_b16 v[54:55], v11 offset:10240
    v_mfma_f32_16x16x32_bf16 v[36:39], v[88:91], v[96:99], v[36:39]
    s_waitcnt lgkmcnt(6)
    v_mfma_f32_16x16x32_bf16 v[24:27], v[100:103], v[108:111], v[24:27]
    ds_read_b128 v[56:59], v9 offset:16384
    ds_read_b128 v[60:63], v9 offset:18432
    v_mfma_f32_16x16x32_bf16 v[28:31], v[100:103], v[112:115], v[28:31]
    ds_read_b64_tr_b16 v[64:65], v10 offset:16384
    ds_read_b64_tr_b16 v[66:67], v10 offset:18432
    v_mfma_f32_16x16x32_bf16 v[32:35], v[104:107], v[108:111], v[32:35]
    ds_read_b64_tr_b16 v[68:69], v11 offset:16384
    ds_read_b64_tr_b16 v[70:71], v11 offset:18432
    v_mfma_f32_16x16x32_bf16 v[36:39], v[104:107], v[112:115], v[36:39]
    s_waitcnt lgkmcnt(6)
    v_mfma_f32_16x16x32_bf16 v[24:27], v[40:43], v[48:51], v[24:27]
    ds_read_b128 v[84:87], v8 offset:20480
    ds_read_b128 v[88:91], v8 offset:22528
    v_mfma_f32_16x16x32_bf16 v[28:31], v[40:43], v[52:55], v[28:31]
    ds_read_b64_tr_b16 v[92:93], v10 offset:24576
    ds_read_b64_tr_b16 v[94:95], v10 offset:26624
    v_mfma_f32_16x16x32_bf16 v[32:35], v[44:47], v[48:51], v[32:35]
    ds_read_b64_tr_b16 v[96:97], v11 offset:24576
    ds_read_b64_tr_b16 v[98:99], v11 offset:26624
    v_mfma_f32_16x16x32_bf16 v[36:39], v[44:47], v[52:55], v[36:39]
    s_waitcnt lgkmcnt(6)
    v_mfma_f32_16x16x32_bf16 v[24:27], v[56:59], v[64:67], v[24:27]
    ds_read_b128 v[100:103], v9 offset:20480
    ds_read_b128 v[104:107], v9 offset:22528
    v_mfma_f32_16x16x32_bf16 v[28:31], v[56:59], v[68:71], v[28:31]
    ds_read_b64_tr_b16 v[108:109], v10 offset:32768
    ds_read_b64_tr_b16 v[110:111], v10 offset:34816
    v_mfma_f32_16x16x32_bf16 v[32:35], v[60:63], v[64:67], v[32:35]
    ds_read_b64_tr_b16 v[112:113], v11 offset:32768
    ds_read_b64_tr_b16 v[114:115], v11 offset:34816
    v_mfma_f32_16x16x32_bf16 v[36:39], v[60:63], v[68:71], v[36:39]
    s_waitcnt lgkmcnt(6)
    v_mfma_f32_16x16x32_bf16 v[24:27], v[84:87], v[92:95], v[24:27]
    ds_read_b128 v[40:43], v8 offset:24576
    ds_read_b128 v[44:47], v8 offset:26624
    v_mfma_f32_16x16x32_bf16 v[28:31], v[84:87], v[96:99], v[28:31]
    ds_read_b64_tr_b16 v[48:49], v10 offset:40960
    ds_read_b64_tr_b16 v[50:51], v10 offset:43008
    v_mfma_f32_16x16x32_bf16 v[32:35], v[88:91], v[92:95], v[32:35]
    ds_read_b64_tr_b16 v[52:53], v11 offset:40960
    ds_read_b64_tr_b16 v[54:55], v11 offset:43008
    v_mfma_f32_16x16x32_bf16 v[36:39], v[88:91], v[96:99], v[36:39]
    s_waitcnt lgkmcnt(6)
    v_mfma_f32_16x16x32_bf16 v[24:27], v[100:103], v[108:111], v[24:27]
    ds_read_b128 v[56:59], v9 offset:24576
    ds_read_b128 v[60:63], v9 offset:26624
    v_mfma_f32_16x16x32_bf16 v[28:31], v[100:103], v[112:115], v[28:31]
    ds_read_b64_tr_b16 v[64:65], v10 offset:49152
    ds_read_b64_tr_b16 v[66:67], v10 offset:51200
    v_mfma_f32_16x16x32_bf16 v[32:35], v[104:107], v[108:111], v[32:35]
    ds_read_b64_tr_b16 v[68:69], v11 offset:49152
    ds_read_b64_tr_b16 v[70:71], v11 offset:51200
    v_mfma_f32_16x16x32_bf16 v[36:39], v[104:107], v[112:115], v[36:39]
    s_waitcnt lgkmcnt(6)
    v_mfma_f32_16x16x32_bf16 v[24:27], v[40:43], v[48:51], v[24:27]
    ds_read_b128 v[84:87], v8 offset:28672
    ds_read_b128 v[88:91], v8 offset:30720
    v_mfma_f32_16x16x32_bf16 v[28:31], v[40:43], v[52:55], v[28:31]
    ds_read_b64_tr_b16 v[92:93], v10 offset:57344
    ds_read_b64_tr_b16 v[94:95], v10 offset:59392
    v_mfma_f32_16x16x32_bf16 v[32:35], v[44:47], v[48:51], v[32:35]
    ds_read_b64_tr_b16 v[96:97], v11 offset:57344
    ds_read_b64_tr_b16 v[98:99], v11 offset:59392
    v_mfma_f32_16x16x32_bf16 v[36:39], v[44:47], v[52:55], v[36:39]
    s_waitcnt lgkmcnt(6)
    v_mfma_f32_16x16x32_bf16 v[24:27], v[56:59], v[64:67], v[24:27]
    ds_read_b128 v[100:103], v9 offset:28672
    ds_read_b128 v[104:107], v9 offset:30720
    v_mfma_f32_16x16x32_bf16 v[28:31], v[56:59], v[68:71], v[28:31]
    ds_read_b64_tr_b16 v[108:109], v6 offset:0
    ds_read_b64_tr_b16 v[110:111], v6 offset:2048
    v_mfma_f32_16x16x32_bf16 v[32:35], v[60:63], v[64:67], v[32:35]
    ds_read_b64_tr_b16 v[112:113], v7 offset:0
    ds_read_b64_tr_b16 v[114:115], v7 offset:2048
    v_mfma_f32_16x16x32_bf16 v[36:39], v[60:63], v[68:71], v[36:39]
    s_waitcnt lgkmcnt(6)
    v_mfma_f32_16x16x32_bf16 v[24:27], v[84:87], v[92:95], v[24:27]
    v_mfma_f32_16x16x32_bf16 v[28:31], v[84:87], v[96:99], v[28:31]
    v_mfma_f32_16x16x32_bf16 v[32:35], v[88:91], v[92:95], v[32:35]
    v_mfma_f32_16x16x32_bf16 v[36:39], v[88:91], v[96:99], v[36:39]
    s_waitcnt lgkmcnt(0)
    v_mfma_f32_16x16x32_bf16 v[24:27], v[100:103], v[108:111], v[24:27]
    v_mfma_f32_16x16x32_bf16 v[28:31], v[100:103], v[112:115], v[28:31]
    v_mfma_f32_16x16x32_bf16 v[32:35], v[104:107], v[108:111], v[32:35]
    v_mfma_f32_16x16x32_bf16 v[36:39], v[104:107], v[112:115], v[36:39]
    s_nop 4
    v_cvt_pk_bf16_f32 v48, v24, v25
    v_cvt_pk_bf16_f32 v49, v26, v27
    v_cvt_pk_bf16_f32 v50, v28, v29
    v_cvt_pk_bf16_f32 v51, v30, v31
    v_cvt_pk_bf16_f32 v52, v32, v33
    v_cvt_pk_bf16_f32 v53, v34, v35
    v_cvt_pk_bf16_f32 v54, v36, v37
    v_cvt_pk_bf16_f32 v55, v38, v39
    s_barrier
    s_cmp_eq_u32 s52, 2
    s_cbranch_scc1 c_resxt
    ds_read_b64_tr_b16 v[120:121], v72 offset:0
    ds_read_b64_tr_b16 v[122:123], v73 offset:0
    ds_read_b64_tr_b16 v[124:125], v72 offset:4096
    ds_read_b64_tr_b16 v[126:127], v73 offset:4096
    s_branch c_havres
c_resxt:
    ds_read_b64 v[120:121], v79 offset:0
    ds_read_b64 v[122:123], v79 offset:1024
    ds_read_b64 v[124:125], v79 offset:32
    ds_read_b64 v[126:127], v79 offset:1056
c_havres:
    v_lshlrev_b32 v24, 16, v48
    v_and_b32 v25, s35, v48
    v_lshlrev_b32 v26, 16, v49
    v_and_b32 v27, s35, v49
    v_lshlrev_b32 v28, 16, v50
    v_and_b32 v29, s35, v50
    v_lshlrev_b32 v30, 16, v51
    v_and_b32 v31, s35, v51
    v_lshlrev_b32 v32, 16, v52
    v_and_b32 v33, s35, v52
    v_lshlrev_b32 v34, 16, v53
    v_and_b32 v35, s35, v53
    v_lshlrev_b32 v36, 16, v54
    v_and_b32 v37, s35, v54
    v_lshlrev_b32 v38, 16, v55
    v_and_b32 v39, s35, v55
    s_waitcnt lgkmcnt(0)
    v_lshlrev_b32 v56, 16, v120
    v_and_b32 v57, s35, v120
    v_lshlrev_b32 v58, 16, v121
    v_and_b32 v59, s35, v121
    v_lshlrev_b32 v60, 16, v122
    v_and_b32 v61, s35, v122
    v_lshlrev_b32 v62, 16, v123
    v_and_b32 v63, s35, v123
    v_lshlrev_b32 v64, 16, v124
    v_and_b32 v65, s35, v124
    v_lshlrev_b32 v66, 16, v125
    v_and_b32 v67, s35, v125
    v_lshlrev_b32 v68, 16, v126
    v_and_b32 v69, s35, v126
    v_lshlrev_b32 v70, 16, v127
    v_and_b32 v71, s35, v127
    v_pk_add_f32 v[24:25], v[24:25], v[56:57]
    v_pk_add_f32 v[26:27], v[26:27], v[58:59]
    v_pk_add_f32 v[28:29], v[28:29], v[60:61]
    v_pk_add_f32 v[30:31], v[30:31], v[62:63]
    v_pk_add_f32 v[32:33], v[32:33], v[64:65]
    v_pk_add_f32 v[34:35], v[34:35], v[66:67]
    v_pk_add_f32 v[36:37], v[36:37], v[68:69]
    v_pk_add_f32 v[38:39], v[38:39], v[70:71]
    v_cvt_pk_bf16_f32 v48, v24, v25
    v_cvt_pk_bf16_f32 v49, v26, v27
    ds_write_b64 v74, v[48:49] offset:8192
    v_cvt_pk_bf16_f32 v50, v28, v29
    v_cvt_pk_bf16_f32 v51, v30, v31
    ds_write_b64 v74, v[50:51] offset:9728
    v_cvt_pk_bf16_f32 v52, v32, v33
    v_cvt_pk_bf16_f32 v53, v34, v35
    ds_write_b64 v74, v[52:53] offset:8224
    v_cvt_pk_bf16_f32 v54, v36, v37
    v_cvt_pk_bf16_f32 v55, v38, v39
    ds_write_b64 v74, v[54:55] offset:9760
    v_mov_b32 v2, 126988
    v_mov_b32 v3, 1
    s_waitcnt vmcnt(0) lgkmcnt(0)
    s_mov_b64 exec, 1
    ds_add_u32 v2, v3
    s_mov_b64 exec, -1
    s_mov_b32 s34, 0
c_sy:
    ds_read_b32 v3, v2
    s_add_u32 s34, s34, 1
    s_waitcnt lgkmcnt(0)
    v_readfirstlane_b32 s33, v3
    s_cmp_gt_u32 s34, 32768
    s_cbranch_scc1 c_syd
    s_cmp_lt_u32 s33, 4
    s_cbranch_scc1 c_sy
c_syd:
    ds_read_b128 v[24:27], v76 offset:8192
    ds_read_b128 v[28:31], v76 offset:14336
    s_cmp_lt_u32 s27, 2
    s_cbranch_scc0 c_nostats
    ds_read_b64_tr_b16 v[40:41], v78 offset:8192
    ds_read_b64_tr_b16 v[42:43], v78 offset:8576
    ds_read_b64_tr_b16 v[44:45], v78 offset:11264
    ds_read_b64_tr_b16 v[46:47], v78 offset:11648
    ds_read_b64_tr_b16 v[48:49], v78 offset:14336
    ds_read_b64_tr_b16 v[50:51], v78 offset:14720
    ds_read_b64_tr_b16 v[52:53], v78 offset:17408
    ds_read_b64_tr_b16 v[54:55], v78 offset:17792
    s_waitcnt lgkmcnt(8)
    buffer_store_dwordx4 v[24:27], v75, s[12:15], s38 offen sc1
    buffer_store_dwordx4 v[28:31], v77, s[12:15], s38 offen sc1
    s_waitcnt lgkmcnt(6)
    v_mfma_f32_16x16x32_bf16 v[56:59], v[40:43], v[80:83], 0
    v_mfma_f32_16x16x32_bf16 v[60:63], v[40:43], v[40:43], 0
    s_waitcnt lgkmcnt(4)
    v_mfma_f32_16x16x32_bf16 v[56:59], v[44:47], v[80:83], v[56:59]
    v_mfma_f32_16x16x32_bf16 v[60:63], v[44:47], v[44:47], v[60:63]
    s_waitcnt lgkmcnt(2)
    v_mfma_f32_16x16x32_bf16 v[56:59], v[48:51], v[80:83], v[56:59]
    v_mfma_f32_16x16x32_bf16 v[60:63], v[48:51], v[48:51], v[60:63]
    s_waitcnt lgkmcnt(0)
    v_mfma_f32_16x16x32_bf16 v[56:59], v[52:55], v[80:83], v[56:59]
    v_mfma_f32_16x16x32_bf16 v[60:63], v[52:55], v[52:55], v[60:63]
    s_mov_b32 s40, 0x00f0000f
    s_mov_b32 s41, 0xf0000f00
    s_nop 4
    v_cndmask_b32 v64, v56, v57, s[42:43]
    v_cndmask_b32 v65, v58, v59, s[42:43]
    v_cndmask_b32 v66, v60, v61, s[42:43]
    v_cndmask_b32 v67, v62, v63, s[42:43]
    v_cndmask_b32 v64, v64, v65, s[50:51]
    v_cndmask_b32 v65, v66, v67, s[50:51]
    s_mov_b64 exec, s[40:41]
    buffer_store_dwordx2 v[64:65], v4, s[12:15], s39 offen sc1
    s_mov_b64 exec, -1
    s_branch c_conv
c_nostats:
    s_waitcnt lgkmcnt(0)
    buffer_store_dwordx4 v[24:27], v75, s[12:15], s38 offen sc1
    buffer_store_dwordx4 v[28:31], v77, s[12:15], s38 offen sc1
c_conv:
    s_setprio 2
    s_cmp_eq_u32 s52, 2
    s_cbranch_scc1 c_nopre
    v_lshrrev_b32 v6, 5, v1
    v_mul_u32_u24 v6, 6144, v6
    v_bfe_u32 v8, v1, 2, 3
    v_lshl_add_u32 v6, v8, 7, v6
    v_bfe_u32 v8, v1, 3, 2
    v_xor_b32 v8, s27, v8
    v_lshl_add_u32 v6, v8, 5, v6
    v_and_b32 v8, 3, v1
    v_lshl_add_u32 v6, v8, 3, v6
    v_add_u32 v6, 10240, v6
    v_add_u32 v7, 69632, v6
    v_and_b32 v2, 1, v12
    v_lshl_add_u32 v3, v13, 2, v2
    v_cmp_eq_u32 s[42:43], 1, v2
    v_cmp_le_u32 s[44:45], v3, v12
    v_add_u32 v3, 2, v3
    v_cmp_le_u32 s[46:47], v3, v12
    s_cmp_eq_u32 s24, 0
    s_cselect_b64 s[48:49], -1, 0
    v_mov_b32 v156, v128
    v_mov_b32 v157, v129
    v_mov_b32 v158, v130
    v_mov_b32 v159, v131
    v_mov_b32 v160, v132
    v_mov_b32 v161, v133
    v_mov_b32 v162, v134
    v_mov_b32 v163, v135
    v_mov_b32 v164, v136
    v_lshrrev_b32 v2, 5, v1
    v_lshlrev_b32 v2, 4, v2
    v_bfe_u32 v3, v1, 2, 3
    v_add_u32 v2, v2, v3
    v_and_b32 v3, 3, v1
    v_lshlrev_b32 v3, 3, v3
    v_lshl_add_u32 v147, v2, 5, v3
    v_add_u32 v147, 0x2000, v147
    v_add_u32 v166, 69632, v147
    v_lshl_add_u32 v8, v2, 7, v3
    v_bfe_u32 v3, v1, 3, 2
    v_lshl_add_u32 v8, v3, 5, v8
    v_xor_b32 v9, 32, v8
    v_xor_b32 v10, 64, v8
    v_xor_b32 v11, 96, v8
    v_add_u32 v14, 69632, v8
    v_add_u32 v15, 69632, v9
    v_add_u32 v148, 69632, v10
    v_add_u32 v149, 69632, v11
    s_mov_b32 s34, 0
    s_mov_b64 exec, 0xffffffff
c_arr:
    v_lshrrev_b32 v3, 4, v119
    v_and_b32 v3, 0x0f0f0f0f, v3
    v_and_b32 v2, 0x0f0f0f0f, v119
    v_add_u32 v2, v2, v3
    v_lshrrev_b32 v3, 16, v2
    v_add_u32 v2, v2, v3
    v_lshrrev_b32 v3, 8, v2
    v_add_u32 v2, v2, v3
    v_and_b32 v2, 0xff, v2
    v_cmp_ne_u32 vcc, 8, v2
    s_add_u32 s34, s34, 1
    s_cmp_gt_u32 s34, 32768
    s_cbranch_scc1 c_arrd
    s_nop 2
    s_cbranch_vccz c_arrd
    buffer_load_dword v119, v118, s[8:11], 0 offen sc1
    s_waitcnt vmcnt(0)
    s_branch c_arr
c_arrd:
    s_mov_b64 exec, -1
c_nopre:
    v_lshrrev_b32 v128, 4, v0
    v_lshlrev_b32 v128, 7, v128
    v_lshl_add_u32 v128, v12, 2, v128
    v_lshlrev_b32 v129, 4, v0
    s_lshl_b32 s28, s77, 13
    s_lshl_b32 s29, s53, 21
    s_add_u32 s28, s28, s29
    s_add_u32 s28, s28, 4194304
    s_add_u32 s29, s28, 4096
    s_lshl_b32 s30, s53, 16
    s_add_u32 s30, s30, 11534336
    buffer_load_dword v80, v128, s[12:15], s28 offen offset:0 sc1
    buffer_load_dword v81, v128, s[12:15], s28 offen offset:64 sc1
    s_add_u32 s31, s30, 0
    buffer_load_dwordx4 v[16:19], v129, s[12:15], s31 offen sc1
    s_add_u32 s31, s30, 16384
    buffer_load_dwordx4 v[20:23], v129, s[12:15], s31 offen sc1
    s_add_u32 s31, s30, 32768
    buffer_load_dwordx4 v[24:27], v129, s[12:15], s31 offen sc1
    s_add_u32 s31, s30, 49152
    buffer_load_dwordx4 v[28:31], v129, s[12:15], s31 offen sc1
    v_lshlrev_b32 v130, 2, v0
    v_add_u32 v130, 150528, v130
    v_lshrrev_b32 v131, 7, v0
    v_mul_u32_u24 v131, 1280, v131
    v_bfe_u32 v2, v0, 1, 2
    v_mul_u32_u24 v2, 320, v2
    v_bfe_u32 v3, v0, 3, 4
    v_lshl_add_u32 v2, v3, 4, v2
    v_and_b32 v3, 1, v0
    v_lshl_add_u32 v2, v3, 3, v2
    v_add_u32 v131, v131, v2
    v_add_u32 v131, 69632, v131
    v_mov_b32 v133, 0x3727c5ac
    s_mov_b32 s41, 0x3b000000
    s_lshl_b32 s36, s76, 16
    s_and_b32 s37, s76, 0xffff0000
    s_cmp_eq_u32 s52, 2
    s_cbranch_scc1 c_o2
    s_add_u32 s4, s66, 0x00800000
    s_addc_u32 s5, s67, 0
    s_mov_b32 s6, 0x00280000
    s_mov_b32 s7, 0x00020000
    v_lshrrev_b32 v132, 5, v0
    v_lshlrev_b32 v132, 14, v132
    v_and_b32 v2, 7, v0
    v_lshl_add_u32 v132, v2, 2, v132
    v_lshlrev_b32 v4, 2, v0
    s_lshl_b32 s38, s77, 13
    s_add_u32 s39, s38, 4096
    s_lshl_b32 s40, s77, 6
    s_add_u32 s40, s40, 2097152
    s_mov_b32 s50, 0xff000000
    s_mov_b32 s51, 0xff000000
    s_branch c_o3
c_o2:
    s_mov_b32 s4, s74
    s_mov_b32 s5, s75
    s_mov_b32 s6, 0x00200000
    s_mov_b32 s7, 0x00020000
    v_lshlrev_b32 v4, 11, v0
    s_lshl_b32 s38, s77, 2
c_o3:
    s_mov_b32 s34, 0
    s_waitcnt vmcnt(0)
c_n0:
    v_add_f32 v16, v16, v20
    v_add_f32 v24, v24, v28
    v_add_f32 v17, v17, v21
    v_add_f32 v25, v25, v29
    v_add_f32 v18, v18, v22
    v_add_f32 v26, v26, v30
    v_add_f32 v19, v19, v23
    v_add_f32 v27, v27, v31
    v_add_f32 v16, v16, v24
    v_add_f32 v17, v17, v25
    v_add_f32 v18, v18, v26
    v_add_f32 v19, v19, v27
    v_mul_f32 v16, s41, v16
    v_fma_f32 v17, v17, s41, v133
    v_mul_f32 v18, s41, v18
    v_fma_f32 v19, v19, s41, v133
    v_fma_f32 v17, -v16, v16, v17
    v_fma_f32 v19, -v18, v18, v19
    v_max_f32 v17, v133, v17
    v_max_f32 v19, v133, v19
    v_sqrt_f32 v17, v17
    v_sqrt_f32 v19, v19
    v_lshlrev_b32 v96, 16, v80
    v_and_b32 v97, s35, v80
    v_lshlrev_b32 v98, 16, v81
    v_and_b32 v99, s35, v81
    v_cvt_pk_bf16_f32 v17, v17, v19
    v_sub_f32 v96, v96, v16
    v_sub_f32 v97, v97, v18
    v_sub_f32 v98, v98, v16
    v_sub_f32 v99, v99, v18
    v_and_b32 v19, s35, v17
    v_lshlrev_b32 v17, 16, v17
    v_rcp_f32 v19, v19
    v_rcp_f32 v17, v17
    v_cmp_u_f32 vcc, v96, v97
    v_cmp_u_f32 s[32:33], v98, v99
    v_mul_f32 v96, v96, v17
    v_mul_f32 v97, v97, v19
    v_mul_f32 v98, v98, v17
    v_mul_f32 v99, v99, v19
    s_or_b64 vcc, vcc, s[32:33]
    s_cbranch_vccz c_n0_ok
    s_add_u32 s34, s34, 1
    s_cmp_gt_u32 s34, 32768
    s_cbranch_scc1 c_n0_ok
    buffer_load_dword v80, v128, s[12:15], s28 offen offset:0 sc1
    buffer_load_dword v81, v128, s[12:15], s28 offen offset:64 sc1
    s_add_u32 s31, s30, 0
    buffer_load_dwordx4 v[16:19], v129, s[12:15], s31 offen sc1
    s_add_u32 s31, s30, 16384
    buffer_load_dwordx4 v[20:23], v129, s[12:15], s31 offen sc1
    s_add_u32 s31, s30, 32768
    buffer_load_dwordx4 v[24:27], v129, s[12:15], s31 offen sc1
    s_add_u32 s31, s30, 49152
    buffer_load_dwordx4 v[28:31], v129, s[12:15], s31 offen sc1
    s_waitcnt vmcnt(0)
    s_branch c_n0
c_n0_ok:
    v_cvt_pk_bf16_f32 v88, v96, v97
    ds_write_b32 v130, v88 offset:0
    v_cvt_pk_bf16_f32 v89, v98, v99
    ds_write_b32 v130, v89 offset:5120
    buffer_load_dword v82, v128, s[12:15], s28 offen offset:2048 sc1
    buffer_load_dword v83, v128, s[12:15], s28 offen offset:2112 sc1
    s_add_u32 s31, s30, 4096
    buffer_load_dwordx4 v[32:35], v129, s[12:15], s31 offen sc1
    s_add_u32 s31, s30, 20480
    buffer_load_dwordx4 v[36:39], v129, s[12:15], s31 offen sc1
    s_add_u32 s31, s30, 36864
    buffer_load_dwordx4 v[40:43], v129, s[12:15], s31 offen sc1
    s_add_u32 s31, s30, 53248
    buffer_load_dwordx4 v[44:47], v129, s[12:15], s31 offen sc1
    buffer_load_dword v84, v128, s[12:15], s29 offen offset:0 sc1
    buffer_load_dword v85, v128, s[12:15], s29 offen offset:64 sc1
    s_add_u32 s31, s30, 8192
    buffer_load_dwordx4 v[48:51], v129, s[12:15], s31 offen sc1
    s_add_u32 s31, s30, 24576
    buffer_load_dwordx4 v[52:55], v129, s[12:15], s31 offen sc1
    s_add_u32 s31, s30, 40960
    buffer_load_dwordx4 v[56:59], v129, s[12:15], s31 offen sc1
    s_add_u32 s31, s30, 57344
    buffer_load_dwordx4 v[60:63], v129, s[12:15], s31 offen sc1
    buffer_load_dword v86, v128, s[12:15], s29 offen offset:2048 sc1
    buffer_load_dword v87, v128, s[12:15], s29 offen offset:2112 sc1
    s_add_u32 s31, s30, 12288
    buffer_load_dwordx4 v[64:67], v129, s[12:15], s31 offen sc1
    s_add_u32 s31, s30, 28672
    buffer_load_dwordx4 v[68:71], v129, s[12:15], s31 offen sc1
    s_add_u32 s31, s30, 45056
    buffer_load_dwordx4 v[72:75], v129, s[12:15], s31 offen sc1
    s_add_u32 s31, s30, 61440
    buffer_load_dwordx4 v[76:79], v129, s[12:15], s31 offen sc1
    s_waitcnt lgkmcnt(0)
    s_barrier
    s_waitcnt vmcnt(12)
c_n1:
    v_add_f32 v32, v32, v36
    v_add_f32 v40, v40, v44
    v_add_f32 v33, v33, v37
    v_add_f32 v41, v41, v45
    v_add_f32 v34, v34, v38
    v_add_f32 v42, v42, v46
    v_add_f32 v35, v35, v39
    v_add_f32 v43, v43, v47
    v_add_f32 v32, v32, v40
    v_add_f32 v33, v33, v41
    v_add_f32 v34, v34, v42
    v_add_f32 v35, v35, v43
    v_mul_f32 v32, s41, v32
    v_fma_f32 v33, v33, s41, v133
    v_mul_f32 v34, s41, v34
    v_fma_f32 v35, v35, s41, v133
    v_fma_f32 v33, -v32, v32, v33
    v_fma_f32 v35, -v34, v34, v35
    v_max_f32 v33, v133, v33
    v_max_f32 v35, v133, v35
    v_sqrt_f32 v33, v33
    v_sqrt_f32 v35, v35
    v_lshlrev_b32 v96, 16, v82
    v_and_b32 v97, s35, v82
    v_lshlrev_b32 v98, 16, v83
    v_and_b32 v99, s35, v83
    v_cvt_pk_bf16_f32 v33, v33, v35
    v_sub_f32 v96, v96, v32
    v_sub_f32 v97, v97, v34
    v_sub_f32 v98, v98, v32
    v_sub_f32 v99, v99, v34
    v_and_b32 v35, s35, v33
    v_lshlrev_b32 v33, 16, v33
    v_rcp_f32 v35, v35
    v_rcp_f32 v33, v33
    v_cmp_u_f32 vcc, v96, v97
    v_cmp_u_f32 s[32:33], v98, v99
    v_mul_f32 v96, v96, v33
    v_mul_f32 v97, v97, v35
    v_mul_f32 v98, v98, v33
    v_mul_f32 v99, v99, v35
    s_or_b64 vcc, vcc, s[32:33]
    s_cbranch_vccz c_n1_ok
    s_add_u32 s34, s34, 1
    s_cmp_gt_u32 s34, 32768
    s_cbranch_scc1 c_n1_ok
    buffer_load_dword v82, v128, s[12:15], s28 offen offset:2048 sc1
    buffer_load_dword v83, v128, s[12:15], s28 offen offset:2112 sc1
    s_add_u32 s31, s30, 4096
    buffer_load_dwordx4 v[32:35], v129, s[12:15], s31 offen sc1
    s_add_u32 s31, s30, 20480
    buffer_load_dwordx4 v[36:39], v129, s[12:15], s31 offen sc1
    s_add_u32 s31, s30, 36864
    buffer_load_dwordx4 v[40:43], v129, s[12:15], s31 offen sc1
    s_add_u32 s31, s30, 53248
    buffer_load_dwordx4 v[44:47], v129, s[12:15], s31 offen sc1
    s_waitcnt vmcnt(0)
    s_branch c_n1
c_n1_ok:
    v_cvt_pk_bf16_f32 v90, v96, v97
    ds_write_b32 v130, v90 offset:1024
    v_cvt_pk_bf16_f32 v91, v98, v99
    ds_write_b32 v130, v91 offset:6144
    s_waitcnt lgkmcnt(0)
    s_barrier
    ds_read2st64_b64 v[112:115], v131 offset0:0 offset1:10
    ds_read2st64_b64 v[116:119], v131 offset0:20 offset1:30
    ds_read2st64_b64 v[120:123], v131 offset0:40 offset1:50
    ds_read2st64_b64 v[124:127], v131 offset0:60 offset1:70
    s_waitcnt vmcnt(6)
c_n2:
    v_add_f32 v48, v48, v52
    v_add_f32 v56, v56, v60
    v_add_f32 v49, v49, v53
    v_add_f32 v57, v57, v61
    v_add_f32 v50, v50, v54
    v_add_f32 v58, v58, v62
    v_add_f32 v51, v51, v55
    v_add_f32 v59, v59, v63
    v_add_f32 v48, v48, v56
    v_add_f32 v49, v49, v57
    v_add_f32 v50, v50, v58
    v_add_f32 v51, v51, v59
    v_mul_f32 v48, s41, v48
    v_fma_f32 v49, v49, s41, v133
    v_mul_f32 v50, s41, v50
    v_fma_f32 v51, v51, s41, v133
    v_fma_f32 v49, -v48, v48, v49
    v_fma_f32 v51, -v50, v50, v51
    v_max_f32 v49, v133, v49
    v_max_f32 v51, v133, v51
    v_sqrt_f32 v49, v49
    v_sqrt_f32 v51, v51
    v_lshlrev_b32 v96, 16, v84
    v_and_b32 v97, s35, v84
    v_lshlrev_b32 v98, 16, v85
    v_and_b32 v99, s35, v85
    v_cvt_pk_bf16_f32 v49, v49, v51
    v_sub_f32 v96, v96, v48
    v_sub_f32 v97, v97, v50
    v_sub_f32 v98, v98, v48
    v_sub_f32 v99, v99, v50
    v_and_b32 v51, s35, v49
    v_lshlrev_b32 v49, 16, v49
    v_rcp_f32 v51, v51
    v_rcp_f32 v49, v49
    v_cmp_u_f32 vcc, v96, v97
    v_cmp_u_f32 s[32:33], v98, v99
    v_mul_f32 v96, v96, v49
    v_mul_f32 v97, v97, v51
    v_mul_f32 v98, v98, v49
    v_mul_f32 v99, v99, v51
    s_or_b64 vcc, vcc, s[32:33]
    s_cbranch_vccz c_n2_ok
    s_add_u32 s34, s34, 1
    s_cmp_gt_u32 s34, 32768
    s_cbranch_scc1 c_n2_ok
    buffer_load_dword v84, v128, s[12:15], s29 offen offset:0 sc1
    buffer_load_dword v85, v128, s[12:15], s29 offen offset:64 sc1
    s_add_u32 s31, s30, 8192
    buffer_load_dwordx4 v[48:51], v129, s[12:15], s31 offen sc1
    s_add_u32 s31, s30, 24576
    buffer_load_dwordx4 v[52:55], v129, s[12:15], s31 offen sc1
    s_add_u32 s31, s30, 40960
    buffer_load_dwordx4 v[56:59], v129, s[12:15], s31 offen sc1
    s_add_u32 s31, s30, 57344
    buffer_load_dwordx4 v[60:63], v129, s[12:15], s31 offen sc1
    s_waitcnt vmcnt(0)
    s_branch c_n2
c_n2_ok:
    v_cvt_pk_bf16_f32 v92, v96, v97
    ds_write_b32 v130, v92 offset:2048
    v_cvt_pk_bf16_f32 v93, v98, v99
    ds_write_b32 v130, v93 offset:7168
    v_lshlrev_b32 v96, 16, v80
    v_and_b32 v97, s35, v80
    v_lshlrev_b32 v100, 16, v88
    v_and_b32 v101, s35, v88
    v_lshlrev_b32 v98, 16, v81
    v_and_b32 v99, s35, v81
    v_lshlrev_b32 v102, 16, v89
    v_and_b32 v103, s35, v89
    v_fma_f32 v96, v100, s36, v96
    v_fma_f32 v97, v101, s36, v97
    v_fma_f32 v98, v102, s37, v98
    v_fma_f32 v99, v103, s37, v99
    s_waitcnt vmcnt(0) lgkmcnt(2)
    v_add_f32 v112, v112, v114
    v_add_f32 v116, v116, v118
    v_add_f32 v113, v113, v115
    v_add_f32 v117, v117, v119
    v_add_f32 v120, v120, v122
    v_add_f32 v124, v124, v126
    v_add_f32 v121, v121, v123
    v_add_f32 v125, v125, v127
    v_add_f32 v96, v96, v112
    v_add_f32 v97, v97, v113
    v_add_f32 v98, v98, v120
    v_add_f32 v99, v99, v121
    v_add_f32 v96, v96, v116
    v_add_f32 v97, v97, v117
    v_add_f32 v98, v98, v124
    v_add_f32 v99, v99, v125
    s_cmp_eq_u32 s52, 2
    s_cbranch_scc1 c_st2_0
    v_cvt_pk_bf16_f32 v104, v96, v97
    v_cvt_pk_bf16_f32 v105, v98, v99
    s_mov_b64 exec, s[50:51]
    s_add_u32 s31, s40, 0
    buffer_store_dword v104, v132, s[4:7], s31 offen offset:0 sc1
    buffer_store_dword v105, v132, s[4:7], s31 offen offset:32 sc1
    s_mov_b64 exec, -1
    buffer_store_dword v104, v4, s[4:7], s38 offen offset:0 sc1
    buffer_store_dword v105, v4, s[4:7], s39 offen offset:0 sc1
    s_branch c_st3_0
c_st2_0:
    v_cvt_pk_bf16_f32 v104, v96, v98
    v_cvt_pk_bf16_f32 v105, v97, v99
    s_add_u32 s31, s38, 0
    buffer_store_dword v104, v4, s[4:7], s31 offen offset:0
    buffer_store_dword v105, v4, s[4:7], s31 offen offset:1024
c_st3_0:
    s_waitcnt lgkmcnt(0)
    s_barrier
    ds_read2st64_b64 v[112:115], v131 offset0:5 offset1:15
    ds_read2st64_b64 v[116:119], v131 offset0:25 offset1:35
    ds_read2st64_b64 v[120:123], v131 offset0:45 offset1:55
    ds_read2st64_b64 v[124:127], v131 offset0:65 offset1:75
c_n3:
    v_add_f32 v64, v64, v68
    v_add_f32 v72, v72, v76
    v_add_f32 v65, v65, v69
    v_add_f32 v73, v73, v77
    v_add_f32 v66, v66, v70
    v_add_f32 v74, v74, v78
    v_add_f32 v67, v67, v71
    v_add_f32 v75, v75, v79
    v_add_f32 v64, v64, v72
    v_add_f32 v65, v65, v73
    v_add_f32 v66, v66, v74
    v_add_f32 v67, v67, v75
    v_mul_f32 v64, s41, v64
    v_fma_f32 v65, v65, s41, v133
    v_mul_f32 v66, s41, v66
    v_fma_f32 v67, v67, s41, v133
    v_fma_f32 v65, -v64, v64, v65
    v_fma_f32 v67, -v66, v66, v67
    v_max_f32 v65, v133, v65
    v_max_f32 v67, v133, v67
    v_sqrt_f32 v65, v65
    v_sqrt_f32 v67, v67
    v_lshlrev_b32 v96, 16, v86
    v_and_b32 v97, s35, v86
    v_lshlrev_b32 v98, 16, v87
    v_and_b32 v99, s35, v87
    v_cvt_pk_bf16_f32 v65, v65, v67
    v_sub_f32 v96, v96, v64
    v_sub_f32 v97, v97, v66
    v_sub_f32 v98, v98, v64
    v_sub_f32 v99, v99, v66
    v_and_b32 v67, s35, v65
    v_lshlrev_b32 v65, 16, v65
    v_rcp_f32 v67, v67
    v_rcp_f32 v65, v65
    v_cmp_u_f32 vcc, v96, v97
    v_cmp_u_f32 s[32:33], v98, v99
    v_mul_f32 v96, v96, v65
    v_mul_f32 v97, v97, v67
    v_mul_f32 v98, v98, v65
    v_mul_f32 v99, v99, v67
    s_or_b64 vcc, vcc, s[32:33]
    s_cbranch_vccz c_n3_ok
    s_add_u32 s34, s34, 1
    s_cmp_gt_u32 s34, 32768
    s_cbranch_scc1 c_n3_ok
    buffer_load_dword v86, v128, s[12:15], s29 offen offset:2048 sc1
    buffer_load_dword v87, v128, s[12:15], s29 offen offset:2112 sc1
    s_add_u32 s31, s30, 12288
    buffer_load_dwordx4 v[64:67], v129, s[12:15], s31 offen sc1
    s_add_u32 s31, s30, 28672
    buffer_load_dwordx4 v[68:71], v129, s[12:15], s31 offen sc1
    s_add_u32 s31, s30, 45056
    buffer_load_dwordx4 v[72:75], v129, s[12:15], s31 offen sc1
    s_add_u32 s31, s30, 61440
    buffer_load_dwordx4 v[76:79], v129, s[12:15], s31 offen sc1
    s_waitcnt vmcnt(0)
    s_branch c_n3
c_n3_ok:
    v_cvt_pk_bf16_f32 v94, v96, v97
    ds_write_b32 v130, v94 offset:3072
    v_cvt_pk_bf16_f32 v95, v98, v99
    ds_write_b32 v130, v95 offset:8192
    v_lshlrev_b32 v96, 16, v82
    v_and_b32 v97, s35, v82
    v_lshlrev_b32 v100, 16, v90
    v_and_b32 v101, s35, v90
    v_lshlrev_b32 v98, 16, v83
    v_and_b32 v99, s35, v83
    v_lshlrev_b32 v102, 16, v91
    v_and_b32 v103, s35, v91
    v_fma_f32 v96, v100, s36, v96
    v_fma_f32 v97, v101, s36, v97
    v_fma_f32 v98, v102, s37, v98
    v_fma_f32 v99, v103, s37, v99
    s_waitcnt lgkmcnt(2)
    v_add_f32 v112, v112, v114
    v_add_f32 v116, v116, v118
    v_add_f32 v113, v113, v115
    v_add_f32 v117, v117, v119
    v_add_f32 v120, v120, v122
    v_add_f32 v124, v124, v126
    v_add_f32 v121, v121, v123
    v_add_f32 v125, v125, v127
    v_add_f32 v96, v96, v112
    v_add_f32 v97, v97, v113
    v_add_f32 v98, v98, v120
    v_add_f32 v99, v99, v121
    v_add_f32 v96, v96, v116
    v_add_f32 v97, v97, v117
    v_add_f32 v98, v98, v124
    v_add_f32 v99, v99, v125
    s_cmp_eq_u32 s52, 2
    s_cbranch_scc1 c_st2_1
    v_cvt_pk_bf16_f32 v104, v96, v97
    v_cvt_pk_bf16_f32 v105, v98, v99
    s_mov_b64 exec, s[50:51]
    s_add_u32 s31, s40, 131072
    buffer_store_dword v104, v132, s[4:7], s31 offen offset:0 sc1
    buffer_store_dword v105, v132, s[4:7], s31 offen offset:32 sc1
    s_mov_b64 exec, -1
    buffer_store_dword v104, v4, s[4:7], s38 offen offset:1024 sc1
    buffer_store_dword v105, v4, s[4:7], s39 offen offset:1024 sc1
    s_branch c_st3_1
c_st2_1:
    v_cvt_pk_bf16_f32 v104, v96, v98
    v_cvt_pk_bf16_f32 v105, v97, v99
    s_add_u32 s31, s38, 524288
    buffer_store_dword v104, v4, s[4:7], s31 offen offset:0
    buffer_store_dword v105, v4, s[4:7], s31 offen offset:1024
c_st3_1:
    s_waitcnt lgkmcnt(0)
    s_barrier
    ds_read2st64_b64 v[112:115], v131 offset0:0 offset1:10
    ds_read2st64_b64 v[116:119], v131 offset0:20 offset1:30
    ds_read2st64_b64 v[120:123], v131 offset0:40 offset1:50
    ds_read2st64_b64 v[124:127], v131 offset0:60 offset1:70
    v_lshlrev_b32 v96, 16, v84
    v_and_b32 v97, s35, v84
    v_lshlrev_b32 v100, 16, v92
    v_and_b32 v101, s35, v92
    v_lshlrev_b32 v98, 16, v85
    v_and_b32 v99, s35, v85
    v_lshlrev_b32 v102, 16, v93
    v_and_b32 v103, s35, v93
    v_fma_f32 v96, v100, s36, v96
    v_fma_f32 v97, v101, s36, v97
    v_fma_f32 v98, v102, s37, v98
    v_fma_f32 v99, v103, s37, v99
    s_waitcnt lgkmcnt(0)
    v_add_f32 v112, v112, v114
    v_add_f32 v116, v116, v118
    v_add_f32 v113, v113, v115
    v_add_f32 v117, v117, v119
    v_add_f32 v120, v120, v122
    v_add_f32 v124, v124, v126
    v_add_f32 v121, v121, v123
    v_add_f32 v125, v125, v127
    v_add_f32 v96, v96, v112
    v_add_f32 v97, v97, v113
    v_add_f32 v98, v98, v120
    v_add_f32 v99, v99, v121
    v_add_f32 v96, v96, v116
    v_add_f32 v97, v97, v117
    v_add_f32 v98, v98, v124
    v_add_f32 v99, v99, v125
    s_cmp_eq_u32 s52, 2
    s_cbranch_scc1 c_st2_2
    v_cvt_pk_bf16_f32 v104, v96, v97
    v_cvt_pk_bf16_f32 v105, v98, v99
    s_mov_b64 exec, s[50:51]
    s_add_u32 s31, s40, 262144
    buffer_store_dword v104, v132, s[4:7], s31 offen offset:0 sc1
    buffer_store_dword v105, v132, s[4:7], s31 offen offset:32 sc1
    s_mov_b64 exec, -1
    buffer_store_dword v104, v4, s[4:7], s38 offen offset:2048 sc1
    buffer_store_dword v105, v4, s[4:7], s39 offen offset:2048 sc1
    s_branch c_st3_2
c_st2_2:
    v_cvt_pk_bf16_f32 v104, v96, v98
    v_cvt_pk_bf16_f32 v105, v97, v99
    s_add_u32 s31, s38, 1048576
    buffer_store_dword v104, v4, s[4:7], s31 offen offset:0
    buffer_store_dword v105, v4, s[4:7], s31 offen offset:1024
c_st3_2:
    s_barrier
    ds_read2st64_b64 v[112:115], v131 offset0:5 offset1:15
    ds_read2st64_b64 v[116:119], v131 offset0:25 offset1:35
    ds_read2st64_b64 v[120:123], v131 offset0:45 offset1:55
    ds_read2st64_b64 v[124:127], v131 offset0:65 offset1:75
    v_lshlrev_b32 v96, 16, v86
    v_and_b32 v97, s35, v86
    v_lshlrev_b32 v100, 16, v94
    v_and_b32 v101, s35, v94
    v_lshlrev_b32 v98, 16, v87
    v_and_b32 v99, s35, v87
    v_lshlrev_b32 v102, 16, v95
    v_and_b32 v103, s35, v95
    v_fma_f32 v96, v100, s36, v96
    v_fma_f32 v97, v101, s36, v97
    v_fma_f32 v98, v102, s37, v98
    v_fma_f32 v99, v103, s37, v99
    s_waitcnt lgkmcnt(0)
    v_add_f32 v112, v112, v114
    v_add_f32 v116, v116, v118
    v_add_f32 v113, v113, v115
    v_add_f32 v117, v117, v119
    v_add_f32 v120, v120, v122
    v_add_f32 v124, v124, v126
    v_add_f32 v121, v121, v123
    v_add_f32 v125, v125, v127
    v_add_f32 v96, v96, v112
    v_add_f32 v97, v97, v113
    v_add_f32 v98, v98, v120
    v_add_f32 v99, v99, v121
    v_add_f32 v96, v96, v116
    v_add_f32 v97, v97, v117
    v_add_f32 v98, v98, v124
    v_add_f32 v99, v99, v125
    s_cmp_eq_u32 s52, 2
    s_cbranch_scc1 c_st2_3
    v_cvt_pk_bf16_f32 v104, v96, v97
    v_cvt_pk_bf16_f32 v105, v98, v99
    s_mov_b64 exec, s[50:51]
    s_add_u32 s31, s40, 393216
    buffer_store_dword v104, v132, s[4:7], s31 offen offset:0 sc1
    buffer_store_dword v105, v132, s[4:7], s31 offen offset:32 sc1
    s_mov_b64 exec, -1
    buffer_store_dword v104, v4, s[4:7], s38 offen offset:3072 sc1
    buffer_store_dword v105, v4, s[4:7], s39 offen offset:3072 sc1
    s_branch c_st3_3
c_st2_3:
    v_cvt_pk_bf16_f32 v104, v96, v98
    v_cvt_pk_bf16_f32 v105, v97, v99
    s_add_u32 s31, s38, 1572864
    buffer_store_dword v104, v4, s[4:7], s31 offen offset:0
    buffer_store_dword v105, v4, s[4:7], s31 offen offset:1024
c_st3_3:
    s_cmp_eq_u32 s52, 2
    s_cbranch_scc1 c_end
    s_mov_b32 s52, 2
    s_setprio 0
    s_branch c_att_xt
c_end:
k_exit:
    s_endpgm
.p2align 7
.type kgen_tab,@object
kgen_tab:
    .short 13800, 9216, 9216, 9216, 9216, 9180, 9180, 9180, 9180, 0, 0, 0, 0, 0, 0, 0
    .short 9180, 9180, 9180, 9180, 9144, 9144, 9144, 9144, 9144, 0, 0, 0, 0, 0, 0, 0
    .short 9144, 9144, 9144, 9144, 9144, 9108, 9108, 9108, 9108, 0, 0, 0, 0, 0, 0, 0
    .short 9108, 9108, 9108, 9108, 9072, 9072, 9072, 9072, 9072, 0, 0, 0, 0, 0, 0, 0
    .short 9072, 9072, 9072, 9072, 9072, 9036, 9036, 9036, 9036, 0, 0, 0, 0, 0, 0, 0
    .short 9036, 9036, 9036, 9036, 9000, 9000, 9000, 9000, 9000, 0, 0, 0, 0, 0, 0, 0
    .short 9000, 9000, 9000, 9000, 9000, 8964, 8964, 8964, 8964, 0, 0, 0, 0, 0, 0, 0
    .short 8964, 8964, 8964, 8964, 8928, 8928, 8928, 8928, 8928, 0, 0, 0, 0, 0, 0, 0
    .short 8928, 8928, 8928, 8928, 8928, 8892, 8892, 8892, 8892, 0, 0, 0, 0, 0, 0, 0
    .short 8892, 8892, 8892, 8892, 8856, 8856, 8856, 8856, 8856, 0, 0, 0, 0, 0, 0, 0
    .short 8856, 8856, 8856, 8856, 8856, 8820, 8820, 8820, 8820, 0, 0, 0, 0, 0, 0, 0
    .short 8820, 8820, 8820, 8820, 8784, 8784, 8784, 8784, 8784, 0, 0, 0, 0, 0, 0, 0
    .short 8784, 8784, 8784, 8784, 8784, 8748, 8748, 8748, 8748, 0, 0, 0, 0, 0, 0, 0
    .short 8748, 8748, 8748, 8748, 8712, 8712, 8712, 8712, 8712, 0, 0, 0, 0, 0, 0, 0
    .short 8712, 8712, 8712, 8712, 8712, 8676, 8676, 8676, 8676, 0, 0, 0, 0, 0, 0, 0
    .short 8676, 8676, 8676, 8676, 8640, 8640, 8640, 8640, 8640, 0, 0, 0, 0, 0, 0, 0
    .short 8640, 8640, 8640, 8640, 8640, 8604, 8604, 8604, 8604, 0, 0, 0, 0, 0, 0, 0
    .short 8604, 8604, 8604, 8604, 8568, 8568, 8568, 8568, 8568, 0, 0, 0, 0, 0, 0, 0
    .short 8568, 8568, 8568, 8568, 8568, 8532, 8532, 8532, 8532, 0, 0, 0, 0, 0, 0, 0
    .short 8532, 8532, 8532, 8532, 8496, 8496, 8496, 8496, 8496, 0, 0, 0, 0, 0, 0, 0
    .short 8496, 8496, 8496, 8496, 8496, 8460, 8460, 8460, 8460, 0, 0, 0, 0, 0, 0, 0
    .short 8460, 8460, 8460, 8460, 8424, 8424, 8424, 8424, 8424, 0, 0, 0, 0, 0, 0, 0
    .short 8424, 8424, 8424, 8424, 8424, 8388, 8388, 8388, 8388, 0, 0, 0, 0, 0, 0, 0
    .short 8388, 8388, 8388, 8388, 8352, 8352, 8352, 8352, 8352, 0, 0, 0, 0, 0, 0, 0
    .short 8352, 8352, 8352, 8352, 8352, 8316, 8316, 8316, 8316, 0, 0, 0, 0, 0, 0, 0
    .short 8316, 8316, 8316, 8316, 8280, 8280, 8280, 8280, 8280, 0, 0, 0, 0, 0, 0, 0
    .short 8280, 8280, 8280, 8280, 8280, 8244, 8244, 8244, 8244, 0, 0, 0, 0, 0, 0, 0
    .short 8244, 8244, 8244, 8244, 8208, 8208, 8208, 8208, 8208, 0, 0, 0, 0, 0, 0, 0
    .short 8208, 8208, 8208, 8208, 8208, 8172, 8172, 8172, 8172, 0, 0, 0, 0, 0, 0, 0
    .short 8172, 8172, 8172, 8172, 8136, 8136, 8136, 8136, 8136, 0, 0, 0, 0, 0, 0, 0
    .short 8136, 8136, 8136, 8136, 8136, 8100, 8100, 8100, 8100, 0, 0, 0, 0, 0, 0, 0
    .short 8100, 8100, 8100, 8100, 8064, 8064, 8064, 8064, 8064, 0, 0, 0, 0, 0, 0, 0
    .short 8064, 8064, 8064, 8064, 8064, 8028, 8028, 8028, 8028, 0, 0, 0, 0, 0, 0, 0
    .short 8028, 8028, 8028, 8028, 7992, 7992, 7992, 7992, 7992, 0, 0, 0, 0, 0, 0, 0
    .short 7992, 7992, 7992, 7992, 7992, 7956, 7956, 7956, 7956, 0, 0, 0, 0, 0, 0, 0
    .short 7956, 7956, 7956, 7956, 7920, 7920, 7920, 7920, 7920, 0, 0, 0, 0, 0, 0, 0
    .short 7920, 7920, 7920, 7920, 7920, 7884, 7884, 7884, 7884, 0, 0, 0, 0, 0, 0, 0
    .short 7884, 7884, 7884, 7884, 7848, 7848, 7848, 7848, 7848, 0, 0, 0, 0, 0, 0, 0
    .short 7848, 7848, 7848, 7848, 7848, 7812, 7812, 7812, 7812, 0, 0, 0, 0, 0, 0, 0
    .short 7812, 7812, 7812, 7812, 7776, 7776, 7776, 7776, 7776, 0, 0, 0, 0, 0, 0, 0
    .short 7776, 7776, 7776, 7776, 7776, 7740, 7740, 7740, 7740, 0, 0, 0, 0, 0, 0, 0
    .short 7740, 7740, 7740, 7740, 7704, 7704, 7704, 7704, 7704, 0, 0, 0, 0, 0, 0, 0
    .short 7704, 7704, 7704, 7704, 7704, 7668, 7668, 7668, 7668, 0, 0, 0, 0, 0, 0, 0
    .short 7668, 7668, 7668, 7668, 7632, 7632, 7632, 7632, 7632, 0, 0, 0, 0, 0, 0, 0
    .short 7632, 7632, 7632, 7632, 7632, 7596, 7596, 7596, 7596, 0, 0, 0, 0, 0, 0, 0
    .short 7596, 7596, 7596, 7596, 7560, 7560, 7560, 7560, 7560, 0, 0, 0, 0, 0, 0, 0
    .short 7560, 7560, 7560, 7560, 7560, 7524, 7524, 7524, 7524, 0, 0, 0, 0, 0, 0, 0
    .short 7524, 7524, 7524, 7524, 7488, 7488, 7488, 7488, 7488, 0, 0, 0, 0, 0, 0, 0
    .short 7488, 7488, 7488, 7488, 7488, 7452, 7452, 7452, 7452, 0, 0, 0, 0, 0, 0, 0
    .short 7452, 7452, 7452, 7452, 7416, 7416, 7416, 7416, 7416, 0, 0, 0, 0, 0, 0, 0
    .short 7416, 7416, 7416, 7416, 7416, 7380, 7380, 7380, 7380, 0, 0, 0, 0, 0, 0, 0
    .short 7380, 7380, 7380, 7380, 7344, 7344, 7344, 7344, 7344, 0, 0, 0, 0, 0, 0, 0
    .short 7344, 7344, 7344, 7344, 7344, 7308, 7308, 7308, 7308, 0, 0, 0, 0, 0, 0, 0
    .short 7308, 7308, 7308, 7308, 7272, 7272, 7272, 7272, 7272, 0, 0, 0, 0, 0, 0, 0
    .short 7272, 7272, 7272, 7272, 7272, 7236, 7236, 7236, 7236, 0, 0, 0, 0, 0, 0, 0
    .short 7236, 7236, 7236, 7236, 7200, 7200, 7200, 7200, 7200, 0, 0, 0, 0, 0, 0, 0
    .short 7200, 7200, 7200, 7200, 7200, 7164, 7164, 7164, 7164, 0, 0, 0, 0, 0, 0, 0
    .short 7164, 7164, 7164, 7164, 7128, 7128, 7128, 7128, 7128, 0, 0, 0, 0, 0, 0, 0
    .short 7128, 7128, 7128, 7128, 7128, 7092, 7092, 7092, 7092, 0, 0, 0, 0, 0, 0, 0
    .short 7092, 7092, 7092, 7092, 7056, 7056, 7056, 7056, 7056, 0, 0, 0, 0, 0, 0, 0
    .short 7056, 7056, 7056, 7056, 7056, 7020, 7020, 7020, 7020, 0, 0, 0, 0, 0, 0, 0
    .short 7020, 7020, 7020, 7020, 6984, 6984, 6984, 6984, 6984, 0, 0, 0, 0, 0, 0, 0
    .short 6984, 6984, 6984, 6984, 6984, 6948, 6948, 6948, 6948, 0, 0, 0, 0, 0, 0, 0
    .short 6948, 6948, 6948, 6948, 6912, 6912, 6912, 6912, 6912, 0, 0, 0, 0, 0, 0, 0
    .short 6912, 6912, 6912, 6912, 6912, 6876, 6876, 6876, 6876, 0, 0, 0, 0, 0, 0, 0
    .short 6876, 6876, 6876, 6876, 6840, 6840, 6840, 6840, 6840, 0, 0, 0, 0, 0, 0, 0
    .short 6840, 6840, 6840, 6840, 6840, 6804, 6804, 6804, 6804, 0, 0, 0, 0, 0, 0, 0
    .short 6804, 6804, 6804, 6804, 6768, 6768, 6768, 6768, 6768, 0, 0, 0, 0, 0, 0, 0
    .short 6768, 6768, 6768, 6768, 6768, 6732, 6732, 6732, 6732, 0, 0, 0, 0, 0, 0, 0
    .short 6732, 6732, 6732, 6732, 6696, 6696, 6696, 6696, 6696, 0, 0, 0, 0, 0, 0, 0
    .short 6696, 6696, 6696, 6696, 6696, 6660, 6660, 6660, 6660, 0, 0, 0, 0, 0, 0, 0
    .short 6660, 6660, 6660, 6660, 6624, 6624, 6624, 6624, 6624, 0, 0, 0, 0, 0, 0, 0
    .short 6624, 6624, 6624, 6624, 6624, 6588, 6588, 6588, 6588, 0, 0, 0, 0, 0, 0, 0
    .short 6588, 6588, 6588, 6588, 6552, 6552, 6552, 6552, 6552, 0, 0, 0, 0, 0, 0, 0
    .short 6552, 6552, 6552, 6552, 6552, 6516, 6516, 6516, 6516, 0, 0, 0, 0, 0, 0, 0
    .short 6516, 6516, 6516, 6516, 6480, 6480, 6480, 6480, 6480, 0, 0, 0, 0, 0, 0, 0
    .short 6480, 6480, 6480, 6480, 6480, 6444, 6444, 6444, 6444, 0, 0, 0, 0, 0, 0, 0
    .short 6444, 6444, 6444, 6444, 6408, 6408, 6408, 6408, 6408, 0, 0, 0, 0, 0, 0, 0
    .short 6408, 6408, 6408, 6408, 6408, 6372, 6372, 6372, 6372, 0, 0, 0, 0, 0, 0, 0
    .short 6372, 6372, 6372, 6372, 6336, 6336, 6336, 6336, 6336, 0, 0, 0, 0, 0, 0, 0
    .short 6336, 6336, 6336, 6336, 6336, 6300, 6300, 6300, 6300, 0, 0, 0, 0, 0, 0, 0
    .short 6300, 6300, 6300, 6300, 6264, 6264, 6264, 6264, 6264, 0, 0, 0, 0, 0, 0, 0
    .short 6264, 6264, 6264, 6264, 6264, 6228, 6228, 6228, 6228, 0, 0, 0, 0, 0, 0, 0
    .short 6228, 6228, 6228, 6228, 6192, 6192, 6192, 6192, 6192, 0, 0, 0, 0, 0, 0, 0
    .short 6192, 6192, 6192, 6192, 6192, 6156, 6156, 6156, 6156, 0, 0, 0, 0, 0, 0, 0
    .short 6156, 6156, 6156, 6156, 6120, 6120, 6120, 6120, 6120, 0, 0, 0, 0, 0, 0, 0
    .short 6120, 6120, 6120, 6120, 6120, 6084, 6084, 6084, 6084, 0, 0, 0, 0, 0, 0, 0
    .short 6084, 6084, 6084, 6084, 6048, 6048, 6048, 6048, 6048, 0, 0, 0, 0, 0, 0, 0
    .short 6048, 6048, 6048, 6048, 6048, 6012, 6012, 6012, 6012, 0, 0, 0, 0, 0, 0, 0
    .short 6012, 6012, 6012, 6012, 5976, 5976, 5976, 5976, 5976, 0, 0, 0, 0, 0, 0, 0
    .short 5976, 5976, 5976, 5976, 5976, 5940, 5940, 5940, 5940, 0, 0, 0, 0, 0, 0, 0
    .short 5940, 5940, 5940, 5940, 5904, 5904, 5904, 5904, 5904, 0, 0, 0, 0, 0, 0, 0
    .short 5904, 5904, 5904, 5904, 5904, 5868, 5868, 5868, 5868, 0, 0, 0, 0, 0, 0, 0
    .short 5868, 5868, 5868, 5868, 5832, 5832, 5832, 5832, 5832, 0, 0, 0, 0, 0, 0, 0
    .short 5832, 5832, 5832, 5832, 5832, 5796, 5796, 5796, 5796, 0, 0, 0, 0, 0, 0, 0
    .short 5796, 5796, 5796, 5796, 5760, 5760, 5760, 5760, 5760, 0, 0, 0, 0, 0, 0, 0
    .short 5760, 5760, 5760, 5760, 5760, 5724, 5724, 5724, 5724, 0, 0, 0, 0, 0, 0, 0
    .short 5724, 5724, 5724, 5724, 5688, 5688, 5688, 5688, 5688, 0, 0, 0, 0, 0, 0, 0
    .short 5688, 5688, 5688, 5688, 5688, 5652, 5652, 5652, 5652, 0, 0, 0, 0, 0, 0, 0
    .short 5652, 5652, 5652, 5652, 5616, 5616, 5616, 5616, 5616, 0, 0, 0, 0, 0, 0, 0
    .short 5616, 5616, 5616, 5616, 5616, 5580, 5580, 5580, 5580, 0, 0, 0, 0, 0, 0, 0
    .short 5580, 5580, 5580, 5580, 5544, 5544, 5544, 5544, 5544, 0, 0, 0, 0, 0, 0, 0
    .short 5544, 5544, 5544, 5544, 5544, 5508, 5508, 5508, 5508, 0, 0, 0, 0, 0, 0, 0
    .short 5508, 5508, 5508, 5508, 5472, 5472, 5472, 5472, 5472, 0, 0, 0, 0, 0, 0, 0
    .short 5472, 5472, 5472, 5472, 5472, 5436, 5436, 5436, 5436, 0, 0, 0, 0, 0, 0, 0
    .short 5436, 5436, 5436, 5436, 5400, 5400, 5400, 5400, 5400, 0, 0, 0, 0, 0, 0, 0
    .short 5400, 5400, 5400, 5400, 5400, 5364, 5364, 5364, 5364, 0, 0, 0, 0, 0, 0, 0
    .short 5364, 5364, 5364, 5364, 5328, 5328, 5328, 5328, 5328, 0, 0, 0, 0, 0, 0, 0
    .short 5328, 5328, 5328, 5328, 5328, 5292, 5292, 5292, 5292, 0, 0, 0, 0, 0, 0, 0
    .short 5292, 5292, 5292, 5292, 5256, 5256, 5256, 5256, 5256, 0, 0, 0, 0, 0, 0, 0
    .short 5256, 5256, 5256, 5256, 5256, 5220, 5220, 5220, 5220, 0, 0, 0, 0, 0, 0, 0
    .short 5220, 5220, 5220, 5220, 5184, 5184, 5184, 5184, 5184, 0, 0, 0, 0, 0, 0, 0
    .short 5184, 5184, 5184, 5184, 5184, 5148, 5148, 5148, 5148, 0, 0, 0, 0, 0, 0, 0
    .short 5148, 5148, 5148, 5148, 5112, 5112, 5112, 5112, 5112, 0, 0, 0, 0, 0, 0, 0
    .short 5112, 5112, 5112, 5112, 5112, 5076, 5076, 5076, 5076, 0, 0, 0, 0, 0, 0, 0
    .short 5076, 5076, 5076, 5076, 5040, 5040, 5040, 5040, 5040, 0, 0, 0, 0, 0, 0, 0
    .short 5040, 5040, 5040, 5040, 5040, 5004, 5004, 5004, 5004, 0, 0, 0, 0, 0, 0, 0
    .short 5004, 5004, 5004, 5004, 4968, 4968, 4968, 4968, 4968, 0, 0, 0, 0, 0, 0, 0
    .short 4968, 4968, 4968, 4968, 4968, 4932, 4932, 4932, 4932, 0, 0, 0, 0, 0, 0, 0
    .short 4932, 4932, 4932, 4932, 4896, 4896, 4896, 4896, 4896, 0, 0, 0, 0, 0, 0, 0
    .short 4896, 4896, 4896, 4896, 4896, 4860, 4860, 4860, 4860, 0, 0, 0, 0, 0, 0, 0
    .short 4860, 4860, 4860, 4860, 4824, 4824, 4824, 4824, 4824, 0, 0, 0, 0, 0, 0, 0
    .short 4824, 4824, 4824, 4824, 4824, 4788, 4788, 4788, 4788, 0, 0, 0, 0, 0, 0, 0
    .short 4788, 4788, 4788, 4788, 4752, 4752, 4752, 4752, 4752, 0, 0, 0, 0, 0, 0, 0
    .short 4752, 4752, 4752, 4752, 4752, 4716, 4716, 4716, 4716, 0, 0, 0, 0, 0, 0, 0
    .short 4716, 4716, 4716, 4716, 4680, 4680, 4680, 4680, 4680, 0, 0, 0, 0, 0, 0, 0
    .short 4680, 4680, 4680, 4680, 4680, 4644, 4644, 4644, 4644, 0, 0, 0, 0, 0, 0, 0
    .short 4644, 4644, 4644, 4644, 4608, 4608, 4608, 4608, 4608, 0, 0, 0, 0, 0, 0, 0
    .short 4608, 4608, 4608, 4588, 4588, 4588, 4572, 4572, 4572, 0, 0, 0, 0, 0, 0, 0
    .short 4572, 4572, 4572, 4552, 4552, 4552, 4536, 4536, 4536, 0, 0, 0, 0, 0, 0, 0
    .short 4536, 4536, 4536, 4516, 4516, 4516, 4500, 4500, 4500, 0, 0, 0, 0, 0, 0, 0
    .short 4500, 4500, 4500, 4480, 4480, 4480, 4464, 4464, 4464, 0, 0, 0, 0, 0, 0, 0
    .short 4464, 4464, 4464, 4444, 4444, 4444, 4428, 4428, 4428, 0, 0, 0, 0, 0, 0, 0
    .short 4428, 4428, 4428, 4408, 4408, 4408, 4392, 4392, 4392, 0, 0, 0, 0, 0, 0, 0
    .short 4392, 4392, 4392, 4372, 4372, 4372, 4356, 4356, 4356, 0, 0, 0, 0, 0, 0, 0
    .short 4356, 4356, 4356, 4336, 4336, 4336, 4320, 4320, 4320, 0, 0, 0, 0, 0, 0, 0
    .short 4320, 4320, 4320, 4300, 4300, 4300, 4284, 4284, 4284, 0, 0, 0, 0, 0, 0, 0
    .short 4284, 4284, 4284, 4264, 4264, 4264, 4248, 4248, 4248, 0, 0, 0, 0, 0, 0, 0
    .short 4248, 4248, 4248, 4228, 4228, 4228, 4212, 4212, 4212, 0, 0, 0, 0, 0, 0, 0
    .short 4212, 4212, 4212, 4192, 4192, 4192, 4176, 4176, 4176, 0, 0, 0, 0, 0, 0, 0
    .short 4176, 4176, 4176, 4156, 4156, 4156, 4140, 4140, 4140, 0, 0, 0, 0, 0, 0, 0
    .short 4140, 4140, 4140, 4120, 4120, 4120, 4104, 4104, 4104, 0, 0, 0, 0, 0, 0, 0
    .short 4104, 4104, 4104, 4084, 4084, 4084, 4068, 4068, 4068, 0, 0, 0, 0, 0, 0, 0
    .short 4068, 4068, 4068, 4048, 4048, 4048, 4032, 4032, 4032, 0, 0, 0, 0, 0, 0, 0
    .short 4032, 4032, 4032, 4012, 4012, 4012, 3996, 3996, 3996, 0, 0, 0, 0, 0, 0, 0
    .short 3996, 3996, 3996, 3976, 3976, 3976, 3960, 3960, 3960, 0, 0, 0, 0, 0, 0, 0
    .short 3960, 3960, 3960, 3940, 3940, 3940, 3924, 3924, 3924, 0, 0, 0, 0, 0, 0, 0
    .short 3924, 3924, 3924, 3904, 3904, 3904, 3888, 3888, 3888, 0, 0, 0, 0, 0, 0, 0
    .short 3888, 3888, 3888, 3868, 3868, 3868, 3852, 3852, 3852, 0, 0, 0, 0, 0, 0, 0
    .short 3852, 3852, 3852, 3832, 3832, 3832, 3816, 3816, 3816, 0, 0, 0, 0, 0, 0, 0
    .short 3816, 3816, 3816, 3796, 3796, 3796, 3780, 3780, 3780, 0, 0, 0, 0, 0, 0, 0
    .short 3780, 3780, 3780, 3760, 3760, 3760, 3744, 3744, 3744, 0, 0, 0, 0, 0, 0, 0
    .short 3744, 3744, 3744, 3724, 3724, 3724, 3708, 3708, 3708, 0, 0, 0, 0, 0, 0, 0
    .short 3708, 3708, 3708, 3688, 3688, 3688, 3672, 3672, 3672, 0, 0, 0, 0, 0, 0, 0
    .short 3672, 3672, 3672, 3652, 3652, 3652, 3636, 3636, 3636, 0, 0, 0, 0, 0, 0, 0
    .short 3636, 3636, 3636, 3616, 3616, 3616, 3600, 3600, 3600, 0, 0, 0, 0, 0, 0, 0
    .short 3600, 3600, 3600, 3580, 3580, 3580, 3564, 3564, 3564, 0, 0, 0, 0, 0, 0, 0
    .short 3564, 3564, 3564, 3544, 3544, 3544, 3528, 3528, 3528, 0, 0, 0, 0, 0, 0, 0
    .short 3528, 3528, 3528, 3508, 3508, 3508, 3492, 3492, 3492, 0, 0, 0, 0, 0, 0, 0
    .short 3492, 3492, 3492, 3472, 3472, 3472, 3456, 3456, 3456, 0, 0, 0, 0, 0, 0, 0
    .short 3456, 3456, 3456, 3436, 3436, 3436, 3420, 3420, 3420, 0, 0, 0, 0, 0, 0, 0
    .short 3420, 3420, 3420, 3400, 3400, 3400, 3384, 3384, 3384, 0, 0, 0, 0, 0, 0, 0
    .short 3384, 3384, 3384, 3364, 3364, 3364, 3348, 3348, 3348, 0, 0, 0, 0, 0, 0, 0
    .short 3348, 3348, 3348, 3328, 3328, 3328, 3312, 3312, 3312, 0, 0, 0, 0, 0, 0, 0
    .short 3312, 3312, 3312, 3292, 3292, 3292, 3276, 3276, 3276, 0, 0, 0, 0, 0, 0, 0
    .short 3276, 3276, 3276, 3256, 3256, 3256, 3240, 3240, 3240, 0, 0, 0, 0, 0, 0, 0
    .short 3240, 3240, 3240, 3220, 3220, 3220, 3204, 3204, 3204, 0, 0, 0, 0, 0, 0, 0
    .short 3204, 3204, 3204, 3184, 3184, 3184, 3168, 3168, 3168, 0, 0, 0, 0, 0, 0, 0
    .short 3168, 3168, 3168, 3148, 3148, 3148, 3132, 3132, 3132, 0, 0, 0, 0, 0, 0, 0
    .short 3132, 3132, 3132, 3112, 3112, 3112, 3096, 3096, 3096, 0, 0, 0, 0, 0, 0, 0
    .short 3096, 3096, 3096, 3076, 3076, 3076, 3060, 3060, 3060, 0, 0, 0, 0, 0, 0, 0
    .short 3060, 3060, 3060, 3040, 3040, 3040, 3024, 3024, 3024, 0, 0, 0, 0, 0, 0, 0
    .short 3024, 3024, 3024, 3004, 3004, 3004, 2988, 2988, 2988, 0, 0, 0, 0, 0, 0, 0
    .short 2988, 2988, 2988, 2968, 2968, 2968, 2952, 2952, 2952, 0, 0, 0, 0, 0, 0, 0
    .short 2952, 2952, 2952, 2932, 2932, 2932, 2916, 2916, 2916, 0, 0, 0, 0, 0, 0, 0
    .short 2916, 2916, 2916, 2896, 2896, 2896, 2880, 2880, 2880, 0, 0, 0, 0, 0, 0, 0
    .short 2880, 2880, 2880, 2860, 2860, 2860, 2844, 2844, 2844, 0, 0, 0, 0, 0, 0, 0
    .short 2844, 2844, 2844, 2824, 2824, 2824, 2808, 2808, 2808, 0, 0, 0, 0, 0, 0, 0
    .short 2808, 2808, 2808, 2788, 2788, 2788, 2772, 2772, 2772, 0, 0, 0, 0, 0, 0, 0
    .short 2772, 2772, 2772, 2752, 2752, 2752, 2736, 2736, 2736, 0, 0, 0, 0, 0, 0, 0
    .short 2736, 2736, 2736, 2716, 2716, 2716, 2700, 2700, 2700, 0, 0, 0, 0, 0, 0, 0
    .short 2700, 2700, 2700, 2680, 2680, 2680, 2664, 2664, 2664, 0, 0, 0, 0, 0, 0, 0
    .short 2664, 2664, 2664, 2644, 2644, 2644, 2628, 2628, 2628, 0, 0, 0, 0, 0, 0, 0
    .short 2628, 2628, 2628, 2608, 2608, 2608, 2592, 2592, 2592, 0, 0, 0, 0, 0, 0, 0
    .short 2592, 2592, 2592, 2572, 2572, 2572, 2556, 2556, 2556, 0, 0, 0, 0, 0, 0, 0
    .short 2556, 2556, 2556, 2536, 2536, 2536, 2520, 2520, 2520, 0, 0, 0, 0, 0, 0, 0
    .short 2520, 2520, 2520, 2500, 2500, 2500, 2484, 2484, 2484, 0, 0, 0, 0, 0, 0, 0
    .short 2484, 2484, 2484, 2464, 2464, 2464, 2448, 2448, 2448, 0, 0, 0, 0, 0, 0, 0
    .short 2448, 2448, 2448, 2428, 2428, 2428, 2412, 2412, 2412, 0, 0, 0, 0, 0, 0, 0
    .short 2412, 2412, 2412, 2392, 2392, 2392, 2376, 2376, 2376, 0, 0, 0, 0, 0, 0, 0
    .short 2376, 2376, 2376, 2356, 2356, 2356, 2340, 2340, 2340, 0, 0, 0, 0, 0, 0, 0
    .short 2340, 2340, 2340, 2320, 2320, 2320, 2304, 2304, 2304, 0, 0, 0, 0, 0, 0, 0
    .short 2304, 2304, 2292, 2284, 2284, 2284, 2276, 2268, 2268, 0, 0, 0, 0, 0, 0, 0
    .short 2268, 2268, 2256, 2248, 2248, 2248, 2240, 2232, 2232, 0, 0, 0, 0, 0, 0, 0
    .short 2232, 2232, 2220, 2212, 2212, 2212, 2204, 2196, 2196, 0, 0, 0, 0, 0, 0, 0
    .short 2196, 2196, 2184, 2176, 2176, 2176, 2168, 2160, 2160, 0, 0, 0, 0, 0, 0, 0
    .short 2160, 2160, 2148, 2140, 2140, 2140, 2132, 2124, 2124, 0, 0, 0, 0, 0, 0, 0
    .short 2124, 2124, 2112, 2104, 2104, 2104, 2096, 2088, 2088, 0, 0, 0, 0, 0, 0, 0
    .short 2088, 2088, 2076, 2068, 2068, 2068, 2060, 2052, 2052, 0, 0, 0, 0, 0, 0, 0
    .short 2052, 2052, 2040, 2032, 2032, 2032, 2024, 2016, 2016, 0, 0, 0, 0, 0, 0, 0
    .short 2016, 2016, 2004, 1996, 1996, 1996, 1988, 1980, 1980, 0, 0, 0, 0, 0, 0, 0
    .short 1980, 1980, 1968, 1960, 1960, 1960, 1952, 1944, 1944, 0, 0, 0, 0, 0, 0, 0
    .short 1944, 1944, 1932, 1924, 1924, 1924, 1916, 1908, 1908, 0, 0, 0, 0, 0, 0, 0
    .short 1908, 1908, 1896, 1888, 1888, 1888, 1880, 1872, 1872, 0, 0, 0, 0, 0, 0, 0
    .short 1872, 1872, 1860, 1852, 1852, 1852, 1844, 1836, 1836, 0, 0, 0, 0, 0, 0, 0
    .short 1836, 1836, 1824, 1816, 1816, 1816, 1808, 1800, 1800, 0, 0, 0, 0, 0, 0, 0
    .short 1800, 1800, 1788, 1780, 1780, 1780, 1772, 1764, 1764, 0, 0, 0, 0, 0, 0, 0
    .short 1764, 1764, 1752, 1744, 1744, 1744, 1736, 1728, 1728, 0, 0, 0, 0, 0, 0, 0
    .short 1728, 1728, 1716, 1708, 1708, 1708, 1700, 1692, 1692, 0, 0, 0, 0, 0, 0, 0
    .short 1692, 1692, 1680, 1672, 1672, 1672, 1664, 1656, 1656, 0, 0, 0, 0, 0, 0, 0
    .short 1656, 1656, 1644, 1636, 1636, 1636, 1628, 1620, 1620, 0, 0, 0, 0, 0, 0, 0
    .short 1620, 1620, 1608, 1600, 1600, 1600, 1592, 1584, 1584, 0, 0, 0, 0, 0, 0, 0
    .short 1584, 1584, 1572, 1564, 1564, 1564, 1556, 1548, 1548, 0, 0, 0, 0, 0, 0, 0
    .short 1548, 1548, 1536, 1528, 1528, 1528, 1520, 1512, 1512, 0, 0, 0, 0, 0, 0, 0
    .short 1512, 1512, 1500, 1492, 1492, 1492, 1484, 1476, 1476, 0, 0, 0, 0, 0, 0, 0
    .short 1476, 1476, 1464, 1456, 1456, 1456, 1448, 1440, 1440, 0, 0, 0, 0, 0, 0, 0
    .short 1440, 1440, 1428, 1420, 1420, 1420, 1412, 1404, 1404, 0, 0, 0, 0, 0, 0, 0
    .short 1404, 1404, 1392, 1384, 1384, 1384, 1376, 1368, 1368, 0, 0, 0, 0, 0, 0, 0
    .short 1368, 1368, 1356, 1348, 1348, 1348, 1340, 1332, 1332, 0, 0, 0, 0, 0, 0, 0
    .short 1332, 1332, 1320, 1312, 1312, 1312, 1304, 1296, 1296, 0, 0, 0, 0, 0, 0, 0
    .short 1296, 1296, 1284, 1276, 1276, 1276, 1268, 1260, 1260, 0, 0, 0, 0, 0, 0, 0
    .short 1260, 1260, 1248, 1240, 1240, 1240, 1232, 1224, 1224, 0, 0, 0, 0, 0, 0, 0
    .short 1224, 1224, 1212, 1204, 1204, 1204, 1196, 1188, 1188, 0, 0, 0, 0, 0, 0, 0
    .short 1188, 1188, 1176, 1168, 1168, 1168, 1160, 1152, 1152, 0, 0, 0, 0, 0, 0, 0
    .short 1152, 1144, 1140, 1136, 1132, 1128, 1124, 1120, 1116, 0, 0, 0, 0, 0, 0, 0
    .short 1116, 1108, 1104, 1100, 1096, 1092, 1088, 1084, 1080, 0, 0, 0, 0, 0, 0, 0
    .short 1080, 1072, 1068, 1064, 1060, 1056, 1052, 1048, 1044, 0, 0, 0, 0, 0, 0, 0
    .short 1044, 1036, 1032, 1028, 1024, 1020, 1016, 1012, 1008, 0, 0, 0, 0, 0, 0, 0
    .short 1008, 1000, 996, 992, 988, 984, 980, 976, 972, 0, 0, 0, 0, 0, 0, 0
    .short 972, 964, 960, 956, 952, 948, 944, 940, 936, 0, 0, 0, 0, 0, 0, 0
    .short 936, 928, 924, 920, 916, 912, 908, 904, 900, 0, 0, 0, 0, 0, 0, 0
    .short 900, 892, 888, 884, 880, 876, 872, 868, 864, 0, 0, 0, 0, 0, 0, 0
    .short 864, 856, 852, 848, 844, 840, 836, 832, 828, 0, 0, 0, 0, 0, 0, 0
    .short 828, 820, 816, 812, 808, 804, 800, 796, 792, 0, 0, 0, 0, 0, 0, 0
    .short 792, 784, 780, 776, 772, 768, 764, 760, 756, 0, 0, 0, 0, 0, 0, 0
    .short 756, 748, 744, 740, 736, 732, 728, 724, 720, 0, 0, 0, 0, 0, 0, 0
    .short 720, 712, 708, 704, 700, 696, 692, 688, 684, 0, 0, 0, 0, 0, 0, 0
    .short 684, 676, 672, 668, 664, 660, 656, 652, 648, 0, 0, 0, 0, 0, 0, 0
    .short 648, 640, 636, 632, 628, 624, 620, 616, 612, 0, 0, 0, 0, 0, 0, 0
    .short 612, 604, 600, 596, 592, 588, 584, 580, 576, 0, 0, 0, 0, 0, 0, 0
    .short 576, 568, 564, 560, 556, 552, 548, 544, 540, 0, 0, 0, 0, 0, 0, 0
    .short 540, 532, 528, 524, 520, 516, 512, 508, 504, 0, 0, 0, 0, 0, 0, 0
    .short 504, 496, 492, 488, 484, 480, 476, 472, 468, 0, 0, 0, 0, 0, 0, 0
    .short 468, 460, 456, 452, 448, 444, 440, 436, 432, 0, 0, 0, 0, 0, 0, 0
    .short 432, 424, 420, 416, 412, 408, 404, 400, 396, 0, 0, 0, 0, 0, 0, 0
    .short 396, 388, 384, 380, 376, 372, 368, 364, 360, 0, 0, 0, 0, 0, 0, 0
    .short 360, 352, 348, 344, 340, 336, 332, 328, 324, 0, 0, 0, 0, 0, 0, 0
    .short 324, 316, 312, 308, 304, 300, 296, 292, 288, 0, 0, 0, 0, 0, 0, 0
    .short 288, 280, 276, 272, 268, 264, 260, 256, 252, 0, 0, 0, 0, 0, 0, 0
    .short 252, 244, 240, 236, 232, 228, 224, 220, 216, 0, 0, 0, 0, 0, 0, 0
    .short 216, 208, 204, 200, 196, 192, 188, 184, 180, 0, 0, 0, 0, 0, 0, 0
    .short 180, 172, 168, 164, 160, 156, 152, 148, 144, 0, 0, 0, 0, 0, 0, 0
    .short 144, 136, 132, 128, 124, 120, 116, 112, 108, 0, 0, 0, 0, 0, 0, 0
    .short 108, 100, 96, 92, 88, 84, 80, 76, 72, 0, 0, 0, 0, 0, 0, 0
    .short 72, 64, 60, 56, 52, 48, 44, 40, 36, 0, 0, 0, 0, 0, 0, 0
    .short 36, 28, 24, 20, 16, 12, 8, 4, 0, 0, 0, 0, 0, 0, 0, 0
    .long 0, 1, 2, 3, 4, 5, 6, 7, 128, 129, 130, 131, 132, 133, 134, 135, 256, 258, 260, 262, 384, 386, 388, 390, 512, 516, 640, 644, 768, 772, 896, 900, 1024, 1152, 1280, 1408, 1536, 1664, 1792, 1920, 2048, 2176, 2304, 2432, 2560, 2688, 2816, 2944, 1024, 1152, 1280, 1408, 1536, 1664, 1792, 1920, 2048, 2176, 2304, 2432, 2560, 2688, 2816, 2944
.size kgen_tab, 8448
text_end:
.section .rodata,"a"
.p2align 6
.amdhsa_kernel main_kernel
  .amdhsa_next_free_vgpr 168
  .amdhsa_next_free_sgpr 96
  .amdhsa_accum_offset 168
  .amdhsa_group_segment_fixed_size 0
  .amdhsa_kernarg_size 120
  .amdhsa_user_sgpr_count 2
  .amdhsa_user_sgpr_kernarg_segment_ptr 1
  .amdhsa_system_sgpr_workgroup_id_x 1
.end_amdhsa_kernel
```

```asm
; @launch kernel=main_kernel grid=(256,1,1) block=(768,1,1) lds=163840
.amdgcn_target "amdgcn-amd-amdhsa--gfx950"
.text
.globl main_kernel
.p2align 8
.type main_kernel,@function
main_kernel:
    s_cmp_ge_u32 s2, 256
    s_cbranch_scc1 k_exit
    s_load_dwordx4 s[68:71], s[0:1], 0
    s_load_dwordx4 s[64:67], s[0:1], 104
    s_load_dwordx2 s[72:73], s[0:1], 16
    s_load_dwordx2 s[74:75], s[0:1], 96
    s_load_dwordx16 s[80:95], s[0:1], 32
    v_lshrrev_b32 v2, 6, v0
    s_and_b32 s22, s2, 7
    s_lshr_b32 s23, s2, 3
    v_readfirstlane_b32 s27, v2
    s_lshl_b32 s24, s22, 2
    s_lshr_b32 s25, s23, 3
    s_add_u32 s24, s24, s25
    s_and_b32 s25, s23, 7
    s_lshl_b32 s24, s24, 6
    s_lshl_b32 s77, s22, 5
    s_add_u32 s77, s77, s23
    s_mov_b32 s52, 1
    s_mov_b32 s78, 0
    v_and_b32 v1, 63, v0
    v_and_b32 v12, 15, v0
    v_lshrrev_b32 v13, 4, v1
    v_lshlrev_b32 v5, 4, v1
    s_cmp_lt_u32 s27, 4
    s_nop 1
    s_cbranch_scc1 comp_start
    s_setprio 3
    s_sub_u32 s28, s27, 4
    s_lshr_b32 s38, s28, 2
    s_and_b32 s39, s28, 3
    v_lshrrev_b32 v6, 3, v1
    v_lshrrev_b32 v7, 4, v1
    s_and_b32 s29, s28, 1
    s_lshl_b32 s29, s29, 2
    v_xor_b32 v7, s29, v7
    v_and_b32 v2, 7, v1
    v_xor_b32 v2, v2, v7
    v_lshlrev_b32 v2, 4, v2
    s_lshl_b32 s29, s28, 3
    s_add_u32 s29, s29, s24
    s_sub_u32 s29, s29, 16
    v_add_u32 v3, s29, v6
    v_lshl_add_u32 v2, v3, 10, v2
    v_add_u32 v3, 0x10000, v2
    s_movk_i32 s26, 128
    s_movk_i32 s63, 128
    s_cmp_eq_u32 s28, 0
    s_cselect_b32 s40, 0xffffff00, -1
    v_lshrrev_b32 v4, 2, v6
    v_lshlrev_b32 v4, 3, v4
    v_and_b32 v7, 3, v6
    v_add_u32 v14, v4, v7
    s_lshr_b32 s29, s39, 1
    s_lshl_b32 s29, s29, 4
    s_and_b32 s33, s39, 1
    s_lshl_b32 s33, s33, 2
    s_add_u32 s29, s29, s33
    v_add_u32 v14, s29, v14
    s_lshl_b32 s33, s38, 5
    v_add_u32 v4, s33, v14
    v_mul_u32_u24 v4, 3072, v4
    v_bfe_u32 v7, v1, 1, 2
    v_xor_b32 v7, v7, v13
    v_lshlrev_b32 v7, 5, v7
    v_and_b32 v8, 1, v1
    v_lshl_add_u32 v7, v8, 4, v7
    s_lshl_b32 s29, s25, 7
    v_add3_u32 v4, v4, v7, s29
    s_mov_b32 s30, 0
    s_mov_b32 s62, 0
    s_mov_b32 s31, 0
    s_mov_b32 s32, 0
    s_mul_i32 s50, s28, 3072
    s_add_u32 s50, s50, 10240
    s_lshl_b32 s51, s28, 10
    s_mov_b32 s41, -1
    s_waitcnt lgkmcnt(0)
    s_mov_b32 s4, s68
    s_mov_b32 s5, s69
    s_mov_b32 s6, 0x00200000
    s_mov_b32 s7, 0x00020000
    s_mov_b32 s8, s70
    s_mov_b32 s9, s71
    s_mov_b32 s10, 0x00180000
    s_mov_b32 s11, 0x00020000
    s_add_u32 m0, s30, s51
    s_mov_b64 exec, s[40:41]
    buffer_load_dwordx4 v2, s[4:7], s31 offen sc1 lds
    s_mov_b64 exec, -1
    s_cmp_lt_u32 s28, 2
    s_cbranch_scc0 ld_nx_1
    s_add_u32 m0, m0, 8192
    s_nop 0
    buffer_load_dwordx4 v3, s[4:7], s62 offen sc1 lds
    s_add_u32 s62, s62, s63
ld_nx_1:
    s_add_u32 m0, s30, s50
    s_add_u32 s31, s31, s26
    buffer_load_dwordx4 v4, s[8:11], s32 offen lds
    buffer_load_dwordx4 v4, s[8:11], s32 offen offset:1024 lds
    buffer_load_dwordx4 v4, s[8:11], s32 offen offset:2048 lds
    s_add_u32 s32, s32, 196608
    s_add_u32 s30, s30, 34816
    s_cmp_ge_u32 s30, 104448
    s_cselect_b32 s30, 0, s30
    s_lshr_b32 s20, s28, 2
    s_lshl_b32 s21, s77, 1
    s_add_u32 s21, s21, s20
    s_lshl_b32 s22, s21, 8
    s_and_b32 s33, s28, 1
    s_lshl_b32 s33, s33, 7
    s_add_u32 s22, s22, s33
    v_lshl_add_u32 v64, v1, 1, s22
    s_lshl_b32 s21, s21, 1
    v_mov_b32 v65, s21
    v_mov_b32 v48, 0
    v_mov_b32 v49, 0
    v_mov_b32 v50, 0
    v_mov_b32 v51, 0
    v_mov_b32 v52, 0
    v_mov_b32 v53, 0
    v_mov_b32 v54, 0
    global_load_short_d16_hi v54, v65, s[92:93]
    global_load_short_d16_hi v48, v64, s[80:81]
    global_load_short_d16_hi v49, v64, s[82:83]
    global_load_short_d16_hi v50, v64, s[84:85]
    global_load_short_d16_hi v51, v64, s[86:87]
    global_load_short_d16_hi v52, v64, s[88:89]
    global_load_short_d16_hi v53, v64, s[90:91]
    s_getpc_b64 s[20:21]
kg_pc:
    s_add_u32 s20, s20, kgen_tab-kg_pc
    s_addc_u32 s21, s21, 0
    s_lshl_b32 s33, s39, 6
    v_add_u32 v64, s33, v1
    v_lshlrev_b32 v64, 5, v64
    v_lshl_add_u32 v65, v13, 4, s33
    v_add_u32 v65, 0x2000, v65
    global_load_dwordx4 v[56:59], v64, s[20:21]
    global_load_dword v55, v64, s[20:21] offset:16
    global_load_dwordx4 v[60:63], v65, s[20:21]
    s_add_u32 m0, s30, s51
    s_mov_b64 exec, s[40:41]
    buffer_load_dwordx4 v2, s[4:7], s31 offen sc1 lds
    s_mov_b64 exec, -1
    s_cmp_lt_u32 s28, 2
    s_cbranch_scc0 ld_nx_2
    s_add_u32 m0, m0, 8192
    s_nop 0
    buffer_load_dwordx4 v3, s[4:7], s62 offen sc1 lds
    s_add_u32 s62, s62, s63
ld_nx_2:
    s_add_u32 m0, s30, s50
    s_add_u32 s31, s31, s26
    buffer_load_dwordx4 v4, s[8:11], s32 offen lds
    buffer_load_dwordx4 v4, s[8:11], s32 offen offset:1024 lds
    buffer_load_dwordx4 v4, s[8:11], s32 offen offset:2048 lds
    s_add_u32 s32, s32, 196608
    s_add_u32 s30, s30, 34816
    s_cmp_ge_u32 s30, 104448
    s_cselect_b32 s30, 0, s30
    s_mov_b32 s12, s72
    s_mov_b32 s13, s73
    s_mov_b32 s14, 0x00080000
    s_mov_b32 s15, 0x00020000
    s_mov_b32 s16, s66
    s_mov_b32 s17, s67
    s_mov_b32 s18, 0x01800000
    s_mov_b32 s19, 0x00020000
    v_lshl_add_u32 v14, v14, 10, v7
    s_and_b32 s33, s25, 3
    s_lshl_b32 s33, s33, 8
    s_lshl_b32 s29, s38, 7
    s_add_u32 s33, s33, s29
    v_add_u32 v14, s33, v14
    s_max_u32 s29, s28, 3
    s_sub_u32 s29, s29, 3
    v_lshrrev_b32 v10, 3, v12
    v_lshlrev_b32 v10, 10, v10
    v_and_b32 v9, 7, v12
    v_lshl_add_u32 v10, v9, 7, v10
    v_lshrrev_b32 v9, 1, v12
    v_xor_b32 v9, v9, v13
    v_lshl_add_u32 v10, v9, 4, v10
    s_lshl_b32 s33, s29, 11
    v_add_u32 v8, s33, v10
    s_cmp_eq_u32 s28, 3
    s_cselect_b32 s44, 1, 0
    s_lshl_b32 s60, s39, 11
    s_lshl_b32 s33, s38, 10
    s_add_u32 s60, s60, s33
    s_add_u32 s60, s60, 106496
    s_mov_b32 s61, 0
    s_mov_b32 s36, 0
    v_mov_b32 v24, 0x3f803f80
    v_mov_b32 v25, 0x3f803f80
    v_mov_b32 v26, 0x3f803f80
    v_mov_b32 v27, 0x3f803f80
    v_mov_b32 v28, 0x3f803f80
    v_mov_b32 v29, 0x3f803f80
    v_mov_b32 v30, 0x3f803f80
    v_mov_b32 v31, 0x3f803f80
    v_mov_b32 v40, 0
    v_mov_b32 v41, 0
    v_mov_b32 v42, 0
    v_mov_b32 v43, 0
    v_mov_b32 v44, 0
    v_mov_b32 v45, 0
    v_mov_b32 v46, 0
    v_mov_b32 v47, 0
    v_mov_b32 v16, 0x3f803f80
    v_mov_b32 v17, 0x3f803f80
    v_mov_b32 v18, 0x3f803f80
    v_mov_b32 v19, 0x3f803f80
    s_min_u32 s33, s39, 2
    s_mul_i32 s33, s33, 34816
    v_add_u32 v6, s33, v5
    s_mov_b64 exec, 0xff
    ds_write_b128 v6, v[16:19]
    s_mov_b64 exec, -1
    s_cmp_eq_u32 s28, 0
    s_cbranch_scc0 ld_nozf_3
    v_mov_b32 v6, 0
    v_and_b32 v7, 7, v1
    v_lshlrev_b32 v7, 2, v7
    v_add_u32 v7, 106368, v7
    ds_write_b32 v7, v6
ld_nozf_3:
ld_main:
    s_mov_b32 s34, 0
ld_loop:
    s_lshl1_add_u32 s33, s34, s52
    s_cmp_eq_u32 s33, 1
    s_cbranch_scc0 ld_w4
    s_waitcnt vmcnt(15) lgkmcnt(0)
    s_cmp_lt_u32 s28, 2
    s_cbranch_scc1 ld_w5
    s_waitcnt vmcnt(14)
    s_branch ld_w5
ld_w4:
    s_waitcnt vmcnt(5) lgkmcnt(0)
    s_cmp_lt_u32 s28, 2
    s_cbranch_scc1 ld_w5
    s_waitcnt vmcnt(4)
ld_w5:
    s_barrier
    s_cmp_lt_u32 s28, 3
    s_cbranch_scc1 ld_nx_4_r
    v_add_u32 v6, s36, v8
    s_cmp_eq_u32 s52, 2
    s_cbranch_scc1 ld_nx_4_t
    v_add_u32 v7, s36, v10
    ds_read_b128 v[16:19], v6
    ds_read_b128 v[24:27], v7
    v_xor_b32 v6, 64, v6
    v_xor_b32 v7, 64, v7
    ds_read_b128 v[20:23], v6
    ds_read_b128 v[28:31], v7
    s_branch ld_nx_4_u
ld_nx_4_t:
    v_add_u32 v7, s36, v11
    ds_read_b64_tr_b16 v[16:17], v6
    ds_read_b64_tr_b16 v[18:19], v7
    v_add_u32 v6, s45, v6
    v_add_u32 v7, s45, v7
    ds_read_b64_tr_b16 v[20:21], v6
    ds_read_b64_tr_b16 v[22:23], v7
ld_nx_4_u:
    s_add_u32 s36, s36, 34816
    s_cmp_ge_u32 s36, 104448
    s_cselect_b32 s36, 0, s36
ld_nx_4_r:
    s_add_u32 m0, s30, s51
    s_mov_b64 exec, s[40:41]
    buffer_load_dwordx4 v2, s[4:7], s31 offen sc1 lds
    s_mov_b64 exec, -1
    s_cmp_lt_u32 s28, 2
    s_cbranch_scc0 ld_nx_4
    s_add_u32 m0, m0, 8192
    s_nop 0
    buffer_load_dwordx4 v3, s[4:7], s62 offen sc1 lds
    s_add_u32 s62, s62, s63
ld_nx_4:
    s_add_u32 m0, s30, s50
    s_add_u32 s31, s31, s26
    buffer_load_dwordx4 v4, s[8:11], s32 offen lds
    s_cmp_lt_u32 s28, 3
    s_cbranch_scc1 ld_nx_4_a
    s_waitcnt lgkmcnt(0)
    v_mfma_f32_16x16x32_bf16 v[40:43], v[16:19], v[16:19], v[40:43]
    v_mfma_f32_16x16x32_bf16 v[40:43], v[20:23], v[20:23], v[40:43]
    s_cmp_eq_u32 s44, 1
    s_cbranch_scc1 ld_nx_4_a
    v_mfma_f32_16x16x32_bf16 v[44:47], v[16:19], v[24:27], v[44:47]
    v_mfma_f32_16x16x32_bf16 v[44:47], v[20:23], v[28:31], v[44:47]
ld_nx_4_a:
    buffer_load_dwordx4 v4, s[8:11], s32 offen offset:1024 lds
    buffer_load_dwordx4 v4, s[8:11], s32 offen offset:2048 lds
    s_add_u32 s32, s32, 196608
    s_add_u32 s30, s30, 34816
    s_cmp_ge_u32 s30, 104448
    s_cselect_b32 s30, 0, s30
    s_cmp_eq_u32 s52, 1
    s_cbranch_scc1 kg_piece
ld_kgret:
    s_add_u32 s34, s34, 1
    s_cmp_lt_u32 s34, 6
    s_cbranch_scc1 ld_loop
    s_waitcnt vmcnt(4)
    s_barrier
    s_cmp_lt_u32 s28, 3
    s_cbranch_scc1 ld_nx_5_r
    v_add_u32 v6, s36, v8
    s_cmp_eq_u32 s52, 2
    s_cbranch_scc1 ld_nx_5_t
    v_add_u32 v7, s36, v10
    ds_read_b128 v[16:19], v6
    ds_read_b128 v[24:27], v7
    v_xor_b32 v6, 64, v6
    v_xor_b32 v7, 64, v7
    ds_read_b128 v[20:23], v6
    ds_read_b128 v[28:31], v7
    s_branch ld_nx_5_u
ld_nx_5_t:
    v_add_u32 v7, s36, v11
    ds_read_b64_tr_b16 v[16:17], v6
    ds_read_b64_tr_b16 v[18:19], v7
    v_add_u32 v6, s45, v6
    v_add_u32 v7, s45, v7
    ds_read_b64_tr_b16 v[20:21], v6
    ds_read_b64_tr_b16 v[22:23], v7
ld_nx_5_u:
    s_add_u32 s36, s36, 34816
    s_cmp_ge_u32 s36, 104448
    s_cselect_b32 s36, 0, s36
ld_nx_5_r:
    s_mov_b32 m0, s60
    s_add_u32 s60, s60, 8192
    buffer_load_dwordx4 v14, s[12:15], s61 offen lds
    s_add_u32 s61, s61, 32768
    s_mov_b32 m0, s60
    s_add_u32 s60, s60, 8192
    buffer_load_dwordx4 v14, s[12:15], s61 offen lds
    s_add_u32 s61, s61, 32768
    s_mov_b32 m0, s60
    s_add_u32 s60, s60, 8192
    buffer_load_dwordx4 v14, s[12:15], s61 offen lds
    s_add_u32 s61, s61, 32768
    s_mov_b32 m0, s60
    s_add_u32 s60, s60, 8192
    buffer_load_dwordx4 v14, s[12:15], s61 offen lds
    s_add_u32 s61, s61, 32768
    s_cmp_lt_u32 s28, 3
    s_cbranch_scc1 ld_nx_5_a
    s_waitcnt lgkmcnt(0)
    v_mfma_f32_16x16x32_bf16 v[40:43], v[16:19], v[16:19], v[40:43]
    v_mfma_f32_16x16x32_bf16 v[40:43], v[20:23], v[20:23], v[40:43]
    s_cmp_eq_u32 s44, 1
    s_cbranch_scc1 ld_nx_5_a
    v_mfma_f32_16x16x32_bf16 v[44:47], v[16:19], v[24:27], v[44:47]
    v_mfma_f32_16x16x32_bf16 v[44:47], v[20:23], v[28:31], v[44:47]
ld_nx_5_a:
    s_waitcnt vmcnt(4)
    s_barrier
    s_cmp_lt_u32 s28, 3
    s_cbranch_scc1 ld_nx_6_r
    v_add_u32 v6, s36, v8
    s_cmp_eq_u32 s52, 2
    s_cbranch_scc1 ld_nx_6_t
    v_add_u32 v7, s36, v10
    ds_read_b128 v[16:19], v6
    ds_read_b128 v[24:27], v7
    v_xor_b32 v6, 64, v6
    v_xor_b32 v7, 64, v7
    ds_read_b128 v[20:23], v6
    ds_read_b128 v[28:31], v7
    s_branch ld_nx_6_u
ld_nx_6_t:
    v_add_u32 v7, s36, v11
    ds_read_b64_tr_b16 v[16:17], v6
    ds_read_b64_tr_b16 v[18:19], v7
    v_add_u32 v6, s45, v6
    v_add_u32 v7, s45, v7
    ds_read_b64_tr_b16 v[20:21], v6
    ds_read_b64_tr_b16 v[22:23], v7
ld_nx_6_u:
    s_add_u32 s36, s36, 34816
    s_cmp_ge_u32 s36, 104448
    s_cselect_b32 s36, 0, s36
ld_nx_6_r:
    s_mov_b32 m0, s60
    s_add_u32 s60, s60, 8192
    buffer_load_dwordx4 v14, s[12:15], s61 offen lds
    s_add_u32 s61, s61, 32768
    s_mov_b32 m0, s60
    s_add_u32 s60, s60, 8192
    buffer_load_dwordx4 v14, s[12:15], s61 offen lds
    s_add_u32 s61, s61, 32768
    s_mov_b32 m0, s60
    s_add_u32 s60, s60, 8192
    buffer_load_dwordx4 v14, s[12:15], s61 offen lds
    s_add_u32 s61, s61, 32768
    s_cmp_lt_u32 s28, 3
    s_cbranch_scc1 ld_nx_6_a
    s_waitcnt lgkmcnt(0)
    v_mfma_f32_16x16x32_bf16 v[40:43], v[16:19], v[16:19], v[40:43]
    v_mfma_f32_16x16x32_bf16 v[40:43], v[20:23], v[20:23], v[40:43]
    s_cmp_eq_u32 s44, 1
    s_cbranch_scc1 ld_nx_6_a
    v_mfma_f32_16x16x32_bf16 v[44:47], v[16:19], v[24:27], v[44:47]
    v_mfma_f32_16x16x32_bf16 v[44:47], v[20:23], v[28:31], v[44:47]
ld_nx_6_a:
    s_cmp_lt_u32 s28, 3
    s_cbranch_scc1 ld_fin
    s_sub_u32 s29, s28, 3
    s_lshl_b32 s33, s29, 7
    s_add_u32 s33, s33, 105728
    v_lshlrev_b32 v6, 2, v12
    v_add_u32 v6, s33, v6
    v_lshlrev_b32 v7, 4, v13
    v_add_u32 v7, s33, v7
    v_and_b32 v16, 1, v12
    v_cmp_eq_u32 vcc, 1, v16
    v_and_b32 v16, 2, v12
    s_cmp_eq_u32 s44, 1
    s_cselect_b64 s[46:47], -1, 0
    v_cmp_eq_u32 s[48:49], 2, v16
    s_nop 4
    v_cndmask_b32 v16, v40, v41, vcc
    v_cndmask_b32 v17, v42, v43, vcc
    v_cndmask_b32 v20, v44, v40, s[46:47]
    v_cndmask_b32 v21, v45, v41, s[46:47]
    v_cndmask_b32 v22, v46, v42, s[46:47]
    v_cndmask_b32 v23, v47, v43, s[46:47]
    v_cndmask_b32 v16, v16, v17, s[48:49]
    s_mov_b32 s42, 0x00f0000f
    s_mov_b32 s43, 0xf0000f00
    s_mov_b64 exec, s[42:43]
    ds_write_b32 v6, v16 offset:64
    s_mov_b32 s42, 0x00010001
    s_mov_b32 s43, 0x00010001
    s_mov_b64 exec, s[42:43]
    ds_write_b128 v7, v[20:23]
    s_mov_b64 exec, -1
    s_waitcnt lgkmcnt(0)
    ds_read2_b32 v[40:41], v6 offset0:0 offset1:16
    s_lshl_b32 s33, s78, 2
    s_add_u32 s33, s33, 106368
    v_mov_b32 v18, s33
    s_waitcnt lgkmcnt(0)
    v_cmp_u_f32 vcc, v41, v41
    v_mul_f32 v40, 0x3b000000, v40
    v_mul_f32 v41, 0x3b000000, v41
    s_cmp_eq_u32 s52, 2
    s_cselect_b64 exec, vcc, 0
    s_cbranch_execz ld_noflag
    ds_write_b32 v18, v18
ld_noflag:
    s_mov_b64 exec, -1
    v_fma_f32 v41, -v40, v40, v41
    v_max_f32 v41, 0, v41
    v_cvt_pk_bf16_f32 v40, v40, v41
    v_and_b32 v17, 0xffff0000, v40
    v_lshlrev_b32 v16, 16, v40
    v_add_f32 v17, 0x3727c5ac, v17
    v_cvt_pk_bf16_f32 v17, v17, v17
    v_lshlrev_b32 v17, 16, v17
    v_sqrt_f32 v17, v17
    s_nop 0
    v_cvt_pk_bf16_f32 v17, v17, v17
    v_lshlrev_b32 v17, 16, v17
    v_rcp_f32 v17, v17
    s_lshl_b32 s33, s29, 4
    v_add_u32 v6, s33, v12
    v_lshlrev_b32 v7, 2, v6
    v_lshlrev_b32 v6, 3, v6
    v_add_u32 v6, 104448, v6
    v_add_u32 v7, 105088, v7
    ds_write_b64 v6, v[16:17]
    ds_write2_b32 v7, v16, v17 offset0:0 offset1:80
    s_waitcnt lgkmcnt(0)
ld_fin:
    s_barrier
    s_setprio 0
    s_lshl_b32 s33, s78, 2
    s_add_u32 s33, s33, 106368
    v_mov_b32 v6, s33
    ds_read_b32 v6, v6
    s_mov_b32 s56, s64
    s_mov_b32 s57, s65
    s_mov_b32 s58, 0x00000100
    s_mov_b32 s59, 0x00020000
    s_lshr_b32 s35, s24, 3
    s_lshl2_add_u32 s35, s52, s35
    s_sub_u32 s35, s35, 4
    s_waitcnt lgkmcnt(0)
    v_readfirstlane_b32 s33, v6
    s_cmp_eq_u32 s33, 0
    s_cbranch_scc1 ld_go
    s_add_u32 s78, s78, 1
    s_cmp_lt_u32 s78, 8
    s_cbranch_scc0 ld_go0
    s_setprio 3
    s_mov_b32 s30, 0
    s_mov_b32 s62, 0
    s_mov_b32 s31, 0
    s_mov_b32 s32, 0
    s_waitcnt vmcnt(0)
    s_add_u32 m0, s30, s51
    s_mov_b64 exec, s[40:41]
    buffer_load_dwordx4 v2, s[4:7], s31 offen sc1 lds
    s_mov_b64 exec, -1
    s_cmp_lt_u32 s28, 2
    s_cbranch_scc0 ld_nx_7
    s_add_u32 m0, m0, 8192
    s_nop 0
    buffer_load_dwordx4 v3, s[4:7], s62 offen sc1 lds
    s_add_u32 s62, s62, s63
ld_nx_7:
    s_add_u32 m0, s30, s50
    s_add_u32 s31, s31, s26
    buffer_load_dwordx4 v4, s[8:11], s32 offen lds
    buffer_load_dwordx4 v4, s[8:11], s32 offen offset:1024 lds
    buffer_load_dwordx4 v4, s[8:11], s32 offen offset:2048 lds
    s_add_u32 s32, s32, 196608
    s_add_u32 s30, s30, 34816
    s_cmp_ge_u32 s30, 104448
    s_cselect_b32 s30, 0, s30
    s_add_u32 m0, s30, s51
    s_mov_b64 exec, s[40:41]
    buffer_load_dwordx4 v2, s[4:7], s31 offen sc1 lds
    s_mov_b64 exec, -1
    s_cmp_lt_u32 s28, 2
    s_cbranch_scc0 ld_nx_8
    s_add_u32 m0, m0, 8192
    s_nop 0
    buffer_load_dwordx4 v3, s[4:7], s62 offen sc1 lds
    s_add_u32 s62, s62, s63
ld_nx_8:
    s_add_u32 m0, s30, s50
    s_add_u32 s31, s31, s26
    buffer_load_dwordx4 v4, s[8:11], s32 offen lds
    buffer_load_dwordx4 v4, s[8:11], s32 offen offset:1024 lds
    buffer_load_dwordx4 v4, s[8:11], s32 offen offset:2048 lds
    s_add_u32 s32, s32, 196608
    s_add_u32 s30, s30, 34816
    s_cmp_ge_u32 s30, 104448
    s_cselect_b32 s30, 0, s30
    s_lshl_b32 s60, s39, 11
    s_lshl_b32 s33, s38, 10
    s_add_u32 s60, s60, s33
    s_add_u32 s60, s60, 106496
    s_mov_b32 s61, 0
    s_mov_b32 s36, 0
    v_mov_b32 v24, 0x3f803f80
    v_mov_b32 v25, 0x3f803f80
    v_mov_b32 v26, 0x3f803f80
    v_mov_b32 v27, 0x3f803f80
    v_mov_b32 v28, 0x3f803f80
    v_mov_b32 v29, 0x3f803f80
    v_mov_b32 v30, 0x3f803f80
    v_mov_b32 v31, 0x3f803f80
    v_mov_b32 v40, 0
    v_mov_b32 v41, 0
    v_mov_b32 v42, 0
    v_mov_b32 v43, 0
    v_mov_b32 v44, 0
    v_mov_b32 v45, 0
    v_mov_b32 v46, 0
    v_mov_b32 v47, 0
    s_nop 2
    s_branch ld_main
ld_go0:
    s_mov_b32 s78, 7
ld_go:
    v_mov_b32 v6, 0
    buffer_load_dword v31, v6, s[56:59], s35 offen sc1
    s_sub_u32 s60, s60, 163840
ld_wo:
    s_mov_b32 m0, s60
    s_add_u32 s60, s60, 8192
    buffer_load_dwordx4 v14, s[12:15], s61 offen lds
    s_add_u32 s61, s61, 32768
    s_cmp_lt_u32 s61, 524288
    s_cbranch_scc1 ld_wo
    s_and_b32 s36, s25, 3
    s_lshr_b32 s37, s25, 2
    s_lshl_b32 s37, s37, 5
    s_add_u32 s37, s37, s24
    s_cmp_eq_u32 s52, 2
    s_cbranch_scc1 ld_resxt
    s_lshl_b32 s32, s36, 8
    s_and_b32 s33, s28, 1
    s_lshl_b32 s33, s33, 2
    v_xor_b32 v8, s33, v13
    v_bfe_u32 v9, v1, 1, 3
    v_xor_b32 v8, v8, v9
    v_lshlrev_b32 v8, 5, v8
    v_and_b32 v7, 1, v1
    v_lshl_add_u32 v8, v7, 4, v8
    v_lshl_add_u32 v8, v13, 10, v8
    s_lshl_b32 s33, s28, 2
    s_add_u32 s33, s33, s37
    s_lshl_b32 s33, s33, 10
    s_add_u32 s33, s33, s32
    buffer_load_dwordx4 v[32:35], v8, s[4:7], s33 offen
    s_branch ld_havres
ld_resxt:
    v_lshrrev_b32 v8, 2, v1
    v_lshlrev_b32 v8, 7, v8
    v_and_b32 v9, 3, v1
    v_lshl_add_u32 v8, v9, 4, v8
    s_lshl_b32 s33, s36, 14
    s_lshl_b32 s34, s28, 11
    s_add_u32 s33, s33, s34
    s_lshl_b32 s34, s24, 10
    s_add_u32 s33, s33, s34
    s_sub_u32 s34, s37, s24
    s_lshl_b32 s34, s34, 1
    s_add_u32 s33, s33, s34
    buffer_load_dwordx4 v[32:35], v8, s[4:7], s33 offen sc1
ld_havres:
    v_lshrrev_b32 v6, 3, v1
    v_and_b32 v2, 7, v1
    v_xor_b32 v2, v2, v13
    v_lshrrev_b32 v9, 1, v2
    v_and_b32 v2, 1, v2
    v_lshlrev_b32 v2, 4, v2
    v_lshl_add_u32 v2, v9, 11, v2
    v_lshl_add_u32 v2, v6, 5, v2
    v_xor_b32 v3, 0x1000, v2
    s_lshl_b32 s33, s24, 10
    s_sub_u32 s34, s37, s24
    s_lshl_b32 s34, s34, 5
    s_add_u32 s33, s33, s34
    s_lshl_b32 s34, s28, 13
    s_add_u32 s33, s33, s34
    s_sub_u32 s34, s52, 1
    s_lshl_b32 s34, s34, 21
    s_add_u32 s33, s33, s34
    s_lshl_b32 s34, s28, 12
    s_add_u32 s34, s34, 73728
    v_add_u32 v9, s34, v5
    s_add_u32 s34, s51, 106496
    v_add_u32 v10, s34, v5
    v_mov_b32 v6, 0
    s_mov_b32 s34, 0
    s_waitcnt vmcnt(10)
    v_lshrrev_b32 v8, 4, v31
    v_and_b32 v8, 0x0f0f0f0f, v8
    v_and_b32 v7, 0x0f0f0f0f, v31
    v_add_u32 v7, v7, v8
    v_lshrrev_b32 v8, 16, v7
    v_add_u32 v7, v7, v8
    v_lshrrev_b32 v8, 8, v7
    v_add_u32 v7, v7, v8
    v_and_b32 v7, 0xff, v7
    v_cmp_ne_u32 vcc, 8, v7
    s_nop 3
    s_cbranch_vccz ld_arrd
ld_arr:
    buffer_load_dword v7, v6, s[56:59], s35 offen sc1
    s_add_u32 s34, s34, 1
    s_waitcnt vmcnt(0)
    v_lshrrev_b32 v8, 4, v7
    v_and_b32 v8, 0x0f0f0f0f, v8
    v_and_b32 v7, 0x0f0f0f0f, v7
    v_add_u32 v7, v7, v8
    v_lshrrev_b32 v8, 16, v7
    v_add_u32 v7, v7, v8
    v_lshrrev_b32 v8, 8, v7
    v_add_u32 v7, v7, v8
    v_and_b32 v7, 0xff, v7
    v_cmp_ne_u32 vcc, 8, v7
    s_cmp_gt_u32 s34, 32768
    s_cbranch_scc1 ld_arrd
    s_nop 3
    s_cbranch_vccnz ld_arr
ld_arrd:
    s_mov_b32 s34, 0
    s_barrier
ld_poll2:
    buffer_load_dwordx4 v[16:19], v2, s[16:19], s33 offen offset:0 sc1
    buffer_load_dwordx4 v[20:23], v3, s[16:19], s33 offen offset:256 sc1
    buffer_load_dwordx4 v[24:27], v2, s[16:19], s33 offen offset:512 sc1
    buffer_load_dwordx4 v[28:31], v3, s[16:19], s33 offen offset:768 sc1
    s_add_u32 s34, s34, 1
    s_waitcnt vmcnt(0)
    v_max3_u32 v7, v16, v20, v24
    v_max_u32 v7, v7, v28
    v_cmp_eq_u32 vcc, -1, v7
    s_nop 1
    s_cmp_gt_u32 s34, 32768
    s_cbranch_scc1 ld_polld
    s_cbranch_vccnz ld_poll2
ld_polld:
    ds_write_b128 v9, v[16:19] offset:0
    ds_write_b128 v9, v[20:23] offset:1024
    ds_write_b128 v9, v[24:27] offset:2048
    ds_write_b128 v9, v[28:31] offset:3072
    s_waitcnt lgkmcnt(0)
    s_barrier
    s_cmp_eq_u32 s52, 2
    s_cbranch_scc0 kg_pre
    s_barrier
    ds_write_b128 v10, v[32:35]
    v_mov_b32 v6, 0
    v_and_b32 v7, 7, v1
    v_lshlrev_b32 v7, 2, v7
    v_add_u32 v7, 126976, v7
    ds_write_b32 v7, v6
    s_waitcnt lgkmcnt(0)
    s_barrier
    s_branch cv_setup
kg_piece:
    s_cmp_lt_u32 s39, 2
    s_cbranch_scc0 kg_piece1
    s_cmp_eq_u32 s34, 1
    s_cbranch_scc1 kg_p0_0
    s_cmp_eq_u32 s34, 2
    s_cbranch_scc1 kg_p0_1
    s_cmp_eq_u32 s34, 3
    s_cbranch_scc1 kg_p0_2
    s_cmp_eq_u32 s34, 4
    s_cbranch_scc1 kg_p0_3
    s_cmp_eq_u32 s34, 5
    s_cbranch_scc1 kg_p0_4
    s_branch ld_kgret
kg_p0_0:
    s_setprio 0
    s_mov_b32 s20, 0x3fb8aa3b
    s_mov_b32 s21, 0x32a57060
    s_mov_b32 s22, 0x3f317218
    v_mul_f32 v72, s20, v54
    v_fma_f32 v73, v54, s20, -v72
    v_fma_f32 v73, v54, s21, v73
    v_exp_f32 v72, v72
    v_mul_f32 v73, s22, v73
    v_fma_f32 v72, v72, v73, v72
    v_cvt_pk_bf16_f32 v72, v72, v72
    v_lshlrev_b32 v72, 16, v72
    v_mul_f32 v48, v72, v48
    v_mul_f32 v49, v72, v49
    v_mul_f32 v50, v72, v50
    v_mul_f32 v51, v72, v51
    v_mul_f32 v74, s20, v48
    v_mul_f32 v75, v52, v50
    v_mul_f32 v76, v52, v51
    v_mul_f32 v65, 0x3e22f983, v49
    v_fma_f32 v75, -v53, v51, v75
    v_fma_f32 v76, v53, v50, v76
    v_mov_b32 v68, v74
    v_mov_b32 v70, 0x02081cea
    v_max3_f32 v69, abs(v75), abs(v76), v70
    v_max_f32_dpp v68, v68, v68 row_ror:8 row_mask:0xf bank_mask:0xf
    s_nop 0
    v_max_f32_dpp v69, v69, v69 row_ror:8 row_mask:0xf bank_mask:0xf
    v_max_f32_dpp v68, v68, v68 row_ror:4 row_mask:0xf bank_mask:0xf
    s_nop 0
    v_max_f32_dpp v69, v69, v69 row_ror:4 row_mask:0xf bank_mask:0xf
    v_max_f32_dpp v68, v68, v68 row_ror:2 row_mask:0xf bank_mask:0xf
    s_nop 0
    v_max_f32_dpp v69, v69, v69 row_ror:2 row_mask:0xf bank_mask:0xf
    v_max_f32_dpp v68, v68, v68 row_ror:1 row_mask:0xf bank_mask:0xf
    s_nop 0
    v_max_f32_dpp v69, v69, v69 row_ror:1 row_mask:0xf bank_mask:0xf
    v_mov_b32 v70, v68
    v_mov_b32 v71, v69
    s_nop 0
    v_permlane16_swap_b32 v68, v70
    v_permlane16_swap_b32 v69, v71
    v_max_f32 v68, v68, v70
    v_max_f32 v69, v69, v71
    v_mov_b32 v70, v68
    v_mov_b32 v71, v69
    s_nop 0
    v_permlane32_swap_b32 v68, v70
    v_permlane32_swap_b32 v69, v71
    v_max_f32 v68, v68, v70
    v_max_f32 v69, v69, v71
    v_rcp_f32 v70, v69
    v_sub_f32 v64, v74, v68
    v_mul_f32 v66, v75, v70
    v_mul_f32 v67, v76, v70
    v_rcp_f32 v69, v70
    v_mul_f32 v84, 0x3f800000, v64
    s_setprio 3
    s_nop 1
    s_branch ld_kgret
kg_p0_1:
    s_setprio 0
    v_mul_f32 v136, 0x3f800000, v65
    v_mul_f32 v85, 0x40000000, v64
    v_mul_f32 v138, 0x40000000, v65
    v_mul_f32 v86, 0x40800000, v64
    v_mul_f32 v140, 0x40800000, v65
    v_mul_f32 v87, 0x43000000, v64
    v_mul_f32 v142, 0x43000000, v65
    v_mul_f32 v88, 0x43800000, v64
    v_mul_f32 v144, 0x43800000, v65
    v_mul_f32 v89, 0x44000000, v64
    v_mul_f32 v146, 0x44000000, v65
    v_exp_f32 v84, v84
    v_fract_f32 v136, v136
    v_exp_f32 v85, v85
    v_fract_f32 v138, v138
    v_exp_f32 v86, v86
    v_fract_f32 v140, v140
    v_exp_f32 v87, v87
    v_fract_f32 v142, v142
    v_exp_f32 v88, v88
    v_fract_f32 v144, v144
    v_exp_f32 v89, v89
    v_fract_f32 v146, v146
    v_sin_f32 v137, v136
    v_cos_f32 v136, v136
    v_sin_f32 v139, v138
    v_cos_f32 v138, v138
    v_sin_f32 v141, v140
    s_setprio 3
    s_nop 1
    s_branch ld_kgret
kg_p0_2:
    s_setprio 0
    v_cos_f32 v140, v140
    v_sin_f32 v143, v142
    v_cos_f32 v142, v142
    v_sin_f32 v145, v144
    v_cos_f32 v144, v144
    v_sin_f32 v147, v146
    v_cos_f32 v146, v146
    v_mul_f32 v137, v137, v84
    v_mul_f32 v136, v136, v84
    v_mul_f32 v139, v139, v85
    v_mul_f32 v138, v138, v85
    v_mul_f32 v141, v141, v86
    v_mul_f32 v140, v140, v86
    v_mul_f32 v143, v143, v87
    v_mul_f32 v142, v142, v87
    v_mul_f32 v145, v145, v88
    v_mul_f32 v144, v144, v88
    v_mul_f32 v147, v147, v89
    v_mul_f32 v146, v146, v89
    v_mov_b32 v104, 0x3c00
    v_cvt_pk_f16_f32 v105, v136, v137
    v_cvt_pk_f16_f32 v106, v138, v139
    v_cvt_pk_f16_f32 v107, v140, v141
    v_cvt_pk_f16_f32 v108, v142, v143
    v_cvt_pk_f16_f32 v109, v144, v145
    v_cvt_pk_f16_f32 v110, v146, v147
    v_mul_f32 v148, v136, v138
    v_mul_f32 v149, v136, v139
    v_mul_f32 v150, v136, v140
    v_mul_f32 v151, v136, v141
    v_mul_f32 v152, v138, v140
    v_mul_f32 v153, v138, v141
    v_mul_f32 v154, v142, v144
    v_mul_f32 v155, v142, v145
    v_mul_f32 v156, v146, v142
    s_setprio 3
    s_nop 1
    s_branch ld_kgret
kg_p0_3:
    s_setprio 0
    v_mul_f32 v157, v146, v143
    v_mul_f32 v158, v146, v144
    v_mul_f32 v159, v146, v145
    v_fma_f32 v148, -v137, v139, v148
    v_fma_f32 v149, v137, v138, v149
    v_fma_f32 v150, -v137, v141, v150
    v_fma_f32 v151, v137, v140, v151
    v_fma_f32 v152, -v139, v141, v152
    v_fma_f32 v153, v139, v140, v153
    v_fma_f32 v154, -v143, v145, v154
    v_fma_f32 v155, v143, v144, v155
    v_fma_f32 v156, -v147, v143, v156
    v_fma_f32 v157, v147, v142, v157
    v_fma_f32 v158, -v147, v145, v158
    v_fma_f32 v159, v147, v144, v159
    v_cvt_pk_f16_f32 v111, v148, v149
    v_cvt_pk_f16_f32 v112, v150, v151
    v_cvt_pk_f16_f32 v113, v152, v153
    v_cvt_pk_f16_f32 v114, v154, v155
    v_cvt_pk_f16_f32 v115, v156, v157
    v_cvt_pk_f16_f32 v116, v158, v159
    v_mul_f32 v160, v148, v140
    v_mul_f32 v161, v148, v141
    v_mul_f32 v162, v146, v154
    v_mul_f32 v163, v146, v155
    v_mul_f32 v72, v142, v136
    v_mul_f32 v73, v142, v137
    v_mul_f32 v74, v142, v138
    v_mul_f32 v75, v142, v139
    v_mul_f32 v76, v142, v148
    v_mul_f32 v77, v142, v149
    v_mul_f32 v78, v142, v140
    v_mul_f32 v79, v142, v141
    v_fma_f32 v160, -v149, v141, v160
    v_fma_f32 v161, v149, v140, v161
    v_fma_f32 v162, -v147, v155, v162
    v_fma_f32 v163, v147, v154, v163
    v_fma_f32 v72, -v143, v137, v72
    v_fma_f32 v73, v143, v136, v73
    v_fma_f32 v74, -v143, v139, v74
    v_fma_f32 v75, v143, v138, v75
    v_fma_f32 v76, -v143, v149, v76
    v_fma_f32 v77, v143, v148, v77
    v_fma_f32 v78, -v143, v141, v78
    v_fma_f32 v79, v143, v140, v79
    v_cvt_pk_f16_f32 v117, v160, v161
    v_cvt_pk_f16_f32 v118, v162, v163
    v_cvt_pk_f16_f32 v119, v72, v73
    v_cvt_pk_f16_f32 v120, v74, v75
    v_cvt_pk_f16_f32 v121, v76, v77
    v_cvt_pk_f16_f32 v122, v78, v79
    v_mul_f32 v80, v142, v150
    v_mul_f32 v81, v142, v151
    v_mul_f32 v82, v142, v152
    v_mul_f32 v83, v142, v153
    v_mul_f32 v72, v142, v160
    v_mul_f32 v73, v142, v161
    v_mul_f32 v74, v144, v138
    s_setprio 3
    s_nop 1
    s_branch ld_kgret
kg_p0_4:
    s_setprio 0
    v_mul_f32 v75, v144, v139
    v_mul_f32 v76, v144, v140
    v_mul_f32 v77, v144, v141
    v_mul_f32 v78, v144, v152
    v_mul_f32 v79, v144, v153
    v_fma_f32 v80, -v143, v151, v80
    v_fma_f32 v81, v143, v150, v81
    v_fma_f32 v82, -v143, v153, v82
    v_fma_f32 v83, v143, v152, v83
    v_fma_f32 v72, -v143, v161, v72
    v_fma_f32 v73, v143, v160, v73
    v_fma_f32 v74, -v145, v139, v74
    v_fma_f32 v75, v145, v138, v75
    v_fma_f32 v76, -v145, v141, v76
    v_fma_f32 v77, v145, v140, v77
    v_fma_f32 v78, -v145, v153, v78
    v_fma_f32 v79, v145, v152, v79
    v_cvt_pk_f16_f32 v123, v80, v81
    v_cvt_pk_f16_f32 v124, v82, v83
    v_cvt_pk_f16_f32 v125, v72, v73
    v_cvt_pk_f16_f32 v126, v74, v75
    v_cvt_pk_f16_f32 v127, v76, v77
    v_cvt_pk_f16_f32 v128, v78, v79
    v_mul_f32 v80, v154, v138
    v_mul_f32 v81, v154, v139
    v_mul_f32 v82, v154, v140
    v_mul_f32 v83, v154, v141
    v_mul_f32 v72, v154, v152
    v_mul_f32 v73, v154, v153
    v_mul_f32 v74, v146, v140
    v_mul_f32 v75, v146, v141
    v_mul_f32 v76, v156, v140
    v_mul_f32 v77, v156, v141
    v_mul_f32 v78, v158, v140
    v_mul_f32 v79, v158, v141
    v_fma_f32 v80, -v155, v139, v80
    v_fma_f32 v81, v155, v138, v81
    v_fma_f32 v82, -v155, v141, v82
    v_fma_f32 v83, v155, v140, v83
    v_fma_f32 v72, -v155, v153, v72
    v_fma_f32 v73, v155, v152, v73
    v_fma_f32 v74, -v147, v141, v74
    v_fma_f32 v75, v147, v140, v75
    v_fma_f32 v76, -v157, v141, v76
    v_fma_f32 v77, v157, v140, v77
    v_fma_f32 v78, -v159, v141, v78
    v_fma_f32 v79, v159, v140, v79
    v_cvt_pk_f16_f32 v129, v80, v81
    v_cvt_pk_f16_f32 v130, v82, v83
    v_cvt_pk_f16_f32 v131, v72, v73
    v_cvt_pk_f16_f32 v132, v74, v75
    v_cvt_pk_f16_f32 v133, v76, v77
    v_cvt_pk_f16_f32 v134, v78, v79
    v_mul_f32 v80, v162, v140
    v_mul_f32 v81, v162, v141
    v_fma_f32 v80, -v163, v141, v80
    v_fma_f32 v81, v163, v140, v81
    v_cvt_pk_f16_f32 v135, v80, v81
    s_setprio 3
    s_nop 1
    s_branch ld_kgret
kg_piece1:
    s_cmp_eq_u32 s34, 1
    s_cbranch_scc1 kg_p1_0
    s_cmp_eq_u32 s34, 2
    s_cbranch_scc1 kg_p1_1
    s_cmp_eq_u32 s34, 3
    s_cbranch_scc1 kg_p1_2
    s_cmp_eq_u32 s34, 4
    s_cbranch_scc1 kg_p1_3
    s_cmp_eq_u32 s34, 5
    s_cbranch_scc1 kg_p1_4
    s_branch ld_kgret
kg_p1_0:
    s_setprio 0
    s_mov_b32 s20, 0x3fb8aa3b
    s_mov_b32 s21, 0x32a57060
    s_mov_b32 s22, 0x3f317218
    v_mul_f32 v72, s20, v54
    v_fma_f32 v73, v54, s20, -v72
    v_fma_f32 v73, v54, s21, v73
    v_exp_f32 v72, v72
    v_mul_f32 v73, s22, v73
    v_fma_f32 v72, v72, v73, v72
    v_cvt_pk_bf16_f32 v72, v72, v72
    v_lshlrev_b32 v72, 16, v72
    v_mul_f32 v48, v72, v48
    v_mul_f32 v49, v72, v49
    v_mul_f32 v50, v72, v50
    v_mul_f32 v51, v72, v51
    v_mul_f32 v74, s20, v48
    v_mul_f32 v75, v52, v50
    v_mul_f32 v76, v52, v51
    v_mul_f32 v65, 0x3e22f983, v49
    v_fma_f32 v75, -v53, v51, v75
    v_fma_f32 v76, v53, v50, v76
    v_mov_b32 v68, v74
    v_mov_b32 v70, 0x02081cea
    v_max3_f32 v69, abs(v75), abs(v76), v70
    v_max_f32_dpp v68, v68, v68 row_ror:8 row_mask:0xf bank_mask:0xf
    s_nop 0
    v_max_f32_dpp v69, v69, v69 row_ror:8 row_mask:0xf bank_mask:0xf
    v_max_f32_dpp v68, v68, v68 row_ror:4 row_mask:0xf bank_mask:0xf
    s_nop 0
    v_max_f32_dpp v69, v69, v69 row_ror:4 row_mask:0xf bank_mask:0xf
    v_max_f32_dpp v68, v68, v68 row_ror:2 row_mask:0xf bank_mask:0xf
    s_nop 0
    v_max_f32_dpp v69, v69, v69 row_ror:2 row_mask:0xf bank_mask:0xf
    v_max_f32_dpp v68, v68, v68 row_ror:1 row_mask:0xf bank_mask:0xf
    s_nop 0
    v_max_f32_dpp v69, v69, v69 row_ror:1 row_mask:0xf bank_mask:0xf
    v_mov_b32 v70, v68
    v_mov_b32 v71, v69
    s_nop 0
    v_permlane16_swap_b32 v68, v70
    v_permlane16_swap_b32 v69, v71
    v_max_f32 v68, v68, v70
    v_max_f32 v69, v69, v71
    v_mov_b32 v70, v68
    v_mov_b32 v71, v69
    s_nop 0
    v_permlane32_swap_b32 v68, v70
    v_permlane32_swap_b32 v69, v71
    v_max_f32 v68, v68, v70
    v_max_f32 v69, v69, v71
    v_rcp_f32 v70, v69
    v_sub_f32 v64, v74, v68
    v_mul_f32 v66, v75, v70
    v_mul_f32 v67, v76, v70
    v_rcp_f32 v69, v70
    v_mul_f32 v84, 0x41000000, v64
    v_mul_f32 v136, 0x41000000, v65
    v_mul_f32 v85, 0x41800000, v64
    v_mul_f32 v138, 0x41800000, v65
    v_mul_f32 v86, 0x42000000, v64
    s_setprio 3
    s_nop 1
    s_branch ld_kgret
kg_p1_1:
    s_setprio 0
    v_mul_f32 v140, 0x42000000, v65
    v_mul_f32 v87, 0x42800000, v64
    v_mul_f32 v142, 0x42800000, v65
    v_mul_f32 v88, 0x43000000, v64
    v_mul_f32 v144, 0x43000000, v65
    v_mul_f32 v89, 0x43800000, v64
    v_mul_f32 v146, 0x43800000, v65
    v_mul_f32 v90, 0x44000000, v64
    v_mul_f32 v148, 0x44000000, v65
    v_mul_f32 v91, 0x44800000, v64
    v_mul_f32 v150, 0x44800000, v65
    v_exp_f32 v84, v84
    v_fract_f32 v136, v136
    v_exp_f32 v85, v85
    v_fract_f32 v138, v138
    v_exp_f32 v86, v86
    v_fract_f32 v140, v140
    v_exp_f32 v87, v87
    v_fract_f32 v142, v142
    v_exp_f32 v88, v88
    v_fract_f32 v144, v144
    v_exp_f32 v89, v89
    v_fract_f32 v146, v146
    v_exp_f32 v90, v90
    v_fract_f32 v148, v148
    v_exp_f32 v91, v91
    v_fract_f32 v150, v150
    v_sin_f32 v137, v136
    v_cos_f32 v136, v136
    v_sin_f32 v139, v138
    s_setprio 3
    s_nop 1
    s_branch ld_kgret
kg_p1_2:
    s_setprio 0
    v_cos_f32 v138, v138
    v_sin_f32 v141, v140
    v_cos_f32 v140, v140
    v_sin_f32 v143, v142
    v_cos_f32 v142, v142
    v_sin_f32 v145, v144
    v_cos_f32 v144, v144
    v_sin_f32 v147, v146
    v_cos_f32 v146, v146
    v_sin_f32 v149, v148
    v_cos_f32 v148, v148
    v_sin_f32 v151, v150
    v_cos_f32 v150, v150
    v_mul_f32 v137, v137, v84
    v_mul_f32 v136, v136, v84
    v_mul_f32 v139, v139, v85
    v_mul_f32 v138, v138, v85
    v_mul_f32 v141, v141, v86
    v_mul_f32 v140, v140, v86
    v_mul_f32 v143, v143, v87
    v_mul_f32 v142, v142, v87
    v_mul_f32 v145, v145, v88
    s_setprio 3
    s_nop 1
    s_branch ld_kgret
kg_p1_3:
    s_setprio 0
    v_mul_f32 v144, v144, v88
    v_mul_f32 v147, v147, v89
    v_mul_f32 v146, v146, v89
    v_mul_f32 v149, v149, v90
    v_mul_f32 v148, v148, v90
    v_mul_f32 v151, v151, v91
    v_mul_f32 v150, v150, v91
    v_cvt_pk_f16_f32 v104, v66, -v67
    v_cvt_pk_f16_f32 v105, v150, v151
    v_mul_f32 v72, v66, v136
    v_mul_f32 v73, v66, v137
    v_mul_f32 v152, v66, v138
    v_mul_f32 v153, v66, v139
    v_mul_f32 v154, v66, v140
    v_mul_f32 v155, v66, v141
    v_mul_f32 v156, v66, v142
    v_mul_f32 v157, v66, v143
    v_mul_f32 v74, v150, v144
    v_mul_f32 v75, v150, v145
    v_mul_f32 v158, v150, v146
    v_mul_f32 v159, v150, v147
    v_mul_f32 v160, v150, v148
    v_mul_f32 v161, v150, v149
    v_mul_f32 v76, v150, v150
    v_mul_f32 v77, v150, v151
    v_fma_f32 v72, -v67, v137, v72
    v_fma_f32 v73, v67, v136, v73
    v_fma_f32 v152, -v67, v139, v152
    v_fma_f32 v153, v67, v138, v153
    v_fma_f32 v154, -v67, v141, v154
    v_fma_f32 v155, v67, v140, v155
    v_fma_f32 v156, -v67, v143, v156
    v_fma_f32 v157, v67, v142, v157
    v_fma_f32 v74, -v151, v145, v74
    v_fma_f32 v75, v151, v144, v75
    v_fma_f32 v158, -v151, v147, v158
    v_fma_f32 v159, v151, v146, v159
    v_fma_f32 v160, -v151, v149, v160
    v_fma_f32 v161, v151, v148, v161
    v_fma_f32 v76, -v151, v151, v76
    v_fma_f32 v77, v151, v150, v77
    v_cvt_pk_f16_f32 v106, v72, -v73
    v_cvt_pk_f16_f32 v107, v152, -v153
    v_cvt_pk_f16_f32 v108, v154, -v155
    v_cvt_pk_f16_f32 v109, v156, -v157
    v_cvt_pk_f16_f32 v110, v74, v75
    v_cvt_pk_f16_f32 v111, v158, v159
    v_cvt_pk_f16_f32 v112, v160, v161
    v_cvt_pk_f16_f32 v113, v76, v77
    v_mul_f32 v78, v152, v136
    v_mul_f32 v79, v152, v137
    v_mul_f32 v80, v154, v136
    v_mul_f32 v81, v154, v137
    v_mul_f32 v162, v154, v138
    v_mul_f32 v163, v154, v139
    v_mul_f32 v82, v156, v136
    v_mul_f32 v83, v156, v137
    v_mul_f32 v164, v156, v138
    v_mul_f32 v165, v156, v139
    v_mul_f32 v166, v156, v140
    v_mul_f32 v167, v156, v141
    v_mul_f32 v72, v158, v144
    s_setprio 3
    s_nop 1
    s_branch ld_kgret
kg_p1_4:
    s_setprio 0
    v_mul_f32 v73, v158, v145
    v_mul_f32 v74, v160, v144
    v_mul_f32 v75, v160, v145
    v_mul_f32 v92, v160, v146
    v_mul_f32 v93, v160, v147
    v_fma_f32 v78, -v153, v137, v78
    v_fma_f32 v79, v153, v136, v79
    v_fma_f32 v80, -v155, v137, v80
    v_fma_f32 v81, v155, v136, v81
    v_fma_f32 v162, -v155, v139, v162
    v_fma_f32 v163, v155, v138, v163
    v_fma_f32 v82, -v157, v137, v82
    v_fma_f32 v83, v157, v136, v83
    v_fma_f32 v164, -v157, v139, v164
    v_fma_f32 v165, v157, v138, v165
    v_fma_f32 v166, -v157, v141, v166
    v_fma_f32 v167, v157, v140, v167
    v_fma_f32 v72, -v159, v145, v72
    v_fma_f32 v73, v159, v144, v73
    v_fma_f32 v74, -v161, v145, v74
    v_fma_f32 v75, v161, v144, v75
    v_fma_f32 v92, -v161, v147, v92
    v_fma_f32 v93, v161, v146, v93
    v_cvt_pk_f16_f32 v114, v78, -v79
    v_cvt_pk_f16_f32 v115, v80, -v81
    v_cvt_pk_f16_f32 v116, v162, -v163
    v_cvt_pk_f16_f32 v117, v82, -v83
    v_cvt_pk_f16_f32 v118, v164, -v165
    v_cvt_pk_f16_f32 v119, v166, -v167
    v_cvt_pk_f16_f32 v120, v72, v73
    v_cvt_pk_f16_f32 v121, v74, v75
    v_cvt_pk_f16_f32 v122, v92, v93
    v_mul_f32 v76, v162, v136
    v_mul_f32 v77, v162, v137
    v_mul_f32 v78, v164, v136
    v_mul_f32 v79, v164, v137
    v_mul_f32 v80, v166, v136
    v_mul_f32 v81, v166, v137
    v_mul_f32 v94, v166, v138
    v_mul_f32 v95, v166, v139
    v_mul_f32 v82, v92, v144
    v_mul_f32 v83, v92, v145
    v_fma_f32 v76, -v163, v137, v76
    v_fma_f32 v77, v163, v136, v77
    v_fma_f32 v78, -v165, v137, v78
    v_fma_f32 v79, v165, v136, v79
    v_fma_f32 v80, -v167, v137, v80
    v_fma_f32 v81, v167, v136, v81
    v_fma_f32 v94, -v167, v139, v94
    v_fma_f32 v95, v167, v138, v95
    v_fma_f32 v82, -v93, v145, v82
    v_fma_f32 v83, v93, v144, v83
    v_cvt_pk_f16_f32 v123, v76, -v77
    v_cvt_pk_f16_f32 v124, v78, -v79
    v_cvt_pk_f16_f32 v125, v80, -v81
    v_cvt_pk_f16_f32 v126, v94, -v95
    v_cvt_pk_f16_f32 v127, v82, v83
    v_mul_f32 v72, v94, v136
    v_mul_f32 v73, v94, v137
    v_fma_f32 v72, -v95, v137, v72
    v_fma_f32 v73, v95, v136, v73
    v_cvt_pk_f16_f32 v128, v72, -v73
    s_setprio 3
    s_nop 1
    s_branch ld_kgret
kg_pre:
    s_lshl_b32 s53, s24, 10
    s_lshl_b32 s34, s25, 13
    s_add_u32 s53, s53, s34
    s_add_u32 s53, s53, s51
    s_add_u32 s53, s53, 2097152
    s_lshl_b32 s54, s36, 19
    s_lshl_b32 s34, s28, 16
    s_add_u32 s54, s54, s34
    s_lshl_b32 s34, s37, 2
    s_add_u32 s54, s54, s34
    s_add_u32 s54, s54, 14680064
    s_lshl_b32 s55, s36, 8
    s_lshl_b32 s34, s37, 5
    s_add_u32 s55, s55, s34
    s_lshl_b32 s34, s28, 5
    s_add_u32 s55, s55, s34
    s_add_u32 s55, s55, 11599872
    s_lshr_b32 s20, s28, 2
    s_mul_i32 s35, s20, 49152
    s_and_b32 s37, s28, 1
    v_mul_u32_u24 v36, 1088, v13
    v_bfe_u32 v6, v1, 2, 2
    v_mul_u32_u24 v6, 272, v6
    v_add_u32 v36, v36, v6
    v_and_b32 v6, 3, v1
    v_lshl_add_u32 v36, v6, 2, v36
    s_mul_i32 s33, s37, 4352
    s_add_u32 s33, s33, s35
    v_add_u32 v36, s33, v36
    s_barrier
    ds_write_b128 v10, v[32:35]
    v_mov_b32 v6, 0
    v_and_b32 v7, 7, v1
    v_lshlrev_b32 v7, 2, v7
    v_add_u32 v7, 126976, v7
    ds_write_b32 v7, v6
    s_lshl_b32 s33, s20, 4
    s_add_u32 s33, s33, 126976
    v_mov_b32 v37, s33
    v_mov_b32 v38, 1
    s_add_u32 s21, s35, 34816
    s_mul_i32 s22, s20, 9216
    s_add_u32 s22, s22, 131072
    v_mul_u32_u24 v100, 272, v13
    v_lshl_add_u32 v100, v12, 4, v100
    v_add_u32 v100, s35, v100
    s_mul_i32 s33, s39, 8704
    v_add_u32 v39, s33, v100
    v_mov_b32 v101, s35
    v_lshlrev_b32 v6, 3, v12
    v_add_u32 v60, v60, v6
    v_add_u32 v61, v61, v6
    v_add_u32 v62, v62, v6
    v_add_u32 v63, v63, v6
    v_cvt_f32_u32 v20, v60
    v_cvt_f32_u32 v21, v61
    v_cvt_f32_u32 v22, v62
    v_cvt_f32_u32 v23, v63
    v_lshrrev_b32 v24, 3, v60
    v_lshrrev_b32 v25, 3, v61
    v_lshrrev_b32 v26, 3, v62
    v_lshrrev_b32 v27, 3, v63
    v_add_u32 v60, v60, v24
    v_add_u32 v61, v61, v25
    v_add_u32 v62, v62, v26
    v_add_u32 v63, v63, v27
    v_lshl_add_u32 v60, v60, 2, s21
    v_lshl_add_u32 v61, v61, 2, s21
    v_lshl_add_u32 v62, v62, 2, s21
    v_lshl_add_u32 v63, v63, 2, s21
    v_add_u32_sdwa v84, v56, s21 dst_sel:DWORD dst_unused:UNUSED_PAD src0_sel:WORD_0 src1_sel:DWORD
    v_add_u32_sdwa v85, v56, s21 dst_sel:DWORD dst_unused:UNUSED_PAD src0_sel:WORD_1 src1_sel:DWORD
    v_add_u32_sdwa v86, v57, s21 dst_sel:DWORD dst_unused:UNUSED_PAD src0_sel:WORD_0 src1_sel:DWORD
    v_add_u32_sdwa v87, v57, s21 dst_sel:DWORD dst_unused:UNUSED_PAD src0_sel:WORD_1 src1_sel:DWORD
    v_add_u32_sdwa v88, v58, s21 dst_sel:DWORD dst_unused:UNUSED_PAD src0_sel:WORD_0 src1_sel:DWORD
    v_add_u32_sdwa v89, v58, s21 dst_sel:DWORD dst_unused:UNUSED_PAD src0_sel:WORD_1 src1_sel:DWORD
    v_add_u32_sdwa v90, v59, s21 dst_sel:DWORD dst_unused:UNUSED_PAD src0_sel:WORD_0 src1_sel:DWORD
    v_add_u32_sdwa v91, v59, s21 dst_sel:DWORD dst_unused:UNUSED_PAD src0_sel:WORD_1 src1_sel:DWORD
    v_add_u32_sdwa v92, v55, s21 dst_sel:DWORD dst_unused:UNUSED_PAD src0_sel:WORD_0 src1_sel:DWORD
    s_lshl_b32 s33, s39, 10
    s_add_u32 s33, s33, s22
    v_add_u32 v102, s33, v5
    v_add_u32 v6, 1, v12
    v_lshrrev_b32 v6, 1, v6
    v_lshlrev_b32 v6, 2, v6
    v_lshlrev_b32 v7, 4, v13
    v_sub_u32 v6, v7, v6
    v_and_b32 v7, 1, v12
    v_mul_u32_u24 v7, 4416, v7
    s_lshl_b32 s33, s39, 6
    s_sub_u32 s33, s22, s33
    s_add_u32 s33, s33, 480
    v_add3_u32 v93, v6, v7, s33
    v_add_u32 v94, 1024, v93
    v_add_u32 v95, 2048, v93
    v_add_u32 v96, 3072, v93
    v_lshrrev_b32 v6, 3, v1
    s_lshl_b32 s29, s28, 3
    v_add_u32 v7, s29, v6
    v_and_b32 v2, 0x33, v7
    v_bfe_u32 v8, v7, 2, 1
    v_lshl_add_u32 v2, v8, 3, v2
    v_bfe_u32 v8, v7, 3, 1
    v_lshl_add_u32 v2, v8, 2, v2
    v_lshlrev_b32 v2, 7, v2
    v_bfe_u32 v7, v1, 1, 2
    v_xor_b32 v7, v7, v13
    v_lshl_add_u32 v2, v7, 5, v2
    v_and_b32 v8, 1, v1
    v_lshl_add_u32 v2, v8, 4, v2
    s_lshl_b32 s33, s24, 10
    v_add_u32 v2, s33, v2
    v_and_b32 v7, 3, v1
    v_lshl_add_u32 v7, v7, 1, s29
    v_and_b32 v0, 0x33, v7
    v_bfe_u32 v9, v7, 2, 1
    v_lshl_add_u32 v0, v9, 3, v0
    v_bfe_u32 v9, v7, 3, 1
    v_lshl_add_u32 v0, v9, 2, v0
    v_lshlrev_b32 v0, 7, v0
    v_bfe_u32 v7, v1, 2, 3
    v_lshl_add_u32 v0, v7, 13, v0
    s_add_u32 s33, s33, 252
    v_add_u32 v0, s33, v0
    s_lshl_b32 s29, s28, 5
    v_lshrrev_b32 v7, 1, v1
    v_add_u32 v7, s29, v7
    v_and_b32 v3, 0x33, v7
    v_bfe_u32 v9, v7, 2, 1
    v_lshl_add_u32 v3, v9, 3, v3
    v_bfe_u32 v9, v7, 3, 1
    v_lshl_add_u32 v3, v9, 2, v3
    v_lshlrev_b32 v3, 5, v3
    v_lshl_add_u32 v3, v8, 4, v3
    s_lshl_b32 s29, s24, 8
    s_add_u32 s29, s29, 2080768
    s_cmp_eq_u32 s24, 0
    s_cselect_b32 s29, 0x7f000000, s29
    v_add_u32 v3, s29, v3
    v_and_b32 v7, 31, v1
    v_bfe_u32 v9, v1, 4, 1
    v_mul_u32_u24 v9, 16, v9
    s_cmp_lt_u32 s28, 2
    s_cselect_b32 s33, 1, 0
    v_mad_u32_u24 v7, v9, s33, v7
    s_cselect_b32 s33, 10, 11
    s_lshl_b32 s33, s28, s33
    s_add_u32 s33, s33, s29
    s_add_u32 s33, s33, 60
    s_mov_b32 exec_lo, 0
    v_lshl_add_u32 v0, v7, 6, s33
    s_mov_b32 exec_lo, -1
    s_mov_b32 s63, 0x800
    s_mov_b32 s26, 0x2000
    s_mov_b32 s40, -1
    s_mov_b32 s44, 0
    s_add_u32 s4, s66, 0x00800000
    s_addc_u32 s5, s67, 0
    s_mov_b32 s6, 0x00280000
    s_mov_b32 s7, 0x00020000
    s_max_u32 s29, s28, 3
    s_sub_u32 s29, s29, 3
    v_lshrrev_b32 v10, 5, v1
    v_lshlrev_b32 v10, 4, v10
    v_bfe_u32 v9, v1, 2, 3
    v_add_u32 v10, v10, v9
    v_and_b32 v9, 3, v1
    v_lshlrev_b32 v9, 3, v9
    v_lshl_add_u32 v11, v10, 5, v9
    v_add_u32 v11, 0x2000, v11
    v_lshl_add_u32 v10, v10, 7, v9
    v_bfe_u32 v9, v1, 3, 2
    s_sub_u32 s33, s29, 1
    v_xor_b32 v9, s33, v9
    v_and_b32 v9, 3, v9
    v_lshl_add_u32 v10, v9, 5, v10
    s_cmp_eq_u32 s29, 0
    s_cselect_b64 s[46:47], -1, 0
    v_cndmask_b32 v8, v10, v11, s[46:47]
    s_cselect_b32 s45, 4, 16
    s_lshl_b32 s45, s45, 6
    v_add_u32 v11, s45, v8
    s_lshl_b32 s45, s45, 2
    s_add_u32 s33, s21, 13800
    v_mov_b32 v6, s33
    v_and_b32 v7, 1, v1
    v_lshl_add_u32 v7, v7, 4, s22
    s_lshl_b32 s33, s37, 3
    s_add_u32 s33, s33, s35
    v_mov_b32 v9, s33
    v_mov_b32 v16, 0
    v_mov_b32 v17, 0
    v_mov_b32 v18, 0
    v_mov_b32 v19, 0
    s_waitcnt lgkmcnt(0)
    s_barrier
    s_cmp_lt_u32 s39, 2
    s_cbranch_scc0 kg_put1
    ds_write_b32 v36, v104 offset:0
    ds_write_b32 v36, v105 offset:16
    ds_write_b32 v36, v106 offset:32
    ds_write_b32 v36, v107 offset:64
    ds_write_b32 v36, v108 offset:128
    ds_write_b32 v36, v109 offset:8704
    ds_write_b32 v36, v110 offset:8832
    ds_write_b32 v36, v111 offset:48
    ds_write_b32 v36, v112 offset:80
    ds_write_b32 v36, v113 offset:96
    ds_write_b32 v36, v114 offset:8768
    ds_write_b32 v36, v115 offset:8864
    ds_write_b32 v36, v116 offset:8896
    ds_write_b32 v36, v117 offset:112
    ds_write_b32 v36, v118 offset:8928
    ds_write_b32 v36, v119 offset:144
    ds_write_b32 v36, v120 offset:160
    ds_write_b32 v36, v121 offset:176
    ds_write_b32 v36, v122 offset:192
    ds_write_b32 v36, v123 offset:208
    ds_write_b32 v36, v124 offset:224
    ds_write_b32 v36, v125 offset:240
    ds_write_b32 v36, v126 offset:8720
    ds_write_b32 v36, v127 offset:8736
    ds_write_b32 v36, v128 offset:8752
    ds_write_b32 v36, v129 offset:8784
    ds_write_b32 v36, v130 offset:8800
    ds_write_b32 v36, v131 offset:8816
    ds_write_b32 v36, v132 offset:8848
    ds_write_b32 v36, v133 offset:8880
    ds_write_b32 v36, v134 offset:8912
    ds_write_b32 v36, v135 offset:8944
    s_branch kg_tabdone
kg_put1:
    ds_write_b32 v36, v104 offset:26112
    ds_write_b32 v36, v105 offset:17408
    ds_write_b32 v36, v106 offset:26128
    ds_write_b32 v36, v107 offset:26144
    ds_write_b32 v36, v108 offset:26176
    ds_write_b32 v36, v109 offset:26240
    ds_write_b32 v36, v110 offset:17424
    ds_write_b32 v36, v111 offset:17440
    ds_write_b32 v36, v112 offset:17472
    ds_write_b32 v36, v113 offset:17536
    ds_write_b32 v36, v114 offset:26160
    ds_write_b32 v36, v115 offset:26192
    ds_write_b32 v36, v116 offset:26208
    ds_write_b32 v36, v117 offset:26256
    ds_write_b32 v36, v118 offset:26272
    ds_write_b32 v36, v119 offset:26304
    ds_write_b32 v36, v120 offset:17456
    ds_write_b32 v36, v121 offset:17488
    ds_write_b32 v36, v122 offset:17504
    ds_write_b32 v36, v123 offset:26224
    ds_write_b32 v36, v124 offset:26288
    ds_write_b32 v36, v125 offset:26320
    ds_write_b32 v36, v126 offset:26336
    ds_write_b32 v36, v127 offset:17520
    ds_write_b32 v36, v128 offset:26352
    ds_write_b64 v9, v[68:69] offset:48640
kg_tabdone:
    ds_write_b32 v6, v16
    ds_write_b128 v7, v[16:19] offset:4352
    ds_write_b128 v7, v[16:19] offset:8768
    s_waitcnt lgkmcnt(0)
    s_mov_b64 exec, 1
    ds_add_u32 v37, v38 offset:0
    s_mov_b64 exec, -1
    s_mov_b32 s34, 0
kg_sy0:
    ds_read_b32 v6, v37 offset:0
    s_add_u32 s34, s34, 1
    s_waitcnt lgkmcnt(0)
    v_readfirstlane_b32 s33, v6
    s_cmp_gt_u32 s34, 32768
    s_cbranch_scc1 kg_sd0
    s_cmp_lt_u32 s33, 4
    s_cbranch_scc1 kg_sy0
kg_sd0:
    s_cmp_lt_u32 s39, 3
    s_cbranch_scc0 kg_fin
    ds_read_b128 v[16:19], v101 offset:48640
    ds_read_b128 v[104:107], v39 offset:0
    ds_read_b128 v[108:111], v100 offset:26112
    ds_read_b128 v[112:115], v39 offset:1088
    ds_read_b128 v[116:119], v100 offset:27200
    ds_read_b128 v[120:123], v39 offset:2176
    ds_read_b128 v[124:127], v100 offset:28288
    ds_read_b128 v[128:131], v39 offset:3264
    ds_read_b128 v[132:135], v100 offset:29376
    ds_read_b128 v[136:139], v39 offset:4352
    ds_read_b128 v[140:143], v100 offset:30464
    ds_read_b128 v[144:147], v39 offset:5440
    ds_read_b128 v[148:151], v100 offset:31552
    ds_read_b128 v[152:155], v39 offset:6528
    ds_read_b128 v[156:159], v100 offset:32640
    ds_read_b128 v[160:163], v39 offset:7616
    ds_read_b128 v[164:167], v100 offset:33728
    s_waitcnt lgkmcnt(15)
    v_mul_f32 v24, v20, v16
    v_mul_f32 v20, v20, v18
    v_mul_f32 v25, v21, v16
    v_mul_f32 v21, v21, v18
    v_mul_f32 v26, v22, v16
    v_mul_f32 v22, v22, v18
    v_mul_f32 v27, v23, v16
    v_mul_f32 v23, v23, v18
    s_waitcnt lgkmcnt(14)
    v_mfma_f32_16x16x32_f16 v[28:31], v[104:107], v[108:111], 0
    v_exp_f32 v24, v24
    v_exp_f32 v20, v20
    s_waitcnt lgkmcnt(12)
    v_mfma_f32_16x16x32_f16 v[28:31], v[112:115], v[116:119], v[28:31]
    v_exp_f32 v25, v25
    v_exp_f32 v21, v21
    s_waitcnt lgkmcnt(10)
    v_mfma_f32_16x16x32_f16 v[28:31], v[120:123], v[124:127], v[28:31]
    v_exp_f32 v26, v26
    v_exp_f32 v22, v22
    s_waitcnt lgkmcnt(8)
    v_mfma_f32_16x16x32_f16 v[28:31], v[128:131], v[132:135], v[28:31]
    v_exp_f32 v27, v27
    v_exp_f32 v23, v23
    s_waitcnt lgkmcnt(6)
    v_mfma_f32_16x16x32_f16 v[32:35], v[136:139], v[140:143], 0
    v_mul_f32 v24, v24, v17
    v_mul_f32 v20, v20, v19
    s_waitcnt lgkmcnt(4)
    v_mfma_f32_16x16x32_f16 v[32:35], v[144:147], v[148:151], v[32:35]
    v_mul_f32 v25, v25, v17
    v_mul_f32 v21, v21, v19
    s_waitcnt lgkmcnt(2)
    v_mfma_f32_16x16x32_f16 v[32:35], v[152:155], v[156:159], v[32:35]
    v_mul_f32 v26, v26, v17
    v_mul_f32 v22, v22, v19
    s_waitcnt lgkmcnt(0)
    v_mfma_f32_16x16x32_f16 v[32:35], v[160:163], v[164:167], v[32:35]
    v_mul_f32 v27, v27, v17
    v_mul_f32 v23, v23, v19
    v_mul_f32 v28, v28, v24
    v_mul_f32 v29, v29, v25
    v_mul_f32 v30, v30, v26
    v_mul_f32 v31, v31, v27
    s_nop 1
    v_fma_f32 v28, v32, v20, v28
    v_fma_f32 v29, v33, v21, v29
    v_fma_f32 v30, v34, v22, v30
    v_fma_f32 v31, v35, v23, v31
    ds_write_b32 v60, v28
    ds_write_b32 v61, v29
    ds_write_b32 v62, v30
    ds_write_b32 v63, v31
kg_fin:
    s_waitcnt lgkmcnt(0)
    s_mov_b64 exec, 1
    ds_add_u32 v37, v38 offset:4
    s_mov_b64 exec, -1
    s_mov_b32 s34, 0
kg_sy1:
    ds_read_b32 v6, v37 offset:4
    s_add_u32 s34, s34, 1
    s_waitcnt lgkmcnt(0)
    v_readfirstlane_b32 s33, v6
    s_cmp_gt_u32 s34, 32768
    s_cbranch_scc1 kg_sd1
    s_cmp_lt_u32 s33, 4
    s_cbranch_scc1 kg_sy1
kg_sd1:
    ds_read_b32 v84, v84
    ds_read_b32 v85, v85
    ds_read_b32 v86, v86
    ds_read_b32 v87, v87
    ds_read_b32 v88, v88
    ds_read_b32 v89, v89
    ds_read_b32 v90, v90
    ds_read_b32 v91, v91
    ds_read_b32 v92, v92
    s_waitcnt lgkmcnt(0)
    v_cvt_pk_bf16_f32 v16, v84, v85
    v_cvt_pk_bf16_f32 v20, v85, v86
    v_cvt_pk_bf16_f32 v17, v86, v87
    v_cvt_pk_bf16_f32 v21, v87, v88
    v_cvt_pk_bf16_f32 v18, v88, v89
    v_cvt_pk_bf16_f32 v22, v89, v90
    v_cvt_pk_bf16_f32 v19, v90, v91
    v_cvt_pk_bf16_f32 v23, v91, v92
    ds_write_b128 v102, v[16:19] offset:256
    ds_write_b128 v102, v[20:23] offset:4672
    s_cmp_eq_u32 s39, 3
    s_cbranch_scc0 kg_not0
    s_mov_b32 exec_lo, 0
    s_mov_b32 exec_hi, 0x80000000
    ds_write_b16_d16_hi v102, v23 offset:272
    s_mov_b64 exec, -1
kg_not0:
    s_waitcnt lgkmcnt(0)
    s_mov_b64 exec, 1
    ds_add_u32 v37, v38 offset:8
    s_mov_b64 exec, -1
    s_mov_b32 s34, 0
kg_sy2:
    ds_read_b32 v6, v37 offset:8
    s_add_u32 s34, s34, 1
    s_waitcnt lgkmcnt(0)
    v_readfirstlane_b32 s33, v6
    s_cmp_gt_u32 s34, 32768
    s_cbranch_scc1 kg_sd2
    s_cmp_lt_u32 s33, 4
    s_cbranch_scc1 kg_sy2
kg_sd2:
    ds_read2_b32 v[104:105], v96 offset0:192 offset1:193
    ds_read2_b32 v[106:107], v96 offset0:194 offset1:195
    ds_read2_b32 v[108:109], v96 offset0:128 offset1:129
    ds_read2_b32 v[110:111], v96 offset0:130 offset1:131
    ds_read2_b32 v[112:113], v96 offset0:64 offset1:65
    ds_read2_b32 v[114:115], v96 offset0:66 offset1:67
    ds_read2_b32 v[116:117], v96 offset0:0 offset1:1
    ds_read2_b32 v[118:119], v96 offset0:2 offset1:3
    ds_read2_b32 v[120:121], v95 offset0:192 offset1:193
    ds_read2_b32 v[122:123], v95 offset0:194 offset1:195
    ds_read2_b32 v[124:125], v95 offset0:128 offset1:129
    ds_read2_b32 v[126:127], v95 offset0:130 offset1:131
    ds_read2_b32 v[128:129], v95 offset0:64 offset1:65
    ds_read2_b32 v[130:131], v95 offset0:66 offset1:67
    ds_read2_b32 v[132:133], v95 offset0:0 offset1:1
    ds_read2_b32 v[134:135], v95 offset0:2 offset1:3
    ds_read2_b32 v[136:137], v94 offset0:192 offset1:193
    ds_read2_b32 v[138:139], v94 offset0:194 offset1:195
    ds_read2_b32 v[140:141], v94 offset0:128 offset1:129
    ds_read2_b32 v[142:143], v94 offset0:130 offset1:131
    ds_read2_b32 v[144:145], v94 offset0:64 offset1:65
    ds_read2_b32 v[146:147], v94 offset0:66 offset1:67
    ds_read2_b32 v[148:149], v94 offset0:0 offset1:1
    ds_read2_b32 v[150:151], v94 offset0:2 offset1:3
    ds_read2_b32 v[152:153], v93 offset0:192 offset1:193
    ds_read2_b32 v[154:155], v93 offset0:194 offset1:195
    ds_read2_b32 v[156:157], v93 offset0:128 offset1:129
    ds_read2_b32 v[158:159], v93 offset0:130 offset1:131
    ds_read2_b32 v[160:161], v93 offset0:64 offset1:65
    ds_read2_b32 v[162:163], v93 offset0:66 offset1:67
    ds_read2_b32 v[164:165], v93 offset0:0 offset1:1
    ds_read2_b32 v[166:167], v93 offset0:2 offset1:3
cv_setup:
    s_lshr_b32 s20, s28, 2
    v_lshlrev_b32 v9, 5, v12
    v_lshl_add_u32 v9, v13, 4, v9
    s_mul_i32 s33, s20, 5120
    s_lshl_b32 s34, s39, 6
    s_sub_u32 s34, s33, s34
    s_add_u32 s34, s34, 150240
    v_add_u32 v9, s34, v9
    v_mul_u32_u24 v10, 320, v13
    v_lshl_add_u32 v10, v12, 4, v10
    s_mul_i32 s34, s28, 5120
    s_lshl_b32 s21, s20, 5
    s_add_u32 s34, s34, s21
    s_add_u32 s34, s34, 69632
    v_add_u32 v10, s34, v10
    s_cmp_eq_u32 s39, 0
    s_cbranch_scc0 cv_nozero
    v_mov_b32 v16, 0
    v_mov_b32 v17, 0
    v_mov_b32 v18, 0
    v_mov_b32 v19, 0
    s_add_u32 s33, s33, 149504
    v_add_u32 v6, s33, v5
    ds_write_b128 v6, v[16:19]
cv_nozero:
    s_waitcnt lgkmcnt(0)
    s_barrier
    ds_read_b128 v[40:43], v9 offset:0
    ds_read_b128 v[44:47], v9 offset:256
    ds_read_b128 v[48:51], v9 offset:512
    ds_read_b128 v[52:55], v9 offset:768
    s_cmp_eq_u32 s52, 1
    s_cbranch_scc0 cv_nopre
    s_add_u32 m0, s50, 0
    s_mov_b32 s32, 0
    buffer_load_dwordx4 v4, s[8:11], s32 offen offset:0 lds
    buffer_load_dwordx4 v4, s[8:11], s32 offen offset:1024 lds
    buffer_load_dwordx4 v4, s[8:11], s32 offen offset:2048 lds
    s_add_u32 m0, s50, 34816
    s_mov_b32 s32, 196608
    buffer_load_dwordx4 v4, s[8:11], s32 offen offset:0 lds
    buffer_load_dwordx4 v4, s[8:11], s32 offen offset:1024 lds
    buffer_load_dwordx4 v4, s[8:11], s32 offen offset:2048 lds
cv_nopre:
    s_waitcnt lgkmcnt(3)
    v_mfma_f32_16x16x32_bf16 v[16:19], v[108:111], v[40:43], 0
    v_mfma_f32_16x16x32_bf16 v[20:23], v[116:119], v[40:43], 0
    s_waitcnt lgkmcnt(2)
    v_mfma_f32_16x16x32_bf16 v[16:19], v[104:107], v[44:47], v[16:19]
    v_mfma_f32_16x16x32_bf16 v[20:23], v[112:115], v[44:47], v[20:23]
    s_waitcnt lgkmcnt(1)
    v_mfma_f32_16x16x32_bf16 v[20:23], v[108:111], v[48:51], v[20:23]
    s_waitcnt lgkmcnt(0)
    v_mfma_f32_16x16x32_bf16 v[20:23], v[104:107], v[52:55], v[20:23]
    v_mfma_f32_16x16x32_bf16 v[24:27], v[124:127], v[40:43], 0
    v_mfma_f32_16x16x32_bf16 v[28:31], v[132:135], v[40:43], 0
    s_nop 0
    ds_write_b128 v10, v[16:19] offset:0
    v_mfma_f32_16x16x32_bf16 v[24:27], v[120:123], v[44:47], v[24:27]
    s_nop 2
    ds_write_b128 v10, v[20:23] offset:1280
    v_mfma_f32_16x16x32_bf16 v[28:31], v[128:131], v[44:47], v[28:31]
    s_waitcnt lgkmcnt(0)
    s_barrier
    ds_read_b128 v[56:59], v9 offset:1024
    ds_read_b128 v[60:63], v9 offset:1280
    ds_read_b128 v[64:67], v9 offset:1536
    ds_read_b128 v[68:71], v9 offset:1792
    s_cmp_eq_u32 s52, 1
    s_cbranch_scc0 cv_nopf
    v_mov_b32 v32, -1
    v_mov_b32 v33, -1
    v_mov_b32 v34, -1
    v_mov_b32 v35, -1
    v_lshrrev_b32 v6, 3, v1
    v_lshlrev_b32 v6, 13, v6
    v_and_b32 v7, 7, v1
    v_lshl_add_u32 v6, v7, 4, v6
    buffer_store_dwordx4 v[32:35], v5, s[16:19], s53 offen sc1
    buffer_store_dwordx4 v[32:35], v6, s[16:19], s54 offen sc1
    s_mov_b64 exec, 3
    buffer_store_dwordx4 v[32:35], v5, s[16:19], s55 offen sc1
    s_mov_b64 exec, -1
cv_nopf:
    v_mfma_f32_16x16x32_bf16 v[24:27], v[116:119], v[48:51], v[24:27]
    v_mfma_f32_16x16x32_bf16 v[28:31], v[124:127], v[48:51], v[28:31]
    v_mfma_f32_16x16x32_bf16 v[24:27], v[112:115], v[52:55], v[24:27]
    v_mfma_f32_16x16x32_bf16 v[28:31], v[120:123], v[52:55], v[28:31]
    s_waitcnt lgkmcnt(3)
    v_mfma_f32_16x16x32_bf16 v[24:27], v[108:111], v[56:59], v[24:27]
    v_mfma_f32_16x16x32_bf16 v[28:31], v[116:119], v[56:59], v[28:31]
    s_waitcnt lgkmcnt(2)
    v_mfma_f32_16x16x32_bf16 v[24:27], v[104:107], v[60:63], v[24:27]
    v_mfma_f32_16x16x32_bf16 v[28:31], v[112:115], v[60:63], v[28:31]
    s_waitcnt lgkmcnt(1)
    v_mfma_f32_16x16x32_bf16 v[28:31], v[108:111], v[64:67], v[28:31]
    s_waitcnt lgkmcnt(0)
    v_mfma_f32_16x16x32_bf16 v[28:31], v[104:107], v[68:71], v[28:31]
    v_mfma_f32_16x16x32_bf16 v[16:19], v[140:143], v[40:43], 0
    v_mfma_f32_16x16x32_bf16 v[20:23], v[148:151], v[40:43], 0
    s_nop 0
    ds_write_b128 v10, v[24:27] offset:2560
    v_mfma_f32_16x16x32_bf16 v[16:19], v[136:139], v[44:47], v[16:19]
    s_nop 2
    ds_write_b128 v10, v[28:31] offset:3840
    v_mfma_f32_16x16x32_bf16 v[20:23], v[144:147], v[44:47], v[20:23]
    v_mfma_f32_16x16x32_bf16 v[16:19], v[132:135], v[48:51], v[16:19]
    v_mfma_f32_16x16x32_bf16 v[20:23], v[140:143], v[48:51], v[20:23]
    v_mfma_f32_16x16x32_bf16 v[16:19], v[128:131], v[52:55], v[16:19]
    v_mfma_f32_16x16x32_bf16 v[20:23], v[136:139], v[52:55], v[20:23]
    s_waitcnt lgkmcnt(0)
    s_barrier
    ds_read_b128 v[72:75], v9 offset:2048
    ds_read_b128 v[76:79], v9 offset:2304
    ds_read_b128 v[80:83], v9 offset:2560
    ds_read_b128 v[84:87], v9 offset:2816
    v_mfma_f32_16x16x32_bf16 v[16:19], v[124:127], v[56:59], v[16:19]
    v_mfma_f32_16x16x32_bf16 v[20:23], v[132:135], v[56:59], v[20:23]
    v_mfma_f32_16x16x32_bf16 v[16:19], v[120:123], v[60:63], v[16:19]
    v_mfma_f32_16x16x32_bf16 v[20:23], v[128:131], v[60:63], v[20:23]
    v_mfma_f32_16x16x32_bf16 v[16:19], v[116:119], v[64:67], v[16:19]
    v_mfma_f32_16x16x32_bf16 v[20:23], v[124:127], v[64:67], v[20:23]
    v_mfma_f32_16x16x32_bf16 v[16:19], v[112:115], v[68:71], v[16:19]
    v_mfma_f32_16x16x32_bf16 v[20:23], v[120:123], v[68:71], v[20:23]
    s_waitcnt lgkmcnt(3)
    v_mfma_f32_16x16x32_bf16 v[16:19], v[108:111], v[72:75], v[16:19]
    v_mfma_f32_16x16x32_bf16 v[20:23], v[116:119], v[72:75], v[20:23]
    s_waitcnt lgkmcnt(2)
    v_mfma_f32_16x16x32_bf16 v[16:19], v[104:107], v[76:79], v[16:19]
    v_mfma_f32_16x16x32_bf16 v[20:23], v[112:115], v[76:79], v[20:23]
    s_waitcnt lgkmcnt(1)
    v_mfma_f32_16x16x32_bf16 v[20:23], v[108:111], v[80:83], v[20:23]
    s_waitcnt lgkmcnt(0)
    v_mfma_f32_16x16x32_bf16 v[20:23], v[104:107], v[84:87], v[20:23]
    v_mfma_f32_16x16x32_bf16 v[24:27], v[156:159], v[40:43], 0
    v_mfma_f32_16x16x32_bf16 v[28:31], v[164:167], v[40:43], 0
    s_nop 0
    ds_write_b128 v10, v[16:19] offset:0
    v_mfma_f32_16x16x32_bf16 v[24:27], v[152:155], v[44:47], v[24:27]
    s_nop 2
    ds_write_b128 v10, v[20:23] offset:1280
    v_mfma_f32_16x16x32_bf16 v[28:31], v[160:163], v[44:47], v[28:31]
    v_mfma_f32_16x16x32_bf16 v[24:27], v[148:151], v[48:51], v[24:27]
    v_mfma_f32_16x16x32_bf16 v[28:31], v[156:159], v[48:51], v[28:31]
    v_mfma_f32_16x16x32_bf16 v[24:27], v[144:147], v[52:55], v[24:27]
    v_mfma_f32_16x16x32_bf16 v[28:31], v[152:155], v[52:55], v[28:31]
    v_mfma_f32_16x16x32_bf16 v[24:27], v[140:143], v[56:59], v[24:27]
    v_mfma_f32_16x16x32_bf16 v[28:31], v[148:151], v[56:59], v[28:31]
    v_mfma_f32_16x16x32_bf16 v[24:27], v[136:139], v[60:63], v[24:27]
    v_mfma_f32_16x16x32_bf16 v[28:31], v[144:147], v[60:63], v[28:31]
    s_waitcnt lgkmcnt(0)
    s_barrier
    ds_read_b128 v[88:91], v9 offset:3072
    ds_read_b128 v[92:95], v9 offset:3328
    ds_read_b128 v[96:99], v9 offset:3584
    ds_read_b128 v[100:103], v9 offset:3840
    v_mfma_f32_16x16x32_bf16 v[24:27], v[132:135], v[64:67], v[24:27]
    v_mfma_f32_16x16x32_bf16 v[28:31], v[140:143], v[64:67], v[28:31]
    v_mfma_f32_16x16x32_bf16 v[24:27], v[128:131], v[68:71], v[24:27]
    v_mfma_f32_16x16x32_bf16 v[28:31], v[136:139], v[68:71], v[28:31]
    v_mfma_f32_16x16x32_bf16 v[24:27], v[124:127], v[72:75], v[24:27]
    v_mfma_f32_16x16x32_bf16 v[28:31], v[132:135], v[72:75], v[28:31]
    v_mfma_f32_16x16x32_bf16 v[24:27], v[120:123], v[76:79], v[24:27]
    v_mfma_f32_16x16x32_bf16 v[28:31], v[128:131], v[76:79], v[28:31]
    v_mfma_f32_16x16x32_bf16 v[24:27], v[116:119], v[80:83], v[24:27]
    v_mfma_f32_16x16x32_bf16 v[28:31], v[124:127], v[80:83], v[28:31]
    v_mfma_f32_16x16x32_bf16 v[24:27], v[112:115], v[84:87], v[24:27]
    v_mfma_f32_16x16x32_bf16 v[28:31], v[120:123], v[84:87], v[28:31]
    s_waitcnt lgkmcnt(3)
    v_mfma_f32_16x16x32_bf16 v[24:27], v[108:111], v[88:91], v[24:27]
    v_mfma_f32_16x16x32_bf16 v[28:31], v[116:119], v[88:91], v[28:31]
    s_waitcnt lgkmcnt(2)
    v_mfma_f32_16x16x32_bf16 v[24:27], v[104:107], v[92:95], v[24:27]
    v_mfma_f32_16x16x32_bf16 v[28:31], v[112:115], v[92:95], v[28:31]
    s_waitcnt lgkmcnt(1)
    v_mfma_f32_16x16x32_bf16 v[28:31], v[108:111], v[96:99], v[28:31]
    s_waitcnt lgkmcnt(0)
    v_mfma_f32_16x16x32_bf16 v[28:31], v[104:107], v[100:103], v[28:31]
    s_nop 2
    ds_write_b128 v10, v[24:27] offset:2560
    s_nop 3
    ds_write_b128 v10, v[28:31] offset:3840
    s_waitcnt lgkmcnt(0)
    s_waitcnt vmcnt(0)
    s_barrier
    s_cmp_eq_u32 s52, 2
    s_cbranch_scc0 ld_next
    s_endpgm
ld_next:
    s_setprio 3
    s_mov_b32 s52, 2
    s_mov_b32 s30, 0
    s_mov_b32 s31, 0
    s_mov_b32 s62, 0
    s_mov_b32 s34, 0
    s_cmp_lt_u32 s24, 1024
    s_cbranch_scc1 ld_nox
    s_barrier
ld_nox:
ld_pa:
    buffer_load_dword v32, v0, s[4:7], 0 offen sc1
    s_add_u32 s34, s34, 1
    s_waitcnt vmcnt(0)
    v_cmp_eq_u32 vcc, -1, v32
    s_cmp_gt_u32 s34, 32768
    s_cbranch_scc1 ld_pad
    s_nop 1
    s_and_b64 exec, exec, vcc
    s_cbranch_scc1 ld_pa
ld_pad:
    s_mov_b64 exec, -1
    s_add_u32 m0, s30, s51
    s_mov_b64 exec, s[40:41]
    buffer_load_dwordx4 v2, s[4:7], s31 offen sc1 lds
    s_mov_b64 exec, -1
    s_cmp_lt_u32 s28, 2
    s_cbranch_scc0 ld_x2_0
    s_add_u32 m0, m0, 8192
    s_nop 0
    buffer_load_dwordx4 v3, s[4:7], s62 offen sc1 lds
    s_add_u32 s62, s62, s63
ld_x2_0:
    s_add_u32 s31, s31, s26
    s_add_u32 s30, s30, 34816
    s_add_u32 m0, s30, s51
    s_mov_b64 exec, s[40:41]
    buffer_load_dwordx4 v2, s[4:7], s31 offen sc1 lds
    s_mov_b64 exec, -1
    s_cmp_lt_u32 s28, 2
    s_cbranch_scc0 ld_x2_1
    s_add_u32 m0, m0, 8192
    s_nop 0
    buffer_load_dwordx4 v3, s[4:7], s62 offen sc1 lds
    s_add_u32 s62, s62, s63
ld_x2_1:
    s_add_u32 s31, s31, s26
    s_add_u32 s30, s30, 34816
    s_mov_b32 s32, 393216
    s_lshl_b32 s60, s39, 11
    s_lshl_b32 s33, s38, 10
    s_add_u32 s60, s60, s33
    s_add_u32 s60, s60, 106496
    s_mov_b32 s61, 0
    s_mov_b32 s36, 0
    v_mov_b32 v24, 0x3f803f80
    v_mov_b32 v25, 0x3f803f80
    v_mov_b32 v26, 0x3f803f80
    v_mov_b32 v27, 0x3f803f80
    v_mov_b32 v28, 0x3f803f80
    v_mov_b32 v29, 0x3f803f80
    v_mov_b32 v30, 0x3f803f80
    v_mov_b32 v31, 0x3f803f80
    v_mov_b32 v40, 0
    v_mov_b32 v41, 0
    v_mov_b32 v42, 0
    v_mov_b32 v43, 0
    v_mov_b32 v44, 0
    v_mov_b32 v45, 0
    v_mov_b32 v46, 0
    v_mov_b32 v47, 0
    s_cmp_eq_u32 s28, 0
    s_cbranch_scc0 ld_nozf_9
    v_mov_b32 v6, 0
    v_and_b32 v7, 7, v1
    v_lshlrev_b32 v7, 2, v7
    v_add_u32 v7, 106368, v7
    ds_write_b32 v7, v6
ld_nozf_9:
    s_waitcnt vmcnt(2)
    s_cmp_lt_u32 s28, 2
    s_cbranch_scc1 ld_main
    s_waitcnt vmcnt(1)
    s_branch ld_main
comp_start:
    v_lshrrev_b32 v6, 5, v1
    v_mul_u32_u24 v6, 6144, v6
    v_bfe_u32 v8, v1, 2, 3
    v_lshl_add_u32 v6, v8, 7, v6
    v_bfe_u32 v8, v1, 3, 2
    v_xor_b32 v8, s27, v8
    v_lshl_add_u32 v6, v8, 5, v6
    v_and_b32 v8, 3, v1
    v_lshl_add_u32 v6, v8, 3, v6
    v_add_u32 v6, 10240, v6
    v_add_u32 v7, 69632, v6
    v_and_b32 v2, 1, v12
    v_lshl_add_u32 v3, v13, 2, v2
    v_cmp_eq_u32 s[42:43], 1, v2
    v_cmp_le_u32 s[44:45], v3, v12
    v_add_u32 v3, 2, v3
    v_cmp_le_u32 s[46:47], v3, v12
    s_cmp_eq_u32 s24, 0
    s_cselect_b64 s[48:49], -1, 0
    v_lshrrev_b32 v8, 3, v12
    v_lshlrev_b32 v8, 10, v8
    v_and_b32 v9, 7, v12
    v_lshl_add_u32 v8, v9, 7, v8
    v_lshrrev_b32 v9, 1, v12
    v_xor_b32 v9, v9, v13
    v_lshl_add_u32 v8, v9, 4, v8
    v_xor_b32 v9, 64, v8
    v_add_u32 v10, 69632, v8
    v_add_u32 v11, 69632, v9
    v_mov_b32 v2, 0x0c0c0100
    v_mov_b32 v3, 0x01000c0c
    v_mov_b32 v4, 0x0c0c0c0c
    v_cndmask_b32 v2, v2, v3, s[42:43]
    v_cndmask_b32 v140, v2, v4, s[44:45]
    v_cndmask_b32 v142, v4, v2, s[44:45]
    v_mov_b32 v2, 0x0c0c0302
    v_mov_b32 v3, 0x03020c0c
    v_cndmask_b32 v2, v2, v3, s[42:43]
    v_cndmask_b32 v141, v2, v4, s[46:47]
    v_cndmask_b32 v143, v4, v2, s[46:47]
    v_and_b32 v2, 1, v13
    v_lshl_add_u32 v144, v2, 4, v12
    v_lshlrev_b32 v144, 5, v144
    v_lshrrev_b32 v2, 1, v13
    v_lshl_add_u32 v144, v2, 4, v144
    v_lshlrev_b32 v145, 3, v12
    v_add_u32 v145, 104448, v145
    v_lshlrev_b32 v146, 4, v13
    v_add_u32 v146, 105088, v146
    s_getreg_b32 s33, hwreg(HW_REG_XCC_ID, 0, 3)
    s_lshl_b32 s54, s33, 2
    s_lshr_b32 s55, s24, 3
    v_mov_b32 v156, -1
    v_mov_b32 v157, -1
    v_mov_b32 v158, -1
    v_mov_b32 v159, -1
    v_lshrrev_b32 v2, 3, v0
    v_lshlrev_b32 v2, 13, v2
    v_and_b32 v3, 7, v0
    v_lshl_add_u32 v160, v3, 4, v2
    v_add_u32 v161, 0x40000, v160
    v_lshrrev_b32 v2, 2, v1
    v_lshlrev_b32 v2, 14, v2
    v_and_b32 v3, 3, v1
    v_lshl_add_u32 v162, v3, 4, v2
    s_and_b32 s36, s25, 3
    s_lshr_b32 s37, s25, 2
    s_lshl_b32 s37, s37, 5
    s_add_u32 s37, s37, s24
    s_lshl_b32 s30, s24, 10
    s_lshl_b32 s31, s25, 13
    s_add_u32 s30, s30, s31
    s_lshl_b32 s38, s27, 11
    s_add_u32 s30, s30, s38
    s_lshl_b32 s31, s36, 19
    s_lshl_b32 s32, s37, 2
    s_add_u32 s31, s31, s32
    s_add_u32 s39, s31, 12582912
    s_lshl_b32 s32, s36, 8
    s_lshl_b32 s33, s37, 5
    s_add_u32 s32, s32, s33
    s_add_u32 s32, s32, 11534336
    s_lshl_b32 s36, s77, 8
    s_lshl_b32 s38, s27, 19
    s_add_u32 s36, s36, s38
    s_add_u32 s36, s36, 8388608
    s_lshl_b32 s37, s77, 6
    s_lshl_b32 s38, s27, 17
    s_add_u32 s37, s37, s38
    s_add_u32 s37, s37, 10485760
    s_lshl_b32 s33, s77, 2
    v_lshlrev_b32 v4, 7, v1
    v_lshrrev_b32 v2, 4, v1
    v_lshlrev_b32 v2, 16, v2
    v_and_b32 v3, 15, v1
    v_lshl_add_u32 v164, v3, 4, v2
    v_add_u32 v165, 0x40000, v164
    s_waitcnt lgkmcnt(0)
    s_load_dword s76, s[94:95], s33
    s_mov_b32 s12, s66
    s_mov_b32 s13, s67
    s_mov_b32 s14, 0x01800000
    s_mov_b32 s15, 0x00020000
    s_mov_b32 s8, s64
    s_mov_b32 s9, s65
    s_mov_b32 s10, 0x00000100
    s_mov_b32 s11, 0x00020000
    s_cmp_lt_u32 s27, 3
    s_cbranch_scc0 c_t3
    s_mul_i32 s33, s23, 3
    s_add_u32 s33, s33, s27
    s_lshl_b32 s33, s33, 13
    v_add_u32 v2, s33, v4
    v_add_u32 v3, 0xc0000, v2
    global_load_dword v163, v2, s[70:71]
    global_load_dword v163, v3, s[70:71]
    s_branch c_t4
c_t3:
    s_lshl_b32 s33, s22, 18
    s_lshl_b32 s34, s23, 13
    s_add_u32 s33, s33, s34
    v_add_u32 v2, s33, v4
    global_load_dword v163, v2, s[68:69]
    s_lshl_b32 s33, s23, 14
    v_add_u32 v2, s33, v4
    v_add_u32 v3, 0x2000, v2
    global_load_dword v163, v2, s[72:73]
    global_load_dword v163, v3, s[72:73]
c_t4:
    s_cmp_lt_u32 s2, 16
    s_cbranch_scc0 c_t5
    s_getpc_b64 s[34:35]
c_pc:
    s_sub_u32 s34, s34, c_pc-main_kernel
    s_subb_u32 s35, s35, 0
    v_lshlrev_b32 v2, 7, v0
    v_add_u32 v3, 0, v0
    v_cmp_gt_u32 vcc, (text_end-main_kernel)>>7, v3
    s_and_saveexec_b64 s[40:41], vcc
    s_cbranch_execz c_nc0
    global_load_dword v163, v2, s[34:35]
c_nc0:
    s_mov_b64 exec, s[40:41]
    v_add_u32 v2, 0x8000, v2
    v_add_u32 v3, 256, v0
    v_cmp_gt_u32 vcc, (text_end-main_kernel)>>7, v3
    s_and_saveexec_b64 s[40:41], vcc
    s_cbranch_execz c_nc1
    global_load_dword v163, v2, s[34:35]
c_nc1:
    s_mov_b64 exec, s[40:41]
    v_add_u32 v2, 0x8000, v2
    v_add_u32 v3, 512, v0
    v_cmp_gt_u32 vcc, (text_end-main_kernel)>>7, v3
    s_and_saveexec_b64 s[40:41], vcc
    s_cbranch_execz c_nc2
    global_load_dword v163, v2, s[34:35]
c_nc2:
    s_mov_b64 exec, s[40:41]
    v_add_u32 v2, 0x8000, v2
c_t5:
    buffer_store_dwordx4 v[156:159], v5, s[12:15], s30 offen sc1
    buffer_store_dwordx4 v[156:159], v5, s[12:15], s30 offen offset:1024 sc1
    s_mov_b64 exec, 0xffff
    buffer_store_dwordx4 v[156:159], v5, s[12:15], s32 offen sc1
    s_mov_b64 exec, -1
    buffer_store_dwordx4 v[156:159], v160, s[12:15], s39 offen sc1
    buffer_store_dwordx4 v[156:159], v161, s[12:15], s39 offen sc1
    s_nop 1
c_att_rm:
    s_barrier
    ds_read_b64_tr_b16 v[96:97], v6 offset:0
    ds_read_b64_tr_b16 v[98:99], v6 offset:3072
    ds_read_b64_tr_b16 v[100:101], v6 offset:1024
    ds_read_b64_tr_b16 v[102:103], v6 offset:4096
    ds_read_b64_tr_b16 v[104:105], v6 offset:2048
    ds_read_b64_tr_b16 v[106:107], v6 offset:5120
    ds_read_b128 v[76:79], v8 offset:0
    ds_read_b128 v[80:83], v8 offset:2048
    ds_read_b128 v[84:87], v8 offset:4096
    ds_read_b128 v[88:91], v8 offset:6144
    ds_read_b128 v[92:95], v8 offset:8192
    s_waitcnt lgkmcnt(0)
    v_mfma_f32_16x16x32_bf16 v[16:19], v[96:99], v[76:79], 0
    ds_read_b64_tr_b16 v[128:129], v6 offset:12288
    v_mfma_f32_16x16x32_bf16 v[20:23], v[100:103], v[76:79], 0
    ds_read_b64_tr_b16 v[130:131], v6 offset:15360
    v_mfma_f32_16x16x32_bf16 v[24:27], v[76:79], v[104:107], 0
    ds_read_b64_tr_b16 v[132:133], v6 offset:13312
    v_mfma_f32_16x16x32_bf16 v[28:31], v[96:99], v[80:83], 0
    ds_read_b64_tr_b16 v[134:135], v6 offset:16384
    v_mfma_f32_16x16x32_bf16 v[32:35], v[100:103], v[80:83], 0
    ds_read_b64_tr_b16 v[136:137], v6 offset:14336
    v_mfma_f32_16x16x32_bf16 v[36:39], v[80:83], v[104:107], 0
    ds_read_b64_tr_b16 v[138:139], v6 offset:17408
    v_mfma_f32_16x16x32_bf16 v[40:43], v[96:99], v[84:87], 0
    ds_read_b128 v[108:111], v9 offset:0
    v_mfma_f32_16x16x32_bf16 v[44:47], v[100:103], v[84:87], 0
    ds_read_b128 v[112:115], v9 offset:2048
    v_mfma_f32_16x16x32_bf16 v[48:51], v[84:87], v[104:107], 0
    ds_read_b128 v[116:119], v9 offset:4096
    v_mfma_f32_16x16x32_bf16 v[52:55], v[96:99], v[88:91], 0
    ds_read_b128 v[120:123], v9 offset:6144
    v_mfma_f32_16x16x32_bf16 v[56:59], v[100:103], v[88:91], 0
    ds_read_b128 v[124:127], v9 offset:8192
    v_mfma_f32_16x16x32_bf16 v[60:63], v[88:91], v[104:107], 0
    v_mfma_f32_16x16x32_bf16 v[64:67], v[96:99], v[92:95], 0
    v_mfma_f32_16x16x32_bf16 v[68:71], v[100:103], v[92:95], 0
    v_mfma_f32_16x16x32_bf16 v[72:75], v[92:95], v[104:107], 0
    s_waitcnt lgkmcnt(0)
    s_barrier
    v_mfma_f32_16x16x32_bf16 v[16:19], v[128:131], v[108:111], v[16:19]
    ds_read_b64_tr_b16 v[96:97], v6 offset:34816
    v_mfma_f32_16x16x32_bf16 v[20:23], v[132:135], v[108:111], v[20:23]
    ds_read_b64_tr_b16 v[98:99], v6 offset:37888
    v_mfma_f32_16x16x32_bf16 v[24:27], v[108:111], v[136:139], v[24:27]
    ds_read_b64_tr_b16 v[100:101], v6 offset:35840
    v_mfma_f32_16x16x32_bf16 v[28:31], v[128:131], v[112:115], v[28:31]
    ds_read_b64_tr_b16 v[102:103], v6 offset:38912
    v_mfma_f32_16x16x32_bf16 v[32:35], v[132:135], v[112:115], v[32:35]
    ds_read_b64_tr_b16 v[104:105], v6 offset:36864
    v_mfma_f32_16x16x32_bf16 v[36:39], v[112:115], v[136:139], v[36:39]
    ds_read_b64_tr_b16 v[106:107], v6 offset:39936
    v_mfma_f32_16x16x32_bf16 v[40:43], v[128:131], v[116:119], v[40:43]
    ds_read_b128 v[76:79], v8 offset:34816
    v_mfma_f32_16x16x32_bf16 v[44:47], v[132:135], v[116:119], v[44:47]
    ds_read_b128 v[80:83], v8 offset:36864
    v_mfma_f32_16x16x32_bf16 v[48:51], v[116:119], v[136:139], v[48:51]
    ds_read_b128 v[84:87], v8 offset:38912
    v_mfma_f32_16x16x32_bf16 v[52:55], v[128:131], v[120:123], v[52:55]
    ds_read_b128 v[88:91], v8 offset:40960
    v_mfma_f32_16x16x32_bf16 v[56:59], v[132:135], v[120:123], v[56:59]
    ds_read_b128 v[92:95], v8 offset:43008
    v_mfma_f32_16x16x32_bf16 v[60:63], v[120:123], v[136:139], v[60:63]
    v_mfma_f32_16x16x32_bf16 v[64:67], v[128:131], v[124:127], v[64:67]
    v_mfma_f32_16x16x32_bf16 v[68:71], v[132:135], v[124:127], v[68:71]
    v_mfma_f32_16x16x32_bf16 v[72:75], v[124:127], v[136:139], v[72:75]
    s_waitcnt lgkmcnt(0)
    v_mfma_f32_16x16x32_bf16 v[16:19], v[96:99], v[76:79], v[16:19]
    ds_read_b64_tr_b16 v[128:129], v6 offset:47104
    v_mfma_f32_16x16x32_bf16 v[20:23], v[100:103], v[76:79], v[20:23]
    ds_read_b64_tr_b16 v[130:131], v6 offset:50176
    v_mfma_f32_16x16x32_bf16 v[24:27], v[76:79], v[104:107], v[24:27]
    ds_read_b64_tr_b16 v[132:133], v6 offset:48128
    v_mfma_f32_16x16x32_bf16 v[28:31], v[96:99], v[80:83], v[28:31]
    ds_read_b64_tr_b16 v[134:135], v6 offset:51200
    v_mfma_f32_16x16x32_bf16 v[32:35], v[100:103], v[80:83], v[32:35]
    ds_read_b64_tr_b16 v[136:137], v6 offset:49152
    v_mfma_f32_16x16x32_bf16 v[36:39], v[80:83], v[104:107], v[36:39]
    ds_read_b64_tr_b16 v[138:139], v6 offset:52224
    v_mfma_f32_16x16x32_bf16 v[40:43], v[96:99], v[84:87], v[40:43]
    ds_read_b128 v[108:111], v9 offset:34816
    v_mfma_f32_16x16x32_bf16 v[44:47], v[100:103], v[84:87], v[44:47]
    ds_read_b128 v[112:115], v9 offset:36864
    v_mfma_f32_16x16x32_bf16 v[48:51], v[84:87], v[104:107], v[48:51]
    ds_read_b128 v[116:119], v9 offset:38912
    v_mfma_f32_16x16x32_bf16 v[52:55], v[96:99], v[88:91], v[52:55]
    ds_read_b128 v[120:123], v9 offset:40960
    v_mfma_f32_16x16x32_bf16 v[56:59], v[100:103], v[88:91], v[56:59]
    ds_read_b128 v[124:127], v9 offset:43008
    v_mfma_f32_16x16x32_bf16 v[60:63], v[88:91], v[104:107], v[60:63]
    v_mfma_f32_16x16x32_bf16 v[64:67], v[96:99], v[92:95], v[64:67]
    v_mfma_f32_16x16x32_bf16 v[68:71], v[100:103], v[92:95], v[68:71]
    v_mfma_f32_16x16x32_bf16 v[72:75], v[92:95], v[104:107], v[72:75]
    s_waitcnt lgkmcnt(0)
    s_barrier
    v_mfma_f32_16x16x32_bf16 v[16:19], v[128:131], v[108:111], v[16:19]
    ds_read_b64_tr_b16 v[96:97], v7 offset:0
    v_mfma_f32_16x16x32_bf16 v[20:23], v[132:135], v[108:111], v[20:23]
    ds_read_b64_tr_b16 v[98:99], v7 offset:3072
    v_mfma_f32_16x16x32_bf16 v[24:27], v[108:111], v[136:139], v[24:27]
    ds_read_b64_tr_b16 v[100:101], v7 offset:1024
    v_mfma_f32_16x16x32_bf16 v[28:31], v[128:131], v[112:115], v[28:31]
    ds_read_b64_tr_b16 v[102:103], v7 offset:4096
    v_mfma_f32_16x16x32_bf16 v[32:35], v[132:135], v[112:115], v[32:35]
    ds_read_b64_tr_b16 v[104:105], v7 offset:2048
    v_mfma_f32_16x16x32_bf16 v[36:39], v[112:115], v[136:139], v[36:39]
    ds_read_b64_tr_b16 v[106:107], v7 offset:5120
    v_mfma_f32_16x16x32_bf16 v[40:43], v[128:131], v[116:119], v[40:43]
    ds_read_b128 v[76:79], v10 offset:0
    v_mfma_f32_16x16x32_bf16 v[44:47], v[132:135], v[116:119], v[44:47]
    ds_read_b128 v[80:83], v10 offset:2048
    v_mfma_f32_16x16x32_bf16 v[48:51], v[116:119], v[136:139], v[48:51]
    ds_read_b128 v[84:87], v10 offset:4096
    v_mfma_f32_16x16x32_bf16 v[52:55], v[128:131], v[120:123], v[52:55]
    ds_read_b128 v[88:91], v10 offset:6144
    v_mfma_f32_16x16x32_bf16 v[56:59], v[132:135], v[120:123], v[56:59]
    ds_read_b128 v[92:95], v10 offset:8192
    v_mfma_f32_16x16x32_bf16 v[60:63], v[120:123], v[136:139], v[60:63]
    v_mfma_f32_16x16x32_bf16 v[64:67], v[128:131], v[124:127], v[64:67]
    v_mfma_f32_16x16x32_bf16 v[68:71], v[132:135], v[124:127], v[68:71]
    v_mfma_f32_16x16x32_bf16 v[72:75], v[124:127], v[136:139], v[72:75]
    s_waitcnt lgkmcnt(0)
    v_mfma_f32_16x16x32_bf16 v[16:19], v[96:99], v[76:79], v[16:19]
    ds_read_b64_tr_b16 v[128:129], v7 offset:12288
    v_mfma_f32_16x16x32_bf16 v[20:23], v[100:103], v[76:79], v[20:23]
    ds_read_b64_tr_b16 v[130:131], v7 offset:15360
    v_mfma_f32_16x16x32_bf16 v[24:27], v[76:79], v[104:107], v[24:27]
    ds_read_b64_tr_b16 v[132:133], v7 offset:13312
    v_mfma_f32_16x16x32_bf16 v[28:31], v[96:99], v[80:83], v[28:31]
    ds_read_b64_tr_b16 v[134:135], v7 offset:16384
    v_mfma_f32_16x16x32_bf16 v[32:35], v[100:103], v[80:83], v[32:35]
    ds_read_b64_tr_b16 v[136:137], v7 offset:14336
    v_mfma_f32_16x16x32_bf16 v[36:39], v[80:83], v[104:107], v[36:39]
    ds_read_b64_tr_b16 v[138:139], v7 offset:17408
    v_mfma_f32_16x16x32_bf16 v[40:43], v[96:99], v[84:87], v[40:43]
    ds_read_b128 v[108:111], v11 offset:0
    v_mfma_f32_16x16x32_bf16 v[44:47], v[100:103], v[84:87], v[44:47]
    ds_read_b128 v[112:115], v11 offset:2048
    v_mfma_f32_16x16x32_bf16 v[48:51], v[84:87], v[104:107], v[48:51]
    ds_read_b128 v[116:119], v11 offset:4096
    v_mfma_f32_16x16x32_bf16 v[52:55], v[96:99], v[88:91], v[52:55]
    ds_read_b128 v[120:123], v11 offset:6144
    v_mfma_f32_16x16x32_bf16 v[56:59], v[100:103], v[88:91], v[56:59]
    ds_read_b128 v[124:127], v11 offset:8192
    v_mfma_f32_16x16x32_bf16 v[60:63], v[88:91], v[104:107], v[60:63]
    v_mfma_f32_16x16x32_bf16 v[64:67], v[96:99], v[92:95], v[64:67]
    v_mfma_f32_16x16x32_bf16 v[68:71], v[100:103], v[92:95], v[68:71]
    v_mfma_f32_16x16x32_bf16 v[72:75], v[92:95], v[104:107], v[72:75]
    s_waitcnt lgkmcnt(0)
    s_barrier
    v_mfma_f32_16x16x32_bf16 v[16:19], v[128:131], v[108:111], v[16:19]
    ds_read_b64_tr_b16 v[96:97], v6 offset:0
    v_mfma_f32_16x16x32_bf16 v[20:23], v[132:135], v[108:111], v[20:23]
    ds_read_b64_tr_b16 v[98:99], v6 offset:3072
    v_mfma_f32_16x16x32_bf16 v[24:27], v[108:111], v[136:139], v[24:27]
    ds_read_b64_tr_b16 v[100:101], v6 offset:1024
    v_mfma_f32_16x16x32_bf16 v[28:31], v[128:131], v[112:115], v[28:31]
    ds_read_b64_tr_b16 v[102:103], v6 offset:4096
    v_mfma_f32_16x16x32_bf16 v[32:35], v[132:135], v[112:115], v[32:35]
    ds_read_b64_tr_b16 v[104:105], v6 offset:2048
    v_mfma_f32_16x16x32_bf16 v[36:39], v[112:115], v[136:139], v[36:39]
    ds_read_b64_tr_b16 v[106:107], v6 offset:5120
    v_mfma_f32_16x16x32_bf16 v[40:43], v[128:131], v[116:119], v[40:43]
    ds_read_b128 v[76:79], v8 offset:0
    v_mfma_f32_16x16x32_bf16 v[44:47], v[132:135], v[116:119], v[44:47]
    ds_read_b128 v[80:83], v8 offset:2048
    v_mfma_f32_16x16x32_bf16 v[48:51], v[116:119], v[136:139], v[48:51]
    ds_read_b128 v[84:87], v8 offset:4096
    v_mfma_f32_16x16x32_bf16 v[52:55], v[128:131], v[120:123], v[52:55]
    ds_read_b128 v[88:91], v8 offset:6144
    v_mfma_f32_16x16x32_bf16 v[56:59], v[132:135], v[120:123], v[56:59]
    ds_read_b128 v[92:95], v8 offset:8192
    v_mfma_f32_16x16x32_bf16 v[60:63], v[120:123], v[136:139], v[60:63]
    v_mfma_f32_16x16x32_bf16 v[64:67], v[128:131], v[124:127], v[64:67]
    v_mfma_f32_16x16x32_bf16 v[68:71], v[132:135], v[124:127], v[68:71]
    v_mfma_f32_16x16x32_bf16 v[72:75], v[124:127], v[136:139], v[72:75]
    s_waitcnt lgkmcnt(0)
    v_mfma_f32_16x16x32_bf16 v[16:19], v[96:99], v[76:79], v[16:19]
    ds_read_b64_tr_b16 v[128:129], v6 offset:12288
    v_mfma_f32_16x16x32_bf16 v[20:23], v[100:103], v[76:79], v[20:23]
    ds_read_b64_tr_b16 v[130:131], v6 offset:15360
    v_mfma_f32_16x16x32_bf16 v[24:27], v[76:79], v[104:107], v[24:27]
    ds_read_b64_tr_b16 v[132:133], v6 offset:13312
    v_mfma_f32_16x16x32_bf16 v[28:31], v[96:99], v[80:83], v[28:31]
    ds_read_b64_tr_b16 v[134:135], v6 offset:16384
    v_mfma_f32_16x16x32_bf16 v[32:35], v[100:103], v[80:83], v[32:35]
    ds_read_b64_tr_b16 v[136:137], v6 offset:14336
    v_mfma_f32_16x16x32_bf16 v[36:39], v[80:83], v[104:107], v[36:39]
    ds_read_b64_tr_b16 v[138:139], v6 offset:17408
    v_mfma_f32_16x16x32_bf16 v[40:43], v[96:99], v[84:87], v[40:43]
    ds_read_b128 v[108:111], v9 offset:0
    v_mfma_f32_16x16x32_bf16 v[44:47], v[100:103], v[84:87], v[44:47]
    ds_read_b128 v[112:115], v9 offset:2048
    v_mfma_f32_16x16x32_bf16 v[48:51], v[84:87], v[104:107], v[48:51]
    ds_read_b128 v[116:119], v9 offset:4096
    v_mfma_f32_16x16x32_bf16 v[52:55], v[96:99], v[88:91], v[52:55]
    ds_read_b128 v[120:123], v9 offset:6144
    v_mfma_f32_16x16x32_bf16 v[56:59], v[100:103], v[88:91], v[56:59]
    ds_read_b128 v[124:127], v9 offset:8192
    v_mfma_f32_16x16x32_bf16 v[60:63], v[88:91], v[104:107], v[60:63]
    v_mfma_f32_16x16x32_bf16 v[64:67], v[96:99], v[92:95], v[64:67]
    v_mfma_f32_16x16x32_bf16 v[68:71], v[100:103], v[92:95], v[68:71]
    v_mfma_f32_16x16x32_bf16 v[72:75], v[92:95], v[104:107], v[72:75]
    s_waitcnt lgkmcnt(0)
    s_waitcnt vmcnt(0)
    s_barrier
    s_cmp_eq_u32 s27, 0
    s_cbranch_scc0 c_noarr
    s_lshl_b32 s33, 1, s54
    v_mov_b32 v3, s33
    v_mov_b32 v2, 0
    s_mov_b64 exec, 1
    buffer_atomic_add v3, v2, s[8:11], s55 offen sc1
    s_mov_b64 exec, -1
c_noarr:
    v_mfma_f32_16x16x32_bf16 v[16:19], v[128:131], v[108:111], v[16:19]
    ds_read_b64_tr_b16 v[96:97], v6 offset:34816
    v_mfma_f32_16x16x32_bf16 v[20:23], v[132:135], v[108:111], v[20:23]
    ds_read_b64_tr_b16 v[98:99], v6 offset:37888
    v_mfma_f32_16x16x32_bf16 v[24:27], v[108:111], v[136:139], v[24:27]
    ds_read_b64_tr_b16 v[100:101], v6 offset:35840
    v_mfma_f32_16x16x32_bf16 v[28:31], v[128:131], v[112:115], v[28:31]
    ds_read_b64_tr_b16 v[102:103], v6 offset:38912
    v_mfma_f32_16x16x32_bf16 v[32:35], v[132:135], v[112:115], v[32:35]
    ds_read_b64_tr_b16 v[104:105], v6 offset:36864
    v_mfma_f32_16x16x32_bf16 v[36:39], v[112:115], v[136:139], v[36:39]
    ds_read_b64_tr_b16 v[106:107], v6 offset:39936
    v_mfma_f32_16x16x32_bf16 v[40:43], v[128:131], v[116:119], v[40:43]
    ds_read_b128 v[76:79], v8 offset:34816
    v_mfma_f32_16x16x32_bf16 v[44:47], v[132:135], v[116:119], v[44:47]
    ds_read_b128 v[80:83], v8 offset:36864
    v_mfma_f32_16x16x32_bf16 v[48:51], v[116:119], v[136:139], v[48:51]
    ds_read_b128 v[84:87], v8 offset:38912
    v_mfma_f32_16x16x32_bf16 v[52:55], v[128:131], v[120:123], v[52:55]
    ds_read_b128 v[88:91], v8 offset:40960
    v_mfma_f32_16x16x32_bf16 v[56:59], v[132:135], v[120:123], v[56:59]
    ds_read_b128 v[92:95], v8 offset:43008
    v_mfma_f32_16x16x32_bf16 v[60:63], v[120:123], v[136:139], v[60:63]
    v_mfma_f32_16x16x32_bf16 v[64:67], v[128:131], v[124:127], v[64:67]
    v_mfma_f32_16x16x32_bf16 v[68:71], v[132:135], v[124:127], v[68:71]
    v_mfma_f32_16x16x32_bf16 v[72:75], v[124:127], v[136:139], v[72:75]
    s_waitcnt lgkmcnt(0)
    v_mfma_f32_16x16x32_bf16 v[16:19], v[96:99], v[76:79], v[16:19]
    ds_read_b64_tr_b16 v[128:129], v6 offset:47104
    v_mfma_f32_16x16x32_bf16 v[20:23], v[100:103], v[76:79], v[20:23]
    ds_read_b64_tr_b16 v[130:131], v6 offset:50176
    v_mfma_f32_16x16x32_bf16 v[24:27], v[76:79], v[104:107], v[24:27]
    ds_read_b64_tr_b16 v[132:133], v6 offset:48128
    v_mfma_f32_16x16x32_bf16 v[28:31], v[96:99], v[80:83], v[28:31]
    ds_read_b64_tr_b16 v[134:135], v6 offset:51200
    v_mfma_f32_16x16x32_bf16 v[32:35], v[100:103], v[80:83], v[32:35]
    ds_read_b64_tr_b16 v[136:137], v6 offset:49152
    v_mfma_f32_16x16x32_bf16 v[36:39], v[80:83], v[104:107], v[36:39]
    ds_read_b64_tr_b16 v[138:139], v6 offset:52224
    v_mfma_f32_16x16x32_bf16 v[40:43], v[96:99], v[84:87], v[40:43]
    ds_read_b128 v[108:111], v9 offset:34816
    v_mfma_f32_16x16x32_bf16 v[44:47], v[100:103], v[84:87], v[44:47]
    ds_read_b128 v[112:115], v9 offset:36864
    v_mfma_f32_16x16x32_bf16 v[48:51], v[84:87], v[104:107], v[48:51]
    ds_read_b128 v[116:119], v9 offset:38912
    v_mfma_f32_16x16x32_bf16 v[52:55], v[96:99], v[88:91], v[52:55]
    ds_read_b128 v[120:123], v9 offset:40960
    v_mfma_f32_16x16x32_bf16 v[56:59], v[100:103], v[88:91], v[56:59]
    ds_read_b128 v[124:127], v9 offset:43008
    v_mfma_f32_16x16x32_bf16 v[60:63], v[88:91], v[104:107], v[60:63]
    v_mfma_f32_16x16x32_bf16 v[64:67], v[96:99], v[92:95], v[64:67]
    v_mfma_f32_16x16x32_bf16 v[68:71], v[100:103], v[92:95], v[68:71]
    v_mfma_f32_16x16x32_bf16 v[72:75], v[92:95], v[104:107], v[72:75]
    s_waitcnt lgkmcnt(0)
    buffer_store_dwordx4 v[156:159], v164, s[12:15], s36 offen sc1
    s_barrier
    v_mfma_f32_16x16x32_bf16 v[16:19], v[128:131], v[108:111], v[16:19]
    ds_read_b64_tr_b16 v[96:97], v7 offset:0
    v_mfma_f32_16x16x32_bf16 v[20:23], v[132:135], v[108:111], v[20:23]
    ds_read_b64_tr_b16 v[98:99], v7 offset:3072
    v_mfma_f32_16x16x32_bf16 v[24:27], v[108:111], v[136:139], v[24:27]
    ds_read_b64_tr_b16 v[100:101], v7 offset:1024
    v_mfma_f32_16x16x32_bf16 v[28:31], v[128:131], v[112:115], v[28:31]
    ds_read_b64_tr_b16 v[102:103], v7 offset:4096
    v_mfma_f32_16x16x32_bf16 v[32:35], v[132:135], v[112:115], v[32:35]
    ds_read_b64_tr_b16 v[104:105], v7 offset:2048
    v_mfma_f32_16x16x32_bf16 v[36:39], v[112:115], v[136:139], v[36:39]
    ds_read_b64_tr_b16 v[106:107], v7 offset:5120
    v_mfma_f32_16x16x32_bf16 v[40:43], v[128:131], v[116:119], v[40:43]
    ds_read_b128 v[76:79], v10 offset:0
    v_mfma_f32_16x16x32_bf16 v[44:47], v[132:135], v[116:119], v[44:47]
    ds_read_b128 v[80:83], v10 offset:2048
    v_mfma_f32_16x16x32_bf16 v[48:51], v[116:119], v[136:139], v[48:51]
    ds_read_b128 v[84:87], v10 offset:4096
    v_mfma_f32_16x16x32_bf16 v[52:55], v[128:131], v[120:123], v[52:55]
    ds_read_b128 v[88:91], v10 offset:6144
    v_mfma_f32_16x16x32_bf16 v[56:59], v[132:135], v[120:123], v[56:59]
    ds_read_b128 v[92:95], v10 offset:8192
    v_mfma_f32_16x16x32_bf16 v[60:63], v[120:123], v[136:139], v[60:63]
    v_mfma_f32_16x16x32_bf16 v[64:67], v[128:131], v[124:127], v[64:67]
    v_mfma_f32_16x16x32_bf16 v[68:71], v[132:135], v[124:127], v[68:71]
    v_mfma_f32_16x16x32_bf16 v[72:75], v[124:127], v[136:139], v[72:75]
    s_waitcnt lgkmcnt(0)
    v_mfma_f32_16x16x32_bf16 v[16:19], v[96:99], v[76:79], v[16:19]
    ds_read_b64_tr_b16 v[128:129], v7 offset:12288
    v_mfma_f32_16x16x32_bf16 v[20:23], v[100:103], v[76:79], v[20:23]
    ds_read_b64_tr_b16 v[130:131], v7 offset:15360
    v_mfma_f32_16x16x32_bf16 v[24:27], v[76:79], v[104:107], v[24:27]
    ds_read_b64_tr_b16 v[132:133], v7 offset:13312
    v_mfma_f32_16x16x32_bf16 v[28:31], v[96:99], v[80:83], v[28:31]
    ds_read_b64_tr_b16 v[134:135], v7 offset:16384
    v_mfma_f32_16x16x32_bf16 v[32:35], v[100:103], v[80:83], v[32:35]
    ds_read_b64_tr_b16 v[136:137], v7 offset:14336
    v_mfma_f32_16x16x32_bf16 v[36:39], v[80:83], v[104:107], v[36:39]
    ds_read_b64_tr_b16 v[138:139], v7 offset:17408
    v_mfma_f32_16x16x32_bf16 v[40:43], v[96:99], v[84:87], v[40:43]
    ds_read_b128 v[108:111], v11 offset:0
    v_mfma_f32_16x16x32_bf16 v[44:47], v[100:103], v[84:87], v[44:47]
    ds_read_b128 v[112:115], v11 offset:2048
    v_mfma_f32_16x16x32_bf16 v[48:51], v[84:87], v[104:107], v[48:51]
    ds_read_b128 v[116:119], v11 offset:4096
    v_mfma_f32_16x16x32_bf16 v[52:55], v[96:99], v[88:91], v[52:55]
    ds_read_b128 v[120:123], v11 offset:6144
    v_mfma_f32_16x16x32_bf16 v[56:59], v[100:103], v[88:91], v[56:59]
    ds_read_b128 v[124:127], v11 offset:8192
    v_mfma_f32_16x16x32_bf16 v[60:63], v[88:91], v[104:107], v[60:63]
    v_mfma_f32_16x16x32_bf16 v[64:67], v[96:99], v[92:95], v[64:67]
    v_mfma_f32_16x16x32_bf16 v[68:71], v[100:103], v[92:95], v[68:71]
    v_mfma_f32_16x16x32_bf16 v[72:75], v[92:95], v[104:107], v[72:75]
    s_waitcnt lgkmcnt(0)
    buffer_store_dwordx4 v[156:159], v165, s[12:15], s36 offen sc1
    s_barrier
    v_mfma_f32_16x16x32_bf16 v[16:19], v[128:131], v[108:111], v[16:19]
    ds_read_b64_tr_b16 v[96:97], v6 offset:0
    v_mfma_f32_16x16x32_bf16 v[20:23], v[132:135], v[108:111], v[20:23]
    ds_read_b64_tr_b16 v[98:99], v6 offset:3072
    v_mfma_f32_16x16x32_bf16 v[24:27], v[108:111], v[136:139], v[24:27]
    ds_read_b64_tr_b16 v[100:101], v6 offset:1024
    v_mfma_f32_16x16x32_bf16 v[28:31], v[128:131], v[112:115], v[28:31]
    ds_read_b64_tr_b16 v[102:103], v6 offset:4096
    v_mfma_f32_16x16x32_bf16 v[32:35], v[132:135], v[112:115], v[32:35]
    ds_read_b64_tr_b16 v[104:105], v6 offset:2048
    v_mfma_f32_16x16x32_bf16 v[36:39], v[112:115], v[136:139], v[36:39]
    ds_read_b64_tr_b16 v[106:107], v6 offset:5120
    v_mfma_f32_16x16x32_bf16 v[40:43], v[128:131], v[116:119], v[40:43]
    ds_read_b128 v[76:79], v8 offset:0
    v_mfma_f32_16x16x32_bf16 v[44:47], v[132:135], v[116:119], v[44:47]
    ds_read_b128 v[80:83], v8 offset:2048
    v_mfma_f32_16x16x32_bf16 v[48:51], v[116:119], v[136:139], v[48:51]
    ds_read_b128 v[84:87], v8 offset:4096
    v_mfma_f32_16x16x32_bf16 v[52:55], v[128:131], v[120:123], v[52:55]
    ds_read_b128 v[88:91], v8 offset:6144
    v_mfma_f32_16x16x32_bf16 v[56:59], v[132:135], v[120:123], v[56:59]
    ds_read_b128 v[92:95], v8 offset:8192
    v_mfma_f32_16x16x32_bf16 v[60:63], v[120:123], v[136:139], v[60:63]
    v_mfma_f32_16x16x32_bf16 v[64:67], v[128:131], v[124:127], v[64:67]
    v_mfma_f32_16x16x32_bf16 v[68:71], v[132:135], v[124:127], v[68:71]
    v_mfma_f32_16x16x32_bf16 v[72:75], v[124:127], v[136:139], v[72:75]
    s_waitcnt lgkmcnt(0)
    v_mfma_f32_16x16x32_bf16 v[16:19], v[96:99], v[76:79], v[16:19]
    ds_read_b64_tr_b16 v[128:129], v6 offset:12288
    v_mfma_f32_16x16x32_bf16 v[20:23], v[100:103], v[76:79], v[20:23]
    ds_read_b64_tr_b16 v[130:131], v6 offset:15360
    v_mfma_f32_16x16x32_bf16 v[24:27], v[76:79], v[104:107], v[24:27]
    ds_read_b64_tr_b16 v[132:133], v6 offset:13312
    v_mfma_f32_16x16x32_bf16 v[28:31], v[96:99], v[80:83], v[28:31]
    ds_read_b64_tr_b16 v[134:135], v6 offset:16384
    v_mfma_f32_16x16x32_bf16 v[32:35], v[100:103], v[80:83], v[32:35]
    ds_read_b64_tr_b16 v[136:137], v6 offset:14336
    v_mfma_f32_16x16x32_bf16 v[36:39], v[80:83], v[104:107], v[36:39]
    ds_read_b64_tr_b16 v[138:139], v6 offset:17408
    v_mfma_f32_16x16x32_bf16 v[40:43], v[96:99], v[84:87], v[40:43]
    ds_read_b128 v[108:111], v9 offset:0
    v_mfma_f32_16x16x32_bf16 v[44:47], v[100:103], v[84:87], v[44:47]
    ds_read_b128 v[112:115], v9 offset:2048
    v_mfma_f32_16x16x32_bf16 v[48:51], v[84:87], v[104:107], v[48:51]
    ds_read_b128 v[116:119], v9 offset:4096
    v_mfma_f32_16x16x32_bf16 v[52:55], v[96:99], v[88:91], v[52:55]
    ds_read_b128 v[120:123], v9 offset:6144
    v_mfma_f32_16x16x32_bf16 v[56:59], v[100:103], v[88:91], v[56:59]
    ds_read_b128 v[124:127], v9 offset:8192
    v_mfma_f32_16x16x32_bf16 v[60:63], v[88:91], v[104:107], v[60:63]
    v_mfma_f32_16x16x32_bf16 v[64:67], v[96:99], v[92:95], v[64:67]
    v_mfma_f32_16x16x32_bf16 v[68:71], v[100:103], v[92:95], v[68:71]
    v_mfma_f32_16x16x32_bf16 v[72:75], v[92:95], v[104:107], v[72:75]
    s_waitcnt lgkmcnt(0)
    s_mov_b64 exec, 0xffffffff
    buffer_store_dwordx4 v[156:159], v162, s[12:15], s37 offen sc1
    s_mov_b64 exec, -1
    s_barrier
    v_mfma_f32_16x16x32_bf16 v[16:19], v[128:131], v[108:111], v[16:19]
    ds_read_b64_tr_b16 v[96:97], v6 offset:34816
    v_mfma_f32_16x16x32_bf16 v[20:23], v[132:135], v[108:111], v[20:23]
    ds_read_b64_tr_b16 v[98:99], v6 offset:37888
    v_mfma_f32_16x16x32_bf16 v[24:27], v[108:111], v[136:139], v[24:27]
    ds_read_b64_tr_b16 v[100:101], v6 offset:35840
    v_mfma_f32_16x16x32_bf16 v[28:31], v[128:131], v[112:115], v[28:31]
    ds_read_b64_tr_b16 v[102:103], v6 offset:38912
    v_mfma_f32_16x16x32_bf16 v[32:35], v[132:135], v[112:115], v[32:35]
    ds_read_b64_tr_b16 v[104:105], v6 offset:36864
    v_mfma_f32_16x16x32_bf16 v[36:39], v[112:115], v[136:139], v[36:39]
    ds_read_b64_tr_b16 v[106:107], v6 offset:39936
    v_mfma_f32_16x16x32_bf16 v[40:43], v[128:131], v[116:119], v[40:43]
    ds_read_b128 v[76:79], v8 offset:34816
    v_mfma_f32_16x16x32_bf16 v[44:47], v[132:135], v[116:119], v[44:47]
    ds_read_b128 v[80:83], v8 offset:36864
    v_mfma_f32_16x16x32_bf16 v[48:51], v[116:119], v[136:139], v[48:51]
    ds_read_b128 v[84:87], v8 offset:38912
    v_mfma_f32_16x16x32_bf16 v[52:55], v[128:131], v[120:123], v[52:55]
    ds_read_b128 v[88:91], v8 offset:40960
    v_mfma_f32_16x16x32_bf16 v[56:59], v[132:135], v[120:123], v[56:59]
    ds_read_b128 v[92:95], v8 offset:43008
    v_mfma_f32_16x16x32_bf16 v[60:63], v[120:123], v[136:139], v[60:63]
    v_mfma_f32_16x16x32_bf16 v[64:67], v[128:131], v[124:127], v[64:67]
    v_mfma_f32_16x16x32_bf16 v[68:71], v[132:135], v[124:127], v[68:71]
    v_mfma_f32_16x16x32_bf16 v[72:75], v[124:127], v[136:139], v[72:75]
    s_waitcnt lgkmcnt(0)
    v_mfma_f32_16x16x32_bf16 v[16:19], v[96:99], v[76:79], v[16:19]
    ds_read_b64_tr_b16 v[128:129], v6 offset:47104
    v_mfma_f32_16x16x32_bf16 v[20:23], v[100:103], v[76:79], v[20:23]
    ds_read_b64_tr_b16 v[130:131], v6 offset:50176
    v_mfma_f32_16x16x32_bf16 v[24:27], v[76:79], v[104:107], v[24:27]
    ds_read_b64_tr_b16 v[132:133], v6 offset:48128
    v_mfma_f32_16x16x32_bf16 v[28:31], v[96:99], v[80:83], v[28:31]
    ds_read_b64_tr_b16 v[134:135], v6 offset:51200
    v_mfma_f32_16x16x32_bf16 v[32:35], v[100:103], v[80:83], v[32:35]
    ds_read_b64_tr_b16 v[136:137], v6 offset:49152
    v_mfma_f32_16x16x32_bf16 v[36:39], v[80:83], v[104:107], v[36:39]
    ds_read_b64_tr_b16 v[138:139], v6 offset:52224
    v_mfma_f32_16x16x32_bf16 v[40:43], v[96:99], v[84:87], v[40:43]
    ds_read_b128 v[108:111], v9 offset:34816
    v_mfma_f32_16x16x32_bf16 v[44:47], v[100:103], v[84:87], v[44:47]
    ds_read_b128 v[112:115], v9 offset:36864
    v_mfma_f32_16x16x32_bf16 v[48:51], v[84:87], v[104:107], v[48:51]
    ds_read_b128 v[116:119], v9 offset:38912
    v_mfma_f32_16x16x32_bf16 v[52:55], v[96:99], v[88:91], v[52:55]
    ds_read_b128 v[120:123], v9 offset:40960
    v_mfma_f32_16x16x32_bf16 v[56:59], v[100:103], v[88:91], v[56:59]
    ds_read_b128 v[124:127], v9 offset:43008
    v_mfma_f32_16x16x32_bf16 v[60:63], v[88:91], v[104:107], v[60:63]
    v_mfma_f32_16x16x32_bf16 v[64:67], v[96:99], v[92:95], v[64:67]
    v_mfma_f32_16x16x32_bf16 v[68:71], v[100:103], v[92:95], v[68:71]
    v_mfma_f32_16x16x32_bf16 v[72:75], v[92:95], v[104:107], v[72:75]
    s_waitcnt lgkmcnt(0)
    v_mfma_f32_16x16x32_bf16 v[16:19], v[128:131], v[108:111], v[16:19]
    v_mfma_f32_16x16x32_bf16 v[20:23], v[132:135], v[108:111], v[20:23]
    v_mfma_f32_16x16x32_bf16 v[24:27], v[108:111], v[136:139], v[24:27]
    v_mfma_f32_16x16x32_bf16 v[28:31], v[128:131], v[112:115], v[28:31]
    v_mfma_f32_16x16x32_bf16 v[32:35], v[132:135], v[112:115], v[32:35]
    v_mfma_f32_16x16x32_bf16 v[36:39], v[112:115], v[136:139], v[36:39]
    v_mfma_f32_16x16x32_bf16 v[40:43], v[128:131], v[116:119], v[40:43]
    v_mfma_f32_16x16x32_bf16 v[44:47], v[132:135], v[116:119], v[44:47]
    v_mfma_f32_16x16x32_bf16 v[48:51], v[116:119], v[136:139], v[48:51]
    v_mfma_f32_16x16x32_bf16 v[52:55], v[128:131], v[120:123], v[52:55]
    v_mfma_f32_16x16x32_bf16 v[56:59], v[132:135], v[120:123], v[56:59]
    v_mfma_f32_16x16x32_bf16 v[60:63], v[120:123], v[136:139], v[60:63]
    v_mfma_f32_16x16x32_bf16 v[64:67], v[128:131], v[124:127], v[64:67]
    v_mfma_f32_16x16x32_bf16 v[68:71], v[132:135], v[124:127], v[68:71]
    v_mfma_f32_16x16x32_bf16 v[72:75], v[124:127], v[136:139], v[72:75]
    s_branch c_loopdone
c_att_xt:
    s_barrier
    ds_read_b64_tr_b16 v[76:77], v147 offset:0
    ds_read_b64_tr_b16 v[78:79], v147 offset:256
    ds_read_b64_tr_b16 v[96:97], v6 offset:0
    ds_read_b64_tr_b16 v[98:99], v6 offset:3072
    ds_read_b64_tr_b16 v[100:101], v6 offset:1024
    ds_read_b64_tr_b16 v[102:103], v6 offset:4096
    ds_read_b64_tr_b16 v[104:105], v6 offset:2048
    ds_read_b64_tr_b16 v[106:107], v6 offset:5120
    ds_read_b64_tr_b16 v[80:81], v8 offset:0
    ds_read_b64_tr_b16 v[82:83], v8 offset:1024
    ds_read_b64_tr_b16 v[84:85], v9 offset:0
    ds_read_b64_tr_b16 v[86:87], v9 offset:1024
    ds_read_b64_tr_b16 v[88:89], v10 offset:0
    ds_read_b64_tr_b16 v[90:91], v10 offset:1024
    ds_read_b64_tr_b16 v[92:93], v11 offset:0
    ds_read_b64_tr_b16 v[94:95], v11 offset:1024
    s_waitcnt lgkmcnt(0)
    v_mfma_f32_16x16x32_bf16 v[20:23], v[100:103], v[76:79], 0
    ds_read_b64_tr_b16 v[108:109], v147 offset:1024
    ds_read_b64_tr_b16 v[110:111], v147 offset:1280
    v_mfma_f32_16x16x32_bf16 v[24:27], v[76:79], v[104:107], 0
    ds_read_b64_tr_b16 v[128:129], v6 offset:12288
    ds_read_b64_tr_b16 v[130:131], v6 offset:15360
    v_mfma_f32_16x16x32_bf16 v[28:31], v[96:99], v[80:83], 0
    ds_read_b64_tr_b16 v[132:133], v6 offset:13312
    ds_read_b64_tr_b16 v[134:135], v6 offset:16384
    v_mfma_f32_16x16x32_bf16 v[32:35], v[100:103], v[80:83], 0
    ds_read_b64_tr_b16 v[136:137], v6 offset:14336
    ds_read_b64_tr_b16 v[138:139], v6 offset:17408
    v_mfma_f32_16x16x32_bf16 v[36:39], v[80:83], v[104:107], 0
    ds_read_b64_tr_b16 v[112:113], v8 offset:4096
    v_mfma_f32_16x16x32_bf16 v[40:43], v[96:99], v[84:87], 0
    ds_read_b64_tr_b16 v[114:115], v8 offset:5120
    v_mfma_f32_16x16x32_bf16 v[44:47], v[100:103], v[84:87], 0
    ds_read_b64_tr_b16 v[116:117], v9 offset:4096
    v_mfma_f32_16x16x32_bf16 v[48:51], v[84:87], v[104:107], 0
    ds_read_b64_tr_b16 v[118:119], v9 offset:5120
    v_mfma_f32_16x16x32_bf16 v[52:55], v[96:99], v[88:91], 0
    ds_read_b64_tr_b16 v[120:121], v10 offset:4096
    v_mfma_f32_16x16x32_bf16 v[56:59], v[100:103], v[88:91], 0
    ds_read_b64_tr_b16 v[122:123], v10 offset:5120
    v_mfma_f32_16x16x32_bf16 v[60:63], v[88:91], v[104:107], 0
    ds_read_b64_tr_b16 v[124:125], v11 offset:4096
    v_mfma_f32_16x16x32_bf16 v[64:67], v[96:99], v[92:95], 0
    ds_read_b64_tr_b16 v[126:127], v11 offset:5120
    v_mfma_f32_16x16x32_bf16 v[68:71], v[100:103], v[92:95], 0
    v_mfma_f32_16x16x32_bf16 v[72:75], v[92:95], v[104:107], 0
    s_waitcnt lgkmcnt(0)
    s_barrier
    v_mfma_f32_16x16x32_bf16 v[20:23], v[132:135], v[108:111], v[20:23]
    ds_read_b64_tr_b16 v[76:77], v147 offset:34816
    ds_read_b64_tr_b16 v[78:79], v147 offset:35072
    v_mfma_f32_16x16x32_bf16 v[24:27], v[108:111], v[136:139], v[24:27]
    ds_read_b64_tr_b16 v[96:97], v6 offset:34816
    ds_read_b64_tr_b16 v[98:99], v6 offset:37888
    v_mfma_f32_16x16x32_bf16 v[28:31], v[128:131], v[112:115], v[28:31]
    ds_read_b64_tr_b16 v[100:101], v6 offset:35840
    ds_read_b64_tr_b16 v[102:103], v6 offset:38912
    v_mfma_f32_16x16x32_bf16 v[32:35], v[132:135], v[112:115], v[32:35]
    ds_read_b64_tr_b16 v[104:105], v6 offset:36864
    ds_read_b64_tr_b16 v[106:107], v6 offset:39936
    v_mfma_f32_16x16x32_bf16 v[36:39], v[112:115], v[136:139], v[36:39]
    ds_read_b64_tr_b16 v[80:81], v8 offset:34816
    v_mfma_f32_16x16x32_bf16 v[40:43], v[128:131], v[116:119], v[40:43]
    ds_read_b64_tr_b16 v[82:83], v8 offset:35840
    v_mfma_f32_16x16x32_bf16 v[44:47], v[132:135], v[116:119], v[44:47]
    ds_read_b64_tr_b16 v[84:85], v9 offset:34816
    v_mfma_f32_16x16x32_bf16 v[48:51], v[116:119], v[136:139], v[48:51]
    ds_read_b64_tr_b16 v[86:87], v9 offset:35840
    v_mfma_f32_16x16x32_bf16 v[52:55], v[128:131], v[120:123], v[52:55]
    ds_read_b64_tr_b16 v[88:89], v10 offset:34816
    v_mfma_f32_16x16x32_bf16 v[56:59], v[132:135], v[120:123], v[56:59]
    ds_read_b64_tr_b16 v[90:91], v10 offset:35840
    v_mfma_f32_16x16x32_bf16 v[60:63], v[120:123], v[136:139], v[60:63]
    ds_read_b64_tr_b16 v[92:93], v11 offset:34816
    v_mfma_f32_16x16x32_bf16 v[64:67], v[128:131], v[124:127], v[64:67]
    ds_read_b64_tr_b16 v[94:95], v11 offset:35840
    v_mfma_f32_16x16x32_bf16 v[68:71], v[132:135], v[124:127], v[68:71]
    v_mfma_f32_16x16x32_bf16 v[72:75], v[124:127], v[136:139], v[72:75]
    s_waitcnt lgkmcnt(0)
    v_mfma_f32_16x16x32_bf16 v[20:23], v[100:103], v[76:79], v[20:23]
    ds_read_b64_tr_b16 v[108:109], v147 offset:35840
    ds_read_b64_tr_b16 v[110:111], v147 offset:36096
    v_mfma_f32_16x16x32_bf16 v[24:27], v[76:79], v[104:107], v[24:27]
    ds_read_b64_tr_b16 v[128:129], v6 offset:47104
    ds_read_b64_tr_b16 v[130:131], v6 offset:50176
    v_mfma_f32_16x16x32_bf16 v[28:31], v[96:99], v[80:83], v[28:31]
    ds_read_b64_tr_b16 v[132:133], v6 offset:48128
    ds_read_b64_tr_b16 v[134:135], v6 offset:51200
    v_mfma_f32_16x16x32_bf16 v[32:35], v[100:103], v[80:83], v[32:35]
    ds_read_b64_tr_b16 v[136:137], v6 offset:49152
    ds_read_b64_tr_b16 v[138:139], v6 offset:52224
    v_mfma_f32_16x16x32_bf16 v[36:39], v[80:83], v[104:107], v[36:39]
    ds_read_b64_tr_b16 v[112:113], v8 offset:38912
    v_mfma_f32_16x16x32_bf16 v[40:43], v[96:99], v[84:87], v[40:43]
    ds_read_b64_tr_b16 v[114:115], v8 offset:39936
    v_mfma_f32_16x16x32_bf16 v[44:47], v[100:103], v[84:87], v[44:47]
    ds_read_b64_tr_b16 v[116:117], v9 offset:38912
    v_mfma_f32_16x16x32_bf16 v[48:51], v[84:87], v[104:107], v[48:51]
    ds_read_b64_tr_b16 v[118:119], v9 offset:39936
    v_mfma_f32_16x16x32_bf16 v[52:55], v[96:99], v[88:91], v[52:55]
    ds_read_b64_tr_b16 v[120:121], v10 offset:38912
    v_mfma_f32_16x16x32_bf16 v[56:59], v[100:103], v[88:91], v[56:59]
    ds_read_b64_tr_b16 v[122:123], v10 offset:39936
    v_mfma_f32_16x16x32_bf16 v[60:63], v[88:91], v[104:107], v[60:63]
    ds_read_b64_tr_b16 v[124:125], v11 offset:38912
    v_mfma_f32_16x16x32_bf16 v[64:67], v[96:99], v[92:95], v[64:67]
    ds_read_b64_tr_b16 v[126:127], v11 offset:39936
    v_mfma_f32_16x16x32_bf16 v[68:71], v[100:103], v[92:95], v[68:71]
    v_mfma_f32_16x16x32_bf16 v[72:75], v[92:95], v[104:107], v[72:75]
    s_waitcnt lgkmcnt(0)
    s_barrier
    v_mfma_f32_16x16x32_bf16 v[20:23], v[132:135], v[108:111], v[20:23]
    ds_read_b64_tr_b16 v[76:77], v166 offset:0
    ds_read_b64_tr_b16 v[78:79], v166 offset:256
    v_mfma_f32_16x16x32_bf16 v[24:27], v[108:111], v[136:139], v[24:27]
    ds_read_b64_tr_b16 v[96:97], v7 offset:0
    ds_read_b64_tr_b16 v[98:99], v7 offset:3072
    v_mfma_f32_16x16x32_bf16 v[28:31], v[128:131], v[112:115], v[28:31]
    ds_read_b64_tr_b16 v[100:101], v7 offset:1024
    ds_read_b64_tr_b16 v[102:103], v7 offset:4096
    v_mfma_f32_16x16x32_bf16 v[32:35], v[132:135], v[112:115], v[32:35]
    ds_read_b64_tr_b16 v[104:105], v7 offset:2048
    ds_read_b64_tr_b16 v[106:107], v7 offset:5120
    v_mfma_f32_16x16x32_bf16 v[36:39], v[112:115], v[136:139], v[36:39]
    ds_read_b64_tr_b16 v[80:81], v14 offset:0
    v_mfma_f32_16x16x32_bf16 v[40:43], v[128:131], v[116:119], v[40:43]
    ds_read_b64_tr_b16 v[82:83], v14 offset:1024
    v_mfma_f32_16x16x32_bf16 v[44:47], v[132:135], v[116:119], v[44:47]
    ds_read_b64_tr_b16 v[84:85], v15 offset:0
    v_mfma_f32_16x16x32_bf16 v[48:51], v[116:119], v[136:139], v[48:51]
    ds_read_b64_tr_b16 v[86:87], v15 offset:1024
    v_mfma_f32_16x16x32_bf16 v[52:55], v[128:131], v[120:123], v[52:55]
    ds_read_b64_tr_b16 v[88:89], v148 offset:0
    v_mfma_f32_16x16x32_bf16 v[56:59], v[132:135], v[120:123], v[56:59]
    ds_read_b64_tr_b16 v[90:91], v148 offset:1024
    v_mfma_f32_16x16x32_bf16 v[60:63], v[120:123], v[136:139], v[60:63]
    ds_read_b64_tr_b16 v[92:93], v149 offset:0
    v_mfma_f32_16x16x32_bf16 v[64:67], v[128:131], v[124:127], v[64:67]
    ds_read_b64_tr_b16 v[94:95], v149 offset:1024
    v_mfma_f32_16x16x32_bf16 v[68:71], v[132:135], v[124:127], v[68:71]
    v_mfma_f32_16x16x32_bf16 v[72:75], v[124:127], v[136:139], v[72:75]
    s_waitcnt lgkmcnt(0)
    v_mfma_f32_16x16x32_bf16 v[20:23], v[100:103], v[76:79], v[20:23]
    ds_read_b64_tr_b16 v[108:109], v166 offset:1024
    ds_read_b64_tr_b16 v[110:111], v166 offset:1280
    v_mfma_f32_16x16x32_bf16 v[24:27], v[76:79], v[104:107], v[24:27]
    ds_read_b64_tr_b16 v[128:129], v7 offset:12288
    ds_read_b64_tr_b16 v[130:131], v7 offset:15360
    v_mfma_f32_16x16x32_bf16 v[28:31], v[96:99], v[80:83], v[28:31]
    ds_read_b64_tr_b16 v[132:133], v7 offset:13312
    ds_read_b64_tr_b16 v[134:135], v7 offset:16384
    v_mfma_f32_16x16x32_bf16 v[32:35], v[100:103], v[80:83], v[32:35]
    ds_read_b64_tr_b16 v[136:137], v7 offset:14336
    ds_read_b64_tr_b16 v[138:139], v7 offset:17408
    v_mfma_f32_16x16x32_bf16 v[36:39], v[80:83], v[104:107], v[36:39]
    ds_read_b64_tr_b16 v[112:113], v14 offset:4096
    v_mfma_f32_16x16x32_bf16 v[40:43], v[96:99], v[84:87], v[40:43]
    ds_read_b64_tr_b16 v[114:115], v14 offset:5120
    v_mfma_f32_16x16x32_bf16 v[44:47], v[100:103], v[84:87], v[44:47]
    ds_read_b64_tr_b16 v[116:117], v15 offset:4096
    v_mfma_f32_16x16x32_bf16 v[48:51], v[84:87], v[104:107], v[48:51]
    ds_read_b64_tr_b16 v[118:119], v15 offset:5120
    v_mfma_f32_16x16x32_bf16 v[52:55], v[96:99], v[88:91], v[52:55]
    ds_read_b64_tr_b16 v[120:121], v148 offset:4096
    v_mfma_f32_16x16x32_bf16 v[56:59], v[100:103], v[88:91], v[56:59]
    ds_read_b64_tr_b16 v[122:123], v148 offset:5120
    v_mfma_f32_16x16x32_bf16 v[60:63], v[88:91], v[104:107], v[60:63]
    ds_read_b64_tr_b16 v[124:125], v149 offset:4096
    v_mfma_f32_16x16x32_bf16 v[64:67], v[96:99], v[92:95], v[64:67]
    ds_read_b64_tr_b16 v[126:127], v149 offset:5120
    v_mfma_f32_16x16x32_bf16 v[68:71], v[100:103], v[92:95], v[68:71]
    v_mfma_f32_16x16x32_bf16 v[72:75], v[92:95], v[104:107], v[72:75]
    s_waitcnt lgkmcnt(0)
    s_barrier
    v_mfma_f32_16x16x32_bf16 v[20:23], v[132:135], v[108:111], v[20:23]
    ds_read_b64_tr_b16 v[76:77], v147 offset:0
    ds_read_b64_tr_b16 v[78:79], v147 offset:256
    v_mfma_f32_16x16x32_bf16 v[24:27], v[108:111], v[136:139], v[24:27]
    ds_read_b64_tr_b16 v[96:97], v6 offset:0
    ds_read_b64_tr_b16 v[98:99], v6 offset:3072
    v_mfma_f32_16x16x32_bf16 v[28:31], v[128:131], v[112:115], v[28:31]
    ds_read_b64_tr_b16 v[100:101], v6 offset:1024
    ds_read_b64_tr_b16 v[102:103], v6 offset:4096
    v_mfma_f32_16x16x32_bf16 v[32:35], v[132:135], v[112:115], v[32:35]
    ds_read_b64_tr_b16 v[104:105], v6 offset:2048
    ds_read_b64_tr_b16 v[106:107], v6 offset:5120
    v_mfma_f32_16x16x32_bf16 v[36:39], v[112:115], v[136:139], v[36:39]
    ds_read_b64_tr_b16 v[80:81], v8 offset:0
    v_mfma_f32_16x16x32_bf16 v[40:43], v[128:131], v[116:119], v[40:43]
    ds_read_b64_tr_b16 v[82:83], v8 offset:1024
    v_mfma_f32_16x16x32_bf16 v[44:47], v[132:135], v[116:119], v[44:47]
    ds_read_b64_tr_b16 v[84:85], v9 offset:0
    v_mfma_f32_16x16x32_bf16 v[48:51], v[116:119], v[136:139], v[48:51]
    ds_read_b64_tr_b16 v[86:87], v9 offset:1024
    v_mfma_f32_16x16x32_bf16 v[52:55], v[128:131], v[120:123], v[52:55]
    ds_read_b64_tr_b16 v[88:89], v10 offset:0
    v_mfma_f32_16x16x32_bf16 v[56:59], v[132:135], v[120:123], v[56:59]
    ds_read_b64_tr_b16 v[90:91], v10 offset:1024
    v_mfma_f32_16x16x32_bf16 v[60:63], v[120:123], v[136:139], v[60:63]
    ds_read_b64_tr_b16 v[92:93], v11 offset:0
    v_mfma_f32_16x16x32_bf16 v[64:67], v[128:131], v[124:127], v[64:67]
    ds_read_b64_tr_b16 v[94:95], v11 offset:1024
    v_mfma_f32_16x16x32_bf16 v[68:71], v[132:135], v[124:127], v[68:71]
    v_mfma_f32_16x16x32_bf16 v[72:75], v[124:127], v[136:139], v[72:75]
    s_waitcnt lgkmcnt(0)
    v_mfma_f32_16x16x32_bf16 v[20:23], v[100:103], v[76:79], v[20:23]
    ds_read_b64_tr_b16 v[108:109], v147 offset:1024
    ds_read_b64_tr_b16 v[110:111], v147 offset:1280
    v_mfma_f32_16x16x32_bf16 v[24:27], v[76:79], v[104:107], v[24:27]
    ds_read_b64_tr_b16 v[128:129], v6 offset:12288
    ds_read_b64_tr_b16 v[130:131], v6 offset:15360
    v_mfma_f32_16x16x32_bf16 v[28:31], v[96:99], v[80:83], v[28:31]
    ds_read_b64_tr_b16 v[132:133], v6 offset:13312
    ds_read_b64_tr_b16 v[134:135], v6 offset:16384
    v_mfma_f32_16x16x32_bf16 v[32:35], v[100:103], v[80:83], v[32:35]
    ds_read_b64_tr_b16 v[136:137], v6 offset:14336
    ds_read_b64_tr_b16 v[138:139], v6 offset:17408
    v_mfma_f32_16x16x32_bf16 v[36:39], v[80:83], v[104:107], v[36:39]
    ds_read_b64_tr_b16 v[112:113], v8 offset:4096
    v_mfma_f32_16x16x32_bf16 v[40:43], v[96:99], v[84:87], v[40:43]
    ds_read_b64_tr_b16 v[114:115], v8 offset:5120
    v_mfma_f32_16x16x32_bf16 v[44:47], v[100:103], v[84:87], v[44:47]
    ds_read_b64_tr_b16 v[116:117], v9 offset:4096
    v_mfma_f32_16x16x32_bf16 v[48:51], v[84:87], v[104:107], v[48:51]
    ds_read_b64_tr_b16 v[118:119], v9 offset:5120
    v_mfma_f32_16x16x32_bf16 v[52:55], v[96:99], v[88:91], v[52:55]
    ds_read_b64_tr_b16 v[120:121], v10 offset:4096
    v_mfma_f32_16x16x32_bf16 v[56:59], v[100:103], v[88:91], v[56:59]
    ds_read_b64_tr_b16 v[122:123], v10 offset:5120
    v_mfma_f32_16x16x32_bf16 v[60:63], v[88:91], v[104:107], v[60:63]
    ds_read_b64_tr_b16 v[124:125], v11 offset:4096
    v_mfma_f32_16x16x32_bf16 v[64:67], v[96:99], v[92:95], v[64:67]
    ds_read_b64_tr_b16 v[126:127], v11 offset:5120
    v_mfma_f32_16x16x32_bf16 v[68:71], v[100:103], v[92:95], v[68:71]
    v_mfma_f32_16x16x32_bf16 v[72:75], v[92:95], v[104:107], v[72:75]
    s_waitcnt lgkmcnt(0)
    s_barrier
    v_mfma_f32_16x16x32_bf16 v[20:23], v[132:135], v[108:111], v[20:23]
    ds_read_b64_tr_b16 v[76:77], v147 offset:34816
    ds_read_b64_tr_b16 v[78:79], v147 offset:35072
    v_mfma_f32_16x16x32_bf16 v[24:27], v[108:111], v[136:139], v[24:27]
    ds_read_b64_tr_b16 v[96:97], v6 offset:34816
    ds_read_b64_tr_b16 v[98:99], v6 offset:37888
    v_mfma_f32_16x16x32_bf16 v[28:31], v[128:131], v[112:115], v[28:31]
    ds_read_b64_tr_b16 v[100:101], v6 offset:35840
    ds_read_b64_tr_b16 v[102:103], v6 offset:38912
    v_mfma_f32_16x16x32_bf16 v[32:35], v[132:135], v[112:115], v[32:35]
    ds_read_b64_tr_b16 v[104:105], v6 offset:36864
    ds_read_b64_tr_b16 v[106:107], v6 offset:39936
    v_mfma_f32_16x16x32_bf16 v[36:39], v[112:115], v[136:139], v[36:39]
    ds_read_b64_tr_b16 v[80:81], v8 offset:34816
    v_mfma_f32_16x16x32_bf16 v[40:43], v[128:131], v[116:119], v[40:43]
    ds_read_b64_tr_b16 v[82:83], v8 offset:35840
    v_mfma_f32_16x16x32_bf16 v[44:47], v[132:135], v[116:119], v[44:47]
    ds_read_b64_tr_b16 v[84:85], v9 offset:34816
    v_mfma_f32_16x16x32_bf16 v[48:51], v[116:119], v[136:139], v[48:51]
    ds_read_b64_tr_b16 v[86:87], v9 offset:35840
    v_mfma_f32_16x16x32_bf16 v[52:55], v[128:131], v[120:123], v[52:55]
    ds_read_b64_tr_b16 v[88:89], v10 offset:34816
    v_mfma_f32_16x16x32_bf16 v[56:59], v[132:135], v[120:123], v[56:59]
    ds_read_b64_tr_b16 v[90:91], v10 offset:35840
    v_mfma_f32_16x16x32_bf16 v[60:63], v[120:123], v[136:139], v[60:63]
    ds_read_b64_tr_b16 v[92:93], v11 offset:34816
    v_mfma_f32_16x16x32_bf16 v[64:67], v[128:131], v[124:127], v[64:67]
    ds_read_b64_tr_b16 v[94:95], v11 offset:35840
    v_mfma_f32_16x16x32_bf16 v[68:71], v[132:135], v[124:127], v[68:71]
    v_mfma_f32_16x16x32_bf16 v[72:75], v[124:127], v[136:139], v[72:75]
    s_waitcnt lgkmcnt(0)
    v_mfma_f32_16x16x32_bf16 v[20:23], v[100:103], v[76:79], v[20:23]
    ds_read_b64_tr_b16 v[108:109], v147 offset:35840
    ds_read_b64_tr_b16 v[110:111], v147 offset:36096
    v_mfma_f32_16x16x32_bf16 v[24:27], v[76:79], v[104:107], v[24:27]
    ds_read_b64_tr_b16 v[128:129], v6 offset:47104
    ds_read_b64_tr_b16 v[130:131], v6 offset:50176
    v_mfma_f32_16x16x32_bf16 v[28:31], v[96:99], v[80:83], v[28:31]
    ds_read_b64_tr_b16 v[132:133], v6 offset:48128
    ds_read_b64_tr_b16 v[134:135], v6 offset:51200
    v_mfma_f32_16x16x32_bf16 v[32:35], v[100:103], v[80:83], v[32:35]
    ds_read_b64_tr_b16 v[136:137], v6 offset:49152
    ds_read_b64_tr_b16 v[138:139], v6 offset:52224
    v_mfma_f32_16x16x32_bf16 v[36:39], v[80:83], v[104:107], v[36:39]
    ds_read_b64_tr_b16 v[112:113], v8 offset:38912
    v_mfma_f32_16x16x32_bf16 v[40:43], v[96:99], v[84:87], v[40:43]
    ds_read_b64_tr_b16 v[114:115], v8 offset:39936
    v_mfma_f32_16x16x32_bf16 v[44:47], v[100:103], v[84:87], v[44:47]
    ds_read_b64_tr_b16 v[116:117], v9 offset:38912
    v_mfma_f32_16x16x32_bf16 v[48:51], v[84:87], v[104:107], v[48:51]
    ds_read_b64_tr_b16 v[118:119], v9 offset:39936
    v_mfma_f32_16x16x32_bf16 v[52:55], v[96:99], v[88:91], v[52:55]
    ds_read_b64_tr_b16 v[120:121], v10 offset:38912
    v_mfma_f32_16x16x32_bf16 v[56:59], v[100:103], v[88:91], v[56:59]
    ds_read_b64_tr_b16 v[122:123], v10 offset:39936
    v_mfma_f32_16x16x32_bf16 v[60:63], v[88:91], v[104:107], v[60:63]
    ds_read_b64_tr_b16 v[124:125], v11 offset:38912
    v_mfma_f32_16x16x32_bf16 v[64:67], v[96:99], v[92:95], v[64:67]
    ds_read_b64_tr_b16 v[126:127], v11 offset:39936
    v_mfma_f32_16x16x32_bf16 v[68:71], v[100:103], v[92:95], v[68:71]
    v_mfma_f32_16x16x32_bf16 v[72:75], v[92:95], v[104:107], v[72:75]
    s_waitcnt lgkmcnt(0)
    s_barrier
    v_mfma_f32_16x16x32_bf16 v[20:23], v[132:135], v[108:111], v[20:23]
    ds_read_b64_tr_b16 v[76:77], v166 offset:0
    ds_read_b64_tr_b16 v[78:79], v166 offset:256
    v_mfma_f32_16x16x32_bf16 v[24:27], v[108:111], v[136:139], v[24:27]
    ds_read_b64_tr_b16 v[96:97], v7 offset:0
    ds_read_b64_tr_b16 v[98:99], v7 offset:3072
    v_mfma_f32_16x16x32_bf16 v[28:31], v[128:131], v[112:115], v[28:31]
    ds_read_b64_tr_b16 v[100:101], v7 offset:1024
    ds_read_b64_tr_b16 v[102:103], v7 offset:4096
    v_mfma_f32_16x16x32_bf16 v[32:35], v[132:135], v[112:115], v[32:35]
    ds_read_b64_tr_b16 v[104:105], v7 offset:2048
    ds_read_b64_tr_b16 v[106:107], v7 offset:5120
    v_mfma_f32_16x16x32_bf16 v[36:39], v[112:115], v[136:139], v[36:39]
    ds_read_b64_tr_b16 v[80:81], v14 offset:0
    v_mfma_f32_16x16x32_bf16 v[40:43], v[128:131], v[116:119], v[40:43]
    ds_read_b64_tr_b16 v[82:83], v14 offset:1024
    v_mfma_f32_16x16x32_bf16 v[44:47], v[132:135], v[116:119], v[44:47]
    ds_read_b64_tr_b16 v[84:85], v15 offset:0
    v_mfma_f32_16x16x32_bf16 v[48:51], v[116:119], v[136:139], v[48:51]
    ds_read_b64_tr_b16 v[86:87], v15 offset:1024
    v_mfma_f32_16x16x32_bf16 v[52:55], v[128:131], v[120:123], v[52:55]
    ds_read_b64_tr_b16 v[88:89], v148 offset:0
    v_mfma_f32_16x16x32_bf16 v[56:59], v[132:135], v[120:123], v[56:59]
    ds_read_b64_tr_b16 v[90:91], v148 offset:1024
    v_mfma_f32_16x16x32_bf16 v[60:63], v[120:123], v[136:139], v[60:63]
    ds_read_b64_tr_b16 v[92:93], v149 offset:0
    v_mfma_f32_16x16x32_bf16 v[64:67], v[128:131], v[124:127], v[64:67]
    ds_read_b64_tr_b16 v[94:95], v149 offset:1024
    v_mfma_f32_16x16x32_bf16 v[68:71], v[132:135], v[124:127], v[68:71]
    v_mfma_f32_16x16x32_bf16 v[72:75], v[124:127], v[136:139], v[72:75]
    s_waitcnt lgkmcnt(0)
    v_mfma_f32_16x16x32_bf16 v[20:23], v[100:103], v[76:79], v[20:23]
    ds_read_b64_tr_b16 v[108:109], v166 offset:1024
    ds_read_b64_tr_b16 v[110:111], v166 offset:1280
    v_mfma_f32_16x16x32_bf16 v[24:27], v[76:79], v[104:107], v[24:27]
    ds_read_b64_tr_b16 v[128:129], v7 offset:12288
    ds_read_b64_tr_b16 v[130:131], v7 offset:15360
    v_mfma_f32_16x16x32_bf16 v[28:31], v[96:99], v[80:83], v[28:31]
    ds_read_b64_tr_b16 v[132:133], v7 offset:13312
    ds_read_b64_tr_b16 v[134:135], v7 offset:16384
    v_mfma_f32_16x16x32_bf16 v[32:35], v[100:103], v[80:83], v[32:35]
    ds_read_b64_tr_b16 v[136:137], v7 offset:14336
    ds_read_b64_tr_b16 v[138:139], v7 offset:17408
    v_mfma_f32_16x16x32_bf16 v[36:39], v[80:83], v[104:107], v[36:39]
    ds_read_b64_tr_b16 v[112:113], v14 offset:4096
    v_mfma_f32_16x16x32_bf16 v[40:43], v[96:99], v[84:87], v[40:43]
    ds_read_b64_tr_b16 v[114:115], v14 offset:5120
    v_mfma_f32_16x16x32_bf16 v[44:47], v[100:103], v[84:87], v[44:47]
    ds_read_b64_tr_b16 v[116:117], v15 offset:4096
    v_mfma_f32_16x16x32_bf16 v[48:51], v[84:87], v[104:107], v[48:51]
    ds_read_b64_tr_b16 v[118:119], v15 offset:5120
    v_mfma_f32_16x16x32_bf16 v[52:55], v[96:99], v[88:91], v[52:55]
    ds_read_b64_tr_b16 v[120:121], v148 offset:4096
    v_mfma_f32_16x16x32_bf16 v[56:59], v[100:103], v[88:91], v[56:59]
    ds_read_b64_tr_b16 v[122:123], v148 offset:5120
    v_mfma_f32_16x16x32_bf16 v[60:63], v[88:91], v[104:107], v[60:63]
    ds_read_b64_tr_b16 v[124:125], v149 offset:4096
    v_mfma_f32_16x16x32_bf16 v[64:67], v[96:99], v[92:95], v[64:67]
    ds_read_b64_tr_b16 v[126:127], v149 offset:5120
    v_mfma_f32_16x16x32_bf16 v[68:71], v[100:103], v[92:95], v[68:71]
    v_mfma_f32_16x16x32_bf16 v[72:75], v[92:95], v[104:107], v[72:75]
    s_waitcnt lgkmcnt(0)
    s_barrier
    v_mfma_f32_16x16x32_bf16 v[20:23], v[132:135], v[108:111], v[20:23]
    ds_read_b64_tr_b16 v[76:77], v147 offset:0
    ds_read_b64_tr_b16 v[78:79], v147 offset:256
    v_mfma_f32_16x16x32_bf16 v[24:27], v[108:111], v[136:139], v[24:27]
    ds_read_b64_tr_b16 v[96:97], v6 offset:0
    ds_read_b64_tr_b16 v[98:99], v6 offset:3072
    v_mfma_f32_16x16x32_bf16 v[28:31], v[128:131], v[112:115], v[28:31]
    ds_read_b64_tr_b16 v[100:101], v6 offset:1024
    ds_read_b64_tr_b16 v[102:103], v6 offset:4096
    v_mfma_f32_16x16x32_bf16 v[32:35], v[132:135], v[112:115], v[32:35]
    ds_read_b64_tr_b16 v[104:105], v6 offset:2048
    ds_read_b64_tr_b16 v[106:107], v6 offset:5120
    v_mfma_f32_16x16x32_bf16 v[36:39], v[112:115], v[136:139], v[36:39]
    ds_read_b64_tr_b16 v[80:81], v8 offset:0
    v_mfma_f32_16x16x32_bf16 v[40:43], v[128:131], v[116:119], v[40:43]
    ds_read_b64_tr_b16 v[82:83], v8 offset:1024
    v_mfma_f32_16x16x32_bf16 v[44:47], v[132:135], v[116:119], v[44:47]
    ds_read_b64_tr_b16 v[84:85], v9 offset:0
    v_mfma_f32_16x16x32_bf16 v[48:51], v[116:119], v[136:139], v[48:51]
    ds_read_b64_tr_b16 v[86:87], v9 offset:1024
    v_mfma_f32_16x16x32_bf16 v[52:55], v[128:131], v[120:123], v[52:55]
    ds_read_b64_tr_b16 v[88:89], v10 offset:0
    v_mfma_f32_16x16x32_bf16 v[56:59], v[132:135], v[120:123], v[56:59]
    ds_read_b64_tr_b16 v[90:91], v10 offset:1024
    v_mfma_f32_16x16x32_bf16 v[60:63], v[120:123], v[136:139], v[60:63]
    ds_read_b64_tr_b16 v[92:93], v11 offset:0
    v_mfma_f32_16x16x32_bf16 v[64:67], v[128:131], v[124:127], v[64:67]
    ds_read_b64_tr_b16 v[94:95], v11 offset:1024
    v_mfma_f32_16x16x32_bf16 v[68:71], v[132:135], v[124:127], v[68:71]
    v_mfma_f32_16x16x32_bf16 v[72:75], v[124:127], v[136:139], v[72:75]
    s_waitcnt lgkmcnt(0)
    v_mfma_f32_16x16x32_bf16 v[20:23], v[100:103], v[76:79], v[20:23]
    ds_read_b64_tr_b16 v[108:109], v147 offset:1024
    ds_read_b64_tr_b16 v[110:111], v147 offset:1280
    v_mfma_f32_16x16x32_bf16 v[24:27], v[76:79], v[104:107], v[24:27]
    ds_read_b64_tr_b16 v[128:129], v6 offset:12288
    ds_read_b64_tr_b16 v[130:131], v6 offset:15360
    v_mfma_f32_16x16x32_bf16 v[28:31], v[96:99], v[80:83], v[28:31]
    ds_read_b64_tr_b16 v[132:133], v6 offset:13312
    ds_read_b64_tr_b16 v[134:135], v6 offset:16384
    v_mfma_f32_16x16x32_bf16 v[32:35], v[100:103], v[80:83], v[32:35]
    ds_read_b64_tr_b16 v[136:137], v6 offset:14336
    ds_read_b64_tr_b16 v[138:139], v6 offset:17408
    v_mfma_f32_16x16x32_bf16 v[36:39], v[80:83], v[104:107], v[36:39]
    ds_read_b64_tr_b16 v[112:113], v8 offset:4096
    v_mfma_f32_16x16x32_bf16 v[40:43], v[96:99], v[84:87], v[40:43]
    ds_read_b64_tr_b16 v[114:115], v8 offset:5120
    v_mfma_f32_16x16x32_bf16 v[44:47], v[100:103], v[84:87], v[44:47]
    ds_read_b64_tr_b16 v[116:117], v9 offset:4096
    v_mfma_f32_16x16x32_bf16 v[48:51], v[84:87], v[104:107], v[48:51]
    ds_read_b64_tr_b16 v[118:119], v9 offset:5120
    v_mfma_f32_16x16x32_bf16 v[52:55], v[96:99], v[88:91], v[52:55]
    ds_read_b64_tr_b16 v[120:121], v10 offset:4096
    v_mfma_f32_16x16x32_bf16 v[56:59], v[100:103], v[88:91], v[56:59]
    ds_read_b64_tr_b16 v[122:123], v10 offset:5120
    v_mfma_f32_16x16x32_bf16 v[60:63], v[88:91], v[104:107], v[60:63]
    ds_read_b64_tr_b16 v[124:125], v11 offset:4096
    v_mfma_f32_16x16x32_bf16 v[64:67], v[96:99], v[92:95], v[64:67]
    ds_read_b64_tr_b16 v[126:127], v11 offset:5120
    v_mfma_f32_16x16x32_bf16 v[68:71], v[100:103], v[92:95], v[68:71]
    v_mfma_f32_16x16x32_bf16 v[72:75], v[92:95], v[104:107], v[72:75]
    s_waitcnt lgkmcnt(0)
    s_barrier
    v_mfma_f32_16x16x32_bf16 v[20:23], v[132:135], v[108:111], v[20:23]
    ds_read_b64_tr_b16 v[76:77], v147 offset:34816
    ds_read_b64_tr_b16 v[78:79], v147 offset:35072
    v_mfma_f32_16x16x32_bf16 v[24:27], v[108:111], v[136:139], v[24:27]
    ds_read_b64_tr_b16 v[96:97], v6 offset:34816
    ds_read_b64_tr_b16 v[98:99], v6 offset:37888
    v_mfma_f32_16x16x32_bf16 v[28:31], v[128:131], v[112:115], v[28:31]
    ds_read_b64_tr_b16 v[100:101], v6 offset:35840
    ds_read_b64_tr_b16 v[102:103], v6 offset:38912
    v_mfma_f32_16x16x32_bf16 v[32:35], v[132:135], v[112:115], v[32:35]
    ds_read_b64_tr_b16 v[104:105], v6 offset:36864
    ds_read_b64_tr_b16 v[106:107], v6 offset:39936
    v_mfma_f32_16x16x32_bf16 v[36:39], v[112:115], v[136:139], v[36:39]
    ds_read_b64_tr_b16 v[80:81], v8 offset:34816
    v_mfma_f32_16x16x32_bf16 v[40:43], v[128:131], v[116:119], v[40:43]
    ds_read_b64_tr_b16 v[82:83], v8 offset:35840
    v_mfma_f32_16x16x32_bf16 v[44:47], v[132:135], v[116:119], v[44:47]
    ds_read_b64_tr_b16 v[84:85], v9 offset:34816
    v_mfma_f32_16x16x32_bf16 v[48:51], v[116:119], v[136:139], v[48:51]
    ds_read_b64_tr_b16 v[86:87], v9 offset:35840
    v_mfma_f32_16x16x32_bf16 v[52:55], v[128:131], v[120:123], v[52:55]
    ds_read_b64_tr_b16 v[88:89], v10 offset:34816
    v_mfma_f32_16x16x32_bf16 v[56:59], v[132:135], v[120:123], v[56:59]
    ds_read_b64_tr_b16 v[90:91], v10 offset:35840
    v_mfma_f32_16x16x32_bf16 v[60:63], v[120:123], v[136:139], v[60:63]
    ds_read_b64_tr_b16 v[92:93], v11 offset:34816
    v_mfma_f32_16x16x32_bf16 v[64:67], v[128:131], v[124:127], v[64:67]
    ds_read_b64_tr_b16 v[94:95], v11 offset:35840
    v_mfma_f32_16x16x32_bf16 v[68:71], v[132:135], v[124:127], v[68:71]
    v_mfma_f32_16x16x32_bf16 v[72:75], v[124:127], v[136:139], v[72:75]
    s_waitcnt lgkmcnt(0)
    v_mfma_f32_16x16x32_bf16 v[20:23], v[100:103], v[76:79], v[20:23]
    ds_read_b64_tr_b16 v[108:109], v147 offset:35840
    ds_read_b64_tr_b16 v[110:111], v147 offset:36096
    v_mfma_f32_16x16x32_bf16 v[24:27], v[76:79], v[104:107], v[24:27]
    ds_read_b64_tr_b16 v[128:129], v6 offset:47104
    ds_read_b64_tr_b16 v[130:131], v6 offset:50176
    v_mfma_f32_16x16x32_bf16 v[28:31], v[96:99], v[80:83], v[28:31]
    ds_read_b64_tr_b16 v[132:133], v6 offset:48128
    ds_read_b64_tr_b16 v[134:135], v6 offset:51200
    v_mfma_f32_16x16x32_bf16 v[32:35], v[100:103], v[80:83], v[32:35]
    ds_read_b64_tr_b16 v[136:137], v6 offset:49152
    ds_read_b64_tr_b16 v[138:139], v6 offset:52224
    v_mfma_f32_16x16x32_bf16 v[36:39], v[80:83], v[104:107], v[36:39]
    ds_read_b64_tr_b16 v[112:113], v8 offset:38912
    v_mfma_f32_16x16x32_bf16 v[40:43], v[96:99], v[84:87], v[40:43]
    ds_read_b64_tr_b16 v[114:115], v8 offset:39936
    v_mfma_f32_16x16x32_bf16 v[44:47], v[100:103], v[84:87], v[44:47]
    ds_read_b64_tr_b16 v[116:117], v9 offset:38912
    v_mfma_f32_16x16x32_bf16 v[48:51], v[84:87], v[104:107], v[48:51]
    ds_read_b64_tr_b16 v[118:119], v9 offset:39936
    v_mfma_f32_16x16x32_bf16 v[52:55], v[96:99], v[88:91], v[52:55]
    ds_read_b64_tr_b16 v[120:121], v10 offset:38912
    v_mfma_f32_16x16x32_bf16 v[56:59], v[100:103], v[88:91], v[56:59]
    ds_read_b64_tr_b16 v[122:123], v10 offset:39936
    v_mfma_f32_16x16x32_bf16 v[60:63], v[88:91], v[104:107], v[60:63]
    ds_read_b64_tr_b16 v[124:125], v11 offset:38912
    v_mfma_f32_16x16x32_bf16 v[64:67], v[96:99], v[92:95], v[64:67]
    ds_read_b64_tr_b16 v[126:127], v11 offset:39936
    v_mfma_f32_16x16x32_bf16 v[68:71], v[100:103], v[92:95], v[68:71]
    v_mfma_f32_16x16x32_bf16 v[72:75], v[92:95], v[104:107], v[72:75]
    s_waitcnt lgkmcnt(0)
    v_mfma_f32_16x16x32_bf16 v[20:23], v[132:135], v[108:111], v[20:23]
    v_mfma_f32_16x16x32_bf16 v[24:27], v[108:111], v[136:139], v[24:27]
    v_mfma_f32_16x16x32_bf16 v[28:31], v[128:131], v[112:115], v[28:31]
    v_mfma_f32_16x16x32_bf16 v[32:35], v[132:135], v[112:115], v[32:35]
    v_mfma_f32_16x16x32_bf16 v[36:39], v[112:115], v[136:139], v[36:39]
    v_mfma_f32_16x16x32_bf16 v[40:43], v[128:131], v[116:119], v[40:43]
    v_mfma_f32_16x16x32_bf16 v[44:47], v[132:135], v[116:119], v[44:47]
    v_mfma_f32_16x16x32_bf16 v[48:51], v[116:119], v[136:139], v[48:51]
    v_mfma_f32_16x16x32_bf16 v[52:55], v[128:131], v[120:123], v[52:55]
    v_mfma_f32_16x16x32_bf16 v[56:59], v[132:135], v[120:123], v[56:59]
    v_mfma_f32_16x16x32_bf16 v[60:63], v[120:123], v[136:139], v[60:63]
    v_mfma_f32_16x16x32_bf16 v[64:67], v[128:131], v[124:127], v[64:67]
    v_mfma_f32_16x16x32_bf16 v[68:71], v[132:135], v[124:127], v[68:71]
    v_mfma_f32_16x16x32_bf16 v[72:75], v[124:127], v[136:139], v[72:75]
c_loopdone:
    s_lshl_b32 s33, s78, 2
    s_add_u32 s33, s33, 106368
    v_mov_b32 v3, s33
    s_barrier
    s_setprio 2
    ds_read_b32 v3, v3
    ds_read_b64 v[76:77], v145 offset:0
    ds_read_b64 v[78:79], v145 offset:128
    ds_read_b64 v[80:81], v145 offset:256
    ds_read_b64 v[82:83], v145 offset:384
    ds_read_b64 v[84:85], v145 offset:512
    ds_read_b128 v[88:91], v146 offset:0
    ds_read_b128 v[92:95], v146 offset:320
    ds_read_b128 v[96:99], v146 offset:64
    ds_read_b128 v[100:103], v146 offset:384
    ds_read_b128 v[104:107], v146 offset:128
    ds_read_b128 v[108:111], v146 offset:448
    ds_read_b128 v[112:115], v146 offset:192
    ds_read_b128 v[116:119], v146 offset:512
    ds_read_b128 v[120:123], v146 offset:256
    ds_read_b128 v[124:127], v146 offset:576
    s_cmp_eq_u32 s52, 2
    s_cbranch_scc1 c_cs2
    v_mov_b32_dpp v128, v16 row_newbcast:0 row_mask:0xf bank_mask:0xf
    v_mov_b32_dpp v129, v17 row_newbcast:0 row_mask:0xf bank_mask:0xf
    v_mov_b32_dpp v130, v18 row_newbcast:0 row_mask:0xf bank_mask:0xf
    v_mov_b32_dpp v131, v19 row_newbcast:0 row_mask:0xf bank_mask:0xf
    v_mov_b32_dpp v132, v20 row_newbcast:0 row_mask:0xf bank_mask:0xf
    v_mov_b32_dpp v133, v21 row_newbcast:0 row_mask:0xf bank_mask:0xf
    v_mov_b32_dpp v134, v22 row_newbcast:0 row_mask:0xf bank_mask:0xf
    v_mov_b32_dpp v135, v23 row_newbcast:0 row_mask:0xf bank_mask:0xf
    v_mov_b32 v136, v24
    v_mov_b32 v137, v24
    s_nop 1
    v_permlane16_swap_b32 v136, v137
    v_mov_b32 v137, v136
    s_nop 1
    v_permlane32_swap_b32 v136, v137
    s_branch c_cs3
c_cs2:
    s_waitcnt lgkmcnt(15)
    v_readfirstlane_b32 s33, v3
    v_mov_b32 v128, v156
    v_mov_b32 v129, v157
    v_mov_b32 v130, v158
    v_mov_b32 v131, v159
    v_mov_b32 v132, v160
    v_mov_b32 v133, v161
    v_mov_b32 v134, v162
    v_mov_b32 v135, v163
    v_mov_b32 v136, v164
    s_cmp_eq_u32 s33, 0
    s_cbranch_scc1 c_cs3
    s_add_u32 s78, s78, 1
    s_cmp_lt_u32 s78, 8
    s_waitcnt lgkmcnt(0)
    s_setprio 0
    s_cbranch_scc1 c_att_xt
    s_mov_b32 s78, 7
    s_nop 0
c_cs3:
    s_waitcnt lgkmcnt(10)
    v_pk_fma_f32 v[20:21], v[132:133], v[76:77], v[20:21] op_sel_hi:[1,0,1] neg_lo:[0,1,0] neg_hi:[0,1,0]
    v_pk_fma_f32 v[22:23], v[134:135], v[76:77], v[22:23] op_sel_hi:[1,0,1] neg_lo:[0,1,0] neg_hi:[0,1,0]
    v_pk_fma_f32 v[28:29], v[128:129], v[78:79], v[28:29] op_sel_hi:[1,0,1] neg_lo:[0,1,0] neg_hi:[0,1,0]
    v_pk_fma_f32 v[30:31], v[130:131], v[78:79], v[30:31] op_sel_hi:[1,0,1] neg_lo:[0,1,0] neg_hi:[0,1,0]
    v_pk_fma_f32 v[32:33], v[132:133], v[78:79], v[32:33] op_sel_hi:[1,0,1] neg_lo:[0,1,0] neg_hi:[0,1,0]
    v_pk_fma_f32 v[34:35], v[134:135], v[78:79], v[34:35] op_sel_hi:[1,0,1] neg_lo:[0,1,0] neg_hi:[0,1,0]
    v_pk_fma_f32 v[40:41], v[128:129], v[80:81], v[40:41] op_sel_hi:[1,0,1] neg_lo:[0,1,0] neg_hi:[0,1,0]
    v_pk_fma_f32 v[42:43], v[130:131], v[80:81], v[42:43] op_sel_hi:[1,0,1] neg_lo:[0,1,0] neg_hi:[0,1,0]
    v_pk_fma_f32 v[44:45], v[132:133], v[80:81], v[44:45] op_sel_hi:[1,0,1] neg_lo:[0,1,0] neg_hi:[0,1,0]
    v_pk_fma_f32 v[46:47], v[134:135], v[80:81], v[46:47] op_sel_hi:[1,0,1] neg_lo:[0,1,0] neg_hi:[0,1,0]
    v_pk_fma_f32 v[52:53], v[128:129], v[82:83], v[52:53] op_sel_hi:[1,0,1] neg_lo:[0,1,0] neg_hi:[0,1,0]
    v_pk_fma_f32 v[54:55], v[130:131], v[82:83], v[54:55] op_sel_hi:[1,0,1] neg_lo:[0,1,0] neg_hi:[0,1,0]
    v_pk_fma_f32 v[56:57], v[132:133], v[82:83], v[56:57] op_sel_hi:[1,0,1] neg_lo:[0,1,0] neg_hi:[0,1,0]
    v_pk_fma_f32 v[58:59], v[134:135], v[82:83], v[58:59] op_sel_hi:[1,0,1] neg_lo:[0,1,0] neg_hi:[0,1,0]
    v_pk_fma_f32 v[64:65], v[128:129], v[84:85], v[64:65] op_sel_hi:[1,0,1] neg_lo:[0,1,0] neg_hi:[0,1,0]
    v_pk_fma_f32 v[66:67], v[130:131], v[84:85], v[66:67] op_sel_hi:[1,0,1] neg_lo:[0,1,0] neg_hi:[0,1,0]
    v_pk_fma_f32 v[68:69], v[132:133], v[84:85], v[68:69] op_sel_hi:[1,0,1] neg_lo:[0,1,0] neg_hi:[0,1,0]
    v_pk_fma_f32 v[70:71], v[134:135], v[84:85], v[70:71] op_sel_hi:[1,0,1] neg_lo:[0,1,0] neg_hi:[0,1,0]
    v_pk_mul_f32 v[20:21], v[20:21], v[76:77] op_sel:[0,1] op_sel_hi:[1,1]
    v_pk_mul_f32 v[22:23], v[22:23], v[76:77] op_sel:[0,1] op_sel_hi:[1,1]
    v_pk_mul_f32 v[28:29], v[28:29], v[78:79] op_sel:[0,1] op_sel_hi:[1,1]
    v_pk_mul_f32 v[30:31], v[30:31], v[78:79] op_sel:[0,1] op_sel_hi:[1,1]
    v_pk_mul_f32 v[32:33], v[32:33], v[78:79] op_sel:[0,1] op_sel_hi:[1,1]
    v_pk_mul_f32 v[34:35], v[34:35], v[78:79] op_sel:[0,1] op_sel_hi:[1,1]
    v_pk_mul_f32 v[40:41], v[40:41], v[80:81] op_sel:[0,1] op_sel_hi:[1,1]
    v_pk_mul_f32 v[42:43], v[42:43], v[80:81] op_sel:[0,1] op_sel_hi:[1,1]
    v_pk_mul_f32 v[44:45], v[44:45], v[80:81] op_sel:[0,1] op_sel_hi:[1,1]
    v_pk_mul_f32 v[46:47], v[46:47], v[80:81] op_sel:[0,1] op_sel_hi:[1,1]
    v_pk_mul_f32 v[52:53], v[52:53], v[82:83] op_sel:[0,1] op_sel_hi:[1,1]
    v_pk_mul_f32 v[54:55], v[54:55], v[82:83] op_sel:[0,1] op_sel_hi:[1,1]
    v_pk_mul_f32 v[56:57], v[56:57], v[82:83] op_sel:[0,1] op_sel_hi:[1,1]
    v_pk_mul_f32 v[58:59], v[58:59], v[82:83] op_sel:[0,1] op_sel_hi:[1,1]
    v_pk_mul_f32 v[64:65], v[64:65], v[84:85] op_sel:[0,1] op_sel_hi:[1,1]
    v_pk_mul_f32 v[66:67], v[66:67], v[84:85] op_sel:[0,1] op_sel_hi:[1,1]
    v_pk_mul_f32 v[68:69], v[68:69], v[84:85] op_sel:[0,1] op_sel_hi:[1,1]
    v_pk_mul_f32 v[70:71], v[70:71], v[84:85] op_sel:[0,1] op_sel_hi:[1,1]
    v_cvt_pk_bf16_f32 v20, v20, v21
    v_cvt_pk_bf16_f32 v21, v22, v23
    v_cvt_pk_bf16_f32 v148, v28, v29
    v_cvt_pk_bf16_f32 v149, v30, v31
    v_cvt_pk_bf16_f32 v32, v32, v33
    v_cvt_pk_bf16_f32 v33, v34, v35
    v_cvt_pk_bf16_f32 v150, v40, v41
    v_cvt_pk_bf16_f32 v151, v42, v43
    v_cvt_pk_bf16_f32 v44, v44, v45
    v_cvt_pk_bf16_f32 v45, v46, v47
    v_cvt_pk_bf16_f32 v152, v52, v53
    v_cvt_pk_bf16_f32 v153, v54, v55
    v_cvt_pk_bf16_f32 v56, v56, v57
    v_cvt_pk_bf16_f32 v57, v58, v59
    v_cvt_pk_bf16_f32 v154, v64, v65
    v_cvt_pk_bf16_f32 v155, v66, v67
    v_cvt_pk_bf16_f32 v68, v68, v69
    v_cvt_pk_bf16_f32 v69, v70, v71
    s_waitcnt lgkmcnt(0)
    v_pk_fma_f32 v[24:25], v[88:89], v[136:137], v[24:25] op_sel_hi:[1,0,1] neg_lo:[1,0,0] neg_hi:[1,0,0]
    v_pk_fma_f32 v[26:27], v[90:91], v[136:137], v[26:27] op_sel_hi:[1,0,1] neg_lo:[1,0,0] neg_hi:[1,0,0]
    v_pk_fma_f32 v[36:37], v[96:97], v[136:137], v[36:37] op_sel_hi:[1,0,1] neg_lo:[1,0,0] neg_hi:[1,0,0]
    v_pk_fma_f32 v[38:39], v[98:99], v[136:137], v[38:39] op_sel_hi:[1,0,1] neg_lo:[1,0,0] neg_hi:[1,0,0]
    v_pk_fma_f32 v[48:49], v[104:105], v[136:137], v[48:49] op_sel_hi:[1,0,1] neg_lo:[1,0,0] neg_hi:[1,0,0]
    v_pk_fma_f32 v[50:51], v[106:107], v[136:137], v[50:51] op_sel_hi:[1,0,1] neg_lo:[1,0,0] neg_hi:[1,0,0]
    v_pk_fma_f32 v[60:61], v[112:113], v[136:137], v[60:61] op_sel_hi:[1,0,1] neg_lo:[1,0,0] neg_hi:[1,0,0]
    v_pk_fma_f32 v[62:63], v[114:115], v[136:137], v[62:63] op_sel_hi:[1,0,1] neg_lo:[1,0,0] neg_hi:[1,0,0]
    v_pk_fma_f32 v[72:73], v[120:121], v[136:137], v[72:73] op_sel_hi:[1,0,1] neg_lo:[1,0,0] neg_hi:[1,0,0]
    v_pk_fma_f32 v[74:75], v[122:123], v[136:137], v[74:75] op_sel_hi:[1,0,1] neg_lo:[1,0,0] neg_hi:[1,0,0]
    v_pk_mul_f32 v[24:25], v[24:25], v[92:93]
    v_pk_mul_f32 v[26:27], v[26:27], v[94:95]
    v_pk_mul_f32 v[36:37], v[36:37], v[100:101]
    v_pk_mul_f32 v[38:39], v[38:39], v[102:103]
    v_pk_mul_f32 v[48:49], v[48:49], v[108:109]
    v_pk_mul_f32 v[50:51], v[50:51], v[110:111]
    v_pk_mul_f32 v[60:61], v[60:61], v[116:117]
    v_pk_mul_f32 v[62:63], v[62:63], v[118:119]
    v_pk_mul_f32 v[72:73], v[72:73], v[124:125]
    v_pk_mul_f32 v[74:75], v[74:75], v[126:127]
    v_cvt_pk_bf16_f32 v156, v24, v25
    v_cvt_pk_bf16_f32 v157, v26, v27
    v_cvt_pk_bf16_f32 v158, v36, v37
    v_cvt_pk_bf16_f32 v159, v38, v39
    v_cvt_pk_bf16_f32 v160, v48, v49
    v_cvt_pk_bf16_f32 v161, v50, v51
    v_cvt_pk_bf16_f32 v162, v60, v61
    v_cvt_pk_bf16_f32 v163, v62, v63
    v_cvt_pk_bf16_f32 v164, v72, v73
    v_cvt_pk_bf16_f32 v165, v74, v75
    v_mov_b32 v139, 0
    buffer_load_dword v138, v139, s[8:11], s55 offen sc1
    v_mfma_f32_16x16x16_bf16 v[28:31], v[32:33], v[148:149], 0
    v_mfma_f32_16x16x16_bf16 v[36:39], v[20:21], v[148:149], 0
    v_mfma_f32_16x16x16_bf16 v[40:43], v[44:45], v[150:151], 0
    v_mfma_f32_16x16x16_bf16 v[48:51], v[32:33], v[150:151], 0
    v_mfma_f32_16x16x16_bf16 v[52:55], v[56:57], v[152:153], 0
    v_mfma_f32_16x16x16_bf16 v[60:63], v[44:45], v[152:153], 0
    v_mfma_f32_16x16x16_bf16 v[64:67], v[68:69], v[154:155], 0
    v_mfma_f32_16x16x16_bf16 v[72:75], v[56:57], v[154:155], 0
    v_mov_b32 v2, 0xcf6e6b28
    s_mov_b32 s35, 0xffff0000
    s_mov_b32 s36, 0x3eb8aa3b
    s_lshl_b32 s34, s25, 2
    s_add_u32 s34, s34, s27
    s_lshl_b32 s34, s34, 11
    s_lshl_b32 s31, s24, 10
    s_add_u32 s34, s34, s31
    s_sub_u32 s53, s52, 1
    s_lshl_b32 s31, s53, 21
    s_add_u32 s34, s34, s31
    v_cndmask_b32 v76, v28, v29, s[42:43]
    v_cndmask_b32 v77, v30, v31, s[42:43]
    v_cndmask_b32 v78, v36, v37, s[42:43]
    v_cndmask_b32 v79, v38, v39, s[42:43]
    v_cndmask_b32 v78, v78, v2, s[48:49]
    v_cndmask_b32 v79, v79, v2, s[48:49]
    v_cndmask_b32 v84, v40, v41, s[42:43]
    v_cndmask_b32 v85, v42, v43, s[42:43]
    v_cndmask_b32 v86, v48, v49, s[42:43]
    v_cndmask_b32 v87, v50, v51, s[42:43]
    v_cndmask_b32 v92, v52, v53, s[42:43]
    v_cndmask_b32 v93, v54, v55, s[42:43]
    v_cndmask_b32 v94, v60, v61, s[42:43]
    v_cndmask_b32 v95, v62, v63, s[42:43]
    v_cndmask_b32 v100, v64, v65, s[42:43]
    v_cndmask_b32 v101, v66, v67, s[42:43]
    v_cndmask_b32 v102, v72, v73, s[42:43]
    v_cndmask_b32 v103, v74, v75, s[42:43]
    v_cndmask_b32 v76, v78, v76, s[44:45]
    v_cndmask_b32 v77, v79, v77, s[46:47]
    v_cndmask_b32 v84, v86, v84, s[44:45]
    v_cndmask_b32 v85, v87, v85, s[46:47]
    v_cndmask_b32 v92, v94, v92, s[44:45]
    v_cndmask_b32 v93, v95, v93, s[46:47]
    v_cndmask_b32 v100, v102, v100, s[44:45]
    v_cndmask_b32 v101, v103, v101, s[46:47]
    v_cvt_pk_bf16_f32 v78, v76, v77
    v_cvt_pk_bf16_f32 v86, v84, v85
    v_cvt_pk_bf16_f32 v94, v92, v93
    v_cvt_pk_bf16_f32 v102, v100, v101
    v_lshlrev_b32 v76, 16, v78
    v_and_b32 v77, s35, v78
    v_lshlrev_b32 v84, 16, v86
    v_and_b32 v85, s35, v86
    v_lshlrev_b32 v92, 16, v94
    v_and_b32 v93, s35, v94
    v_lshlrev_b32 v100, 16, v102
    v_and_b32 v101, s35, v102
    v_max_f32 v78, v76, v77
    v_max_f32 v86, v84, v85
    v_max_f32 v94, v92, v93
    v_max_f32 v102, v100, v101
    v_mov_b32 v79, v78
    v_mov_b32 v87, v86
    v_mov_b32 v95, v94
    v_mov_b32 v103, v102
    v_permlane16_swap_b32 v78, v79
    v_permlane16_swap_b32 v86, v87
    v_permlane16_swap_b32 v94, v95
    v_permlane16_swap_b32 v102, v103
    v_max_f32 v78, v78, v79
    v_max_f32 v86, v86, v87
    v_max_f32 v94, v94, v95
    v_max_f32 v102, v102, v103
    v_mov_b32 v79, v78
    v_mov_b32 v87, v86
    v_mov_b32 v95, v94
    v_mov_b32 v103, v102
    v_permlane32_swap_b32 v78, v79
    v_permlane32_swap_b32 v86, v87
    v_permlane32_swap_b32 v94, v95
    v_permlane32_swap_b32 v102, v103
    v_max_f32 v78, v78, v79
    v_max_f32 v86, v86, v87
    v_max_f32 v94, v94, v95
    v_max_f32 v102, v102, v103
    v_sub_f32 v76, v76, v78
    v_sub_f32 v77, v77, v78
    v_sub_f32 v84, v84, v86
    v_sub_f32 v85, v85, v86
    v_sub_f32 v92, v92, v94
    v_sub_f32 v93, v93, v94
    v_sub_f32 v100, v100, v102
    v_sub_f32 v101, v101, v102
    v_mul_f32 v76, s36, v76
    v_mul_f32 v77, s36, v77
    v_mul_f32 v84, s36, v84
    v_mul_f32 v85, s36, v85
    v_mul_f32 v92, s36, v92
    v_mul_f32 v93, s36, v93
    v_mul_f32 v100, s36, v100
    v_mul_f32 v101, s36, v101
    v_exp_f32 v76, v76
    v_exp_f32 v77, v77
    v_exp_f32 v84, v84
    v_exp_f32 v85, v85
    v_exp_f32 v92, v92
    v_exp_f32 v93, v93
    v_exp_f32 v100, v100
    v_exp_f32 v101, v101
    v_add_f32 v78, v76, v77
    v_add_f32 v86, v84, v85
    v_add_f32 v94, v92, v93
    v_add_f32 v102, v100, v101
    v_mov_b32 v79, v78
    v_mov_b32 v87, v86
    v_mov_b32 v95, v94
    v_mov_b32 v103, v102
    v_permlane16_swap_b32 v78, v79
    v_permlane16_swap_b32 v86, v87
    v_permlane16_swap_b32 v94, v95
    v_permlane16_swap_b32 v102, v103
    v_add_f32 v78, v78, v79
    v_add_f32 v86, v86, v87
    v_add_f32 v94, v94, v95
    v_add_f32 v102, v102, v103
    v_mov_b32 v79, v78
    v_mov_b32 v87, v86
    v_mov_b32 v95, v94
    v_mov_b32 v103, v102
    v_permlane32_swap_b32 v78, v79
    v_permlane32_swap_b32 v86, v87
    v_permlane32_swap_b32 v94, v95
    v_permlane32_swap_b32 v102, v103
    v_add_f32 v78, v78, v79
    v_add_f32 v86, v86, v87
    v_add_f32 v94, v94, v95
    v_add_f32 v102, v102, v103
    v_rcp_f32 v78, v78
    v_rcp_f32 v86, v86
    v_rcp_f32 v94, v94
    v_rcp_f32 v102, v102
    v_mul_f32 v76, v76, v78
    v_mul_f32 v77, v77, v78
    v_mul_f32 v84, v84, v86
    v_mul_f32 v85, v85, v86
    v_mul_f32 v92, v92, v94
    v_mul_f32 v93, v93, v94
    v_mul_f32 v100, v100, v102
    v_mul_f32 v101, v101, v102
    v_cvt_pk_bf16_f32 v78, v76, v77
    v_cvt_pk_bf16_f32 v86, v84, v85
    v_cvt_pk_bf16_f32 v94, v92, v93
    v_cvt_pk_bf16_f32 v102, v100, v101
    v_perm_b32 v80, v78, v78, v140
    v_perm_b32 v81, v78, v78, v141
    v_perm_b32 v82, v78, v78, v142
    v_perm_b32 v83, v78, v78, v143
    v_perm_b32 v88, v86, v86, v140
    v_perm_b32 v89, v86, v86, v141
    v_perm_b32 v90, v86, v86, v142
    v_perm_b32 v91, v86, v86, v143
    v_perm_b32 v96, v94, v94, v140
    v_perm_b32 v97, v94, v94, v141
    v_perm_b32 v98, v94, v94, v142
    v_perm_b32 v99, v94, v94, v143
    v_perm_b32 v104, v102, v102, v140
    v_perm_b32 v105, v102, v102, v141
    v_perm_b32 v106, v102, v102, v142
    v_perm_b32 v107, v102, v102, v143
    v_mfma_f32_16x16x32_bf16 v[28:31], v[156:159], v[80:83], 0
    v_mfma_f32_16x16x32_bf16 v[40:43], v[158:161], v[88:91], 0
    v_mfma_f32_16x16x32_bf16 v[52:55], v[160:163], v[96:99], 0
    v_mfma_f32_16x16x32_bf16 v[64:67], v[162:165], v[104:107], 0
    s_waitcnt vmcnt(0)
    v_readfirstlane_b32 s33, v138
    s_nop 2
    v_cvt_pk_bf16_f32 v76, v28, v29
    v_cvt_pk_bf16_f32 v77, v30, v31
    v_cvt_pk_bf16_f32 v78, v40, v41
    v_cvt_pk_bf16_f32 v79, v42, v43
    v_cvt_pk_bf16_f32 v84, v52, v53
    v_cvt_pk_bf16_f32 v85, v54, v55
    v_cvt_pk_bf16_f32 v86, v64, v65
    v_cvt_pk_bf16_f32 v87, v66, v67
    v_permlane16_swap_b32 v76, v78
    v_permlane16_swap_b32 v77, v79
    v_permlane16_swap_b32 v84, v86
    v_permlane16_swap_b32 v85, v87
    s_lshr_b32 s33, s33, s54
    s_and_b32 s33, s33, 15
    s_cmp_eq_u32 s33, 8
    s_cselect_b32 s79, 1, 0
    s_cbranch_scc1 c_olocal
    buffer_store_dwordx4 v[76:79], v144, s[12:15], s34 offen offset:0 sc1
    buffer_store_dwordx4 v[84:87], v144, s[12:15], s34 offen offset:1024 sc1
    s_branch c_odone
c_olocal:
    buffer_store_dwordx4 v[76:79], v144, s[12:15], s34 offen offset:0
    buffer_store_dwordx4 v[84:87], v144, s[12:15], s34 offen offset:1024
c_odone:
    s_barrier
    s_and_b32 s36, s25, 3
    s_lshr_b32 s37, s25, 2
    s_lshl_b32 s37, s37, 5
    s_add_u32 s37, s37, s24
    v_lshrrev_b32 v8, 3, v12
    v_lshlrev_b32 v8, 10, v8
    v_and_b32 v9, 7, v12
    v_lshl_add_u32 v8, v9, 7, v8
    v_lshrrev_b32 v9, 1, v12
    v_xor_b32 v9, v9, v13
    v_lshl_add_u32 v8, v9, 4, v8
    v_add_u32 v8, 73728, v8
    v_xor_b32 v9, 64, v8
    v_lshrrev_b32 v10, 5, v1
    v_lshlrev_b32 v10, 12, v10
    v_bfe_u32 v14, v1, 2, 3
    v_lshl_add_u32 v10, v14, 7, v10
    v_bfe_u32 v14, v1, 3, 2
    s_and_b32 s34, s27, 1
    s_lshl_b32 s34, s34, 1
    v_xor_b32 v14, s34, v14
    v_lshl_add_u32 v10, v14, 5, v10
    v_and_b32 v14, 3, v1
    v_lshl_add_u32 v10, v14, 3, v10
    s_lshr_b32 s34, s27, 1
    s_lshl_b32 s34, s34, 10
    v_add_u32 v10, s34, v10
    v_xor_b32 v11, 32, v10
    v_add_u32 v6, 0x10000, v10
    v_add_u32 v7, 0x10000, v11
    v_add_u32 v116, 0x20000, v10
    v_add_u32 v117, 0x20000, v11
    v_lshrrev_b32 v14, 2, v1
    v_lshlrev_b32 v72, 8, v14
    v_and_b32 v14, 7, v14
    s_lshl_b32 s34, s27, 1
    v_xor_b32 v14, s34, v14
    v_lshl_add_u32 v72, v14, 5, v72
    v_and_b32 v14, 3, v1
    v_lshl_add_u32 v72, v14, 3, v72
    v_xor_b32 v73, 32, v72
    s_lshl_b32 s34, s27, 5
    v_add_u32 v74, s34, v12
    v_mul_u32_u24 v74, 96, v74
    v_lshl_add_u32 v74, v13, 3, v74
    v_lshrrev_b32 v75, 2, v0
    v_and_b32 v14, 3, v0
    v_mul_u32_u24 v76, 96, v75
    v_lshl_add_u32 v76, v14, 4, v76
    v_lshrrev_b32 v75, 3, v0
    v_lshlrev_b32 v75, 13, v75
    v_and_b32 v14, 7, v0
    v_lshl_add_u32 v75, v14, 4, v75
    v_add_u32 v77, 0x40000, v75
    v_bfe_u32 v14, v1, 2, 2
    v_lshl_add_u32 v14, v13, 3, v14
    v_mul_u32_u24 v78, 96, v14
    v_and_b32 v14, 3, v1
    v_lshl_add_u32 v78, v14, 3, v78
    s_lshl_b32 s34, s27, 5
    v_add_u32 v78, s34, v78
    s_lshl_b32 s34, s27, 11
    v_lshlrev_b32 v79, 6, v12
    v_lshl_add_u32 v79, v13, 3, v79
    v_add_u32 v79, s34, v79
    v_add_u32 v72, 106496, v72
    v_add_u32 v73, 106496, v73
    v_add_u32 v74, 106496, v74
    v_add_u32 v76, 106496, v76
    v_add_u32 v78, 106496, v78
    v_add_u32 v79, 106496, v79
    v_and_b32 v14, 2, v12
    v_cmp_eq_u32 s[50:51], 2, v14
    v_mov_b32 v80, 0x3f803f80
    v_mov_b32 v81, 0x3f803f80
    v_mov_b32 v82, 0x3f803f80
    v_mov_b32 v83, 0x3f803f80
    s_lshl_b32 s38, s36, 19
    s_lshl_b32 s34, s37, 2
    s_add_u32 s38, s38, s34
    s_lshl_b32 s34, s53, 21
    s_add_u32 s38, s38, s34
    s_add_u32 s38, s38, 4194304
    s_lshl_b32 s39, s37, 5
    s_lshl_b32 s34, s27, 7
    s_add_u32 s39, s39, s34
    s_lshl_b32 s34, s53, 16
    s_add_u32 s39, s39, s34
    s_add_u32 s39, s39, 11534336
    s_lshl_b32 s37, s36, 8
    s_add_u32 s37, s37, s39
    s_add_u32 s36, s38, 8388608
    s_lshl_b32 s34, s27, 6
    s_add_u32 s34, s34, 127040
    v_lshl_add_u32 v137, v12, 2, s34
    v_and_b32 v139, 3, v1
    v_lshlrev_b32 v139, 5, v139
    v_add_u32 v139, 127040, v139
    v_lshlrev_b32 v4, 3, v12
    v_lshlrev_b32 v118, 3, v1
    v_lshrrev_b32 v151, 2, v0
    v_and_b32 v152, 1, v0
    v_lshl_add_u32 v151, v151, 1, v152
    v_bfe_u32 v152, v0, 1, 1
    v_lshrrev_b32 v150, 3, v151
    v_lshlrev_b32 v150, 7, v150
    v_lshl_add_u32 v150, v152, 6, v150
    v_and_b32 v153, 7, v151
    v_lshl_add_u32 v150, v153, 3, v150
    s_lshl_b32 s28, s77, 13
    s_lshl_b32 s29, s53, 21
    s_add_u32 s30, s28, s29
    s_add_u32 s28, s30, 12582912
    s_add_u32 s29, s28, 4096
    s_add_u32 s30, s30, 4194304
    s_add_u32 s31, s30, 4096
    s_barrier
    ds_read_b128 v[40:43], v8 offset:0
    ds_read_b128 v[44:47], v8 offset:2048
    ds_read_b64_tr_b16 v[48:49], v6 offset:40960
    ds_read_b64_tr_b16 v[50:51], v6 offset:43008
    ds_read_b64_tr_b16 v[52:53], v7 offset:40960
    ds_read_b64_tr_b16 v[54:55], v7 offset:43008
    ds_read_b128 v[56:59], v9 offset:0
    ds_read_b128 v[60:63], v9 offset:2048
    ds_read_b64_tr_b16 v[64:65], v6 offset:49152
    ds_read_b64_tr_b16 v[66:67], v6 offset:51200
    ds_read_b64_tr_b16 v[68:69], v7 offset:49152
    ds_read_b64_tr_b16 v[70:71], v7 offset:51200
    s_lshl_b32 s34, s53, 2
    s_mov_b64 exec, 0xffffffff
    buffer_load_dword v119, v118, s[8:11], s34 offen sc1
    s_mov_b64 exec, -1
    s_waitcnt lgkmcnt(6)
    v_mfma_f32_16x16x32_bf16 v[24:27], v[40:43], v[48:51], 0
    ds_read_b128 v[84:87], v8 offset:4096
    ds_read_b128 v[88:91], v8 offset:6144
    v_mfma_f32_16x16x32_bf16 v[28:31], v[40:43], v[52:55], 0
    ds_read_b64_tr_b16 v[92:93], v6 offset:57344
    ds_read_b64_tr_b16 v[94:95], v6 offset:59392
    v_mfma_f32_16x16x32_bf16 v[32:35], v[44:47], v[48:51], 0
    ds_read_b64_tr_b16 v[96:97], v7 offset:57344
    ds_read_b64_tr_b16 v[98:99], v7 offset:59392
    v_mfma_f32_16x16x32_bf16 v[36:39], v[44:47], v[52:55], 0
    s_waitcnt lgkmcnt(6)
    v_mfma_f32_16x16x32_bf16 v[24:27], v[56:59], v[64:67], v[24:27]
    ds_read_b128 v[100:103], v9 offset:4096
    ds_read_b128 v[104:107], v9 offset:6144
    v_mfma_f32_16x16x32_bf16 v[28:31], v[56:59], v[68:71], v[28:31]
    ds_read_b64_tr_b16 v[108:109], v116 offset:0
    ds_read_b64_tr_b16 v[110:111], v116 offset:2048
    v_mfma_f32_16x16x32_bf16 v[32:35], v[60:63], v[64:67], v[32:35]
    ds_read_b64_tr_b16 v[112:113], v117 offset:0
    ds_read_b64_tr_b16 v[114:115], v117 offset:2048
    v_mfma_f32_16x16x32_bf16 v[36:39], v[60:63], v[68:71], v[36:39]
    s_waitcnt lgkmcnt(6)
    v_mfma_f32_16x16x32_bf16 v[24:27], v[84:87], v[92:95], v[24:27]
    ds_read_b128 v[40:43], v8 offset:8192
    ds_read_b128 v[44:47], v8 offset:10240
    v_mfma_f32_16x16x32_bf16 v[28:31], v[84:87], v[96:99], v[28:31]
    ds_read_b64_tr_b16 v[48:49], v116 offset:8192
    ds_read_b64_tr_b16 v[50:51], v116 offset:10240
    v_mfma_f32_16x16x32_bf16 v[32:35], v[88:91], v[92:95], v[32:35]
    ds_read_b64_tr_b16 v[52:53], v117 offset:8192
    ds_read_b64_tr_b16 v[54:55], v117 offset:10240
    v_mfma_f32_16x16x32_bf16 v[36:39], v[88:91], v[96:99], v[36:39]
    s_waitcnt lgkmcnt(6)
    v_mfma_f32_16x16x32_bf16 v[24:27], v[100:103], v[108:111], v[24:27]
    ds_read_b128 v[56:59], v9 offset:8192
    ds_read_b128 v[60:63], v9 offset:10240
    v_mfma_f32_16x16x32_bf16 v[28:31], v[100:103], v[112:115], v[28:31]
    ds_read_b64_tr_b16 v[64:65], v116 offset:16384
    ds_read_b64_tr_b16 v[66:67], v116 offset:18432
    v_mfma_f32_16x16x32_bf16 v[32:35], v[104:107], v[108:111], v[32:35]
    ds_read_b64_tr_b16 v[68:69], v117 offset:16384
    ds_read_b64_tr_b16 v[70:71], v117 offset:18432
    v_mfma_f32_16x16x32_bf16 v[36:39], v[104:107], v[112:115], v[36:39]
    s_waitcnt lgkmcnt(6)
    v_mfma_f32_16x16x32_bf16 v[24:27], v[40:43], v[48:51], v[24:27]
    ds_read_b128 v[84:87], v8 offset:12288
    ds_read_b128 v[88:91], v8 offset:14336
    v_mfma_f32_16x16x32_bf16 v[28:31], v[40:43], v[52:55], v[28:31]
    ds_read_b64_tr_b16 v[92:93], v116 offset:24576
    ds_read_b64_tr_b16 v[94:95], v116 offset:26624
    v_mfma_f32_16x16x32_bf16 v[32:35], v[44:47], v[48:51], v[32:35]
    ds_read_b64_tr_b16 v[96:97], v117 offset:24576
    ds_read_b64_tr_b16 v[98:99], v117 offset:26624
    v_mfma_f32_16x16x32_bf16 v[36:39], v[44:47], v[52:55], v[36:39]
    s_barrier
    s_waitcnt lgkmcnt(6)
    v_mfma_f32_16x16x32_bf16 v[24:27], v[56:59], v[64:67], v[24:27]
    ds_read_b128 v[100:103], v9 offset:12288
    ds_read_b128 v[104:107], v9 offset:14336
    v_mfma_f32_16x16x32_bf16 v[28:31], v[56:59], v[68:71], v[28:31]
    ds_read_b64_tr_b16 v[108:109], v10 offset:0
    ds_read_b64_tr_b16 v[110:111], v10 offset:2048
    v_mfma_f32_16x16x32_bf16 v[32:35], v[60:63], v[64:67], v[32:35]
    ds_read_b64_tr_b16 v[112:113], v11 offset:0
    ds_read_b64_tr_b16 v[114:115], v11 offset:2048
    v_mfma_f32_16x16x32_bf16 v[36:39], v[60:63], v[68:71], v[36:39]
    s_waitcnt lgkmcnt(6)
    v_mfma_f32_16x16x32_bf16 v[24:27], v[84:87], v[92:95], v[24:27]
    ds_read_b128 v[40:43], v8 offset:16384
    ds_read_b128 v[44:47], v8 offset:18432
    v_mfma_f32_16x16x32_bf16 v[28:31], v[84:87], v[96:99], v[28:31]
    ds_read_b64_tr_b16 v[48:49], v10 offset:8192
    ds_read_b64_tr_b16 v[50:51], v10 offset:10240
    v_mfma_f32_16x16x32_bf16 v[32:35], v[88:91], v[92:95], v[32:35]
    ds_read_b64_tr_b16 v[52:53], v11 offset:8192
    ds_read_b64_tr_b16 v[54:55], v11 offset:10240
    v_mfma_f32_16x16x32_bf16 v[36:39], v[88:91], v[96:99], v[36:39]
    s_waitcnt lgkmcnt(6)
    v_mfma_f32_16x16x32_bf16 v[24:27], v[100:103], v[108:111], v[24:27]
    ds_read_b128 v[56:59], v9 offset:16384
    ds_read_b128 v[60:63], v9 offset:18432
    v_mfma_f32_16x16x32_bf16 v[28:31], v[100:103], v[112:115], v[28:31]
    ds_read_b64_tr_b16 v[64:65], v10 offset:16384
    ds_read_b64_tr_b16 v[66:67], v10 offset:18432
    v_mfma_f32_16x16x32_bf16 v[32:35], v[104:107], v[108:111], v[32:35]
    ds_read_b64_tr_b16 v[68:69], v11 offset:16384
    ds_read_b64_tr_b16 v[70:71], v11 offset:18432
    v_mfma_f32_16x16x32_bf16 v[36:39], v[104:107], v[112:115], v[36:39]
    s_waitcnt lgkmcnt(6)
    v_mfma_f32_16x16x32_bf16 v[24:27], v[40:43], v[48:51], v[24:27]
    ds_read_b128 v[84:87], v8 offset:20480
    ds_read_b128 v[88:91], v8 offset:22528
    v_mfma_f32_16x16x32_bf16 v[28:31], v[40:43], v[52:55], v[28:31]
    ds_read_b64_tr_b16 v[92:93], v10 offset:24576
    ds_read_b64_tr_b16 v[94:95], v10 offset:26624
    v_mfma_f32_16x16x32_bf16 v[32:35], v[44:47], v[48:51], v[32:35]
    ds_read_b64_tr_b16 v[96:97], v11 offset:24576
    ds_read_b64_tr_b16 v[98:99], v11 offset:26624
    v_mfma_f32_16x16x32_bf16 v[36:39], v[44:47], v[52:55], v[36:39]
    s_waitcnt lgkmcnt(6)
    v_mfma_f32_16x16x32_bf16 v[24:27], v[56:59], v[64:67], v[24:27]
    ds_read_b128 v[100:103], v9 offset:20480
    ds_read_b128 v[104:107], v9 offset:22528
    v_mfma_f32_16x16x32_bf16 v[28:31], v[56:59], v[68:71], v[28:31]
    ds_read_b64_tr_b16 v[108:109], v10 offset:32768
    ds_read_b64_tr_b16 v[110:111], v10 offset:34816
    v_mfma_f32_16x16x32_bf16 v[32:35], v[60:63], v[64:67], v[32:35]
    ds_read_b64_tr_b16 v[112:113], v11 offset:32768
    ds_read_b64_tr_b16 v[114:115], v11 offset:34816
    v_mfma_f32_16x16x32_bf16 v[36:39], v[60:63], v[68:71], v[36:39]
    s_waitcnt lgkmcnt(6)
    v_mfma_f32_16x16x32_bf16 v[24:27], v[84:87], v[92:95], v[24:27]
    ds_read_b128 v[40:43], v8 offset:24576
    ds_read_b128 v[44:47], v8 offset:26624
    v_mfma_f32_16x16x32_bf16 v[28:31], v[84:87], v[96:99], v[28:31]
    ds_read_b64_tr_b16 v[48:49], v10 offset:40960
    ds_read_b64_tr_b16 v[50:51], v10 offset:43008
    v_mfma_f32_16x16x32_bf16 v[32:35], v[88:91], v[92:95], v[32:35]
    ds_read_b64_tr_b16 v[52:53], v11 offset:40960
    ds_read_b64_tr_b16 v[54:55], v11 offset:43008
    v_mfma_f32_16x16x32_bf16 v[36:39], v[88:91], v[96:99], v[36:39]
    s_waitcnt lgkmcnt(6)
    v_mfma_f32_16x16x32_bf16 v[24:27], v[100:103], v[108:111], v[24:27]
    ds_read_b128 v[56:59], v9 offset:24576
    ds_read_b128 v[60:63], v9 offset:26624
    v_mfma_f32_16x16x32_bf16 v[28:31], v[100:103], v[112:115], v[28:31]
    ds_read_b64_tr_b16 v[64:65], v10 offset:49152
    ds_read_b64_tr_b16 v[66:67], v10 offset:51200
    v_mfma_f32_16x16x32_bf16 v[32:35], v[104:107], v[108:111], v[32:35]
    ds_read_b64_tr_b16 v[68:69], v11 offset:49152
    ds_read_b64_tr_b16 v[70:71], v11 offset:51200
    v_mfma_f32_16x16x32_bf16 v[36:39], v[104:107], v[112:115], v[36:39]
    s_waitcnt lgkmcnt(6)
    v_mfma_f32_16x16x32_bf16 v[24:27], v[40:43], v[48:51], v[24:27]
    ds_read_b128 v[84:87], v8 offset:28672
    ds_read_b128 v[88:91], v8 offset:30720
    v_mfma_f32_16x16x32_bf16 v[28:31], v[40:43], v[52:55], v[28:31]
    ds_read_b64_tr_b16 v[92:93], v10 offset:57344
    ds_read_b64_tr_b16 v[94:95], v10 offset:59392
    v_mfma_f32_16x16x32_bf16 v[32:35], v[44:47], v[48:51], v[32:35]
    ds_read_b64_tr_b16 v[96:97], v11 offset:57344
    ds_read_b64_tr_b16 v[98:99], v11 offset:59392
    v_mfma_f32_16x16x32_bf16 v[36:39], v[44:47], v[52:55], v[36:39]
    s_waitcnt vmcnt(0)
    v_lshrrev_b32 v153, 4, v119
    v_and_b32 v153, 0x0f0f0f0f, v153
    v_and_b32 v154, 0x0f0f0f0f, v119
    v_add_u32 v154, v154, v153
    v_lshrrev_b32 v153, 16, v154
    v_add_u32 v154, v154, v153
    v_lshrrev_b32 v153, 8, v154
    v_add_u32 v154, v154, v153
    v_and_b32 v154, 0xff, v154
    v_cmp_ne_u32 s[58:59], 8, v154
    s_waitcnt lgkmcnt(6)
    v_mfma_f32_16x16x32_bf16 v[24:27], v[56:59], v[64:67], v[24:27]
    ds_read_b128 v[100:103], v9 offset:28672
    ds_read_b128 v[104:107], v9 offset:30720
    v_mfma_f32_16x16x32_bf16 v[28:31], v[56:59], v[68:71], v[28:31]
    ds_read_b64_tr_b16 v[108:109], v6 offset:0
    ds_read_b64_tr_b16 v[110:111], v6 offset:2048
    v_mfma_f32_16x16x32_bf16 v[32:35], v[60:63], v[64:67], v[32:35]
    ds_read_b64_tr_b16 v[112:113], v7 offset:0
    ds_read_b64_tr_b16 v[114:115], v7 offset:2048
    v_mfma_f32_16x16x32_bf16 v[36:39], v[60:63], v[68:71], v[36:39]
    s_waitcnt lgkmcnt(6)
    v_mfma_f32_16x16x32_bf16 v[24:27], v[84:87], v[92:95], v[24:27]
    v_mfma_f32_16x16x32_bf16 v[28:31], v[84:87], v[96:99], v[28:31]
    v_mfma_f32_16x16x32_bf16 v[32:35], v[88:91], v[92:95], v[32:35]
    v_mfma_f32_16x16x32_bf16 v[36:39], v[88:91], v[96:99], v[36:39]
    s_waitcnt lgkmcnt(0)
    v_mfma_f32_16x16x32_bf16 v[24:27], v[100:103], v[108:111], v[24:27]
    v_mfma_f32_16x16x32_bf16 v[28:31], v[100:103], v[112:115], v[28:31]
    v_mfma_f32_16x16x32_bf16 v[32:35], v[104:107], v[108:111], v[32:35]
    v_mfma_f32_16x16x32_bf16 v[36:39], v[104:107], v[112:115], v[36:39]
    s_nop 4
    v_cvt_pk_bf16_f32 v48, v24, v25
    v_cvt_pk_bf16_f32 v49, v26, v27
    v_cvt_pk_bf16_f32 v50, v28, v29
    v_cvt_pk_bf16_f32 v51, v30, v31
    v_cvt_pk_bf16_f32 v52, v32, v33
    v_cvt_pk_bf16_f32 v53, v34, v35
    v_cvt_pk_bf16_f32 v54, v36, v37
    v_cvt_pk_bf16_f32 v55, v38, v39
    s_barrier
    s_cmp_eq_u32 s52, 2
    s_cbranch_scc1 c_resxt
    ds_read_b64_tr_b16 v[120:121], v72 offset:0
    ds_read_b64_tr_b16 v[122:123], v73 offset:0
    ds_read_b64_tr_b16 v[124:125], v72 offset:4096
    ds_read_b64_tr_b16 v[126:127], v73 offset:4096
    s_branch c_havres
c_resxt:
    ds_read_b64 v[120:121], v79 offset:0
    ds_read_b64 v[122:123], v79 offset:1024
    ds_read_b64 v[124:125], v79 offset:32
    ds_read_b64 v[126:127], v79 offset:1056
c_havres:
    v_lshlrev_b32 v24, 16, v48
    v_and_b32 v25, s35, v48
    v_lshlrev_b32 v26, 16, v49
    v_and_b32 v27, s35, v49
    v_lshlrev_b32 v28, 16, v50
    v_and_b32 v29, s35, v50
    v_lshlrev_b32 v30, 16, v51
    v_and_b32 v31, s35, v51
    v_lshlrev_b32 v32, 16, v52
    v_and_b32 v33, s35, v52
    v_lshlrev_b32 v34, 16, v53
    v_and_b32 v35, s35, v53
    v_lshlrev_b32 v36, 16, v54
    v_and_b32 v37, s35, v54
    v_lshlrev_b32 v38, 16, v55
    v_and_b32 v39, s35, v55
    s_waitcnt lgkmcnt(0)
    v_lshlrev_b32 v56, 16, v120
    v_and_b32 v57, s35, v120
    v_lshlrev_b32 v58, 16, v121
    v_and_b32 v59, s35, v121
    v_lshlrev_b32 v60, 16, v122
    v_and_b32 v61, s35, v122
    v_lshlrev_b32 v62, 16, v123
    v_and_b32 v63, s35, v123
    v_lshlrev_b32 v64, 16, v124
    v_and_b32 v65, s35, v124
    v_lshlrev_b32 v66, 16, v125
    v_and_b32 v67, s35, v125
    v_lshlrev_b32 v68, 16, v126
    v_and_b32 v69, s35, v126
    v_lshlrev_b32 v70, 16, v127
    v_and_b32 v71, s35, v127
    v_pk_add_f32 v[24:25], v[24:25], v[56:57]
    v_pk_add_f32 v[26:27], v[26:27], v[58:59]
    v_pk_add_f32 v[28:29], v[28:29], v[60:61]
    v_pk_add_f32 v[30:31], v[30:31], v[62:63]
    v_pk_add_f32 v[32:33], v[32:33], v[64:65]
    v_pk_add_f32 v[34:35], v[34:35], v[66:67]
    v_pk_add_f32 v[36:37], v[36:37], v[68:69]
    v_pk_add_f32 v[38:39], v[38:39], v[70:71]
    v_cvt_pk_bf16_f32 v48, v24, v25
    v_cvt_pk_bf16_f32 v49, v26, v27
    ds_write_b64 v74, v[48:49] offset:8192
    v_cvt_pk_bf16_f32 v50, v28, v29
    v_cvt_pk_bf16_f32 v51, v30, v31
    ds_write_b64 v74, v[50:51] offset:9728
    v_cvt_pk_bf16_f32 v52, v32, v33
    v_cvt_pk_bf16_f32 v53, v34, v35
    ds_write_b64 v74, v[52:53] offset:8224
    v_cvt_pk_bf16_f32 v54, v36, v37
    v_cvt_pk_bf16_f32 v55, v38, v39
    ds_write_b64 v74, v[54:55] offset:9760
    v_mov_b32 v2, 126988
    v_mov_b32 v69, 1
    s_waitcnt lgkmcnt(0)
    s_mov_b64 exec, 1
    ds_add_u32 v2, v69
    s_mov_b64 exec, -1
    s_mov_b32 s34, 0
c_sy:
    ds_read_b32 v3, v2
    s_add_u32 s34, s34, 1
    s_waitcnt lgkmcnt(0)
    v_readfirstlane_b32 s33, v3
    s_cmp_gt_u32 s34, 32768
    s_cbranch_scc1 c_syd
    s_cmp_lt_u32 s33, 4
    s_cbranch_scc1 c_sy
c_syd:
    s_cmp_lt_u32 s27, 2
    s_cbranch_scc0 c_nostats
    ds_read_b64_tr_b16 v[40:41], v78 offset:8192
    ds_read_b64_tr_b16 v[42:43], v78 offset:8576
    ds_read_b64_tr_b16 v[44:45], v78 offset:11264
    ds_read_b64_tr_b16 v[46:47], v78 offset:11648
    ds_read_b64_tr_b16 v[48:49], v78 offset:14336
    ds_read_b64_tr_b16 v[50:51], v78 offset:14720
    ds_read_b64_tr_b16 v[52:53], v78 offset:17408
    ds_read_b64_tr_b16 v[54:55], v78 offset:17792
    ds_read_b128 v[24:27], v76 offset:8192
    ds_read_b128 v[28:31], v76 offset:14336
    s_mov_b32 s40, 0x00f0000f
    s_mov_b32 s41, 0xf0000f00
    s_waitcnt lgkmcnt(8)
    v_mfma_f32_16x16x32_bf16 v[56:59], v[40:43], v[80:83], 0
    v_mfma_f32_16x16x32_bf16 v[60:63], v[40:43], v[40:43], 0
    s_waitcnt lgkmcnt(6)
    v_mfma_f32_16x16x32_bf16 v[56:59], v[44:47], v[80:83], v[56:59]
    v_mfma_f32_16x16x32_bf16 v[60:63], v[44:47], v[44:47], v[60:63]
    s_waitcnt lgkmcnt(4)
    v_mfma_f32_16x16x32_bf16 v[56:59], v[48:51], v[80:83], v[56:59]
    v_mfma_f32_16x16x32_bf16 v[60:63], v[48:51], v[48:51], v[60:63]
    s_waitcnt lgkmcnt(2)
    v_mfma_f32_16x16x32_bf16 v[56:59], v[52:55], v[80:83], v[56:59]
    v_mfma_f32_16x16x32_bf16 v[60:63], v[52:55], v[52:55], v[60:63]
    s_nop 6
    v_cndmask_b32 v64, v56, v57, s[42:43]
    v_cndmask_b32 v65, v58, v59, s[42:43]
    v_cndmask_b32 v66, v60, v61, s[42:43]
    v_cndmask_b32 v67, v62, v63, s[42:43]
    v_cndmask_b32 v64, v64, v65, s[50:51]
    v_cndmask_b32 v65, v66, v67, s[50:51]
    s_mov_b64 exec, s[40:41]
    s_cmp_eq_u32 s79, 1
    s_cbranch_scc1 c_slocal
    buffer_store_dwordx2 v[64:65], v4, s[12:15], s37 offen sc1
    s_branch c_sdone
c_slocal:
    buffer_store_dwordx2 v[64:65], v4, s[12:15], s37 offen
c_sdone:
    s_mov_b32 s34, 0
    buffer_load_dwordx2 v[40:41], v4, s[12:15], s39 offen offset:0 sc1
    buffer_load_dwordx2 v[42:43], v4, s[12:15], s39 offen offset:256 sc1
    buffer_load_dwordx2 v[44:45], v4, s[12:15], s39 offen offset:512 sc1
    buffer_load_dwordx2 v[46:47], v4, s[12:15], s39 offen offset:768 sc1
    s_mov_b64 exec, -1
    s_waitcnt lgkmcnt(0)
    v_lshlrev_b32 v84, 16, v24
    v_and_b32 v85, s35, v24
    v_lshlrev_b32 v86, 16, v25
    v_and_b32 v87, s35, v25
    v_lshlrev_b32 v88, 16, v26
    v_and_b32 v89, s35, v26
    v_lshlrev_b32 v90, 16, v27
    v_and_b32 v91, s35, v27
    v_lshlrev_b32 v92, 16, v28
    v_and_b32 v93, s35, v28
    v_lshlrev_b32 v94, 16, v29
    v_and_b32 v95, s35, v29
    v_lshlrev_b32 v96, 16, v30
    v_and_b32 v97, s35, v30
    v_lshlrev_b32 v98, 16, v31
    v_and_b32 v99, s35, v31
    s_mov_b64 exec, s[40:41]
c_sp:
    s_waitcnt vmcnt(0)
    v_pk_add_f32 v[40:41], v[40:41], v[42:43]
    v_pk_add_f32 v[44:45], v[44:45], v[46:47]
    v_pk_add_f32 v[40:41], v[40:41], v[44:45]
    s_add_u32 s34, s34, 1
    v_cmp_u_f32 vcc, v40, v41
    s_cmp_gt_u32 s34, 32768
    s_cbranch_scc1 c_spd
    s_nop 2
    s_cbranch_vccz c_spd
    buffer_load_dwordx2 v[40:41], v4, s[12:15], s39 offen offset:0 sc1
    buffer_load_dwordx2 v[42:43], v4, s[12:15], s39 offen offset:256 sc1
    buffer_load_dwordx2 v[44:45], v4, s[12:15], s39 offen offset:512 sc1
    buffer_load_dwordx2 v[46:47], v4, s[12:15], s39 offen offset:768 sc1
    s_branch c_sp
c_spd:
    v_mul_f32 v40, 0x3b000000, v40
    v_mul_f32 v41, 0x3b000000, v41
    v_fma_f32 v41, -v40, v40, v41
    v_max_f32 v41, 0, v41
    v_cvt_pk_bf16_f32 v40, v40, v41
    v_and_b32 v41, s35, v40
    v_lshlrev_b32 v40, 16, v40
    v_add_f32 v41, 0x3727c5ac, v41
    v_cvt_pk_bf16_f32 v41, v41, v41
    v_lshlrev_b32 v41, 16, v41
    v_sqrt_f32 v41, v41
    s_nop 0
    v_cvt_pk_bf16_f32 v41, v41, v41
    v_lshlrev_b32 v41, 16, v41
    v_rcp_f32 v41, v41
    s_nop 0
    v_mul_f32 v40, v40, v41
    ds_write2_b32 v137, v40, v41 offset0:0 offset1:32
    s_mov_b64 exec, 1
    s_waitcnt lgkmcnt(0)
    ds_add_u32 v2, v69
    s_mov_b64 exec, -1
    s_branch c_norm
c_nostats:
    ds_read_b128 v[24:27], v76 offset:8192
    ds_read_b128 v[28:31], v76 offset:14336
    ds_read_b128 v[32:35], v76 offset:5120
    ds_read_b128 v[36:39], v76 offset:11264
    s_sub_u32 s34, s38, 0x20000
    s_waitcnt lgkmcnt(3)
    buffer_store_dwordx4 v[24:27], v75, s[12:15], s38 offen sc1
    s_waitcnt lgkmcnt(2)
    buffer_store_dwordx4 v[28:31], v77, s[12:15], s38 offen sc1
    s_waitcnt lgkmcnt(1)
    buffer_store_dwordx4 v[32:35], v75, s[12:15], s34 offen sc1
    s_waitcnt lgkmcnt(0)
    buffer_store_dwordx4 v[36:39], v77, s[12:15], s34 offen sc1
    v_lshlrev_b32 v84, 16, v24
    v_and_b32 v85, s35, v24
    v_lshlrev_b32 v86, 16, v25
    v_and_b32 v87, s35, v25
    v_lshlrev_b32 v88, 16, v26
    v_and_b32 v89, s35, v26
    v_lshlrev_b32 v90, 16, v27
    v_and_b32 v91, s35, v27
    v_lshlrev_b32 v92, 16, v28
    v_and_b32 v93, s35, v28
    v_lshlrev_b32 v94, 16, v29
    v_and_b32 v95, s35, v29
    v_lshlrev_b32 v96, 16, v30
    v_and_b32 v97, s35, v30
    v_lshlrev_b32 v98, 16, v31
    v_and_b32 v99, s35, v31
    s_mov_b64 exec, 1
    s_waitcnt vmcnt(0)
    ds_add_u32 v2, v69
    s_mov_b64 exec, -1
c_norm:
    s_nop 0
    s_cmp_eq_u32 s58, 0
    s_cbranch_scc1 c_arrd
    s_mov_b32 s34, 0
    s_lshl_b32 s33, s53, 2
    s_mov_b64 exec, 0xffffffff
c_arr:
    buffer_load_dword v119, v118, s[8:11], s33 offen sc1
    s_add_u32 s34, s34, 1
    s_waitcnt vmcnt(0)
    v_lshrrev_b32 v153, 4, v119
    v_and_b32 v153, 0x0f0f0f0f, v153
    v_and_b32 v154, 0x0f0f0f0f, v119
    v_add_u32 v154, v154, v153
    v_lshrrev_b32 v153, 16, v154
    v_add_u32 v154, v154, v153
    v_lshrrev_b32 v153, 8, v154
    v_add_u32 v154, v154, v153
    v_and_b32 v154, 0xff, v154
    v_cmp_ne_u32 vcc, 8, v154
    s_cmp_gt_u32 s34, 32768
    s_cbranch_scc1 c_arre
    s_nop 2
    s_cbranch_vccnz c_arr
c_arre:
    s_mov_b64 exec, -1
c_arrd:
    s_cmp_ge_u32 s24, 1536
    s_cselect_b32 s59, s52, 0
    s_cmp_eq_u32 s59, 2
    s_cbranch_scc0 c_noeu
    buffer_load_dwordx2 v[16:17], v150, s[12:15], s28 offen offset:0 sc1
    buffer_load_dwordx2 v[18:19], v150, s[12:15], s28 offen offset:2048 sc1
c_noeu:
    s_mov_b32 s34, 0
c_sz:
    ds_read_b32 v3, v2
    s_add_u32 s34, s34, 1
    s_waitcnt lgkmcnt(0)
    v_readfirstlane_b32 s33, v3
    s_cmp_gt_u32 s34, 32768
    s_cbranch_scc1 c_szd
    s_cmp_lt_u32 s33, 8
    s_cbranch_scc1 c_sz
c_szd:
    ds_read_b128 v[100:103], v139 offset:0
    ds_read_b128 v[104:107], v139 offset:16
    ds_read_b128 v[108:111], v139 offset:128
    ds_read_b128 v[112:115], v139 offset:144
    s_waitcnt lgkmcnt(1)
    v_pk_fma_f32 v[84:85], v[84:85], v[108:109], v[100:101] neg_lo:[0,0,1] neg_hi:[0,0,1]
    v_pk_fma_f32 v[86:87], v[86:87], v[110:111], v[102:103] neg_lo:[0,0,1] neg_hi:[0,0,1]
    v_pk_fma_f32 v[92:93], v[92:93], v[108:109], v[100:101] neg_lo:[0,0,1] neg_hi:[0,0,1]
    v_pk_fma_f32 v[94:95], v[94:95], v[110:111], v[102:103] neg_lo:[0,0,1] neg_hi:[0,0,1]
    s_waitcnt lgkmcnt(0)
    v_pk_fma_f32 v[88:89], v[88:89], v[112:113], v[104:105] neg_lo:[0,0,1] neg_hi:[0,0,1]
    v_pk_fma_f32 v[90:91], v[90:91], v[114:115], v[106:107] neg_lo:[0,0,1] neg_hi:[0,0,1]
    v_pk_fma_f32 v[96:97], v[96:97], v[112:113], v[104:105] neg_lo:[0,0,1] neg_hi:[0,0,1]
    v_pk_fma_f32 v[98:99], v[98:99], v[114:115], v[106:107] neg_lo:[0,0,1] neg_hi:[0,0,1]
    v_cvt_pk_bf16_f32 v40, v84, v85
    v_cvt_pk_bf16_f32 v41, v86, v87
    v_cvt_pk_bf16_f32 v42, v88, v89
    v_cvt_pk_bf16_f32 v43, v90, v91
    buffer_store_dwordx4 v[40:43], v75, s[12:15], s36 offen sc1
    v_cvt_pk_bf16_f32 v44, v92, v93
    v_cvt_pk_bf16_f32 v45, v94, v95
    v_cvt_pk_bf16_f32 v46, v96, v97
    v_cvt_pk_bf16_f32 v47, v98, v99
    buffer_store_dwordx4 v[44:47], v77, s[12:15], s36 offen sc1
    s_setprio 2
    s_cmp_eq_u32 s52, 2
    s_cbranch_scc1 c_nopre
    v_lshrrev_b32 v6, 5, v1
    v_mul_u32_u24 v6, 6144, v6
    v_bfe_u32 v8, v1, 2, 3
    v_lshl_add_u32 v6, v8, 7, v6
    v_bfe_u32 v8, v1, 3, 2
    v_xor_b32 v8, s27, v8
    v_lshl_add_u32 v6, v8, 5, v6
    v_and_b32 v8, 3, v1
    v_lshl_add_u32 v6, v8, 3, v6
    v_add_u32 v6, 10240, v6
    v_add_u32 v7, 69632, v6
    v_and_b32 v2, 1, v12
    v_lshl_add_u32 v3, v13, 2, v2
    v_cmp_eq_u32 s[42:43], 1, v2
    v_cmp_le_u32 s[44:45], v3, v12
    v_add_u32 v3, 2, v3
    v_cmp_le_u32 s[46:47], v3, v12
    s_cmp_eq_u32 s24, 0
    s_cselect_b64 s[48:49], -1, 0
    v_mov_b32 v156, v128
    v_mov_b32 v157, v129
    v_mov_b32 v158, v130
    v_mov_b32 v159, v131
    v_mov_b32 v160, v132
    v_mov_b32 v161, v133
    v_mov_b32 v162, v134
    v_mov_b32 v163, v135
    v_mov_b32 v164, v136
    v_lshrrev_b32 v2, 5, v1
    v_lshlrev_b32 v2, 4, v2
    v_bfe_u32 v3, v1, 2, 3
    v_add_u32 v2, v2, v3
    v_and_b32 v3, 3, v1
    v_lshlrev_b32 v3, 3, v3
    v_lshl_add_u32 v147, v2, 5, v3
    v_add_u32 v147, 0x2000, v147
    v_add_u32 v166, 69632, v147
    v_lshl_add_u32 v8, v2, 7, v3
    v_bfe_u32 v3, v1, 3, 2
    v_lshl_add_u32 v8, v3, 5, v8
    v_xor_b32 v9, 32, v8
    v_xor_b32 v10, 64, v8
    v_xor_b32 v11, 96, v8
    v_add_u32 v14, 69632, v8
    v_add_u32 v15, 69632, v9
    v_add_u32 v148, 69632, v10
    v_add_u32 v149, 69632, v11
c_nopre:
    s_cmp_eq_u32 s59, 2
    s_cbranch_scc1 c_noeu2
    s_waitcnt vmcnt(0)
    buffer_load_dwordx2 v[16:17], v150, s[12:15], s28 offen offset:0 sc1
    buffer_load_dwordx2 v[18:19], v150, s[12:15], s28 offen offset:2048 sc1
c_noeu2:
    v_mov_b32 v2, v151
    v_mov_b32 v3, v152
    v_mul_u32_u24 v129, 5120, v3
    v_lshl_add_u32 v129, v2, 3, v129
    v_add_u32 v129, 150528, v129
    v_lshrrev_b32 v130, 6, v2
    v_mul_u32_u24 v130, 1280, v130
    v_and_b32 v131, 3, v2
    v_mul_u32_u24 v131, 320, v131
    v_add_u32 v130, v130, v131
    v_bfe_u32 v131, v2, 2, 4
    v_lshl_add_u32 v130, v131, 4, v130
    v_mul_u32_u24 v131, 20512, v3
    v_add_u32 v130, v130, v131
    v_add_u32 v130, 69632, v130
    v_cmp_eq_u32 s[36:37], 1, v3
    s_lshl_b32 s33, s76, 16
    s_and_b32 s34, s76, 0xffff0000
    v_mov_b32 v132, s33
    v_mov_b32 v131, s34
    v_cndmask_b32 v132, v132, v131, s[36:37]
    s_cmp_eq_u32 s52, 2
    s_cbranch_scc1 c_o2
    s_add_u32 s4, s66, 0x00800000
    s_addc_u32 s5, s67, 0
    s_mov_b32 s6, 0x00280000
    s_mov_b32 s7, 0x00020000
    v_lshrrev_b32 v131, 5, v0
    v_lshlrev_b32 v131, 14, v131
    v_lshl_add_u32 v131, v3, 5, v131
    v_bfe_u32 v4, v0, 2, 1
    v_lshl_add_u32 v131, v4, 4, v131
    v_and_b32 v4, 15, v2
    v_lshlrev_b32 v4, 3, v4
    v_lshl_add_u32 v4, v3, 7, v4
    v_lshrrev_b32 v2, 4, v2
    v_lshl_add_u32 v4, v2, 16, v4
    s_lshl_b32 s38, s77, 8
    s_lshl_b32 s40, s77, 6
    s_add_u32 s40, s40, 2097152
    s_mov_b32 s50, 0x55000000
    s_mov_b32 s51, 0x55000000
    s_mov_b32 s56, 0x55555555
    s_mov_b32 s57, 0x55555555
    s_branch c_o3
c_o2:
    s_mov_b32 s4, s74
    s_mov_b32 s5, s75
    s_mov_b32 s6, 0x00200000
    s_mov_b32 s7, 0x00020000
    v_lshlrev_b32 v4, 12, v2
    v_lshl_add_u32 v4, v3, 11, v4
    s_lshl_b32 s38, s77, 2
    v_mov_b32 v133, 0x05040100
    v_mov_b32 v134, 0x01000504
    v_cndmask_b32 v133, v133, v134, s[36:37]
    v_add_u32 v134, 0x02020202, v133
c_o3:
    s_mov_b32 s34, 0
    s_waitcnt vmcnt(2)
    s_cmp_eq_u32 s59, 2
    s_cbranch_scc1 c_noeu3
    s_waitcnt vmcnt(0)
c_noeu3:
c_u0:
    v_cmp_eq_u32 vcc, -1, v16
    s_add_u32 s34, s34, 1
    s_cmp_gt_u32 s34, 32768
    s_cbranch_scc1 c_u0_ok
    s_nop 1
    s_and_b64 exec, exec, vcc
    s_cbranch_scc0 c_u0_ok
    buffer_load_dwordx2 v[16:17], v150, s[12:15], s28 offen offset:0 sc1
    s_waitcnt vmcnt(0)
    s_branch c_u0
c_u0_ok:
    s_mov_b64 exec, -1
    ds_write_b64 v129, v[16:17] offset:0
    buffer_load_dwordx2 v[24:25], v150, s[12:15], s30 offen offset:0 sc1
    s_waitcnt lgkmcnt(0)
    s_barrier
c_u1:
    v_cmp_eq_u32 vcc, -1, v18
    s_add_u32 s34, s34, 1
    s_cmp_gt_u32 s34, 32768
    s_cbranch_scc1 c_u1_ok
    s_nop 1
    s_and_b64 exec, exec, vcc
    s_cbranch_scc0 c_u1_ok
    buffer_load_dwordx2 v[18:19], v150, s[12:15], s28 offen offset:2048 sc1
    s_waitcnt vmcnt(0)
    s_branch c_u1
c_u1_ok:
    s_mov_b64 exec, -1
    ds_write_b64 v129, v[18:19] offset:1024
    buffer_load_dwordx2 v[26:27], v150, s[12:15], s30 offen offset:2048 sc1
    buffer_load_dwordx2 v[20:21], v150, s[12:15], s29 offen offset:0 sc1
    s_waitcnt lgkmcnt(0)
    s_barrier
    ds_read_b128 v[32:35], v130 offset:0
    ds_read_b128 v[36:39], v130 offset:5120
    ds_read_b128 v[40:43], v130 offset:10240
    ds_read_b128 v[44:47], v130 offset:15360
    s_waitcnt vmcnt(0)
c_u2:
    v_cmp_eq_u32 vcc, -1, v20
    s_add_u32 s34, s34, 1
    s_cmp_gt_u32 s34, 32768
    s_cbranch_scc1 c_u2_ok
    s_nop 1
    s_and_b64 exec, exec, vcc
    s_cbranch_scc0 c_u2_ok
    buffer_load_dwordx2 v[20:21], v150, s[12:15], s29 offen offset:0 sc1
    s_waitcnt vmcnt(0)
    s_branch c_u2
c_u2_ok:
    s_mov_b64 exec, -1
    ds_write_b64 v129, v[20:21] offset:2048
    buffer_load_dwordx2 v[28:29], v150, s[12:15], s31 offen offset:0 sc1
    buffer_load_dwordx2 v[22:23], v150, s[12:15], s29 offen offset:2048 sc1
    v_lshlrev_b32 v48, 16, v24
    v_and_b32 v49, s35, v24
    v_lshlrev_b32 v52, 16, v16
    v_and_b32 v53, s35, v16
    v_lshlrev_b32 v50, 16, v25
    v_and_b32 v51, s35, v25
    v_lshlrev_b32 v54, 16, v17
    v_and_b32 v55, s35, v17
    v_fma_f32 v48, v52, v132, v48
    v_fma_f32 v49, v53, v132, v49
    v_fma_f32 v50, v54, v132, v50
    v_fma_f32 v51, v55, v132, v51
    s_waitcnt lgkmcnt(3)
    v_add_f32 v32, v32, v36
    v_add_f32 v33, v33, v37
    v_add_f32 v34, v34, v38
    v_add_f32 v35, v35, v39
    s_waitcnt lgkmcnt(1)
    v_add_f32 v40, v40, v44
    v_add_f32 v41, v41, v45
    v_add_f32 v42, v42, v46
    v_add_f32 v43, v43, v47
    v_add_f32 v48, v48, v32
    v_add_f32 v49, v49, v33
    v_add_f32 v50, v50, v34
    v_add_f32 v51, v51, v35
    v_add_f32 v48, v48, v40
    v_add_f32 v49, v49, v41
    v_add_f32 v50, v50, v42
    v_add_f32 v51, v51, v43
    v_cvt_pk_bf16_f32 v56, v48, v49
    v_cvt_pk_bf16_f32 v57, v50, v51
    s_cmp_eq_u32 s52, 2
    s_cbranch_scc1 c_st2_0
    v_mov_b32_dpp v58, v56 quad_perm:[1,1,3,3] row_mask:0xf bank_mask:0xf
    v_mov_b32_dpp v59, v57 quad_perm:[1,1,3,3] row_mask:0xf bank_mask:0xf
    s_add_u32 s33, s40, 0
    s_mov_b64 exec, s[50:51]
    buffer_store_dwordx4 v[56:59], v131, s[4:7], s33 offen sc1
    s_mov_b64 exec, s[56:57]
    s_add_u32 s33, s38, 0
    buffer_store_dwordx4 v[56:59], v4, s[4:7], s33 offen sc1
    s_mov_b64 exec, -1
    s_branch c_st3_0
c_st2_0:
    v_cndmask_b32 v58, v57, v56, s[36:37]
    v_cndmask_b32 v56, v56, v57, s[36:37]
    s_nop 0
    v_mov_b32_dpp v59, v58 quad_perm:[2,3,0,1] row_mask:0xf bank_mask:0xf
    s_add_u32 s33, s38, 0
    v_perm_b32 v57, v59, v56, v134
    v_perm_b32 v56, v59, v56, v133
    buffer_store_dword v56, v4, s[4:7], s33 offen offset:0
    buffer_store_dword v57, v4, s[4:7], s33 offen offset:1024
c_st3_0:
    s_nop 0
    s_waitcnt lgkmcnt(0)
    s_barrier
    ds_read_b128 v[32:35], v130 offset:2560
    ds_read_b128 v[36:39], v130 offset:7680
    ds_read_b128 v[40:43], v130 offset:12800
    ds_read_b128 v[44:47], v130 offset:17920
    s_waitcnt vmcnt(2)
c_u3:
    v_cmp_eq_u32 vcc, -1, v22
    s_add_u32 s34, s34, 1
    s_cmp_gt_u32 s34, 32768
    s_cbranch_scc1 c_u3_ok
    s_nop 1
    s_and_b64 exec, exec, vcc
    s_cbranch_scc0 c_u3_ok
    buffer_load_dwordx2 v[22:23], v150, s[12:15], s29 offen offset:2048 sc1
    s_waitcnt vmcnt(0)
    s_branch c_u3
c_u3_ok:
    s_mov_b64 exec, -1
    ds_write_b64 v129, v[22:23] offset:3072
    buffer_load_dwordx2 v[30:31], v150, s[12:15], s31 offen offset:2048 sc1
    v_lshlrev_b32 v48, 16, v26
    v_and_b32 v49, s35, v26
    v_lshlrev_b32 v52, 16, v18
    v_and_b32 v53, s35, v18
    v_lshlrev_b32 v50, 16, v27
    v_and_b32 v51, s35, v27
    v_lshlrev_b32 v54, 16, v19
    v_and_b32 v55, s35, v19
    v_fma_f32 v48, v52, v132, v48
    v_fma_f32 v49, v53, v132, v49
    v_fma_f32 v50, v54, v132, v50
    v_fma_f32 v51, v55, v132, v51
    s_waitcnt lgkmcnt(3)
    v_add_f32 v32, v32, v36
    v_add_f32 v33, v33, v37
    v_add_f32 v34, v34, v38
    v_add_f32 v35, v35, v39
    s_waitcnt lgkmcnt(1)
    v_add_f32 v40, v40, v44
    v_add_f32 v41, v41, v45
    v_add_f32 v42, v42, v46
    v_add_f32 v43, v43, v47
    v_add_f32 v48, v48, v32
    v_add_f32 v49, v49, v33
    v_add_f32 v50, v50, v34
    v_add_f32 v51, v51, v35
    v_add_f32 v48, v48, v40
    v_add_f32 v49, v49, v41
    v_add_f32 v50, v50, v42
    v_add_f32 v51, v51, v43
    v_cvt_pk_bf16_f32 v60, v48, v49
    v_cvt_pk_bf16_f32 v61, v50, v51
    s_cmp_eq_u32 s52, 2
    s_cbranch_scc1 c_st2_1
    v_mov_b32_dpp v62, v60 quad_perm:[1,1,3,3] row_mask:0xf bank_mask:0xf
    v_mov_b32_dpp v63, v61 quad_perm:[1,1,3,3] row_mask:0xf bank_mask:0xf
    s_add_u32 s33, s40, 131072
    s_mov_b64 exec, s[50:51]
    buffer_store_dwordx4 v[60:63], v131, s[4:7], s33 offen sc1
    s_mov_b64 exec, s[56:57]
    s_add_u32 s33, s38, 524288
    buffer_store_dwordx4 v[60:63], v4, s[4:7], s33 offen sc1
    s_mov_b64 exec, -1
    s_branch c_st3_1
c_st2_1:
    v_cndmask_b32 v62, v61, v60, s[36:37]
    v_cndmask_b32 v60, v60, v61, s[36:37]
    s_nop 0
    v_mov_b32_dpp v63, v62 quad_perm:[2,3,0,1] row_mask:0xf bank_mask:0xf
    s_add_u32 s33, s38, 524288
    v_perm_b32 v61, v63, v60, v134
    v_perm_b32 v60, v63, v60, v133
    buffer_store_dword v60, v4, s[4:7], s33 offen offset:0
    buffer_store_dword v61, v4, s[4:7], s33 offen offset:1024
c_st3_1:
    s_nop 0
    s_waitcnt lgkmcnt(0)
    s_barrier
    ds_read_b128 v[32:35], v130 offset:0
    ds_read_b128 v[36:39], v130 offset:5120
    ds_read_b128 v[40:43], v130 offset:10240
    ds_read_b128 v[44:47], v130 offset:15360
    v_lshlrev_b32 v48, 16, v28
    v_and_b32 v49, s35, v28
    v_lshlrev_b32 v52, 16, v20
    v_and_b32 v53, s35, v20
    v_lshlrev_b32 v50, 16, v29
    v_and_b32 v51, s35, v29
    v_lshlrev_b32 v54, 16, v21
    v_and_b32 v55, s35, v21
    v_fma_f32 v48, v52, v132, v48
    v_fma_f32 v49, v53, v132, v49
    v_fma_f32 v50, v54, v132, v50
    v_fma_f32 v51, v55, v132, v51
    s_waitcnt lgkmcnt(2)
    v_add_f32 v32, v32, v36
    v_add_f32 v33, v33, v37
    v_add_f32 v34, v34, v38
    v_add_f32 v35, v35, v39
    s_waitcnt lgkmcnt(0)
    v_add_f32 v40, v40, v44
    v_add_f32 v41, v41, v45
    v_add_f32 v42, v42, v46
    v_add_f32 v43, v43, v47
    v_add_f32 v48, v48, v32
    v_add_f32 v49, v49, v33
    v_add_f32 v50, v50, v34
    v_add_f32 v51, v51, v35
    v_add_f32 v48, v48, v40
    v_add_f32 v49, v49, v41
    v_add_f32 v50, v50, v42
    v_add_f32 v51, v51, v43
    v_cvt_pk_bf16_f32 v56, v48, v49
    v_cvt_pk_bf16_f32 v57, v50, v51
    s_cmp_eq_u32 s52, 2
    s_cbranch_scc1 c_st2_2
    v_mov_b32_dpp v58, v56 quad_perm:[1,1,3,3] row_mask:0xf bank_mask:0xf
    v_mov_b32_dpp v59, v57 quad_perm:[1,1,3,3] row_mask:0xf bank_mask:0xf
    s_add_u32 s33, s40, 262144
    s_mov_b64 exec, s[50:51]
    buffer_store_dwordx4 v[56:59], v131, s[4:7], s33 offen sc1
    s_mov_b64 exec, s[56:57]
    s_add_u32 s33, s38, 1048576
    buffer_store_dwordx4 v[56:59], v4, s[4:7], s33 offen sc1
    s_mov_b64 exec, -1
    s_branch c_st3_2
c_st2_2:
    v_cndmask_b32 v58, v57, v56, s[36:37]
    v_cndmask_b32 v56, v56, v57, s[36:37]
    s_nop 0
    v_mov_b32_dpp v59, v58 quad_perm:[2,3,0,1] row_mask:0xf bank_mask:0xf
    s_add_u32 s33, s38, 1048576
    v_perm_b32 v57, v59, v56, v134
    v_perm_b32 v56, v59, v56, v133
    buffer_store_dword v56, v4, s[4:7], s33 offen offset:0
    buffer_store_dword v57, v4, s[4:7], s33 offen offset:1024
c_st3_2:
    s_nop 0
    s_barrier
    ds_read_b128 v[32:35], v130 offset:2560
    ds_read_b128 v[36:39], v130 offset:7680
    ds_read_b128 v[40:43], v130 offset:12800
    ds_read_b128 v[44:47], v130 offset:17920
    s_waitcnt vmcnt(4)
    v_lshlrev_b32 v48, 16, v30
    v_and_b32 v49, s35, v30
    v_lshlrev_b32 v52, 16, v22
    v_and_b32 v53, s35, v22
    v_lshlrev_b32 v50, 16, v31
    v_and_b32 v51, s35, v31
    v_lshlrev_b32 v54, 16, v23
    v_and_b32 v55, s35, v23
    v_fma_f32 v48, v52, v132, v48
    v_fma_f32 v49, v53, v132, v49
    v_fma_f32 v50, v54, v132, v50
    v_fma_f32 v51, v55, v132, v51
    s_waitcnt lgkmcnt(2)
    v_add_f32 v32, v32, v36
    v_add_f32 v33, v33, v37
    v_add_f32 v34, v34, v38
    v_add_f32 v35, v35, v39
    s_waitcnt lgkmcnt(0)
    v_add_f32 v40, v40, v44
    v_add_f32 v41, v41, v45
    v_add_f32 v42, v42, v46
    v_add_f32 v43, v43, v47
    v_add_f32 v48, v48, v32
    v_add_f32 v49, v49, v33
    v_add_f32 v50, v50, v34
    v_add_f32 v51, v51, v35
    v_add_f32 v48, v48, v40
    v_add_f32 v49, v49, v41
    v_add_f32 v50, v50, v42
    v_add_f32 v51, v51, v43
    v_cvt_pk_bf16_f32 v60, v48, v49
    v_cvt_pk_bf16_f32 v61, v50, v51
    s_cmp_eq_u32 s52, 2
    s_cbranch_scc1 c_st2_3
    v_mov_b32_dpp v62, v60 quad_perm:[1,1,3,3] row_mask:0xf bank_mask:0xf
    v_mov_b32_dpp v63, v61 quad_perm:[1,1,3,3] row_mask:0xf bank_mask:0xf
    s_add_u32 s33, s40, 393216
    s_mov_b64 exec, s[50:51]
    buffer_store_dwordx4 v[60:63], v131, s[4:7], s33 offen sc1
    s_mov_b64 exec, s[56:57]
    s_add_u32 s33, s38, 1572864
    buffer_store_dwordx4 v[60:63], v4, s[4:7], s33 offen sc1
    s_mov_b64 exec, -1
    s_branch c_st3_3
c_st2_3:
    v_cndmask_b32 v62, v61, v60, s[36:37]
    v_cndmask_b32 v60, v60, v61, s[36:37]
    s_nop 0
    v_mov_b32_dpp v63, v62 quad_perm:[2,3,0,1] row_mask:0xf bank_mask:0xf
    s_add_u32 s33, s38, 1572864
    v_perm_b32 v61, v63, v60, v134
    v_perm_b32 v60, v63, v60, v133
    buffer_store_dword v60, v4, s[4:7], s33 offen offset:0
    buffer_store_dword v61, v4, s[4:7], s33 offen offset:1024
c_st3_3:
    s_nop 0
    s_cmp_eq_u32 s52, 2
    s_cbranch_scc1 c_end
    s_cmp_lt_u32 s24, 1024
    s_cbranch_scc1 c_nox
    s_waitcnt vmcnt(0)
    s_barrier
c_nox:
    s_add_u32 s55, s55, 4
    s_cmp_eq_u32 s27, 0
    s_cbranch_scc0 c_noarr2
    s_lshl_b32 s33, 1, s54
    v_mov_b32 v3, s33
    v_mov_b32 v2, 0
    s_mov_b64 exec, 1
    buffer_atomic_add v3, v2, s[8:11], s55 offen sc1
    s_mov_b64 exec, -1
c_noarr2:
    s_mov_b32 s52, 2
    s_setprio 0
    s_branch c_att_xt
c_end:
k_exit:
    s_endpgm
.p2align 7
.type kgen_tab,@object
kgen_tab:
    .short 13800, 9216, 9216, 9216, 9216, 9180, 9180, 9180, 9180, 0, 0, 0, 0, 0, 0, 0
    .short 9180, 9180, 9180, 9180, 9144, 9144, 9144, 9144, 9144, 0, 0, 0, 0, 0, 0, 0
    .short 9144, 9144, 9144, 9144, 9144, 9108, 9108, 9108, 9108, 0, 0, 0, 0, 0, 0, 0
    .short 9108, 9108, 9108, 9108, 9072, 9072, 9072, 9072, 9072, 0, 0, 0, 0, 0, 0, 0
    .short 9072, 9072, 9072, 9072, 9072, 9036, 9036, 9036, 9036, 0, 0, 0, 0, 0, 0, 0
    .short 9036, 9036, 9036, 9036, 9000, 9000, 9000, 9000, 9000, 0, 0, 0, 0, 0, 0, 0
    .short 9000, 9000, 9000, 9000, 9000, 8964, 8964, 8964, 8964, 0, 0, 0, 0, 0, 0, 0
    .short 8964, 8964, 8964, 8964, 8928, 8928, 8928, 8928, 8928, 0, 0, 0, 0, 0, 0, 0
    .short 8928, 8928, 8928, 8928, 8928, 8892, 8892, 8892, 8892, 0, 0, 0, 0, 0, 0, 0
    .short 8892, 8892, 8892, 8892, 8856, 8856, 8856, 8856, 8856, 0, 0, 0, 0, 0, 0, 0
    .short 8856, 8856, 8856, 8856, 8856, 8820, 8820, 8820, 8820, 0, 0, 0, 0, 0, 0, 0
    .short 8820, 8820, 8820, 8820, 8784, 8784, 8784, 8784, 8784, 0, 0, 0, 0, 0, 0, 0
    .short 8784, 8784, 8784, 8784, 8784, 8748, 8748, 8748, 8748, 0, 0, 0, 0, 0, 0, 0
    .short 8748, 8748, 8748, 8748, 8712, 8712, 8712, 8712, 8712, 0, 0, 0, 0, 0, 0, 0
    .short 8712, 8712, 8712, 8712, 8712, 8676, 8676, 8676, 8676, 0, 0, 0, 0, 0, 0, 0
    .short 8676, 8676, 8676, 8676, 8640, 8640, 8640, 8640, 8640, 0, 0, 0, 0, 0, 0, 0
    .short 8640, 8640, 8640, 8640, 8640, 8604, 8604, 8604, 8604, 0, 0, 0, 0, 0, 0, 0
    .short 8604, 8604, 8604, 8604, 8568, 8568, 8568, 8568, 8568, 0, 0, 0, 0, 0, 0, 0
    .short 8568, 8568, 8568, 8568, 8568, 8532, 8532, 8532, 8532, 0, 0, 0, 0, 0, 0, 0
    .short 8532, 8532, 8532, 8532, 8496, 8496, 8496, 8496, 8496, 0, 0, 0, 0, 0, 0, 0
    .short 8496, 8496, 8496, 8496, 8496, 8460, 8460, 8460, 8460, 0, 0, 0, 0, 0, 0, 0
    .short 8460, 8460, 8460, 8460, 8424, 8424, 8424, 8424, 8424, 0, 0, 0, 0, 0, 0, 0
    .short 8424, 8424, 8424, 8424, 8424, 8388, 8388, 8388, 8388, 0, 0, 0, 0, 0, 0, 0
    .short 8388, 8388, 8388, 8388, 8352, 8352, 8352, 8352, 8352, 0, 0, 0, 0, 0, 0, 0
    .short 8352, 8352, 8352, 8352, 8352, 8316, 8316, 8316, 8316, 0, 0, 0, 0, 0, 0, 0
    .short 8316, 8316, 8316, 8316, 8280, 8280, 8280, 8280, 8280, 0, 0, 0, 0, 0, 0, 0
    .short 8280, 8280, 8280, 8280, 8280, 8244, 8244, 8244, 8244, 0, 0, 0, 0, 0, 0, 0
    .short 8244, 8244, 8244, 8244, 8208, 8208, 8208, 8208, 8208, 0, 0, 0, 0, 0, 0, 0
    .short 8208, 8208, 8208, 8208, 8208, 8172, 8172, 8172, 8172, 0, 0, 0, 0, 0, 0, 0
    .short 8172, 8172, 8172, 8172, 8136, 8136, 8136, 8136, 8136, 0, 0, 0, 0, 0, 0, 0
    .short 8136, 8136, 8136, 8136, 8136, 8100, 8100, 8100, 8100, 0, 0, 0, 0, 0, 0, 0
    .short 8100, 8100, 8100, 8100, 8064, 8064, 8064, 8064, 8064, 0, 0, 0, 0, 0, 0, 0
    .short 8064, 8064, 8064, 8064, 8064, 8028, 8028, 8028, 8028, 0, 0, 0, 0, 0, 0, 0
    .short 8028, 8028, 8028, 8028, 7992, 7992, 7992, 7992, 7992, 0, 0, 0, 0, 0, 0, 0
    .short 7992, 7992, 7992, 7992, 7992, 7956, 7956, 7956, 7956, 0, 0, 0, 0, 0, 0, 0
    .short 7956, 7956, 7956, 7956, 7920, 7920, 7920, 7920, 7920, 0, 0, 0, 0, 0, 0, 0
    .short 7920, 7920, 7920, 7920, 7920, 7884, 7884, 7884, 7884, 0, 0, 0, 0, 0, 0, 0
    .short 7884, 7884, 7884, 7884, 7848, 7848, 7848, 7848, 7848, 0, 0, 0, 0, 0, 0, 0
    .short 7848, 7848, 7848, 7848, 7848, 7812, 7812, 7812, 7812, 0, 0, 0, 0, 0, 0, 0
    .short 7812, 7812, 7812, 7812, 7776, 7776, 7776, 7776, 7776, 0, 0, 0, 0, 0, 0, 0
    .short 7776, 7776, 7776, 7776, 7776, 7740, 7740, 7740, 7740, 0, 0, 0, 0, 0, 0, 0
    .short 7740, 7740, 7740, 7740, 7704, 7704, 7704, 7704, 7704, 0, 0, 0, 0, 0, 0, 0
    .short 7704, 7704, 7704, 7704, 7704, 7668, 7668, 7668, 7668, 0, 0, 0, 0, 0, 0, 0
    .short 7668, 7668, 7668, 7668, 7632, 7632, 7632, 7632, 7632, 0, 0, 0, 0, 0, 0, 0
    .short 7632, 7632, 7632, 7632, 7632, 7596, 7596, 7596, 7596, 0, 0, 0, 0, 0, 0, 0
    .short 7596, 7596, 7596, 7596, 7560, 7560, 7560, 7560, 7560, 0, 0, 0, 0, 0, 0, 0
    .short 7560, 7560, 7560, 7560, 7560, 7524, 7524, 7524, 7524, 0, 0, 0, 0, 0, 0, 0
    .short 7524, 7524, 7524, 7524, 7488, 7488, 7488, 7488, 7488, 0, 0, 0, 0, 0, 0, 0
    .short 7488, 7488, 7488, 7488, 7488, 7452, 7452, 7452, 7452, 0, 0, 0, 0, 0, 0, 0
    .short 7452, 7452, 7452, 7452, 7416, 7416, 7416, 7416, 7416, 0, 0, 0, 0, 0, 0, 0
    .short 7416, 7416, 7416, 7416, 7416, 7380, 7380, 7380, 7380, 0, 0, 0, 0, 0, 0, 0
    .short 7380, 7380, 7380, 7380, 7344, 7344, 7344, 7344, 7344, 0, 0, 0, 0, 0, 0, 0
    .short 7344, 7344, 7344, 7344, 7344, 7308, 7308, 7308, 7308, 0, 0, 0, 0, 0, 0, 0
    .short 7308, 7308, 7308, 7308, 7272, 7272, 7272, 7272, 7272, 0, 0, 0, 0, 0, 0, 0
    .short 7272, 7272, 7272, 7272, 7272, 7236, 7236, 7236, 7236, 0, 0, 0, 0, 0, 0, 0
    .short 7236, 7236, 7236, 7236, 7200, 7200, 7200, 7200, 7200, 0, 0, 0, 0, 0, 0, 0
    .short 7200, 7200, 7200, 7200, 7200, 7164, 7164, 7164, 7164, 0, 0, 0, 0, 0, 0, 0
    .short 7164, 7164, 7164, 7164, 7128, 7128, 7128, 7128, 7128, 0, 0, 0, 0, 0, 0, 0
    .short 7128, 7128, 7128, 7128, 7128, 7092, 7092, 7092, 7092, 0, 0, 0, 0, 0, 0, 0
    .short 7092, 7092, 7092, 7092, 7056, 7056, 7056, 7056, 7056, 0, 0, 0, 0, 0, 0, 0
    .short 7056, 7056, 7056, 7056, 7056, 7020, 7020, 7020, 7020, 0, 0, 0, 0, 0, 0, 0
    .short 7020, 7020, 7020, 7020, 6984, 6984, 6984, 6984, 6984, 0, 0, 0, 0, 0, 0, 0
    .short 6984, 6984, 6984, 6984, 6984, 6948, 6948, 6948, 6948, 0, 0, 0, 0, 0, 0, 0
    .short 6948, 6948, 6948, 6948, 6912, 6912, 6912, 6912, 6912, 0, 0, 0, 0, 0, 0, 0
    .short 6912, 6912, 6912, 6912, 6912, 6876, 6876, 6876, 6876, 0, 0, 0, 0, 0, 0, 0
    .short 6876, 6876, 6876, 6876, 6840, 6840, 6840, 6840, 6840, 0, 0, 0, 0, 0, 0, 0
    .short 6840, 6840, 6840, 6840, 6840, 6804, 6804, 6804, 6804, 0, 0, 0, 0, 0, 0, 0
    .short 6804, 6804, 6804, 6804, 6768, 6768, 6768, 6768, 6768, 0, 0, 0, 0, 0, 0, 0
    .short 6768, 6768, 6768, 6768, 6768, 6732, 6732, 6732, 6732, 0, 0, 0, 0, 0, 0, 0
    .short 6732, 6732, 6732, 6732, 6696, 6696, 6696, 6696, 6696, 0, 0, 0, 0, 0, 0, 0
    .short 6696, 6696, 6696, 6696, 6696, 6660, 6660, 6660, 6660, 0, 0, 0, 0, 0, 0, 0
    .short 6660, 6660, 6660, 6660, 6624, 6624, 6624, 6624, 6624, 0, 0, 0, 0, 0, 0, 0
    .short 6624, 6624, 6624, 6624, 6624, 6588, 6588, 6588, 6588, 0, 0, 0, 0, 0, 0, 0
    .short 6588, 6588, 6588, 6588, 6552, 6552, 6552, 6552, 6552, 0, 0, 0, 0, 0, 0, 0
    .short 6552, 6552, 6552, 6552, 6552, 6516, 6516, 6516, 6516, 0, 0, 0, 0, 0, 0, 0
    .short 6516, 6516, 6516, 6516, 6480, 6480, 6480, 6480, 6480, 0, 0, 0, 0, 0, 0, 0
    .short 6480, 6480, 6480, 6480, 6480, 6444, 6444, 6444, 6444, 0, 0, 0, 0, 0, 0, 0
    .short 6444, 6444, 6444, 6444, 6408, 6408, 6408, 6408, 6408, 0, 0, 0, 0, 0, 0, 0
    .short 6408, 6408, 6408, 6408, 6408, 6372, 6372, 6372, 6372, 0, 0, 0, 0, 0, 0, 0
    .short 6372, 6372, 6372, 6372, 6336, 6336, 6336, 6336, 6336, 0, 0, 0, 0, 0, 0, 0
    .short 6336, 6336, 6336, 6336, 6336, 6300, 6300, 6300, 6300, 0, 0, 0, 0, 0, 0, 0
    .short 6300, 6300, 6300, 6300, 6264, 6264, 6264, 6264, 6264, 0, 0, 0, 0, 0, 0, 0
    .short 6264, 6264, 6264, 6264, 6264, 6228, 6228, 6228, 6228, 0, 0, 0, 0, 0, 0, 0
    .short 6228, 6228, 6228, 6228, 6192, 6192, 6192, 6192, 6192, 0, 0, 0, 0, 0, 0, 0
    .short 6192, 6192, 6192, 6192, 6192, 6156, 6156, 6156, 6156, 0, 0, 0, 0, 0, 0, 0
    .short 6156, 6156, 6156, 6156, 6120, 6120, 6120, 6120, 6120, 0, 0, 0, 0, 0, 0, 0
    .short 6120, 6120, 6120, 6120, 6120, 6084, 6084, 6084, 6084, 0, 0, 0, 0, 0, 0, 0
    .short 6084, 6084, 6084, 6084, 6048, 6048, 6048, 6048, 6048, 0, 0, 0, 0, 0, 0, 0
    .short 6048, 6048, 6048, 6048, 6048, 6012, 6012, 6012, 6012, 0, 0, 0, 0, 0, 0, 0
    .short 6012, 6012, 6012, 6012, 5976, 5976, 5976, 5976, 5976, 0, 0, 0, 0, 0, 0, 0
    .short 5976, 5976, 5976, 5976, 5976, 5940, 5940, 5940, 5940, 0, 0, 0, 0, 0, 0, 0
    .short 5940, 5940, 5940, 5940, 5904, 5904, 5904, 5904, 5904, 0, 0, 0, 0, 0, 0, 0
    .short 5904, 5904, 5904, 5904, 5904, 5868, 5868, 5868, 5868, 0, 0, 0, 0, 0, 0, 0
    .short 5868, 5868, 5868, 5868, 5832, 5832, 5832, 5832, 5832, 0, 0, 0, 0, 0, 0, 0
    .short 5832, 5832, 5832, 5832, 5832, 5796, 5796, 5796, 5796, 0, 0, 0, 0, 0, 0, 0
    .short 5796, 5796, 5796, 5796, 5760, 5760, 5760, 5760, 5760, 0, 0, 0, 0, 0, 0, 0
    .short 5760, 5760, 5760, 5760, 5760, 5724, 5724, 5724, 5724, 0, 0, 0, 0, 0, 0, 0
    .short 5724, 5724, 5724, 5724, 5688, 5688, 5688, 5688, 5688, 0, 0, 0, 0, 0, 0, 0
    .short 5688, 5688, 5688, 5688, 5688, 5652, 5652, 5652, 5652, 0, 0, 0, 0, 0, 0, 0
    .short 5652, 5652, 5652, 5652, 5616, 5616, 5616, 5616, 5616, 0, 0, 0, 0, 0, 0, 0
    .short 5616, 5616, 5616, 5616, 5616, 5580, 5580, 5580, 5580, 0, 0, 0, 0, 0, 0, 0
    .short 5580, 5580, 5580, 5580, 5544, 5544, 5544, 5544, 5544, 0, 0, 0, 0, 0, 0, 0
    .short 5544, 5544, 5544, 5544, 5544, 5508, 5508, 5508, 5508, 0, 0, 0, 0, 0, 0, 0
    .short 5508, 5508, 5508, 5508, 5472, 5472, 5472, 5472, 5472, 0, 0, 0, 0, 0, 0, 0
    .short 5472, 5472, 5472, 5472, 5472, 5436, 5436, 5436, 5436, 0, 0, 0, 0, 0, 0, 0
    .short 5436, 5436, 5436, 5436, 5400, 5400, 5400, 5400, 5400, 0, 0, 0, 0, 0, 0, 0
    .short 5400, 5400, 5400, 5400, 5400, 5364, 5364, 5364, 5364, 0, 0, 0, 0, 0, 0, 0
    .short 5364, 5364, 5364, 5364, 5328, 5328, 5328, 5328, 5328, 0, 0, 0, 0, 0, 0, 0
    .short 5328, 5328, 5328, 5328, 5328, 5292, 5292, 5292, 5292, 0, 0, 0, 0, 0, 0, 0
    .short 5292, 5292, 5292, 5292, 5256, 5256, 5256, 5256, 5256, 0, 0, 0, 0, 0, 0, 0
    .short 5256, 5256, 5256, 5256, 5256, 5220, 5220, 5220, 5220, 0, 0, 0, 0, 0, 0, 0
    .short 5220, 5220, 5220, 5220, 5184, 5184, 5184, 5184, 5184, 0, 0, 0, 0, 0, 0, 0
    .short 5184, 5184, 5184, 5184, 5184, 5148, 5148, 5148, 5148, 0, 0, 0, 0, 0, 0, 0
    .short 5148, 5148, 5148, 5148, 5112, 5112, 5112, 5112, 5112, 0, 0, 0, 0, 0, 0, 0
    .short 5112, 5112, 5112, 5112, 5112, 5076, 5076, 5076, 5076, 0, 0, 0, 0, 0, 0, 0
    .short 5076, 5076, 5076, 5076, 5040, 5040, 5040, 5040, 5040, 0, 0, 0, 0, 0, 0, 0
    .short 5040, 5040, 5040, 5040, 5040, 5004, 5004, 5004, 5004, 0, 0, 0, 0, 0, 0, 0
    .short 5004, 5004, 5004, 5004, 4968, 4968, 4968, 4968, 4968, 0, 0, 0, 0, 0, 0, 0
    .short 4968, 4968, 4968, 4968, 4968, 4932, 4932, 4932, 4932, 0, 0, 0, 0, 0, 0, 0
    .short 4932, 4932, 4932, 4932, 4896, 4896, 4896, 4896, 4896, 0, 0, 0, 0, 0, 0, 0
    .short 4896, 4896, 4896, 4896, 4896, 4860, 4860, 4860, 4860, 0, 0, 0, 0, 0, 0, 0
    .short 4860, 4860, 4860, 4860, 4824, 4824, 4824, 4824, 4824, 0, 0, 0, 0, 0, 0, 0
    .short 4824, 4824, 4824, 4824, 4824, 4788, 4788, 4788, 4788, 0, 0, 0, 0, 0, 0, 0
    .short 4788, 4788, 4788, 4788, 4752, 4752, 4752, 4752, 4752, 0, 0, 0, 0, 0, 0, 0
    .short 4752, 4752, 4752, 4752, 4752, 4716, 4716, 4716, 4716, 0, 0, 0, 0, 0, 0, 0
    .short 4716, 4716, 4716, 4716, 4680, 4680, 4680, 4680, 4680, 0, 0, 0, 0, 0, 0, 0
    .short 4680, 4680, 4680, 4680, 4680, 4644, 4644, 4644, 4644, 0, 0, 0, 0, 0, 0, 0
    .short 4644, 4644, 4644, 4644, 4608, 4608, 4608, 4608, 4608, 0, 0, 0, 0, 0, 0, 0
    .short 4608, 4608, 4608, 4588, 4588, 4588, 4572, 4572, 4572, 0, 0, 0, 0, 0, 0, 0
    .short 4572, 4572, 4572, 4552, 4552, 4552, 4536, 4536, 4536, 0, 0, 0, 0, 0, 0, 0
    .short 4536, 4536, 4536, 4516, 4516, 4516, 4500, 4500, 4500, 0, 0, 0, 0, 0, 0, 0
    .short 4500, 4500, 4500, 4480, 4480, 4480, 4464, 4464, 4464, 0, 0, 0, 0, 0, 0, 0
    .short 4464, 4464, 4464, 4444, 4444, 4444, 4428, 4428, 4428, 0, 0, 0, 0, 0, 0, 0
    .short 4428, 4428, 4428, 4408, 4408, 4408, 4392, 4392, 4392, 0, 0, 0, 0, 0, 0, 0
    .short 4392, 4392, 4392, 4372, 4372, 4372, 4356, 4356, 4356, 0, 0, 0, 0, 0, 0, 0
    .short 4356, 4356, 4356, 4336, 4336, 4336, 4320, 4320, 4320, 0, 0, 0, 0, 0, 0, 0
    .short 4320, 4320, 4320, 4300, 4300, 4300, 4284, 4284, 4284, 0, 0, 0, 0, 0, 0, 0
    .short 4284, 4284, 4284, 4264, 4264, 4264, 4248, 4248, 4248, 0, 0, 0, 0, 0, 0, 0
    .short 4248, 4248, 4248, 4228, 4228, 4228, 4212, 4212, 4212, 0, 0, 0, 0, 0, 0, 0
    .short 4212, 4212, 4212, 4192, 4192, 4192, 4176, 4176, 4176, 0, 0, 0, 0, 0, 0, 0
    .short 4176, 4176, 4176, 4156, 4156, 4156, 4140, 4140, 4140, 0, 0, 0, 0, 0, 0, 0
    .short 4140, 4140, 4140, 4120, 4120, 4120, 4104, 4104, 4104, 0, 0, 0, 0, 0, 0, 0
    .short 4104, 4104, 4104, 4084, 4084, 4084, 4068, 4068, 4068, 0, 0, 0, 0, 0, 0, 0
    .short 4068, 4068, 4068, 4048, 4048, 4048, 4032, 4032, 4032, 0, 0, 0, 0, 0, 0, 0
    .short 4032, 4032, 4032, 4012, 4012, 4012, 3996, 3996, 3996, 0, 0, 0, 0, 0, 0, 0
    .short 3996, 3996, 3996, 3976, 3976, 3976, 3960, 3960, 3960, 0, 0, 0, 0, 0, 0, 0
    .short 3960, 3960, 3960, 3940, 3940, 3940, 3924, 3924, 3924, 0, 0, 0, 0, 0, 0, 0
    .short 3924, 3924, 3924, 3904, 3904, 3904, 3888, 3888, 3888, 0, 0, 0, 0, 0, 0, 0
    .short 3888, 3888, 3888, 3868, 3868, 3868, 3852, 3852, 3852, 0, 0, 0, 0, 0, 0, 0
    .short 3852, 3852, 3852, 3832, 3832, 3832, 3816, 3816, 3816, 0, 0, 0, 0, 0, 0, 0
    .short 3816, 3816, 3816, 3796, 3796, 3796, 3780, 3780, 3780, 0, 0, 0, 0, 0, 0, 0
    .short 3780, 3780, 3780, 3760, 3760, 3760, 3744, 3744, 3744, 0, 0, 0, 0, 0, 0, 0
    .short 3744, 3744, 3744, 3724, 3724, 3724, 3708, 3708, 3708, 0, 0, 0, 0, 0, 0, 0
    .short 3708, 3708, 3708, 3688, 3688, 3688, 3672, 3672, 3672, 0, 0, 0, 0, 0, 0, 0
    .short 3672, 3672, 3672, 3652, 3652, 3652, 3636, 3636, 3636, 0, 0, 0, 0, 0, 0, 0
    .short 3636, 3636, 3636, 3616, 3616, 3616, 3600, 3600, 3600, 0, 0, 0, 0, 0, 0, 0
    .short 3600, 3600, 3600, 3580, 3580, 3580, 3564, 3564, 3564, 0, 0, 0, 0, 0, 0, 0
    .short 3564, 3564, 3564, 3544, 3544, 3544, 3528, 3528, 3528, 0, 0, 0, 0, 0, 0, 0
    .short 3528, 3528, 3528, 3508, 3508, 3508, 3492, 3492, 3492, 0, 0, 0, 0, 0, 0, 0
    .short 3492, 3492, 3492, 3472, 3472, 3472, 3456, 3456, 3456, 0, 0, 0, 0, 0, 0, 0
    .short 3456, 3456, 3456, 3436, 3436, 3436, 3420, 3420, 3420, 0, 0, 0, 0, 0, 0, 0
    .short 3420, 3420, 3420, 3400, 3400, 3400, 3384, 3384, 3384, 0, 0, 0, 0, 0, 0, 0
    .short 3384, 3384, 3384, 3364, 3364, 3364, 3348, 3348, 3348, 0, 0, 0, 0, 0, 0, 0
    .short 3348, 3348, 3348, 3328, 3328, 3328, 3312, 3312, 3312, 0, 0, 0, 0, 0, 0, 0
    .short 3312, 3312, 3312, 3292, 3292, 3292, 3276, 3276, 3276, 0, 0, 0, 0, 0, 0, 0
    .short 3276, 3276, 3276, 3256, 3256, 3256, 3240, 3240, 3240, 0, 0, 0, 0, 0, 0, 0
    .short 3240, 3240, 3240, 3220, 3220, 3220, 3204, 3204, 3204, 0, 0, 0, 0, 0, 0, 0
    .short 3204, 3204, 3204, 3184, 3184, 3184, 3168, 3168, 3168, 0, 0, 0, 0, 0, 0, 0
    .short 3168, 3168, 3168, 3148, 3148, 3148, 3132, 3132, 3132, 0, 0, 0, 0, 0, 0, 0
    .short 3132, 3132, 3132, 3112, 3112, 3112, 3096, 3096, 3096, 0, 0, 0, 0, 0, 0, 0
    .short 3096, 3096, 3096, 3076, 3076, 3076, 3060, 3060, 3060, 0, 0, 0, 0, 0, 0, 0
    .short 3060, 3060, 3060, 3040, 3040, 3040, 3024, 3024, 3024, 0, 0, 0, 0, 0, 0, 0
    .short 3024, 3024, 3024, 3004, 3004, 3004, 2988, 2988, 2988, 0, 0, 0, 0, 0, 0, 0
    .short 2988, 2988, 2988, 2968, 2968, 2968, 2952, 2952, 2952, 0, 0, 0, 0, 0, 0, 0
    .short 2952, 2952, 2952, 2932, 2932, 2932, 2916, 2916, 2916, 0, 0, 0, 0, 0, 0, 0
    .short 2916, 2916, 2916, 2896, 2896, 2896, 2880, 2880, 2880, 0, 0, 0, 0, 0, 0, 0
    .short 2880, 2880, 2880, 2860, 2860, 2860, 2844, 2844, 2844, 0, 0, 0, 0, 0, 0, 0
    .short 2844, 2844, 2844, 2824, 2824, 2824, 2808, 2808, 2808, 0, 0, 0, 0, 0, 0, 0
    .short 2808, 2808, 2808, 2788, 2788, 2788, 2772, 2772, 2772, 0, 0, 0, 0, 0, 0, 0
    .short 2772, 2772, 2772, 2752, 2752, 2752, 2736, 2736, 2736, 0, 0, 0, 0, 0, 0, 0
    .short 2736, 2736, 2736, 2716, 2716, 2716, 2700, 2700, 2700, 0, 0, 0, 0, 0, 0, 0
    .short 2700, 2700, 2700, 2680, 2680, 2680, 2664, 2664, 2664, 0, 0, 0, 0, 0, 0, 0
    .short 2664, 2664, 2664, 2644, 2644, 2644, 2628, 2628, 2628, 0, 0, 0, 0, 0, 0, 0
    .short 2628, 2628, 2628, 2608, 2608, 2608, 2592, 2592, 2592, 0, 0, 0, 0, 0, 0, 0
    .short 2592, 2592, 2592, 2572, 2572, 2572, 2556, 2556, 2556, 0, 0, 0, 0, 0, 0, 0
    .short 2556, 2556, 2556, 2536, 2536, 2536, 2520, 2520, 2520, 0, 0, 0, 0, 0, 0, 0
    .short 2520, 2520, 2520, 2500, 2500, 2500, 2484, 2484, 2484, 0, 0, 0, 0, 0, 0, 0
    .short 2484, 2484, 2484, 2464, 2464, 2464, 2448, 2448, 2448, 0, 0, 0, 0, 0, 0, 0
    .short 2448, 2448, 2448, 2428, 2428, 2428, 2412, 2412, 2412, 0, 0, 0, 0, 0, 0, 0
    .short 2412, 2412, 2412, 2392, 2392, 2392, 2376, 2376, 2376, 0, 0, 0, 0, 0, 0, 0
    .short 2376, 2376, 2376, 2356, 2356, 2356, 2340, 2340, 2340, 0, 0, 0, 0, 0, 0, 0
    .short 2340, 2340, 2340, 2320, 2320, 2320, 2304, 2304, 2304, 0, 0, 0, 0, 0, 0, 0
    .short 2304, 2304, 2292, 2284, 2284, 2284, 2276, 2268, 2268, 0, 0, 0, 0, 0, 0, 0
    .short 2268, 2268, 2256, 2248, 2248, 2248, 2240, 2232, 2232, 0, 0, 0, 0, 0, 0, 0
    .short 2232, 2232, 2220, 2212, 2212, 2212, 2204, 2196, 2196, 0, 0, 0, 0, 0, 0, 0
    .short 2196, 2196, 2184, 2176, 2176, 2176, 2168, 2160, 2160, 0, 0, 0, 0, 0, 0, 0
    .short 2160, 2160, 2148, 2140, 2140, 2140, 2132, 2124, 2124, 0, 0, 0, 0, 0, 0, 0
    .short 2124, 2124, 2112, 2104, 2104, 2104, 2096, 2088, 2088, 0, 0, 0, 0, 0, 0, 0
    .short 2088, 2088, 2076, 2068, 2068, 2068, 2060, 2052, 2052, 0, 0, 0, 0, 0, 0, 0
    .short 2052, 2052, 2040, 2032, 2032, 2032, 2024, 2016, 2016, 0, 0, 0, 0, 0, 0, 0
    .short 2016, 2016, 2004, 1996, 1996, 1996, 1988, 1980, 1980, 0, 0, 0, 0, 0, 0, 0
    .short 1980, 1980, 1968, 1960, 1960, 1960, 1952, 1944, 1944, 0, 0, 0, 0, 0, 0, 0
    .short 1944, 1944, 1932, 1924, 1924, 1924, 1916, 1908, 1908, 0, 0, 0, 0, 0, 0, 0
    .short 1908, 1908, 1896, 1888, 1888, 1888, 1880, 1872, 1872, 0, 0, 0, 0, 0, 0, 0
    .short 1872, 1872, 1860, 1852, 1852, 1852, 1844, 1836, 1836, 0, 0, 0, 0, 0, 0, 0
    .short 1836, 1836, 1824, 1816, 1816, 1816, 1808, 1800, 1800, 0, 0, 0, 0, 0, 0, 0
    .short 1800, 1800, 1788, 1780, 1780, 1780, 1772, 1764, 1764, 0, 0, 0, 0, 0, 0, 0
    .short 1764, 1764, 1752, 1744, 1744, 1744, 1736, 1728, 1728, 0, 0, 0, 0, 0, 0, 0
    .short 1728, 1728, 1716, 1708, 1708, 1708, 1700, 1692, 1692, 0, 0, 0, 0, 0, 0, 0
    .short 1692, 1692, 1680, 1672, 1672, 1672, 1664, 1656, 1656, 0, 0, 0, 0, 0, 0, 0
    .short 1656, 1656, 1644, 1636, 1636, 1636, 1628, 1620, 1620, 0, 0, 0, 0, 0, 0, 0
    .short 1620, 1620, 1608, 1600, 1600, 1600, 1592, 1584, 1584, 0, 0, 0, 0, 0, 0, 0
    .short 1584, 1584, 1572, 1564, 1564, 1564, 1556, 1548, 1548, 0, 0, 0, 0, 0, 0, 0
    .short 1548, 1548, 1536, 1528, 1528, 1528, 1520, 1512, 1512, 0, 0, 0, 0, 0, 0, 0
    .short 1512, 1512, 1500, 1492, 1492, 1492, 1484, 1476, 1476, 0, 0, 0, 0, 0, 0, 0
    .short 1476, 1476, 1464, 1456, 1456, 1456, 1448, 1440, 1440, 0, 0, 0, 0, 0, 0, 0
    .short 1440, 1440, 1428, 1420, 1420, 1420, 1412, 1404, 1404, 0, 0, 0, 0, 0, 0, 0
    .short 1404, 1404, 1392, 1384, 1384, 1384, 1376, 1368, 1368, 0, 0, 0, 0, 0, 0, 0
    .short 1368, 1368, 1356, 1348, 1348, 1348, 1340, 1332, 1332, 0, 0, 0, 0, 0, 0, 0
    .short 1332, 1332, 1320, 1312, 1312, 1312, 1304, 1296, 1296, 0, 0, 0, 0, 0, 0, 0
    .short 1296, 1296, 1284, 1276, 1276, 1276, 1268, 1260, 1260, 0, 0, 0, 0, 0, 0, 0
    .short 1260, 1260, 1248, 1240, 1240, 1240, 1232, 1224, 1224, 0, 0, 0, 0, 0, 0, 0
    .short 1224, 1224, 1212, 1204, 1204, 1204, 1196, 1188, 1188, 0, 0, 0, 0, 0, 0, 0
    .short 1188, 1188, 1176, 1168, 1168, 1168, 1160, 1152, 1152, 0, 0, 0, 0, 0, 0, 0
    .short 1152, 1144, 1140, 1136, 1132, 1128, 1124, 1120, 1116, 0, 0, 0, 0, 0, 0, 0
    .short 1116, 1108, 1104, 1100, 1096, 1092, 1088, 1084, 1080, 0, 0, 0, 0, 0, 0, 0
    .short 1080, 1072, 1068, 1064, 1060, 1056, 1052, 1048, 1044, 0, 0, 0, 0, 0, 0, 0
    .short 1044, 1036, 1032, 1028, 1024, 1020, 1016, 1012, 1008, 0, 0, 0, 0, 0, 0, 0
    .short 1008, 1000, 996, 992, 988, 984, 980, 976, 972, 0, 0, 0, 0, 0, 0, 0
    .short 972, 964, 960, 956, 952, 948, 944, 940, 936, 0, 0, 0, 0, 0, 0, 0
    .short 936, 928, 924, 920, 916, 912, 908, 904, 900, 0, 0, 0, 0, 0, 0, 0
    .short 900, 892, 888, 884, 880, 876, 872, 868, 864, 0, 0, 0, 0, 0, 0, 0
    .short 864, 856, 852, 848, 844, 840, 836, 832, 828, 0, 0, 0, 0, 0, 0, 0
    .short 828, 820, 816, 812, 808, 804, 800, 796, 792, 0, 0, 0, 0, 0, 0, 0
    .short 792, 784, 780, 776, 772, 768, 764, 760, 756, 0, 0, 0, 0, 0, 0, 0
    .short 756, 748, 744, 740, 736, 732, 728, 724, 720, 0, 0, 0, 0, 0, 0, 0
    .short 720, 712, 708, 704, 700, 696, 692, 688, 684, 0, 0, 0, 0, 0, 0, 0
    .short 684, 676, 672, 668, 664, 660, 656, 652, 648, 0, 0, 0, 0, 0, 0, 0
    .short 648, 640, 636, 632, 628, 624, 620, 616, 612, 0, 0, 0, 0, 0, 0, 0
    .short 612, 604, 600, 596, 592, 588, 584, 580, 576, 0, 0, 0, 0, 0, 0, 0
    .short 576, 568, 564, 560, 556, 552, 548, 544, 540, 0, 0, 0, 0, 0, 0, 0
    .short 540, 532, 528, 524, 520, 516, 512, 508, 504, 0, 0, 0, 0, 0, 0, 0
    .short 504, 496, 492, 488, 484, 480, 476, 472, 468, 0, 0, 0, 0, 0, 0, 0
    .short 468, 460, 456, 452, 448, 444, 440, 436, 432, 0, 0, 0, 0, 0, 0, 0
    .short 432, 424, 420, 416, 412, 408, 404, 400, 396, 0, 0, 0, 0, 0, 0, 0
    .short 396, 388, 384, 380, 376, 372, 368, 364, 360, 0, 0, 0, 0, 0, 0, 0
    .short 360, 352, 348, 344, 340, 336, 332, 328, 324, 0, 0, 0, 0, 0, 0, 0
    .short 324, 316, 312, 308, 304, 300, 296, 292, 288, 0, 0, 0, 0, 0, 0, 0
    .short 288, 280, 276, 272, 268, 264, 260, 256, 252, 0, 0, 0, 0, 0, 0, 0
    .short 252, 244, 240, 236, 232, 228, 224, 220, 216, 0, 0, 0, 0, 0, 0, 0
    .short 216, 208, 204, 200, 196, 192, 188, 184, 180, 0, 0, 0, 0, 0, 0, 0
    .short 180, 172, 168, 164, 160, 156, 152, 148, 144, 0, 0, 0, 0, 0, 0, 0
    .short 144, 136, 132, 128, 124, 120, 116, 112, 108, 0, 0, 0, 0, 0, 0, 0
    .short 108, 100, 96, 92, 88, 84, 80, 76, 72, 0, 0, 0, 0, 0, 0, 0
    .short 72, 64, 60, 56, 52, 48, 44, 40, 36, 0, 0, 0, 0, 0, 0, 0
    .short 36, 28, 24, 20, 16, 12, 8, 4, 0, 0, 0, 0, 0, 0, 0, 0
    .long 0, 1, 2, 3, 4, 5, 6, 7, 128, 129, 130, 131, 132, 133, 134, 135, 256, 258, 260, 262, 384, 386, 388, 390, 512, 516, 640, 644, 768, 772, 896, 900, 1024, 1152, 1280, 1408, 1536, 1664, 1792, 1920, 2048, 2176, 2304, 2432, 2560, 2688, 2816, 2944, 1024, 1152, 1280, 1408, 1536, 1664, 1792, 1920, 2048, 2176, 2304, 2432, 2560, 2688, 2816, 2944
.size kgen_tab, 8448
text_end:
.section .rodata,"a"
.p2align 6
.amdhsa_kernel main_kernel
  .amdhsa_next_free_vgpr 168
  .amdhsa_next_free_sgpr 96
  .amdhsa_accum_offset 168
  .amdhsa_group_segment_fixed_size 0
  .amdhsa_kernarg_size 120
  .amdhsa_user_sgpr_count 2
  .amdhsa_user_sgpr_kernarg_segment_ptr 1
  .amdhsa_system_sgpr_workgroup_id_x 1
.end_amdhsa_kernel
```

```asm
; @launch kernel=main_kernel grid=(256,1,1) block=(768,1,1) lds=163840
.amdgcn_target "amdgcn-amd-amdhsa--gfx950"
.text
.globl main_kernel
.p2align 8
.type main_kernel,@function
main_kernel:
    s_cmp_ge_u32 s2, 256
    s_cbranch_scc1 k_exit
    s_load_dwordx4 s[68:71], s[0:1], 0
    s_load_dwordx4 s[64:67], s[0:1], 104
    s_load_dwordx2 s[72:73], s[0:1], 16
    s_load_dwordx2 s[74:75], s[0:1], 96
    s_load_dwordx16 s[80:95], s[0:1], 32
    s_cmp_lt_u32 s2, 16
    s_cbranch_scc0 k_nct
    s_getpc_b64 s[34:35]
k_pc:
    s_sub_u32 s34, s34, k_pc-main_kernel
    s_subb_u32 s35, s35, 0
    v_lshlrev_b32 v2, 7, v0
    v_cmp_gt_u32 vcc, (text_end-main_kernel)>>7, v0
    s_and_saveexec_b64 s[40:41], vcc
    s_cbranch_execz k_nc
    global_load_dword v163, v2, s[34:35]
k_nc:
    s_mov_b64 exec, s[40:41]
k_nct:
    v_lshrrev_b32 v2, 6, v0
    s_and_b32 s22, s2, 7
    s_lshr_b32 s23, s2, 3
    v_readfirstlane_b32 s27, v2
    s_lshl_b32 s24, s22, 2
    s_lshr_b32 s25, s23, 3
    s_add_u32 s24, s24, s25
    s_and_b32 s25, s23, 7
    s_lshl_b32 s24, s24, 6
    s_lshl_b32 s77, s22, 5
    s_add_u32 s77, s77, s23
    s_mov_b32 s52, 1
    s_mov_b32 s78, 0
    v_and_b32 v1, 63, v0
    v_and_b32 v12, 15, v0
    v_lshrrev_b32 v13, 4, v1
    v_lshlrev_b32 v5, 4, v1
    s_cmp_lt_u32 s27, 4
    s_nop 1
    s_cbranch_scc1 comp_start
    s_setprio 3
    s_sub_u32 s28, s27, 4
    s_lshr_b32 s38, s28, 2
    s_and_b32 s39, s28, 3
    v_lshrrev_b32 v6, 3, v1
    v_lshrrev_b32 v7, 4, v1
    s_and_b32 s29, s28, 1
    s_lshl_b32 s29, s29, 2
    v_xor_b32 v7, s29, v7
    v_and_b32 v2, 7, v1
    v_xor_b32 v2, v2, v7
    v_lshlrev_b32 v2, 4, v2
    s_lshl_b32 s29, s28, 3
    s_add_u32 s29, s29, s24
    s_sub_u32 s29, s29, 16
    v_add_u32 v3, s29, v6
    v_lshl_add_u32 v2, v3, 10, v2
    v_add_u32 v3, 0x10000, v2
    s_movk_i32 s26, 128
    s_movk_i32 s63, 128
    s_cmp_eq_u32 s28, 0
    s_cselect_b32 s40, 0xffffff00, -1
    v_lshrrev_b32 v4, 2, v6
    v_lshlrev_b32 v4, 3, v4
    v_and_b32 v7, 3, v6
    v_add_u32 v14, v4, v7
    s_lshr_b32 s29, s39, 1
    s_lshl_b32 s29, s29, 4
    s_and_b32 s33, s39, 1
    s_lshl_b32 s33, s33, 2
    s_add_u32 s29, s29, s33
    v_add_u32 v14, s29, v14
    s_lshl_b32 s33, s38, 5
    v_add_u32 v4, s33, v14
    v_mul_u32_u24 v4, 3072, v4
    v_bfe_u32 v7, v1, 1, 2
    v_xor_b32 v7, v7, v13
    v_lshlrev_b32 v7, 5, v7
    v_and_b32 v8, 1, v1
    v_lshl_add_u32 v7, v8, 4, v7
    s_lshl_b32 s29, s25, 7
    v_add3_u32 v4, v4, v7, s29
    s_mov_b32 s30, 0
    s_mov_b32 s62, 0
    s_mov_b32 s31, 0
    s_mov_b32 s32, 0
    s_mul_i32 s50, s28, 3072
    s_add_u32 s50, s50, 10240
    s_lshl_b32 s51, s28, 10
    s_mov_b32 s41, -1
    s_waitcnt lgkmcnt(0)
    s_mov_b32 s4, s68
    s_mov_b32 s5, s69
    s_mov_b32 s6, 0x00200000
    s_mov_b32 s7, 0x00020000
    s_mov_b32 s8, s70
    s_mov_b32 s9, s71
    s_mov_b32 s10, 0x00180000
    s_mov_b32 s11, 0x00020000
    s_lshr_b32 s20, s28, 2
    s_lshl_b32 s21, s77, 1
    s_add_u32 s21, s21, s20
    s_lshl_b32 s22, s21, 8
    s_and_b32 s33, s28, 1
    s_lshl_b32 s33, s33, 7
    s_add_u32 s22, s22, s33
    v_lshl_add_u32 v64, v1, 1, s22
    s_lshl_b32 s21, s21, 1
    v_mov_b32 v65, s21
    v_mov_b32 v48, 0
    v_mov_b32 v49, 0
    v_mov_b32 v50, 0
    v_mov_b32 v51, 0
    v_mov_b32 v52, 0
    v_mov_b32 v53, 0
    v_mov_b32 v54, 0
    global_load_short_d16_hi v54, v65, s[92:93]
    global_load_short_d16_hi v48, v64, s[80:81]
    global_load_short_d16_hi v49, v64, s[82:83]
    global_load_short_d16_hi v50, v64, s[84:85]
    global_load_short_d16_hi v51, v64, s[86:87]
    global_load_short_d16_hi v52, v64, s[88:89]
    global_load_short_d16_hi v53, v64, s[90:91]
    s_getpc_b64 s[20:21]
kg_pc:
    s_add_u32 s20, s20, kgen_tab-kg_pc
    s_addc_u32 s21, s21, 0
    s_lshl_b32 s33, s39, 6
    v_add_u32 v64, s33, v1
    v_lshlrev_b32 v64, 5, v64
    v_lshl_add_u32 v65, v13, 4, s33
    v_add_u32 v65, 0x2000, v65
    global_load_dwordx4 v[56:59], v64, s[20:21]
    global_load_dword v55, v64, s[20:21] offset:16
    global_load_dwordx4 v[60:63], v65, s[20:21]
    s_add_u32 m0, s30, s51
    s_mov_b64 exec, s[40:41]
    buffer_load_dwordx4 v2, s[4:7], s31 offen sc1 lds
    s_mov_b64 exec, -1
    s_cmp_lt_u32 s28, 2
    s_cbranch_scc0 ld_nx_1
    s_add_u32 m0, m0, 8192
    s_nop 0
    buffer_load_dwordx4 v3, s[4:7], s62 offen sc1 lds
    s_add_u32 s62, s62, s63
ld_nx_1:
    s_add_u32 m0, s30, s50
    s_add_u32 s31, s31, s26
    buffer_load_dwordx4 v4, s[8:11], s32 offen lds
    buffer_load_dwordx4 v4, s[8:11], s32 offen offset:1024 lds
    buffer_load_dwordx4 v4, s[8:11], s32 offen offset:2048 lds
    s_add_u32 s32, s32, 196608
    s_add_u32 s30, s30, 34816
    s_cmp_ge_u32 s30, 104448
    s_cselect_b32 s30, 0, s30
    s_add_u32 m0, s30, s51
    s_mov_b64 exec, s[40:41]
    buffer_load_dwordx4 v2, s[4:7], s31 offen sc1 lds
    s_mov_b64 exec, -1
    s_cmp_lt_u32 s28, 2
    s_cbranch_scc0 ld_nx_2
    s_add_u32 m0, m0, 8192
    s_nop 0
    buffer_load_dwordx4 v3, s[4:7], s62 offen sc1 lds
    s_add_u32 s62, s62, s63
ld_nx_2:
    s_add_u32 m0, s30, s50
    s_add_u32 s31, s31, s26
    buffer_load_dwordx4 v4, s[8:11], s32 offen lds
    buffer_load_dwordx4 v4, s[8:11], s32 offen offset:1024 lds
    buffer_load_dwordx4 v4, s[8:11], s32 offen offset:2048 lds
    s_add_u32 s32, s32, 196608
    s_add_u32 s30, s30, 34816
    s_cmp_ge_u32 s30, 104448
    s_cselect_b32 s30, 0, s30
    s_mov_b32 s12, s72
    s_mov_b32 s13, s73
    s_mov_b32 s14, 0x00080000
    s_mov_b32 s15, 0x00020000
    s_mov_b32 s16, s66
    s_mov_b32 s17, s67
    s_mov_b32 s18, 0x01800000
    s_mov_b32 s19, 0x00020000
    v_lshl_add_u32 v14, v14, 10, v7
    s_and_b32 s33, s25, 3
    s_lshl_b32 s33, s33, 8
    s_lshl_b32 s29, s38, 7
    s_add_u32 s33, s33, s29
    v_add_u32 v14, s33, v14
    s_max_u32 s29, s28, 3
    s_sub_u32 s29, s29, 3
    v_lshrrev_b32 v10, 3, v12
    v_lshlrev_b32 v10, 10, v10
    v_and_b32 v9, 7, v12
    v_lshl_add_u32 v10, v9, 7, v10
    v_lshrrev_b32 v9, 1, v12
    v_xor_b32 v9, v9, v13
    v_lshl_add_u32 v10, v9, 4, v10
    s_lshl_b32 s33, s29, 11
    v_add_u32 v8, s33, v10
    s_cmp_eq_u32 s28, 3
    s_cselect_b32 s44, 1, 0
    s_lshl_b32 s60, s39, 11
    s_lshl_b32 s33, s38, 10
    s_add_u32 s60, s60, s33
    s_add_u32 s60, s60, 106496
    s_mov_b32 s61, 0
    s_mov_b32 s36, 0
    v_mov_b32 v24, 0x3f803f80
    v_mov_b32 v25, 0x3f803f80
    v_mov_b32 v26, 0x3f803f80
    v_mov_b32 v27, 0x3f803f80
    v_mov_b32 v28, 0x3f803f80
    v_mov_b32 v29, 0x3f803f80
    v_mov_b32 v30, 0x3f803f80
    v_mov_b32 v31, 0x3f803f80
    v_mov_b32 v40, 0
    v_mov_b32 v41, 0
    v_mov_b32 v42, 0
    v_mov_b32 v43, 0
    v_mov_b32 v44, 0
    v_mov_b32 v45, 0
    v_mov_b32 v46, 0
    v_mov_b32 v47, 0
    v_mov_b32 v16, 0x3f803f80
    v_mov_b32 v17, 0x3f803f80
    v_mov_b32 v18, 0x3f803f80
    v_mov_b32 v19, 0x3f803f80
    s_min_u32 s33, s39, 2
    s_mul_i32 s33, s33, 34816
    v_add_u32 v6, s33, v5
    s_mov_b64 exec, 0xff
    ds_write_b128 v6, v[16:19]
    s_mov_b64 exec, -1
    s_cmp_eq_u32 s28, 0
    s_cbranch_scc0 ld_nozf_3
    v_mov_b32 v6, 0
    v_and_b32 v7, 7, v1
    v_lshlrev_b32 v7, 2, v7
    v_add_u32 v7, 106368, v7
    ds_write_b32 v7, v6
ld_nozf_3:
    s_waitcnt vmcnt(10)
    s_cmp_lt_u32 s28, 2
    s_cbranch_scc1 kg_pre0
    s_waitcnt vmcnt(8)
kg_pre0:
    s_cmp_lt_u32 s39, 2
    s_cbranch_scc1 kg_p0_0
    s_branch kg_p1_0
ld_main:
    s_mov_b32 s34, 0
ld_loop:
    s_lshl1_add_u32 s33, s34, s52
    s_cmp_eq_u32 s33, -1
    s_cbranch_scc0 ld_w4
    s_waitcnt vmcnt(15) lgkmcnt(0)
    s_cmp_lt_u32 s28, 2
    s_cbranch_scc1 ld_w5
    s_waitcnt vmcnt(14)
    s_branch ld_w5
ld_w4:
    s_waitcnt vmcnt(5) lgkmcnt(0)
    s_cmp_lt_u32 s28, 2
    s_cbranch_scc1 ld_w5
    s_waitcnt vmcnt(4)
ld_w5:
    s_barrier
    s_cmp_lt_u32 s28, 3
    s_cbranch_scc1 ld_nx_4_r
    v_add_u32 v6, s36, v8
    s_cmp_eq_u32 s52, 2
    s_cbranch_scc1 ld_nx_4_t
    v_add_u32 v7, s36, v10
    ds_read_b128 v[16:19], v6
    ds_read_b128 v[24:27], v7
    v_xor_b32 v6, 64, v6
    v_xor_b32 v7, 64, v7
    ds_read_b128 v[20:23], v6
    ds_read_b128 v[28:31], v7
    s_branch ld_nx_4_u
ld_nx_4_t:
    v_add_u32 v7, s36, v11
    ds_read_b64_tr_b16 v[16:17], v6
    ds_read_b64_tr_b16 v[18:19], v7
    v_add_u32 v6, s45, v6
    v_add_u32 v7, s45, v7
    ds_read_b64_tr_b16 v[20:21], v6
    ds_read_b64_tr_b16 v[22:23], v7
ld_nx_4_u:
    s_add_u32 s36, s36, 34816
    s_cmp_ge_u32 s36, 104448
    s_cselect_b32 s36, 0, s36
ld_nx_4_r:
    s_add_u32 m0, s30, s51
    s_mov_b64 exec, s[40:41]
    buffer_load_dwordx4 v2, s[4:7], s31 offen sc1 lds
    s_mov_b64 exec, -1
    s_cmp_lt_u32 s28, 2
    s_cbranch_scc0 ld_nx_4
    s_add_u32 m0, m0, 8192
    s_nop 0
    buffer_load_dwordx4 v3, s[4:7], s62 offen sc1 lds
    s_add_u32 s62, s62, s63
ld_nx_4:
    s_add_u32 m0, s30, s50
    s_add_u32 s31, s31, s26
    buffer_load_dwordx4 v4, s[8:11], s32 offen lds
    s_cmp_lt_u32 s28, 3
    s_cbranch_scc1 ld_nx_4_a
    s_waitcnt lgkmcnt(0)
    v_mfma_f32_16x16x32_bf16 v[40:43], v[16:19], v[16:19], v[40:43]
    v_mfma_f32_16x16x32_bf16 v[40:43], v[20:23], v[20:23], v[40:43]
    s_cmp_eq_u32 s44, 1
    s_cbranch_scc1 ld_nx_4_a
    v_mfma_f32_16x16x32_bf16 v[44:47], v[16:19], v[24:27], v[44:47]
    v_mfma_f32_16x16x32_bf16 v[44:47], v[20:23], v[28:31], v[44:47]
ld_nx_4_a:
    buffer_load_dwordx4 v4, s[8:11], s32 offen offset:1024 lds
    buffer_load_dwordx4 v4, s[8:11], s32 offen offset:2048 lds
    s_add_u32 s32, s32, 196608
    s_add_u32 s30, s30, 34816
    s_cmp_ge_u32 s30, 104448
    s_cselect_b32 s30, 0, s30
    s_cmp_eq_u32 s52, 1
    s_cbranch_scc1 kg_piece
ld_kgret:
    s_add_u32 s34, s34, 1
    s_cmp_lt_u32 s34, 6
    s_cbranch_scc1 ld_loop
    s_waitcnt vmcnt(4)
    s_barrier
    s_cmp_lt_u32 s28, 3
    s_cbranch_scc1 ld_nx_5_r
    v_add_u32 v6, s36, v8
    s_cmp_eq_u32 s52, 2
    s_cbranch_scc1 ld_nx_5_t
    v_add_u32 v7, s36, v10
    ds_read_b128 v[16:19], v6
    ds_read_b128 v[24:27], v7
    v_xor_b32 v6, 64, v6
    v_xor_b32 v7, 64, v7
    ds_read_b128 v[20:23], v6
    ds_read_b128 v[28:31], v7
    s_branch ld_nx_5_u
ld_nx_5_t:
    v_add_u32 v7, s36, v11
    ds_read_b64_tr_b16 v[16:17], v6
    ds_read_b64_tr_b16 v[18:19], v7
    v_add_u32 v6, s45, v6
    v_add_u32 v7, s45, v7
    ds_read_b64_tr_b16 v[20:21], v6
    ds_read_b64_tr_b16 v[22:23], v7
ld_nx_5_u:
    s_add_u32 s36, s36, 34816
    s_cmp_ge_u32 s36, 104448
    s_cselect_b32 s36, 0, s36
ld_nx_5_r:
    s_mov_b32 m0, s60
    s_add_u32 s60, s60, 8192
    buffer_load_dwordx4 v14, s[12:15], s61 offen lds
    s_add_u32 s61, s61, 32768
    s_mov_b32 m0, s60
    s_add_u32 s60, s60, 8192
    buffer_load_dwordx4 v14, s[12:15], s61 offen lds
    s_add_u32 s61, s61, 32768
    s_mov_b32 m0, s60
    s_add_u32 s60, s60, 8192
    buffer_load_dwordx4 v14, s[12:15], s61 offen lds
    s_add_u32 s61, s61, 32768
    s_mov_b32 m0, s60
    s_add_u32 s60, s60, 8192
    buffer_load_dwordx4 v14, s[12:15], s61 offen lds
    s_add_u32 s61, s61, 32768
    s_cmp_lt_u32 s28, 3
    s_cbranch_scc1 ld_nx_5_a
    s_waitcnt lgkmcnt(0)
    v_mfma_f32_16x16x32_bf16 v[40:43], v[16:19], v[16:19], v[40:43]
    v_mfma_f32_16x16x32_bf16 v[40:43], v[20:23], v[20:23], v[40:43]
    s_cmp_eq_u32 s44, 1
    s_cbranch_scc1 ld_nx_5_a
    v_mfma_f32_16x16x32_bf16 v[44:47], v[16:19], v[24:27], v[44:47]
    v_mfma_f32_16x16x32_bf16 v[44:47], v[20:23], v[28:31], v[44:47]
ld_nx_5_a:
    s_waitcnt vmcnt(4)
    s_barrier
    s_cmp_lt_u32 s28, 3
    s_cbranch_scc1 ld_nx_6_r
    v_add_u32 v6, s36, v8
    s_cmp_eq_u32 s52, 2
    s_cbranch_scc1 ld_nx_6_t
    v_add_u32 v7, s36, v10
    ds_read_b128 v[16:19], v6
    ds_read_b128 v[24:27], v7
    v_xor_b32 v6, 64, v6
    v_xor_b32 v7, 64, v7
    ds_read_b128 v[20:23], v6
    ds_read_b128 v[28:31], v7
    s_branch ld_nx_6_u
ld_nx_6_t:
    v_add_u32 v7, s36, v11
    ds_read_b64_tr_b16 v[16:17], v6
    ds_read_b64_tr_b16 v[18:19], v7
    v_add_u32 v6, s45, v6
    v_add_u32 v7, s45, v7
    ds_read_b64_tr_b16 v[20:21], v6
    ds_read_b64_tr_b16 v[22:23], v7
ld_nx_6_u:
    s_add_u32 s36, s36, 34816
    s_cmp_ge_u32 s36, 104448
    s_cselect_b32 s36, 0, s36
ld_nx_6_r:
    s_mov_b32 m0, s60
    s_add_u32 s60, s60, 8192
    buffer_load_dwordx4 v14, s[12:15], s61 offen lds
    s_add_u32 s61, s61, 32768
    s_mov_b32 m0, s60
    s_add_u32 s60, s60, 8192
    buffer_load_dwordx4 v14, s[12:15], s61 offen lds
    s_add_u32 s61, s61, 32768
    s_mov_b32 m0, s60
    s_add_u32 s60, s60, 8192
    buffer_load_dwordx4 v14, s[12:15], s61 offen lds
    s_add_u32 s61, s61, 32768
    s_cmp_lt_u32 s28, 3
    s_cbranch_scc1 ld_nx_6_a
    s_waitcnt lgkmcnt(0)
    v_mfma_f32_16x16x32_bf16 v[40:43], v[16:19], v[16:19], v[40:43]
    v_mfma_f32_16x16x32_bf16 v[40:43], v[20:23], v[20:23], v[40:43]
    s_cmp_eq_u32 s44, 1
    s_cbranch_scc1 ld_nx_6_a
    v_mfma_f32_16x16x32_bf16 v[44:47], v[16:19], v[24:27], v[44:47]
    v_mfma_f32_16x16x32_bf16 v[44:47], v[20:23], v[28:31], v[44:47]
ld_nx_6_a:
    s_cmp_lt_u32 s28, 3
    s_cbranch_scc1 ld_fin
    s_sub_u32 s29, s28, 3
    s_lshl_b32 s33, s29, 7
    s_add_u32 s33, s33, 105728
    v_lshlrev_b32 v6, 2, v12
    v_add_u32 v6, s33, v6
    v_lshlrev_b32 v7, 4, v13
    v_add_u32 v7, s33, v7
    v_and_b32 v16, 1, v12
    v_cmp_eq_u32 vcc, 1, v16
    v_and_b32 v16, 2, v12
    s_cmp_eq_u32 s44, 1
    s_cselect_b64 s[46:47], -1, 0
    v_cmp_eq_u32 s[48:49], 2, v16
    s_nop 4
    v_cndmask_b32 v16, v40, v41, vcc
    v_cndmask_b32 v17, v42, v43, vcc
    v_cndmask_b32 v20, v44, v40, s[46:47]
    v_cndmask_b32 v21, v45, v41, s[46:47]
    v_cndmask_b32 v22, v46, v42, s[46:47]
    v_cndmask_b32 v23, v47, v43, s[46:47]
    v_cndmask_b32 v16, v16, v17, s[48:49]
    s_mov_b32 s42, 0x00f0000f
    s_mov_b32 s43, 0xf0000f00
    s_mov_b64 exec, s[42:43]
    ds_write_b32 v6, v16 offset:64
    s_mov_b32 s42, 0x00010001
    s_mov_b32 s43, 0x00010001
    s_mov_b64 exec, s[42:43]
    ds_write_b128 v7, v[20:23]
    s_mov_b64 exec, -1
    s_waitcnt lgkmcnt(0)
    ds_read2_b32 v[40:41], v6 offset0:0 offset1:16
    s_lshl_b32 s33, s78, 2
    s_add_u32 s33, s33, 106368
    v_mov_b32 v18, s33
    s_waitcnt lgkmcnt(0)
    v_cmp_u_f32 vcc, v41, v41
    v_mul_f32 v40, 0x3b000000, v40
    v_mul_f32 v41, 0x3b000000, v41
    s_cmp_eq_u32 s52, 2
    s_cselect_b64 exec, vcc, 0
    s_cbranch_execz ld_noflag
    ds_write_b32 v18, v18
ld_noflag:
    s_mov_b64 exec, -1
    v_fma_f32 v41, -v40, v40, v41
    v_max_f32 v41, 0, v41
    v_cvt_pk_bf16_f32 v40, v40, v41
    v_and_b32 v17, 0xffff0000, v40
    v_lshlrev_b32 v16, 16, v40
    v_add_f32 v17, 0x3727c5ac, v17
    v_cvt_pk_bf16_f32 v17, v17, v17
    v_lshlrev_b32 v17, 16, v17
    v_sqrt_f32 v17, v17
    s_nop 0
    v_cvt_pk_bf16_f32 v17, v17, v17
    v_lshlrev_b32 v17, 16, v17
    v_rcp_f32 v17, v17
    s_lshl_b32 s33, s29, 4
    v_add_u32 v6, s33, v12
    v_lshlrev_b32 v7, 2, v6
    v_lshlrev_b32 v6, 3, v6
    v_add_u32 v6, 104448, v6
    v_add_u32 v7, 105088, v7
    ds_write_b64 v6, v[16:17]
    ds_write2_b32 v7, v16, v17 offset0:0 offset1:80
    s_waitcnt lgkmcnt(0)
ld_fin:
    s_barrier
    s_setprio 0
    s_lshl_b32 s33, s78, 2
    s_add_u32 s33, s33, 106368
    v_mov_b32 v6, s33
    ds_read_b32 v6, v6
    s_mov_b32 s56, s64
    s_mov_b32 s57, s65
    s_mov_b32 s58, 0x00000100
    s_mov_b32 s59, 0x00020000
    s_lshr_b32 s35, s24, 3
    s_lshl2_add_u32 s35, s52, s35
    s_sub_u32 s35, s35, 4
    s_waitcnt lgkmcnt(0)
    v_readfirstlane_b32 s33, v6
    s_cmp_eq_u32 s33, 0
    s_cbranch_scc1 ld_go
    s_add_u32 s78, s78, 1
    s_cmp_lt_u32 s78, 8
    s_cbranch_scc0 ld_go0
    s_setprio 3
    s_mov_b32 s30, 0
    s_mov_b32 s62, 0
    s_mov_b32 s31, 0
    s_mov_b32 s32, 0
    s_waitcnt vmcnt(0)
    s_add_u32 m0, s30, s51
    s_mov_b64 exec, s[40:41]
    buffer_load_dwordx4 v2, s[4:7], s31 offen sc1 lds
    s_mov_b64 exec, -1
    s_cmp_lt_u32 s28, 2
    s_cbranch_scc0 ld_nx_7
    s_add_u32 m0, m0, 8192
    s_nop 0
    buffer_load_dwordx4 v3, s[4:7], s62 offen sc1 lds
    s_add_u32 s62, s62, s63
ld_nx_7:
    s_add_u32 m0, s30, s50
    s_add_u32 s31, s31, s26
    buffer_load_dwordx4 v4, s[8:11], s32 offen lds
    buffer_load_dwordx4 v4, s[8:11], s32 offen offset:1024 lds
    buffer_load_dwordx4 v4, s[8:11], s32 offen offset:2048 lds
    s_add_u32 s32, s32, 196608
    s_add_u32 s30, s30, 34816
    s_cmp_ge_u32 s30, 104448
    s_cselect_b32 s30, 0, s30
    s_add_u32 m0, s30, s51
    s_mov_b64 exec, s[40:41]
    buffer_load_dwordx4 v2, s[4:7], s31 offen sc1 lds
    s_mov_b64 exec, -1
    s_cmp_lt_u32 s28, 2
    s_cbranch_scc0 ld_nx_8
    s_add_u32 m0, m0, 8192
    s_nop 0
    buffer_load_dwordx4 v3, s[4:7], s62 offen sc1 lds
    s_add_u32 s62, s62, s63
ld_nx_8:
    s_add_u32 m0, s30, s50
    s_add_u32 s31, s31, s26
    buffer_load_dwordx4 v4, s[8:11], s32 offen lds
    buffer_load_dwordx4 v4, s[8:11], s32 offen offset:1024 lds
    buffer_load_dwordx4 v4, s[8:11], s32 offen offset:2048 lds
    s_add_u32 s32, s32, 196608
    s_add_u32 s30, s30, 34816
    s_cmp_ge_u32 s30, 104448
    s_cselect_b32 s30, 0, s30
    s_lshl_b32 s60, s39, 11
    s_lshl_b32 s33, s38, 10
    s_add_u32 s60, s60, s33
    s_add_u32 s60, s60, 106496
    s_mov_b32 s61, 0
    s_mov_b32 s36, 0
    v_mov_b32 v24, 0x3f803f80
    v_mov_b32 v25, 0x3f803f80
    v_mov_b32 v26, 0x3f803f80
    v_mov_b32 v27, 0x3f803f80
    v_mov_b32 v28, 0x3f803f80
    v_mov_b32 v29, 0x3f803f80
    v_mov_b32 v30, 0x3f803f80
    v_mov_b32 v31, 0x3f803f80
    v_mov_b32 v40, 0
    v_mov_b32 v41, 0
    v_mov_b32 v42, 0
    v_mov_b32 v43, 0
    v_mov_b32 v44, 0
    v_mov_b32 v45, 0
    v_mov_b32 v46, 0
    v_mov_b32 v47, 0
    s_nop 2
    s_branch ld_main
ld_go0:
    s_mov_b32 s78, 7
ld_go:
    v_mov_b32 v6, 0
    buffer_load_dword v31, v6, s[56:59], s35 offen sc1
    s_sub_u32 s60, s60, 163840
ld_wo:
    s_mov_b32 m0, s60
    s_add_u32 s60, s60, 8192
    buffer_load_dwordx4 v14, s[12:15], s61 offen lds
    s_add_u32 s61, s61, 32768
    s_cmp_lt_u32 s61, 524288
    s_cbranch_scc1 ld_wo
    s_and_b32 s36, s25, 3
    s_lshr_b32 s37, s25, 2
    s_lshl_b32 s37, s37, 5
    s_add_u32 s37, s37, s24
    s_cmp_eq_u32 s52, 2
    s_cbranch_scc1 ld_resxt
    s_lshl_b32 s32, s36, 8
    s_and_b32 s33, s28, 1
    s_lshl_b32 s33, s33, 2
    v_xor_b32 v8, s33, v13
    v_bfe_u32 v9, v1, 1, 3
    v_xor_b32 v8, v8, v9
    v_lshlrev_b32 v8, 5, v8
    v_and_b32 v7, 1, v1
    v_lshl_add_u32 v8, v7, 4, v8
    v_lshl_add_u32 v8, v13, 10, v8
    s_lshl_b32 s33, s28, 2
    s_add_u32 s33, s33, s37
    s_lshl_b32 s33, s33, 10
    s_add_u32 s33, s33, s32
    buffer_load_dwordx4 v[32:35], v8, s[4:7], s33 offen
    s_branch ld_havres
ld_resxt:
    v_lshrrev_b32 v8, 2, v1
    v_lshlrev_b32 v8, 7, v8
    v_and_b32 v9, 3, v1
    v_lshl_add_u32 v8, v9, 4, v8
    s_lshl_b32 s33, s36, 14
    s_lshl_b32 s34, s28, 11
    s_add_u32 s33, s33, s34
    s_lshl_b32 s34, s24, 10
    s_add_u32 s33, s33, s34
    s_sub_u32 s34, s37, s24
    s_lshl_b32 s34, s34, 1
    s_add_u32 s33, s33, s34
    buffer_load_dwordx4 v[32:35], v8, s[4:7], s33 offen sc1
ld_havres:
    v_lshrrev_b32 v6, 3, v1
    v_and_b32 v2, 7, v1
    v_xor_b32 v2, v2, v13
    v_lshrrev_b32 v9, 1, v2
    v_and_b32 v2, 1, v2
    v_lshlrev_b32 v2, 4, v2
    v_lshl_add_u32 v2, v9, 11, v2
    v_lshl_add_u32 v2, v6, 5, v2
    v_xor_b32 v3, 0x1000, v2
    s_lshl_b32 s33, s24, 10
    s_sub_u32 s34, s37, s24
    s_lshl_b32 s34, s34, 5
    s_add_u32 s33, s33, s34
    s_lshl_b32 s34, s28, 13
    s_add_u32 s33, s33, s34
    s_sub_u32 s34, s52, 1
    s_lshl_b32 s34, s34, 21
    s_add_u32 s33, s33, s34
    s_lshl_b32 s34, s28, 12
    s_add_u32 s34, s34, 73728
    v_add_u32 v9, s34, v5
    s_add_u32 s34, s51, 106496
    v_add_u32 v10, s34, v5
    v_mov_b32 v6, 0
    s_mov_b32 s34, 0
    s_waitcnt vmcnt(10)
    v_lshrrev_b32 v8, 4, v31
    v_and_b32 v8, 0x0f0f0f0f, v8
    v_and_b32 v7, 0x0f0f0f0f, v31
    v_add_u32 v7, v7, v8
    v_lshrrev_b32 v8, 16, v7
    v_add_u32 v7, v7, v8
    v_lshrrev_b32 v8, 8, v7
    v_add_u32 v7, v7, v8
    v_and_b32 v7, 0xff, v7
    v_cmp_ne_u32 vcc, 8, v7
    s_nop 3
    s_cbranch_vccz ld_arrd
ld_arr:
    buffer_load_dword v7, v6, s[56:59], s35 offen sc1
    s_add_u32 s34, s34, 1
    s_waitcnt vmcnt(0)
    v_lshrrev_b32 v8, 4, v7
    v_and_b32 v8, 0x0f0f0f0f, v8
    v_and_b32 v7, 0x0f0f0f0f, v7
    v_add_u32 v7, v7, v8
    v_lshrrev_b32 v8, 16, v7
    v_add_u32 v7, v7, v8
    v_lshrrev_b32 v8, 8, v7
    v_add_u32 v7, v7, v8
    v_and_b32 v7, 0xff, v7
    v_cmp_ne_u32 vcc, 8, v7
    s_cmp_gt_u32 s34, 32768
    s_cbranch_scc1 ld_arrd
    s_nop 3
    s_cbranch_vccnz ld_arr
ld_arrd:
    s_mov_b32 s34, 0
    s_barrier
ld_poll2:
    buffer_load_dwordx4 v[16:19], v2, s[16:19], s33 offen offset:0 sc1
    buffer_load_dwordx4 v[20:23], v3, s[16:19], s33 offen offset:256 sc1
    buffer_load_dwordx4 v[24:27], v2, s[16:19], s33 offen offset:512 sc1
    buffer_load_dwordx4 v[28:31], v3, s[16:19], s33 offen offset:768 sc1
    s_add_u32 s34, s34, 1
    s_waitcnt vmcnt(0)
    v_max3_u32 v7, v16, v20, v24
    v_max_u32 v7, v7, v28
    v_cmp_eq_u32 vcc, -1, v7
    s_nop 1
    s_cmp_gt_u32 s34, 32768
    s_cbranch_scc1 ld_polld
    s_cbranch_vccnz ld_poll2
ld_polld:
    ds_write_b128 v9, v[16:19] offset:0
    ds_write_b128 v9, v[20:23] offset:1024
    ds_write_b128 v9, v[24:27] offset:2048
    ds_write_b128 v9, v[28:31] offset:3072
    s_waitcnt lgkmcnt(0)
    s_barrier
    s_cmp_eq_u32 s52, 2
    s_cbranch_scc0 kg_pre
    s_barrier
    ds_write_b128 v10, v[32:35]
    v_mov_b32 v6, 0
    v_and_b32 v7, 7, v1
    v_lshlrev_b32 v7, 2, v7
    v_add_u32 v7, 126976, v7
    ds_write_b32 v7, v6
    s_waitcnt lgkmcnt(0)
    s_barrier
    s_branch cv_setup
kg_piece:
    s_cmp_lt_u32 s39, 2
    s_cbranch_scc0 kg_piece1
    s_branch ld_kgret
kg_p0_0:
    s_setprio 0
    s_mov_b32 s20, 0x3fb8aa3b
    s_mov_b32 s21, 0x32a57060
    s_mov_b32 s22, 0x3f317218
    v_mul_f32 v72, s20, v54
    v_fma_f32 v73, v54, s20, -v72
    v_fma_f32 v73, v54, s21, v73
    v_exp_f32 v72, v72
    v_mul_f32 v73, s22, v73
    v_fma_f32 v72, v72, v73, v72
    v_cvt_pk_bf16_f32 v72, v72, v72
    v_lshlrev_b32 v72, 16, v72
    v_mul_f32 v48, v72, v48
    v_mul_f32 v49, v72, v49
    v_mul_f32 v50, v72, v50
    v_mul_f32 v51, v72, v51
    v_mul_f32 v74, s20, v48
    v_mul_f32 v75, v52, v50
    v_mul_f32 v76, v52, v51
    v_mul_f32 v65, 0x3e22f983, v49
    v_fma_f32 v75, -v53, v51, v75
    v_fma_f32 v76, v53, v50, v76
    v_mov_b32 v68, v74
    v_mov_b32 v70, 0x02081cea
    v_max3_f32 v69, abs(v75), abs(v76), v70
    v_max_f32_dpp v68, v68, v68 row_ror:8 row_mask:0xf bank_mask:0xf
    s_nop 0
    v_max_f32_dpp v69, v69, v69 row_ror:8 row_mask:0xf bank_mask:0xf
    v_max_f32_dpp v68, v68, v68 row_ror:4 row_mask:0xf bank_mask:0xf
    s_nop 0
    v_max_f32_dpp v69, v69, v69 row_ror:4 row_mask:0xf bank_mask:0xf
    v_max_f32_dpp v68, v68, v68 row_ror:2 row_mask:0xf bank_mask:0xf
    s_nop 0
    v_max_f32_dpp v69, v69, v69 row_ror:2 row_mask:0xf bank_mask:0xf
    v_max_f32_dpp v68, v68, v68 row_ror:1 row_mask:0xf bank_mask:0xf
    s_nop 0
    v_max_f32_dpp v69, v69, v69 row_ror:1 row_mask:0xf bank_mask:0xf
    v_mov_b32 v70, v68
    v_mov_b32 v71, v69
    s_nop 0
    v_permlane16_swap_b32 v68, v70
    v_permlane16_swap_b32 v69, v71
    v_max_f32 v68, v68, v70
    v_max_f32 v69, v69, v71
    v_mov_b32 v70, v68
    v_mov_b32 v71, v69
    s_nop 0
    v_permlane32_swap_b32 v68, v70
    v_permlane32_swap_b32 v69, v71
    v_max_f32 v68, v68, v70
    v_max_f32 v69, v69, v71
    v_rcp_f32 v70, v69
    v_sub_f32 v64, v74, v68
    v_mul_f32 v66, v75, v70
    v_mul_f32 v67, v76, v70
    v_rcp_f32 v69, v70
    v_mul_f32 v84, 0x3f800000, v64
    v_mul_f32 v136, 0x3f800000, v65
    v_mul_f32 v85, 0x40000000, v64
    v_mul_f32 v138, 0x40000000, v65
    v_mul_f32 v86, 0x40800000, v64
    v_mul_f32 v140, 0x40800000, v65
    v_mul_f32 v87, 0x43000000, v64
    v_mul_f32 v142, 0x43000000, v65
    v_mul_f32 v88, 0x43800000, v64
    v_mul_f32 v144, 0x43800000, v65
    v_mul_f32 v89, 0x44000000, v64
    v_mul_f32 v146, 0x44000000, v65
    v_exp_f32 v84, v84
    v_fract_f32 v136, v136
    v_exp_f32 v85, v85
    v_fract_f32 v138, v138
    v_exp_f32 v86, v86
    v_fract_f32 v140, v140
    v_exp_f32 v87, v87
    v_fract_f32 v142, v142
    v_exp_f32 v88, v88
    v_fract_f32 v144, v144
    v_exp_f32 v89, v89
    v_fract_f32 v146, v146
    v_sin_f32 v137, v136
    v_cos_f32 v136, v136
    v_sin_f32 v139, v138
    v_cos_f32 v138, v138
    v_sin_f32 v141, v140
    v_cos_f32 v140, v140
    v_sin_f32 v143, v142
    v_cos_f32 v142, v142
    v_sin_f32 v145, v144
    v_cos_f32 v144, v144
    v_sin_f32 v147, v146
    v_cos_f32 v146, v146
    v_mul_f32 v137, v137, v84
    v_mul_f32 v136, v136, v84
    v_mul_f32 v139, v139, v85
    v_mul_f32 v138, v138, v85
    v_mul_f32 v141, v141, v86
    v_mul_f32 v140, v140, v86
    v_mul_f32 v143, v143, v87
    v_mul_f32 v142, v142, v87
    v_mul_f32 v145, v145, v88
    v_mul_f32 v144, v144, v88
    v_mul_f32 v147, v147, v89
    v_mul_f32 v146, v146, v89
    v_mov_b32 v104, 0x3c00
    v_cvt_pk_f16_f32 v105, v136, v137
    v_cvt_pk_f16_f32 v106, v138, v139
    v_cvt_pk_f16_f32 v107, v140, v141
    v_cvt_pk_f16_f32 v108, v142, v143
    v_cvt_pk_f16_f32 v109, v144, v145
    v_cvt_pk_f16_f32 v110, v146, v147
    v_pk_mul_f32 v[148:149], v[136:137], v[138:139] op_sel:[0,0] op_sel_hi:[0,1]
    v_pk_mul_f32 v[150:151], v[136:137], v[140:141] op_sel:[0,0] op_sel_hi:[0,1]
    v_pk_mul_f32 v[152:153], v[138:139], v[140:141] op_sel:[0,0] op_sel_hi:[0,1]
    v_pk_mul_f32 v[154:155], v[142:143], v[144:145] op_sel:[0,0] op_sel_hi:[0,1]
    v_pk_mul_f32 v[156:157], v[146:147], v[142:143] op_sel:[0,0] op_sel_hi:[0,1]
    v_pk_mul_f32 v[158:159], v[146:147], v[144:145] op_sel:[0,0] op_sel_hi:[0,1]
    v_pk_fma_f32 v[148:149], v[136:137], v[138:139], v[148:149] op_sel:[1,1,0] op_sel_hi:[1,0,1] neg_lo:[1,0,0]
    v_pk_fma_f32 v[150:151], v[136:137], v[140:141], v[150:151] op_sel:[1,1,0] op_sel_hi:[1,0,1] neg_lo:[1,0,0]
    v_pk_fma_f32 v[152:153], v[138:139], v[140:141], v[152:153] op_sel:[1,1,0] op_sel_hi:[1,0,1] neg_lo:[1,0,0]
    v_pk_fma_f32 v[154:155], v[142:143], v[144:145], v[154:155] op_sel:[1,1,0] op_sel_hi:[1,0,1] neg_lo:[1,0,0]
    v_pk_fma_f32 v[156:157], v[146:147], v[142:143], v[156:157] op_sel:[1,1,0] op_sel_hi:[1,0,1] neg_lo:[1,0,0]
    v_pk_fma_f32 v[158:159], v[146:147], v[144:145], v[158:159] op_sel:[1,1,0] op_sel_hi:[1,0,1] neg_lo:[1,0,0]
    v_cvt_pk_f16_f32 v111, v148, v149
    v_cvt_pk_f16_f32 v112, v150, v151
    v_cvt_pk_f16_f32 v113, v152, v153
    v_cvt_pk_f16_f32 v114, v154, v155
    v_cvt_pk_f16_f32 v115, v156, v157
    v_cvt_pk_f16_f32 v116, v158, v159
    v_pk_mul_f32 v[160:161], v[148:149], v[140:141] op_sel:[0,0] op_sel_hi:[0,1]
    v_pk_mul_f32 v[162:163], v[146:147], v[154:155] op_sel:[0,0] op_sel_hi:[0,1]
    v_pk_mul_f32 v[72:73], v[142:143], v[136:137] op_sel:[0,0] op_sel_hi:[0,1]
    v_pk_mul_f32 v[74:75], v[142:143], v[138:139] op_sel:[0,0] op_sel_hi:[0,1]
    v_pk_mul_f32 v[76:77], v[142:143], v[148:149] op_sel:[0,0] op_sel_hi:[0,1]
    v_pk_mul_f32 v[78:79], v[142:143], v[140:141] op_sel:[0,0] op_sel_hi:[0,1]
    v_pk_fma_f32 v[160:161], v[148:149], v[140:141], v[160:161] op_sel:[1,1,0] op_sel_hi:[1,0,1] neg_lo:[1,0,0]
    v_pk_fma_f32 v[162:163], v[146:147], v[154:155], v[162:163] op_sel:[1,1,0] op_sel_hi:[1,0,1] neg_lo:[1,0,0]
    v_pk_fma_f32 v[72:73], v[142:143], v[136:137], v[72:73] op_sel:[1,1,0] op_sel_hi:[1,0,1] neg_lo:[1,0,0]
    v_pk_fma_f32 v[74:75], v[142:143], v[138:139], v[74:75] op_sel:[1,1,0] op_sel_hi:[1,0,1] neg_lo:[1,0,0]
    v_pk_fma_f32 v[76:77], v[142:143], v[148:149], v[76:77] op_sel:[1,1,0] op_sel_hi:[1,0,1] neg_lo:[1,0,0]
    v_pk_fma_f32 v[78:79], v[142:143], v[140:141], v[78:79] op_sel:[1,1,0] op_sel_hi:[1,0,1] neg_lo:[1,0,0]
    v_cvt_pk_f16_f32 v117, v160, v161
    v_cvt_pk_f16_f32 v118, v162, v163
    v_cvt_pk_f16_f32 v119, v72, v73
    v_cvt_pk_f16_f32 v120, v74, v75
    v_cvt_pk_f16_f32 v121, v76, v77
    v_cvt_pk_f16_f32 v122, v78, v79
    v_pk_mul_f32 v[80:81], v[142:143], v[150:151] op_sel:[0,0] op_sel_hi:[0,1]
    v_pk_mul_f32 v[82:83], v[142:143], v[152:153] op_sel:[0,0] op_sel_hi:[0,1]
    v_pk_mul_f32 v[72:73], v[142:143], v[160:161] op_sel:[0,0] op_sel_hi:[0,1]
    v_pk_mul_f32 v[74:75], v[144:145], v[138:139] op_sel:[0,0] op_sel_hi:[0,1]
    v_pk_mul_f32 v[76:77], v[144:145], v[140:141] op_sel:[0,0] op_sel_hi:[0,1]
    v_pk_mul_f32 v[78:79], v[144:145], v[152:153] op_sel:[0,0] op_sel_hi:[0,1]
    v_pk_fma_f32 v[80:81], v[142:143], v[150:151], v[80:81] op_sel:[1,1,0] op_sel_hi:[1,0,1] neg_lo:[1,0,0]
    v_pk_fma_f32 v[82:83], v[142:143], v[152:153], v[82:83] op_sel:[1,1,0] op_sel_hi:[1,0,1] neg_lo:[1,0,0]
    v_pk_fma_f32 v[72:73], v[142:143], v[160:161], v[72:73] op_sel:[1,1,0] op_sel_hi:[1,0,1] neg_lo:[1,0,0]
    v_pk_fma_f32 v[74:75], v[144:145], v[138:139], v[74:75] op_sel:[1,1,0] op_sel_hi:[1,0,1] neg_lo:[1,0,0]
    v_pk_fma_f32 v[76:77], v[144:145], v[140:141], v[76:77] op_sel:[1,1,0] op_sel_hi:[1,0,1] neg_lo:[1,0,0]
    v_pk_fma_f32 v[78:79], v[144:145], v[152:153], v[78:79] op_sel:[1,1,0] op_sel_hi:[1,0,1] neg_lo:[1,0,0]
    v_cvt_pk_f16_f32 v123, v80, v81
    v_cvt_pk_f16_f32 v124, v82, v83
    v_cvt_pk_f16_f32 v125, v72, v73
    v_cvt_pk_f16_f32 v126, v74, v75
    v_cvt_pk_f16_f32 v127, v76, v77
    v_cvt_pk_f16_f32 v128, v78, v79
    v_pk_mul_f32 v[80:81], v[154:155], v[138:139] op_sel:[0,0] op_sel_hi:[0,1]
    v_pk_mul_f32 v[82:83], v[154:155], v[140:141] op_sel:[0,0] op_sel_hi:[0,1]
    v_pk_mul_f32 v[72:73], v[154:155], v[152:153] op_sel:[0,0] op_sel_hi:[0,1]
    v_pk_mul_f32 v[74:75], v[146:147], v[140:141] op_sel:[0,0] op_sel_hi:[0,1]
    v_pk_mul_f32 v[76:77], v[156:157], v[140:141] op_sel:[0,0] op_sel_hi:[0,1]
    v_pk_mul_f32 v[78:79], v[158:159], v[140:141] op_sel:[0,0] op_sel_hi:[0,1]
    v_pk_fma_f32 v[80:81], v[154:155], v[138:139], v[80:81] op_sel:[1,1,0] op_sel_hi:[1,0,1] neg_lo:[1,0,0]
    v_pk_fma_f32 v[82:83], v[154:155], v[140:141], v[82:83] op_sel:[1,1,0] op_sel_hi:[1,0,1] neg_lo:[1,0,0]
    v_pk_fma_f32 v[72:73], v[154:155], v[152:153], v[72:73] op_sel:[1,1,0] op_sel_hi:[1,0,1] neg_lo:[1,0,0]
    v_pk_fma_f32 v[74:75], v[146:147], v[140:141], v[74:75] op_sel:[1,1,0] op_sel_hi:[1,0,1] neg_lo:[1,0,0]
    v_pk_fma_f32 v[76:77], v[156:157], v[140:141], v[76:77] op_sel:[1,1,0] op_sel_hi:[1,0,1] neg_lo:[1,0,0]
    v_pk_fma_f32 v[78:79], v[158:159], v[140:141], v[78:79] op_sel:[1,1,0] op_sel_hi:[1,0,1] neg_lo:[1,0,0]
    v_cvt_pk_f16_f32 v129, v80, v81
    v_cvt_pk_f16_f32 v130, v82, v83
    v_cvt_pk_f16_f32 v131, v72, v73
    v_cvt_pk_f16_f32 v132, v74, v75
    v_cvt_pk_f16_f32 v133, v76, v77
    v_cvt_pk_f16_f32 v134, v78, v79
    v_pk_mul_f32 v[80:81], v[162:163], v[140:141] op_sel:[0,0] op_sel_hi:[0,1]
    v_pk_fma_f32 v[80:81], v[162:163], v[140:141], v[80:81] op_sel:[1,1,0] op_sel_hi:[1,0,1] neg_lo:[1,0,0]
    v_cvt_pk_f16_f32 v135, v80, v81
    s_setprio 3
    s_nop 1
    s_branch ld_main
kg_piece1:
    s_branch ld_kgret
kg_p1_0:
    s_setprio 0
    s_mov_b32 s20, 0x3fb8aa3b
    s_mov_b32 s21, 0x32a57060
    s_mov_b32 s22, 0x3f317218
    v_mul_f32 v72, s20, v54
    v_fma_f32 v73, v54, s20, -v72
    v_fma_f32 v73, v54, s21, v73
    v_exp_f32 v72, v72
    v_mul_f32 v73, s22, v73
    v_fma_f32 v72, v72, v73, v72
    v_cvt_pk_bf16_f32 v72, v72, v72
    v_lshlrev_b32 v72, 16, v72
    v_mul_f32 v48, v72, v48
    v_mul_f32 v49, v72, v49
    v_mul_f32 v50, v72, v50
    v_mul_f32 v51, v72, v51
    v_mul_f32 v74, s20, v48
    v_mul_f32 v75, v52, v50
    v_mul_f32 v76, v52, v51
    v_mul_f32 v65, 0x3e22f983, v49
    v_fma_f32 v75, -v53, v51, v75
    v_fma_f32 v76, v53, v50, v76
    v_mov_b32 v68, v74
    v_mov_b32 v70, 0x02081cea
    v_max3_f32 v69, abs(v75), abs(v76), v70
    v_max_f32_dpp v68, v68, v68 row_ror:8 row_mask:0xf bank_mask:0xf
    s_nop 0
    v_max_f32_dpp v69, v69, v69 row_ror:8 row_mask:0xf bank_mask:0xf
    v_max_f32_dpp v68, v68, v68 row_ror:4 row_mask:0xf bank_mask:0xf
    s_nop 0
    v_max_f32_dpp v69, v69, v69 row_ror:4 row_mask:0xf bank_mask:0xf
    v_max_f32_dpp v68, v68, v68 row_ror:2 row_mask:0xf bank_mask:0xf
    s_nop 0
    v_max_f32_dpp v69, v69, v69 row_ror:2 row_mask:0xf bank_mask:0xf
    v_max_f32_dpp v68, v68, v68 row_ror:1 row_mask:0xf bank_mask:0xf
    s_nop 0
    v_max_f32_dpp v69, v69, v69 row_ror:1 row_mask:0xf bank_mask:0xf
    v_mov_b32 v70, v68
    v_mov_b32 v71, v69
    s_nop 0
    v_permlane16_swap_b32 v68, v70
    v_permlane16_swap_b32 v69, v71
    v_max_f32 v68, v68, v70
    v_max_f32 v69, v69, v71
    v_mov_b32 v70, v68
    v_mov_b32 v71, v69
    s_nop 0
    v_permlane32_swap_b32 v68, v70
    v_permlane32_swap_b32 v69, v71
    v_max_f32 v68, v68, v70
    v_max_f32 v69, v69, v71
    v_rcp_f32 v70, v69
    v_sub_f32 v64, v74, v68
    v_mul_f32 v66, v75, v70
    v_mul_f32 v67, v76, v70
    v_rcp_f32 v69, v70
    v_mul_f32 v84, 0x41000000, v64
    v_mul_f32 v136, 0x41000000, v65
    v_mul_f32 v85, 0x41800000, v64
    v_mul_f32 v138, 0x41800000, v65
    v_mul_f32 v86, 0x42000000, v64
    v_mul_f32 v140, 0x42000000, v65
    v_mul_f32 v87, 0x42800000, v64
    v_mul_f32 v142, 0x42800000, v65
    v_mul_f32 v88, 0x43000000, v64
    v_mul_f32 v144, 0x43000000, v65
    v_mul_f32 v89, 0x43800000, v64
    v_mul_f32 v146, 0x43800000, v65
    v_mul_f32 v90, 0x44000000, v64
    v_mul_f32 v148, 0x44000000, v65
    v_mul_f32 v91, 0x44800000, v64
    v_mul_f32 v150, 0x44800000, v65
    v_exp_f32 v84, v84
    v_fract_f32 v136, v136
    v_exp_f32 v85, v85
    v_fract_f32 v138, v138
    v_exp_f32 v86, v86
    v_fract_f32 v140, v140
    v_exp_f32 v87, v87
    v_fract_f32 v142, v142
    v_exp_f32 v88, v88
    v_fract_f32 v144, v144
    v_exp_f32 v89, v89
    v_fract_f32 v146, v146
    v_exp_f32 v90, v90
    v_fract_f32 v148, v148
    v_exp_f32 v91, v91
    v_fract_f32 v150, v150
    v_sin_f32 v137, v136
    v_cos_f32 v136, v136
    v_sin_f32 v139, v138
    v_cos_f32 v138, v138
    v_sin_f32 v141, v140
    v_cos_f32 v140, v140
    v_sin_f32 v143, v142
    v_cos_f32 v142, v142
    v_sin_f32 v145, v144
    v_cos_f32 v144, v144
    v_sin_f32 v147, v146
    v_cos_f32 v146, v146
    v_sin_f32 v149, v148
    v_cos_f32 v148, v148
    v_sin_f32 v151, v150
    v_cos_f32 v150, v150
    v_mul_f32 v137, v137, v84
    v_mul_f32 v136, v136, v84
    v_mul_f32 v139, v139, v85
    v_mul_f32 v138, v138, v85
    v_mul_f32 v141, v141, v86
    v_mul_f32 v140, v140, v86
    v_mul_f32 v143, v143, v87
    v_mul_f32 v142, v142, v87
    v_mul_f32 v145, v145, v88
    v_mul_f32 v144, v144, v88
    v_mul_f32 v147, v147, v89
    v_mul_f32 v146, v146, v89
    v_mul_f32 v149, v149, v90
    v_mul_f32 v148, v148, v90
    v_mul_f32 v151, v151, v91
    v_mul_f32 v150, v150, v91
    v_cvt_pk_f16_f32 v104, v66, -v67
    v_cvt_pk_f16_f32 v105, v150, v151
    v_pk_mul_f32 v[72:73], v[66:67], v[136:137] op_sel:[0,0] op_sel_hi:[0,1]
    v_pk_mul_f32 v[152:153], v[66:67], v[138:139] op_sel:[0,0] op_sel_hi:[0,1]
    v_pk_mul_f32 v[154:155], v[66:67], v[140:141] op_sel:[0,0] op_sel_hi:[0,1]
    v_pk_mul_f32 v[156:157], v[66:67], v[142:143] op_sel:[0,0] op_sel_hi:[0,1]
    v_pk_mul_f32 v[74:75], v[150:151], v[144:145] op_sel:[0,0] op_sel_hi:[0,1]
    v_pk_mul_f32 v[158:159], v[150:151], v[146:147] op_sel:[0,0] op_sel_hi:[0,1]
    v_pk_mul_f32 v[160:161], v[150:151], v[148:149] op_sel:[0,0] op_sel_hi:[0,1]
    v_pk_mul_f32 v[76:77], v[150:151], v[150:151] op_sel:[0,0] op_sel_hi:[0,1]
    v_pk_fma_f32 v[72:73], v[66:67], v[136:137], v[72:73] op_sel:[1,1,0] op_sel_hi:[1,0,1] neg_lo:[1,0,0]
    v_pk_fma_f32 v[152:153], v[66:67], v[138:139], v[152:153] op_sel:[1,1,0] op_sel_hi:[1,0,1] neg_lo:[1,0,0]
    v_pk_fma_f32 v[154:155], v[66:67], v[140:141], v[154:155] op_sel:[1,1,0] op_sel_hi:[1,0,1] neg_lo:[1,0,0]
    v_pk_fma_f32 v[156:157], v[66:67], v[142:143], v[156:157] op_sel:[1,1,0] op_sel_hi:[1,0,1] neg_lo:[1,0,0]
    v_pk_fma_f32 v[74:75], v[150:151], v[144:145], v[74:75] op_sel:[1,1,0] op_sel_hi:[1,0,1] neg_lo:[1,0,0]
    v_pk_fma_f32 v[158:159], v[150:151], v[146:147], v[158:159] op_sel:[1,1,0] op_sel_hi:[1,0,1] neg_lo:[1,0,0]
    v_pk_fma_f32 v[160:161], v[150:151], v[148:149], v[160:161] op_sel:[1,1,0] op_sel_hi:[1,0,1] neg_lo:[1,0,0]
    v_pk_fma_f32 v[76:77], v[150:151], v[150:151], v[76:77] op_sel:[1,1,0] op_sel_hi:[1,0,1] neg_lo:[1,0,0]
    v_cvt_pk_f16_f32 v106, v72, -v73
    v_cvt_pk_f16_f32 v107, v152, -v153
    v_cvt_pk_f16_f32 v108, v154, -v155
    v_cvt_pk_f16_f32 v109, v156, -v157
    v_cvt_pk_f16_f32 v110, v74, v75
    v_cvt_pk_f16_f32 v111, v158, v159
    v_cvt_pk_f16_f32 v112, v160, v161
    v_cvt_pk_f16_f32 v113, v76, v77
    v_pk_mul_f32 v[78:79], v[152:153], v[136:137] op_sel:[0,0] op_sel_hi:[0,1]
    v_pk_mul_f32 v[80:81], v[154:155], v[136:137] op_sel:[0,0] op_sel_hi:[0,1]
    v_pk_mul_f32 v[162:163], v[154:155], v[138:139] op_sel:[0,0] op_sel_hi:[0,1]
    v_pk_mul_f32 v[82:83], v[156:157], v[136:137] op_sel:[0,0] op_sel_hi:[0,1]
    v_pk_mul_f32 v[164:165], v[156:157], v[138:139] op_sel:[0,0] op_sel_hi:[0,1]
    v_pk_mul_f32 v[166:167], v[156:157], v[140:141] op_sel:[0,0] op_sel_hi:[0,1]
    v_pk_mul_f32 v[72:73], v[158:159], v[144:145] op_sel:[0,0] op_sel_hi:[0,1]
    v_pk_mul_f32 v[74:75], v[160:161], v[144:145] op_sel:[0,0] op_sel_hi:[0,1]
    v_pk_mul_f32 v[92:93], v[160:161], v[146:147] op_sel:[0,0] op_sel_hi:[0,1]
    v_pk_fma_f32 v[78:79], v[152:153], v[136:137], v[78:79] op_sel:[1,1,0] op_sel_hi:[1,0,1] neg_lo:[1,0,0]
    v_pk_fma_f32 v[80:81], v[154:155], v[136:137], v[80:81] op_sel:[1,1,0] op_sel_hi:[1,0,1] neg_lo:[1,0,0]
    v_pk_fma_f32 v[162:163], v[154:155], v[138:139], v[162:163] op_sel:[1,1,0] op_sel_hi:[1,0,1] neg_lo:[1,0,0]
    v_pk_fma_f32 v[82:83], v[156:157], v[136:137], v[82:83] op_sel:[1,1,0] op_sel_hi:[1,0,1] neg_lo:[1,0,0]
    v_pk_fma_f32 v[164:165], v[156:157], v[138:139], v[164:165] op_sel:[1,1,0] op_sel_hi:[1,0,1] neg_lo:[1,0,0]
    v_pk_fma_f32 v[166:167], v[156:157], v[140:141], v[166:167] op_sel:[1,1,0] op_sel_hi:[1,0,1] neg_lo:[1,0,0]
    v_pk_fma_f32 v[72:73], v[158:159], v[144:145], v[72:73] op_sel:[1,1,0] op_sel_hi:[1,0,1] neg_lo:[1,0,0]
    v_pk_fma_f32 v[74:75], v[160:161], v[144:145], v[74:75] op_sel:[1,1,0] op_sel_hi:[1,0,1] neg_lo:[1,0,0]
    v_pk_fma_f32 v[92:93], v[160:161], v[146:147], v[92:93] op_sel:[1,1,0] op_sel_hi:[1,0,1] neg_lo:[1,0,0]
    v_cvt_pk_f16_f32 v114, v78, -v79
    v_cvt_pk_f16_f32 v115, v80, -v81
    v_cvt_pk_f16_f32 v116, v162, -v163
    v_cvt_pk_f16_f32 v117, v82, -v83
    v_cvt_pk_f16_f32 v118, v164, -v165
    v_cvt_pk_f16_f32 v119, v166, -v167
    v_cvt_pk_f16_f32 v120, v72, v73
    v_cvt_pk_f16_f32 v121, v74, v75
    v_cvt_pk_f16_f32 v122, v92, v93
    v_pk_mul_f32 v[76:77], v[162:163], v[136:137] op_sel:[0,0] op_sel_hi:[0,1]
    v_pk_mul_f32 v[78:79], v[164:165], v[136:137] op_sel:[0,0] op_sel_hi:[0,1]
    v_pk_mul_f32 v[80:81], v[166:167], v[136:137] op_sel:[0,0] op_sel_hi:[0,1]
    v_pk_mul_f32 v[94:95], v[166:167], v[138:139] op_sel:[0,0] op_sel_hi:[0,1]
    v_pk_mul_f32 v[82:83], v[92:93], v[144:145] op_sel:[0,0] op_sel_hi:[0,1]
    v_pk_fma_f32 v[76:77], v[162:163], v[136:137], v[76:77] op_sel:[1,1,0] op_sel_hi:[1,0,1] neg_lo:[1,0,0]
    v_pk_fma_f32 v[78:79], v[164:165], v[136:137], v[78:79] op_sel:[1,1,0] op_sel_hi:[1,0,1] neg_lo:[1,0,0]
    v_pk_fma_f32 v[80:81], v[166:167], v[136:137], v[80:81] op_sel:[1,1,0] op_sel_hi:[1,0,1] neg_lo:[1,0,0]
    v_pk_fma_f32 v[94:95], v[166:167], v[138:139], v[94:95] op_sel:[1,1,0] op_sel_hi:[1,0,1] neg_lo:[1,0,0]
    v_pk_fma_f32 v[82:83], v[92:93], v[144:145], v[82:83] op_sel:[1,1,0] op_sel_hi:[1,0,1] neg_lo:[1,0,0]
    v_cvt_pk_f16_f32 v123, v76, -v77
    v_cvt_pk_f16_f32 v124, v78, -v79
    v_cvt_pk_f16_f32 v125, v80, -v81
    v_cvt_pk_f16_f32 v126, v94, -v95
    v_cvt_pk_f16_f32 v127, v82, v83
    v_pk_mul_f32 v[72:73], v[94:95], v[136:137] op_sel:[0,0] op_sel_hi:[0,1]
    v_pk_fma_f32 v[72:73], v[94:95], v[136:137], v[72:73] op_sel:[1,1,0] op_sel_hi:[1,0,1] neg_lo:[1,0,0]
    v_cvt_pk_f16_f32 v128, v72, -v73
    s_setprio 3
    s_nop 1
    s_branch ld_main
kg_pre:
    s_lshl_b32 s53, s24, 10
    s_lshl_b32 s34, s25, 13
    s_add_u32 s53, s53, s34
    s_add_u32 s53, s53, s51
    s_add_u32 s53, s53, 2097152
    s_lshl_b32 s54, s36, 19
    s_lshl_b32 s34, s28, 16
    s_add_u32 s54, s54, s34
    s_lshl_b32 s34, s37, 2
    s_add_u32 s54, s54, s34
    s_add_u32 s54, s54, 14680064
    s_lshl_b32 s55, s36, 8
    s_lshl_b32 s34, s37, 5
    s_add_u32 s55, s55, s34
    s_lshl_b32 s34, s28, 5
    s_add_u32 s55, s55, s34
    s_add_u32 s55, s55, 11599872
    s_lshr_b32 s20, s28, 2
    s_mul_i32 s35, s20, 49152
    s_and_b32 s37, s28, 1
    v_mul_u32_u24 v36, 1088, v13
    v_bfe_u32 v6, v1, 2, 2
    v_mul_u32_u24 v6, 272, v6
    v_add_u32 v36, v36, v6
    v_and_b32 v6, 3, v1
    v_lshl_add_u32 v36, v6, 2, v36
    s_mul_i32 s33, s37, 4352
    s_add_u32 s33, s33, s35
    v_add_u32 v36, s33, v36
    s_barrier
    ds_write_b128 v10, v[32:35]
    v_mov_b32 v6, 0
    v_and_b32 v7, 7, v1
    v_lshlrev_b32 v7, 2, v7
    v_add_u32 v7, 126976, v7
    ds_write_b32 v7, v6
    s_lshl_b32 s33, s20, 4
    s_add_u32 s33, s33, 126976
    v_mov_b32 v37, s33
    v_mov_b32 v38, 1
    s_add_u32 s21, s35, 34816
    s_mul_i32 s22, s20, 9216
    s_add_u32 s22, s22, 131072
    v_mul_u32_u24 v100, 272, v13
    v_lshl_add_u32 v100, v12, 4, v100
    v_add_u32 v100, s35, v100
    s_mul_i32 s33, s39, 8704
    v_add_u32 v39, s33, v100
    v_mov_b32 v101, s35
    v_lshlrev_b32 v6, 3, v12
    v_add_u32 v60, v60, v6
    v_add_u32 v61, v61, v6
    v_add_u32 v62, v62, v6
    v_add_u32 v63, v63, v6
    v_cvt_f32_u32 v20, v60
    v_cvt_f32_u32 v21, v61
    v_cvt_f32_u32 v22, v62
    v_cvt_f32_u32 v23, v63
    v_lshrrev_b32 v24, 3, v60
    v_lshrrev_b32 v25, 3, v61
    v_lshrrev_b32 v26, 3, v62
    v_lshrrev_b32 v27, 3, v63
    v_add_u32 v60, v60, v24
    v_add_u32 v61, v61, v25
    v_add_u32 v62, v62, v26
    v_add_u32 v63, v63, v27
    v_lshl_add_u32 v60, v60, 2, s21
    v_lshl_add_u32 v61, v61, 2, s21
    v_lshl_add_u32 v62, v62, 2, s21
    v_lshl_add_u32 v63, v63, 2, s21
    v_add_u32_sdwa v84, v56, s21 dst_sel:DWORD dst_unused:UNUSED_PAD src0_sel:WORD_0 src1_sel:DWORD
    v_add_u32_sdwa v85, v56, s21 dst_sel:DWORD dst_unused:UNUSED_PAD src0_sel:WORD_1 src1_sel:DWORD
    v_add_u32_sdwa v86, v57, s21 dst_sel:DWORD dst_unused:UNUSED_PAD src0_sel:WORD_0 src1_sel:DWORD
    v_add_u32_sdwa v87, v57, s21 dst_sel:DWORD dst_unused:UNUSED_PAD src0_sel:WORD_1 src1_sel:DWORD
    v_add_u32_sdwa v88, v58, s21 dst_sel:DWORD dst_unused:UNUSED_PAD src0_sel:WORD_0 src1_sel:DWORD
    v_add_u32_sdwa v89, v58, s21 dst_sel:DWORD dst_unused:UNUSED_PAD src0_sel:WORD_1 src1_sel:DWORD
    v_add_u32_sdwa v90, v59, s21 dst_sel:DWORD dst_unused:UNUSED_PAD src0_sel:WORD_0 src1_sel:DWORD
    v_add_u32_sdwa v91, v59, s21 dst_sel:DWORD dst_unused:UNUSED_PAD src0_sel:WORD_1 src1_sel:DWORD
    v_add_u32_sdwa v92, v55, s21 dst_sel:DWORD dst_unused:UNUSED_PAD src0_sel:WORD_0 src1_sel:DWORD
    s_lshl_b32 s33, s39, 10
    s_add_u32 s33, s33, s22
    v_add_u32 v102, s33, v5
    v_add_u32 v6, 1, v12
    v_lshrrev_b32 v6, 1, v6
    v_lshlrev_b32 v6, 2, v6
    v_lshlrev_b32 v7, 4, v13
    v_sub_u32 v6, v7, v6
    v_and_b32 v7, 1, v12
    v_mul_u32_u24 v7, 4416, v7
    s_lshl_b32 s33, s39, 6
    s_sub_u32 s33, s22, s33
    s_add_u32 s33, s33, 480
    v_add3_u32 v93, v6, v7, s33
    v_add_u32 v94, 1024, v93
    v_add_u32 v95, 2048, v93
    v_add_u32 v96, 3072, v93
    v_lshrrev_b32 v6, 3, v1
    s_lshl_b32 s29, s28, 3
    v_add_u32 v7, s29, v6
    v_and_b32 v2, 0x33, v7
    v_bfe_u32 v8, v7, 2, 1
    v_lshl_add_u32 v2, v8, 3, v2
    v_bfe_u32 v8, v7, 3, 1
    v_lshl_add_u32 v2, v8, 2, v2
    v_lshlrev_b32 v2, 7, v2
    v_bfe_u32 v7, v1, 1, 2
    v_xor_b32 v7, v7, v13
    v_lshl_add_u32 v2, v7, 5, v2
    v_and_b32 v8, 1, v1
    v_lshl_add_u32 v2, v8, 4, v2
    s_lshl_b32 s33, s24, 10
    v_add_u32 v2, s33, v2
    v_and_b32 v7, 3, v1
    v_lshl_add_u32 v7, v7, 1, s29
    v_and_b32 v0, 0x33, v7
    v_bfe_u32 v9, v7, 2, 1
    v_lshl_add_u32 v0, v9, 3, v0
    v_bfe_u32 v9, v7, 3, 1
    v_lshl_add_u32 v0, v9, 2, v0
    v_lshlrev_b32 v0, 7, v0
    v_bfe_u32 v7, v1, 2, 3
    v_lshl_add_u32 v0, v7, 13, v0
    s_add_u32 s33, s33, 252
    v_add_u32 v0, s33, v0
    s_lshl_b32 s29, s28, 5
    v_lshrrev_b32 v7, 1, v1
    v_add_u32 v7, s29, v7
    v_and_b32 v3, 0x33, v7
    v_bfe_u32 v9, v7, 2, 1
    v_lshl_add_u32 v3, v9, 3, v3
    v_bfe_u32 v9, v7, 3, 1
    v_lshl_add_u32 v3, v9, 2, v3
    v_lshlrev_b32 v3, 5, v3
    v_lshl_add_u32 v3, v8, 4, v3
    s_lshl_b32 s29, s24, 8
    s_add_u32 s29, s29, 2080768
    s_cmp_eq_u32 s24, 0
    s_cselect_b32 s29, 0x7f000000, s29
    v_add_u32 v3, s29, v3
    v_and_b32 v7, 31, v1
    v_bfe_u32 v9, v1, 4, 1
    v_mul_u32_u24 v9, 16, v9
    s_cmp_lt_u32 s28, 2
    s_cselect_b32 s33, 1, 0
    v_mad_u32_u24 v7, v9, s33, v7
    s_cselect_b32 s33, 10, 11
    s_lshl_b32 s33, s28, s33
    s_add_u32 s33, s33, s29
    s_add_u32 s33, s33, 60
    s_mov_b32 exec_lo, 0
    v_lshl_add_u32 v0, v7, 6, s33
    s_mov_b32 exec_lo, -1
    s_mov_b32 s63, 0x800
    s_mov_b32 s26, 0x2000
    s_mov_b32 s40, -1
    s_mov_b32 s44, 0
    s_add_u32 s4, s66, 0x00800000
    s_addc_u32 s5, s67, 0
    s_mov_b32 s6, 0x00280000
    s_mov_b32 s7, 0x00020000
    s_max_u32 s29, s28, 3
    s_sub_u32 s29, s29, 3
    v_lshrrev_b32 v10, 5, v1
    v_lshlrev_b32 v10, 4, v10
    v_bfe_u32 v9, v1, 2, 3
    v_add_u32 v10, v10, v9
    v_and_b32 v9, 3, v1
    v_lshlrev_b32 v9, 3, v9
    v_lshl_add_u32 v11, v10, 5, v9
    v_add_u32 v11, 0x2000, v11
    v_lshl_add_u32 v10, v10, 7, v9
    v_bfe_u32 v9, v1, 3, 2
    s_sub_u32 s33, s29, 1
    v_xor_b32 v9, s33, v9
    v_and_b32 v9, 3, v9
    v_lshl_add_u32 v10, v9, 5, v10
    s_cmp_eq_u32 s29, 0
    s_cselect_b64 s[46:47], -1, 0
    v_cndmask_b32 v8, v10, v11, s[46:47]
    s_cselect_b32 s45, 4, 16
    s_lshl_b32 s45, s45, 6
    v_add_u32 v11, s45, v8
    s_lshl_b32 s45, s45, 2
    s_add_u32 s33, s21, 13800
    v_mov_b32 v6, s33
    v_and_b32 v7, 1, v1
    v_lshl_add_u32 v7, v7, 4, s22
    s_lshl_b32 s33, s37, 3
    s_add_u32 s33, s33, s35
    v_mov_b32 v9, s33
    v_mov_b32 v16, 0
    v_mov_b32 v17, 0
    v_mov_b32 v18, 0
    v_mov_b32 v19, 0
    s_waitcnt lgkmcnt(0)
    s_barrier
    s_cmp_lt_u32 s39, 2
    s_cbranch_scc0 kg_put1
    v_add_u32 v98, 0, v36
    ds_write2_b32 v98, v104, v105 offset0:0 offset1:4
    ds_write2_b32 v98, v106, v111 offset0:8 offset1:12
    ds_write2_b32 v98, v107, v112 offset0:16 offset1:20
    ds_write2_b32 v98, v113, v117 offset0:24 offset1:28
    ds_write2_b32 v98, v108, v119 offset0:32 offset1:36
    ds_write2_b32 v98, v120, v121 offset0:40 offset1:44
    ds_write2_b32 v98, v122, v123 offset0:48 offset1:52
    ds_write2_b32 v98, v124, v125 offset0:56 offset1:60
    v_add_u32 v99, 8704, v36
    ds_write2_b32 v99, v109, v126 offset0:0 offset1:4
    ds_write2_b32 v99, v127, v128 offset0:8 offset1:12
    ds_write2_b32 v99, v114, v129 offset0:16 offset1:20
    ds_write2_b32 v99, v130, v131 offset0:24 offset1:28
    ds_write2_b32 v99, v110, v132 offset0:32 offset1:36
    ds_write2_b32 v99, v115, v133 offset0:40 offset1:44
    ds_write2_b32 v99, v116, v134 offset0:48 offset1:52
    ds_write2_b32 v99, v118, v135 offset0:56 offset1:60
    s_branch kg_tabdone
kg_put1:
    v_add_u32 v98, 17408, v36
    ds_write2_b32 v98, v105, v110 offset0:0 offset1:4
    ds_write2_b32 v98, v111, v120 offset0:8 offset1:12
    ds_write2_b32 v98, v112, v121 offset0:16 offset1:20
    ds_write2_b32 v98, v122, v127 offset0:24 offset1:28
    ds_write_b32 v98, v113 offset:128
    v_add_u32 v99, 26112, v36
    ds_write2_b32 v99, v104, v106 offset0:0 offset1:4
    ds_write2_b32 v99, v107, v114 offset0:8 offset1:12
    ds_write2_b32 v99, v108, v115 offset0:16 offset1:20
    ds_write2_b32 v99, v116, v123 offset0:24 offset1:28
    ds_write2_b32 v99, v109, v117 offset0:32 offset1:36
    ds_write2_b32 v99, v118, v124 offset0:40 offset1:44
    ds_write2_b32 v99, v119, v125 offset0:48 offset1:52
    ds_write2_b32 v99, v126, v128 offset0:56 offset1:60
    ds_write_b64 v9, v[68:69] offset:48640
kg_tabdone:
    ds_write_b32 v6, v16
    ds_write_b128 v7, v[16:19] offset:4352
    ds_write_b128 v7, v[16:19] offset:8768
    s_waitcnt lgkmcnt(0)
    s_mov_b64 exec, 1
    ds_add_u32 v37, v38 offset:0
    s_mov_b64 exec, -1
    s_mov_b32 s34, 0
kg_sy0:
    ds_read_b32 v6, v37 offset:0
    s_add_u32 s34, s34, 1
    s_waitcnt lgkmcnt(0)
    v_readfirstlane_b32 s33, v6
    s_cmp_gt_u32 s34, 32768
    s_cbranch_scc1 kg_sd0
    s_cmp_lt_u32 s33, 4
    s_cbranch_scc1 kg_sy0
kg_sd0:
    s_cmp_lt_u32 s39, 3
    s_cbranch_scc0 kg_fin
    ds_read_b128 v[16:19], v101 offset:48640
    ds_read_b128 v[104:107], v39 offset:0
    ds_read_b128 v[108:111], v100 offset:26112
    ds_read_b128 v[112:115], v39 offset:1088
    ds_read_b128 v[116:119], v100 offset:27200
    ds_read_b128 v[120:123], v39 offset:2176
    ds_read_b128 v[124:127], v100 offset:28288
    ds_read_b128 v[128:131], v39 offset:3264
    ds_read_b128 v[132:135], v100 offset:29376
    ds_read_b128 v[136:139], v39 offset:4352
    ds_read_b128 v[140:143], v100 offset:30464
    ds_read_b128 v[144:147], v39 offset:5440
    ds_read_b128 v[148:151], v100 offset:31552
    ds_read_b128 v[152:155], v39 offset:6528
    ds_read_b128 v[156:159], v100 offset:32640
    ds_read_b128 v[160:163], v39 offset:7616
    ds_read_b128 v[164:167], v100 offset:33728
    s_waitcnt lgkmcnt(15)
    v_mul_f32 v24, v20, v16
    v_mul_f32 v20, v20, v18
    v_mul_f32 v25, v21, v16
    v_mul_f32 v21, v21, v18
    v_mul_f32 v26, v22, v16
    v_mul_f32 v22, v22, v18
    v_mul_f32 v27, v23, v16
    v_mul_f32 v23, v23, v18
    s_waitcnt lgkmcnt(14)
    v_mfma_f32_16x16x32_f16 v[28:31], v[104:107], v[108:111], 0
    v_exp_f32 v24, v24
    v_exp_f32 v20, v20
    s_waitcnt lgkmcnt(12)
    v_mfma_f32_16x16x32_f16 v[28:31], v[112:115], v[116:119], v[28:31]
    v_exp_f32 v25, v25
    v_exp_f32 v21, v21
    s_waitcnt lgkmcnt(10)
    v_mfma_f32_16x16x32_f16 v[28:31], v[120:123], v[124:127], v[28:31]
    v_exp_f32 v26, v26
    v_exp_f32 v22, v22
    s_waitcnt lgkmcnt(8)
    v_mfma_f32_16x16x32_f16 v[28:31], v[128:131], v[132:135], v[28:31]
    v_exp_f32 v27, v27
    v_exp_f32 v23, v23
    s_waitcnt lgkmcnt(6)
    v_mfma_f32_16x16x32_f16 v[32:35], v[136:139], v[140:143], 0
    v_mul_f32 v24, v24, v17
    v_mul_f32 v20, v20, v19
    s_waitcnt lgkmcnt(4)
    v_mfma_f32_16x16x32_f16 v[32:35], v[144:147], v[148:151], v[32:35]
    v_mul_f32 v25, v25, v17
    v_mul_f32 v21, v21, v19
    s_waitcnt lgkmcnt(2)
    v_mfma_f32_16x16x32_f16 v[32:35], v[152:155], v[156:159], v[32:35]
    v_mul_f32 v26, v26, v17
    v_mul_f32 v22, v22, v19
    s_waitcnt lgkmcnt(0)
    v_mfma_f32_16x16x32_f16 v[32:35], v[160:163], v[164:167], v[32:35]
    v_mul_f32 v27, v27, v17
    v_mul_f32 v23, v23, v19
    v_mul_f32 v28, v28, v24
    v_mul_f32 v29, v29, v25
    v_mul_f32 v30, v30, v26
    v_mul_f32 v31, v31, v27
    s_nop 1
    v_fma_f32 v28, v32, v20, v28
    v_fma_f32 v29, v33, v21, v29
    v_fma_f32 v30, v34, v22, v30
    v_fma_f32 v31, v35, v23, v31
    ds_write_b32 v60, v28
    ds_write_b32 v61, v29
    ds_write_b32 v62, v30
    ds_write_b32 v63, v31
kg_fin:
    s_waitcnt lgkmcnt(0)
    s_mov_b64 exec, 1
    ds_add_u32 v37, v38 offset:4
    s_mov_b64 exec, -1
    s_mov_b32 s34, 0
kg_sy1:
    ds_read_b32 v6, v37 offset:4
    s_add_u32 s34, s34, 1
    s_waitcnt lgkmcnt(0)
    v_readfirstlane_b32 s33, v6
    s_cmp_gt_u32 s34, 32768
    s_cbranch_scc1 kg_sd1
    s_cmp_lt_u32 s33, 4
    s_cbranch_scc1 kg_sy1
kg_sd1:
    ds_read_b32 v84, v84
    ds_read_b32 v85, v85
    ds_read_b32 v86, v86
    ds_read_b32 v87, v87
    ds_read_b32 v88, v88
    ds_read_b32 v89, v89
    ds_read_b32 v90, v90
    ds_read_b32 v91, v91
    ds_read_b32 v92, v92
    s_waitcnt lgkmcnt(0)
    v_cvt_pk_bf16_f32 v16, v84, v85
    v_cvt_pk_bf16_f32 v20, v85, v86
    v_cvt_pk_bf16_f32 v17, v86, v87
    v_cvt_pk_bf16_f32 v21, v87, v88
    v_cvt_pk_bf16_f32 v18, v88, v89
    v_cvt_pk_bf16_f32 v22, v89, v90
    v_cvt_pk_bf16_f32 v19, v90, v91
    v_cvt_pk_bf16_f32 v23, v91, v92
    ds_write_b128 v102, v[16:19] offset:256
    ds_write_b128 v102, v[20:23] offset:4672
    s_cmp_eq_u32 s39, 3
    s_cbranch_scc0 kg_not0
    s_mov_b32 exec_lo, 0
    s_mov_b32 exec_hi, 0x80000000
    ds_write_b16_d16_hi v102, v23 offset:272
    s_mov_b64 exec, -1
kg_not0:
    s_waitcnt lgkmcnt(0)
    s_mov_b64 exec, 1
    ds_add_u32 v37, v38 offset:8
    s_mov_b64 exec, -1
    s_mov_b32 s34, 0
kg_sy2:
    ds_read_b32 v6, v37 offset:8
    s_add_u32 s34, s34, 1
    s_waitcnt lgkmcnt(0)
    v_readfirstlane_b32 s33, v6
    s_cmp_gt_u32 s34, 32768
    s_cbranch_scc1 kg_sd2
    s_cmp_lt_u32 s33, 4
    s_cbranch_scc1 kg_sy2
kg_sd2:
    ds_read2_b32 v[104:105], v96 offset0:192 offset1:193
    ds_read2_b32 v[106:107], v96 offset0:194 offset1:195
    ds_read2_b32 v[108:109], v96 offset0:128 offset1:129
    ds_read2_b32 v[110:111], v96 offset0:130 offset1:131
    ds_read2_b32 v[112:113], v96 offset0:64 offset1:65
    ds_read2_b32 v[114:115], v96 offset0:66 offset1:67
    ds_read2_b32 v[116:117], v96 offset0:0 offset1:1
    ds_read2_b32 v[118:119], v96 offset0:2 offset1:3
    ds_read2_b32 v[120:121], v95 offset0:192 offset1:193
    ds_read2_b32 v[122:123], v95 offset0:194 offset1:195
    ds_read2_b32 v[124:125], v95 offset0:128 offset1:129
    ds_read2_b32 v[126:127], v95 offset0:130 offset1:131
    ds_read2_b32 v[128:129], v95 offset0:64 offset1:65
    ds_read2_b32 v[130:131], v95 offset0:66 offset1:67
    ds_read2_b32 v[132:133], v95 offset0:0 offset1:1
    ds_read2_b32 v[134:135], v95 offset0:2 offset1:3
    ds_read2_b32 v[136:137], v94 offset0:192 offset1:193
    ds_read2_b32 v[138:139], v94 offset0:194 offset1:195
    ds_read2_b32 v[140:141], v94 offset0:128 offset1:129
    ds_read2_b32 v[142:143], v94 offset0:130 offset1:131
    ds_read2_b32 v[144:145], v94 offset0:64 offset1:65
    ds_read2_b32 v[146:147], v94 offset0:66 offset1:67
    ds_read2_b32 v[148:149], v94 offset0:0 offset1:1
    ds_read2_b32 v[150:151], v94 offset0:2 offset1:3
    ds_read2_b32 v[152:153], v93 offset0:192 offset1:193
    ds_read2_b32 v[154:155], v93 offset0:194 offset1:195
    ds_read2_b32 v[156:157], v93 offset0:128 offset1:129
    ds_read2_b32 v[158:159], v93 offset0:130 offset1:131
    ds_read2_b32 v[160:161], v93 offset0:64 offset1:65
    ds_read2_b32 v[162:163], v93 offset0:66 offset1:67
    ds_read2_b32 v[164:165], v93 offset0:0 offset1:1
    ds_read2_b32 v[166:167], v93 offset0:2 offset1:3
cv_setup:
    s_lshr_b32 s20, s28, 2
    v_lshlrev_b32 v9, 5, v12
    v_lshl_add_u32 v9, v13, 4, v9
    s_mul_i32 s33, s20, 5120
    s_lshl_b32 s34, s39, 6
    s_sub_u32 s34, s33, s34
    s_add_u32 s34, s34, 150240
    v_add_u32 v9, s34, v9
    v_mul_u32_u24 v10, 320, v13
    v_lshl_add_u32 v10, v12, 4, v10
    s_mul_i32 s34, s28, 5120
    s_lshl_b32 s21, s20, 5
    s_add_u32 s34, s34, s21
    s_add_u32 s34, s34, 69632
    v_add_u32 v10, s34, v10
    s_cmp_eq_u32 s39, 0
    s_cbranch_scc0 cv_nozero
    v_mov_b32 v16, 0
    v_mov_b32 v17, 0
    v_mov_b32 v18, 0
    v_mov_b32 v19, 0
    s_add_u32 s33, s33, 149504
    v_add_u32 v6, s33, v5
    ds_write_b128 v6, v[16:19]
cv_nozero:
    s_waitcnt lgkmcnt(0)
    s_barrier
    ds_read_b128 v[40:43], v9 offset:0
    ds_read_b128 v[44:47], v9 offset:256
    ds_read_b128 v[48:51], v9 offset:512
    ds_read_b128 v[52:55], v9 offset:768
    s_cmp_eq_u32 s52, 1
    s_cbranch_scc0 cv_nopre
    s_add_u32 m0, s50, 0
    s_mov_b32 s32, 0
    buffer_load_dwordx4 v4, s[8:11], s32 offen offset:0 lds
    buffer_load_dwordx4 v4, s[8:11], s32 offen offset:1024 lds
    buffer_load_dwordx4 v4, s[8:11], s32 offen offset:2048 lds
    s_add_u32 m0, s50, 34816
    s_mov_b32 s32, 196608
    buffer_load_dwordx4 v4, s[8:11], s32 offen offset:0 lds
    buffer_load_dwordx4 v4, s[8:11], s32 offen offset:1024 lds
    buffer_load_dwordx4 v4, s[8:11], s32 offen offset:2048 lds
cv_nopre:
    s_waitcnt lgkmcnt(3)
    v_mfma_f32_16x16x32_bf16 v[16:19], v[108:111], v[40:43], 0
    v_mfma_f32_16x16x32_bf16 v[20:23], v[116:119], v[40:43], 0
    s_waitcnt lgkmcnt(2)
    v_mfma_f32_16x16x32_bf16 v[16:19], v[104:107], v[44:47], v[16:19]
    v_mfma_f32_16x16x32_bf16 v[20:23], v[112:115], v[44:47], v[20:23]
    s_waitcnt lgkmcnt(1)
    v_mfma_f32_16x16x32_bf16 v[20:23], v[108:111], v[48:51], v[20:23]
    s_waitcnt lgkmcnt(0)
    v_mfma_f32_16x16x32_bf16 v[20:23], v[104:107], v[52:55], v[20:23]
    v_mfma_f32_16x16x32_bf16 v[24:27], v[124:127], v[40:43], 0
    v_mfma_f32_16x16x32_bf16 v[28:31], v[132:135], v[40:43], 0
    s_nop 0
    ds_write_b128 v10, v[16:19] offset:0
    v_mfma_f32_16x16x32_bf16 v[24:27], v[120:123], v[44:47], v[24:27]
    s_nop 2
    ds_write_b128 v10, v[20:23] offset:1280
    v_mfma_f32_16x16x32_bf16 v[28:31], v[128:131], v[44:47], v[28:31]
    s_waitcnt lgkmcnt(0)
    s_barrier
    ds_read_b128 v[56:59], v9 offset:1024
    ds_read_b128 v[60:63], v9 offset:1280
    ds_read_b128 v[64:67], v9 offset:1536
    ds_read_b128 v[68:71], v9 offset:1792
    s_cmp_eq_u32 s52, 1
    s_cbranch_scc0 cv_nopf
    v_mov_b32 v32, -1
    v_mov_b32 v33, -1
    v_mov_b32 v34, -1
    v_mov_b32 v35, -1
    v_lshrrev_b32 v6, 3, v1
    v_lshlrev_b32 v6, 13, v6
    v_and_b32 v7, 7, v1
    v_lshl_add_u32 v6, v7, 4, v6
    buffer_store_dwordx4 v[32:35], v5, s[16:19], s53 offen sc1
    buffer_store_dwordx4 v[32:35], v6, s[16:19], s54 offen sc1
    s_mov_b64 exec, 3
    buffer_store_dwordx4 v[32:35], v5, s[16:19], s55 offen sc1
    s_mov_b64 exec, -1
cv_nopf:
    v_mfma_f32_16x16x32_bf16 v[24:27], v[116:119], v[48:51], v[24:27]
    v_mfma_f32_16x16x32_bf16 v[28:31], v[124:127], v[48:51], v[28:31]
    v_mfma_f32_16x16x32_bf16 v[24:27], v[112:115], v[52:55], v[24:27]
    v_mfma_f32_16x16x32_bf16 v[28:31], v[120:123], v[52:55], v[28:31]
    s_waitcnt lgkmcnt(3)
    v_mfma_f32_16x16x32_bf16 v[24:27], v[108:111], v[56:59], v[24:27]
    v_mfma_f32_16x16x32_bf16 v[28:31], v[116:119], v[56:59], v[28:31]
    s_waitcnt lgkmcnt(2)
    v_mfma_f32_16x16x32_bf16 v[24:27], v[104:107], v[60:63], v[24:27]
    v_mfma_f32_16x16x32_bf16 v[28:31], v[112:115], v[60:63], v[28:31]
    s_waitcnt lgkmcnt(1)
    v_mfma_f32_16x16x32_bf16 v[28:31], v[108:111], v[64:67], v[28:31]
    s_waitcnt lgkmcnt(0)
    v_mfma_f32_16x16x32_bf16 v[28:31], v[104:107], v[68:71], v[28:31]
    v_mfma_f32_16x16x32_bf16 v[16:19], v[140:143], v[40:43], 0
    v_mfma_f32_16x16x32_bf16 v[20:23], v[148:151], v[40:43], 0
    s_nop 0
    ds_write_b128 v10, v[24:27] offset:2560
    v_mfma_f32_16x16x32_bf16 v[16:19], v[136:139], v[44:47], v[16:19]
    s_nop 2
    ds_write_b128 v10, v[28:31] offset:3840
    v_mfma_f32_16x16x32_bf16 v[20:23], v[144:147], v[44:47], v[20:23]
    v_mfma_f32_16x16x32_bf16 v[16:19], v[132:135], v[48:51], v[16:19]
    v_mfma_f32_16x16x32_bf16 v[20:23], v[140:143], v[48:51], v[20:23]
    v_mfma_f32_16x16x32_bf16 v[16:19], v[128:131], v[52:55], v[16:19]
    v_mfma_f32_16x16x32_bf16 v[20:23], v[136:139], v[52:55], v[20:23]
    s_waitcnt lgkmcnt(0)
    s_barrier
    ds_read_b128 v[72:75], v9 offset:2048
    ds_read_b128 v[76:79], v9 offset:2304
    ds_read_b128 v[80:83], v9 offset:2560
    ds_read_b128 v[84:87], v9 offset:2816
    v_mfma_f32_16x16x32_bf16 v[16:19], v[124:127], v[56:59], v[16:19]
    v_mfma_f32_16x16x32_bf16 v[20:23], v[132:135], v[56:59], v[20:23]
    v_mfma_f32_16x16x32_bf16 v[16:19], v[120:123], v[60:63], v[16:19]
    v_mfma_f32_16x16x32_bf16 v[20:23], v[128:131], v[60:63], v[20:23]
    v_mfma_f32_16x16x32_bf16 v[16:19], v[116:119], v[64:67], v[16:19]
    v_mfma_f32_16x16x32_bf16 v[20:23], v[124:127], v[64:67], v[20:23]
    v_mfma_f32_16x16x32_bf16 v[16:19], v[112:115], v[68:71], v[16:19]
    v_mfma_f32_16x16x32_bf16 v[20:23], v[120:123], v[68:71], v[20:23]
    s_waitcnt lgkmcnt(3)
    v_mfma_f32_16x16x32_bf16 v[16:19], v[108:111], v[72:75], v[16:19]
    v_mfma_f32_16x16x32_bf16 v[20:23], v[116:119], v[72:75], v[20:23]
    s_waitcnt lgkmcnt(2)
    v_mfma_f32_16x16x32_bf16 v[16:19], v[104:107], v[76:79], v[16:19]
    v_mfma_f32_16x16x32_bf16 v[20:23], v[112:115], v[76:79], v[20:23]
    s_waitcnt lgkmcnt(1)
    v_mfma_f32_16x16x32_bf16 v[20:23], v[108:111], v[80:83], v[20:23]
    s_waitcnt lgkmcnt(0)
    v_mfma_f32_16x16x32_bf16 v[20:23], v[104:107], v[84:87], v[20:23]
    v_mfma_f32_16x16x32_bf16 v[24:27], v[156:159], v[40:43], 0
    v_mfma_f32_16x16x32_bf16 v[28:31], v[164:167], v[40:43], 0
    s_nop 0
    ds_write_b128 v10, v[16:19] offset:0
    v_mfma_f32_16x16x32_bf16 v[24:27], v[152:155], v[44:47], v[24:27]
    s_nop 2
    ds_write_b128 v10, v[20:23] offset:1280
    v_mfma_f32_16x16x32_bf16 v[28:31], v[160:163], v[44:47], v[28:31]
    v_mfma_f32_16x16x32_bf16 v[24:27], v[148:151], v[48:51], v[24:27]
    v_mfma_f32_16x16x32_bf16 v[28:31], v[156:159], v[48:51], v[28:31]
    v_mfma_f32_16x16x32_bf16 v[24:27], v[144:147], v[52:55], v[24:27]
    v_mfma_f32_16x16x32_bf16 v[28:31], v[152:155], v[52:55], v[28:31]
    v_mfma_f32_16x16x32_bf16 v[24:27], v[140:143], v[56:59], v[24:27]
    v_mfma_f32_16x16x32_bf16 v[28:31], v[148:151], v[56:59], v[28:31]
    v_mfma_f32_16x16x32_bf16 v[24:27], v[136:139], v[60:63], v[24:27]
    v_mfma_f32_16x16x32_bf16 v[28:31], v[144:147], v[60:63], v[28:31]
    s_waitcnt lgkmcnt(0)
    s_barrier
    ds_read_b128 v[88:91], v9 offset:3072
    ds_read_b128 v[92:95], v9 offset:3328
    ds_read_b128 v[96:99], v9 offset:3584
    ds_read_b128 v[100:103], v9 offset:3840
    v_mfma_f32_16x16x32_bf16 v[24:27], v[132:135], v[64:67], v[24:27]
    v_mfma_f32_16x16x32_bf16 v[28:31], v[140:143], v[64:67], v[28:31]
    v_mfma_f32_16x16x32_bf16 v[24:27], v[128:131], v[68:71], v[24:27]
    v_mfma_f32_16x16x32_bf16 v[28:31], v[136:139], v[68:71], v[28:31]
    v_mfma_f32_16x16x32_bf16 v[24:27], v[124:127], v[72:75], v[24:27]
    v_mfma_f32_16x16x32_bf16 v[28:31], v[132:135], v[72:75], v[28:31]
    v_mfma_f32_16x16x32_bf16 v[24:27], v[120:123], v[76:79], v[24:27]
    v_mfma_f32_16x16x32_bf16 v[28:31], v[128:131], v[76:79], v[28:31]
    v_mfma_f32_16x16x32_bf16 v[24:27], v[116:119], v[80:83], v[24:27]
    v_mfma_f32_16x16x32_bf16 v[28:31], v[124:127], v[80:83], v[28:31]
    v_mfma_f32_16x16x32_bf16 v[24:27], v[112:115], v[84:87], v[24:27]
    v_mfma_f32_16x16x32_bf16 v[28:31], v[120:123], v[84:87], v[28:31]
    s_waitcnt lgkmcnt(3)
    v_mfma_f32_16x16x32_bf16 v[24:27], v[108:111], v[88:91], v[24:27]
    v_mfma_f32_16x16x32_bf16 v[28:31], v[116:119], v[88:91], v[28:31]
    s_waitcnt lgkmcnt(2)
    v_mfma_f32_16x16x32_bf16 v[24:27], v[104:107], v[92:95], v[24:27]
    v_mfma_f32_16x16x32_bf16 v[28:31], v[112:115], v[92:95], v[28:31]
    s_waitcnt lgkmcnt(1)
    v_mfma_f32_16x16x32_bf16 v[28:31], v[108:111], v[96:99], v[28:31]
    s_waitcnt lgkmcnt(0)
    v_mfma_f32_16x16x32_bf16 v[28:31], v[104:107], v[100:103], v[28:31]
    s_nop 2
    ds_write_b128 v10, v[24:27] offset:2560
    s_nop 3
    ds_write_b128 v10, v[28:31] offset:3840
    s_waitcnt lgkmcnt(0)
    s_waitcnt vmcnt(0)
    s_barrier
    s_cmp_eq_u32 s52, 2
    s_cbranch_scc0 ld_next
    s_endpgm
ld_next:
    s_setprio 3
    s_mov_b32 s52, 2
    s_mov_b32 s30, 0
    s_mov_b32 s31, 0
    s_mov_b32 s62, 0
    s_mov_b32 s34, 0
    s_cmp_lt_u32 s24, 1024
    s_cbranch_scc1 ld_nox
    s_barrier
ld_nox:
ld_pa:
    buffer_load_dword v32, v0, s[4:7], 0 offen sc1
    s_add_u32 s34, s34, 1
    s_waitcnt vmcnt(0)
    v_cmp_eq_u32 vcc, -1, v32
    s_cmp_gt_u32 s34, 32768
    s_cbranch_scc1 ld_pad
    s_nop 1
    s_and_b64 exec, exec, vcc
    s_cbranch_scc1 ld_pa
ld_pad:
    s_mov_b64 exec, -1
    s_add_u32 m0, s30, s51
    s_mov_b64 exec, s[40:41]
    buffer_load_dwordx4 v2, s[4:7], s31 offen sc1 lds
    s_mov_b64 exec, -1
    s_cmp_lt_u32 s28, 2
    s_cbranch_scc0 ld_x2_0
    s_add_u32 m0, m0, 8192
    s_nop 0
    buffer_load_dwordx4 v3, s[4:7], s62 offen sc1 lds
    s_add_u32 s62, s62, s63
ld_x2_0:
    s_add_u32 s31, s31, s26
    s_add_u32 s30, s30, 34816
    s_add_u32 m0, s30, s51
    s_mov_b64 exec, s[40:41]
    buffer_load_dwordx4 v2, s[4:7], s31 offen sc1 lds
    s_mov_b64 exec, -1
    s_cmp_lt_u32 s28, 2
    s_cbranch_scc0 ld_x2_1
    s_add_u32 m0, m0, 8192
    s_nop 0
    buffer_load_dwordx4 v3, s[4:7], s62 offen sc1 lds
    s_add_u32 s62, s62, s63
ld_x2_1:
    s_add_u32 s31, s31, s26
    s_add_u32 s30, s30, 34816
    s_mov_b32 s32, 393216
    s_lshl_b32 s60, s39, 11
    s_lshl_b32 s33, s38, 10
    s_add_u32 s60, s60, s33
    s_add_u32 s60, s60, 106496
    s_mov_b32 s61, 0
    s_mov_b32 s36, 0
    v_mov_b32 v24, 0x3f803f80
    v_mov_b32 v25, 0x3f803f80
    v_mov_b32 v26, 0x3f803f80
    v_mov_b32 v27, 0x3f803f80
    v_mov_b32 v28, 0x3f803f80
    v_mov_b32 v29, 0x3f803f80
    v_mov_b32 v30, 0x3f803f80
    v_mov_b32 v31, 0x3f803f80
    v_mov_b32 v40, 0
    v_mov_b32 v41, 0
    v_mov_b32 v42, 0
    v_mov_b32 v43, 0
    v_mov_b32 v44, 0
    v_mov_b32 v45, 0
    v_mov_b32 v46, 0
    v_mov_b32 v47, 0
    s_cmp_eq_u32 s28, 0
    s_cbranch_scc0 ld_nozf_9
    v_mov_b32 v6, 0
    v_and_b32 v7, 7, v1
    v_lshlrev_b32 v7, 2, v7
    v_add_u32 v7, 106368, v7
    ds_write_b32 v7, v6
ld_nozf_9:
    s_waitcnt vmcnt(2)
    s_cmp_lt_u32 s28, 2
    s_cbranch_scc1 ld_main
    s_waitcnt vmcnt(1)
    s_branch ld_main
comp_start:
    v_lshrrev_b32 v6, 5, v1
    v_mul_u32_u24 v6, 6144, v6
    v_bfe_u32 v8, v1, 2, 3
    v_lshl_add_u32 v6, v8, 7, v6
    v_bfe_u32 v8, v1, 3, 2
    v_xor_b32 v8, s27, v8
    v_lshl_add_u32 v6, v8, 5, v6
    v_and_b32 v8, 3, v1
    v_lshl_add_u32 v6, v8, 3, v6
    v_add_u32 v6, 10240, v6
    v_add_u32 v7, 69632, v6
    v_and_b32 v2, 1, v12
    v_lshl_add_u32 v3, v13, 2, v2
    v_cmp_eq_u32 s[42:43], 1, v2
    v_cmp_le_u32 s[44:45], v3, v12
    v_add_u32 v3, 2, v3
    v_cmp_le_u32 s[46:47], v3, v12
    s_cmp_eq_u32 s24, 0
    s_cselect_b64 s[48:49], -1, 0
    v_lshrrev_b32 v8, 3, v12
    v_lshlrev_b32 v8, 10, v8
    v_and_b32 v9, 7, v12
    v_lshl_add_u32 v8, v9, 7, v8
    v_lshrrev_b32 v9, 1, v12
    v_xor_b32 v9, v9, v13
    v_lshl_add_u32 v8, v9, 4, v8
    v_xor_b32 v9, 64, v8
    v_add_u32 v10, 69632, v8
    v_add_u32 v11, 69632, v9
    v_mov_b32 v2, 0x0c0c0100
    v_mov_b32 v3, 0x01000c0c
    v_mov_b32 v4, 0x0c0c0c0c
    v_cndmask_b32 v2, v2, v3, s[42:43]
    v_cndmask_b32 v140, v2, v4, s[44:45]
    v_cndmask_b32 v142, v4, v2, s[44:45]
    v_mov_b32 v2, 0x0c0c0302
    v_mov_b32 v3, 0x03020c0c
    v_cndmask_b32 v2, v2, v3, s[42:43]
    v_cndmask_b32 v141, v2, v4, s[46:47]
    v_cndmask_b32 v143, v4, v2, s[46:47]
    v_and_b32 v2, 1, v13
    v_lshl_add_u32 v144, v2, 4, v12
    v_lshlrev_b32 v144, 5, v144
    v_lshrrev_b32 v2, 1, v13
    v_lshl_add_u32 v144, v2, 4, v144
    v_lshlrev_b32 v145, 3, v12
    v_add_u32 v145, 104448, v145
    v_lshlrev_b32 v146, 4, v13
    v_add_u32 v146, 105088, v146
    s_getreg_b32 s33, hwreg(HW_REG_XCC_ID, 0, 3)
    s_lshl_b32 s54, s33, 2
    s_lshr_b32 s55, s24, 3
    v_mov_b32 v156, -1
    v_mov_b32 v157, -1
    v_mov_b32 v158, -1
    v_mov_b32 v159, -1
    v_lshrrev_b32 v2, 3, v0
    v_lshlrev_b32 v2, 13, v2
    v_and_b32 v3, 7, v0
    v_lshl_add_u32 v160, v3, 4, v2
    v_add_u32 v161, 0x40000, v160
    v_lshrrev_b32 v2, 2, v1
    v_lshlrev_b32 v2, 14, v2
    v_and_b32 v3, 3, v1
    v_lshl_add_u32 v162, v3, 4, v2
    s_and_b32 s36, s25, 3
    s_lshr_b32 s37, s25, 2
    s_lshl_b32 s37, s37, 5
    s_add_u32 s37, s37, s24
    s_lshl_b32 s30, s24, 10
    s_lshl_b32 s31, s25, 13
    s_add_u32 s30, s30, s31
    s_lshl_b32 s38, s27, 11
    s_add_u32 s30, s30, s38
    s_lshl_b32 s31, s36, 19
    s_lshl_b32 s32, s37, 2
    s_add_u32 s31, s31, s32
    s_add_u32 s39, s31, 12582912
    s_lshl_b32 s32, s36, 8
    s_lshl_b32 s33, s37, 5
    s_add_u32 s32, s32, s33
    s_add_u32 s32, s32, 11534336
    s_lshl_b32 s36, s77, 8
    s_lshl_b32 s38, s27, 19
    s_add_u32 s36, s36, s38
    s_add_u32 s36, s36, 8388608
    s_lshl_b32 s37, s77, 6
    s_lshl_b32 s38, s27, 17
    s_add_u32 s37, s37, s38
    s_add_u32 s37, s37, 10485760
    s_lshl_b32 s33, s77, 2
    v_lshlrev_b32 v4, 7, v1
    v_lshrrev_b32 v2, 4, v1
    v_lshlrev_b32 v2, 16, v2
    v_and_b32 v3, 15, v1
    v_lshl_add_u32 v164, v3, 4, v2
    v_add_u32 v165, 0x40000, v164
    s_waitcnt lgkmcnt(0)
    s_load_dword s76, s[94:95], s33
    s_mov_b32 s12, s66
    s_mov_b32 s13, s67
    s_mov_b32 s14, 0x01800000
    s_mov_b32 s15, 0x00020000
    s_mov_b32 s8, s64
    s_mov_b32 s9, s65
    s_mov_b32 s10, 0x00000100
    s_mov_b32 s11, 0x00020000
    s_cmp_lt_u32 s27, 3
    s_cbranch_scc0 c_t3
    s_mul_i32 s33, s23, 3
    s_add_u32 s33, s33, s27
    s_lshl_b32 s33, s33, 13
    v_add_u32 v2, s33, v4
    v_add_u32 v3, 0xc0000, v2
    global_load_dword v163, v2, s[70:71]
    global_load_dword v163, v3, s[70:71]
    s_branch c_t4
c_t3:
    s_lshl_b32 s33, s22, 18
    s_lshl_b32 s34, s23, 13
    s_add_u32 s33, s33, s34
    v_add_u32 v2, s33, v4
    global_load_dword v163, v2, s[68:69]
    s_lshl_b32 s33, s23, 14
    v_add_u32 v2, s33, v4
    v_add_u32 v3, 0x2000, v2
    global_load_dword v163, v2, s[72:73]
    global_load_dword v163, v3, s[72:73]
c_t4:
    buffer_store_dwordx4 v[156:159], v5, s[12:15], s30 offen sc1
    buffer_store_dwordx4 v[156:159], v5, s[12:15], s30 offen offset:1024 sc1
    s_mov_b64 exec, 0xffff
    buffer_store_dwordx4 v[156:159], v5, s[12:15], s32 offen sc1
    s_mov_b64 exec, -1
    buffer_store_dwordx4 v[156:159], v160, s[12:15], s39 offen sc1
    buffer_store_dwordx4 v[156:159], v161, s[12:15], s39 offen sc1
    s_nop 1
c_att_rm:
    s_barrier
    ds_read_b64_tr_b16 v[96:97], v6 offset:0
    ds_read_b64_tr_b16 v[98:99], v6 offset:3072
    ds_read_b64_tr_b16 v[100:101], v6 offset:1024
    ds_read_b64_tr_b16 v[102:103], v6 offset:4096
    ds_read_b64_tr_b16 v[104:105], v6 offset:2048
    ds_read_b64_tr_b16 v[106:107], v6 offset:5120
    ds_read_b128 v[76:79], v8 offset:0
    ds_read_b128 v[80:83], v8 offset:2048
    ds_read_b128 v[84:87], v8 offset:4096
    ds_read_b128 v[88:91], v8 offset:6144
    ds_read_b128 v[92:95], v8 offset:8192
    s_waitcnt lgkmcnt(0)
    v_mfma_f32_16x16x32_bf16 v[16:19], v[96:99], v[76:79], 0
    ds_read_b64_tr_b16 v[128:129], v6 offset:12288
    v_mfma_f32_16x16x32_bf16 v[20:23], v[100:103], v[76:79], 0
    ds_read_b64_tr_b16 v[130:131], v6 offset:15360
    v_mfma_f32_16x16x32_bf16 v[24:27], v[76:79], v[104:107], 0
    ds_read_b64_tr_b16 v[132:133], v6 offset:13312
    v_mfma_f32_16x16x32_bf16 v[28:31], v[96:99], v[80:83], 0
    ds_read_b64_tr_b16 v[134:135], v6 offset:16384
    v_mfma_f32_16x16x32_bf16 v[32:35], v[100:103], v[80:83], 0
    ds_read_b64_tr_b16 v[136:137], v6 offset:14336
    v_mfma_f32_16x16x32_bf16 v[36:39], v[80:83], v[104:107], 0
    ds_read_b64_tr_b16 v[138:139], v6 offset:17408
    v_mfma_f32_16x16x32_bf16 v[40:43], v[96:99], v[84:87], 0
    ds_read_b128 v[108:111], v9 offset:0
    v_mfma_f32_16x16x32_bf16 v[44:47], v[100:103], v[84:87], 0
    ds_read_b128 v[112:115], v9 offset:2048
    v_mfma_f32_16x16x32_bf16 v[48:51], v[84:87], v[104:107], 0
    ds_read_b128 v[116:119], v9 offset:4096
    v_mfma_f32_16x16x32_bf16 v[52:55], v[96:99], v[88:91], 0
    ds_read_b128 v[120:123], v9 offset:6144
    v_mfma_f32_16x16x32_bf16 v[56:59], v[100:103], v[88:91], 0
    ds_read_b128 v[124:127], v9 offset:8192
    v_mfma_f32_16x16x32_bf16 v[60:63], v[88:91], v[104:107], 0
    v_mfma_f32_16x16x32_bf16 v[64:67], v[96:99], v[92:95], 0
    v_mfma_f32_16x16x32_bf16 v[68:71], v[100:103], v[92:95], 0
    v_mfma_f32_16x16x32_bf16 v[72:75], v[92:95], v[104:107], 0
    s_waitcnt lgkmcnt(0)
    s_barrier
    v_mfma_f32_16x16x32_bf16 v[16:19], v[128:131], v[108:111], v[16:19]
    ds_read_b64_tr_b16 v[96:97], v6 offset:34816
    v_mfma_f32_16x16x32_bf16 v[20:23], v[132:135], v[108:111], v[20:23]
    ds_read_b64_tr_b16 v[98:99], v6 offset:37888
    v_mfma_f32_16x16x32_bf16 v[24:27], v[108:111], v[136:139], v[24:27]
    ds_read_b64_tr_b16 v[100:101], v6 offset:35840
    v_mfma_f32_16x16x32_bf16 v[28:31], v[128:131], v[112:115], v[28:31]
    ds_read_b64_tr_b16 v[102:103], v6 offset:38912
    v_mfma_f32_16x16x32_bf16 v[32:35], v[132:135], v[112:115], v[32:35]
    ds_read_b64_tr_b16 v[104:105], v6 offset:36864
    v_mfma_f32_16x16x32_bf16 v[36:39], v[112:115], v[136:139], v[36:39]
    ds_read_b64_tr_b16 v[106:107], v6 offset:39936
    v_mfma_f32_16x16x32_bf16 v[40:43], v[128:131], v[116:119], v[40:43]
    ds_read_b128 v[76:79], v8 offset:34816
    v_mfma_f32_16x16x32_bf16 v[44:47], v[132:135], v[116:119], v[44:47]
    ds_read_b128 v[80:83], v8 offset:36864
    v_mfma_f32_16x16x32_bf16 v[48:51], v[116:119], v[136:139], v[48:51]
    ds_read_b128 v[84:87], v8 offset:38912
    v_mfma_f32_16x16x32_bf16 v[52:55], v[128:131], v[120:123], v[52:55]
    ds_read_b128 v[88:91], v8 offset:40960
    v_mfma_f32_16x16x32_bf16 v[56:59], v[132:135], v[120:123], v[56:59]
    ds_read_b128 v[92:95], v8 offset:43008
    v_mfma_f32_16x16x32_bf16 v[60:63], v[120:123], v[136:139], v[60:63]
    v_mfma_f32_16x16x32_bf16 v[64:67], v[128:131], v[124:127], v[64:67]
    v_mfma_f32_16x16x32_bf16 v[68:71], v[132:135], v[124:127], v[68:71]
    v_mfma_f32_16x16x32_bf16 v[72:75], v[124:127], v[136:139], v[72:75]
    s_waitcnt lgkmcnt(0)
    v_mfma_f32_16x16x32_bf16 v[16:19], v[96:99], v[76:79], v[16:19]
    ds_read_b64_tr_b16 v[128:129], v6 offset:47104
    v_mfma_f32_16x16x32_bf16 v[20:23], v[100:103], v[76:79], v[20:23]
    ds_read_b64_tr_b16 v[130:131], v6 offset:50176
    v_mfma_f32_16x16x32_bf16 v[24:27], v[76:79], v[104:107], v[24:27]
    ds_read_b64_tr_b16 v[132:133], v6 offset:48128
    v_mfma_f32_16x16x32_bf16 v[28:31], v[96:99], v[80:83], v[28:31]
    ds_read_b64_tr_b16 v[134:135], v6 offset:51200
    v_mfma_f32_16x16x32_bf16 v[32:35], v[100:103], v[80:83], v[32:35]
    ds_read_b64_tr_b16 v[136:137], v6 offset:49152
    v_mfma_f32_16x16x32_bf16 v[36:39], v[80:83], v[104:107], v[36:39]
    ds_read_b64_tr_b16 v[138:139], v6 offset:52224
    v_mfma_f32_16x16x32_bf16 v[40:43], v[96:99], v[84:87], v[40:43]
    ds_read_b128 v[108:111], v9 offset:34816
    v_mfma_f32_16x16x32_bf16 v[44:47], v[100:103], v[84:87], v[44:47]
    ds_read_b128 v[112:115], v9 offset:36864
    v_mfma_f32_16x16x32_bf16 v[48:51], v[84:87], v[104:107], v[48:51]
    ds_read_b128 v[116:119], v9 offset:38912
    v_mfma_f32_16x16x32_bf16 v[52:55], v[96:99], v[88:91], v[52:55]
    ds_read_b128 v[120:123], v9 offset:40960
    v_mfma_f32_16x16x32_bf16 v[56:59], v[100:103], v[88:91], v[56:59]
    ds_read_b128 v[124:127], v9 offset:43008
    v_mfma_f32_16x16x32_bf16 v[60:63], v[88:91], v[104:107], v[60:63]
    v_mfma_f32_16x16x32_bf16 v[64:67], v[96:99], v[92:95], v[64:67]
    v_mfma_f32_16x16x32_bf16 v[68:71], v[100:103], v[92:95], v[68:71]
    v_mfma_f32_16x16x32_bf16 v[72:75], v[92:95], v[104:107], v[72:75]
    s_waitcnt lgkmcnt(0)
    s_barrier
    v_mfma_f32_16x16x32_bf16 v[16:19], v[128:131], v[108:111], v[16:19]
    ds_read_b64_tr_b16 v[96:97], v7 offset:0
    v_mfma_f32_16x16x32_bf16 v[20:23], v[132:135], v[108:111], v[20:23]
    ds_read_b64_tr_b16 v[98:99], v7 offset:3072
    v_mfma_f32_16x16x32_bf16 v[24:27], v[108:111], v[136:139], v[24:27]
    ds_read_b64_tr_b16 v[100:101], v7 offset:1024
    v_mfma_f32_16x16x32_bf16 v[28:31], v[128:131], v[112:115], v[28:31]
    ds_read_b64_tr_b16 v[102:103], v7 offset:4096
    v_mfma_f32_16x16x32_bf16 v[32:35], v[132:135], v[112:115], v[32:35]
    ds_read_b64_tr_b16 v[104:105], v7 offset:2048
    v_mfma_f32_16x16x32_bf16 v[36:39], v[112:115], v[136:139], v[36:39]
    ds_read_b64_tr_b16 v[106:107], v7 offset:5120
    v_mfma_f32_16x16x32_bf16 v[40:43], v[128:131], v[116:119], v[40:43]
    ds_read_b128 v[76:79], v10 offset:0
    v_mfma_f32_16x16x32_bf16 v[44:47], v[132:135], v[116:119], v[44:47]
    ds_read_b128 v[80:83], v10 offset:2048
    v_mfma_f32_16x16x32_bf16 v[48:51], v[116:119], v[136:139], v[48:51]
    ds_read_b128 v[84:87], v10 offset:4096
    v_mfma_f32_16x16x32_bf16 v[52:55], v[128:131], v[120:123], v[52:55]
    ds_read_b128 v[88:91], v10 offset:6144
    v_mfma_f32_16x16x32_bf16 v[56:59], v[132:135], v[120:123], v[56:59]
    ds_read_b128 v[92:95], v10 offset:8192
    v_mfma_f32_16x16x32_bf16 v[60:63], v[120:123], v[136:139], v[60:63]
    v_mfma_f32_16x16x32_bf16 v[64:67], v[128:131], v[124:127], v[64:67]
    v_mfma_f32_16x16x32_bf16 v[68:71], v[132:135], v[124:127], v[68:71]
    v_mfma_f32_16x16x32_bf16 v[72:75], v[124:127], v[136:139], v[72:75]
    s_waitcnt lgkmcnt(0)
    v_mfma_f32_16x16x32_bf16 v[16:19], v[96:99], v[76:79], v[16:19]
    ds_read_b64_tr_b16 v[128:129], v7 offset:12288
    v_mfma_f32_16x16x32_bf16 v[20:23], v[100:103], v[76:79], v[20:23]
    ds_read_b64_tr_b16 v[130:131], v7 offset:15360
    v_mfma_f32_16x16x32_bf16 v[24:27], v[76:79], v[104:107], v[24:27]
    ds_read_b64_tr_b16 v[132:133], v7 offset:13312
    v_mfma_f32_16x16x32_bf16 v[28:31], v[96:99], v[80:83], v[28:31]
    ds_read_b64_tr_b16 v[134:135], v7 offset:16384
    v_mfma_f32_16x16x32_bf16 v[32:35], v[100:103], v[80:83], v[32:35]
    ds_read_b64_tr_b16 v[136:137], v7 offset:14336
    v_mfma_f32_16x16x32_bf16 v[36:39], v[80:83], v[104:107], v[36:39]
    ds_read_b64_tr_b16 v[138:139], v7 offset:17408
    v_mfma_f32_16x16x32_bf16 v[40:43], v[96:99], v[84:87], v[40:43]
    ds_read_b128 v[108:111], v11 offset:0
    v_mfma_f32_16x16x32_bf16 v[44:47], v[100:103], v[84:87], v[44:47]
    ds_read_b128 v[112:115], v11 offset:2048
    v_mfma_f32_16x16x32_bf16 v[48:51], v[84:87], v[104:107], v[48:51]
    ds_read_b128 v[116:119], v11 offset:4096
    v_mfma_f32_16x16x32_bf16 v[52:55], v[96:99], v[88:91], v[52:55]
    ds_read_b128 v[120:123], v11 offset:6144
    v_mfma_f32_16x16x32_bf16 v[56:59], v[100:103], v[88:91], v[56:59]
    ds_read_b128 v[124:127], v11 offset:8192
    v_mfma_f32_16x16x32_bf16 v[60:63], v[88:91], v[104:107], v[60:63]
    v_mfma_f32_16x16x32_bf16 v[64:67], v[96:99], v[92:95], v[64:67]
    v_mfma_f32_16x16x32_bf16 v[68:71], v[100:103], v[92:95], v[68:71]
    v_mfma_f32_16x16x32_bf16 v[72:75], v[92:95], v[104:107], v[72:75]
    s_waitcnt lgkmcnt(0)
    s_barrier
    v_mfma_f32_16x16x32_bf16 v[16:19], v[128:131], v[108:111], v[16:19]
    ds_read_b64_tr_b16 v[96:97], v6 offset:0
    v_mfma_f32_16x16x32_bf16 v[20:23], v[132:135], v[108:111], v[20:23]
    ds_read_b64_tr_b16 v[98:99], v6 offset:3072
    v_mfma_f32_16x16x32_bf16 v[24:27], v[108:111], v[136:139], v[24:27]
    ds_read_b64_tr_b16 v[100:101], v6 offset:1024
    v_mfma_f32_16x16x32_bf16 v[28:31], v[128:131], v[112:115], v[28:31]
    ds_read_b64_tr_b16 v[102:103], v6 offset:4096
    v_mfma_f32_16x16x32_bf16 v[32:35], v[132:135], v[112:115], v[32:35]
    ds_read_b64_tr_b16 v[104:105], v6 offset:2048
    v_mfma_f32_16x16x32_bf16 v[36:39], v[112:115], v[136:139], v[36:39]
    ds_read_b64_tr_b16 v[106:107], v6 offset:5120
    v_mfma_f32_16x16x32_bf16 v[40:43], v[128:131], v[116:119], v[40:43]
    ds_read_b128 v[76:79], v8 offset:0
    v_mfma_f32_16x16x32_bf16 v[44:47], v[132:135], v[116:119], v[44:47]
    ds_read_b128 v[80:83], v8 offset:2048
    v_mfma_f32_16x16x32_bf16 v[48:51], v[116:119], v[136:139], v[48:51]
    ds_read_b128 v[84:87], v8 offset:4096
    v_mfma_f32_16x16x32_bf16 v[52:55], v[128:131], v[120:123], v[52:55]
    ds_read_b128 v[88:91], v8 offset:6144
    v_mfma_f32_16x16x32_bf16 v[56:59], v[132:135], v[120:123], v[56:59]
    ds_read_b128 v[92:95], v8 offset:8192
    v_mfma_f32_16x16x32_bf16 v[60:63], v[120:123], v[136:139], v[60:63]
    v_mfma_f32_16x16x32_bf16 v[64:67], v[128:131], v[124:127], v[64:67]
    v_mfma_f32_16x16x32_bf16 v[68:71], v[132:135], v[124:127], v[68:71]
    v_mfma_f32_16x16x32_bf16 v[72:75], v[124:127], v[136:139], v[72:75]
    s_waitcnt lgkmcnt(0)
    v_mfma_f32_16x16x32_bf16 v[16:19], v[96:99], v[76:79], v[16:19]
    ds_read_b64_tr_b16 v[128:129], v6 offset:12288
    v_mfma_f32_16x16x32_bf16 v[20:23], v[100:103], v[76:79], v[20:23]
    ds_read_b64_tr_b16 v[130:131], v6 offset:15360
    v_mfma_f32_16x16x32_bf16 v[24:27], v[76:79], v[104:107], v[24:27]
    ds_read_b64_tr_b16 v[132:133], v6 offset:13312
    v_mfma_f32_16x16x32_bf16 v[28:31], v[96:99], v[80:83], v[28:31]
    ds_read_b64_tr_b16 v[134:135], v6 offset:16384
    v_mfma_f32_16x16x32_bf16 v[32:35], v[100:103], v[80:83], v[32:35]
    ds_read_b64_tr_b16 v[136:137], v6 offset:14336
    v_mfma_f32_16x16x32_bf16 v[36:39], v[80:83], v[104:107], v[36:39]
    ds_read_b64_tr_b16 v[138:139], v6 offset:17408
    v_mfma_f32_16x16x32_bf16 v[40:43], v[96:99], v[84:87], v[40:43]
    ds_read_b128 v[108:111], v9 offset:0
    v_mfma_f32_16x16x32_bf16 v[44:47], v[100:103], v[84:87], v[44:47]
    ds_read_b128 v[112:115], v9 offset:2048
    v_mfma_f32_16x16x32_bf16 v[48:51], v[84:87], v[104:107], v[48:51]
    ds_read_b128 v[116:119], v9 offset:4096
    v_mfma_f32_16x16x32_bf16 v[52:55], v[96:99], v[88:91], v[52:55]
    ds_read_b128 v[120:123], v9 offset:6144
    v_mfma_f32_16x16x32_bf16 v[56:59], v[100:103], v[88:91], v[56:59]
    ds_read_b128 v[124:127], v9 offset:8192
    v_mfma_f32_16x16x32_bf16 v[60:63], v[88:91], v[104:107], v[60:63]
    v_mfma_f32_16x16x32_bf16 v[64:67], v[96:99], v[92:95], v[64:67]
    v_mfma_f32_16x16x32_bf16 v[68:71], v[100:103], v[92:95], v[68:71]
    v_mfma_f32_16x16x32_bf16 v[72:75], v[92:95], v[104:107], v[72:75]
    s_waitcnt lgkmcnt(0)
    s_waitcnt vmcnt(0)
    s_barrier
    s_cmp_eq_u32 s27, 0
    s_cbranch_scc0 c_noarr
    s_lshl_b32 s33, 1, s54
    v_mov_b32 v3, s33
    v_mov_b32 v2, 0
    s_mov_b64 exec, 1
    buffer_atomic_add v3, v2, s[8:11], s55 offen sc1
    s_mov_b64 exec, -1
c_noarr:
    v_mfma_f32_16x16x32_bf16 v[16:19], v[128:131], v[108:111], v[16:19]
    ds_read_b64_tr_b16 v[96:97], v6 offset:34816
    v_mfma_f32_16x16x32_bf16 v[20:23], v[132:135], v[108:111], v[20:23]
    ds_read_b64_tr_b16 v[98:99], v6 offset:37888
    v_mfma_f32_16x16x32_bf16 v[24:27], v[108:111], v[136:139], v[24:27]
    ds_read_b64_tr_b16 v[100:101], v6 offset:35840
    v_mfma_f32_16x16x32_bf16 v[28:31], v[128:131], v[112:115], v[28:31]
    ds_read_b64_tr_b16 v[102:103], v6 offset:38912
    v_mfma_f32_16x16x32_bf16 v[32:35], v[132:135], v[112:115], v[32:35]
    ds_read_b64_tr_b16 v[104:105], v6 offset:36864
    v_mfma_f32_16x16x32_bf16 v[36:39], v[112:115], v[136:139], v[36:39]
    ds_read_b64_tr_b16 v[106:107], v6 offset:39936
    v_mfma_f32_16x16x32_bf16 v[40:43], v[128:131], v[116:119], v[40:43]
    ds_read_b128 v[76:79], v8 offset:34816
    v_mfma_f32_16x16x32_bf16 v[44:47], v[132:135], v[116:119], v[44:47]
    ds_read_b128 v[80:83], v8 offset:36864
    v_mfma_f32_16x16x32_bf16 v[48:51], v[116:119], v[136:139], v[48:51]
    ds_read_b128 v[84:87], v8 offset:38912
    v_mfma_f32_16x16x32_bf16 v[52:55], v[128:131], v[120:123], v[52:55]
    ds_read_b128 v[88:91], v8 offset:40960
    v_mfma_f32_16x16x32_bf16 v[56:59], v[132:135], v[120:123], v[56:59]
    ds_read_b128 v[92:95], v8 offset:43008
    v_mfma_f32_16x16x32_bf16 v[60:63], v[120:123], v[136:139], v[60:63]
    v_mfma_f32_16x16x32_bf16 v[64:67], v[128:131], v[124:127], v[64:67]
    v_mfma_f32_16x16x32_bf16 v[68:71], v[132:135], v[124:127], v[68:71]
    v_mfma_f32_16x16x32_bf16 v[72:75], v[124:127], v[136:139], v[72:75]
    s_waitcnt lgkmcnt(0)
    v_mfma_f32_16x16x32_bf16 v[16:19], v[96:99], v[76:79], v[16:19]
    ds_read_b64_tr_b16 v[128:129], v6 offset:47104
    v_mfma_f32_16x16x32_bf16 v[20:23], v[100:103], v[76:79], v[20:23]
    ds_read_b64_tr_b16 v[130:131], v6 offset:50176
    v_mfma_f32_16x16x32_bf16 v[24:27], v[76:79], v[104:107], v[24:27]
    ds_read_b64_tr_b16 v[132:133], v6 offset:48128
    v_mfma_f32_16x16x32_bf16 v[28:31], v[96:99], v[80:83], v[28:31]
    ds_read_b64_tr_b16 v[134:135], v6 offset:51200
    v_mfma_f32_16x16x32_bf16 v[32:35], v[100:103], v[80:83], v[32:35]
    ds_read_b64_tr_b16 v[136:137], v6 offset:49152
    v_mfma_f32_16x16x32_bf16 v[36:39], v[80:83], v[104:107], v[36:39]
    ds_read_b64_tr_b16 v[138:139], v6 offset:52224
    v_mfma_f32_16x16x32_bf16 v[40:43], v[96:99], v[84:87], v[40:43]
    ds_read_b128 v[108:111], v9 offset:34816
    v_mfma_f32_16x16x32_bf16 v[44:47], v[100:103], v[84:87], v[44:47]
    ds_read_b128 v[112:115], v9 offset:36864
    v_mfma_f32_16x16x32_bf16 v[48:51], v[84:87], v[104:107], v[48:51]
    ds_read_b128 v[116:119], v9 offset:38912
    v_mfma_f32_16x16x32_bf16 v[52:55], v[96:99], v[88:91], v[52:55]
    ds_read_b128 v[120:123], v9 offset:40960
    v_mfma_f32_16x16x32_bf16 v[56:59], v[100:103], v[88:91], v[56:59]
    ds_read_b128 v[124:127], v9 offset:43008
    v_mfma_f32_16x16x32_bf16 v[60:63], v[88:91], v[104:107], v[60:63]
    v_mfma_f32_16x16x32_bf16 v[64:67], v[96:99], v[92:95], v[64:67]
    v_mfma_f32_16x16x32_bf16 v[68:71], v[100:103], v[92:95], v[68:71]
    v_mfma_f32_16x16x32_bf16 v[72:75], v[92:95], v[104:107], v[72:75]
    s_waitcnt lgkmcnt(0)
    s_barrier
    v_mfma_f32_16x16x32_bf16 v[16:19], v[128:131], v[108:111], v[16:19]
    ds_read_b64_tr_b16 v[96:97], v7 offset:0
    v_mfma_f32_16x16x32_bf16 v[20:23], v[132:135], v[108:111], v[20:23]
    ds_read_b64_tr_b16 v[98:99], v7 offset:3072
    v_mfma_f32_16x16x32_bf16 v[24:27], v[108:111], v[136:139], v[24:27]
    ds_read_b64_tr_b16 v[100:101], v7 offset:1024
    v_mfma_f32_16x16x32_bf16 v[28:31], v[128:131], v[112:115], v[28:31]
    ds_read_b64_tr_b16 v[102:103], v7 offset:4096
    v_mfma_f32_16x16x32_bf16 v[32:35], v[132:135], v[112:115], v[32:35]
    ds_read_b64_tr_b16 v[104:105], v7 offset:2048
    v_mfma_f32_16x16x32_bf16 v[36:39], v[112:115], v[136:139], v[36:39]
    ds_read_b64_tr_b16 v[106:107], v7 offset:5120
    v_mfma_f32_16x16x32_bf16 v[40:43], v[128:131], v[116:119], v[40:43]
    ds_read_b128 v[76:79], v10 offset:0
    v_mfma_f32_16x16x32_bf16 v[44:47], v[132:135], v[116:119], v[44:47]
    ds_read_b128 v[80:83], v10 offset:2048
    v_mfma_f32_16x16x32_bf16 v[48:51], v[116:119], v[136:139], v[48:51]
    ds_read_b128 v[84:87], v10 offset:4096
    v_mfma_f32_16x16x32_bf16 v[52:55], v[128:131], v[120:123], v[52:55]
    ds_read_b128 v[88:91], v10 offset:6144
    v_mfma_f32_16x16x32_bf16 v[56:59], v[132:135], v[120:123], v[56:59]
    ds_read_b128 v[92:95], v10 offset:8192
    v_mfma_f32_16x16x32_bf16 v[60:63], v[120:123], v[136:139], v[60:63]
    v_mfma_f32_16x16x32_bf16 v[64:67], v[128:131], v[124:127], v[64:67]
    v_mfma_f32_16x16x32_bf16 v[68:71], v[132:135], v[124:127], v[68:71]
    v_mfma_f32_16x16x32_bf16 v[72:75], v[124:127], v[136:139], v[72:75]
    s_waitcnt lgkmcnt(0)
    v_mfma_f32_16x16x32_bf16 v[16:19], v[96:99], v[76:79], v[16:19]
    ds_read_b64_tr_b16 v[128:129], v7 offset:12288
    v_mfma_f32_16x16x32_bf16 v[20:23], v[100:103], v[76:79], v[20:23]
    ds_read_b64_tr_b16 v[130:131], v7 offset:15360
    v_mfma_f32_16x16x32_bf16 v[24:27], v[76:79], v[104:107], v[24:27]
    ds_read_b64_tr_b16 v[132:133], v7 offset:13312
    v_mfma_f32_16x16x32_bf16 v[28:31], v[96:99], v[80:83], v[28:31]
    ds_read_b64_tr_b16 v[134:135], v7 offset:16384
    v_mfma_f32_16x16x32_bf16 v[32:35], v[100:103], v[80:83], v[32:35]
    ds_read_b64_tr_b16 v[136:137], v7 offset:14336
    v_mfma_f32_16x16x32_bf16 v[36:39], v[80:83], v[104:107], v[36:39]
    ds_read_b64_tr_b16 v[138:139], v7 offset:17408
    v_mfma_f32_16x16x32_bf16 v[40:43], v[96:99], v[84:87], v[40:43]
    ds_read_b128 v[108:111], v11 offset:0
    v_mfma_f32_16x16x32_bf16 v[44:47], v[100:103], v[84:87], v[44:47]
    ds_read_b128 v[112:115], v11 offset:2048
    v_mfma_f32_16x16x32_bf16 v[48:51], v[84:87], v[104:107], v[48:51]
    ds_read_b128 v[116:119], v11 offset:4096
    v_mfma_f32_16x16x32_bf16 v[52:55], v[96:99], v[88:91], v[52:55]
    ds_read_b128 v[120:123], v11 offset:6144
    v_mfma_f32_16x16x32_bf16 v[56:59], v[100:103], v[88:91], v[56:59]
    ds_read_b128 v[124:127], v11 offset:8192
    v_mfma_f32_16x16x32_bf16 v[60:63], v[88:91], v[104:107], v[60:63]
    v_mfma_f32_16x16x32_bf16 v[64:67], v[96:99], v[92:95], v[64:67]
    v_mfma_f32_16x16x32_bf16 v[68:71], v[100:103], v[92:95], v[68:71]
    v_mfma_f32_16x16x32_bf16 v[72:75], v[92:95], v[104:107], v[72:75]
    s_waitcnt lgkmcnt(0)
    s_barrier
    v_mfma_f32_16x16x32_bf16 v[16:19], v[128:131], v[108:111], v[16:19]
    ds_read_b64_tr_b16 v[96:97], v6 offset:0
    v_mfma_f32_16x16x32_bf16 v[20:23], v[132:135], v[108:111], v[20:23]
    ds_read_b64_tr_b16 v[98:99], v6 offset:3072
    v_mfma_f32_16x16x32_bf16 v[24:27], v[108:111], v[136:139], v[24:27]
    ds_read_b64_tr_b16 v[100:101], v6 offset:1024
    v_mfma_f32_16x16x32_bf16 v[28:31], v[128:131], v[112:115], v[28:31]
    ds_read_b64_tr_b16 v[102:103], v6 offset:4096
    v_mfma_f32_16x16x32_bf16 v[32:35], v[132:135], v[112:115], v[32:35]
    ds_read_b64_tr_b16 v[104:105], v6 offset:2048
    v_mfma_f32_16x16x32_bf16 v[36:39], v[112:115], v[136:139], v[36:39]
    ds_read_b64_tr_b16 v[106:107], v6 offset:5120
    v_mfma_f32_16x16x32_bf16 v[40:43], v[128:131], v[116:119], v[40:43]
    ds_read_b128 v[76:79], v8 offset:0
    v_mfma_f32_16x16x32_bf16 v[44:47], v[132:135], v[116:119], v[44:47]
    ds_read_b128 v[80:83], v8 offset:2048
    v_mfma_f32_16x16x32_bf16 v[48:51], v[116:119], v[136:139], v[48:51]
    ds_read_b128 v[84:87], v8 offset:4096
    v_mfma_f32_16x16x32_bf16 v[52:55], v[128:131], v[120:123], v[52:55]
    ds_read_b128 v[88:91], v8 offset:6144
    v_mfma_f32_16x16x32_bf16 v[56:59], v[132:135], v[120:123], v[56:59]
    ds_read_b128 v[92:95], v8 offset:8192
    v_mfma_f32_16x16x32_bf16 v[60:63], v[120:123], v[136:139], v[60:63]
    v_mfma_f32_16x16x32_bf16 v[64:67], v[128:131], v[124:127], v[64:67]
    v_mfma_f32_16x16x32_bf16 v[68:71], v[132:135], v[124:127], v[68:71]
    v_mfma_f32_16x16x32_bf16 v[72:75], v[124:127], v[136:139], v[72:75]
    s_waitcnt lgkmcnt(0)
    v_mfma_f32_16x16x32_bf16 v[16:19], v[96:99], v[76:79], v[16:19]
    ds_read_b64_tr_b16 v[128:129], v6 offset:12288
    v_mfma_f32_16x16x32_bf16 v[20:23], v[100:103], v[76:79], v[20:23]
    ds_read_b64_tr_b16 v[130:131], v6 offset:15360
    v_mfma_f32_16x16x32_bf16 v[24:27], v[76:79], v[104:107], v[24:27]
    ds_read_b64_tr_b16 v[132:133], v6 offset:13312
    v_mfma_f32_16x16x32_bf16 v[28:31], v[96:99], v[80:83], v[28:31]
    ds_read_b64_tr_b16 v[134:135], v6 offset:16384
    v_mfma_f32_16x16x32_bf16 v[32:35], v[100:103], v[80:83], v[32:35]
    ds_read_b64_tr_b16 v[136:137], v6 offset:14336
    v_mfma_f32_16x16x32_bf16 v[36:39], v[80:83], v[104:107], v[36:39]
    ds_read_b64_tr_b16 v[138:139], v6 offset:17408
    v_mfma_f32_16x16x32_bf16 v[40:43], v[96:99], v[84:87], v[40:43]
    ds_read_b128 v[108:111], v9 offset:0
    v_mfma_f32_16x16x32_bf16 v[44:47], v[100:103], v[84:87], v[44:47]
    ds_read_b128 v[112:115], v9 offset:2048
    v_mfma_f32_16x16x32_bf16 v[48:51], v[84:87], v[104:107], v[48:51]
    ds_read_b128 v[116:119], v9 offset:4096
    v_mfma_f32_16x16x32_bf16 v[52:55], v[96:99], v[88:91], v[52:55]
    ds_read_b128 v[120:123], v9 offset:6144
    v_mfma_f32_16x16x32_bf16 v[56:59], v[100:103], v[88:91], v[56:59]
    ds_read_b128 v[124:127], v9 offset:8192
    v_mfma_f32_16x16x32_bf16 v[60:63], v[88:91], v[104:107], v[60:63]
    v_mfma_f32_16x16x32_bf16 v[64:67], v[96:99], v[92:95], v[64:67]
    v_mfma_f32_16x16x32_bf16 v[68:71], v[100:103], v[92:95], v[68:71]
    v_mfma_f32_16x16x32_bf16 v[72:75], v[92:95], v[104:107], v[72:75]
    s_waitcnt lgkmcnt(0)
    buffer_store_dwordx4 v[156:159], v164, s[12:15], s36 offen sc1
    buffer_store_dwordx4 v[156:159], v165, s[12:15], s36 offen sc1
    s_mov_b64 exec, 0xffffffff
    buffer_store_dwordx4 v[156:159], v162, s[12:15], s37 offen sc1
    s_mov_b64 exec, -1
    s_barrier
    v_mfma_f32_16x16x32_bf16 v[16:19], v[128:131], v[108:111], v[16:19]
    ds_read_b64_tr_b16 v[96:97], v6 offset:34816
    v_mfma_f32_16x16x32_bf16 v[20:23], v[132:135], v[108:111], v[20:23]
    ds_read_b64_tr_b16 v[98:99], v6 offset:37888
    v_mfma_f32_16x16x32_bf16 v[24:27], v[108:111], v[136:139], v[24:27]
    ds_read_b64_tr_b16 v[100:101], v6 offset:35840
    v_mfma_f32_16x16x32_bf16 v[28:31], v[128:131], v[112:115], v[28:31]
    ds_read_b64_tr_b16 v[102:103], v6 offset:38912
    v_mfma_f32_16x16x32_bf16 v[32:35], v[132:135], v[112:115], v[32:35]
    ds_read_b64_tr_b16 v[104:105], v6 offset:36864
    v_mfma_f32_16x16x32_bf16 v[36:39], v[112:115], v[136:139], v[36:39]
    ds_read_b64_tr_b16 v[106:107], v6 offset:39936
    v_mfma_f32_16x16x32_bf16 v[40:43], v[128:131], v[116:119], v[40:43]
    ds_read_b128 v[76:79], v8 offset:34816
    v_mfma_f32_16x16x32_bf16 v[44:47], v[132:135], v[116:119], v[44:47]
    ds_read_b128 v[80:83], v8 offset:36864
    v_mfma_f32_16x16x32_bf16 v[48:51], v[116:119], v[136:139], v[48:51]
    ds_read_b128 v[84:87], v8 offset:38912
    v_mfma_f32_16x16x32_bf16 v[52:55], v[128:131], v[120:123], v[52:55]
    ds_read_b128 v[88:91], v8 offset:40960
    v_mfma_f32_16x16x32_bf16 v[56:59], v[132:135], v[120:123], v[56:59]
    ds_read_b128 v[92:95], v8 offset:43008
    v_mfma_f32_16x16x32_bf16 v[60:63], v[120:123], v[136:139], v[60:63]
    v_mfma_f32_16x16x32_bf16 v[64:67], v[128:131], v[124:127], v[64:67]
    v_mfma_f32_16x16x32_bf16 v[68:71], v[132:135], v[124:127], v[68:71]
    v_mfma_f32_16x16x32_bf16 v[72:75], v[124:127], v[136:139], v[72:75]
    s_waitcnt lgkmcnt(0)
    v_mfma_f32_16x16x32_bf16 v[16:19], v[96:99], v[76:79], v[16:19]
    ds_read_b64_tr_b16 v[128:129], v6 offset:47104
    v_mfma_f32_16x16x32_bf16 v[20:23], v[100:103], v[76:79], v[20:23]
    ds_read_b64_tr_b16 v[130:131], v6 offset:50176
    v_mfma_f32_16x16x32_bf16 v[24:27], v[76:79], v[104:107], v[24:27]
    ds_read_b64_tr_b16 v[132:133], v6 offset:48128
    v_mfma_f32_16x16x32_bf16 v[28:31], v[96:99], v[80:83], v[28:31]
    ds_read_b64_tr_b16 v[134:135], v6 offset:51200
    v_mfma_f32_16x16x32_bf16 v[32:35], v[100:103], v[80:83], v[32:35]
    ds_read_b64_tr_b16 v[136:137], v6 offset:49152
    v_mfma_f32_16x16x32_bf16 v[36:39], v[80:83], v[104:107], v[36:39]
    ds_read_b64_tr_b16 v[138:139], v6 offset:52224
    v_mfma_f32_16x16x32_bf16 v[40:43], v[96:99], v[84:87], v[40:43]
    ds_read_b128 v[108:111], v9 offset:34816
    v_mfma_f32_16x16x32_bf16 v[44:47], v[100:103], v[84:87], v[44:47]
    ds_read_b128 v[112:115], v9 offset:36864
    v_mfma_f32_16x16x32_bf16 v[48:51], v[84:87], v[104:107], v[48:51]
    ds_read_b128 v[116:119], v9 offset:38912
    v_mfma_f32_16x16x32_bf16 v[52:55], v[96:99], v[88:91], v[52:55]
    ds_read_b128 v[120:123], v9 offset:40960
    v_mfma_f32_16x16x32_bf16 v[56:59], v[100:103], v[88:91], v[56:59]
    ds_read_b128 v[124:127], v9 offset:43008
    v_mfma_f32_16x16x32_bf16 v[60:63], v[88:91], v[104:107], v[60:63]
    v_mfma_f32_16x16x32_bf16 v[64:67], v[96:99], v[92:95], v[64:67]
    v_mfma_f32_16x16x32_bf16 v[68:71], v[100:103], v[92:95], v[68:71]
    v_mfma_f32_16x16x32_bf16 v[72:75], v[92:95], v[104:107], v[72:75]
    s_waitcnt lgkmcnt(0)
    v_mfma_f32_16x16x32_bf16 v[16:19], v[128:131], v[108:111], v[16:19]
    v_mfma_f32_16x16x32_bf16 v[20:23], v[132:135], v[108:111], v[20:23]
    v_mfma_f32_16x16x32_bf16 v[24:27], v[108:111], v[136:139], v[24:27]
    v_mfma_f32_16x16x32_bf16 v[28:31], v[128:131], v[112:115], v[28:31]
    v_mfma_f32_16x16x32_bf16 v[32:35], v[132:135], v[112:115], v[32:35]
    v_mfma_f32_16x16x32_bf16 v[36:39], v[112:115], v[136:139], v[36:39]
    v_mfma_f32_16x16x32_bf16 v[40:43], v[128:131], v[116:119], v[40:43]
    v_mfma_f32_16x16x32_bf16 v[44:47], v[132:135], v[116:119], v[44:47]
    v_mfma_f32_16x16x32_bf16 v[48:51], v[116:119], v[136:139], v[48:51]
    v_mfma_f32_16x16x32_bf16 v[52:55], v[128:131], v[120:123], v[52:55]
    v_mfma_f32_16x16x32_bf16 v[56:59], v[132:135], v[120:123], v[56:59]
    v_mfma_f32_16x16x32_bf16 v[60:63], v[120:123], v[136:139], v[60:63]
    v_mfma_f32_16x16x32_bf16 v[64:67], v[128:131], v[124:127], v[64:67]
    v_mfma_f32_16x16x32_bf16 v[68:71], v[132:135], v[124:127], v[68:71]
    v_mfma_f32_16x16x32_bf16 v[72:75], v[124:127], v[136:139], v[72:75]
    s_branch c_loopdone
c_att_xt:
    s_barrier
    ds_read_b64_tr_b16 v[76:77], v147 offset:0
    ds_read_b64_tr_b16 v[78:79], v147 offset:256
    ds_read_b64_tr_b16 v[96:97], v6 offset:0
    ds_read_b64_tr_b16 v[98:99], v6 offset:3072
    ds_read_b64_tr_b16 v[100:101], v6 offset:1024
    ds_read_b64_tr_b16 v[102:103], v6 offset:4096
    ds_read_b64_tr_b16 v[104:105], v6 offset:2048
    ds_read_b64_tr_b16 v[106:107], v6 offset:5120
    ds_read_b64_tr_b16 v[80:81], v8 offset:0
    ds_read_b64_tr_b16 v[82:83], v8 offset:1024
    ds_read_b64_tr_b16 v[84:85], v9 offset:0
    ds_read_b64_tr_b16 v[86:87], v9 offset:1024
    ds_read_b64_tr_b16 v[88:89], v10 offset:0
    ds_read_b64_tr_b16 v[90:91], v10 offset:1024
    ds_read_b64_tr_b16 v[92:93], v11 offset:0
    ds_read_b64_tr_b16 v[94:95], v11 offset:1024
    s_waitcnt lgkmcnt(0)
    v_mfma_f32_16x16x32_bf16 v[20:23], v[100:103], v[76:79], 0
    ds_read_b64_tr_b16 v[108:109], v147 offset:1024
    ds_read_b64_tr_b16 v[110:111], v147 offset:1280
    v_mfma_f32_16x16x32_bf16 v[24:27], v[76:79], v[104:107], 0
    ds_read_b64_tr_b16 v[128:129], v6 offset:12288
    ds_read_b64_tr_b16 v[130:131], v6 offset:15360
    v_mfma_f32_16x16x32_bf16 v[28:31], v[96:99], v[80:83], 0
    ds_read_b64_tr_b16 v[132:133], v6 offset:13312
    ds_read_b64_tr_b16 v[134:135], v6 offset:16384
    v_mfma_f32_16x16x32_bf16 v[32:35], v[100:103], v[80:83], 0
    ds_read_b64_tr_b16 v[136:137], v6 offset:14336
    ds_read_b64_tr_b16 v[138:139], v6 offset:17408
    v_mfma_f32_16x16x32_bf16 v[36:39], v[80:83], v[104:107], 0
    ds_read_b64_tr_b16 v[112:113], v8 offset:4096
    v_mfma_f32_16x16x32_bf16 v[40:43], v[96:99], v[84:87], 0
    ds_read_b64_tr_b16 v[114:115], v8 offset:5120
    v_mfma_f32_16x16x32_bf16 v[44:47], v[100:103], v[84:87], 0
    ds_read_b64_tr_b16 v[116:117], v9 offset:4096
    v_mfma_f32_16x16x32_bf16 v[48:51], v[84:87], v[104:107], 0
    ds_read_b64_tr_b16 v[118:119], v9 offset:5120
    v_mfma_f32_16x16x32_bf16 v[52:55], v[96:99], v[88:91], 0
    ds_read_b64_tr_b16 v[120:121], v10 offset:4096
    v_mfma_f32_16x16x32_bf16 v[56:59], v[100:103], v[88:91], 0
    ds_read_b64_tr_b16 v[122:123], v10 offset:5120
    v_mfma_f32_16x16x32_bf16 v[60:63], v[88:91], v[104:107], 0
    ds_read_b64_tr_b16 v[124:125], v11 offset:4096
    v_mfma_f32_16x16x32_bf16 v[64:67], v[96:99], v[92:95], 0
    ds_read_b64_tr_b16 v[126:127], v11 offset:5120
    v_mfma_f32_16x16x32_bf16 v[68:71], v[100:103], v[92:95], 0
    v_mfma_f32_16x16x32_bf16 v[72:75], v[92:95], v[104:107], 0
    s_waitcnt lgkmcnt(0)
    s_barrier
    v_mfma_f32_16x16x32_bf16 v[20:23], v[132:135], v[108:111], v[20:23]
    ds_read_b64_tr_b16 v[76:77], v147 offset:34816
    ds_read_b64_tr_b16 v[78:79], v147 offset:35072
    v_mfma_f32_16x16x32_bf16 v[24:27], v[108:111], v[136:139], v[24:27]
    ds_read_b64_tr_b16 v[96:97], v6 offset:34816
    ds_read_b64_tr_b16 v[98:99], v6 offset:37888
    v_mfma_f32_16x16x32_bf16 v[28:31], v[128:131], v[112:115], v[28:31]
    ds_read_b64_tr_b16 v[100:101], v6 offset:35840
    ds_read_b64_tr_b16 v[102:103], v6 offset:38912
    v_mfma_f32_16x16x32_bf16 v[32:35], v[132:135], v[112:115], v[32:35]
    ds_read_b64_tr_b16 v[104:105], v6 offset:36864
    ds_read_b64_tr_b16 v[106:107], v6 offset:39936
    v_mfma_f32_16x16x32_bf16 v[36:39], v[112:115], v[136:139], v[36:39]
    ds_read_b64_tr_b16 v[80:81], v8 offset:34816
    v_mfma_f32_16x16x32_bf16 v[40:43], v[128:131], v[116:119], v[40:43]
    ds_read_b64_tr_b16 v[82:83], v8 offset:35840
    v_mfma_f32_16x16x32_bf16 v[44:47], v[132:135], v[116:119], v[44:47]
    ds_read_b64_tr_b16 v[84:85], v9 offset:34816
    v_mfma_f32_16x16x32_bf16 v[48:51], v[116:119], v[136:139], v[48:51]
    ds_read_b64_tr_b16 v[86:87], v9 offset:35840
    v_mfma_f32_16x16x32_bf16 v[52:55], v[128:131], v[120:123], v[52:55]
    ds_read_b64_tr_b16 v[88:89], v10 offset:34816
    v_mfma_f32_16x16x32_bf16 v[56:59], v[132:135], v[120:123], v[56:59]
    ds_read_b64_tr_b16 v[90:91], v10 offset:35840
    v_mfma_f32_16x16x32_bf16 v[60:63], v[120:123], v[136:139], v[60:63]
    ds_read_b64_tr_b16 v[92:93], v11 offset:34816
    v_mfma_f32_16x16x32_bf16 v[64:67], v[128:131], v[124:127], v[64:67]
    ds_read_b64_tr_b16 v[94:95], v11 offset:35840
    v_mfma_f32_16x16x32_bf16 v[68:71], v[132:135], v[124:127], v[68:71]
    v_mfma_f32_16x16x32_bf16 v[72:75], v[124:127], v[136:139], v[72:75]
    s_waitcnt lgkmcnt(0)
    v_mfma_f32_16x16x32_bf16 v[20:23], v[100:103], v[76:79], v[20:23]
    ds_read_b64_tr_b16 v[108:109], v147 offset:35840
    ds_read_b64_tr_b16 v[110:111], v147 offset:36096
    v_mfma_f32_16x16x32_bf16 v[24:27], v[76:79], v[104:107], v[24:27]
    ds_read_b64_tr_b16 v[128:129], v6 offset:47104
    ds_read_b64_tr_b16 v[130:131], v6 offset:50176
    v_mfma_f32_16x16x32_bf16 v[28:31], v[96:99], v[80:83], v[28:31]
    ds_read_b64_tr_b16 v[132:133], v6 offset:48128
    ds_read_b64_tr_b16 v[134:135], v6 offset:51200
    v_mfma_f32_16x16x32_bf16 v[32:35], v[100:103], v[80:83], v[32:35]
    ds_read_b64_tr_b16 v[136:137], v6 offset:49152
    ds_read_b64_tr_b16 v[138:139], v6 offset:52224
    v_mfma_f32_16x16x32_bf16 v[36:39], v[80:83], v[104:107], v[36:39]
    ds_read_b64_tr_b16 v[112:113], v8 offset:38912
    v_mfma_f32_16x16x32_bf16 v[40:43], v[96:99], v[84:87], v[40:43]
    ds_read_b64_tr_b16 v[114:115], v8 offset:39936
    v_mfma_f32_16x16x32_bf16 v[44:47], v[100:103], v[84:87], v[44:47]
    ds_read_b64_tr_b16 v[116:117], v9 offset:38912
    v_mfma_f32_16x16x32_bf16 v[48:51], v[84:87], v[104:107], v[48:51]
    ds_read_b64_tr_b16 v[118:119], v9 offset:39936
    v_mfma_f32_16x16x32_bf16 v[52:55], v[96:99], v[88:91], v[52:55]
    ds_read_b64_tr_b16 v[120:121], v10 offset:38912
    v_mfma_f32_16x16x32_bf16 v[56:59], v[100:103], v[88:91], v[56:59]
    ds_read_b64_tr_b16 v[122:123], v10 offset:39936
    v_mfma_f32_16x16x32_bf16 v[60:63], v[88:91], v[104:107], v[60:63]
    ds_read_b64_tr_b16 v[124:125], v11 offset:38912
    v_mfma_f32_16x16x32_bf16 v[64:67], v[96:99], v[92:95], v[64:67]
    ds_read_b64_tr_b16 v[126:127], v11 offset:39936
    v_mfma_f32_16x16x32_bf16 v[68:71], v[100:103], v[92:95], v[68:71]
    v_mfma_f32_16x16x32_bf16 v[72:75], v[92:95], v[104:107], v[72:75]
    s_waitcnt lgkmcnt(0)
    s_barrier
    v_mfma_f32_16x16x32_bf16 v[20:23], v[132:135], v[108:111], v[20:23]
    ds_read_b64_tr_b16 v[76:77], v166 offset:0
    ds_read_b64_tr_b16 v[78:79], v166 offset:256
    v_mfma_f32_16x16x32_bf16 v[24:27], v[108:111], v[136:139], v[24:27]
    ds_read_b64_tr_b16 v[96:97], v7 offset:0
    ds_read_b64_tr_b16 v[98:99], v7 offset:3072
    v_mfma_f32_16x16x32_bf16 v[28:31], v[128:131], v[112:115], v[28:31]
    ds_read_b64_tr_b16 v[100:101], v7 offset:1024
    ds_read_b64_tr_b16 v[102:103], v7 offset:4096
    v_mfma_f32_16x16x32_bf16 v[32:35], v[132:135], v[112:115], v[32:35]
    ds_read_b64_tr_b16 v[104:105], v7 offset:2048
    ds_read_b64_tr_b16 v[106:107], v7 offset:5120
    v_mfma_f32_16x16x32_bf16 v[36:39], v[112:115], v[136:139], v[36:39]
    ds_read_b64_tr_b16 v[80:81], v14 offset:0
    v_mfma_f32_16x16x32_bf16 v[40:43], v[128:131], v[116:119], v[40:43]
    ds_read_b64_tr_b16 v[82:83], v14 offset:1024
    v_mfma_f32_16x16x32_bf16 v[44:47], v[132:135], v[116:119], v[44:47]
    ds_read_b64_tr_b16 v[84:85], v15 offset:0
    v_mfma_f32_16x16x32_bf16 v[48:51], v[116:119], v[136:139], v[48:51]
    ds_read_b64_tr_b16 v[86:87], v15 offset:1024
    v_mfma_f32_16x16x32_bf16 v[52:55], v[128:131], v[120:123], v[52:55]
    ds_read_b64_tr_b16 v[88:89], v148 offset:0
    v_mfma_f32_16x16x32_bf16 v[56:59], v[132:135], v[120:123], v[56:59]
    ds_read_b64_tr_b16 v[90:91], v148 offset:1024
    v_mfma_f32_16x16x32_bf16 v[60:63], v[120:123], v[136:139], v[60:63]
    ds_read_b64_tr_b16 v[92:93], v149 offset:0
    v_mfma_f32_16x16x32_bf16 v[64:67], v[128:131], v[124:127], v[64:67]
    ds_read_b64_tr_b16 v[94:95], v149 offset:1024
    v_mfma_f32_16x16x32_bf16 v[68:71], v[132:135], v[124:127], v[68:71]
    v_mfma_f32_16x16x32_bf16 v[72:75], v[124:127], v[136:139], v[72:75]
    s_waitcnt lgkmcnt(0)
    v_mfma_f32_16x16x32_bf16 v[20:23], v[100:103], v[76:79], v[20:23]
    ds_read_b64_tr_b16 v[108:109], v166 offset:1024
    ds_read_b64_tr_b16 v[110:111], v166 offset:1280
    v_mfma_f32_16x16x32_bf16 v[24:27], v[76:79], v[104:107], v[24:27]
    ds_read_b64_tr_b16 v[128:129], v7 offset:12288
    ds_read_b64_tr_b16 v[130:131], v7 offset:15360
    v_mfma_f32_16x16x32_bf16 v[28:31], v[96:99], v[80:83], v[28:31]
    ds_read_b64_tr_b16 v[132:133], v7 offset:13312
    ds_read_b64_tr_b16 v[134:135], v7 offset:16384
    v_mfma_f32_16x16x32_bf16 v[32:35], v[100:103], v[80:83], v[32:35]
    ds_read_b64_tr_b16 v[136:137], v7 offset:14336
    ds_read_b64_tr_b16 v[138:139], v7 offset:17408
    v_mfma_f32_16x16x32_bf16 v[36:39], v[80:83], v[104:107], v[36:39]
    ds_read_b64_tr_b16 v[112:113], v14 offset:4096
    v_mfma_f32_16x16x32_bf16 v[40:43], v[96:99], v[84:87], v[40:43]
    ds_read_b64_tr_b16 v[114:115], v14 offset:5120
    v_mfma_f32_16x16x32_bf16 v[44:47], v[100:103], v[84:87], v[44:47]
    ds_read_b64_tr_b16 v[116:117], v15 offset:4096
    v_mfma_f32_16x16x32_bf16 v[48:51], v[84:87], v[104:107], v[48:51]
    ds_read_b64_tr_b16 v[118:119], v15 offset:5120
    v_mfma_f32_16x16x32_bf16 v[52:55], v[96:99], v[88:91], v[52:55]
    ds_read_b64_tr_b16 v[120:121], v148 offset:4096
    v_mfma_f32_16x16x32_bf16 v[56:59], v[100:103], v[88:91], v[56:59]
    ds_read_b64_tr_b16 v[122:123], v148 offset:5120
    v_mfma_f32_16x16x32_bf16 v[60:63], v[88:91], v[104:107], v[60:63]
    ds_read_b64_tr_b16 v[124:125], v149 offset:4096
    v_mfma_f32_16x16x32_bf16 v[64:67], v[96:99], v[92:95], v[64:67]
    ds_read_b64_tr_b16 v[126:127], v149 offset:5120
    v_mfma_f32_16x16x32_bf16 v[68:71], v[100:103], v[92:95], v[68:71]
    v_mfma_f32_16x16x32_bf16 v[72:75], v[92:95], v[104:107], v[72:75]
    s_waitcnt lgkmcnt(0)
    s_barrier
    v_mfma_f32_16x16x32_bf16 v[20:23], v[132:135], v[108:111], v[20:23]
    ds_read_b64_tr_b16 v[76:77], v147 offset:0
    ds_read_b64_tr_b16 v[78:79], v147 offset:256
    v_mfma_f32_16x16x32_bf16 v[24:27], v[108:111], v[136:139], v[24:27]
    ds_read_b64_tr_b16 v[96:97], v6 offset:0
    ds_read_b64_tr_b16 v[98:99], v6 offset:3072
    v_mfma_f32_16x16x32_bf16 v[28:31], v[128:131], v[112:115], v[28:31]
    ds_read_b64_tr_b16 v[100:101], v6 offset:1024
    ds_read_b64_tr_b16 v[102:103], v6 offset:4096
    v_mfma_f32_16x16x32_bf16 v[32:35], v[132:135], v[112:115], v[32:35]
    ds_read_b64_tr_b16 v[104:105], v6 offset:2048
    ds_read_b64_tr_b16 v[106:107], v6 offset:5120
    v_mfma_f32_16x16x32_bf16 v[36:39], v[112:115], v[136:139], v[36:39]
    ds_read_b64_tr_b16 v[80:81], v8 offset:0
    v_mfma_f32_16x16x32_bf16 v[40:43], v[128:131], v[116:119], v[40:43]
    ds_read_b64_tr_b16 v[82:83], v8 offset:1024
    v_mfma_f32_16x16x32_bf16 v[44:47], v[132:135], v[116:119], v[44:47]
    ds_read_b64_tr_b16 v[84:85], v9 offset:0
    v_mfma_f32_16x16x32_bf16 v[48:51], v[116:119], v[136:139], v[48:51]
    ds_read_b64_tr_b16 v[86:87], v9 offset:1024
    v_mfma_f32_16x16x32_bf16 v[52:55], v[128:131], v[120:123], v[52:55]
    ds_read_b64_tr_b16 v[88:89], v10 offset:0
    v_mfma_f32_16x16x32_bf16 v[56:59], v[132:135], v[120:123], v[56:59]
    ds_read_b64_tr_b16 v[90:91], v10 offset:1024
    v_mfma_f32_16x16x32_bf16 v[60:63], v[120:123], v[136:139], v[60:63]
    ds_read_b64_tr_b16 v[92:93], v11 offset:0
    v_mfma_f32_16x16x32_bf16 v[64:67], v[128:131], v[124:127], v[64:67]
    ds_read_b64_tr_b16 v[94:95], v11 offset:1024
    v_mfma_f32_16x16x32_bf16 v[68:71], v[132:135], v[124:127], v[68:71]
    v_mfma_f32_16x16x32_bf16 v[72:75], v[124:127], v[136:139], v[72:75]
    s_waitcnt lgkmcnt(0)
    v_mfma_f32_16x16x32_bf16 v[20:23], v[100:103], v[76:79], v[20:23]
    ds_read_b64_tr_b16 v[108:109], v147 offset:1024
    ds_read_b64_tr_b16 v[110:111], v147 offset:1280
    v_mfma_f32_16x16x32_bf16 v[24:27], v[76:79], v[104:107], v[24:27]
    ds_read_b64_tr_b16 v[128:129], v6 offset:12288
    ds_read_b64_tr_b16 v[130:131], v6 offset:15360
    v_mfma_f32_16x16x32_bf16 v[28:31], v[96:99], v[80:83], v[28:31]
    ds_read_b64_tr_b16 v[132:133], v6 offset:13312
    ds_read_b64_tr_b16 v[134:135], v6 offset:16384
    v_mfma_f32_16x16x32_bf16 v[32:35], v[100:103], v[80:83], v[32:35]
    ds_read_b64_tr_b16 v[136:137], v6 offset:14336
    ds_read_b64_tr_b16 v[138:139], v6 offset:17408
    v_mfma_f32_16x16x32_bf16 v[36:39], v[80:83], v[104:107], v[36:39]
    ds_read_b64_tr_b16 v[112:113], v8 offset:4096
    v_mfma_f32_16x16x32_bf16 v[40:43], v[96:99], v[84:87], v[40:43]
    ds_read_b64_tr_b16 v[114:115], v8 offset:5120
    v_mfma_f32_16x16x32_bf16 v[44:47], v[100:103], v[84:87], v[44:47]
    ds_read_b64_tr_b16 v[116:117], v9 offset:4096
    v_mfma_f32_16x16x32_bf16 v[48:51], v[84:87], v[104:107], v[48:51]
    ds_read_b64_tr_b16 v[118:119], v9 offset:5120
    v_mfma_f32_16x16x32_bf16 v[52:55], v[96:99], v[88:91], v[52:55]
    ds_read_b64_tr_b16 v[120:121], v10 offset:4096
    v_mfma_f32_16x16x32_bf16 v[56:59], v[100:103], v[88:91], v[56:59]
    ds_read_b64_tr_b16 v[122:123], v10 offset:5120
    v_mfma_f32_16x16x32_bf16 v[60:63], v[88:91], v[104:107], v[60:63]
    ds_read_b64_tr_b16 v[124:125], v11 offset:4096
    v_mfma_f32_16x16x32_bf16 v[64:67], v[96:99], v[92:95], v[64:67]
    ds_read_b64_tr_b16 v[126:127], v11 offset:5120
    v_mfma_f32_16x16x32_bf16 v[68:71], v[100:103], v[92:95], v[68:71]
    v_mfma_f32_16x16x32_bf16 v[72:75], v[92:95], v[104:107], v[72:75]
    s_waitcnt lgkmcnt(0)
    s_barrier
    v_mfma_f32_16x16x32_bf16 v[20:23], v[132:135], v[108:111], v[20:23]
    ds_read_b64_tr_b16 v[76:77], v147 offset:34816
    ds_read_b64_tr_b16 v[78:79], v147 offset:35072
    v_mfma_f32_16x16x32_bf16 v[24:27], v[108:111], v[136:139], v[24:27]
    ds_read_b64_tr_b16 v[96:97], v6 offset:34816
    ds_read_b64_tr_b16 v[98:99], v6 offset:37888
    v_mfma_f32_16x16x32_bf16 v[28:31], v[128:131], v[112:115], v[28:31]
    ds_read_b64_tr_b16 v[100:101], v6 offset:35840
    ds_read_b64_tr_b16 v[102:103], v6 offset:38912
    v_mfma_f32_16x16x32_bf16 v[32:35], v[132:135], v[112:115], v[32:35]
    ds_read_b64_tr_b16 v[104:105], v6 offset:36864
    ds_read_b64_tr_b16 v[106:107], v6 offset:39936
    v_mfma_f32_16x16x32_bf16 v[36:39], v[112:115], v[136:139], v[36:39]
    ds_read_b64_tr_b16 v[80:81], v8 offset:34816
    v_mfma_f32_16x16x32_bf16 v[40:43], v[128:131], v[116:119], v[40:43]
    ds_read_b64_tr_b16 v[82:83], v8 offset:35840
    v_mfma_f32_16x16x32_bf16 v[44:47], v[132:135], v[116:119], v[44:47]
    ds_read_b64_tr_b16 v[84:85], v9 offset:34816
    v_mfma_f32_16x16x32_bf16 v[48:51], v[116:119], v[136:139], v[48:51]
    ds_read_b64_tr_b16 v[86:87], v9 offset:35840
    v_mfma_f32_16x16x32_bf16 v[52:55], v[128:131], v[120:123], v[52:55]
    ds_read_b64_tr_b16 v[88:89], v10 offset:34816
    v_mfma_f32_16x16x32_bf16 v[56:59], v[132:135], v[120:123], v[56:59]
    ds_read_b64_tr_b16 v[90:91], v10 offset:35840
    v_mfma_f32_16x16x32_bf16 v[60:63], v[120:123], v[136:139], v[60:63]
    ds_read_b64_tr_b16 v[92:93], v11 offset:34816
    v_mfma_f32_16x16x32_bf16 v[64:67], v[128:131], v[124:127], v[64:67]
    ds_read_b64_tr_b16 v[94:95], v11 offset:35840
    v_mfma_f32_16x16x32_bf16 v[68:71], v[132:135], v[124:127], v[68:71]
    v_mfma_f32_16x16x32_bf16 v[72:75], v[124:127], v[136:139], v[72:75]
    s_waitcnt lgkmcnt(0)
    v_mfma_f32_16x16x32_bf16 v[20:23], v[100:103], v[76:79], v[20:23]
    ds_read_b64_tr_b16 v[108:109], v147 offset:35840
    ds_read_b64_tr_b16 v[110:111], v147 offset:36096
    v_mfma_f32_16x16x32_bf16 v[24:27], v[76:79], v[104:107], v[24:27]
    ds_read_b64_tr_b16 v[128:129], v6 offset:47104
    ds_read_b64_tr_b16 v[130:131], v6 offset:50176
    v_mfma_f32_16x16x32_bf16 v[28:31], v[96:99], v[80:83], v[28:31]
    ds_read_b64_tr_b16 v[132:133], v6 offset:48128
    ds_read_b64_tr_b16 v[134:135], v6 offset:51200
    v_mfma_f32_16x16x32_bf16 v[32:35], v[100:103], v[80:83], v[32:35]
    ds_read_b64_tr_b16 v[136:137], v6 offset:49152
    ds_read_b64_tr_b16 v[138:139], v6 offset:52224
    v_mfma_f32_16x16x32_bf16 v[36:39], v[80:83], v[104:107], v[36:39]
    ds_read_b64_tr_b16 v[112:113], v8 offset:38912
    v_mfma_f32_16x16x32_bf16 v[40:43], v[96:99], v[84:87], v[40:43]
    ds_read_b64_tr_b16 v[114:115], v8 offset:39936
    v_mfma_f32_16x16x32_bf16 v[44:47], v[100:103], v[84:87], v[44:47]
    ds_read_b64_tr_b16 v[116:117], v9 offset:38912
    v_mfma_f32_16x16x32_bf16 v[48:51], v[84:87], v[104:107], v[48:51]
    ds_read_b64_tr_b16 v[118:119], v9 offset:39936
    v_mfma_f32_16x16x32_bf16 v[52:55], v[96:99], v[88:91], v[52:55]
    ds_read_b64_tr_b16 v[120:121], v10 offset:38912
    v_mfma_f32_16x16x32_bf16 v[56:59], v[100:103], v[88:91], v[56:59]
    ds_read_b64_tr_b16 v[122:123], v10 offset:39936
    v_mfma_f32_16x16x32_bf16 v[60:63], v[88:91], v[104:107], v[60:63]
    ds_read_b64_tr_b16 v[124:125], v11 offset:38912
    v_mfma_f32_16x16x32_bf16 v[64:67], v[96:99], v[92:95], v[64:67]
    ds_read_b64_tr_b16 v[126:127], v11 offset:39936
    v_mfma_f32_16x16x32_bf16 v[68:71], v[100:103], v[92:95], v[68:71]
    v_mfma_f32_16x16x32_bf16 v[72:75], v[92:95], v[104:107], v[72:75]
    s_waitcnt lgkmcnt(0)
    s_barrier
    v_mfma_f32_16x16x32_bf16 v[20:23], v[132:135], v[108:111], v[20:23]
    ds_read_b64_tr_b16 v[76:77], v166 offset:0
    ds_read_b64_tr_b16 v[78:79], v166 offset:256
    v_mfma_f32_16x16x32_bf16 v[24:27], v[108:111], v[136:139], v[24:27]
    ds_read_b64_tr_b16 v[96:97], v7 offset:0
    ds_read_b64_tr_b16 v[98:99], v7 offset:3072
    v_mfma_f32_16x16x32_bf16 v[28:31], v[128:131], v[112:115], v[28:31]
    ds_read_b64_tr_b16 v[100:101], v7 offset:1024
    ds_read_b64_tr_b16 v[102:103], v7 offset:4096
    v_mfma_f32_16x16x32_bf16 v[32:35], v[132:135], v[112:115], v[32:35]
    ds_read_b64_tr_b16 v[104:105], v7 offset:2048
    ds_read_b64_tr_b16 v[106:107], v7 offset:5120
    v_mfma_f32_16x16x32_bf16 v[36:39], v[112:115], v[136:139], v[36:39]
    ds_read_b64_tr_b16 v[80:81], v14 offset:0
    v_mfma_f32_16x16x32_bf16 v[40:43], v[128:131], v[116:119], v[40:43]
    ds_read_b64_tr_b16 v[82:83], v14 offset:1024
    v_mfma_f32_16x16x32_bf16 v[44:47], v[132:135], v[116:119], v[44:47]
    ds_read_b64_tr_b16 v[84:85], v15 offset:0
    v_mfma_f32_16x16x32_bf16 v[48:51], v[116:119], v[136:139], v[48:51]
    ds_read_b64_tr_b16 v[86:87], v15 offset:1024
    v_mfma_f32_16x16x32_bf16 v[52:55], v[128:131], v[120:123], v[52:55]
    ds_read_b64_tr_b16 v[88:89], v148 offset:0
    v_mfma_f32_16x16x32_bf16 v[56:59], v[132:135], v[120:123], v[56:59]
    ds_read_b64_tr_b16 v[90:91], v148 offset:1024
    v_mfma_f32_16x16x32_bf16 v[60:63], v[120:123], v[136:139], v[60:63]
    ds_read_b64_tr_b16 v[92:93], v149 offset:0
    v_mfma_f32_16x16x32_bf16 v[64:67], v[128:131], v[124:127], v[64:67]
    ds_read_b64_tr_b16 v[94:95], v149 offset:1024
    v_mfma_f32_16x16x32_bf16 v[68:71], v[132:135], v[124:127], v[68:71]
    v_mfma_f32_16x16x32_bf16 v[72:75], v[124:127], v[136:139], v[72:75]
    s_waitcnt lgkmcnt(0)
    v_mfma_f32_16x16x32_bf16 v[20:23], v[100:103], v[76:79], v[20:23]
    ds_read_b64_tr_b16 v[108:109], v166 offset:1024
    ds_read_b64_tr_b16 v[110:111], v166 offset:1280
    v_mfma_f32_16x16x32_bf16 v[24:27], v[76:79], v[104:107], v[24:27]
    ds_read_b64_tr_b16 v[128:129], v7 offset:12288
    ds_read_b64_tr_b16 v[130:131], v7 offset:15360
    v_mfma_f32_16x16x32_bf16 v[28:31], v[96:99], v[80:83], v[28:31]
    ds_read_b64_tr_b16 v[132:133], v7 offset:13312
    ds_read_b64_tr_b16 v[134:135], v7 offset:16384
    v_mfma_f32_16x16x32_bf16 v[32:35], v[100:103], v[80:83], v[32:35]
    ds_read_b64_tr_b16 v[136:137], v7 offset:14336
    ds_read_b64_tr_b16 v[138:139], v7 offset:17408
    v_mfma_f32_16x16x32_bf16 v[36:39], v[80:83], v[104:107], v[36:39]
    ds_read_b64_tr_b16 v[112:113], v14 offset:4096
    v_mfma_f32_16x16x32_bf16 v[40:43], v[96:99], v[84:87], v[40:43]
    ds_read_b64_tr_b16 v[114:115], v14 offset:5120
    v_mfma_f32_16x16x32_bf16 v[44:47], v[100:103], v[84:87], v[44:47]
    ds_read_b64_tr_b16 v[116:117], v15 offset:4096
    v_mfma_f32_16x16x32_bf16 v[48:51], v[84:87], v[104:107], v[48:51]
    ds_read_b64_tr_b16 v[118:119], v15 offset:5120
    v_mfma_f32_16x16x32_bf16 v[52:55], v[96:99], v[88:91], v[52:55]
    ds_read_b64_tr_b16 v[120:121], v148 offset:4096
    v_mfma_f32_16x16x32_bf16 v[56:59], v[100:103], v[88:91], v[56:59]
    ds_read_b64_tr_b16 v[122:123], v148 offset:5120
    v_mfma_f32_16x16x32_bf16 v[60:63], v[88:91], v[104:107], v[60:63]
    ds_read_b64_tr_b16 v[124:125], v149 offset:4096
    v_mfma_f32_16x16x32_bf16 v[64:67], v[96:99], v[92:95], v[64:67]
    ds_read_b64_tr_b16 v[126:127], v149 offset:5120
    v_mfma_f32_16x16x32_bf16 v[68:71], v[100:103], v[92:95], v[68:71]
    v_mfma_f32_16x16x32_bf16 v[72:75], v[92:95], v[104:107], v[72:75]
    s_waitcnt lgkmcnt(0)
    s_barrier
    v_mfma_f32_16x16x32_bf16 v[20:23], v[132:135], v[108:111], v[20:23]
    ds_read_b64_tr_b16 v[76:77], v147 offset:0
    ds_read_b64_tr_b16 v[78:79], v147 offset:256
    v_mfma_f32_16x16x32_bf16 v[24:27], v[108:111], v[136:139], v[24:27]
    ds_read_b64_tr_b16 v[96:97], v6 offset:0
    ds_read_b64_tr_b16 v[98:99], v6 offset:3072
    v_mfma_f32_16x16x32_bf16 v[28:31], v[128:131], v[112:115], v[28:31]
    ds_read_b64_tr_b16 v[100:101], v6 offset:1024
    ds_read_b64_tr_b16 v[102:103], v6 offset:4096
    v_mfma_f32_16x16x32_bf16 v[32:35], v[132:135], v[112:115], v[32:35]
    ds_read_b64_tr_b16 v[104:105], v6 offset:2048
    ds_read_b64_tr_b16 v[106:107], v6 offset:5120
    v_mfma_f32_16x16x32_bf16 v[36:39], v[112:115], v[136:139], v[36:39]
    ds_read_b64_tr_b16 v[80:81], v8 offset:0
    v_mfma_f32_16x16x32_bf16 v[40:43], v[128:131], v[116:119], v[40:43]
    ds_read_b64_tr_b16 v[82:83], v8 offset:1024
    v_mfma_f32_16x16x32_bf16 v[44:47], v[132:135], v[116:119], v[44:47]
    ds_read_b64_tr_b16 v[84:85], v9 offset:0
    v_mfma_f32_16x16x32_bf16 v[48:51], v[116:119], v[136:139], v[48:51]
    ds_read_b64_tr_b16 v[86:87], v9 offset:1024
    v_mfma_f32_16x16x32_bf16 v[52:55], v[128:131], v[120:123], v[52:55]
    ds_read_b64_tr_b16 v[88:89], v10 offset:0
    v_mfma_f32_16x16x32_bf16 v[56:59], v[132:135], v[120:123], v[56:59]
    ds_read_b64_tr_b16 v[90:91], v10 offset:1024
    v_mfma_f32_16x16x32_bf16 v[60:63], v[120:123], v[136:139], v[60:63]
    ds_read_b64_tr_b16 v[92:93], v11 offset:0
    v_mfma_f32_16x16x32_bf16 v[64:67], v[128:131], v[124:127], v[64:67]
    ds_read_b64_tr_b16 v[94:95], v11 offset:1024
    v_mfma_f32_16x16x32_bf16 v[68:71], v[132:135], v[124:127], v[68:71]
    v_mfma_f32_16x16x32_bf16 v[72:75], v[124:127], v[136:139], v[72:75]
    s_waitcnt lgkmcnt(0)
    v_mfma_f32_16x16x32_bf16 v[20:23], v[100:103], v[76:79], v[20:23]
    ds_read_b64_tr_b16 v[108:109], v147 offset:1024
    ds_read_b64_tr_b16 v[110:111], v147 offset:1280
    v_mfma_f32_16x16x32_bf16 v[24:27], v[76:79], v[104:107], v[24:27]
    ds_read_b64_tr_b16 v[128:129], v6 offset:12288
    ds_read_b64_tr_b16 v[130:131], v6 offset:15360
    v_mfma_f32_16x16x32_bf16 v[28:31], v[96:99], v[80:83], v[28:31]
    ds_read_b64_tr_b16 v[132:133], v6 offset:13312
    ds_read_b64_tr_b16 v[134:135], v6 offset:16384
    v_mfma_f32_16x16x32_bf16 v[32:35], v[100:103], v[80:83], v[32:35]
    ds_read_b64_tr_b16 v[136:137], v6 offset:14336
    ds_read_b64_tr_b16 v[138:139], v6 offset:17408
    v_mfma_f32_16x16x32_bf16 v[36:39], v[80:83], v[104:107], v[36:39]
    ds_read_b64_tr_b16 v[112:113], v8 offset:4096
    v_mfma_f32_16x16x32_bf16 v[40:43], v[96:99], v[84:87], v[40:43]
    ds_read_b64_tr_b16 v[114:115], v8 offset:5120
    v_mfma_f32_16x16x32_bf16 v[44:47], v[100:103], v[84:87], v[44:47]
    ds_read_b64_tr_b16 v[116:117], v9 offset:4096
    v_mfma_f32_16x16x32_bf16 v[48:51], v[84:87], v[104:107], v[48:51]
    ds_read_b64_tr_b16 v[118:119], v9 offset:5120
    v_mfma_f32_16x16x32_bf16 v[52:55], v[96:99], v[88:91], v[52:55]
    ds_read_b64_tr_b16 v[120:121], v10 offset:4096
    v_mfma_f32_16x16x32_bf16 v[56:59], v[100:103], v[88:91], v[56:59]
    ds_read_b64_tr_b16 v[122:123], v10 offset:5120
    v_mfma_f32_16x16x32_bf16 v[60:63], v[88:91], v[104:107], v[60:63]
    ds_read_b64_tr_b16 v[124:125], v11 offset:4096
    v_mfma_f32_16x16x32_bf16 v[64:67], v[96:99], v[92:95], v[64:67]
    ds_read_b64_tr_b16 v[126:127], v11 offset:5120
    v_mfma_f32_16x16x32_bf16 v[68:71], v[100:103], v[92:95], v[68:71]
    v_mfma_f32_16x16x32_bf16 v[72:75], v[92:95], v[104:107], v[72:75]
    s_waitcnt lgkmcnt(0)
    s_barrier
    v_mfma_f32_16x16x32_bf16 v[20:23], v[132:135], v[108:111], v[20:23]
    ds_read_b64_tr_b16 v[76:77], v147 offset:34816
    ds_read_b64_tr_b16 v[78:79], v147 offset:35072
    v_mfma_f32_16x16x32_bf16 v[24:27], v[108:111], v[136:139], v[24:27]
    ds_read_b64_tr_b16 v[96:97], v6 offset:34816
    ds_read_b64_tr_b16 v[98:99], v6 offset:37888
    v_mfma_f32_16x16x32_bf16 v[28:31], v[128:131], v[112:115], v[28:31]
    ds_read_b64_tr_b16 v[100:101], v6 offset:35840
    ds_read_b64_tr_b16 v[102:103], v6 offset:38912
    v_mfma_f32_16x16x32_bf16 v[32:35], v[132:135], v[112:115], v[32:35]
    ds_read_b64_tr_b16 v[104:105], v6 offset:36864
    ds_read_b64_tr_b16 v[106:107], v6 offset:39936
    v_mfma_f32_16x16x32_bf16 v[36:39], v[112:115], v[136:139], v[36:39]
    ds_read_b64_tr_b16 v[80:81], v8 offset:34816
    v_mfma_f32_16x16x32_bf16 v[40:43], v[128:131], v[116:119], v[40:43]
    ds_read_b64_tr_b16 v[82:83], v8 offset:35840
    v_mfma_f32_16x16x32_bf16 v[44:47], v[132:135], v[116:119], v[44:47]
    ds_read_b64_tr_b16 v[84:85], v9 offset:34816
    v_mfma_f32_16x16x32_bf16 v[48:51], v[116:119], v[136:139], v[48:51]
    ds_read_b64_tr_b16 v[86:87], v9 offset:35840
    v_mfma_f32_16x16x32_bf16 v[52:55], v[128:131], v[120:123], v[52:55]
    ds_read_b64_tr_b16 v[88:89], v10 offset:34816
    v_mfma_f32_16x16x32_bf16 v[56:59], v[132:135], v[120:123], v[56:59]
    ds_read_b64_tr_b16 v[90:91], v10 offset:35840
    v_mfma_f32_16x16x32_bf16 v[60:63], v[120:123], v[136:139], v[60:63]
    ds_read_b64_tr_b16 v[92:93], v11 offset:34816
    v_mfma_f32_16x16x32_bf16 v[64:67], v[128:131], v[124:127], v[64:67]
    ds_read_b64_tr_b16 v[94:95], v11 offset:35840
    v_mfma_f32_16x16x32_bf16 v[68:71], v[132:135], v[124:127], v[68:71]
    v_mfma_f32_16x16x32_bf16 v[72:75], v[124:127], v[136:139], v[72:75]
    s_waitcnt lgkmcnt(0)
    v_mfma_f32_16x16x32_bf16 v[20:23], v[100:103], v[76:79], v[20:23]
    ds_read_b64_tr_b16 v[108:109], v147 offset:35840
    ds_read_b64_tr_b16 v[110:111], v147 offset:36096
    v_mfma_f32_16x16x32_bf16 v[24:27], v[76:79], v[104:107], v[24:27]
    ds_read_b64_tr_b16 v[128:129], v6 offset:47104
    ds_read_b64_tr_b16 v[130:131], v6 offset:50176
    v_mfma_f32_16x16x32_bf16 v[28:31], v[96:99], v[80:83], v[28:31]
    ds_read_b64_tr_b16 v[132:133], v6 offset:48128
    ds_read_b64_tr_b16 v[134:135], v6 offset:51200
    v_mfma_f32_16x16x32_bf16 v[32:35], v[100:103], v[80:83], v[32:35]
    ds_read_b64_tr_b16 v[136:137], v6 offset:49152
    ds_read_b64_tr_b16 v[138:139], v6 offset:52224
    v_mfma_f32_16x16x32_bf16 v[36:39], v[80:83], v[104:107], v[36:39]
    ds_read_b64_tr_b16 v[112:113], v8 offset:38912
    v_mfma_f32_16x16x32_bf16 v[40:43], v[96:99], v[84:87], v[40:43]
    ds_read_b64_tr_b16 v[114:115], v8 offset:39936
    v_mfma_f32_16x16x32_bf16 v[44:47], v[100:103], v[84:87], v[44:47]
    ds_read_b64_tr_b16 v[116:117], v9 offset:38912
    v_mfma_f32_16x16x32_bf16 v[48:51], v[84:87], v[104:107], v[48:51]
    ds_read_b64_tr_b16 v[118:119], v9 offset:39936
    v_mfma_f32_16x16x32_bf16 v[52:55], v[96:99], v[88:91], v[52:55]
    ds_read_b64_tr_b16 v[120:121], v10 offset:38912
    v_mfma_f32_16x16x32_bf16 v[56:59], v[100:103], v[88:91], v[56:59]
    ds_read_b64_tr_b16 v[122:123], v10 offset:39936
    v_mfma_f32_16x16x32_bf16 v[60:63], v[88:91], v[104:107], v[60:63]
    ds_read_b64_tr_b16 v[124:125], v11 offset:38912
    v_mfma_f32_16x16x32_bf16 v[64:67], v[96:99], v[92:95], v[64:67]
    ds_read_b64_tr_b16 v[126:127], v11 offset:39936
    v_mfma_f32_16x16x32_bf16 v[68:71], v[100:103], v[92:95], v[68:71]
    v_mfma_f32_16x16x32_bf16 v[72:75], v[92:95], v[104:107], v[72:75]
    s_waitcnt lgkmcnt(0)
    v_mfma_f32_16x16x32_bf16 v[20:23], v[132:135], v[108:111], v[20:23]
    v_mfma_f32_16x16x32_bf16 v[24:27], v[108:111], v[136:139], v[24:27]
    v_mfma_f32_16x16x32_bf16 v[28:31], v[128:131], v[112:115], v[28:31]
    v_mfma_f32_16x16x32_bf16 v[32:35], v[132:135], v[112:115], v[32:35]
    v_mfma_f32_16x16x32_bf16 v[36:39], v[112:115], v[136:139], v[36:39]
    v_mfma_f32_16x16x32_bf16 v[40:43], v[128:131], v[116:119], v[40:43]
    v_mfma_f32_16x16x32_bf16 v[44:47], v[132:135], v[116:119], v[44:47]
    v_mfma_f32_16x16x32_bf16 v[48:51], v[116:119], v[136:139], v[48:51]
    v_mfma_f32_16x16x32_bf16 v[52:55], v[128:131], v[120:123], v[52:55]
    v_mfma_f32_16x16x32_bf16 v[56:59], v[132:135], v[120:123], v[56:59]
    v_mfma_f32_16x16x32_bf16 v[60:63], v[120:123], v[136:139], v[60:63]
    v_mfma_f32_16x16x32_bf16 v[64:67], v[128:131], v[124:127], v[64:67]
    v_mfma_f32_16x16x32_bf16 v[68:71], v[132:135], v[124:127], v[68:71]
    v_mfma_f32_16x16x32_bf16 v[72:75], v[124:127], v[136:139], v[72:75]
c_loopdone:
    s_lshl_b32 s33, s78, 2
    s_add_u32 s33, s33, 106368
    v_mov_b32 v3, s33
    s_barrier
    s_setprio 2
    ds_read_b32 v3, v3
    ds_read_b64 v[76:77], v145 offset:0
    ds_read_b64 v[78:79], v145 offset:128
    ds_read_b64 v[80:81], v145 offset:256
    ds_read_b64 v[82:83], v145 offset:384
    ds_read_b64 v[84:85], v145 offset:512
    ds_read_b128 v[88:91], v146 offset:0
    ds_read_b128 v[92:95], v146 offset:320
    ds_read_b128 v[96:99], v146 offset:64
    ds_read_b128 v[100:103], v146 offset:384
    ds_read_b128 v[104:107], v146 offset:128
    ds_read_b128 v[108:111], v146 offset:448
    ds_read_b128 v[112:115], v146 offset:192
    ds_read_b128 v[116:119], v146 offset:512
    ds_read_b128 v[120:123], v146 offset:256
    ds_read_b128 v[124:127], v146 offset:576
    s_cmp_eq_u32 s52, 2
    s_cbranch_scc1 c_cs2
    v_mov_b32_dpp v128, v16 row_newbcast:0 row_mask:0xf bank_mask:0xf
    v_mov_b32_dpp v129, v17 row_newbcast:0 row_mask:0xf bank_mask:0xf
    v_mov_b32_dpp v130, v18 row_newbcast:0 row_mask:0xf bank_mask:0xf
    v_mov_b32_dpp v131, v19 row_newbcast:0 row_mask:0xf bank_mask:0xf
    v_mov_b32_dpp v132, v20 row_newbcast:0 row_mask:0xf bank_mask:0xf
    v_mov_b32_dpp v133, v21 row_newbcast:0 row_mask:0xf bank_mask:0xf
    v_mov_b32_dpp v134, v22 row_newbcast:0 row_mask:0xf bank_mask:0xf
    v_mov_b32_dpp v135, v23 row_newbcast:0 row_mask:0xf bank_mask:0xf
    v_mov_b32 v136, v24
    v_mov_b32 v137, v24
    s_nop 1
    v_permlane16_swap_b32 v136, v137
    v_mov_b32 v137, v136
    s_nop 1
    v_permlane32_swap_b32 v136, v137
    s_branch c_cs3
c_cs2:
    s_waitcnt lgkmcnt(15)
    v_readfirstlane_b32 s33, v3
    v_mov_b32 v128, v156
    v_mov_b32 v129, v157
    v_mov_b32 v130, v158
    v_mov_b32 v131, v159
    v_mov_b32 v132, v160
    v_mov_b32 v133, v161
    v_mov_b32 v134, v162
    v_mov_b32 v135, v163
    v_mov_b32 v136, v164
    s_cmp_eq_u32 s33, 0
    s_cbranch_scc1 c_cs3
    s_add_u32 s78, s78, 1
    s_cmp_lt_u32 s78, 8
    s_waitcnt lgkmcnt(0)
    s_setprio 0
    s_cbranch_scc1 c_att_xt
    s_mov_b32 s78, 7
    s_nop 0
c_cs3:
    s_waitcnt lgkmcnt(10)
    v_pk_fma_f32 v[20:21], v[132:133], v[76:77], v[20:21] op_sel_hi:[1,0,1] neg_lo:[0,1,0] neg_hi:[0,1,0]
    v_pk_fma_f32 v[22:23], v[134:135], v[76:77], v[22:23] op_sel_hi:[1,0,1] neg_lo:[0,1,0] neg_hi:[0,1,0]
    v_pk_fma_f32 v[28:29], v[128:129], v[78:79], v[28:29] op_sel_hi:[1,0,1] neg_lo:[0,1,0] neg_hi:[0,1,0]
    v_pk_fma_f32 v[30:31], v[130:131], v[78:79], v[30:31] op_sel_hi:[1,0,1] neg_lo:[0,1,0] neg_hi:[0,1,0]
    v_pk_fma_f32 v[32:33], v[132:133], v[78:79], v[32:33] op_sel_hi:[1,0,1] neg_lo:[0,1,0] neg_hi:[0,1,0]
    v_pk_fma_f32 v[34:35], v[134:135], v[78:79], v[34:35] op_sel_hi:[1,0,1] neg_lo:[0,1,0] neg_hi:[0,1,0]
    v_pk_fma_f32 v[40:41], v[128:129], v[80:81], v[40:41] op_sel_hi:[1,0,1] neg_lo:[0,1,0] neg_hi:[0,1,0]
    v_pk_fma_f32 v[42:43], v[130:131], v[80:81], v[42:43] op_sel_hi:[1,0,1] neg_lo:[0,1,0] neg_hi:[0,1,0]
    v_pk_fma_f32 v[44:45], v[132:133], v[80:81], v[44:45] op_sel_hi:[1,0,1] neg_lo:[0,1,0] neg_hi:[0,1,0]
    v_pk_fma_f32 v[46:47], v[134:135], v[80:81], v[46:47] op_sel_hi:[1,0,1] neg_lo:[0,1,0] neg_hi:[0,1,0]
    v_pk_fma_f32 v[52:53], v[128:129], v[82:83], v[52:53] op_sel_hi:[1,0,1] neg_lo:[0,1,0] neg_hi:[0,1,0]
    v_pk_fma_f32 v[54:55], v[130:131], v[82:83], v[54:55] op_sel_hi:[1,0,1] neg_lo:[0,1,0] neg_hi:[0,1,0]
    v_pk_fma_f32 v[56:57], v[132:133], v[82:83], v[56:57] op_sel_hi:[1,0,1] neg_lo:[0,1,0] neg_hi:[0,1,0]
    v_pk_fma_f32 v[58:59], v[134:135], v[82:83], v[58:59] op_sel_hi:[1,0,1] neg_lo:[0,1,0] neg_hi:[0,1,0]
    v_pk_fma_f32 v[64:65], v[128:129], v[84:85], v[64:65] op_sel_hi:[1,0,1] neg_lo:[0,1,0] neg_hi:[0,1,0]
    v_pk_fma_f32 v[66:67], v[130:131], v[84:85], v[66:67] op_sel_hi:[1,0,1] neg_lo:[0,1,0] neg_hi:[0,1,0]
    v_pk_fma_f32 v[68:69], v[132:133], v[84:85], v[68:69] op_sel_hi:[1,0,1] neg_lo:[0,1,0] neg_hi:[0,1,0]
    v_pk_fma_f32 v[70:71], v[134:135], v[84:85], v[70:71] op_sel_hi:[1,0,1] neg_lo:[0,1,0] neg_hi:[0,1,0]
    v_pk_mul_f32 v[20:21], v[20:21], v[76:77] op_sel:[0,1] op_sel_hi:[1,1]
    v_pk_mul_f32 v[22:23], v[22:23], v[76:77] op_sel:[0,1] op_sel_hi:[1,1]
    v_pk_mul_f32 v[28:29], v[28:29], v[78:79] op_sel:[0,1] op_sel_hi:[1,1]
    v_pk_mul_f32 v[30:31], v[30:31], v[78:79] op_sel:[0,1] op_sel_hi:[1,1]
    v_pk_mul_f32 v[32:33], v[32:33], v[78:79] op_sel:[0,1] op_sel_hi:[1,1]
    v_pk_mul_f32 v[34:35], v[34:35], v[78:79] op_sel:[0,1] op_sel_hi:[1,1]
    v_pk_mul_f32 v[40:41], v[40:41], v[80:81] op_sel:[0,1] op_sel_hi:[1,1]
    v_pk_mul_f32 v[42:43], v[42:43], v[80:81] op_sel:[0,1] op_sel_hi:[1,1]
    v_pk_mul_f32 v[44:45], v[44:45], v[80:81] op_sel:[0,1] op_sel_hi:[1,1]
    v_pk_mul_f32 v[46:47], v[46:47], v[80:81] op_sel:[0,1] op_sel_hi:[1,1]
    v_pk_mul_f32 v[52:53], v[52:53], v[82:83] op_sel:[0,1] op_sel_hi:[1,1]
    v_pk_mul_f32 v[54:55], v[54:55], v[82:83] op_sel:[0,1] op_sel_hi:[1,1]
    v_pk_mul_f32 v[56:57], v[56:57], v[82:83] op_sel:[0,1] op_sel_hi:[1,1]
    v_pk_mul_f32 v[58:59], v[58:59], v[82:83] op_sel:[0,1] op_sel_hi:[1,1]
    v_pk_mul_f32 v[64:65], v[64:65], v[84:85] op_sel:[0,1] op_sel_hi:[1,1]
    v_pk_mul_f32 v[66:67], v[66:67], v[84:85] op_sel:[0,1] op_sel_hi:[1,1]
    v_pk_mul_f32 v[68:69], v[68:69], v[84:85] op_sel:[0,1] op_sel_hi:[1,1]
    v_pk_mul_f32 v[70:71], v[70:71], v[84:85] op_sel:[0,1] op_sel_hi:[1,1]
    v_cvt_pk_bf16_f32 v20, v20, v21
    v_cvt_pk_bf16_f32 v21, v22, v23
    v_cvt_pk_bf16_f32 v148, v28, v29
    v_cvt_pk_bf16_f32 v149, v30, v31
    v_cvt_pk_bf16_f32 v32, v32, v33
    v_cvt_pk_bf16_f32 v33, v34, v35
    v_cvt_pk_bf16_f32 v150, v40, v41
    v_cvt_pk_bf16_f32 v151, v42, v43
    v_cvt_pk_bf16_f32 v44, v44, v45
    v_cvt_pk_bf16_f32 v45, v46, v47
    v_cvt_pk_bf16_f32 v152, v52, v53
    v_cvt_pk_bf16_f32 v153, v54, v55
    v_cvt_pk_bf16_f32 v56, v56, v57
    v_cvt_pk_bf16_f32 v57, v58, v59
    v_cvt_pk_bf16_f32 v154, v64, v65
    v_cvt_pk_bf16_f32 v155, v66, v67
    v_cvt_pk_bf16_f32 v68, v68, v69
    v_cvt_pk_bf16_f32 v69, v70, v71
    s_waitcnt lgkmcnt(0)
    v_pk_fma_f32 v[24:25], v[88:89], v[136:137], v[24:25] op_sel_hi:[1,0,1] neg_lo:[1,0,0] neg_hi:[1,0,0]
    v_pk_fma_f32 v[26:27], v[90:91], v[136:137], v[26:27] op_sel_hi:[1,0,1] neg_lo:[1,0,0] neg_hi:[1,0,0]
    v_pk_fma_f32 v[36:37], v[96:97], v[136:137], v[36:37] op_sel_hi:[1,0,1] neg_lo:[1,0,0] neg_hi:[1,0,0]
    v_pk_fma_f32 v[38:39], v[98:99], v[136:137], v[38:39] op_sel_hi:[1,0,1] neg_lo:[1,0,0] neg_hi:[1,0,0]
    v_pk_fma_f32 v[48:49], v[104:105], v[136:137], v[48:49] op_sel_hi:[1,0,1] neg_lo:[1,0,0] neg_hi:[1,0,0]
    v_pk_fma_f32 v[50:51], v[106:107], v[136:137], v[50:51] op_sel_hi:[1,0,1] neg_lo:[1,0,0] neg_hi:[1,0,0]
    v_pk_fma_f32 v[60:61], v[112:113], v[136:137], v[60:61] op_sel_hi:[1,0,1] neg_lo:[1,0,0] neg_hi:[1,0,0]
    v_pk_fma_f32 v[62:63], v[114:115], v[136:137], v[62:63] op_sel_hi:[1,0,1] neg_lo:[1,0,0] neg_hi:[1,0,0]
    v_pk_fma_f32 v[72:73], v[120:121], v[136:137], v[72:73] op_sel_hi:[1,0,1] neg_lo:[1,0,0] neg_hi:[1,0,0]
    v_pk_fma_f32 v[74:75], v[122:123], v[136:137], v[74:75] op_sel_hi:[1,0,1] neg_lo:[1,0,0] neg_hi:[1,0,0]
    v_pk_mul_f32 v[24:25], v[24:25], v[92:93]
    v_pk_mul_f32 v[26:27], v[26:27], v[94:95]
    v_pk_mul_f32 v[36:37], v[36:37], v[100:101]
    v_pk_mul_f32 v[38:39], v[38:39], v[102:103]
    v_pk_mul_f32 v[48:49], v[48:49], v[108:109]
    v_pk_mul_f32 v[50:51], v[50:51], v[110:111]
    v_pk_mul_f32 v[60:61], v[60:61], v[116:117]
    v_pk_mul_f32 v[62:63], v[62:63], v[118:119]
    v_pk_mul_f32 v[72:73], v[72:73], v[124:125]
    v_pk_mul_f32 v[74:75], v[74:75], v[126:127]
    v_cvt_pk_bf16_f32 v156, v24, v25
    v_cvt_pk_bf16_f32 v157, v26, v27
    v_cvt_pk_bf16_f32 v158, v36, v37
    v_cvt_pk_bf16_f32 v159, v38, v39
    v_cvt_pk_bf16_f32 v160, v48, v49
    v_cvt_pk_bf16_f32 v161, v50, v51
    v_cvt_pk_bf16_f32 v162, v60, v61
    v_cvt_pk_bf16_f32 v163, v62, v63
    v_cvt_pk_bf16_f32 v164, v72, v73
    v_cvt_pk_bf16_f32 v165, v74, v75
    v_mov_b32 v139, 0
    buffer_load_dword v138, v139, s[8:11], s55 offen sc1
    v_mfma_f32_16x16x16_bf16 v[28:31], v[32:33], v[148:149], 0
    v_mfma_f32_16x16x16_bf16 v[36:39], v[20:21], v[148:149], 0
    v_mfma_f32_16x16x16_bf16 v[40:43], v[44:45], v[150:151], 0
    v_mfma_f32_16x16x16_bf16 v[48:51], v[32:33], v[150:151], 0
    v_mfma_f32_16x16x16_bf16 v[52:55], v[56:57], v[152:153], 0
    v_mfma_f32_16x16x16_bf16 v[60:63], v[44:45], v[152:153], 0
    v_mfma_f32_16x16x16_bf16 v[64:67], v[68:69], v[154:155], 0
    v_mfma_f32_16x16x16_bf16 v[72:75], v[56:57], v[154:155], 0
    v_mov_b32 v2, 0xcf6e6b28
    s_mov_b32 s35, 0xffff0000
    s_mov_b32 s36, 0x3eb8aa3b
    s_lshl_b32 s34, s25, 2
    s_add_u32 s34, s34, s27
    s_lshl_b32 s34, s34, 11
    s_lshl_b32 s31, s24, 10
    s_add_u32 s34, s34, s31
    s_sub_u32 s53, s52, 1
    s_lshl_b32 s31, s53, 21
    s_add_u32 s34, s34, s31
    v_cndmask_b32 v76, v28, v29, s[42:43]
    v_cndmask_b32 v77, v30, v31, s[42:43]
    v_cndmask_b32 v78, v36, v37, s[42:43]
    v_cndmask_b32 v79, v38, v39, s[42:43]
    v_cndmask_b32 v78, v78, v2, s[48:49]
    v_cndmask_b32 v79, v79, v2, s[48:49]
    v_cndmask_b32 v84, v40, v41, s[42:43]
    v_cndmask_b32 v85, v42, v43, s[42:43]
    v_cndmask_b32 v86, v48, v49, s[42:43]
    v_cndmask_b32 v87, v50, v51, s[42:43]
    v_cndmask_b32 v92, v52, v53, s[42:43]
    v_cndmask_b32 v93, v54, v55, s[42:43]
    v_cndmask_b32 v94, v60, v61, s[42:43]
    v_cndmask_b32 v95, v62, v63, s[42:43]
    v_cndmask_b32 v100, v64, v65, s[42:43]
    v_cndmask_b32 v101, v66, v67, s[42:43]
    v_cndmask_b32 v102, v72, v73, s[42:43]
    v_cndmask_b32 v103, v74, v75, s[42:43]
    v_cndmask_b32 v76, v78, v76, s[44:45]
    v_cndmask_b32 v77, v79, v77, s[46:47]
    v_cndmask_b32 v84, v86, v84, s[44:45]
    v_cndmask_b32 v85, v87, v85, s[46:47]
    v_cndmask_b32 v92, v94, v92, s[44:45]
    v_cndmask_b32 v93, v95, v93, s[46:47]
    v_cndmask_b32 v100, v102, v100, s[44:45]
    v_cndmask_b32 v101, v103, v101, s[46:47]
    v_cvt_pk_bf16_f32 v78, v76, v77
    v_cvt_pk_bf16_f32 v86, v84, v85
    v_cvt_pk_bf16_f32 v94, v92, v93
    v_cvt_pk_bf16_f32 v102, v100, v101
    v_lshlrev_b32 v76, 16, v78
    v_and_b32 v77, s35, v78
    v_lshlrev_b32 v84, 16, v86
    v_and_b32 v85, s35, v86
    v_lshlrev_b32 v92, 16, v94
    v_and_b32 v93, s35, v94
    v_lshlrev_b32 v100, 16, v102
    v_and_b32 v101, s35, v102
    v_max_f32 v78, v76, v77
    v_max_f32 v86, v84, v85
    v_max_f32 v94, v92, v93
    v_max_f32 v102, v100, v101
    v_mov_b32 v79, v78
    v_mov_b32 v87, v86
    v_mov_b32 v95, v94
    v_mov_b32 v103, v102
    v_permlane16_swap_b32 v78, v79
    v_permlane16_swap_b32 v86, v87
    v_permlane16_swap_b32 v94, v95
    v_permlane16_swap_b32 v102, v103
    v_max_f32 v78, v78, v79
    v_max_f32 v86, v86, v87
    v_max_f32 v94, v94, v95
    v_max_f32 v102, v102, v103
    v_mov_b32 v79, v78
    v_mov_b32 v87, v86
    v_mov_b32 v95, v94
    v_mov_b32 v103, v102
    v_permlane32_swap_b32 v78, v79
    v_permlane32_swap_b32 v86, v87
    v_permlane32_swap_b32 v94, v95
    v_permlane32_swap_b32 v102, v103
    v_max_f32 v78, v78, v79
    v_max_f32 v86, v86, v87
    v_max_f32 v94, v94, v95
    v_max_f32 v102, v102, v103
    v_sub_f32 v76, v76, v78
    v_sub_f32 v77, v77, v78
    v_sub_f32 v84, v84, v86
    v_sub_f32 v85, v85, v86
    v_sub_f32 v92, v92, v94
    v_sub_f32 v93, v93, v94
    v_sub_f32 v100, v100, v102
    v_sub_f32 v101, v101, v102
    v_mul_f32 v76, s36, v76
    v_mul_f32 v77, s36, v77
    v_mul_f32 v84, s36, v84
    v_mul_f32 v85, s36, v85
    v_mul_f32 v92, s36, v92
    v_mul_f32 v93, s36, v93
    v_mul_f32 v100, s36, v100
    v_mul_f32 v101, s36, v101
    v_exp_f32 v76, v76
    v_exp_f32 v77, v77
    v_exp_f32 v84, v84
    v_exp_f32 v85, v85
    v_exp_f32 v92, v92
    v_exp_f32 v93, v93
    v_exp_f32 v100, v100
    v_exp_f32 v101, v101
    v_add_f32 v78, v76, v77
    v_add_f32 v86, v84, v85
    v_add_f32 v94, v92, v93
    v_add_f32 v102, v100, v101
    v_mov_b32 v79, v78
    v_mov_b32 v87, v86
    v_mov_b32 v95, v94
    v_mov_b32 v103, v102
    v_permlane16_swap_b32 v78, v79
    v_permlane16_swap_b32 v86, v87
    v_permlane16_swap_b32 v94, v95
    v_permlane16_swap_b32 v102, v103
    v_add_f32 v78, v78, v79
    v_add_f32 v86, v86, v87
    v_add_f32 v94, v94, v95
    v_add_f32 v102, v102, v103
    v_mov_b32 v79, v78
    v_mov_b32 v87, v86
    v_mov_b32 v95, v94
    v_mov_b32 v103, v102
    v_permlane32_swap_b32 v78, v79
    v_permlane32_swap_b32 v86, v87
    v_permlane32_swap_b32 v94, v95
    v_permlane32_swap_b32 v102, v103
    v_add_f32 v78, v78, v79
    v_add_f32 v86, v86, v87
    v_add_f32 v94, v94, v95
    v_add_f32 v102, v102, v103
    v_rcp_f32 v78, v78
    v_rcp_f32 v86, v86
    v_rcp_f32 v94, v94
    v_rcp_f32 v102, v102
    v_mul_f32 v76, v76, v78
    v_mul_f32 v77, v77, v78
    v_mul_f32 v84, v84, v86
    v_mul_f32 v85, v85, v86
    v_mul_f32 v92, v92, v94
    v_mul_f32 v93, v93, v94
    v_mul_f32 v100, v100, v102
    v_mul_f32 v101, v101, v102
    v_cvt_pk_bf16_f32 v78, v76, v77
    v_cvt_pk_bf16_f32 v86, v84, v85
    v_cvt_pk_bf16_f32 v94, v92, v93
    v_cvt_pk_bf16_f32 v102, v100, v101
    v_perm_b32 v80, v78, v78, v140
    v_perm_b32 v81, v78, v78, v141
    v_perm_b32 v82, v78, v78, v142
    v_perm_b32 v83, v78, v78, v143
    v_perm_b32 v88, v86, v86, v140
    v_perm_b32 v89, v86, v86, v141
    v_perm_b32 v90, v86, v86, v142
    v_perm_b32 v91, v86, v86, v143
    v_perm_b32 v96, v94, v94, v140
    v_perm_b32 v97, v94, v94, v141
    v_perm_b32 v98, v94, v94, v142
    v_perm_b32 v99, v94, v94, v143
    v_perm_b32 v104, v102, v102, v140
    v_perm_b32 v105, v102, v102, v141
    v_perm_b32 v106, v102, v102, v142
    v_perm_b32 v107, v102, v102, v143
    v_mfma_f32_16x16x32_bf16 v[28:31], v[156:159], v[80:83], 0
    v_mfma_f32_16x16x32_bf16 v[40:43], v[158:161], v[88:91], 0
    v_mfma_f32_16x16x32_bf16 v[52:55], v[160:163], v[96:99], 0
    v_mfma_f32_16x16x32_bf16 v[64:67], v[162:165], v[104:107], 0
    s_waitcnt vmcnt(0)
    v_readfirstlane_b32 s33, v138
    s_nop 2
    v_cvt_pk_bf16_f32 v76, v28, v29
    v_cvt_pk_bf16_f32 v77, v30, v31
    v_cvt_pk_bf16_f32 v78, v40, v41
    v_cvt_pk_bf16_f32 v79, v42, v43
    v_cvt_pk_bf16_f32 v84, v52, v53
    v_cvt_pk_bf16_f32 v85, v54, v55
    v_cvt_pk_bf16_f32 v86, v64, v65
    v_cvt_pk_bf16_f32 v87, v66, v67
    v_permlane16_swap_b32 v76, v78
    v_permlane16_swap_b32 v77, v79
    v_permlane16_swap_b32 v84, v86
    v_permlane16_swap_b32 v85, v87
    s_lshr_b32 s33, s33, s54
    s_and_b32 s33, s33, 15
    s_cmp_eq_u32 s33, 8
    s_cselect_b32 s79, 1, 0
    s_cbranch_scc1 c_olocal
    buffer_store_dwordx4 v[76:79], v144, s[12:15], s34 offen offset:0 sc1
    buffer_store_dwordx4 v[84:87], v144, s[12:15], s34 offen offset:1024 sc1
    s_branch c_odone
c_olocal:
    buffer_store_dwordx4 v[76:79], v144, s[12:15], s34 offen offset:0
    buffer_store_dwordx4 v[84:87], v144, s[12:15], s34 offen offset:1024
c_odone:
    s_barrier
    s_and_b32 s36, s25, 3
    s_lshr_b32 s37, s25, 2
    s_lshl_b32 s37, s37, 5
    s_add_u32 s37, s37, s24
    v_lshrrev_b32 v8, 3, v12
    v_lshlrev_b32 v8, 10, v8
    v_and_b32 v9, 7, v12
    v_lshl_add_u32 v8, v9, 7, v8
    v_lshrrev_b32 v9, 1, v12
    v_xor_b32 v9, v9, v13
    v_lshl_add_u32 v8, v9, 4, v8
    v_add_u32 v8, 73728, v8
    v_xor_b32 v9, 64, v8
    v_lshrrev_b32 v10, 5, v1
    v_lshlrev_b32 v10, 12, v10
    v_bfe_u32 v14, v1, 2, 3
    v_lshl_add_u32 v10, v14, 7, v10
    v_bfe_u32 v14, v1, 3, 2
    s_and_b32 s34, s27, 1
    s_lshl_b32 s34, s34, 1
    v_xor_b32 v14, s34, v14
    v_lshl_add_u32 v10, v14, 5, v10
    v_and_b32 v14, 3, v1
    v_lshl_add_u32 v10, v14, 3, v10
    s_lshr_b32 s34, s27, 1
    s_lshl_b32 s34, s34, 10
    v_add_u32 v10, s34, v10
    v_xor_b32 v11, 32, v10
    v_add_u32 v6, 0x10000, v10
    v_add_u32 v7, 0x10000, v11
    v_add_u32 v116, 0x20000, v10
    v_add_u32 v117, 0x20000, v11
    v_lshrrev_b32 v14, 2, v1
    v_lshlrev_b32 v72, 8, v14
    v_and_b32 v14, 7, v14
    s_lshl_b32 s34, s27, 1
    v_xor_b32 v14, s34, v14
    v_lshl_add_u32 v72, v14, 5, v72
    v_and_b32 v14, 3, v1
    v_lshl_add_u32 v72, v14, 3, v72
    v_xor_b32 v73, 32, v72
    s_lshl_b32 s34, s27, 5
    v_add_u32 v74, s34, v12
    v_mul_u32_u24 v74, 96, v74
    v_lshl_add_u32 v74, v13, 3, v74
    v_lshrrev_b32 v75, 2, v0
    v_and_b32 v14, 3, v0
    v_mul_u32_u24 v76, 96, v75
    v_lshl_add_u32 v76, v14, 4, v76
    v_lshrrev_b32 v75, 3, v0
    v_lshlrev_b32 v75, 13, v75
    v_and_b32 v14, 7, v0
    v_lshl_add_u32 v75, v14, 4, v75
    v_add_u32 v77, 0x40000, v75
    v_bfe_u32 v14, v1, 2, 2
    v_lshl_add_u32 v14, v13, 3, v14
    v_mul_u32_u24 v78, 96, v14
    v_and_b32 v14, 3, v1
    v_lshl_add_u32 v78, v14, 3, v78
    s_lshl_b32 s34, s27, 5
    v_add_u32 v78, s34, v78
    s_lshl_b32 s34, s27, 11
    v_lshlrev_b32 v79, 6, v12
    v_lshl_add_u32 v79, v13, 3, v79
    v_add_u32 v79, s34, v79
    v_add_u32 v72, 106496, v72
    v_add_u32 v73, 106496, v73
    v_add_u32 v74, 106496, v74
    v_add_u32 v76, 106496, v76
    v_add_u32 v78, 106496, v78
    v_add_u32 v79, 106496, v79
    v_and_b32 v14, 2, v12
    v_cmp_eq_u32 s[50:51], 2, v14
    v_mov_b32 v80, 0x3f803f80
    v_mov_b32 v81, 0x3f803f80
    v_mov_b32 v82, 0x3f803f80
    v_mov_b32 v83, 0x3f803f80
    s_lshl_b32 s38, s36, 19
    s_lshl_b32 s34, s37, 2
    s_add_u32 s38, s38, s34
    s_lshl_b32 s34, s53, 21
    s_add_u32 s38, s38, s34
    s_add_u32 s38, s38, 4194304
    s_lshl_b32 s39, s37, 5
    s_lshl_b32 s34, s27, 7
    s_add_u32 s39, s39, s34
    s_lshl_b32 s34, s53, 16
    s_add_u32 s39, s39, s34
    s_add_u32 s39, s39, 11534336
    s_lshl_b32 s37, s36, 8
    s_add_u32 s37, s37, s39
    s_add_u32 s36, s38, 8388608
    s_lshl_b32 s34, s27, 6
    s_add_u32 s34, s34, 127040
    v_lshl_add_u32 v137, v12, 2, s34
    v_and_b32 v139, 3, v1
    v_lshlrev_b32 v139, 5, v139
    v_add_u32 v139, 127040, v139
    v_lshlrev_b32 v4, 3, v12
    v_lshlrev_b32 v118, 3, v1
    v_lshrrev_b32 v151, 2, v0
    v_and_b32 v152, 1, v0
    v_lshl_add_u32 v151, v151, 1, v152
    v_bfe_u32 v152, v0, 1, 1
    v_lshrrev_b32 v150, 3, v151
    v_lshlrev_b32 v150, 7, v150
    v_lshl_add_u32 v150, v152, 6, v150
    v_and_b32 v153, 7, v151
    v_lshl_add_u32 v150, v153, 3, v150
    s_lshl_b32 s28, s77, 13
    s_lshl_b32 s29, s53, 21
    s_add_u32 s30, s28, s29
    s_add_u32 s28, s30, 12582912
    s_add_u32 s29, s28, 4096
    s_add_u32 s30, s30, 4194304
    s_add_u32 s31, s30, 4096
    s_barrier
    ds_read_b128 v[40:43], v8 offset:0
    ds_read_b128 v[44:47], v8 offset:2048
    ds_read_b64_tr_b16 v[48:49], v6 offset:40960
    ds_read_b64_tr_b16 v[50:51], v6 offset:43008
    ds_read_b64_tr_b16 v[52:53], v7 offset:40960
    ds_read_b64_tr_b16 v[54:55], v7 offset:43008
    ds_read_b128 v[56:59], v9 offset:0
    ds_read_b128 v[60:63], v9 offset:2048
    ds_read_b64_tr_b16 v[64:65], v6 offset:49152
    ds_read_b64_tr_b16 v[66:67], v6 offset:51200
    ds_read_b64_tr_b16 v[68:69], v7 offset:49152
    ds_read_b64_tr_b16 v[70:71], v7 offset:51200
    s_lshl_b32 s34, s53, 2
    s_mov_b64 exec, 0xffffffff
    buffer_load_dword v119, v118, s[8:11], s34 offen sc1
    s_mov_b64 exec, -1
    s_waitcnt lgkmcnt(6)
    v_mfma_f32_16x16x32_bf16 v[24:27], v[40:43], v[48:51], 0
    ds_read_b128 v[84:87], v8 offset:4096
    ds_read_b128 v[88:91], v8 offset:6144
    v_mfma_f32_16x16x32_bf16 v[28:31], v[40:43], v[52:55], 0
    ds_read_b64_tr_b16 v[92:93], v6 offset:57344
    ds_read_b64_tr_b16 v[94:95], v6 offset:59392
    v_mfma_f32_16x16x32_bf16 v[32:35], v[44:47], v[48:51], 0
    ds_read_b64_tr_b16 v[96:97], v7 offset:57344
    ds_read_b64_tr_b16 v[98:99], v7 offset:59392
    v_mfma_f32_16x16x32_bf16 v[36:39], v[44:47], v[52:55], 0
    s_waitcnt lgkmcnt(6)
    v_mfma_f32_16x16x32_bf16 v[24:27], v[56:59], v[64:67], v[24:27]
    ds_read_b128 v[100:103], v9 offset:4096
    ds_read_b128 v[104:107], v9 offset:6144
    v_mfma_f32_16x16x32_bf16 v[28:31], v[56:59], v[68:71], v[28:31]
    ds_read_b64_tr_b16 v[108:109], v116 offset:0
    ds_read_b64_tr_b16 v[110:111], v116 offset:2048
    v_mfma_f32_16x16x32_bf16 v[32:35], v[60:63], v[64:67], v[32:35]
    ds_read_b64_tr_b16 v[112:113], v117 offset:0
    ds_read_b64_tr_b16 v[114:115], v117 offset:2048
    v_mfma_f32_16x16x32_bf16 v[36:39], v[60:63], v[68:71], v[36:39]
    s_waitcnt lgkmcnt(6)
    v_mfma_f32_16x16x32_bf16 v[24:27], v[84:87], v[92:95], v[24:27]
    ds_read_b128 v[40:43], v8 offset:8192
    ds_read_b128 v[44:47], v8 offset:10240
    v_mfma_f32_16x16x32_bf16 v[28:31], v[84:87], v[96:99], v[28:31]
    ds_read_b64_tr_b16 v[48:49], v116 offset:8192
    ds_read_b64_tr_b16 v[50:51], v116 offset:10240
    v_mfma_f32_16x16x32_bf16 v[32:35], v[88:91], v[92:95], v[32:35]
    ds_read_b64_tr_b16 v[52:53], v117 offset:8192
    ds_read_b64_tr_b16 v[54:55], v117 offset:10240
    v_mfma_f32_16x16x32_bf16 v[36:39], v[88:91], v[96:99], v[36:39]
    s_waitcnt lgkmcnt(6)
    v_mfma_f32_16x16x32_bf16 v[24:27], v[100:103], v[108:111], v[24:27]
    ds_read_b128 v[56:59], v9 offset:8192
    ds_read_b128 v[60:63], v9 offset:10240
    v_mfma_f32_16x16x32_bf16 v[28:31], v[100:103], v[112:115], v[28:31]
    ds_read_b64_tr_b16 v[64:65], v116 offset:16384
    ds_read_b64_tr_b16 v[66:67], v116 offset:18432
    v_mfma_f32_16x16x32_bf16 v[32:35], v[104:107], v[108:111], v[32:35]
    ds_read_b64_tr_b16 v[68:69], v117 offset:16384
    ds_read_b64_tr_b16 v[70:71], v117 offset:18432
    v_mfma_f32_16x16x32_bf16 v[36:39], v[104:107], v[112:115], v[36:39]
    s_waitcnt lgkmcnt(6)
    v_mfma_f32_16x16x32_bf16 v[24:27], v[40:43], v[48:51], v[24:27]
    ds_read_b128 v[84:87], v8 offset:12288
    ds_read_b128 v[88:91], v8 offset:14336
    v_mfma_f32_16x16x32_bf16 v[28:31], v[40:43], v[52:55], v[28:31]
    ds_read_b64_tr_b16 v[92:93], v116 offset:24576
    ds_read_b64_tr_b16 v[94:95], v116 offset:26624
    v_mfma_f32_16x16x32_bf16 v[32:35], v[44:47], v[48:51], v[32:35]
    ds_read_b64_tr_b16 v[96:97], v117 offset:24576
    ds_read_b64_tr_b16 v[98:99], v117 offset:26624
    v_mfma_f32_16x16x32_bf16 v[36:39], v[44:47], v[52:55], v[36:39]
    s_barrier
    s_waitcnt lgkmcnt(6)
    v_mfma_f32_16x16x32_bf16 v[24:27], v[56:59], v[64:67], v[24:27]
    ds_read_b128 v[100:103], v9 offset:12288
    ds_read_b128 v[104:107], v9 offset:14336
    v_mfma_f32_16x16x32_bf16 v[28:31], v[56:59], v[68:71], v[28:31]
    ds_read_b64_tr_b16 v[108:109], v10 offset:0
    ds_read_b64_tr_b16 v[110:111], v10 offset:2048
    v_mfma_f32_16x16x32_bf16 v[32:35], v[60:63], v[64:67], v[32:35]
    ds_read_b64_tr_b16 v[112:113], v11 offset:0
    ds_read_b64_tr_b16 v[114:115], v11 offset:2048
    v_mfma_f32_16x16x32_bf16 v[36:39], v[60:63], v[68:71], v[36:39]
    s_waitcnt lgkmcnt(6)
    v_mfma_f32_16x16x32_bf16 v[24:27], v[84:87], v[92:95], v[24:27]
    ds_read_b128 v[40:43], v8 offset:16384
    ds_read_b128 v[44:47], v8 offset:18432
    v_mfma_f32_16x16x32_bf16 v[28:31], v[84:87], v[96:99], v[28:31]
    ds_read_b64_tr_b16 v[48:49], v10 offset:8192
    ds_read_b64_tr_b16 v[50:51], v10 offset:10240
    v_mfma_f32_16x16x32_bf16 v[32:35], v[88:91], v[92:95], v[32:35]
    ds_read_b64_tr_b16 v[52:53], v11 offset:8192
    ds_read_b64_tr_b16 v[54:55], v11 offset:10240
    v_mfma_f32_16x16x32_bf16 v[36:39], v[88:91], v[96:99], v[36:39]
    s_waitcnt lgkmcnt(6)
    v_mfma_f32_16x16x32_bf16 v[24:27], v[100:103], v[108:111], v[24:27]
    ds_read_b128 v[56:59], v9 offset:16384
    ds_read_b128 v[60:63], v9 offset:18432
    v_mfma_f32_16x16x32_bf16 v[28:31], v[100:103], v[112:115], v[28:31]
    ds_read_b64_tr_b16 v[64:65], v10 offset:16384
    ds_read_b64_tr_b16 v[66:67], v10 offset:18432
    v_mfma_f32_16x16x32_bf16 v[32:35], v[104:107], v[108:111], v[32:35]
    ds_read_b64_tr_b16 v[68:69], v11 offset:16384
    ds_read_b64_tr_b16 v[70:71], v11 offset:18432
    v_mfma_f32_16x16x32_bf16 v[36:39], v[104:107], v[112:115], v[36:39]
    s_waitcnt lgkmcnt(6)
    v_mfma_f32_16x16x32_bf16 v[24:27], v[40:43], v[48:51], v[24:27]
    ds_read_b128 v[84:87], v8 offset:20480
    ds_read_b128 v[88:91], v8 offset:22528
    v_mfma_f32_16x16x32_bf16 v[28:31], v[40:43], v[52:55], v[28:31]
    ds_read_b64_tr_b16 v[92:93], v10 offset:24576
    ds_read_b64_tr_b16 v[94:95], v10 offset:26624
    v_mfma_f32_16x16x32_bf16 v[32:35], v[44:47], v[48:51], v[32:35]
    ds_read_b64_tr_b16 v[96:97], v11 offset:24576
    ds_read_b64_tr_b16 v[98:99], v11 offset:26624
    v_mfma_f32_16x16x32_bf16 v[36:39], v[44:47], v[52:55], v[36:39]
    s_waitcnt lgkmcnt(6)
    v_mfma_f32_16x16x32_bf16 v[24:27], v[56:59], v[64:67], v[24:27]
    ds_read_b128 v[100:103], v9 offset:20480
    ds_read_b128 v[104:107], v9 offset:22528
    v_mfma_f32_16x16x32_bf16 v[28:31], v[56:59], v[68:71], v[28:31]
    ds_read_b64_tr_b16 v[108:109], v10 offset:32768
    ds_read_b64_tr_b16 v[110:111], v10 offset:34816
    v_mfma_f32_16x16x32_bf16 v[32:35], v[60:63], v[64:67], v[32:35]
    ds_read_b64_tr_b16 v[112:113], v11 offset:32768
    ds_read_b64_tr_b16 v[114:115], v11 offset:34816
    v_mfma_f32_16x16x32_bf16 v[36:39], v[60:63], v[68:71], v[36:39]
    s_waitcnt lgkmcnt(6)
    v_mfma_f32_16x16x32_bf16 v[24:27], v[84:87], v[92:95], v[24:27]
    ds_read_b128 v[40:43], v8 offset:24576
    ds_read_b128 v[44:47], v8 offset:26624
    v_mfma_f32_16x16x32_bf16 v[28:31], v[84:87], v[96:99], v[28:31]
    ds_read_b64_tr_b16 v[48:49], v10 offset:40960
    ds_read_b64_tr_b16 v[50:51], v10 offset:43008
    v_mfma_f32_16x16x32_bf16 v[32:35], v[88:91], v[92:95], v[32:35]
    ds_read_b64_tr_b16 v[52:53], v11 offset:40960
    ds_read_b64_tr_b16 v[54:55], v11 offset:43008
    v_mfma_f32_16x16x32_bf16 v[36:39], v[88:91], v[96:99], v[36:39]
    s_waitcnt lgkmcnt(6)
    v_mfma_f32_16x16x32_bf16 v[24:27], v[100:103], v[108:111], v[24:27]
    ds_read_b128 v[56:59], v9 offset:24576
    ds_read_b128 v[60:63], v9 offset:26624
    v_mfma_f32_16x16x32_bf16 v[28:31], v[100:103], v[112:115], v[28:31]
    ds_read_b64_tr_b16 v[64:65], v10 offset:49152
    ds_read_b64_tr_b16 v[66:67], v10 offset:51200
    v_mfma_f32_16x16x32_bf16 v[32:35], v[104:107], v[108:111], v[32:35]
    ds_read_b64_tr_b16 v[68:69], v11 offset:49152
    ds_read_b64_tr_b16 v[70:71], v11 offset:51200
    v_mfma_f32_16x16x32_bf16 v[36:39], v[104:107], v[112:115], v[36:39]
    s_waitcnt lgkmcnt(6)
    v_mfma_f32_16x16x32_bf16 v[24:27], v[40:43], v[48:51], v[24:27]
    ds_read_b128 v[84:87], v8 offset:28672
    ds_read_b128 v[88:91], v8 offset:30720
    v_mfma_f32_16x16x32_bf16 v[28:31], v[40:43], v[52:55], v[28:31]
    ds_read_b64_tr_b16 v[92:93], v10 offset:57344
    ds_read_b64_tr_b16 v[94:95], v10 offset:59392
    v_mfma_f32_16x16x32_bf16 v[32:35], v[44:47], v[48:51], v[32:35]
    ds_read_b64_tr_b16 v[96:97], v11 offset:57344
    ds_read_b64_tr_b16 v[98:99], v11 offset:59392
    v_mfma_f32_16x16x32_bf16 v[36:39], v[44:47], v[52:55], v[36:39]
    s_waitcnt vmcnt(0)
    v_lshrrev_b32 v153, 4, v119
    v_and_b32 v153, 0x0f0f0f0f, v153
    v_and_b32 v154, 0x0f0f0f0f, v119
    v_add_u32 v154, v154, v153
    v_lshrrev_b32 v153, 16, v154
    v_add_u32 v154, v154, v153
    v_lshrrev_b32 v153, 8, v154
    v_add_u32 v154, v154, v153
    v_and_b32 v154, 0xff, v154
    v_cmp_ne_u32 s[58:59], 8, v154
    s_waitcnt lgkmcnt(6)
    v_mfma_f32_16x16x32_bf16 v[24:27], v[56:59], v[64:67], v[24:27]
    ds_read_b128 v[100:103], v9 offset:28672
    ds_read_b128 v[104:107], v9 offset:30720
    v_mfma_f32_16x16x32_bf16 v[28:31], v[56:59], v[68:71], v[28:31]
    ds_read_b64_tr_b16 v[108:109], v6 offset:0
    ds_read_b64_tr_b16 v[110:111], v6 offset:2048
    v_mfma_f32_16x16x32_bf16 v[32:35], v[60:63], v[64:67], v[32:35]
    ds_read_b64_tr_b16 v[112:113], v7 offset:0
    ds_read_b64_tr_b16 v[114:115], v7 offset:2048
    v_mfma_f32_16x16x32_bf16 v[36:39], v[60:63], v[68:71], v[36:39]
    s_waitcnt lgkmcnt(6)
    v_mfma_f32_16x16x32_bf16 v[24:27], v[84:87], v[92:95], v[24:27]
    v_mfma_f32_16x16x32_bf16 v[28:31], v[84:87], v[96:99], v[28:31]
    v_mfma_f32_16x16x32_bf16 v[32:35], v[88:91], v[92:95], v[32:35]
    v_mfma_f32_16x16x32_bf16 v[36:39], v[88:91], v[96:99], v[36:39]
    s_waitcnt lgkmcnt(0)
    v_mfma_f32_16x16x32_bf16 v[24:27], v[100:103], v[108:111], v[24:27]
    v_mfma_f32_16x16x32_bf16 v[28:31], v[100:103], v[112:115], v[28:31]
    v_mfma_f32_16x16x32_bf16 v[32:35], v[104:107], v[108:111], v[32:35]
    v_mfma_f32_16x16x32_bf16 v[36:39], v[104:107], v[112:115], v[36:39]
    s_nop 4
    v_cvt_pk_bf16_f32 v48, v24, v25
    v_cvt_pk_bf16_f32 v49, v26, v27
    v_cvt_pk_bf16_f32 v50, v28, v29
    v_cvt_pk_bf16_f32 v51, v30, v31
    v_cvt_pk_bf16_f32 v52, v32, v33
    v_cvt_pk_bf16_f32 v53, v34, v35
    v_cvt_pk_bf16_f32 v54, v36, v37
    v_cvt_pk_bf16_f32 v55, v38, v39
    s_barrier
    s_cmp_eq_u32 s52, 2
    s_cbranch_scc1 c_resxt
    ds_read_b64_tr_b16 v[120:121], v72 offset:0
    ds_read_b64_tr_b16 v[122:123], v73 offset:0
    ds_read_b64_tr_b16 v[124:125], v72 offset:4096
    ds_read_b64_tr_b16 v[126:127], v73 offset:4096
    s_branch c_havres
c_resxt:
    ds_read_b64 v[120:121], v79 offset:0
    ds_read_b64 v[122:123], v79 offset:1024
    ds_read_b64 v[124:125], v79 offset:32
    ds_read_b64 v[126:127], v79 offset:1056
c_havres:
    v_lshlrev_b32 v24, 16, v48
    v_and_b32 v25, s35, v48
    v_lshlrev_b32 v26, 16, v49
    v_and_b32 v27, s35, v49
    v_lshlrev_b32 v28, 16, v50
    v_and_b32 v29, s35, v50
    v_lshlrev_b32 v30, 16, v51
    v_and_b32 v31, s35, v51
    v_lshlrev_b32 v32, 16, v52
    v_and_b32 v33, s35, v52
    v_lshlrev_b32 v34, 16, v53
    v_and_b32 v35, s35, v53
    v_lshlrev_b32 v36, 16, v54
    v_and_b32 v37, s35, v54
    v_lshlrev_b32 v38, 16, v55
    v_and_b32 v39, s35, v55
    s_waitcnt lgkmcnt(0)
    v_lshlrev_b32 v56, 16, v120
    v_and_b32 v57, s35, v120
    v_lshlrev_b32 v58, 16, v121
    v_and_b32 v59, s35, v121
    v_lshlrev_b32 v60, 16, v122
    v_and_b32 v61, s35, v122
    v_lshlrev_b32 v62, 16, v123
    v_and_b32 v63, s35, v123
    v_lshlrev_b32 v64, 16, v124
    v_and_b32 v65, s35, v124
    v_lshlrev_b32 v66, 16, v125
    v_and_b32 v67, s35, v125
    v_lshlrev_b32 v68, 16, v126
    v_and_b32 v69, s35, v126
    v_lshlrev_b32 v70, 16, v127
    v_and_b32 v71, s35, v127
    v_pk_add_f32 v[24:25], v[24:25], v[56:57]
    v_pk_add_f32 v[26:27], v[26:27], v[58:59]
    v_pk_add_f32 v[28:29], v[28:29], v[60:61]
    v_pk_add_f32 v[30:31], v[30:31], v[62:63]
    v_pk_add_f32 v[32:33], v[32:33], v[64:65]
    v_pk_add_f32 v[34:35], v[34:35], v[66:67]
    v_pk_add_f32 v[36:37], v[36:37], v[68:69]
    v_pk_add_f32 v[38:39], v[38:39], v[70:71]
    v_cvt_pk_bf16_f32 v48, v24, v25
    v_cvt_pk_bf16_f32 v49, v26, v27
    ds_write_b64 v74, v[48:49] offset:8192
    v_cvt_pk_bf16_f32 v50, v28, v29
    v_cvt_pk_bf16_f32 v51, v30, v31
    ds_write_b64 v74, v[50:51] offset:9728
    v_cvt_pk_bf16_f32 v52, v32, v33
    v_cvt_pk_bf16_f32 v53, v34, v35
    ds_write_b64 v74, v[52:53] offset:8224
    v_cvt_pk_bf16_f32 v54, v36, v37
    v_cvt_pk_bf16_f32 v55, v38, v39
    ds_write_b64 v74, v[54:55] offset:9760
    v_mov_b32 v2, 126988
    v_mov_b32 v69, 1
    s_waitcnt lgkmcnt(0)
    s_mov_b64 exec, 1
    ds_add_u32 v2, v69
    s_mov_b64 exec, -1
    s_mov_b32 s34, 0
c_sy:
    ds_read_b32 v3, v2
    s_add_u32 s34, s34, 1
    s_waitcnt lgkmcnt(0)
    v_readfirstlane_b32 s33, v3
    s_cmp_gt_u32 s34, 32768
    s_cbranch_scc1 c_syd
    s_cmp_lt_u32 s33, 4
    s_cbranch_scc1 c_sy
c_syd:
    s_cmp_lt_u32 s27, 2
    s_cbranch_scc0 c_nostats
    ds_read_b64_tr_b16 v[40:41], v78 offset:8192
    ds_read_b64_tr_b16 v[42:43], v78 offset:8576
    ds_read_b64_tr_b16 v[44:45], v78 offset:11264
    ds_read_b64_tr_b16 v[46:47], v78 offset:11648
    ds_read_b64_tr_b16 v[48:49], v78 offset:14336
    ds_read_b64_tr_b16 v[50:51], v78 offset:14720
    ds_read_b64_tr_b16 v[52:53], v78 offset:17408
    ds_read_b64_tr_b16 v[54:55], v78 offset:17792
    ds_read_b128 v[24:27], v76 offset:8192
    ds_read_b128 v[28:31], v76 offset:14336
    s_mov_b32 s40, 0x00f0000f
    s_mov_b32 s41, 0xf0000f00
    s_waitcnt lgkmcnt(8)
    v_mfma_f32_16x16x32_bf16 v[56:59], v[40:43], v[80:83], 0
    v_mfma_f32_16x16x32_bf16 v[60:63], v[40:43], v[40:43], 0
    s_waitcnt lgkmcnt(6)
    v_mfma_f32_16x16x32_bf16 v[56:59], v[44:47], v[80:83], v[56:59]
    v_mfma_f32_16x16x32_bf16 v[60:63], v[44:47], v[44:47], v[60:63]
    s_waitcnt lgkmcnt(4)
    v_mfma_f32_16x16x32_bf16 v[56:59], v[48:51], v[80:83], v[56:59]
    v_mfma_f32_16x16x32_bf16 v[60:63], v[48:51], v[48:51], v[60:63]
    s_waitcnt lgkmcnt(2)
    v_mfma_f32_16x16x32_bf16 v[56:59], v[52:55], v[80:83], v[56:59]
    v_mfma_f32_16x16x32_bf16 v[60:63], v[52:55], v[52:55], v[60:63]
    s_nop 6
    v_cndmask_b32 v64, v56, v57, s[42:43]
    v_cndmask_b32 v65, v58, v59, s[42:43]
    v_cndmask_b32 v66, v60, v61, s[42:43]
    v_cndmask_b32 v67, v62, v63, s[42:43]
    v_cndmask_b32 v64, v64, v65, s[50:51]
    v_cndmask_b32 v65, v66, v67, s[50:51]
    s_mov_b64 exec, s[40:41]
    s_cmp_eq_u32 s79, 1
    s_cbranch_scc1 c_slocal
    buffer_store_dwordx2 v[64:65], v4, s[12:15], s37 offen sc1
    s_branch c_sdone
c_slocal:
    buffer_store_dwordx2 v[64:65], v4, s[12:15], s37 offen
c_sdone:
    s_mov_b32 s34, 0
    buffer_load_dwordx2 v[40:41], v4, s[12:15], s39 offen offset:0 sc1
    buffer_load_dwordx2 v[42:43], v4, s[12:15], s39 offen offset:256 sc1
    buffer_load_dwordx2 v[44:45], v4, s[12:15], s39 offen offset:512 sc1
    buffer_load_dwordx2 v[46:47], v4, s[12:15], s39 offen offset:768 sc1
    s_mov_b64 exec, -1
    s_waitcnt lgkmcnt(0)
    v_lshlrev_b32 v84, 16, v24
    v_and_b32 v85, s35, v24
    v_lshlrev_b32 v86, 16, v25
    v_and_b32 v87, s35, v25
    v_lshlrev_b32 v88, 16, v26
    v_and_b32 v89, s35, v26
    v_lshlrev_b32 v90, 16, v27
    v_and_b32 v91, s35, v27
    v_lshlrev_b32 v92, 16, v28
    v_and_b32 v93, s35, v28
    v_lshlrev_b32 v94, 16, v29
    v_and_b32 v95, s35, v29
    v_lshlrev_b32 v96, 16, v30
    v_and_b32 v97, s35, v30
    v_lshlrev_b32 v98, 16, v31
    v_and_b32 v99, s35, v31
    s_mov_b64 exec, s[40:41]
c_sp:
    s_waitcnt vmcnt(0)
    v_pk_add_f32 v[40:41], v[40:41], v[42:43]
    v_pk_add_f32 v[44:45], v[44:45], v[46:47]
    v_pk_add_f32 v[40:41], v[40:41], v[44:45]
    s_add_u32 s34, s34, 1
    v_cmp_u_f32 vcc, v40, v41
    s_cmp_gt_u32 s34, 32768
    s_cbranch_scc1 c_spd
    s_nop 2
    s_cbranch_vccz c_spd
    buffer_load_dwordx2 v[40:41], v4, s[12:15], s39 offen offset:0 sc1
    buffer_load_dwordx2 v[42:43], v4, s[12:15], s39 offen offset:256 sc1
    buffer_load_dwordx2 v[44:45], v4, s[12:15], s39 offen offset:512 sc1
    buffer_load_dwordx2 v[46:47], v4, s[12:15], s39 offen offset:768 sc1
    s_branch c_sp
c_spd:
    v_mul_f32 v40, 0x3b000000, v40
    v_mul_f32 v41, 0x3b000000, v41
    v_fma_f32 v41, -v40, v40, v41
    v_max_f32 v41, 0, v41
    v_cvt_pk_bf16_f32 v40, v40, v41
    v_and_b32 v41, s35, v40
    v_lshlrev_b32 v40, 16, v40
    v_add_f32 v41, 0x3727c5ac, v41
    v_cvt_pk_bf16_f32 v41, v41, v41
    v_lshlrev_b32 v41, 16, v41
    v_sqrt_f32 v41, v41
    s_nop 0
    v_cvt_pk_bf16_f32 v41, v41, v41
    v_lshlrev_b32 v41, 16, v41
    v_rcp_f32 v41, v41
    s_nop 0
    v_mul_f32 v40, v40, v41
    ds_write2_b32 v137, v40, v41 offset0:0 offset1:32
    s_mov_b64 exec, 1
    s_waitcnt lgkmcnt(0)
    ds_add_u32 v2, v69
    s_mov_b64 exec, -1
    s_branch c_norm
c_nostats:
    ds_read_b128 v[24:27], v76 offset:8192
    ds_read_b128 v[28:31], v76 offset:14336
    ds_read_b128 v[32:35], v76 offset:5120
    ds_read_b128 v[36:39], v76 offset:11264
    s_sub_u32 s34, s38, 0x20000
    s_waitcnt lgkmcnt(3)
    buffer_store_dwordx4 v[24:27], v75, s[12:15], s38 offen sc1
    s_waitcnt lgkmcnt(2)
    buffer_store_dwordx4 v[28:31], v77, s[12:15], s38 offen sc1
    s_waitcnt lgkmcnt(1)
    buffer_store_dwordx4 v[32:35], v75, s[12:15], s34 offen sc1
    s_waitcnt lgkmcnt(0)
    buffer_store_dwordx4 v[36:39], v77, s[12:15], s34 offen sc1
    v_lshlrev_b32 v84, 16, v24
    v_and_b32 v85, s35, v24
    v_lshlrev_b32 v86, 16, v25
    v_and_b32 v87, s35, v25
    v_lshlrev_b32 v88, 16, v26
    v_and_b32 v89, s35, v26
    v_lshlrev_b32 v90, 16, v27
    v_and_b32 v91, s35, v27
    v_lshlrev_b32 v92, 16, v28
    v_and_b32 v93, s35, v28
    v_lshlrev_b32 v94, 16, v29
    v_and_b32 v95, s35, v29
    v_lshlrev_b32 v96, 16, v30
    v_and_b32 v97, s35, v30
    v_lshlrev_b32 v98, 16, v31
    v_and_b32 v99, s35, v31
    s_mov_b64 exec, 1
    s_waitcnt vmcnt(0)
    ds_add_u32 v2, v69
    s_mov_b64 exec, -1
c_norm:
    s_nop 0
    s_cmp_eq_u32 s58, 0
    s_cbranch_scc1 c_arrd
    s_mov_b32 s34, 0
    s_lshl_b32 s33, s53, 2
    s_mov_b64 exec, 0xffffffff
c_arr:
    buffer_load_dword v119, v118, s[8:11], s33 offen sc1
    s_add_u32 s34, s34, 1
    s_waitcnt vmcnt(0)
    v_lshrrev_b32 v153, 4, v119
    v_and_b32 v153, 0x0f0f0f0f, v153
    v_and_b32 v154, 0x0f0f0f0f, v119
    v_add_u32 v154, v154, v153
    v_lshrrev_b32 v153, 16, v154
    v_add_u32 v154, v154, v153
    v_lshrrev_b32 v153, 8, v154
    v_add_u32 v154, v154, v153
    v_and_b32 v154, 0xff, v154
    v_cmp_ne_u32 vcc, 8, v154
    s_cmp_gt_u32 s34, 32768
    s_cbranch_scc1 c_arre
    s_nop 2
    s_cbranch_vccnz c_arr
c_arre:
    s_mov_b64 exec, -1
c_arrd:
    s_cmp_ge_u32 s24, 1536
    s_cselect_b32 s59, s52, 0
    s_cmp_eq_u32 s59, 2
    s_cbranch_scc0 c_noeu
    buffer_load_dwordx2 v[16:17], v150, s[12:15], s28 offen offset:0 sc1
    buffer_load_dwordx2 v[18:19], v150, s[12:15], s28 offen offset:2048 sc1
c_noeu:
    s_mov_b32 s34, 0
c_sz:
    ds_read_b32 v3, v2
    s_add_u32 s34, s34, 1
    s_waitcnt lgkmcnt(0)
    v_readfirstlane_b32 s33, v3
    s_cmp_gt_u32 s34, 32768
    s_cbranch_scc1 c_szd
    s_cmp_lt_u32 s33, 8
    s_cbranch_scc1 c_sz
c_szd:
    ds_read_b128 v[100:103], v139 offset:0
    ds_read_b128 v[104:107], v139 offset:16
    ds_read_b128 v[108:111], v139 offset:128
    ds_read_b128 v[112:115], v139 offset:144
    s_waitcnt lgkmcnt(1)
    v_pk_fma_f32 v[84:85], v[84:85], v[108:109], v[100:101] neg_lo:[0,0,1] neg_hi:[0,0,1]
    v_pk_fma_f32 v[86:87], v[86:87], v[110:111], v[102:103] neg_lo:[0,0,1] neg_hi:[0,0,1]
    v_pk_fma_f32 v[92:93], v[92:93], v[108:109], v[100:101] neg_lo:[0,0,1] neg_hi:[0,0,1]
    v_pk_fma_f32 v[94:95], v[94:95], v[110:111], v[102:103] neg_lo:[0,0,1] neg_hi:[0,0,1]
    s_waitcnt lgkmcnt(0)
    v_pk_fma_f32 v[88:89], v[88:89], v[112:113], v[104:105] neg_lo:[0,0,1] neg_hi:[0,0,1]
    v_pk_fma_f32 v[90:91], v[90:91], v[114:115], v[106:107] neg_lo:[0,0,1] neg_hi:[0,0,1]
    v_pk_fma_f32 v[96:97], v[96:97], v[112:113], v[104:105] neg_lo:[0,0,1] neg_hi:[0,0,1]
    v_pk_fma_f32 v[98:99], v[98:99], v[114:115], v[106:107] neg_lo:[0,0,1] neg_hi:[0,0,1]
    v_cvt_pk_bf16_f32 v40, v84, v85
    v_cvt_pk_bf16_f32 v41, v86, v87
    v_cvt_pk_bf16_f32 v42, v88, v89
    v_cvt_pk_bf16_f32 v43, v90, v91
    buffer_store_dwordx4 v[40:43], v75, s[12:15], s36 offen sc1
    v_cvt_pk_bf16_f32 v44, v92, v93
    v_cvt_pk_bf16_f32 v45, v94, v95
    v_cvt_pk_bf16_f32 v46, v96, v97
    v_cvt_pk_bf16_f32 v47, v98, v99
    buffer_store_dwordx4 v[44:47], v77, s[12:15], s36 offen sc1
    s_setprio 2
    s_cmp_eq_u32 s52, 2
    s_cbranch_scc1 c_nopre
    v_lshrrev_b32 v6, 5, v1
    v_mul_u32_u24 v6, 6144, v6
    v_bfe_u32 v8, v1, 2, 3
    v_lshl_add_u32 v6, v8, 7, v6
    v_bfe_u32 v8, v1, 3, 2
    v_xor_b32 v8, s27, v8
    v_lshl_add_u32 v6, v8, 5, v6
    v_and_b32 v8, 3, v1
    v_lshl_add_u32 v6, v8, 3, v6
    v_add_u32 v6, 10240, v6
    v_add_u32 v7, 69632, v6
    v_and_b32 v2, 1, v12
    v_lshl_add_u32 v3, v13, 2, v2
    v_cmp_eq_u32 s[42:43], 1, v2
    v_cmp_le_u32 s[44:45], v3, v12
    v_add_u32 v3, 2, v3
    v_cmp_le_u32 s[46:47], v3, v12
    s_cmp_eq_u32 s24, 0
    s_cselect_b64 s[48:49], -1, 0
    v_mov_b32 v156, v128
    v_mov_b32 v157, v129
    v_mov_b32 v158, v130
    v_mov_b32 v159, v131
    v_mov_b32 v160, v132
    v_mov_b32 v161, v133
    v_mov_b32 v162, v134
    v_mov_b32 v163, v135
    v_mov_b32 v164, v136
    v_lshrrev_b32 v2, 5, v1
    v_lshlrev_b32 v2, 4, v2
    v_bfe_u32 v3, v1, 2, 3
    v_add_u32 v2, v2, v3
    v_and_b32 v3, 3, v1
    v_lshlrev_b32 v3, 3, v3
    v_lshl_add_u32 v147, v2, 5, v3
    v_add_u32 v147, 0x2000, v147
    v_add_u32 v166, 69632, v147
    v_lshl_add_u32 v8, v2, 7, v3
    v_bfe_u32 v3, v1, 3, 2
    v_lshl_add_u32 v8, v3, 5, v8
    v_xor_b32 v9, 32, v8
    v_xor_b32 v10, 64, v8
    v_xor_b32 v11, 96, v8
    v_add_u32 v14, 69632, v8
    v_add_u32 v15, 69632, v9
    v_add_u32 v148, 69632, v10
    v_add_u32 v149, 69632, v11
c_nopre:
    s_cmp_eq_u32 s59, 2
    s_cbranch_scc1 c_noeu2
    s_waitcnt vmcnt(0)
    buffer_load_dwordx2 v[16:17], v150, s[12:15], s28 offen offset:0 sc1
    buffer_load_dwordx2 v[18:19], v150, s[12:15], s28 offen offset:2048 sc1
c_noeu2:
    v_mov_b32 v2, v151
    v_mov_b32 v3, v152
    v_mul_u32_u24 v129, 5120, v3
    v_lshl_add_u32 v129, v2, 3, v129
    v_add_u32 v129, 150528, v129
    v_lshrrev_b32 v130, 6, v2
    v_mul_u32_u24 v130, 1280, v130
    v_and_b32 v131, 3, v2
    v_mul_u32_u24 v131, 320, v131
    v_add_u32 v130, v130, v131
    v_bfe_u32 v131, v2, 2, 4
    v_lshl_add_u32 v130, v131, 4, v130
    v_mul_u32_u24 v131, 20512, v3
    v_add_u32 v130, v130, v131
    v_add_u32 v130, 69632, v130
    v_cmp_eq_u32 s[36:37], 1, v3
    s_lshl_b32 s33, s76, 16
    s_and_b32 s34, s76, 0xffff0000
    v_mov_b32 v132, s33
    v_mov_b32 v131, s34
    v_cndmask_b32 v132, v132, v131, s[36:37]
    s_cmp_eq_u32 s52, 2
    s_cbranch_scc1 c_o2
    s_add_u32 s4, s66, 0x00800000
    s_addc_u32 s5, s67, 0
    s_mov_b32 s6, 0x00280000
    s_mov_b32 s7, 0x00020000
    v_lshrrev_b32 v131, 5, v0
    v_lshlrev_b32 v131, 14, v131
    v_lshl_add_u32 v131, v3, 5, v131
    v_bfe_u32 v4, v0, 2, 1
    v_lshl_add_u32 v131, v4, 4, v131
    v_and_b32 v4, 15, v2
    v_lshlrev_b32 v4, 3, v4
    v_lshl_add_u32 v4, v3, 7, v4
    v_lshrrev_b32 v2, 4, v2
    v_lshl_add_u32 v4, v2, 16, v4
    s_lshl_b32 s38, s77, 8
    s_lshl_b32 s40, s77, 6
    s_add_u32 s40, s40, 2097152
    s_mov_b32 s50, 0x55000000
    s_mov_b32 s51, 0x55000000
    s_mov_b32 s56, 0x55555555
    s_mov_b32 s57, 0x55555555
    s_branch c_o3
c_o2:
    s_mov_b32 s4, s74
    s_mov_b32 s5, s75
    s_mov_b32 s6, 0x00200000
    s_mov_b32 s7, 0x00020000
    v_lshlrev_b32 v4, 12, v2
    v_lshl_add_u32 v4, v3, 11, v4
    s_lshl_b32 s38, s77, 2
    v_mov_b32 v133, 0x05040100
    v_mov_b32 v134, 0x01000504
    v_cndmask_b32 v133, v133, v134, s[36:37]
    v_add_u32 v134, 0x02020202, v133
c_o3:
    s_mov_b32 s34, 0
    s_waitcnt vmcnt(2)
    s_cmp_eq_u32 s59, 2
    s_cbranch_scc1 c_noeu3
    s_waitcnt vmcnt(0)
c_noeu3:
c_u0:
    v_cmp_eq_u32 vcc, -1, v16
    s_add_u32 s34, s34, 1
    s_cmp_gt_u32 s34, 32768
    s_cbranch_scc1 c_u0_ok
    s_nop 1
    s_and_b64 exec, exec, vcc
    s_cbranch_scc0 c_u0_ok
    buffer_load_dwordx2 v[16:17], v150, s[12:15], s28 offen offset:0 sc1
    s_waitcnt vmcnt(0)
    s_branch c_u0
c_u0_ok:
    s_mov_b64 exec, -1
    ds_write_b64 v129, v[16:17] offset:0
    buffer_load_dwordx2 v[24:25], v150, s[12:15], s30 offen offset:0 sc1
    s_waitcnt lgkmcnt(0)
    s_barrier
c_u1:
    v_cmp_eq_u32 vcc, -1, v18
    s_add_u32 s34, s34, 1
    s_cmp_gt_u32 s34, 32768
    s_cbranch_scc1 c_u1_ok
    s_nop 1
    s_and_b64 exec, exec, vcc
    s_cbranch_scc0 c_u1_ok
    buffer_load_dwordx2 v[18:19], v150, s[12:15], s28 offen offset:2048 sc1
    s_waitcnt vmcnt(0)
    s_branch c_u1
c_u1_ok:
    s_mov_b64 exec, -1
    ds_write_b64 v129, v[18:19] offset:1024
    buffer_load_dwordx2 v[26:27], v150, s[12:15], s30 offen offset:2048 sc1
    buffer_load_dwordx2 v[20:21], v150, s[12:15], s29 offen offset:0 sc1
    s_waitcnt lgkmcnt(0)
    s_barrier
    ds_read_b128 v[32:35], v130 offset:0
    ds_read_b128 v[36:39], v130 offset:5120
    ds_read_b128 v[40:43], v130 offset:10240
    ds_read_b128 v[44:47], v130 offset:15360
    s_waitcnt vmcnt(0)
c_u2:
    v_cmp_eq_u32 vcc, -1, v20
    s_add_u32 s34, s34, 1
    s_cmp_gt_u32 s34, 32768
    s_cbranch_scc1 c_u2_ok
    s_nop 1
    s_and_b64 exec, exec, vcc
    s_cbranch_scc0 c_u2_ok
    buffer_load_dwordx2 v[20:21], v150, s[12:15], s29 offen offset:0 sc1
    s_waitcnt vmcnt(0)
    s_branch c_u2
c_u2_ok:
    s_mov_b64 exec, -1
    ds_write_b64 v129, v[20:21] offset:2048
    buffer_load_dwordx2 v[28:29], v150, s[12:15], s31 offen offset:0 sc1
    buffer_load_dwordx2 v[22:23], v150, s[12:15], s29 offen offset:2048 sc1
    v_lshlrev_b32 v48, 16, v24
    v_and_b32 v49, s35, v24
    v_lshlrev_b32 v52, 16, v16
    v_and_b32 v53, s35, v16
    v_lshlrev_b32 v50, 16, v25
    v_and_b32 v51, s35, v25
    v_lshlrev_b32 v54, 16, v17
    v_and_b32 v55, s35, v17
    v_fma_f32 v48, v52, v132, v48
    v_fma_f32 v49, v53, v132, v49
    v_fma_f32 v50, v54, v132, v50
    v_fma_f32 v51, v55, v132, v51
    s_waitcnt lgkmcnt(3)
    v_add_f32 v32, v32, v36
    v_add_f32 v33, v33, v37
    v_add_f32 v34, v34, v38
    v_add_f32 v35, v35, v39
    s_waitcnt lgkmcnt(1)
    v_add_f32 v40, v40, v44
    v_add_f32 v41, v41, v45
    v_add_f32 v42, v42, v46
    v_add_f32 v43, v43, v47
    v_add_f32 v48, v48, v32
    v_add_f32 v49, v49, v33
    v_add_f32 v50, v50, v34
    v_add_f32 v51, v51, v35
    v_add_f32 v48, v48, v40
    v_add_f32 v49, v49, v41
    v_add_f32 v50, v50, v42
    v_add_f32 v51, v51, v43
    v_cvt_pk_bf16_f32 v56, v48, v49
    v_cvt_pk_bf16_f32 v57, v50, v51
    s_cmp_eq_u32 s52, 2
    s_cbranch_scc1 c_st2_0
    v_mov_b32_dpp v58, v56 quad_perm:[1,1,3,3] row_mask:0xf bank_mask:0xf
    v_mov_b32_dpp v59, v57 quad_perm:[1,1,3,3] row_mask:0xf bank_mask:0xf
    s_add_u32 s33, s40, 0
    s_mov_b64 exec, s[50:51]
    buffer_store_dwordx4 v[56:59], v131, s[4:7], s33 offen sc1
    s_mov_b64 exec, s[56:57]
    s_add_u32 s33, s38, 0
    buffer_store_dwordx4 v[56:59], v4, s[4:7], s33 offen sc1
    s_mov_b64 exec, -1
    s_branch c_st3_0
c_st2_0:
    v_cndmask_b32 v58, v57, v56, s[36:37]
    v_cndmask_b32 v56, v56, v57, s[36:37]
    s_nop 0
    v_mov_b32_dpp v59, v58 quad_perm:[2,3,0,1] row_mask:0xf bank_mask:0xf
    s_add_u32 s33, s38, 0
    v_perm_b32 v57, v59, v56, v134
    v_perm_b32 v56, v59, v56, v133
    buffer_store_dword v56, v4, s[4:7], s33 offen offset:0
    buffer_store_dword v57, v4, s[4:7], s33 offen offset:1024
c_st3_0:
    s_nop 0
    s_waitcnt lgkmcnt(0)
    s_barrier
    ds_read_b128 v[32:35], v130 offset:2560
    ds_read_b128 v[36:39], v130 offset:7680
    ds_read_b128 v[40:43], v130 offset:12800
    ds_read_b128 v[44:47], v130 offset:17920
    s_waitcnt vmcnt(2)
c_u3:
    v_cmp_eq_u32 vcc, -1, v22
    s_add_u32 s34, s34, 1
    s_cmp_gt_u32 s34, 32768
    s_cbranch_scc1 c_u3_ok
    s_nop 1
    s_and_b64 exec, exec, vcc
    s_cbranch_scc0 c_u3_ok
    buffer_load_dwordx2 v[22:23], v150, s[12:15], s29 offen offset:2048 sc1
    s_waitcnt vmcnt(0)
    s_branch c_u3
c_u3_ok:
    s_mov_b64 exec, -1
    ds_write_b64 v129, v[22:23] offset:3072
    buffer_load_dwordx2 v[30:31], v150, s[12:15], s31 offen offset:2048 sc1
    v_lshlrev_b32 v48, 16, v26
    v_and_b32 v49, s35, v26
    v_lshlrev_b32 v52, 16, v18
    v_and_b32 v53, s35, v18
    v_lshlrev_b32 v50, 16, v27
    v_and_b32 v51, s35, v27
    v_lshlrev_b32 v54, 16, v19
    v_and_b32 v55, s35, v19
    v_fma_f32 v48, v52, v132, v48
    v_fma_f32 v49, v53, v132, v49
    v_fma_f32 v50, v54, v132, v50
    v_fma_f32 v51, v55, v132, v51
    s_waitcnt lgkmcnt(3)
    v_add_f32 v32, v32, v36
    v_add_f32 v33, v33, v37
    v_add_f32 v34, v34, v38
    v_add_f32 v35, v35, v39
    s_waitcnt lgkmcnt(1)
    v_add_f32 v40, v40, v44
    v_add_f32 v41, v41, v45
    v_add_f32 v42, v42, v46
    v_add_f32 v43, v43, v47
    v_add_f32 v48, v48, v32
    v_add_f32 v49, v49, v33
    v_add_f32 v50, v50, v34
    v_add_f32 v51, v51, v35
    v_add_f32 v48, v48, v40
    v_add_f32 v49, v49, v41
    v_add_f32 v50, v50, v42
    v_add_f32 v51, v51, v43
    v_cvt_pk_bf16_f32 v60, v48, v49
    v_cvt_pk_bf16_f32 v61, v50, v51
    s_cmp_eq_u32 s52, 2
    s_cbranch_scc1 c_st2_1
    v_mov_b32_dpp v62, v60 quad_perm:[1,1,3,3] row_mask:0xf bank_mask:0xf
    v_mov_b32_dpp v63, v61 quad_perm:[1,1,3,3] row_mask:0xf bank_mask:0xf
    s_add_u32 s33, s40, 131072
    s_mov_b64 exec, s[50:51]
    buffer_store_dwordx4 v[60:63], v131, s[4:7], s33 offen sc1
    s_mov_b64 exec, s[56:57]
    s_add_u32 s33, s38, 524288
    buffer_store_dwordx4 v[60:63], v4, s[4:7], s33 offen sc1
    s_mov_b64 exec, -1
    s_branch c_st3_1
c_st2_1:
    v_cndmask_b32 v62, v61, v60, s[36:37]
    v_cndmask_b32 v60, v60, v61, s[36:37]
    s_nop 0
    v_mov_b32_dpp v63, v62 quad_perm:[2,3,0,1] row_mask:0xf bank_mask:0xf
    s_add_u32 s33, s38, 524288
    v_perm_b32 v61, v63, v60, v134
    v_perm_b32 v60, v63, v60, v133
    buffer_store_dword v60, v4, s[4:7], s33 offen offset:0
    buffer_store_dword v61, v4, s[4:7], s33 offen offset:1024
c_st3_1:
    s_nop 0
    s_waitcnt lgkmcnt(0)
    s_barrier
    ds_read_b128 v[32:35], v130 offset:0
    ds_read_b128 v[36:39], v130 offset:5120
    ds_read_b128 v[40:43], v130 offset:10240
    ds_read_b128 v[44:47], v130 offset:15360
    v_lshlrev_b32 v48, 16, v28
    v_and_b32 v49, s35, v28
    v_lshlrev_b32 v52, 16, v20
    v_and_b32 v53, s35, v20
    v_lshlrev_b32 v50, 16, v29
    v_and_b32 v51, s35, v29
    v_lshlrev_b32 v54, 16, v21
    v_and_b32 v55, s35, v21
    v_fma_f32 v48, v52, v132, v48
    v_fma_f32 v49, v53, v132, v49
    v_fma_f32 v50, v54, v132, v50
    v_fma_f32 v51, v55, v132, v51
    s_waitcnt lgkmcnt(2)
    v_add_f32 v32, v32, v36
    v_add_f32 v33, v33, v37
    v_add_f32 v34, v34, v38
    v_add_f32 v35, v35, v39
    s_waitcnt lgkmcnt(0)
    v_add_f32 v40, v40, v44
    v_add_f32 v41, v41, v45
    v_add_f32 v42, v42, v46
    v_add_f32 v43, v43, v47
    v_add_f32 v48, v48, v32
    v_add_f32 v49, v49, v33
    v_add_f32 v50, v50, v34
    v_add_f32 v51, v51, v35
    v_add_f32 v48, v48, v40
    v_add_f32 v49, v49, v41
    v_add_f32 v50, v50, v42
    v_add_f32 v51, v51, v43
    v_cvt_pk_bf16_f32 v56, v48, v49
    v_cvt_pk_bf16_f32 v57, v50, v51
    s_cmp_eq_u32 s52, 2
    s_cbranch_scc1 c_st2_2
    v_mov_b32_dpp v58, v56 quad_perm:[1,1,3,3] row_mask:0xf bank_mask:0xf
    v_mov_b32_dpp v59, v57 quad_perm:[1,1,3,3] row_mask:0xf bank_mask:0xf
    s_add_u32 s33, s40, 262144
    s_mov_b64 exec, s[50:51]
    buffer_store_dwordx4 v[56:59], v131, s[4:7], s33 offen sc1
    s_mov_b64 exec, s[56:57]
    s_add_u32 s33, s38, 1048576
    buffer_store_dwordx4 v[56:59], v4, s[4:7], s33 offen sc1
    s_mov_b64 exec, -1
    s_branch c_st3_2
c_st2_2:
    v_cndmask_b32 v58, v57, v56, s[36:37]
    v_cndmask_b32 v56, v56, v57, s[36:37]
    s_nop 0
    v_mov_b32_dpp v59, v58 quad_perm:[2,3,0,1] row_mask:0xf bank_mask:0xf
    s_add_u32 s33, s38, 1048576
    v_perm_b32 v57, v59, v56, v134
    v_perm_b32 v56, v59, v56, v133
    buffer_store_dword v56, v4, s[4:7], s33 offen offset:0
    buffer_store_dword v57, v4, s[4:7], s33 offen offset:1024
c_st3_2:
    s_nop 0
    s_barrier
    ds_read_b128 v[32:35], v130 offset:2560
    ds_read_b128 v[36:39], v130 offset:7680
    ds_read_b128 v[40:43], v130 offset:12800
    ds_read_b128 v[44:47], v130 offset:17920
    s_waitcnt vmcnt(4)
    v_lshlrev_b32 v48, 16, v30
    v_and_b32 v49, s35, v30
    v_lshlrev_b32 v52, 16, v22
    v_and_b32 v53, s35, v22
    v_lshlrev_b32 v50, 16, v31
    v_and_b32 v51, s35, v31
    v_lshlrev_b32 v54, 16, v23
    v_and_b32 v55, s35, v23
    v_fma_f32 v48, v52, v132, v48
    v_fma_f32 v49, v53, v132, v49
    v_fma_f32 v50, v54, v132, v50
    v_fma_f32 v51, v55, v132, v51
    s_waitcnt lgkmcnt(2)
    v_add_f32 v32, v32, v36
    v_add_f32 v33, v33, v37
    v_add_f32 v34, v34, v38
    v_add_f32 v35, v35, v39
    s_waitcnt lgkmcnt(0)
    v_add_f32 v40, v40, v44
    v_add_f32 v41, v41, v45
    v_add_f32 v42, v42, v46
    v_add_f32 v43, v43, v47
    v_add_f32 v48, v48, v32
    v_add_f32 v49, v49, v33
    v_add_f32 v50, v50, v34
    v_add_f32 v51, v51, v35
    v_add_f32 v48, v48, v40
    v_add_f32 v49, v49, v41
    v_add_f32 v50, v50, v42
    v_add_f32 v51, v51, v43
    v_cvt_pk_bf16_f32 v60, v48, v49
    v_cvt_pk_bf16_f32 v61, v50, v51
    s_cmp_eq_u32 s52, 2
    s_cbranch_scc1 c_st2_3
    v_mov_b32_dpp v62, v60 quad_perm:[1,1,3,3] row_mask:0xf bank_mask:0xf
    v_mov_b32_dpp v63, v61 quad_perm:[1,1,3,3] row_mask:0xf bank_mask:0xf
    s_add_u32 s33, s40, 393216
    s_mov_b64 exec, s[50:51]
    buffer_store_dwordx4 v[60:63], v131, s[4:7], s33 offen sc1
    s_mov_b64 exec, s[56:57]
    s_add_u32 s33, s38, 1572864
    buffer_store_dwordx4 v[60:63], v4, s[4:7], s33 offen sc1
    s_mov_b64 exec, -1
    s_branch c_st3_3
c_st2_3:
    v_cndmask_b32 v62, v61, v60, s[36:37]
    v_cndmask_b32 v60, v60, v61, s[36:37]
    s_nop 0
    v_mov_b32_dpp v63, v62 quad_perm:[2,3,0,1] row_mask:0xf bank_mask:0xf
    s_add_u32 s33, s38, 1572864
    v_perm_b32 v61, v63, v60, v134
    v_perm_b32 v60, v63, v60, v133
    buffer_store_dword v60, v4, s[4:7], s33 offen offset:0
    buffer_store_dword v61, v4, s[4:7], s33 offen offset:1024
c_st3_3:
    s_nop 0
    s_cmp_eq_u32 s52, 2
    s_cbranch_scc1 c_end
    s_cmp_lt_u32 s24, 1024
    s_cbranch_scc1 c_nox
    s_waitcnt vmcnt(0)
    s_barrier
c_nox:
    s_add_u32 s55, s55, 4
    s_cmp_eq_u32 s27, 0
    s_cbranch_scc0 c_noarr2
    s_lshl_b32 s33, 1, s54
    v_mov_b32 v3, s33
    v_mov_b32 v2, 0
    s_mov_b64 exec, 1
    buffer_atomic_add v3, v2, s[8:11], s55 offen sc1
    s_mov_b64 exec, -1
c_noarr2:
    s_mov_b32 s52, 2
    s_setprio 0
    s_branch c_att_xt
c_end:
k_exit:
    s_endpgm
.p2align 7
.type kgen_tab,@object
kgen_tab:
    .short 13800, 9216, 9216, 9216, 9216, 9180, 9180, 9180, 9180, 0, 0, 0, 0, 0, 0, 0
    .short 9180, 9180, 9180, 9180, 9144, 9144, 9144, 9144, 9144, 0, 0, 0, 0, 0, 0, 0
    .short 9144, 9144, 9144, 9144, 9144, 9108, 9108, 9108, 9108, 0, 0, 0, 0, 0, 0, 0
    .short 9108, 9108, 9108, 9108, 9072, 9072, 9072, 9072, 9072, 0, 0, 0, 0, 0, 0, 0
    .short 9072, 9072, 9072, 9072, 9072, 9036, 9036, 9036, 9036, 0, 0, 0, 0, 0, 0, 0
    .short 9036, 9036, 9036, 9036, 9000, 9000, 9000, 9000, 9000, 0, 0, 0, 0, 0, 0, 0
    .short 9000, 9000, 9000, 9000, 9000, 8964, 8964, 8964, 8964, 0, 0, 0, 0, 0, 0, 0
    .short 8964, 8964, 8964, 8964, 8928, 8928, 8928, 8928, 8928, 0, 0, 0, 0, 0, 0, 0
    .short 8928, 8928, 8928, 8928, 8928, 8892, 8892, 8892, 8892, 0, 0, 0, 0, 0, 0, 0
    .short 8892, 8892, 8892, 8892, 8856, 8856, 8856, 8856, 8856, 0, 0, 0, 0, 0, 0, 0
    .short 8856, 8856, 8856, 8856, 8856, 8820, 8820, 8820, 8820, 0, 0, 0, 0, 0, 0, 0
    .short 8820, 8820, 8820, 8820, 8784, 8784, 8784, 8784, 8784, 0, 0, 0, 0, 0, 0, 0
    .short 8784, 8784, 8784, 8784, 8784, 8748, 8748, 8748, 8748, 0, 0, 0, 0, 0, 0, 0
    .short 8748, 8748, 8748, 8748, 8712, 8712, 8712, 8712, 8712, 0, 0, 0, 0, 0, 0, 0
    .short 8712, 8712, 8712, 8712, 8712, 8676, 8676, 8676, 8676, 0, 0, 0, 0, 0, 0, 0
    .short 8676, 8676, 8676, 8676, 8640, 8640, 8640, 8640, 8640, 0, 0, 0, 0, 0, 0, 0
    .short 8640, 8640, 8640, 8640, 8640, 8604, 8604, 8604, 8604, 0, 0, 0, 0, 0, 0, 0
    .short 8604, 8604, 8604, 8604, 8568, 8568, 8568, 8568, 8568, 0, 0, 0, 0, 0, 0, 0
    .short 8568, 8568, 8568, 8568, 8568, 8532, 8532, 8532, 8532, 0, 0, 0, 0, 0, 0, 0
    .short 8532, 8532, 8532, 8532, 8496, 8496, 8496, 8496, 8496, 0, 0, 0, 0, 0, 0, 0
    .short 8496, 8496, 8496, 8496, 8496, 8460, 8460, 8460, 8460, 0, 0, 0, 0, 0, 0, 0
    .short 8460, 8460, 8460, 8460, 8424, 8424, 8424, 8424, 8424, 0, 0, 0, 0, 0, 0, 0
    .short 8424, 8424, 8424, 8424, 8424, 8388, 8388, 8388, 8388, 0, 0, 0, 0, 0, 0, 0
    .short 8388, 8388, 8388, 8388, 8352, 8352, 8352, 8352, 8352, 0, 0, 0, 0, 0, 0, 0
    .short 8352, 8352, 8352, 8352, 8352, 8316, 8316, 8316, 8316, 0, 0, 0, 0, 0, 0, 0
    .short 8316, 8316, 8316, 8316, 8280, 8280, 8280, 8280, 8280, 0, 0, 0, 0, 0, 0, 0
    .short 8280, 8280, 8280, 8280, 8280, 8244, 8244, 8244, 8244, 0, 0, 0, 0, 0, 0, 0
    .short 8244, 8244, 8244, 8244, 8208, 8208, 8208, 8208, 8208, 0, 0, 0, 0, 0, 0, 0
    .short 8208, 8208, 8208, 8208, 8208, 8172, 8172, 8172, 8172, 0, 0, 0, 0, 0, 0, 0
    .short 8172, 8172, 8172, 8172, 8136, 8136, 8136, 8136, 8136, 0, 0, 0, 0, 0, 0, 0
    .short 8136, 8136, 8136, 8136, 8136, 8100, 8100, 8100, 8100, 0, 0, 0, 0, 0, 0, 0
    .short 8100, 8100, 8100, 8100, 8064, 8064, 8064, 8064, 8064, 0, 0, 0, 0, 0, 0, 0
    .short 8064, 8064, 8064, 8064, 8064, 8028, 8028, 8028, 8028, 0, 0, 0, 0, 0, 0, 0
    .short 8028, 8028, 8028, 8028, 7992, 7992, 7992, 7992, 7992, 0, 0, 0, 0, 0, 0, 0
    .short 7992, 7992, 7992, 7992, 7992, 7956, 7956, 7956, 7956, 0, 0, 0, 0, 0, 0, 0
    .short 7956, 7956, 7956, 7956, 7920, 7920, 7920, 7920, 7920, 0, 0, 0, 0, 0, 0, 0
    .short 7920, 7920, 7920, 7920, 7920, 7884, 7884, 7884, 7884, 0, 0, 0, 0, 0, 0, 0
    .short 7884, 7884, 7884, 7884, 7848, 7848, 7848, 7848, 7848, 0, 0, 0, 0, 0, 0, 0
    .short 7848, 7848, 7848, 7848, 7848, 7812, 7812, 7812, 7812, 0, 0, 0, 0, 0, 0, 0
    .short 7812, 7812, 7812, 7812, 7776, 7776, 7776, 7776, 7776, 0, 0, 0, 0, 0, 0, 0
    .short 7776, 7776, 7776, 7776, 7776, 7740, 7740, 7740, 7740, 0, 0, 0, 0, 0, 0, 0
    .short 7740, 7740, 7740, 7740, 7704, 7704, 7704, 7704, 7704, 0, 0, 0, 0, 0, 0, 0
    .short 7704, 7704, 7704, 7704, 7704, 7668, 7668, 7668, 7668, 0, 0, 0, 0, 0, 0, 0
    .short 7668, 7668, 7668, 7668, 7632, 7632, 7632, 7632, 7632, 0, 0, 0, 0, 0, 0, 0
    .short 7632, 7632, 7632, 7632, 7632, 7596, 7596, 7596, 7596, 0, 0, 0, 0, 0, 0, 0
    .short 7596, 7596, 7596, 7596, 7560, 7560, 7560, 7560, 7560, 0, 0, 0, 0, 0, 0, 0
    .short 7560, 7560, 7560, 7560, 7560, 7524, 7524, 7524, 7524, 0, 0, 0, 0, 0, 0, 0
    .short 7524, 7524, 7524, 7524, 7488, 7488, 7488, 7488, 7488, 0, 0, 0, 0, 0, 0, 0
    .short 7488, 7488, 7488, 7488, 7488, 7452, 7452, 7452, 7452, 0, 0, 0, 0, 0, 0, 0
    .short 7452, 7452, 7452, 7452, 7416, 7416, 7416, 7416, 7416, 0, 0, 0, 0, 0, 0, 0
    .short 7416, 7416, 7416, 7416, 7416, 7380, 7380, 7380, 7380, 0, 0, 0, 0, 0, 0, 0
    .short 7380, 7380, 7380, 7380, 7344, 7344, 7344, 7344, 7344, 0, 0, 0, 0, 0, 0, 0
    .short 7344, 7344, 7344, 7344, 7344, 7308, 7308, 7308, 7308, 0, 0, 0, 0, 0, 0, 0
    .short 7308, 7308, 7308, 7308, 7272, 7272, 7272, 7272, 7272, 0, 0, 0, 0, 0, 0, 0
    .short 7272, 7272, 7272, 7272, 7272, 7236, 7236, 7236, 7236, 0, 0, 0, 0, 0, 0, 0
    .short 7236, 7236, 7236, 7236, 7200, 7200, 7200, 7200, 7200, 0, 0, 0, 0, 0, 0, 0
    .short 7200, 7200, 7200, 7200, 7200, 7164, 7164, 7164, 7164, 0, 0, 0, 0, 0, 0, 0
    .short 7164, 7164, 7164, 7164, 7128, 7128, 7128, 7128, 7128, 0, 0, 0, 0, 0, 0, 0
    .short 7128, 7128, 7128, 7128, 7128, 7092, 7092, 7092, 7092, 0, 0, 0, 0, 0, 0, 0
    .short 7092, 7092, 7092, 7092, 7056, 7056, 7056, 7056, 7056, 0, 0, 0, 0, 0, 0, 0
    .short 7056, 7056, 7056, 7056, 7056, 7020, 7020, 7020, 7020, 0, 0, 0, 0, 0, 0, 0
    .short 7020, 7020, 7020, 7020, 6984, 6984, 6984, 6984, 6984, 0, 0, 0, 0, 0, 0, 0
    .short 6984, 6984, 6984, 6984, 6984, 6948, 6948, 6948, 6948, 0, 0, 0, 0, 0, 0, 0
    .short 6948, 6948, 6948, 6948, 6912, 6912, 6912, 6912, 6912, 0, 0, 0, 0, 0, 0, 0
    .short 6912, 6912, 6912, 6912, 6912, 6876, 6876, 6876, 6876, 0, 0, 0, 0, 0, 0, 0
    .short 6876, 6876, 6876, 6876, 6840, 6840, 6840, 6840, 6840, 0, 0, 0, 0, 0, 0, 0
    .short 6840, 6840, 6840, 6840, 6840, 6804, 6804, 6804, 6804, 0, 0, 0, 0, 0, 0, 0
    .short 6804, 6804, 6804, 6804, 6768, 6768, 6768, 6768, 6768, 0, 0, 0, 0, 0, 0, 0
    .short 6768, 6768, 6768, 6768, 6768, 6732, 6732, 6732, 6732, 0, 0, 0, 0, 0, 0, 0
    .short 6732, 6732, 6732, 6732, 6696, 6696, 6696, 6696, 6696, 0, 0, 0, 0, 0, 0, 0
    .short 6696, 6696, 6696, 6696, 6696, 6660, 6660, 6660, 6660, 0, 0, 0, 0, 0, 0, 0
    .short 6660, 6660, 6660, 6660, 6624, 6624, 6624, 6624, 6624, 0, 0, 0, 0, 0, 0, 0
    .short 6624, 6624, 6624, 6624, 6624, 6588, 6588, 6588, 6588, 0, 0, 0, 0, 0, 0, 0
    .short 6588, 6588, 6588, 6588, 6552, 6552, 6552, 6552, 6552, 0, 0, 0, 0, 0, 0, 0
    .short 6552, 6552, 6552, 6552, 6552, 6516, 6516, 6516, 6516, 0, 0, 0, 0, 0, 0, 0
    .short 6516, 6516, 6516, 6516, 6480, 6480, 6480, 6480, 6480, 0, 0, 0, 0, 0, 0, 0
    .short 6480, 6480, 6480, 6480, 6480, 6444, 6444, 6444, 6444, 0, 0, 0, 0, 0, 0, 0
    .short 6444, 6444, 6444, 6444, 6408, 6408, 6408, 6408, 6408, 0, 0, 0, 0, 0, 0, 0
    .short 6408, 6408, 6408, 6408, 6408, 6372, 6372, 6372, 6372, 0, 0, 0, 0, 0, 0, 0
    .short 6372, 6372, 6372, 6372, 6336, 6336, 6336, 6336, 6336, 0, 0, 0, 0, 0, 0, 0
    .short 6336, 6336, 6336, 6336, 6336, 6300, 6300, 6300, 6300, 0, 0, 0, 0, 0, 0, 0
    .short 6300, 6300, 6300, 6300, 6264, 6264, 6264, 6264, 6264, 0, 0, 0, 0, 0, 0, 0
    .short 6264, 6264, 6264, 6264, 6264, 6228, 6228, 6228, 6228, 0, 0, 0, 0, 0, 0, 0
    .short 6228, 6228, 6228, 6228, 6192, 6192, 6192, 6192, 6192, 0, 0, 0, 0, 0, 0, 0
    .short 6192, 6192, 6192, 6192, 6192, 6156, 6156, 6156, 6156, 0, 0, 0, 0, 0, 0, 0
    .short 6156, 6156, 6156, 6156, 6120, 6120, 6120, 6120, 6120, 0, 0, 0, 0, 0, 0, 0
    .short 6120, 6120, 6120, 6120, 6120, 6084, 6084, 6084, 6084, 0, 0, 0, 0, 0, 0, 0
    .short 6084, 6084, 6084, 6084, 6048, 6048, 6048, 6048, 6048, 0, 0, 0, 0, 0, 0, 0
    .short 6048, 6048, 6048, 6048, 6048, 6012, 6012, 6012, 6012, 0, 0, 0, 0, 0, 0, 0
    .short 6012, 6012, 6012, 6012, 5976, 5976, 5976, 5976, 5976, 0, 0, 0, 0, 0, 0, 0
    .short 5976, 5976, 5976, 5976, 5976, 5940, 5940, 5940, 5940, 0, 0, 0, 0, 0, 0, 0
    .short 5940, 5940, 5940, 5940, 5904, 5904, 5904, 5904, 5904, 0, 0, 0, 0, 0, 0, 0
    .short 5904, 5904, 5904, 5904, 5904, 5868, 5868, 5868, 5868, 0, 0, 0, 0, 0, 0, 0
    .short 5868, 5868, 5868, 5868, 5832, 5832, 5832, 5832, 5832, 0, 0, 0, 0, 0, 0, 0
    .short 5832, 5832, 5832, 5832, 5832, 5796, 5796, 5796, 5796, 0, 0, 0, 0, 0, 0, 0
    .short 5796, 5796, 5796, 5796, 5760, 5760, 5760, 5760, 5760, 0, 0, 0, 0, 0, 0, 0
    .short 5760, 5760, 5760, 5760, 5760, 5724, 5724, 5724, 5724, 0, 0, 0, 0, 0, 0, 0
    .short 5724, 5724, 5724, 5724, 5688, 5688, 5688, 5688, 5688, 0, 0, 0, 0, 0, 0, 0
    .short 5688, 5688, 5688, 5688, 5688, 5652, 5652, 5652, 5652, 0, 0, 0, 0, 0, 0, 0
    .short 5652, 5652, 5652, 5652, 5616, 5616, 5616, 5616, 5616, 0, 0, 0, 0, 0, 0, 0
    .short 5616, 5616, 5616, 5616, 5616, 5580, 5580, 5580, 5580, 0, 0, 0, 0, 0, 0, 0
    .short 5580, 5580, 5580, 5580, 5544, 5544, 5544, 5544, 5544, 0, 0, 0, 0, 0, 0, 0
    .short 5544, 5544, 5544, 5544, 5544, 5508, 5508, 5508, 5508, 0, 0, 0, 0, 0, 0, 0
    .short 5508, 5508, 5508, 5508, 5472, 5472, 5472, 5472, 5472, 0, 0, 0, 0, 0, 0, 0
    .short 5472, 5472, 5472, 5472, 5472, 5436, 5436, 5436, 5436, 0, 0, 0, 0, 0, 0, 0
    .short 5436, 5436, 5436, 5436, 5400, 5400, 5400, 5400, 5400, 0, 0, 0, 0, 0, 0, 0
    .short 5400, 5400, 5400, 5400, 5400, 5364, 5364, 5364, 5364, 0, 0, 0, 0, 0, 0, 0
    .short 5364, 5364, 5364, 5364, 5328, 5328, 5328, 5328, 5328, 0, 0, 0, 0, 0, 0, 0
    .short 5328, 5328, 5328, 5328, 5328, 5292, 5292, 5292, 5292, 0, 0, 0, 0, 0, 0, 0
    .short 5292, 5292, 5292, 5292, 5256, 5256, 5256, 5256, 5256, 0, 0, 0, 0, 0, 0, 0
    .short 5256, 5256, 5256, 5256, 5256, 5220, 5220, 5220, 5220, 0, 0, 0, 0, 0, 0, 0
    .short 5220, 5220, 5220, 5220, 5184, 5184, 5184, 5184, 5184, 0, 0, 0, 0, 0, 0, 0
    .short 5184, 5184, 5184, 5184, 5184, 5148, 5148, 5148, 5148, 0, 0, 0, 0, 0, 0, 0
    .short 5148, 5148, 5148, 5148, 5112, 5112, 5112, 5112, 5112, 0, 0, 0, 0, 0, 0, 0
    .short 5112, 5112, 5112, 5112, 5112, 5076, 5076, 5076, 5076, 0, 0, 0, 0, 0, 0, 0
    .short 5076, 5076, 5076, 5076, 5040, 5040, 5040, 5040, 5040, 0, 0, 0, 0, 0, 0, 0
    .short 5040, 5040, 5040, 5040, 5040, 5004, 5004, 5004, 5004, 0, 0, 0, 0, 0, 0, 0
    .short 5004, 5004, 5004, 5004, 4968, 4968, 4968, 4968, 4968, 0, 0, 0, 0, 0, 0, 0
    .short 4968, 4968, 4968, 4968, 4968, 4932, 4932, 4932, 4932, 0, 0, 0, 0, 0, 0, 0
    .short 4932, 4932, 4932, 4932, 4896, 4896, 4896, 4896, 4896, 0, 0, 0, 0, 0, 0, 0
    .short 4896, 4896, 4896, 4896, 4896, 4860, 4860, 4860, 4860, 0, 0, 0, 0, 0, 0, 0
    .short 4860, 4860, 4860, 4860, 4824, 4824, 4824, 4824, 4824, 0, 0, 0, 0, 0, 0, 0
    .short 4824, 4824, 4824, 4824, 4824, 4788, 4788, 4788, 4788, 0, 0, 0, 0, 0, 0, 0
    .short 4788, 4788, 4788, 4788, 4752, 4752, 4752, 4752, 4752, 0, 0, 0, 0, 0, 0, 0
    .short 4752, 4752, 4752, 4752, 4752, 4716, 4716, 4716, 4716, 0, 0, 0, 0, 0, 0, 0
    .short 4716, 4716, 4716, 4716, 4680, 4680, 4680, 4680, 4680, 0, 0, 0, 0, 0, 0, 0
    .short 4680, 4680, 4680, 4680, 4680, 4644, 4644, 4644, 4644, 0, 0, 0, 0, 0, 0, 0
    .short 4644, 4644, 4644, 4644, 4608, 4608, 4608, 4608, 4608, 0, 0, 0, 0, 0, 0, 0
    .short 4608, 4608, 4608, 4588, 4588, 4588, 4572, 4572, 4572, 0, 0, 0, 0, 0, 0, 0
    .short 4572, 4572, 4572, 4552, 4552, 4552, 4536, 4536, 4536, 0, 0, 0, 0, 0, 0, 0
    .short 4536, 4536, 4536, 4516, 4516, 4516, 4500, 4500, 4500, 0, 0, 0, 0, 0, 0, 0
    .short 4500, 4500, 4500, 4480, 4480, 4480, 4464, 4464, 4464, 0, 0, 0, 0, 0, 0, 0
    .short 4464, 4464, 4464, 4444, 4444, 4444, 4428, 4428, 4428, 0, 0, 0, 0, 0, 0, 0
    .short 4428, 4428, 4428, 4408, 4408, 4408, 4392, 4392, 4392, 0, 0, 0, 0, 0, 0, 0
    .short 4392, 4392, 4392, 4372, 4372, 4372, 4356, 4356, 4356, 0, 0, 0, 0, 0, 0, 0
    .short 4356, 4356, 4356, 4336, 4336, 4336, 4320, 4320, 4320, 0, 0, 0, 0, 0, 0, 0
    .short 4320, 4320, 4320, 4300, 4300, 4300, 4284, 4284, 4284, 0, 0, 0, 0, 0, 0, 0
    .short 4284, 4284, 4284, 4264, 4264, 4264, 4248, 4248, 4248, 0, 0, 0, 0, 0, 0, 0
    .short 4248, 4248, 4248, 4228, 4228, 4228, 4212, 4212, 4212, 0, 0, 0, 0, 0, 0, 0
    .short 4212, 4212, 4212, 4192, 4192, 4192, 4176, 4176, 4176, 0, 0, 0, 0, 0, 0, 0
    .short 4176, 4176, 4176, 4156, 4156, 4156, 4140, 4140, 4140, 0, 0, 0, 0, 0, 0, 0
    .short 4140, 4140, 4140, 4120, 4120, 4120, 4104, 4104, 4104, 0, 0, 0, 0, 0, 0, 0
    .short 4104, 4104, 4104, 4084, 4084, 4084, 4068, 4068, 4068, 0, 0, 0, 0, 0, 0, 0
    .short 4068, 4068, 4068, 4048, 4048, 4048, 4032, 4032, 4032, 0, 0, 0, 0, 0, 0, 0
    .short 4032, 4032, 4032, 4012, 4012, 4012, 3996, 3996, 3996, 0, 0, 0, 0, 0, 0, 0
    .short 3996, 3996, 3996, 3976, 3976, 3976, 3960, 3960, 3960, 0, 0, 0, 0, 0, 0, 0
    .short 3960, 3960, 3960, 3940, 3940, 3940, 3924, 3924, 3924, 0, 0, 0, 0, 0, 0, 0
    .short 3924, 3924, 3924, 3904, 3904, 3904, 3888, 3888, 3888, 0, 0, 0, 0, 0, 0, 0
    .short 3888, 3888, 3888, 3868, 3868, 3868, 3852, 3852, 3852, 0, 0, 0, 0, 0, 0, 0
    .short 3852, 3852, 3852, 3832, 3832, 3832, 3816, 3816, 3816, 0, 0, 0, 0, 0, 0, 0
    .short 3816, 3816, 3816, 3796, 3796, 3796, 3780, 3780, 3780, 0, 0, 0, 0, 0, 0, 0
    .short 3780, 3780, 3780, 3760, 3760, 3760, 3744, 3744, 3744, 0, 0, 0, 0, 0, 0, 0
    .short 3744, 3744, 3744, 3724, 3724, 3724, 3708, 3708, 3708, 0, 0, 0, 0, 0, 0, 0
    .short 3708, 3708, 3708, 3688, 3688, 3688, 3672, 3672, 3672, 0, 0, 0, 0, 0, 0, 0
    .short 3672, 3672, 3672, 3652, 3652, 3652, 3636, 3636, 3636, 0, 0, 0, 0, 0, 0, 0
    .short 3636, 3636, 3636, 3616, 3616, 3616, 3600, 3600, 3600, 0, 0, 0, 0, 0, 0, 0
    .short 3600, 3600, 3600, 3580, 3580, 3580, 3564, 3564, 3564, 0, 0, 0, 0, 0, 0, 0
    .short 3564, 3564, 3564, 3544, 3544, 3544, 3528, 3528, 3528, 0, 0, 0, 0, 0, 0, 0
    .short 3528, 3528, 3528, 3508, 3508, 3508, 3492, 3492, 3492, 0, 0, 0, 0, 0, 0, 0
    .short 3492, 3492, 3492, 3472, 3472, 3472, 3456, 3456, 3456, 0, 0, 0, 0, 0, 0, 0
    .short 3456, 3456, 3456, 3436, 3436, 3436, 3420, 3420, 3420, 0, 0, 0, 0, 0, 0, 0
    .short 3420, 3420, 3420, 3400, 3400, 3400, 3384, 3384, 3384, 0, 0, 0, 0, 0, 0, 0
    .short 3384, 3384, 3384, 3364, 3364, 3364, 3348, 3348, 3348, 0, 0, 0, 0, 0, 0, 0
    .short 3348, 3348, 3348, 3328, 3328, 3328, 3312, 3312, 3312, 0, 0, 0, 0, 0, 0, 0
    .short 3312, 3312, 3312, 3292, 3292, 3292, 3276, 3276, 3276, 0, 0, 0, 0, 0, 0, 0
    .short 3276, 3276, 3276, 3256, 3256, 3256, 3240, 3240, 3240, 0, 0, 0, 0, 0, 0, 0
    .short 3240, 3240, 3240, 3220, 3220, 3220, 3204, 3204, 3204, 0, 0, 0, 0, 0, 0, 0
    .short 3204, 3204, 3204, 3184, 3184, 3184, 3168, 3168, 3168, 0, 0, 0, 0, 0, 0, 0
    .short 3168, 3168, 3168, 3148, 3148, 3148, 3132, 3132, 3132, 0, 0, 0, 0, 0, 0, 0
    .short 3132, 3132, 3132, 3112, 3112, 3112, 3096, 3096, 3096, 0, 0, 0, 0, 0, 0, 0
    .short 3096, 3096, 3096, 3076, 3076, 3076, 3060, 3060, 3060, 0, 0, 0, 0, 0, 0, 0
    .short 3060, 3060, 3060, 3040, 3040, 3040, 3024, 3024, 3024, 0, 0, 0, 0, 0, 0, 0
    .short 3024, 3024, 3024, 3004, 3004, 3004, 2988, 2988, 2988, 0, 0, 0, 0, 0, 0, 0
    .short 2988, 2988, 2988, 2968, 2968, 2968, 2952, 2952, 2952, 0, 0, 0, 0, 0, 0, 0
    .short 2952, 2952, 2952, 2932, 2932, 2932, 2916, 2916, 2916, 0, 0, 0, 0, 0, 0, 0
    .short 2916, 2916, 2916, 2896, 2896, 2896, 2880, 2880, 2880, 0, 0, 0, 0, 0, 0, 0
    .short 2880, 2880, 2880, 2860, 2860, 2860, 2844, 2844, 2844, 0, 0, 0, 0, 0, 0, 0
    .short 2844, 2844, 2844, 2824, 2824, 2824, 2808, 2808, 2808, 0, 0, 0, 0, 0, 0, 0
    .short 2808, 2808, 2808, 2788, 2788, 2788, 2772, 2772, 2772, 0, 0, 0, 0, 0, 0, 0
    .short 2772, 2772, 2772, 2752, 2752, 2752, 2736, 2736, 2736, 0, 0, 0, 0, 0, 0, 0
    .short 2736, 2736, 2736, 2716, 2716, 2716, 2700, 2700, 2700, 0, 0, 0, 0, 0, 0, 0
    .short 2700, 2700, 2700, 2680, 2680, 2680, 2664, 2664, 2664, 0, 0, 0, 0, 0, 0, 0
    .short 2664, 2664, 2664, 2644, 2644, 2644, 2628, 2628, 2628, 0, 0, 0, 0, 0, 0, 0
    .short 2628, 2628, 2628, 2608, 2608, 2608, 2592, 2592, 2592, 0, 0, 0, 0, 0, 0, 0
    .short 2592, 2592, 2592, 2572, 2572, 2572, 2556, 2556, 2556, 0, 0, 0, 0, 0, 0, 0
    .short 2556, 2556, 2556, 2536, 2536, 2536, 2520, 2520, 2520, 0, 0, 0, 0, 0, 0, 0
    .short 2520, 2520, 2520, 2500, 2500, 2500, 2484, 2484, 2484, 0, 0, 0, 0, 0, 0, 0
    .short 2484, 2484, 2484, 2464, 2464, 2464, 2448, 2448, 2448, 0, 0, 0, 0, 0, 0, 0
    .short 2448, 2448, 2448, 2428, 2428, 2428, 2412, 2412, 2412, 0, 0, 0, 0, 0, 0, 0
    .short 2412, 2412, 2412, 2392, 2392, 2392, 2376, 2376, 2376, 0, 0, 0, 0, 0, 0, 0
    .short 2376, 2376, 2376, 2356, 2356, 2356, 2340, 2340, 2340, 0, 0, 0, 0, 0, 0, 0
    .short 2340, 2340, 2340, 2320, 2320, 2320, 2304, 2304, 2304, 0, 0, 0, 0, 0, 0, 0
    .short 2304, 2304, 2292, 2284, 2284, 2284, 2276, 2268, 2268, 0, 0, 0, 0, 0, 0, 0
    .short 2268, 2268, 2256, 2248, 2248, 2248, 2240, 2232, 2232, 0, 0, 0, 0, 0, 0, 0
    .short 2232, 2232, 2220, 2212, 2212, 2212, 2204, 2196, 2196, 0, 0, 0, 0, 0, 0, 0
    .short 2196, 2196, 2184, 2176, 2176, 2176, 2168, 2160, 2160, 0, 0, 0, 0, 0, 0, 0
    .short 2160, 2160, 2148, 2140, 2140, 2140, 2132, 2124, 2124, 0, 0, 0, 0, 0, 0, 0
    .short 2124, 2124, 2112, 2104, 2104, 2104, 2096, 2088, 2088, 0, 0, 0, 0, 0, 0, 0
    .short 2088, 2088, 2076, 2068, 2068, 2068, 2060, 2052, 2052, 0, 0, 0, 0, 0, 0, 0
    .short 2052, 2052, 2040, 2032, 2032, 2032, 2024, 2016, 2016, 0, 0, 0, 0, 0, 0, 0
    .short 2016, 2016, 2004, 1996, 1996, 1996, 1988, 1980, 1980, 0, 0, 0, 0, 0, 0, 0
    .short 1980, 1980, 1968, 1960, 1960, 1960, 1952, 1944, 1944, 0, 0, 0, 0, 0, 0, 0
    .short 1944, 1944, 1932, 1924, 1924, 1924, 1916, 1908, 1908, 0, 0, 0, 0, 0, 0, 0
    .short 1908, 1908, 1896, 1888, 1888, 1888, 1880, 1872, 1872, 0, 0, 0, 0, 0, 0, 0
    .short 1872, 1872, 1860, 1852, 1852, 1852, 1844, 1836, 1836, 0, 0, 0, 0, 0, 0, 0
    .short 1836, 1836, 1824, 1816, 1816, 1816, 1808, 1800, 1800, 0, 0, 0, 0, 0, 0, 0
    .short 1800, 1800, 1788, 1780, 1780, 1780, 1772, 1764, 1764, 0, 0, 0, 0, 0, 0, 0
    .short 1764, 1764, 1752, 1744, 1744, 1744, 1736, 1728, 1728, 0, 0, 0, 0, 0, 0, 0
    .short 1728, 1728, 1716, 1708, 1708, 1708, 1700, 1692, 1692, 0, 0, 0, 0, 0, 0, 0
    .short 1692, 1692, 1680, 1672, 1672, 1672, 1664, 1656, 1656, 0, 0, 0, 0, 0, 0, 0
    .short 1656, 1656, 1644, 1636, 1636, 1636, 1628, 1620, 1620, 0, 0, 0, 0, 0, 0, 0
    .short 1620, 1620, 1608, 1600, 1600, 1600, 1592, 1584, 1584, 0, 0, 0, 0, 0, 0, 0
    .short 1584, 1584, 1572, 1564, 1564, 1564, 1556, 1548, 1548, 0, 0, 0, 0, 0, 0, 0
    .short 1548, 1548, 1536, 1528, 1528, 1528, 1520, 1512, 1512, 0, 0, 0, 0, 0, 0, 0
    .short 1512, 1512, 1500, 1492, 1492, 1492, 1484, 1476, 1476, 0, 0, 0, 0, 0, 0, 0
    .short 1476, 1476, 1464, 1456, 1456, 1456, 1448, 1440, 1440, 0, 0, 0, 0, 0, 0, 0
    .short 1440, 1440, 1428, 1420, 1420, 1420, 1412, 1404, 1404, 0, 0, 0, 0, 0, 0, 0
    .short 1404, 1404, 1392, 1384, 1384, 1384, 1376, 1368, 1368, 0, 0, 0, 0, 0, 0, 0
    .short 1368, 1368, 1356, 1348, 1348, 1348, 1340, 1332, 1332, 0, 0, 0, 0, 0, 0, 0
    .short 1332, 1332, 1320, 1312, 1312, 1312, 1304, 1296, 1296, 0, 0, 0, 0, 0, 0, 0
    .short 1296, 1296, 1284, 1276, 1276, 1276, 1268, 1260, 1260, 0, 0, 0, 0, 0, 0, 0
    .short 1260, 1260, 1248, 1240, 1240, 1240, 1232, 1224, 1224, 0, 0, 0, 0, 0, 0, 0
    .short 1224, 1224, 1212, 1204, 1204, 1204, 1196, 1188, 1188, 0, 0, 0, 0, 0, 0, 0
    .short 1188, 1188, 1176, 1168, 1168, 1168, 1160, 1152, 1152, 0, 0, 0, 0, 0, 0, 0
    .short 1152, 1144, 1140, 1136, 1132, 1128, 1124, 1120, 1116, 0, 0, 0, 0, 0, 0, 0
    .short 1116, 1108, 1104, 1100, 1096, 1092, 1088, 1084, 1080, 0, 0, 0, 0, 0, 0, 0
    .short 1080, 1072, 1068, 1064, 1060, 1056, 1052, 1048, 1044, 0, 0, 0, 0, 0, 0, 0
    .short 1044, 1036, 1032, 1028, 1024, 1020, 1016, 1012, 1008, 0, 0, 0, 0, 0, 0, 0
    .short 1008, 1000, 996, 992, 988, 984, 980, 976, 972, 0, 0, 0, 0, 0, 0, 0
    .short 972, 964, 960, 956, 952, 948, 944, 940, 936, 0, 0, 0, 0, 0, 0, 0
    .short 936, 928, 924, 920, 916, 912, 908, 904, 900, 0, 0, 0, 0, 0, 0, 0
    .short 900, 892, 888, 884, 880, 876, 872, 868, 864, 0, 0, 0, 0, 0, 0, 0
    .short 864, 856, 852, 848, 844, 840, 836, 832, 828, 0, 0, 0, 0, 0, 0, 0
    .short 828, 820, 816, 812, 808, 804, 800, 796, 792, 0, 0, 0, 0, 0, 0, 0
    .short 792, 784, 780, 776, 772, 768, 764, 760, 756, 0, 0, 0, 0, 0, 0, 0
    .short 756, 748, 744, 740, 736, 732, 728, 724, 720, 0, 0, 0, 0, 0, 0, 0
    .short 720, 712, 708, 704, 700, 696, 692, 688, 684, 0, 0, 0, 0, 0, 0, 0
    .short 684, 676, 672, 668, 664, 660, 656, 652, 648, 0, 0, 0, 0, 0, 0, 0
    .short 648, 640, 636, 632, 628, 624, 620, 616, 612, 0, 0, 0, 0, 0, 0, 0
    .short 612, 604, 600, 596, 592, 588, 584, 580, 576, 0, 0, 0, 0, 0, 0, 0
    .short 576, 568, 564, 560, 556, 552, 548, 544, 540, 0, 0, 0, 0, 0, 0, 0
    .short 540, 532, 528, 524, 520, 516, 512, 508, 504, 0, 0, 0, 0, 0, 0, 0
    .short 504, 496, 492, 488, 484, 480, 476, 472, 468, 0, 0, 0, 0, 0, 0, 0
    .short 468, 460, 456, 452, 448, 444, 440, 436, 432, 0, 0, 0, 0, 0, 0, 0
    .short 432, 424, 420, 416, 412, 408, 404, 400, 396, 0, 0, 0, 0, 0, 0, 0
    .short 396, 388, 384, 380, 376, 372, 368, 364, 360, 0, 0, 0, 0, 0, 0, 0
    .short 360, 352, 348, 344, 340, 336, 332, 328, 324, 0, 0, 0, 0, 0, 0, 0
    .short 324, 316, 312, 308, 304, 300, 296, 292, 288, 0, 0, 0, 0, 0, 0, 0
    .short 288, 280, 276, 272, 268, 264, 260, 256, 252, 0, 0, 0, 0, 0, 0, 0
    .short 252, 244, 240, 236, 232, 228, 224, 220, 216, 0, 0, 0, 0, 0, 0, 0
    .short 216, 208, 204, 200, 196, 192, 188, 184, 180, 0, 0, 0, 0, 0, 0, 0
    .short 180, 172, 168, 164, 160, 156, 152, 148, 144, 0, 0, 0, 0, 0, 0, 0
    .short 144, 136, 132, 128, 124, 120, 116, 112, 108, 0, 0, 0, 0, 0, 0, 0
    .short 108, 100, 96, 92, 88, 84, 80, 76, 72, 0, 0, 0, 0, 0, 0, 0
    .short 72, 64, 60, 56, 52, 48, 44, 40, 36, 0, 0, 0, 0, 0, 0, 0
    .short 36, 28, 24, 20, 16, 12, 8, 4, 0, 0, 0, 0, 0, 0, 0, 0
    .long 0, 1, 2, 3, 4, 5, 6, 7, 128, 129, 130, 131, 132, 133, 134, 135, 256, 258, 260, 262, 384, 386, 388, 390, 512, 516, 640, 644, 768, 772, 896, 900, 1024, 1152, 1280, 1408, 1536, 1664, 1792, 1920, 2048, 2176, 2304, 2432, 2560, 2688, 2816, 2944, 1024, 1152, 1280, 1408, 1536, 1664, 1792, 1920, 2048, 2176, 2304, 2432, 2560, 2688, 2816, 2944
.size kgen_tab, 8448
text_end:
.section .rodata,"a"
.p2align 6
.amdhsa_kernel main_kernel
  .amdhsa_next_free_vgpr 168
  .amdhsa_next_free_sgpr 96
  .amdhsa_accum_offset 168
  .amdhsa_group_segment_fixed_size 0
  .amdhsa_kernarg_size 120
  .amdhsa_user_sgpr_count 2
  .amdhsa_user_sgpr_kernarg_segment_ptr 1
  .amdhsa_system_sgpr_workgroup_id_x 1
.end_amdhsa_kernel
```
